```python
import torch

def _softmax(x, axis=-1):
    return torch.softmax(x, dim=axis)

def _gelu(x):
    return torch.nn.functional.gelu(x, approximate='tanh')

def _silu(x):
    return torch.nn.functional.silu(x)

def _sigmoid(x):
    return torch.sigmoid(x)

def _layernorm(x, axis=-1, eps=1e-05):
    m = x.mean(dim=axis, keepdim=True)
    v = x.var(dim=axis, keepdim=True, unbiased=False)
    return (x - m) / torch.sqrt(v + eps)

def _scatter_add(tgt, idx, src, axis=0):
    return tgt.clone().index_add_(axis, idx, src)

def _segment_sum(src, seg, n):
    out = torch.zeros((n,) + src.shape[1:], dtype=src.dtype)
    return out.index_add_(0, seg, src)

def _pad(x, pw):
    flat = tuple((v for pair in reversed(pw) for v in pair))
    return torch.nn.functional.pad(x, flat)
kernel_name = 'interleave_layers__memory_aug_recurrent_mem_tr__glu_gated_swiglu__prompt'

def setup_inputs():

    _w = lambda a: (lambda t: t.to(torch.bfloat16) if t.is_floating_point() else t)(torch.as_tensor(a))

    def _A_setup():
        B, S, Dm = (1, 2048, 576)
        H, Dh = (32, 128)
        M, seg = (8, 32)
        seg = min(seg, S)
        S = S // seg * seg
        return {'x': _w((lambda *s: torch.randn(*s, dtype=torch.bfloat16) * 0.05)(B, S, Dm)), 'mem0': _w((lambda *s: torch.randn(*s, dtype=torch.bfloat16) * 0.2)(B, M, Dm)), 'Wq': _w((lambda *s: torch.randn(*s, dtype=torch.bfloat16) * 1.6)(Dm, H, Dh) * Dm ** (-0.5)), 'Wk': _w((lambda *s: torch.randn(*s, dtype=torch.bfloat16) * 1.6)(Dm, H, Dh) * Dm ** (-0.5)), 'Wv': _w((lambda *s: torch.randn(*s, dtype=torch.bfloat16) * 0.2)(Dm, H, Dh) * Dm ** (-0.5)), 'Wo': _w((lambda *s: torch.randn(*s, dtype=torch.bfloat16) * 0.2)(H, Dh, Dm) * (H * Dh) ** (-0.5)), 'seg_len': seg}
    _A_in = _A_setup()

    def _B_setup():
        B, S, D, F = (1, 2048, 576, 4608)
        return {'x': _w((lambda *s: torch.randn(*s, dtype=torch.bfloat16) * 0.05)(B, S, D)), 'w1': _w((lambda *s: torch.randn(*s, dtype=torch.bfloat16) * 0.2)(D, F) * (2.0 / D) ** 0.5), 'w3': _w((lambda *s: torch.randn(*s, dtype=torch.bfloat16) * 0.2)(D, F) * (2.0 / D) ** 0.5), 'w2': _w((lambda *s: torch.randn(*s, dtype=torch.bfloat16) * 0.2)(F, D) * (2.0 / F) ** 0.5)}
    _B_in = _B_setup()
    return {'A_x': _A_in['x'], 'A_mem0': _A_in['mem0'], 'A_Wq': _A_in['Wq'], 'A_Wk': _A_in['Wk'], 'A_Wv': _A_in['Wv'], 'A_Wo': _A_in['Wo'], 'A_seg_len': _A_in['seg_len'], 'B_x': _B_in['x'], 'B_w1': _B_in['w1'], 'B_w3': _B_in['w3'], 'B_w2': _B_in['w2']}

def reference(A_x, A_mem0, A_Wq, A_Wk, A_Wv, A_Wo, A_seg_len, B_x, B_w1, B_w3, B_w2):

    def _A_ref(x, mem0, Wq, Wk, Wv, Wo, seg_len):
        B, S, Dm = x.shape
        H, Dh = (Wq.shape[1], Wq.shape[2])
        M = mem0.shape[1]
        scale = Dh ** (-0.5)
        n_seg = S // seg_len
        L = M + seg_len
        idx = torch.arange(L)
        mask = (idx[:, None] < M) | (idx[:, None] >= idx[None, :])
        mem = mem0
        outs = []
        for s in range(n_seg):
            xs = x[:, s * seg_len:(s + 1) * seg_len, :].clone()
            h = torch.concatenate([mem, xs], axis=1)
            q = torch.einsum('btd,dhe->bhte', h, Wq)
            k = torch.einsum('btd,dhe->bhte', h, Wk)
            v = torch.einsum('btd,dhe->bhte', h, Wv)
            scores = torch.einsum('bhqe,bhke->bhqk', q, k) * scale
            scores = torch.where(mask[None, None], scores, -1000000000.0)
            p = _softmax(scores, axis=-1)
            o = torch.einsum('bhqk,bhke->bhqe', p, v)
            o = torch.einsum('bhte,hed->btd', o, Wo)
            mem = o[:, :M, :].clone()
            outs.append(o[:, M:, :])
        return torch.concatenate(outs, axis=1)

    def _B_ref(x, w1, w3, w2):
        gate = torch.einsum('bsd,df->bsf', x, w1)
        up = torch.einsum('bsd,df->bsf', x, w3)
        h = _silu(gate) * up
        out = torch.einsum('bsf,fd->bsd', h, w2)
        return out
    x = A_x
    x = x + _A_ref(_layernorm(x, axis=-1), A_mem0, A_Wq, A_Wk, A_Wv, A_Wo, A_seg_len)
    x = x + _B_ref(_layernorm(x, axis=-1), B_w1, B_w3, B_w2)
    x = x + _A_ref(_layernorm(x, axis=-1), A_mem0, A_Wq, A_Wk, A_Wv, A_Wo, A_seg_len)
    x = x + _B_ref(_layernorm(x, axis=-1), B_w1, B_w3, B_w2)
    return x
```

```asm
; @launch grid=(256,1,1) block=(256,1,1) lds=163840
.amdgcn_target "amdgcn-amd-amdhsa--gfx950"
.text
.globl interleave_layers__memory_aug_recurrent_mem_tr__glu_gated_swiglu__prompt_kernel
.p2align 8
.type interleave_layers__memory_aug_recurrent_mem_tr__glu_gated_swiglu__prompt_kernel,@function
interleave_layers__memory_aug_recurrent_mem_tr__glu_gated_swiglu__prompt_kernel:
s_cmp_ge_u32 s2, 256
s_cbranch_scc1 L_end
s_getpc_b64 s[56:57]
L_pc0:
s_sub_u32 s56, s56, L_pc0-interleave_layers__memory_aug_recurrent_mem_tr__glu_gated_swiglu__prompt_kernel
s_subb_u32 s57, s57, 0
s_lshr_b32 s58, s2, 3
s_and_b32 s58, s58, 31
s_mul_i32 s58, s58, (L_code_end-interleave_layers__memory_aug_recurrent_mem_tr__glu_gated_swiglu__prompt_kernel+32*4096-1)/(32*4096)*4096
v_lshlrev_b32 v2, 4, v0
v_add_u32 v2, s58, v2
v_add_u32 v3, 0, v2
v_min_u32 v3, L_code_end-interleave_layers__memory_aug_recurrent_mem_tr__glu_gated_swiglu__prompt_kernel-16, v3
global_load_dwordx4 v[200:203], v3, s[56:57]
v_add_u32 v3, 4096, v2
v_min_u32 v3, L_code_end-interleave_layers__memory_aug_recurrent_mem_tr__glu_gated_swiglu__prompt_kernel-16, v3
global_load_dwordx4 v[204:207], v3, s[56:57]
s_load_dwordx4 s[20:23], s[0:1], 0
s_load_dwordx4 s[24:27], s[0:1], 16
s_load_dwordx4 s[28:31], s[0:1], 32
s_load_dwordx4 s[32:35], s[0:1], 64
s_load_dwordx4 s[36:39], s[0:1], 80
s_load_dwordx4 s[40:43], s[0:1], 96
v_lshrrev_b32 v1, 6, v0
v_and_b32 v0, 63, v0
v_readfirstlane_b32 s3, v1
s_waitcnt lgkmcnt(0)
s_mov_b32 s4, s42
s_and_b32 s5, s43, 0xffff
s_mov_b32 s6, 268435456
s_mov_b32 s7, 0x20000
s_mov_b32 s12, s40
s_and_b32 s13, s41, 0xffff
s_mov_b32 s14, 256
s_mov_b32 s15, 0x20000
s_getreg_b32 s50, hwreg(HW_REG_XCC_ID, 0, 4)
s_and_b32 s50, s50, 7
s_cmp_lg_u32 s3, 0
s_cbranch_scc1 tk_1
v_mov_b32 v2, 1
s_lshl_b32 s51, s50, 2
s_cmp_ge_u32 s50, 2
s_cselect_b32 s52, 128, 0
s_add_u32 s51, s51, s52
v_mov_b32 v3, s51
s_mov_b64 exec, 1
buffer_atomic_add v2, v3, s[12:15], 0 offen sc0
s_waitcnt vmcnt(0)
v_readfirstlane_b32 s51, v2
s_mov_b32 s52, 1
s_cmp_lt_u32 s51, 32
s_cbranch_scc1 native_2
v_mov_b32 v2, 1
v_mov_b32 v3, 32
buffer_atomic_add v2, v3, s[12:15], 0 offen sc0
s_waitcnt vmcnt(0)
v_readfirstlane_b32 s53, v2
s_mov_b64 exec, 0xff
v_lshlrev_b32 v3, 2, v0
v_add_u32 v5, 128, v3
v_cmp_le_u32 vcc, 2, v0
s_nop 1
v_cndmask_b32 v3, v3, v5, vcc
s_mov_b32 s98, 0
olp_3:
buffer_load_dword v4, v3, s[12:15], 0 offen sc1
s_add_u32 s98, s98, 1
s_cmp_gt_u32 s98, 150000
s_cbranch_scc1 obad_4
s_waitcnt vmcnt(0)
s_mov_b32 s54, 0
v_readlane_b32 s55, v4, 0
s_nop 0
s_add_u32 s54, s54, s55
v_readlane_b32 s55, v4, 1
s_nop 0
s_add_u32 s54, s54, s55
v_readlane_b32 s55, v4, 2
s_nop 0
s_add_u32 s54, s54, s55
v_readlane_b32 s55, v4, 3
s_nop 0
s_add_u32 s54, s54, s55
v_readlane_b32 s55, v4, 4
s_nop 0
s_add_u32 s54, s54, s55
v_readlane_b32 s55, v4, 5
s_nop 0
s_add_u32 s54, s54, s55
v_readlane_b32 s55, v4, 6
s_nop 0
s_add_u32 s54, s54, s55
v_readlane_b32 s55, v4, 7
s_nop 0
s_add_u32 s54, s54, s55
s_cmp_lt_u32 s54, 256
s_cbranch_scc1 olp_3
v_readlane_b32 s55, v4, 0
s_nop 0
s_min_u32 s55, s55, 32
s_sub_u32 s54, 32, s55
s_cmp_ge_u32 s53, s54
s_cbranch_scc1 onx_6
s_mov_b32 s50, 0
s_add_u32 s51, s55, s53
s_branch ofin_5
onx_6:
s_sub_u32 s53, s53, s54
v_readlane_b32 s55, v4, 1
s_nop 0
s_min_u32 s55, s55, 32
s_sub_u32 s54, 32, s55
s_cmp_ge_u32 s53, s54
s_cbranch_scc1 onx_7
s_mov_b32 s50, 1
s_add_u32 s51, s55, s53
s_branch ofin_5
onx_7:
s_sub_u32 s53, s53, s54
v_readlane_b32 s55, v4, 2
s_nop 0
s_min_u32 s55, s55, 32
s_sub_u32 s54, 32, s55
s_cmp_ge_u32 s53, s54
s_cbranch_scc1 onx_8
s_mov_b32 s50, 2
s_add_u32 s51, s55, s53
s_branch ofin_5
onx_8:
s_sub_u32 s53, s53, s54
v_readlane_b32 s55, v4, 3
s_nop 0
s_min_u32 s55, s55, 32
s_sub_u32 s54, 32, s55
s_cmp_ge_u32 s53, s54
s_cbranch_scc1 onx_9
s_mov_b32 s50, 3
s_add_u32 s51, s55, s53
s_branch ofin_5
onx_9:
s_sub_u32 s53, s53, s54
v_readlane_b32 s55, v4, 4
s_nop 0
s_min_u32 s55, s55, 32
s_sub_u32 s54, 32, s55
s_cmp_ge_u32 s53, s54
s_cbranch_scc1 onx_10
s_mov_b32 s50, 4
s_add_u32 s51, s55, s53
s_branch ofin_5
onx_10:
s_sub_u32 s53, s53, s54
v_readlane_b32 s55, v4, 5
s_nop 0
s_min_u32 s55, s55, 32
s_sub_u32 s54, 32, s55
s_cmp_ge_u32 s53, s54
s_cbranch_scc1 onx_11
s_mov_b32 s50, 5
s_add_u32 s51, s55, s53
s_branch ofin_5
onx_11:
s_sub_u32 s53, s53, s54
v_readlane_b32 s55, v4, 6
s_nop 0
s_min_u32 s55, s55, 32
s_sub_u32 s54, 32, s55
s_cmp_ge_u32 s53, s54
s_cbranch_scc1 onx_12
s_mov_b32 s50, 6
s_add_u32 s51, s55, s53
s_branch ofin_5
onx_12:
s_sub_u32 s53, s53, s54
v_readlane_b32 s55, v4, 7
s_nop 0
s_min_u32 s55, s55, 32
s_sub_u32 s54, 32, s55
s_cmp_ge_u32 s53, s54
s_cbranch_scc1 onx_13
s_mov_b32 s50, 7
s_add_u32 s51, s55, s53
s_branch ofin_5
onx_13:
s_sub_u32 s53, s53, s54
obad_4:
s_mov_b32 s50, 8
ofin_5:
s_mov_b32 s52, 0x10001
native_2:
s_mov_b64 exec, 1
v_mov_b32 v3, 0
v_mov_b32 v4, s50
v_mov_b32 v5, s51
v_mov_b32 v6, s52
v_mov_b32 v7, 0
ds_write_b128 v3, v[4:7]
s_mov_b64 exec, -1
s_waitcnt lgkmcnt(0)
tk_1:
s_barrier
v_mov_b32 v3, 0
ds_read_b128 v[4:7], v3
s_waitcnt lgkmcnt(0)
v_readfirstlane_b32 s50, v4
v_readfirstlane_b32 s51, v5
v_readfirstlane_b32 s52, v6
s_barrier
s_cmp_ge_u32 s50, 8
s_cbranch_scc1 L_end
s_cmp_ge_u32 s51, 32
s_cbranch_scc1 L_end
s_mov_b32 s100, s50
s_cmp_lt_u32 s50, 2
s_cbranch_scc1 L_chain
s_getpc_b64 s[96:97]
pc_14:
s_add_u32 s96, s96, L_roles-pc_14
s_addc_u32 s97, s97, 0
s_lshl_b32 s53, s50, 5
s_add_u32 s53, s53, s51
s_lshl_b32 s53, s53, 1
v_mov_b32 v1, s53
global_load_ushort v1, v1, s[96:97]
s_waitcnt vmcnt(0)
v_readfirstlane_b32 s53, v1
s_nop 0
s_and_b32 s74, s53, 0xff
s_lshr_b32 s53, s53, 8
s_cmp_eq_u32 s53, 0
s_cbranch_scc1 H_up
s_cmp_eq_u32 s53, 1
s_cbranch_scc1 H_dn
s_cmp_eq_u32 s53, 2
s_cbranch_scc1 H_wo
s_cmp_eq_u32 s53, 3
s_cbranch_scc1 H_att
s_cmp_eq_u32 s53, 4
s_cbranch_scc1 H_red
H_qkv:
s_lshl_b32 s75, s74, 2
s_add_u32 s75, s75, s3
s_mul_i32 s76, s75, 3
v_bfe_u32 v1, v0, 4, 1
v_lshlrev_b32 v1, 10, v1
v_lshrrev_b32 v2, 5, v0
v_lshl_add_u32 v1, v2, 8, v1
v_and_b32 v2, 15, v0
v_lshl_add_u32 v5, v2, 4, v1
v_lshlrev_b32 v6, 4, v0
s_add_u32 s77, s76, 0
s_lshr_b32 s78, s77, 8
s_and_b32 s77, s77, 255
s_lshl_b32 s48, s77, 5
s_cmp_eq_u32 s78, 0
s_cselect_b32 s80, s24, s26
s_cselect_b32 s81, s25, s27
s_cmp_eq_u32 s78, 2
s_cselect_b32 s80, s28, s80
s_cselect_b32 s81, s29, s81
s_mov_b32 s8, s80
s_and_b32 s9, s81, 0xffff
s_mov_b32 s10, 4718592
s_mov_b32 s11, 0x20000
s_lshr_b32 s79, s77, 3
s_mul_i32 s79, s79, 24576
s_lshl_b32 s82, s78, 13
s_add_u32 s79, s79, s82
s_and_b32 s82, s77, 7
s_lshl_b32 s83, s82, 10
s_and_b32 s84, s82, 1
s_lshl_b32 s84, s84, 9
s_andn2_b32 s82, s83, 1024
s_add_u32 s82, s82, s84
s_cmp_eq_u32 s78, 2
s_cselect_b32 s82, s83, s82
s_cselect_b64 vcc, -1, 0
s_add_u32 s79, s79, s82
v_cndmask_b32 v7, v5, v6, vcc
v_add_u32 v19, s79, v7
s_add_u32 s77, s76, 1
s_lshr_b32 s78, s77, 8
s_and_b32 s77, s77, 255
s_lshl_b32 s49, s77, 5
s_cmp_eq_u32 s78, 0
s_cselect_b32 s80, s24, s26
s_cselect_b32 s81, s25, s27
s_cmp_eq_u32 s78, 2
s_cselect_b32 s80, s28, s80
s_cselect_b32 s81, s29, s81
s_mov_b32 s12, s80
s_and_b32 s13, s81, 0xffff
s_mov_b32 s14, 4718592
s_mov_b32 s15, 0x20000
s_lshr_b32 s79, s77, 3
s_mul_i32 s79, s79, 24576
s_lshl_b32 s82, s78, 13
s_add_u32 s79, s79, s82
s_and_b32 s82, s77, 7
s_lshl_b32 s83, s82, 10
s_and_b32 s84, s82, 1
s_lshl_b32 s84, s84, 9
s_andn2_b32 s82, s83, 1024
s_add_u32 s82, s82, s84
s_cmp_eq_u32 s78, 2
s_cselect_b32 s82, s83, s82
s_cselect_b64 vcc, -1, 0
s_add_u32 s79, s79, s82
v_cndmask_b32 v7, v5, v6, vcc
v_add_u32 v20, s79, v7
s_add_u32 s77, s76, 2
s_lshr_b32 s78, s77, 8
s_and_b32 s77, s77, 255
s_lshl_b32 s50, s77, 5
s_cmp_eq_u32 s78, 0
s_cselect_b32 s80, s24, s26
s_cselect_b32 s81, s25, s27
s_cmp_eq_u32 s78, 2
s_cselect_b32 s80, s28, s80
s_cselect_b32 s81, s29, s81
s_mov_b32 s16, s80
s_and_b32 s17, s81, 0xffff
s_mov_b32 s18, 4718592
s_mov_b32 s19, 0x20000
s_lshr_b32 s79, s77, 3
s_mul_i32 s79, s79, 24576
s_lshl_b32 s82, s78, 13
s_add_u32 s79, s79, s82
s_and_b32 s82, s77, 7
s_lshl_b32 s83, s82, 10
s_and_b32 s84, s82, 1
s_lshl_b32 s84, s84, 9
s_andn2_b32 s82, s83, 1024
s_add_u32 s82, s82, s84
s_cmp_eq_u32 s78, 2
s_cselect_b32 s82, s83, s82
s_cselect_b64 vcc, -1, 0
s_add_u32 s79, s79, s82
v_cndmask_b32 v7, v5, v6, vcc
v_add_u32 v21, s79, v7
s_getpc_b64 s[96:97]
pc_15:
s_add_u32 s96, s96, L_order_qkv-pc_15
s_addc_u32 s97, s97, 0
v_lshlrev_b32 v1, 2, v0
global_load_dword v36, v1, s[96:97]
global_load_dword v40, v1, s[96:97] offset:256
v_lshrrev_b32 v1, 5, v0
v_bfe_u32 v2, v0, 3, 1
v_lshl_add_u32 v1, v1, 1, v2
v_bfe_u32 v2, v0, 4, 1
v_bfe_u32 v3, v0, 1, 2
v_lshlrev_b32 v1, 3, v1
v_lshl_add_u32 v1, v2, 2, v1
v_add_u32 v1, v1, v3
v_mul_u32_u24 v1, 8192, v1
v_and_b32 v2, 1, v0
v_lshl_add_u32 v63, v2, 4, v1
s_mul_i32 s70, s3, 40960
v_lshrrev_b32 v1, 5, v0
v_lshlrev_b32 v1, 9, v1
v_bfe_u32 v2, v0, 4, 1
v_lshl_add_u32 v1, v2, 7, v1
v_add_u32 v1, s70, v1
v_and_b32 v2, 15, v0
v_lshl_add_u32 v2, v2, 3, v1
v_add_u32 v60, 0, v2
v_add_u32 v61, 1024, v2
v_add_u32 v62, 2048, v2
s_add_u32 m0, s70, 0
s_add_u32 s71, s48, 0
buffer_load_dwordx4 v63, s[8:11], s71 offen lds
s_add_u32 m0, s70, 1024
s_add_u32 s71, s49, 0
buffer_load_dwordx4 v63, s[12:15], s71 offen lds
s_add_u32 m0, s70, 2048
s_add_u32 s71, s50, 0
buffer_load_dwordx4 v63, s[16:19], s71 offen lds
s_add_u32 m0, s70, 3072
s_add_u32 s71, s48, 262144
buffer_load_dwordx4 v63, s[8:11], s71 offen lds
s_add_u32 m0, s70, 4096
s_add_u32 s71, s49, 262144
buffer_load_dwordx4 v63, s[12:15], s71 offen lds
s_add_u32 m0, s70, 5120
s_add_u32 s71, s50, 262144
buffer_load_dwordx4 v63, s[16:19], s71 offen lds
s_add_u32 m0, s70, 6144
s_add_u32 s71, s48, 524288
buffer_load_dwordx4 v63, s[8:11], s71 offen lds
s_add_u32 m0, s70, 7168
s_add_u32 s71, s49, 524288
buffer_load_dwordx4 v63, s[12:15], s71 offen lds
s_add_u32 m0, s70, 8192
s_add_u32 s71, s50, 524288
buffer_load_dwordx4 v63, s[16:19], s71 offen lds
s_add_u32 m0, s70, 9216
s_add_u32 s71, s48, 786432
buffer_load_dwordx4 v63, s[8:11], s71 offen lds
s_add_u32 m0, s70, 10240
s_add_u32 s71, s49, 786432
buffer_load_dwordx4 v63, s[12:15], s71 offen lds
s_add_u32 m0, s70, 11264
s_add_u32 s71, s50, 786432
buffer_load_dwordx4 v63, s[16:19], s71 offen lds
s_add_u32 m0, s70, 12288
s_add_u32 s71, s48, 1048576
buffer_load_dwordx4 v63, s[8:11], s71 offen lds
s_add_u32 m0, s70, 13312
s_add_u32 s71, s49, 1048576
buffer_load_dwordx4 v63, s[12:15], s71 offen lds
s_add_u32 m0, s70, 14336
s_add_u32 s71, s50, 1048576
buffer_load_dwordx4 v63, s[16:19], s71 offen lds
s_add_u32 m0, s70, 15360
s_add_u32 s71, s48, 1310720
buffer_load_dwordx4 v63, s[8:11], s71 offen lds
s_add_u32 m0, s70, 16384
s_add_u32 s71, s49, 1310720
buffer_load_dwordx4 v63, s[12:15], s71 offen lds
s_add_u32 m0, s70, 17408
s_add_u32 s71, s50, 1310720
buffer_load_dwordx4 v63, s[16:19], s71 offen lds
s_add_u32 m0, s70, 18432
s_add_u32 s71, s48, 1572864
buffer_load_dwordx4 v63, s[8:11], s71 offen lds
s_add_u32 m0, s70, 19456
s_add_u32 s71, s49, 1572864
buffer_load_dwordx4 v63, s[12:15], s71 offen lds
s_add_u32 m0, s70, 20480
s_add_u32 s71, s50, 1572864
buffer_load_dwordx4 v63, s[16:19], s71 offen lds
s_add_u32 m0, s70, 21504
s_add_u32 s71, s48, 1835008
buffer_load_dwordx4 v63, s[8:11], s71 offen lds
s_add_u32 m0, s70, 22528
s_add_u32 s71, s49, 1835008
buffer_load_dwordx4 v63, s[12:15], s71 offen lds
s_add_u32 m0, s70, 23552
s_add_u32 s71, s50, 1835008
buffer_load_dwordx4 v63, s[16:19], s71 offen lds
s_add_u32 m0, s70, 24576
s_add_u32 s71, s48, 2097152
buffer_load_dwordx4 v63, s[8:11], s71 offen lds
s_add_u32 m0, s70, 25600
s_add_u32 s71, s49, 2097152
buffer_load_dwordx4 v63, s[12:15], s71 offen lds
s_add_u32 m0, s70, 26624
s_add_u32 s71, s50, 2097152
buffer_load_dwordx4 v63, s[16:19], s71 offen lds
s_add_u32 m0, s70, 27648
s_add_u32 s71, s48, 2359296
buffer_load_dwordx4 v63, s[8:11], s71 offen lds
s_add_u32 m0, s70, 28672
s_add_u32 s71, s49, 2359296
buffer_load_dwordx4 v63, s[12:15], s71 offen lds
s_add_u32 m0, s70, 29696
s_add_u32 s71, s50, 2359296
buffer_load_dwordx4 v63, s[16:19], s71 offen lds
s_add_u32 m0, s70, 30720
s_add_u32 s71, s48, 2621440
buffer_load_dwordx4 v63, s[8:11], s71 offen lds
s_add_u32 m0, s70, 31744
s_add_u32 s71, s49, 2621440
buffer_load_dwordx4 v63, s[12:15], s71 offen lds
s_add_u32 m0, s70, 32768
s_add_u32 s71, s50, 2621440
buffer_load_dwordx4 v63, s[16:19], s71 offen lds
s_add_u32 m0, s70, 33792
s_add_u32 s71, s48, 2883584
buffer_load_dwordx4 v63, s[8:11], s71 offen lds
s_add_u32 m0, s70, 34816
s_add_u32 s71, s49, 2883584
buffer_load_dwordx4 v63, s[12:15], s71 offen lds
s_add_u32 m0, s70, 35840
s_add_u32 s71, s50, 2883584
buffer_load_dwordx4 v63, s[16:19], s71 offen lds
s_add_u32 m0, s70, 36864
s_add_u32 s71, s48, 3145728
buffer_load_dwordx4 v63, s[8:11], s71 offen lds
s_add_u32 m0, s70, 37888
s_add_u32 s71, s49, 3145728
buffer_load_dwordx4 v63, s[12:15], s71 offen lds
s_add_u32 m0, s70, 38912
s_add_u32 s71, s50, 3145728
buffer_load_dwordx4 v63, s[16:19], s71 offen lds
s_waitcnt vmcnt(36)
ds_read_b64_tr_b16 a[0:1], v60 offset:0
ds_read_b64_tr_b16 a[2:3], v60 offset:256
ds_read_b64_tr_b16 a[72:73], v61 offset:0
ds_read_b64_tr_b16 a[74:75], v61 offset:256
ds_read_b64_tr_b16 a[144:145], v62 offset:0
ds_read_b64_tr_b16 a[146:147], v62 offset:256
s_waitcnt lgkmcnt(0)
s_add_u32 m0, s70, 0
s_add_u32 s71, s48, 3407872
buffer_load_dwordx4 v63, s[8:11], s71 offen lds
s_add_u32 m0, s70, 1024
s_add_u32 s71, s49, 3407872
buffer_load_dwordx4 v63, s[12:15], s71 offen lds
s_add_u32 m0, s70, 2048
s_add_u32 s71, s50, 3407872
buffer_load_dwordx4 v63, s[16:19], s71 offen lds
s_waitcnt vmcnt(36)
ds_read_b64_tr_b16 a[4:5], v60 offset:3072
ds_read_b64_tr_b16 a[6:7], v60 offset:3328
ds_read_b64_tr_b16 a[76:77], v61 offset:3072
ds_read_b64_tr_b16 a[78:79], v61 offset:3328
ds_read_b64_tr_b16 a[148:149], v62 offset:3072
ds_read_b64_tr_b16 a[150:151], v62 offset:3328
s_waitcnt lgkmcnt(0)
s_add_u32 m0, s70, 3072
s_add_u32 s71, s48, 3670016
buffer_load_dwordx4 v63, s[8:11], s71 offen lds
s_add_u32 m0, s70, 4096
s_add_u32 s71, s49, 3670016
buffer_load_dwordx4 v63, s[12:15], s71 offen lds
s_add_u32 m0, s70, 5120
s_add_u32 s71, s50, 3670016
buffer_load_dwordx4 v63, s[16:19], s71 offen lds
s_waitcnt vmcnt(36)
ds_read_b64_tr_b16 a[8:9], v60 offset:6144
ds_read_b64_tr_b16 a[10:11], v60 offset:6400
ds_read_b64_tr_b16 a[80:81], v61 offset:6144
ds_read_b64_tr_b16 a[82:83], v61 offset:6400
ds_read_b64_tr_b16 a[152:153], v62 offset:6144
ds_read_b64_tr_b16 a[154:155], v62 offset:6400
s_waitcnt lgkmcnt(0)
s_add_u32 m0, s70, 6144
s_add_u32 s71, s48, 3932160
buffer_load_dwordx4 v63, s[8:11], s71 offen lds
s_add_u32 m0, s70, 7168
s_add_u32 s71, s49, 3932160
buffer_load_dwordx4 v63, s[12:15], s71 offen lds
s_add_u32 m0, s70, 8192
s_add_u32 s71, s50, 3932160
buffer_load_dwordx4 v63, s[16:19], s71 offen lds
s_waitcnt vmcnt(36)
ds_read_b64_tr_b16 a[12:13], v60 offset:9216
ds_read_b64_tr_b16 a[14:15], v60 offset:9472
ds_read_b64_tr_b16 a[84:85], v61 offset:9216
ds_read_b64_tr_b16 a[86:87], v61 offset:9472
ds_read_b64_tr_b16 a[156:157], v62 offset:9216
ds_read_b64_tr_b16 a[158:159], v62 offset:9472
s_waitcnt lgkmcnt(0)
s_add_u32 m0, s70, 9216
s_add_u32 s71, s48, 4194304
buffer_load_dwordx4 v63, s[8:11], s71 offen lds
s_add_u32 m0, s70, 10240
s_add_u32 s71, s49, 4194304
buffer_load_dwordx4 v63, s[12:15], s71 offen lds
s_add_u32 m0, s70, 11264
s_add_u32 s71, s50, 4194304
buffer_load_dwordx4 v63, s[16:19], s71 offen lds
s_waitcnt vmcnt(36)
ds_read_b64_tr_b16 a[16:17], v60 offset:12288
ds_read_b64_tr_b16 a[18:19], v60 offset:12544
ds_read_b64_tr_b16 a[88:89], v61 offset:12288
ds_read_b64_tr_b16 a[90:91], v61 offset:12544
ds_read_b64_tr_b16 a[160:161], v62 offset:12288
ds_read_b64_tr_b16 a[162:163], v62 offset:12544
s_waitcnt lgkmcnt(0)
s_add_u32 m0, s70, 12288
s_add_u32 s71, s48, 4456448
buffer_load_dwordx4 v63, s[8:11], s71 offen lds
s_add_u32 m0, s70, 13312
s_add_u32 s71, s49, 4456448
buffer_load_dwordx4 v63, s[12:15], s71 offen lds
s_add_u32 m0, s70, 14336
s_add_u32 s71, s50, 4456448
buffer_load_dwordx4 v63, s[16:19], s71 offen lds
s_waitcnt vmcnt(36)
ds_read_b64_tr_b16 a[20:21], v60 offset:15360
ds_read_b64_tr_b16 a[22:23], v60 offset:15616
ds_read_b64_tr_b16 a[92:93], v61 offset:15360
ds_read_b64_tr_b16 a[94:95], v61 offset:15616
ds_read_b64_tr_b16 a[164:165], v62 offset:15360
ds_read_b64_tr_b16 a[166:167], v62 offset:15616
s_waitcnt vmcnt(33)
ds_read_b64_tr_b16 a[24:25], v60 offset:18432
ds_read_b64_tr_b16 a[26:27], v60 offset:18688
ds_read_b64_tr_b16 a[96:97], v61 offset:18432
ds_read_b64_tr_b16 a[98:99], v61 offset:18688
ds_read_b64_tr_b16 a[168:169], v62 offset:18432
ds_read_b64_tr_b16 a[170:171], v62 offset:18688
s_waitcnt vmcnt(30)
ds_read_b64_tr_b16 a[28:29], v60 offset:21504
ds_read_b64_tr_b16 a[30:31], v60 offset:21760
ds_read_b64_tr_b16 a[100:101], v61 offset:21504
ds_read_b64_tr_b16 a[102:103], v61 offset:21760
ds_read_b64_tr_b16 a[172:173], v62 offset:21504
ds_read_b64_tr_b16 a[174:175], v62 offset:21760
s_waitcnt vmcnt(27)
ds_read_b64_tr_b16 a[32:33], v60 offset:24576
ds_read_b64_tr_b16 a[34:35], v60 offset:24832
ds_read_b64_tr_b16 a[104:105], v61 offset:24576
ds_read_b64_tr_b16 a[106:107], v61 offset:24832
ds_read_b64_tr_b16 a[176:177], v62 offset:24576
ds_read_b64_tr_b16 a[178:179], v62 offset:24832
s_waitcnt vmcnt(24)
ds_read_b64_tr_b16 a[36:37], v60 offset:27648
ds_read_b64_tr_b16 a[38:39], v60 offset:27904
ds_read_b64_tr_b16 a[108:109], v61 offset:27648
ds_read_b64_tr_b16 a[110:111], v61 offset:27904
ds_read_b64_tr_b16 a[180:181], v62 offset:27648
ds_read_b64_tr_b16 a[182:183], v62 offset:27904
s_waitcnt vmcnt(21)
ds_read_b64_tr_b16 a[40:41], v60 offset:30720
ds_read_b64_tr_b16 a[42:43], v60 offset:30976
ds_read_b64_tr_b16 a[112:113], v61 offset:30720
ds_read_b64_tr_b16 a[114:115], v61 offset:30976
ds_read_b64_tr_b16 a[184:185], v62 offset:30720
ds_read_b64_tr_b16 a[186:187], v62 offset:30976
s_waitcnt vmcnt(18)
ds_read_b64_tr_b16 a[44:45], v60 offset:33792
ds_read_b64_tr_b16 a[46:47], v60 offset:34048
ds_read_b64_tr_b16 a[116:117], v61 offset:33792
ds_read_b64_tr_b16 a[118:119], v61 offset:34048
ds_read_b64_tr_b16 a[188:189], v62 offset:33792
ds_read_b64_tr_b16 a[190:191], v62 offset:34048
s_waitcnt vmcnt(15)
ds_read_b64_tr_b16 a[48:49], v60 offset:36864
ds_read_b64_tr_b16 a[50:51], v60 offset:37120
ds_read_b64_tr_b16 a[120:121], v61 offset:36864
ds_read_b64_tr_b16 a[122:123], v61 offset:37120
ds_read_b64_tr_b16 a[192:193], v62 offset:36864
ds_read_b64_tr_b16 a[194:195], v62 offset:37120
s_waitcnt vmcnt(12)
ds_read_b64_tr_b16 a[52:53], v60 offset:0
ds_read_b64_tr_b16 a[54:55], v60 offset:256
ds_read_b64_tr_b16 a[124:125], v61 offset:0
ds_read_b64_tr_b16 a[126:127], v61 offset:256
ds_read_b64_tr_b16 a[196:197], v62 offset:0
ds_read_b64_tr_b16 a[198:199], v62 offset:256
s_waitcnt vmcnt(9)
ds_read_b64_tr_b16 a[56:57], v60 offset:3072
ds_read_b64_tr_b16 a[58:59], v60 offset:3328
ds_read_b64_tr_b16 a[128:129], v61 offset:3072
ds_read_b64_tr_b16 a[130:131], v61 offset:3328
ds_read_b64_tr_b16 a[200:201], v62 offset:3072
ds_read_b64_tr_b16 a[202:203], v62 offset:3328
s_waitcnt vmcnt(6)
ds_read_b64_tr_b16 a[60:61], v60 offset:6144
ds_read_b64_tr_b16 a[62:63], v60 offset:6400
ds_read_b64_tr_b16 a[132:133], v61 offset:6144
ds_read_b64_tr_b16 a[134:135], v61 offset:6400
ds_read_b64_tr_b16 a[204:205], v62 offset:6144
ds_read_b64_tr_b16 a[206:207], v62 offset:6400
s_waitcnt vmcnt(3)
ds_read_b64_tr_b16 a[64:65], v60 offset:9216
ds_read_b64_tr_b16 a[66:67], v60 offset:9472
ds_read_b64_tr_b16 a[136:137], v61 offset:9216
ds_read_b64_tr_b16 a[138:139], v61 offset:9472
ds_read_b64_tr_b16 a[208:209], v62 offset:9216
ds_read_b64_tr_b16 a[210:211], v62 offset:9472
s_waitcnt vmcnt(0)
ds_read_b64_tr_b16 a[68:69], v60 offset:12288
ds_read_b64_tr_b16 a[70:71], v60 offset:12544
ds_read_b64_tr_b16 a[140:141], v61 offset:12288
ds_read_b64_tr_b16 a[142:143], v61 offset:12544
ds_read_b64_tr_b16 a[212:213], v62 offset:12288
ds_read_b64_tr_b16 a[214:215], v62 offset:12544
s_waitcnt lgkmcnt(0)
v_lshrrev_b32 v1, 3, v0
v_bfe_u32 v2, v0, 1, 2
v_lshrrev_b32 v3, 5, v0
v_lshlrev_b32 v3, 1, v3
v_xor_b32 v2, v2, v3
v_mul_u32_u24 v1, 2304, v1
v_lshl_add_u32 v1, v2, 5, v1
v_and_b32 v2, 1, v0
v_lshl_add_u32 v1, v2, 4, v1
s_and_b32 s70, s3, 1
s_mul_i32 s70, s70, 18432
s_lshr_b32 s71, s3, 1
s_lshl_b32 s71, s71, 7
s_add_u32 s70, s70, s71
v_add_u32 v1, s70, v1
v_add_u32 v8, 4096, v1
v_add_u32 v9, 3328, v1
v_add_u32 v10, 2560, v1
v_add_u32 v11, 1792, v1
v_add_u32 v12, 5120, v1
v_add_u32 v13, 4352, v1
v_add_u32 v14, 3584, v1
v_add_u32 v15, 2816, v1
v_add_u32 v16, 6144, v1
v_bfe_u32 v1, v0, 1, 3
v_lshlrev_b32 v1, 7, v1
v_lshrrev_b32 v2, 4, v0
v_bfe_u32 v3, v0, 3, 1
v_lshlrev_b32 v3, 1, v3
v_xor_b32 v2, v2, v3
v_lshl_add_u32 v1, v2, 5, v1
v_and_b32 v2, 1, v0
v_lshl_add_u32 v17, v2, 4, v1
v_and_b32 v2, 31, v0
v_add_u32 v1, 0, v2
v_mul_u32_u24 v1, 128, v1
v_lshrrev_b32 v3, 5, v0
v_mul_u32_u24 v3, 32768, v3
v_add_u32 v1, 0, v1
v_add_u32 v1, v1, v3
v_mov_b32 v3, 2147483632
s_cmp_eq_u32 s3, 0
s_cselect_b32 s71, 16, 0
v_cmp_gt_u32 vcc, s71, v2
s_nop 1
v_cndmask_b32 v22, v3, v1, vcc
s_mov_b32 s56, 0xffff
s_mov_b32 s57, 0
s_mul_i32 s70, s74, 128
s_add_u32 s70, s70, 2048
v_mov_b32 v1, s70
s_min_u32 s71, s71, 1
v_cmp_gt_u32 vcc, s71, v0
s_nop 1
v_cndmask_b32 v44, v3, v1, vcc
v_add_u32 v45, 65536, v44
s_getpc_b64 s[96:97]
pc_16:
s_add_u32 s96, s96, L_writers-pc_16
s_addc_u32 s97, s97, 0
v_subrev_u32 v23, 0, v22
v_lshrrev_b32 v23, 7, v23
v_cmp_gt_u32 vcc, 0x200, v23
s_nop 1
v_cndmask_b32 v23, 0, v23, vcc
global_load_ubyte v23, v23, s[96:97]
s_mov_b32 s44, 1368064
s_mov_b32 s46, 10805248
s_mov_b32 s45, 3727360
s_mov_b32 s47, 61136896
v_lshrrev_b32 v1, 8, v36
v_and_b32 v2, 0xff, v36
v_add_u32 v3, 1, v2
v_cmp_gt_u32 vcc, 64, v2
s_nop 1
v_cndmask_b32 v36, -1, v3, vcc
v_lshlrev_b32 v37, 5, v1
v_min_u32 v2, 63, v2
v_cmp_eq_u32 vcc, 0, v1
v_mov_b32 v3, s45
v_mov_b32 v4, s44
v_cndmask_b32 v3, v3, v4, vcc
s_mov_b32 s70, 36864
v_mul_lo_u32 v4, v2, s70
v_add_u32 v38, v3, v4
v_mov_b32 v3, s47
v_mov_b32 v4, s46
v_cndmask_b32 v3, v3, v4, vcc
s_mov_b32 s70, 786432
v_mul_lo_u32 v4, v2, s70
v_add_u32 v39, v3, v4
v_subrev_u32 v38, 4096, v38
v_lshrrev_b32 v1, 8, v40
v_and_b32 v2, 0xff, v40
v_add_u32 v3, 1, v2
v_cmp_gt_u32 vcc, 64, v2
s_nop 1
v_cndmask_b32 v40, -1, v3, vcc
v_lshlrev_b32 v41, 5, v1
v_min_u32 v2, 63, v2
v_cmp_eq_u32 vcc, 0, v1
v_mov_b32 v3, s45
v_mov_b32 v4, s44
v_cndmask_b32 v3, v3, v4, vcc
s_mov_b32 s70, 36864
v_mul_lo_u32 v4, v2, s70
v_add_u32 v42, v3, v4
v_mov_b32 v3, s47
v_mov_b32 v4, s46
v_cndmask_b32 v3, v3, v4, vcc
s_mov_b32 s70, 786432
v_mul_lo_u32 v4, v2, s70
v_add_u32 v43, v3, v4
v_subrev_u32 v42, 4096, v42
s_mov_b32 s76, 1
s_mov_b32 s77, 0
s_add_u32 s78, s44, 4294963200
s_add_u32 s79, s46, 0
s_mov_b32 s80, 0
s_mov_b32 s81, 2
s_mov_b32 s82, 0
s_add_u32 s83, s44, 32768
s_add_u32 s84, s46, 786432
s_mov_b32 s85, 0
s_mov_b32 s91, 0
s_mov_b32 s92, 1835008
s_mov_b32 s94, 1879048192
s_cmp_lt_u32 s75, 170
s_cbranch_scc1 G_sss18
s_cmp_eq_u32 s75, 170
s_cbranch_scc1 G_ssv18
s_mov_b32 s8, s42
s_and_b32 s9, s43, 0xffff
s_mov_b32 s10, 0
s_mov_b32 s11, 0x20000
s_mov_b32 s52, 0
s_mul_i32 s72, s3, 9216
s_add_u32 s73, s72, 36864
s_add_u32 s74, s72, 73728
s_add_u32 s75, s72, 110592
s_mov_b32 s54, 0xbfb8aa3b
v_add_u32 v28, 0, v17
v_add_u32 v29, 36864, v17
v_add_u32 v30, 73728, v17
v_add_u32 v31, 110592, v17
v_lshlrev_b32 v1, 2, v0
v_add_u32 v32, 147456, v1
s_lshl_b32 s70, s3, 8
v_add_u32 v18, s70, v32
v_mov_b64 v[224:225], 0
v_mov_b64 v[236:237], 0
v_mov_b64 v[226:227], 0
v_mov_b64 v[238:239], 0
v_mov_b64 v[228:229], 0
v_mov_b64 v[240:241], 0
v_mov_b64 v[230:231], 0
v_mov_b64 v[242:243], 0
s_mov_b32 s12, s40
s_and_b32 s13, s41, 0xffff
s_mov_b32 s14, 256
s_mov_b32 s15, 0x20000
v_lshlrev_b32 v26, 2, v0
v_add_u32 v27, 128, v26
v_cmp_le_u32 vcc, 2, v0
s_nop 1
v_cndmask_b32 v26, v26, v27, vcc
v_mov_b32 v27, 192
v_cmp_eq_u32 vcc, 8, v0
s_nop 1
v_cndmask_b32 v26, v26, v27, vcc
v_mov_b32 v27, 2147483632
v_cmp_lt_u32 vcc, 8, v0
s_nop 1
v_cndmask_b32 v26, v26, v27, vcc
s_mov_b32 s98, 0
wi_loop_26:
buffer_load_dword v27, v26, s[12:15], 0 offen sc1
s_add_u32 s98, s98, 1
s_cmp_gt_u32 s98, 150000
s_cbranch_scc1 wi_bad_28
s_waitcnt vmcnt(0)
v_cmp_eq_u32 vcc, 32, v27
s_nop 0
s_and_b32 s97, vcc_lo, 0x1ff
s_cmp_eq_u32 s97, 0x1ff
s_cbranch_scc1 wi_ok_27
v_cmp_lt_u32 vcc, 32, v27
s_nop 0
s_and_b32 s96, vcc_lo, 0xff
s_cselect_b32 s96, 0x100, 0
s_and_b32 s96, s96, s97
s_cbranch_scc1 wi_over_29
s_sleep 8
s_branch wi_loop_26
wi_bad_28:
s_mov_b32 s98, 512
s_branch L_fail
wi_over_29:
s_mov_b32 s100, 255
wi_ok_27:
v_add_u32 v26, 65536, v22
v_cmp_eq_u32 vcc, s100, v23
s_nop 1
v_cndmask_b32 v22, v22, v26, vcc
s_cmp_lg_u32 s3, 0
s_cbranch_scc1 sp_ok_31
s_mov_b32 s55, 0
sp_loop_30:
s_lshl_b64 exec, s[56:57], s77
buffer_load_dword v26, v22, s[4:7], 0 offen sc1
s_mov_b64 exec, -1
s_add_u32 s55, s55, 1
s_cmp_gt_u32 s55, 150000
s_cbranch_scc1 sp_bad_32
s_waitcnt vmcnt(0)
v_cmp_gt_u32 vcc, s76, v26
s_nop 0
s_lshr_b64 s[58:59], vcc, s77
s_and_b32 s58, s58, s56
s_cbranch_scc0 sp_ok_31
s_sleep 1
s_branch sp_loop_30
sp_bad_32:
s_mov_b32 s98, 1025
s_branch L_fail
sp_ok_31:
s_barrier
s_add_u32 m0, s72, 0
s_nop 0
buffer_load_dwordx4 v8, s[4:7], s78 offen offset:0 sc1 lds
buffer_load_dwordx4 v9, s[4:7], s78 offen offset:1024 sc1 lds
buffer_load_dwordx4 v10, s[4:7], s78 offen offset:2048 sc1 lds
buffer_load_dwordx4 v11, s[4:7], s78 offen offset:3072 sc1 lds
s_add_u32 m0, s72, 4096
s_nop 0
buffer_load_dwordx4 v12, s[4:7], s78 offen offset:0 sc1 lds
buffer_load_dwordx4 v13, s[4:7], s78 offen offset:1024 sc1 lds
buffer_load_dwordx4 v14, s[4:7], s78 offen offset:2048 sc1 lds
buffer_load_dwordx4 v15, s[4:7], s78 offen offset:3072 sc1 lds
s_add_u32 m0, s72, 8192
s_nop 0
buffer_load_dwordx4 v16, s[4:7], s78 offen offset:0 sc1 lds
s_waitcnt vmcnt(0)
g_join_21:
s_barrier
ds_read_b128 v[64:67], v28 offset:0
ds_read_b128 v[68:71], v28 offset:9216
ds_read_b128 v[72:75], v28 offset:18432
ds_read_b128 v[76:79], v28 offset:27648
ds_read_b128 v[80:83], v28 offset:1024
ds_read_b128 v[84:87], v28 offset:10240
ds_read_b128 v[88:91], v28 offset:19456
ds_read_b128 v[92:95], v28 offset:28672
g_body_17:
s_waitcnt lgkmcnt(4)
v_mfma_f32_16x16x32_bf16 v[208:211], v[64:67], a[0:3], 0
ds_read_b128 v[96:99], v28 offset:2048
s_add_u32 m0, s73, 4096
v_mfma_f32_16x16x32_bf16 v[212:215], v[68:71], a[0:3], 0
ds_read_b128 v[100:103], v28 offset:11264
buffer_load_dwordx4 v12, s[8:11], s83 offen offset:0 sc1 lds
v_mfma_f32_16x16x32_bf16 v[216:219], v[64:67], a[72:75], 0
v_mfma_f32_16x16x32_bf16 v[208:211], v[72:75], a[4:7], v[208:211]
ds_read_b128 v[104:107], v28 offset:20480
v_cvt_pk_bf16_f32 v56, v224, v225
v_mfma_f32_16x16x32_bf16 v[212:215], v[76:79], a[4:7], v[212:215]
ds_read_b128 v[108:111], v28 offset:29696
buffer_load_dwordx4 v13, s[8:11], s83 offen offset:1024 sc1 lds
v_mfma_f32_16x16x32_bf16 v[220:223], v[68:71], a[72:75], 0
v_cvt_pk_bf16_f32 v57, v226, v227
s_waitcnt lgkmcnt(4)
v_mfma_f32_16x16x32_bf16 v[208:211], v[80:83], a[8:11], v[208:211]
ds_read_b128 v[112:115], v28 offset:3072
v_cvt_pk_bf16_f32 v58, v228, v229
v_mfma_f32_16x16x32_bf16 v[212:215], v[84:87], a[8:11], v[212:215]
ds_read_b128 v[116:119], v28 offset:12288
v_cvt_pk_bf16_f32 v59, v230, v231
v_mfma_f32_16x16x32_bf16 v[216:219], v[72:75], a[76:79], v[216:219]
buffer_load_dwordx4 v14, s[8:11], s83 offen offset:2048 sc1 lds
v_mfma_f32_16x16x32_bf16 v[208:211], v[88:91], a[12:15], v[208:211]
ds_read_b128 v[120:123], v28 offset:21504
v_mfma_f32_16x16x32_bf16 v[212:215], v[92:95], a[12:15], v[212:215]
ds_read_b128 v[124:127], v28 offset:30720
v_mfma_f32_16x16x32_bf16 v[220:223], v[76:79], a[76:79], v[220:223]
s_waitcnt lgkmcnt(4)
v_mfma_f32_16x16x32_bf16 v[208:211], v[96:99], a[16:19], v[208:211]
ds_read_b128 v[128:131], v28 offset:4096
buffer_load_dwordx4 v15, s[8:11], s83 offen offset:3072 sc1 lds
v_mfma_f32_16x16x32_bf16 v[212:215], v[100:103], a[16:19], v[212:215]
ds_read_b128 v[132:135], v28 offset:13312
v_mfma_f32_16x16x32_bf16 v[216:219], v[80:83], a[80:83], v[216:219]
buffer_store_dwordx4 v[56:59], v21, s[4:7], s94 offen sc1
v_mfma_f32_16x16x32_bf16 v[208:211], v[104:107], a[20:23], v[208:211]
ds_read_b128 v[136:139], v28 offset:22528
s_add_u32 m0, s73, 8192
v_mfma_f32_16x16x32_bf16 v[212:215], v[108:111], a[20:23], v[212:215]
ds_read_b128 v[140:143], v28 offset:31744
buffer_load_dwordx4 v16, s[8:11], s83 offen offset:0 sc1 lds
v_mfma_f32_16x16x32_bf16 v[220:223], v[84:87], a[80:83], v[220:223]
s_and_b32 s70, s52, 63
s_waitcnt lgkmcnt(4)
v_mfma_f32_16x16x32_bf16 v[208:211], v[112:115], a[24:27], v[208:211]
ds_read_b128 v[144:147], v28 offset:5120
v_mfma_f32_16x16x32_bf16 v[212:215], v[116:119], a[24:27], v[212:215]
ds_read_b128 v[148:151], v28 offset:14336
v_mfma_f32_16x16x32_bf16 v[216:219], v[88:91], a[84:87], v[216:219]
v_readlane_b32 s86, v36, s70
v_mfma_f32_16x16x32_bf16 v[208:211], v[120:123], a[28:31], v[208:211]
ds_read_b128 v[152:155], v28 offset:23552
v_mfma_f32_16x16x32_bf16 v[212:215], v[124:127], a[28:31], v[212:215]
ds_read_b128 v[156:159], v28 offset:32768
v_mfma_f32_16x16x32_bf16 v[220:223], v[92:95], a[84:87], v[220:223]
s_waitcnt lgkmcnt(4)
v_mfma_f32_16x16x32_bf16 v[208:211], v[128:131], a[32:35], v[208:211]
ds_read_b128 v[160:163], v28 offset:6144
v_mfma_f32_16x16x32_bf16 v[212:215], v[132:135], a[32:35], v[212:215]
ds_read_b128 v[164:167], v28 offset:15360
v_mfma_f32_16x16x32_bf16 v[216:219], v[96:99], a[88:91], v[216:219]
v_readlane_b32 s87, v37, s70
v_mfma_f32_16x16x32_bf16 v[208:211], v[136:139], a[36:39], v[208:211]
ds_read_b128 v[168:171], v28 offset:24576
v_mfma_f32_16x16x32_bf16 v[212:215], v[140:143], a[36:39], v[212:215]
ds_read_b128 v[172:175], v28 offset:33792
v_mfma_f32_16x16x32_bf16 v[220:223], v[100:103], a[88:91], v[220:223]
s_waitcnt lgkmcnt(4)
v_mfma_f32_16x16x32_bf16 v[208:211], v[144:147], a[40:43], v[208:211]
ds_read_b128 v[176:179], v28 offset:7168
v_mfma_f32_16x16x32_bf16 v[212:215], v[148:151], a[40:43], v[212:215]
ds_read_b128 v[180:183], v28 offset:16384
v_mfma_f32_16x16x32_bf16 v[216:219], v[104:107], a[92:95], v[216:219]
v_readlane_b32 s88, v38, s70
v_mfma_f32_16x16x32_bf16 v[208:211], v[152:155], a[44:47], v[208:211]
ds_read_b128 v[184:187], v28 offset:25600
v_mfma_f32_16x16x32_bf16 v[212:215], v[156:159], a[44:47], v[212:215]
ds_read_b128 v[188:191], v28 offset:34816
v_mfma_f32_16x16x32_bf16 v[220:223], v[108:111], a[92:95], v[220:223]
s_waitcnt lgkmcnt(4)
v_mfma_f32_16x16x32_bf16 v[208:211], v[160:163], a[48:51], v[208:211]
ds_read_b128 v[192:195], v28 offset:8192
v_mfma_f32_16x16x32_bf16 v[212:215], v[164:167], a[48:51], v[212:215]
ds_read_b128 v[196:199], v28 offset:17408
v_mfma_f32_16x16x32_bf16 v[216:219], v[112:115], a[96:99], v[216:219]
buffer_load_dword v24, v22, s[4:7], 0 offen sc1
v_mfma_f32_16x16x32_bf16 v[208:211], v[168:171], a[52:55], v[208:211]
ds_read_b128 v[200:203], v28 offset:26624
v_mfma_f32_16x16x32_bf16 v[212:215], v[172:175], a[52:55], v[212:215]
ds_read_b128 v[204:207], v28 offset:35840
v_mfma_f32_16x16x32_bf16 v[220:223], v[116:119], a[96:99], v[220:223]
s_waitcnt lgkmcnt(4)
v_mfma_f32_16x16x32_bf16 v[208:211], v[176:179], a[56:59], v[208:211]
v_readlane_b32 s89, v39, s70
v_mfma_f32_16x16x32_bf16 v[212:215], v[180:183], a[56:59], v[212:215]
s_add_u32 s52, s52, 1
v_mov_b32 v27, s91
v_mfma_f32_16x16x32_bf16 v[216:219], v[120:123], a[100:103], v[216:219]
s_lshl_b32 s70, s92, 10
v_mfma_f32_16x16x32_bf16 v[208:211], v[184:187], a[60:63], v[208:211]
v_mfma_f32_16x16x32_bf16 v[212:215], v[188:191], a[60:63], v[212:215]
v_mfma_f32_16x16x32_bf16 v[220:223], v[124:127], a[100:103], v[220:223]
s_waitcnt lgkmcnt(0)
v_mfma_f32_16x16x32_bf16 v[208:211], v[192:195], a[64:67], v[208:211]
v_mfma_f32_16x16x32_bf16 v[212:215], v[196:199], a[64:67], v[212:215]
v_mfma_f32_16x16x32_bf16 v[216:219], v[128:131], a[104:107], v[216:219]
v_mfma_f32_16x16x32_bf16 v[208:211], v[200:203], a[68:71], v[208:211]
v_mfma_f32_16x16x32_bf16 v[212:215], v[204:207], a[68:71], v[212:215]
v_mfma_f32_16x16x32_bf16 v[220:223], v[132:135], a[104:107], v[220:223]
v_mfma_f32_16x16x32_bf16 v[216:219], v[136:139], a[108:111], v[216:219]
v_mfma_f32_16x16x32_bf16 v[220:223], v[140:143], a[108:111], v[220:223]
v_mfma_f32_16x16x32_bf16 v[224:227], v[64:67], a[144:147], 0
v_mfma_f32_16x16x32_bf16 v[216:219], v[144:147], a[112:115], v[216:219]
v_mfma_f32_16x16x32_bf16 v[220:223], v[148:151], a[112:115], v[220:223]
s_nop 0
v_cvt_pk_bf16_f32 v48, v208, v209
v_cvt_pk_bf16_f32 v49, v210, v211
v_mfma_f32_16x16x32_bf16 v[228:231], v[68:71], a[144:147], 0
v_cvt_pk_bf16_f32 v50, v212, v213
v_cvt_pk_bf16_f32 v51, v214, v215
v_mfma_f32_16x16x32_bf16 v[216:219], v[152:155], a[116:119], v[216:219]
buffer_store_dwordx4 v[48:51], v19, s[4:7], s79 offen sc1
v_mfma_f32_16x16x32_bf16 v[220:223], v[156:159], a[116:119], v[220:223]
v_mfma_f32_16x16x32_bf16 v[224:227], v[72:75], a[148:151], v[224:227]
v_mfma_f32_16x16x32_bf16 v[216:219], v[160:163], a[120:123], v[216:219]
v_mfma_f32_16x16x32_bf16 v[220:223], v[164:167], a[120:123], v[220:223]
v_mfma_f32_16x16x32_bf16 v[228:231], v[76:79], a[148:151], v[228:231]
v_mfma_f32_16x16x32_bf16 v[216:219], v[168:171], a[124:127], v[216:219]
v_mfma_f32_16x16x32_bf16 v[220:223], v[172:175], a[124:127], v[220:223]
v_mfma_f32_16x16x32_bf16 v[224:227], v[80:83], a[152:155], v[224:227]
v_mfma_f32_16x16x32_bf16 v[216:219], v[176:179], a[128:131], v[216:219]
v_mfma_f32_16x16x32_bf16 v[220:223], v[180:183], a[128:131], v[220:223]
v_mfma_f32_16x16x32_bf16 v[228:231], v[84:87], a[152:155], v[228:231]
v_mfma_f32_16x16x32_bf16 v[216:219], v[184:187], a[132:135], v[216:219]
v_mfma_f32_16x16x32_bf16 v[220:223], v[188:191], a[132:135], v[220:223]
v_mfma_f32_16x16x32_bf16 v[224:227], v[88:91], a[156:159], v[224:227]
v_mfma_f32_16x16x32_bf16 v[216:219], v[192:195], a[136:139], v[216:219]
v_mfma_f32_16x16x32_bf16 v[220:223], v[196:199], a[136:139], v[220:223]
v_mfma_f32_16x16x32_bf16 v[228:231], v[92:95], a[156:159], v[228:231]
v_mfma_f32_16x16x32_bf16 v[216:219], v[200:203], a[140:143], v[216:219]
v_mfma_f32_16x16x32_bf16 v[220:223], v[204:207], a[140:143], v[220:223]
v_mfma_f32_16x16x32_bf16 v[224:227], v[96:99], a[160:163], v[224:227]
v_mfma_f32_16x16x32_bf16 v[228:231], v[100:103], a[160:163], v[228:231]
s_waitcnt vmcnt(1)
ds_write_b32 v18, v24
v_mfma_f32_16x16x32_bf16 v[224:227], v[104:107], a[164:167], v[224:227]
v_mfma_f32_16x16x32_bf16 v[228:231], v[108:111], a[164:167], v[228:231]
v_mfma_f32_16x16x32_bf16 v[224:227], v[112:115], a[168:171], v[224:227]
s_waitcnt lgkmcnt(0)
s_barrier
v_mfma_f32_16x16x32_bf16 v[228:231], v[116:119], a[168:171], v[228:231]
ds_read_b32 v33, v32
v_cvt_pk_bf16_f32 v52, v216, v217
v_mfma_f32_16x16x32_bf16 v[224:227], v[120:123], a[172:175], v[224:227]
buffer_store_dword v27, v45, s[4:7], s70 offen
v_mfma_f32_16x16x32_bf16 v[228:231], v[124:127], a[172:175], v[228:231]
buffer_store_dword v27, v44, s[4:7], s70 offen sc1
v_mfma_f32_16x16x32_bf16 v[224:227], v[128:131], a[176:179], v[224:227]
s_waitcnt lgkmcnt(0)
v_cmp_gt_u32 vcc, s86, v33
v_mfma_f32_16x16x32_bf16 v[228:231], v[132:135], a[176:179], v[228:231]
s_lshr_b64 s[58:59], vcc, s87
s_and_b32 s58, s58, s56
s_cselect_b32 s10, 0, 268435456
s_cselect_b32 s90, 0, 1
v_mfma_f32_16x16x32_bf16 v[224:227], v[136:139], a[180:183], v[224:227]
s_cmp_eq_u32 s85, 0
s_cbranch_scc1 g_slow_33
v_mfma_f32_16x16x32_bf16 v[228:231], v[140:143], a[180:183], v[228:231]
s_add_u32 m0, s74, 0
v_cvt_pk_bf16_f32 v53, v218, v219
v_mfma_f32_16x16x32_bf16 v[224:227], v[144:147], a[184:187], v[224:227]
buffer_load_dwordx4 v8, s[8:11], s88 offen offset:0 sc1 lds
v_mfma_f32_16x16x32_bf16 v[228:231], v[148:151], a[184:187], v[228:231]
v_cvt_pk_bf16_f32 v54, v220, v221
v_cvt_pk_bf16_f32 v55, v222, v223
v_mfma_f32_16x16x32_bf16 v[224:227], v[152:155], a[188:191], v[224:227]
buffer_store_dwordx4 v[52:55], v20, s[4:7], s79 offen sc1
v_mfma_f32_16x16x32_bf16 v[228:231], v[156:159], a[188:191], v[228:231]
v_mfma_f32_16x16x32_bf16 v[224:227], v[160:163], a[192:195], v[224:227]
buffer_load_dwordx4 v9, s[8:11], s88 offen offset:1024 sc1 lds
v_mfma_f32_16x16x32_bf16 v[228:231], v[164:167], a[192:195], v[228:231]
v_mfma_f32_16x16x32_bf16 v[224:227], v[168:171], a[196:199], v[224:227]
ds_read_b128 v[64:67], v29 offset:0
v_mfma_f32_16x16x32_bf16 v[228:231], v[172:175], a[196:199], v[228:231]
ds_read_b128 v[68:71], v29 offset:9216
v_mfma_f32_16x16x32_bf16 v[224:227], v[176:179], a[200:203], v[224:227]
buffer_load_dwordx4 v10, s[8:11], s88 offen offset:2048 sc1 lds
ds_read_b128 v[72:75], v29 offset:18432
v_mfma_f32_16x16x32_bf16 v[228:231], v[180:183], a[200:203], v[228:231]
ds_read_b128 v[76:79], v29 offset:27648
v_mfma_f32_16x16x32_bf16 v[224:227], v[184:187], a[204:207], v[224:227]
ds_read_b128 v[80:83], v29 offset:1024
v_mfma_f32_16x16x32_bf16 v[228:231], v[188:191], a[204:207], v[228:231]
ds_read_b128 v[84:87], v29 offset:10240
v_mfma_f32_16x16x32_bf16 v[224:227], v[192:195], a[208:211], v[224:227]
buffer_load_dwordx4 v11, s[8:11], s88 offen offset:3072 sc1 lds
ds_read_b128 v[88:91], v29 offset:19456
v_mfma_f32_16x16x32_bf16 v[228:231], v[196:199], a[208:211], v[228:231]
ds_read_b128 v[92:95], v29 offset:28672
v_mfma_f32_16x16x32_bf16 v[224:227], v[200:203], a[212:215], v[224:227]
v_mfma_f32_16x16x32_bf16 v[228:231], v[204:207], a[212:215], v[228:231]
g_body_18:
s_waitcnt lgkmcnt(4)
v_mfma_f32_16x16x32_bf16 v[208:211], v[64:67], a[0:3], 0
ds_read_b128 v[96:99], v29 offset:2048
s_add_u32 m0, s74, 4096
v_mfma_f32_16x16x32_bf16 v[212:215], v[68:71], a[0:3], 0
ds_read_b128 v[100:103], v29 offset:11264
buffer_load_dwordx4 v12, s[8:11], s88 offen offset:0 sc1 lds
v_mfma_f32_16x16x32_bf16 v[216:219], v[64:67], a[72:75], 0
v_mfma_f32_16x16x32_bf16 v[208:211], v[72:75], a[4:7], v[208:211]
ds_read_b128 v[104:107], v29 offset:20480
v_cvt_pk_bf16_f32 v56, v224, v225
v_mfma_f32_16x16x32_bf16 v[212:215], v[76:79], a[4:7], v[212:215]
ds_read_b128 v[108:111], v29 offset:29696
buffer_load_dwordx4 v13, s[8:11], s88 offen offset:1024 sc1 lds
v_mfma_f32_16x16x32_bf16 v[220:223], v[68:71], a[72:75], 0
v_cvt_pk_bf16_f32 v57, v226, v227
s_waitcnt lgkmcnt(4)
v_mfma_f32_16x16x32_bf16 v[208:211], v[80:83], a[8:11], v[208:211]
ds_read_b128 v[112:115], v29 offset:3072
v_cvt_pk_bf16_f32 v58, v228, v229
v_mfma_f32_16x16x32_bf16 v[212:215], v[84:87], a[8:11], v[212:215]
ds_read_b128 v[116:119], v29 offset:12288
v_cvt_pk_bf16_f32 v59, v230, v231
v_mfma_f32_16x16x32_bf16 v[216:219], v[72:75], a[76:79], v[216:219]
buffer_load_dwordx4 v14, s[8:11], s88 offen offset:2048 sc1 lds
v_mfma_f32_16x16x32_bf16 v[208:211], v[88:91], a[12:15], v[208:211]
ds_read_b128 v[120:123], v29 offset:21504
v_mfma_f32_16x16x32_bf16 v[212:215], v[92:95], a[12:15], v[212:215]
ds_read_b128 v[124:127], v29 offset:30720
v_mfma_f32_16x16x32_bf16 v[220:223], v[76:79], a[76:79], v[220:223]
s_waitcnt lgkmcnt(4)
v_mfma_f32_16x16x32_bf16 v[208:211], v[96:99], a[16:19], v[208:211]
ds_read_b128 v[128:131], v29 offset:4096
buffer_load_dwordx4 v15, s[8:11], s88 offen offset:3072 sc1 lds
v_mfma_f32_16x16x32_bf16 v[212:215], v[100:103], a[16:19], v[212:215]
ds_read_b128 v[132:135], v29 offset:13312
v_mfma_f32_16x16x32_bf16 v[216:219], v[80:83], a[80:83], v[216:219]
buffer_store_dwordx4 v[56:59], v21, s[4:7], s79 offen sc1
v_mfma_f32_16x16x32_bf16 v[208:211], v[104:107], a[20:23], v[208:211]
ds_read_b128 v[136:139], v29 offset:22528
s_add_u32 m0, s74, 8192
v_mfma_f32_16x16x32_bf16 v[212:215], v[108:111], a[20:23], v[212:215]
ds_read_b128 v[140:143], v29 offset:31744
buffer_load_dwordx4 v16, s[8:11], s88 offen offset:0 sc1 lds
v_mfma_f32_16x16x32_bf16 v[220:223], v[84:87], a[80:83], v[220:223]
s_and_b32 s70, s52, 63
s_waitcnt lgkmcnt(4)
v_mfma_f32_16x16x32_bf16 v[208:211], v[112:115], a[24:27], v[208:211]
ds_read_b128 v[144:147], v29 offset:5120
v_mfma_f32_16x16x32_bf16 v[212:215], v[116:119], a[24:27], v[212:215]
ds_read_b128 v[148:151], v29 offset:14336
v_mfma_f32_16x16x32_bf16 v[216:219], v[88:91], a[84:87], v[216:219]
v_readlane_b32 s91, v36, s70
v_mfma_f32_16x16x32_bf16 v[208:211], v[120:123], a[28:31], v[208:211]
ds_read_b128 v[152:155], v29 offset:23552
v_mfma_f32_16x16x32_bf16 v[212:215], v[124:127], a[28:31], v[212:215]
ds_read_b128 v[156:159], v29 offset:32768
v_mfma_f32_16x16x32_bf16 v[220:223], v[92:95], a[84:87], v[220:223]
s_waitcnt lgkmcnt(4)
v_mfma_f32_16x16x32_bf16 v[208:211], v[128:131], a[32:35], v[208:211]
ds_read_b128 v[160:163], v29 offset:6144
v_mfma_f32_16x16x32_bf16 v[212:215], v[132:135], a[32:35], v[212:215]
ds_read_b128 v[164:167], v29 offset:15360
v_mfma_f32_16x16x32_bf16 v[216:219], v[96:99], a[88:91], v[216:219]
v_readlane_b32 s92, v37, s70
v_mfma_f32_16x16x32_bf16 v[208:211], v[136:139], a[36:39], v[208:211]
ds_read_b128 v[168:171], v29 offset:24576
v_mfma_f32_16x16x32_bf16 v[212:215], v[140:143], a[36:39], v[212:215]
ds_read_b128 v[172:175], v29 offset:33792
v_mfma_f32_16x16x32_bf16 v[220:223], v[100:103], a[88:91], v[220:223]
s_waitcnt lgkmcnt(4)
v_mfma_f32_16x16x32_bf16 v[208:211], v[144:147], a[40:43], v[208:211]
ds_read_b128 v[176:179], v29 offset:7168
v_mfma_f32_16x16x32_bf16 v[212:215], v[148:151], a[40:43], v[212:215]
ds_read_b128 v[180:183], v29 offset:16384
v_mfma_f32_16x16x32_bf16 v[216:219], v[104:107], a[92:95], v[216:219]
v_readlane_b32 s93, v38, s70
v_mfma_f32_16x16x32_bf16 v[208:211], v[152:155], a[44:47], v[208:211]
ds_read_b128 v[184:187], v29 offset:25600
v_mfma_f32_16x16x32_bf16 v[212:215], v[156:159], a[44:47], v[212:215]
ds_read_b128 v[188:191], v29 offset:34816
v_mfma_f32_16x16x32_bf16 v[220:223], v[108:111], a[92:95], v[220:223]
s_waitcnt lgkmcnt(4)
v_mfma_f32_16x16x32_bf16 v[208:211], v[160:163], a[48:51], v[208:211]
ds_read_b128 v[192:195], v29 offset:8192
v_mfma_f32_16x16x32_bf16 v[212:215], v[164:167], a[48:51], v[212:215]
ds_read_b128 v[196:199], v29 offset:17408
v_mfma_f32_16x16x32_bf16 v[216:219], v[112:115], a[96:99], v[216:219]
buffer_load_dword v24, v22, s[4:7], 0 offen sc1
v_mfma_f32_16x16x32_bf16 v[208:211], v[168:171], a[52:55], v[208:211]
ds_read_b128 v[200:203], v29 offset:26624
v_mfma_f32_16x16x32_bf16 v[212:215], v[172:175], a[52:55], v[212:215]
ds_read_b128 v[204:207], v29 offset:35840
v_mfma_f32_16x16x32_bf16 v[220:223], v[116:119], a[96:99], v[220:223]
s_waitcnt lgkmcnt(4)
v_mfma_f32_16x16x32_bf16 v[208:211], v[176:179], a[56:59], v[208:211]
v_readlane_b32 s94, v39, s70
v_mfma_f32_16x16x32_bf16 v[212:215], v[180:183], a[56:59], v[212:215]
s_add_u32 s52, s52, 1
v_mov_b32 v27, s76
v_mfma_f32_16x16x32_bf16 v[216:219], v[120:123], a[100:103], v[216:219]
s_lshl_b32 s70, s77, 10
v_mfma_f32_16x16x32_bf16 v[208:211], v[184:187], a[60:63], v[208:211]
v_mfma_f32_16x16x32_bf16 v[212:215], v[188:191], a[60:63], v[212:215]
v_mfma_f32_16x16x32_bf16 v[220:223], v[124:127], a[100:103], v[220:223]
s_waitcnt lgkmcnt(0)
v_mfma_f32_16x16x32_bf16 v[208:211], v[192:195], a[64:67], v[208:211]
v_mfma_f32_16x16x32_bf16 v[212:215], v[196:199], a[64:67], v[212:215]
v_mfma_f32_16x16x32_bf16 v[216:219], v[128:131], a[104:107], v[216:219]
v_mfma_f32_16x16x32_bf16 v[208:211], v[200:203], a[68:71], v[208:211]
v_mfma_f32_16x16x32_bf16 v[212:215], v[204:207], a[68:71], v[212:215]
v_mfma_f32_16x16x32_bf16 v[220:223], v[132:135], a[104:107], v[220:223]
v_mfma_f32_16x16x32_bf16 v[216:219], v[136:139], a[108:111], v[216:219]
v_mfma_f32_16x16x32_bf16 v[220:223], v[140:143], a[108:111], v[220:223]
v_mfma_f32_16x16x32_bf16 v[224:227], v[64:67], a[144:147], 0
v_mfma_f32_16x16x32_bf16 v[216:219], v[144:147], a[112:115], v[216:219]
v_mfma_f32_16x16x32_bf16 v[220:223], v[148:151], a[112:115], v[220:223]
s_nop 0
v_cvt_pk_bf16_f32 v48, v208, v209
v_cvt_pk_bf16_f32 v49, v210, v211
v_mfma_f32_16x16x32_bf16 v[228:231], v[68:71], a[144:147], 0
v_cvt_pk_bf16_f32 v50, v212, v213
v_cvt_pk_bf16_f32 v51, v214, v215
v_mfma_f32_16x16x32_bf16 v[216:219], v[152:155], a[116:119], v[216:219]
buffer_store_dwordx4 v[48:51], v19, s[4:7], s84 offen sc1
v_mfma_f32_16x16x32_bf16 v[220:223], v[156:159], a[116:119], v[220:223]
v_mfma_f32_16x16x32_bf16 v[224:227], v[72:75], a[148:151], v[224:227]
v_mfma_f32_16x16x32_bf16 v[216:219], v[160:163], a[120:123], v[216:219]
v_mfma_f32_16x16x32_bf16 v[220:223], v[164:167], a[120:123], v[220:223]
v_mfma_f32_16x16x32_bf16 v[228:231], v[76:79], a[148:151], v[228:231]
v_mfma_f32_16x16x32_bf16 v[216:219], v[168:171], a[124:127], v[216:219]
v_mfma_f32_16x16x32_bf16 v[220:223], v[172:175], a[124:127], v[220:223]
v_mfma_f32_16x16x32_bf16 v[224:227], v[80:83], a[152:155], v[224:227]
v_mfma_f32_16x16x32_bf16 v[216:219], v[176:179], a[128:131], v[216:219]
v_mfma_f32_16x16x32_bf16 v[220:223], v[180:183], a[128:131], v[220:223]
v_mfma_f32_16x16x32_bf16 v[228:231], v[84:87], a[152:155], v[228:231]
v_mfma_f32_16x16x32_bf16 v[216:219], v[184:187], a[132:135], v[216:219]
v_mfma_f32_16x16x32_bf16 v[220:223], v[188:191], a[132:135], v[220:223]
v_mfma_f32_16x16x32_bf16 v[224:227], v[88:91], a[156:159], v[224:227]
v_mfma_f32_16x16x32_bf16 v[216:219], v[192:195], a[136:139], v[216:219]
v_mfma_f32_16x16x32_bf16 v[220:223], v[196:199], a[136:139], v[220:223]
v_mfma_f32_16x16x32_bf16 v[228:231], v[92:95], a[156:159], v[228:231]
v_mfma_f32_16x16x32_bf16 v[216:219], v[200:203], a[140:143], v[216:219]
v_mfma_f32_16x16x32_bf16 v[220:223], v[204:207], a[140:143], v[220:223]
v_mfma_f32_16x16x32_bf16 v[224:227], v[96:99], a[160:163], v[224:227]
v_mfma_f32_16x16x32_bf16 v[228:231], v[100:103], a[160:163], v[228:231]
s_waitcnt vmcnt(1)
ds_write_b32 v18, v24
v_mfma_f32_16x16x32_bf16 v[224:227], v[104:107], a[164:167], v[224:227]
v_mfma_f32_16x16x32_bf16 v[228:231], v[108:111], a[164:167], v[228:231]
v_mfma_f32_16x16x32_bf16 v[224:227], v[112:115], a[168:171], v[224:227]
s_waitcnt lgkmcnt(0)
s_barrier
v_mfma_f32_16x16x32_bf16 v[228:231], v[116:119], a[168:171], v[228:231]
ds_read_b32 v33, v32
v_cvt_pk_bf16_f32 v52, v216, v217
v_mfma_f32_16x16x32_bf16 v[224:227], v[120:123], a[172:175], v[224:227]
buffer_store_dword v27, v45, s[4:7], s70 offen
v_mfma_f32_16x16x32_bf16 v[228:231], v[124:127], a[172:175], v[228:231]
buffer_store_dword v27, v44, s[4:7], s70 offen sc1
v_mfma_f32_16x16x32_bf16 v[224:227], v[128:131], a[176:179], v[224:227]
s_waitcnt lgkmcnt(0)
v_cmp_gt_u32 vcc, s91, v33
v_mfma_f32_16x16x32_bf16 v[228:231], v[132:135], a[176:179], v[228:231]
s_lshr_b64 s[58:59], vcc, s92
s_and_b32 s58, s58, s56
s_cselect_b32 s10, 0, 268435456
s_cselect_b32 s95, 0, 1
v_mfma_f32_16x16x32_bf16 v[224:227], v[136:139], a[180:183], v[224:227]
s_cmp_eq_u32 s90, 0
s_cbranch_scc1 g_slow_34
v_mfma_f32_16x16x32_bf16 v[228:231], v[140:143], a[180:183], v[228:231]
s_add_u32 m0, s75, 0
v_cvt_pk_bf16_f32 v53, v218, v219
v_mfma_f32_16x16x32_bf16 v[224:227], v[144:147], a[184:187], v[224:227]
buffer_load_dwordx4 v8, s[8:11], s93 offen offset:0 sc1 lds
v_mfma_f32_16x16x32_bf16 v[228:231], v[148:151], a[184:187], v[228:231]
v_cvt_pk_bf16_f32 v54, v220, v221
v_cvt_pk_bf16_f32 v55, v222, v223
v_mfma_f32_16x16x32_bf16 v[224:227], v[152:155], a[188:191], v[224:227]
buffer_store_dwordx4 v[52:55], v20, s[4:7], s84 offen sc1
v_mfma_f32_16x16x32_bf16 v[228:231], v[156:159], a[188:191], v[228:231]
v_mfma_f32_16x16x32_bf16 v[224:227], v[160:163], a[192:195], v[224:227]
buffer_load_dwordx4 v9, s[8:11], s93 offen offset:1024 sc1 lds
v_mfma_f32_16x16x32_bf16 v[228:231], v[164:167], a[192:195], v[228:231]
v_mfma_f32_16x16x32_bf16 v[224:227], v[168:171], a[196:199], v[224:227]
ds_read_b128 v[64:67], v30 offset:0
v_mfma_f32_16x16x32_bf16 v[228:231], v[172:175], a[196:199], v[228:231]
ds_read_b128 v[68:71], v30 offset:9216
v_mfma_f32_16x16x32_bf16 v[224:227], v[176:179], a[200:203], v[224:227]
buffer_load_dwordx4 v10, s[8:11], s93 offen offset:2048 sc1 lds
ds_read_b128 v[72:75], v30 offset:18432
v_mfma_f32_16x16x32_bf16 v[228:231], v[180:183], a[200:203], v[228:231]
ds_read_b128 v[76:79], v30 offset:27648
v_mfma_f32_16x16x32_bf16 v[224:227], v[184:187], a[204:207], v[224:227]
ds_read_b128 v[80:83], v30 offset:1024
v_mfma_f32_16x16x32_bf16 v[228:231], v[188:191], a[204:207], v[228:231]
ds_read_b128 v[84:87], v30 offset:10240
v_mfma_f32_16x16x32_bf16 v[224:227], v[192:195], a[208:211], v[224:227]
buffer_load_dwordx4 v11, s[8:11], s93 offen offset:3072 sc1 lds
ds_read_b128 v[88:91], v30 offset:19456
v_mfma_f32_16x16x32_bf16 v[228:231], v[196:199], a[208:211], v[228:231]
ds_read_b128 v[92:95], v30 offset:28672
v_mfma_f32_16x16x32_bf16 v[224:227], v[200:203], a[212:215], v[224:227]
v_mfma_f32_16x16x32_bf16 v[228:231], v[204:207], a[212:215], v[228:231]
g_body_19:
s_waitcnt lgkmcnt(4)
v_mfma_f32_16x16x32_bf16 v[208:211], v[64:67], a[0:3], 0
ds_read_b128 v[96:99], v30 offset:2048
s_add_u32 m0, s75, 4096
v_mfma_f32_16x16x32_bf16 v[212:215], v[68:71], a[0:3], 0
ds_read_b128 v[100:103], v30 offset:11264
buffer_load_dwordx4 v12, s[8:11], s93 offen offset:0 sc1 lds
v_mfma_f32_16x16x32_bf16 v[216:219], v[64:67], a[72:75], 0
v_mfma_f32_16x16x32_bf16 v[208:211], v[72:75], a[4:7], v[208:211]
ds_read_b128 v[104:107], v30 offset:20480
v_cvt_pk_bf16_f32 v56, v224, v225
v_mfma_f32_16x16x32_bf16 v[212:215], v[76:79], a[4:7], v[212:215]
ds_read_b128 v[108:111], v30 offset:29696
buffer_load_dwordx4 v13, s[8:11], s93 offen offset:1024 sc1 lds
v_mfma_f32_16x16x32_bf16 v[220:223], v[68:71], a[72:75], 0
v_cvt_pk_bf16_f32 v57, v226, v227
s_waitcnt lgkmcnt(4)
v_mfma_f32_16x16x32_bf16 v[208:211], v[80:83], a[8:11], v[208:211]
ds_read_b128 v[112:115], v30 offset:3072
v_cvt_pk_bf16_f32 v58, v228, v229
v_mfma_f32_16x16x32_bf16 v[212:215], v[84:87], a[8:11], v[212:215]
ds_read_b128 v[116:119], v30 offset:12288
v_cvt_pk_bf16_f32 v59, v230, v231
v_mfma_f32_16x16x32_bf16 v[216:219], v[72:75], a[76:79], v[216:219]
buffer_load_dwordx4 v14, s[8:11], s93 offen offset:2048 sc1 lds
v_mfma_f32_16x16x32_bf16 v[208:211], v[88:91], a[12:15], v[208:211]
ds_read_b128 v[120:123], v30 offset:21504
v_mfma_f32_16x16x32_bf16 v[212:215], v[92:95], a[12:15], v[212:215]
ds_read_b128 v[124:127], v30 offset:30720
v_mfma_f32_16x16x32_bf16 v[220:223], v[76:79], a[76:79], v[220:223]
s_waitcnt lgkmcnt(4)
v_mfma_f32_16x16x32_bf16 v[208:211], v[96:99], a[16:19], v[208:211]
ds_read_b128 v[128:131], v30 offset:4096
buffer_load_dwordx4 v15, s[8:11], s93 offen offset:3072 sc1 lds
v_mfma_f32_16x16x32_bf16 v[212:215], v[100:103], a[16:19], v[212:215]
ds_read_b128 v[132:135], v30 offset:13312
v_mfma_f32_16x16x32_bf16 v[216:219], v[80:83], a[80:83], v[216:219]
buffer_store_dwordx4 v[56:59], v21, s[4:7], s84 offen sc1
v_mfma_f32_16x16x32_bf16 v[208:211], v[104:107], a[20:23], v[208:211]
ds_read_b128 v[136:139], v30 offset:22528
s_add_u32 m0, s75, 8192
v_mfma_f32_16x16x32_bf16 v[212:215], v[108:111], a[20:23], v[212:215]
ds_read_b128 v[140:143], v30 offset:31744
buffer_load_dwordx4 v16, s[8:11], s93 offen offset:0 sc1 lds
v_mfma_f32_16x16x32_bf16 v[220:223], v[84:87], a[80:83], v[220:223]
s_and_b32 s70, s52, 63
s_waitcnt lgkmcnt(4)
v_mfma_f32_16x16x32_bf16 v[208:211], v[112:115], a[24:27], v[208:211]
ds_read_b128 v[144:147], v30 offset:5120
v_mfma_f32_16x16x32_bf16 v[212:215], v[116:119], a[24:27], v[212:215]
ds_read_b128 v[148:151], v30 offset:14336
v_mfma_f32_16x16x32_bf16 v[216:219], v[88:91], a[84:87], v[216:219]
v_readlane_b32 s76, v36, s70
v_mfma_f32_16x16x32_bf16 v[208:211], v[120:123], a[28:31], v[208:211]
ds_read_b128 v[152:155], v30 offset:23552
v_mfma_f32_16x16x32_bf16 v[212:215], v[124:127], a[28:31], v[212:215]
ds_read_b128 v[156:159], v30 offset:32768
v_mfma_f32_16x16x32_bf16 v[220:223], v[92:95], a[84:87], v[220:223]
s_waitcnt lgkmcnt(4)
v_mfma_f32_16x16x32_bf16 v[208:211], v[128:131], a[32:35], v[208:211]
ds_read_b128 v[160:163], v30 offset:6144
v_mfma_f32_16x16x32_bf16 v[212:215], v[132:135], a[32:35], v[212:215]
ds_read_b128 v[164:167], v30 offset:15360
v_mfma_f32_16x16x32_bf16 v[216:219], v[96:99], a[88:91], v[216:219]
v_readlane_b32 s77, v37, s70
v_mfma_f32_16x16x32_bf16 v[208:211], v[136:139], a[36:39], v[208:211]
ds_read_b128 v[168:171], v30 offset:24576
v_mfma_f32_16x16x32_bf16 v[212:215], v[140:143], a[36:39], v[212:215]
ds_read_b128 v[172:175], v30 offset:33792
v_mfma_f32_16x16x32_bf16 v[220:223], v[100:103], a[88:91], v[220:223]
s_waitcnt lgkmcnt(4)
v_mfma_f32_16x16x32_bf16 v[208:211], v[144:147], a[40:43], v[208:211]
ds_read_b128 v[176:179], v30 offset:7168
v_mfma_f32_16x16x32_bf16 v[212:215], v[148:151], a[40:43], v[212:215]
ds_read_b128 v[180:183], v30 offset:16384
v_mfma_f32_16x16x32_bf16 v[216:219], v[104:107], a[92:95], v[216:219]
v_readlane_b32 s78, v38, s70
v_mfma_f32_16x16x32_bf16 v[208:211], v[152:155], a[44:47], v[208:211]
ds_read_b128 v[184:187], v30 offset:25600
v_mfma_f32_16x16x32_bf16 v[212:215], v[156:159], a[44:47], v[212:215]
ds_read_b128 v[188:191], v30 offset:34816
v_mfma_f32_16x16x32_bf16 v[220:223], v[108:111], a[92:95], v[220:223]
s_waitcnt lgkmcnt(4)
v_mfma_f32_16x16x32_bf16 v[208:211], v[160:163], a[48:51], v[208:211]
ds_read_b128 v[192:195], v30 offset:8192
v_mfma_f32_16x16x32_bf16 v[212:215], v[164:167], a[48:51], v[212:215]
ds_read_b128 v[196:199], v30 offset:17408
v_mfma_f32_16x16x32_bf16 v[216:219], v[112:115], a[96:99], v[216:219]
buffer_load_dword v24, v22, s[4:7], 0 offen sc1
v_mfma_f32_16x16x32_bf16 v[208:211], v[168:171], a[52:55], v[208:211]
ds_read_b128 v[200:203], v30 offset:26624
v_mfma_f32_16x16x32_bf16 v[212:215], v[172:175], a[52:55], v[212:215]
ds_read_b128 v[204:207], v30 offset:35840
v_mfma_f32_16x16x32_bf16 v[220:223], v[116:119], a[96:99], v[220:223]
s_waitcnt lgkmcnt(4)
v_mfma_f32_16x16x32_bf16 v[208:211], v[176:179], a[56:59], v[208:211]
v_readlane_b32 s79, v39, s70
v_mfma_f32_16x16x32_bf16 v[212:215], v[180:183], a[56:59], v[212:215]
s_add_u32 s52, s52, 1
v_mov_b32 v27, s81
v_mfma_f32_16x16x32_bf16 v[216:219], v[120:123], a[100:103], v[216:219]
s_lshl_b32 s70, s82, 10
v_mfma_f32_16x16x32_bf16 v[208:211], v[184:187], a[60:63], v[208:211]
v_mfma_f32_16x16x32_bf16 v[212:215], v[188:191], a[60:63], v[212:215]
v_mfma_f32_16x16x32_bf16 v[220:223], v[124:127], a[100:103], v[220:223]
s_waitcnt lgkmcnt(0)
v_mfma_f32_16x16x32_bf16 v[208:211], v[192:195], a[64:67], v[208:211]
v_mfma_f32_16x16x32_bf16 v[212:215], v[196:199], a[64:67], v[212:215]
v_mfma_f32_16x16x32_bf16 v[216:219], v[128:131], a[104:107], v[216:219]
v_mfma_f32_16x16x32_bf16 v[208:211], v[200:203], a[68:71], v[208:211]
v_mfma_f32_16x16x32_bf16 v[212:215], v[204:207], a[68:71], v[212:215]
v_mfma_f32_16x16x32_bf16 v[220:223], v[132:135], a[104:107], v[220:223]
v_mfma_f32_16x16x32_bf16 v[216:219], v[136:139], a[108:111], v[216:219]
v_mfma_f32_16x16x32_bf16 v[220:223], v[140:143], a[108:111], v[220:223]
v_mfma_f32_16x16x32_bf16 v[224:227], v[64:67], a[144:147], 0
v_mfma_f32_16x16x32_bf16 v[216:219], v[144:147], a[112:115], v[216:219]
v_mfma_f32_16x16x32_bf16 v[220:223], v[148:151], a[112:115], v[220:223]
s_nop 0
v_cvt_pk_bf16_f32 v48, v208, v209
v_cvt_pk_bf16_f32 v49, v210, v211
v_mfma_f32_16x16x32_bf16 v[228:231], v[68:71], a[144:147], 0
v_cvt_pk_bf16_f32 v50, v212, v213
v_cvt_pk_bf16_f32 v51, v214, v215
v_mfma_f32_16x16x32_bf16 v[216:219], v[152:155], a[116:119], v[216:219]
buffer_store_dwordx4 v[48:51], v19, s[4:7], s89 offen sc1
v_mfma_f32_16x16x32_bf16 v[220:223], v[156:159], a[116:119], v[220:223]
v_mfma_f32_16x16x32_bf16 v[224:227], v[72:75], a[148:151], v[224:227]
v_mfma_f32_16x16x32_bf16 v[216:219], v[160:163], a[120:123], v[216:219]
v_mfma_f32_16x16x32_bf16 v[220:223], v[164:167], a[120:123], v[220:223]
v_mfma_f32_16x16x32_bf16 v[228:231], v[76:79], a[148:151], v[228:231]
v_mfma_f32_16x16x32_bf16 v[216:219], v[168:171], a[124:127], v[216:219]
v_mfma_f32_16x16x32_bf16 v[220:223], v[172:175], a[124:127], v[220:223]
v_mfma_f32_16x16x32_bf16 v[224:227], v[80:83], a[152:155], v[224:227]
v_mfma_f32_16x16x32_bf16 v[216:219], v[176:179], a[128:131], v[216:219]
v_mfma_f32_16x16x32_bf16 v[220:223], v[180:183], a[128:131], v[220:223]
v_mfma_f32_16x16x32_bf16 v[228:231], v[84:87], a[152:155], v[228:231]
v_mfma_f32_16x16x32_bf16 v[216:219], v[184:187], a[132:135], v[216:219]
v_mfma_f32_16x16x32_bf16 v[220:223], v[188:191], a[132:135], v[220:223]
v_mfma_f32_16x16x32_bf16 v[224:227], v[88:91], a[156:159], v[224:227]
v_mfma_f32_16x16x32_bf16 v[216:219], v[192:195], a[136:139], v[216:219]
v_mfma_f32_16x16x32_bf16 v[220:223], v[196:199], a[136:139], v[220:223]
v_mfma_f32_16x16x32_bf16 v[228:231], v[92:95], a[156:159], v[228:231]
v_mfma_f32_16x16x32_bf16 v[216:219], v[200:203], a[140:143], v[216:219]
v_mfma_f32_16x16x32_bf16 v[220:223], v[204:207], a[140:143], v[220:223]
v_mfma_f32_16x16x32_bf16 v[224:227], v[96:99], a[160:163], v[224:227]
v_mfma_f32_16x16x32_bf16 v[228:231], v[100:103], a[160:163], v[228:231]
s_waitcnt vmcnt(1)
ds_write_b32 v18, v24
v_mfma_f32_16x16x32_bf16 v[224:227], v[104:107], a[164:167], v[224:227]
v_mfma_f32_16x16x32_bf16 v[228:231], v[108:111], a[164:167], v[228:231]
v_mfma_f32_16x16x32_bf16 v[224:227], v[112:115], a[168:171], v[224:227]
s_waitcnt lgkmcnt(0)
s_barrier
v_mfma_f32_16x16x32_bf16 v[228:231], v[116:119], a[168:171], v[228:231]
ds_read_b32 v33, v32
v_cvt_pk_bf16_f32 v52, v216, v217
v_mfma_f32_16x16x32_bf16 v[224:227], v[120:123], a[172:175], v[224:227]
buffer_store_dword v27, v45, s[4:7], s70 offen
v_mfma_f32_16x16x32_bf16 v[228:231], v[124:127], a[172:175], v[228:231]
buffer_store_dword v27, v44, s[4:7], s70 offen sc1
v_mfma_f32_16x16x32_bf16 v[224:227], v[128:131], a[176:179], v[224:227]
s_waitcnt lgkmcnt(0)
v_cmp_gt_u32 vcc, s76, v33
v_mfma_f32_16x16x32_bf16 v[228:231], v[132:135], a[176:179], v[228:231]
s_lshr_b64 s[58:59], vcc, s77
s_and_b32 s58, s58, s56
s_cselect_b32 s10, 0, 268435456
s_cselect_b32 s80, 0, 1
v_mfma_f32_16x16x32_bf16 v[224:227], v[136:139], a[180:183], v[224:227]
s_cmp_eq_u32 s95, 0
s_cbranch_scc1 g_slow_35
v_mfma_f32_16x16x32_bf16 v[228:231], v[140:143], a[180:183], v[228:231]
s_add_u32 m0, s72, 0
v_cvt_pk_bf16_f32 v53, v218, v219
v_mfma_f32_16x16x32_bf16 v[224:227], v[144:147], a[184:187], v[224:227]
buffer_load_dwordx4 v8, s[8:11], s78 offen offset:0 sc1 lds
v_mfma_f32_16x16x32_bf16 v[228:231], v[148:151], a[184:187], v[228:231]
v_cvt_pk_bf16_f32 v54, v220, v221
v_cvt_pk_bf16_f32 v55, v222, v223
v_mfma_f32_16x16x32_bf16 v[224:227], v[152:155], a[188:191], v[224:227]
buffer_store_dwordx4 v[52:55], v20, s[4:7], s89 offen sc1
v_mfma_f32_16x16x32_bf16 v[228:231], v[156:159], a[188:191], v[228:231]
v_mfma_f32_16x16x32_bf16 v[224:227], v[160:163], a[192:195], v[224:227]
buffer_load_dwordx4 v9, s[8:11], s78 offen offset:1024 sc1 lds
v_mfma_f32_16x16x32_bf16 v[228:231], v[164:167], a[192:195], v[228:231]
v_mfma_f32_16x16x32_bf16 v[224:227], v[168:171], a[196:199], v[224:227]
ds_read_b128 v[64:67], v31 offset:0
v_mfma_f32_16x16x32_bf16 v[228:231], v[172:175], a[196:199], v[228:231]
ds_read_b128 v[68:71], v31 offset:9216
v_mfma_f32_16x16x32_bf16 v[224:227], v[176:179], a[200:203], v[224:227]
buffer_load_dwordx4 v10, s[8:11], s78 offen offset:2048 sc1 lds
ds_read_b128 v[72:75], v31 offset:18432
v_mfma_f32_16x16x32_bf16 v[228:231], v[180:183], a[200:203], v[228:231]
ds_read_b128 v[76:79], v31 offset:27648
v_mfma_f32_16x16x32_bf16 v[224:227], v[184:187], a[204:207], v[224:227]
ds_read_b128 v[80:83], v31 offset:1024
v_mfma_f32_16x16x32_bf16 v[228:231], v[188:191], a[204:207], v[228:231]
ds_read_b128 v[84:87], v31 offset:10240
v_mfma_f32_16x16x32_bf16 v[224:227], v[192:195], a[208:211], v[224:227]
buffer_load_dwordx4 v11, s[8:11], s78 offen offset:3072 sc1 lds
ds_read_b128 v[88:91], v31 offset:19456
v_mfma_f32_16x16x32_bf16 v[228:231], v[196:199], a[208:211], v[228:231]
ds_read_b128 v[92:95], v31 offset:28672
v_mfma_f32_16x16x32_bf16 v[224:227], v[200:203], a[212:215], v[224:227]
v_mfma_f32_16x16x32_bf16 v[228:231], v[204:207], a[212:215], v[228:231]
g_body_20:
s_waitcnt lgkmcnt(4)
v_mfma_f32_16x16x32_bf16 v[208:211], v[64:67], a[0:3], 0
ds_read_b128 v[96:99], v31 offset:2048
s_add_u32 m0, s72, 4096
v_mfma_f32_16x16x32_bf16 v[212:215], v[68:71], a[0:3], 0
ds_read_b128 v[100:103], v31 offset:11264
buffer_load_dwordx4 v12, s[8:11], s78 offen offset:0 sc1 lds
v_mfma_f32_16x16x32_bf16 v[216:219], v[64:67], a[72:75], 0
v_mfma_f32_16x16x32_bf16 v[208:211], v[72:75], a[4:7], v[208:211]
ds_read_b128 v[104:107], v31 offset:20480
v_cvt_pk_bf16_f32 v56, v224, v225
v_mfma_f32_16x16x32_bf16 v[212:215], v[76:79], a[4:7], v[212:215]
ds_read_b128 v[108:111], v31 offset:29696
buffer_load_dwordx4 v13, s[8:11], s78 offen offset:1024 sc1 lds
v_mfma_f32_16x16x32_bf16 v[220:223], v[68:71], a[72:75], 0
v_cvt_pk_bf16_f32 v57, v226, v227
s_waitcnt lgkmcnt(4)
v_mfma_f32_16x16x32_bf16 v[208:211], v[80:83], a[8:11], v[208:211]
ds_read_b128 v[112:115], v31 offset:3072
v_cvt_pk_bf16_f32 v58, v228, v229
v_mfma_f32_16x16x32_bf16 v[212:215], v[84:87], a[8:11], v[212:215]
ds_read_b128 v[116:119], v31 offset:12288
v_cvt_pk_bf16_f32 v59, v230, v231
v_mfma_f32_16x16x32_bf16 v[216:219], v[72:75], a[76:79], v[216:219]
buffer_load_dwordx4 v14, s[8:11], s78 offen offset:2048 sc1 lds
v_mfma_f32_16x16x32_bf16 v[208:211], v[88:91], a[12:15], v[208:211]
ds_read_b128 v[120:123], v31 offset:21504
v_mfma_f32_16x16x32_bf16 v[212:215], v[92:95], a[12:15], v[212:215]
ds_read_b128 v[124:127], v31 offset:30720
v_mfma_f32_16x16x32_bf16 v[220:223], v[76:79], a[76:79], v[220:223]
s_waitcnt lgkmcnt(4)
v_mfma_f32_16x16x32_bf16 v[208:211], v[96:99], a[16:19], v[208:211]
ds_read_b128 v[128:131], v31 offset:4096
buffer_load_dwordx4 v15, s[8:11], s78 offen offset:3072 sc1 lds
v_mfma_f32_16x16x32_bf16 v[212:215], v[100:103], a[16:19], v[212:215]
ds_read_b128 v[132:135], v31 offset:13312
v_mfma_f32_16x16x32_bf16 v[216:219], v[80:83], a[80:83], v[216:219]
buffer_store_dwordx4 v[56:59], v21, s[4:7], s89 offen sc1
v_mfma_f32_16x16x32_bf16 v[208:211], v[104:107], a[20:23], v[208:211]
ds_read_b128 v[136:139], v31 offset:22528
s_add_u32 m0, s72, 8192
v_mfma_f32_16x16x32_bf16 v[212:215], v[108:111], a[20:23], v[212:215]
ds_read_b128 v[140:143], v31 offset:31744
buffer_load_dwordx4 v16, s[8:11], s78 offen offset:0 sc1 lds
v_mfma_f32_16x16x32_bf16 v[220:223], v[84:87], a[80:83], v[220:223]
s_and_b32 s70, s52, 63
s_waitcnt lgkmcnt(4)
v_mfma_f32_16x16x32_bf16 v[208:211], v[112:115], a[24:27], v[208:211]
ds_read_b128 v[144:147], v31 offset:5120
v_mfma_f32_16x16x32_bf16 v[212:215], v[116:119], a[24:27], v[212:215]
ds_read_b128 v[148:151], v31 offset:14336
v_mfma_f32_16x16x32_bf16 v[216:219], v[88:91], a[84:87], v[216:219]
v_readlane_b32 s81, v36, s70
v_mfma_f32_16x16x32_bf16 v[208:211], v[120:123], a[28:31], v[208:211]
ds_read_b128 v[152:155], v31 offset:23552
v_mfma_f32_16x16x32_bf16 v[212:215], v[124:127], a[28:31], v[212:215]
ds_read_b128 v[156:159], v31 offset:32768
v_mfma_f32_16x16x32_bf16 v[220:223], v[92:95], a[84:87], v[220:223]
s_waitcnt lgkmcnt(4)
v_mfma_f32_16x16x32_bf16 v[208:211], v[128:131], a[32:35], v[208:211]
ds_read_b128 v[160:163], v31 offset:6144
v_mfma_f32_16x16x32_bf16 v[212:215], v[132:135], a[32:35], v[212:215]
ds_read_b128 v[164:167], v31 offset:15360
v_mfma_f32_16x16x32_bf16 v[216:219], v[96:99], a[88:91], v[216:219]
v_readlane_b32 s82, v37, s70
v_mfma_f32_16x16x32_bf16 v[208:211], v[136:139], a[36:39], v[208:211]
ds_read_b128 v[168:171], v31 offset:24576
v_mfma_f32_16x16x32_bf16 v[212:215], v[140:143], a[36:39], v[212:215]
ds_read_b128 v[172:175], v31 offset:33792
v_mfma_f32_16x16x32_bf16 v[220:223], v[100:103], a[88:91], v[220:223]
s_waitcnt lgkmcnt(4)
v_mfma_f32_16x16x32_bf16 v[208:211], v[144:147], a[40:43], v[208:211]
ds_read_b128 v[176:179], v31 offset:7168
v_mfma_f32_16x16x32_bf16 v[212:215], v[148:151], a[40:43], v[212:215]
ds_read_b128 v[180:183], v31 offset:16384
v_mfma_f32_16x16x32_bf16 v[216:219], v[104:107], a[92:95], v[216:219]
v_readlane_b32 s83, v38, s70
v_mfma_f32_16x16x32_bf16 v[208:211], v[152:155], a[44:47], v[208:211]
ds_read_b128 v[184:187], v31 offset:25600
v_mfma_f32_16x16x32_bf16 v[212:215], v[156:159], a[44:47], v[212:215]
ds_read_b128 v[188:191], v31 offset:34816
v_mfma_f32_16x16x32_bf16 v[220:223], v[108:111], a[92:95], v[220:223]
s_waitcnt lgkmcnt(4)
v_mfma_f32_16x16x32_bf16 v[208:211], v[160:163], a[48:51], v[208:211]
ds_read_b128 v[192:195], v31 offset:8192
v_mfma_f32_16x16x32_bf16 v[212:215], v[164:167], a[48:51], v[212:215]
ds_read_b128 v[196:199], v31 offset:17408
v_mfma_f32_16x16x32_bf16 v[216:219], v[112:115], a[96:99], v[216:219]
buffer_load_dword v24, v22, s[4:7], 0 offen sc1
v_mfma_f32_16x16x32_bf16 v[208:211], v[168:171], a[52:55], v[208:211]
ds_read_b128 v[200:203], v31 offset:26624
v_mfma_f32_16x16x32_bf16 v[212:215], v[172:175], a[52:55], v[212:215]
ds_read_b128 v[204:207], v31 offset:35840
v_mfma_f32_16x16x32_bf16 v[220:223], v[116:119], a[96:99], v[220:223]
s_waitcnt lgkmcnt(4)
v_mfma_f32_16x16x32_bf16 v[208:211], v[176:179], a[56:59], v[208:211]
v_readlane_b32 s84, v39, s70
v_mfma_f32_16x16x32_bf16 v[212:215], v[180:183], a[56:59], v[212:215]
s_add_u32 s52, s52, 1
v_mfma_f32_16x16x32_bf16 v[216:219], v[120:123], a[100:103], v[216:219]
s_cmp_eq_u32 s52, 64
s_cbranch_scc1 rare_37
back_38:
v_mfma_f32_16x16x32_bf16 v[208:211], v[184:187], a[60:63], v[208:211]
v_mov_b32 v27, s86
s_lshl_b32 s70, s87, 10
v_mfma_f32_16x16x32_bf16 v[212:215], v[188:191], a[60:63], v[212:215]
v_mfma_f32_16x16x32_bf16 v[220:223], v[124:127], a[100:103], v[220:223]
s_waitcnt lgkmcnt(0)
v_mfma_f32_16x16x32_bf16 v[208:211], v[192:195], a[64:67], v[208:211]
v_mfma_f32_16x16x32_bf16 v[212:215], v[196:199], a[64:67], v[212:215]
v_mfma_f32_16x16x32_bf16 v[216:219], v[128:131], a[104:107], v[216:219]
v_mfma_f32_16x16x32_bf16 v[208:211], v[200:203], a[68:71], v[208:211]
v_mfma_f32_16x16x32_bf16 v[212:215], v[204:207], a[68:71], v[212:215]
v_mfma_f32_16x16x32_bf16 v[220:223], v[132:135], a[104:107], v[220:223]
v_mfma_f32_16x16x32_bf16 v[216:219], v[136:139], a[108:111], v[216:219]
v_mfma_f32_16x16x32_bf16 v[220:223], v[140:143], a[108:111], v[220:223]
v_mfma_f32_16x16x32_bf16 v[224:227], v[64:67], a[144:147], 0
v_mfma_f32_16x16x32_bf16 v[216:219], v[144:147], a[112:115], v[216:219]
v_mfma_f32_16x16x32_bf16 v[220:223], v[148:151], a[112:115], v[220:223]
s_nop 0
v_cvt_pk_bf16_f32 v48, v208, v209
v_cvt_pk_bf16_f32 v49, v210, v211
v_mfma_f32_16x16x32_bf16 v[228:231], v[68:71], a[144:147], 0
v_cvt_pk_bf16_f32 v50, v212, v213
v_cvt_pk_bf16_f32 v51, v214, v215
v_mfma_f32_16x16x32_bf16 v[216:219], v[152:155], a[116:119], v[216:219]
buffer_store_dwordx4 v[48:51], v19, s[4:7], s94 offen sc1
v_mfma_f32_16x16x32_bf16 v[220:223], v[156:159], a[116:119], v[220:223]
v_mfma_f32_16x16x32_bf16 v[224:227], v[72:75], a[148:151], v[224:227]
v_mfma_f32_16x16x32_bf16 v[216:219], v[160:163], a[120:123], v[216:219]
v_mfma_f32_16x16x32_bf16 v[220:223], v[164:167], a[120:123], v[220:223]
v_mfma_f32_16x16x32_bf16 v[228:231], v[76:79], a[148:151], v[228:231]
v_mfma_f32_16x16x32_bf16 v[216:219], v[168:171], a[124:127], v[216:219]
v_mfma_f32_16x16x32_bf16 v[220:223], v[172:175], a[124:127], v[220:223]
v_mfma_f32_16x16x32_bf16 v[224:227], v[80:83], a[152:155], v[224:227]
v_mfma_f32_16x16x32_bf16 v[216:219], v[176:179], a[128:131], v[216:219]
v_mfma_f32_16x16x32_bf16 v[220:223], v[180:183], a[128:131], v[220:223]
v_mfma_f32_16x16x32_bf16 v[228:231], v[84:87], a[152:155], v[228:231]
v_mfma_f32_16x16x32_bf16 v[216:219], v[184:187], a[132:135], v[216:219]
v_mfma_f32_16x16x32_bf16 v[220:223], v[188:191], a[132:135], v[220:223]
v_mfma_f32_16x16x32_bf16 v[224:227], v[88:91], a[156:159], v[224:227]
v_mfma_f32_16x16x32_bf16 v[216:219], v[192:195], a[136:139], v[216:219]
v_mfma_f32_16x16x32_bf16 v[220:223], v[196:199], a[136:139], v[220:223]
v_mfma_f32_16x16x32_bf16 v[228:231], v[92:95], a[156:159], v[228:231]
v_mfma_f32_16x16x32_bf16 v[216:219], v[200:203], a[140:143], v[216:219]
v_mfma_f32_16x16x32_bf16 v[220:223], v[204:207], a[140:143], v[220:223]
v_mfma_f32_16x16x32_bf16 v[224:227], v[96:99], a[160:163], v[224:227]
v_mfma_f32_16x16x32_bf16 v[228:231], v[100:103], a[160:163], v[228:231]
s_waitcnt vmcnt(1)
ds_write_b32 v18, v24
v_mfma_f32_16x16x32_bf16 v[224:227], v[104:107], a[164:167], v[224:227]
v_mfma_f32_16x16x32_bf16 v[228:231], v[108:111], a[164:167], v[228:231]
v_mfma_f32_16x16x32_bf16 v[224:227], v[112:115], a[168:171], v[224:227]
s_waitcnt lgkmcnt(0)
s_barrier
v_mfma_f32_16x16x32_bf16 v[228:231], v[116:119], a[168:171], v[228:231]
ds_read_b32 v33, v32
v_cvt_pk_bf16_f32 v52, v216, v217
v_mfma_f32_16x16x32_bf16 v[224:227], v[120:123], a[172:175], v[224:227]
buffer_store_dword v27, v45, s[4:7], s70 offen
v_mfma_f32_16x16x32_bf16 v[228:231], v[124:127], a[172:175], v[228:231]
buffer_store_dword v27, v44, s[4:7], s70 offen sc1
v_mfma_f32_16x16x32_bf16 v[224:227], v[128:131], a[176:179], v[224:227]
s_waitcnt lgkmcnt(0)
v_cmp_gt_u32 vcc, s81, v33
v_mfma_f32_16x16x32_bf16 v[228:231], v[132:135], a[176:179], v[228:231]
s_lshr_b64 s[58:59], vcc, s82
s_and_b32 s58, s58, s56
s_cselect_b32 s10, 0, 268435456
s_cselect_b32 s85, 0, 1
v_mfma_f32_16x16x32_bf16 v[224:227], v[136:139], a[180:183], v[224:227]
s_cmp_eq_u32 s80, 0
s_cbranch_scc1 g_slow_36
v_mfma_f32_16x16x32_bf16 v[228:231], v[140:143], a[180:183], v[228:231]
s_add_u32 m0, s73, 0
v_cvt_pk_bf16_f32 v53, v218, v219
v_mfma_f32_16x16x32_bf16 v[224:227], v[144:147], a[184:187], v[224:227]
buffer_load_dwordx4 v8, s[8:11], s83 offen offset:0 sc1 lds
v_mfma_f32_16x16x32_bf16 v[228:231], v[148:151], a[184:187], v[228:231]
v_cvt_pk_bf16_f32 v54, v220, v221
v_cvt_pk_bf16_f32 v55, v222, v223
v_mfma_f32_16x16x32_bf16 v[224:227], v[152:155], a[188:191], v[224:227]
buffer_store_dwordx4 v[52:55], v20, s[4:7], s94 offen sc1
v_mfma_f32_16x16x32_bf16 v[228:231], v[156:159], a[188:191], v[228:231]
v_mfma_f32_16x16x32_bf16 v[224:227], v[160:163], a[192:195], v[224:227]
buffer_load_dwordx4 v9, s[8:11], s83 offen offset:1024 sc1 lds
v_mfma_f32_16x16x32_bf16 v[228:231], v[164:167], a[192:195], v[228:231]
v_mfma_f32_16x16x32_bf16 v[224:227], v[168:171], a[196:199], v[224:227]
ds_read_b128 v[64:67], v28 offset:0
v_mfma_f32_16x16x32_bf16 v[228:231], v[172:175], a[196:199], v[228:231]
ds_read_b128 v[68:71], v28 offset:9216
v_mfma_f32_16x16x32_bf16 v[224:227], v[176:179], a[200:203], v[224:227]
buffer_load_dwordx4 v10, s[8:11], s83 offen offset:2048 sc1 lds
ds_read_b128 v[72:75], v28 offset:18432
v_mfma_f32_16x16x32_bf16 v[228:231], v[180:183], a[200:203], v[228:231]
ds_read_b128 v[76:79], v28 offset:27648
v_mfma_f32_16x16x32_bf16 v[224:227], v[184:187], a[204:207], v[224:227]
ds_read_b128 v[80:83], v28 offset:1024
v_mfma_f32_16x16x32_bf16 v[228:231], v[188:191], a[204:207], v[228:231]
ds_read_b128 v[84:87], v28 offset:10240
v_mfma_f32_16x16x32_bf16 v[224:227], v[192:195], a[208:211], v[224:227]
buffer_load_dwordx4 v11, s[8:11], s83 offen offset:3072 sc1 lds
ds_read_b128 v[88:91], v28 offset:19456
v_mfma_f32_16x16x32_bf16 v[228:231], v[196:199], a[208:211], v[228:231]
ds_read_b128 v[92:95], v28 offset:28672
v_mfma_f32_16x16x32_bf16 v[224:227], v[200:203], a[212:215], v[224:227]
v_mfma_f32_16x16x32_bf16 v[228:231], v[204:207], a[212:215], v[228:231]
s_branch g_body_17
g_slow_33:
v_cmp_gt_u32 vcc, s81, v33
s_nop 0
s_lshr_b64 s[58:59], vcc, s82
s_and_b32 s58, s58, s56
s_cbranch_scc1 g_notyet_39
s_add_u32 m0, s73, 0
s_nop 0
buffer_load_dwordx4 v8, s[4:7], s83 offen offset:0 sc1 lds
buffer_load_dwordx4 v9, s[4:7], s83 offen offset:1024 sc1 lds
buffer_load_dwordx4 v10, s[4:7], s83 offen offset:2048 sc1 lds
buffer_load_dwordx4 v11, s[4:7], s83 offen offset:3072 sc1 lds
s_add_u32 m0, s73, 4096
s_nop 0
buffer_load_dwordx4 v12, s[4:7], s83 offen offset:0 sc1 lds
buffer_load_dwordx4 v13, s[4:7], s83 offen offset:1024 sc1 lds
buffer_load_dwordx4 v14, s[4:7], s83 offen offset:2048 sc1 lds
buffer_load_dwordx4 v15, s[4:7], s83 offen offset:3072 sc1 lds
s_add_u32 m0, s73, 8192
s_nop 0
buffer_load_dwordx4 v16, s[4:7], s83 offen offset:0 sc1 lds
v_mfma_f32_16x16x32_bf16 v[228:231], v[140:143], a[180:183], v[228:231]
s_add_u32 m0, s74, 0
v_cvt_pk_bf16_f32 v53, v218, v219
v_mfma_f32_16x16x32_bf16 v[224:227], v[144:147], a[184:187], v[224:227]
buffer_load_dwordx4 v8, s[8:11], s88 offen offset:0 sc1 lds
v_mfma_f32_16x16x32_bf16 v[228:231], v[148:151], a[184:187], v[228:231]
v_cvt_pk_bf16_f32 v54, v220, v221
v_cvt_pk_bf16_f32 v55, v222, v223
v_mfma_f32_16x16x32_bf16 v[224:227], v[152:155], a[188:191], v[224:227]
buffer_store_dwordx4 v[52:55], v20, s[4:7], s79 offen sc1
v_mfma_f32_16x16x32_bf16 v[228:231], v[156:159], a[188:191], v[228:231]
v_mfma_f32_16x16x32_bf16 v[224:227], v[160:163], a[192:195], v[224:227]
buffer_load_dwordx4 v9, s[8:11], s88 offen offset:1024 sc1 lds
v_mfma_f32_16x16x32_bf16 v[228:231], v[164:167], a[192:195], v[228:231]
v_mfma_f32_16x16x32_bf16 v[224:227], v[168:171], a[196:199], v[224:227]
v_mfma_f32_16x16x32_bf16 v[228:231], v[172:175], a[196:199], v[228:231]
v_mfma_f32_16x16x32_bf16 v[224:227], v[176:179], a[200:203], v[224:227]
buffer_load_dwordx4 v10, s[8:11], s88 offen offset:2048 sc1 lds
v_mfma_f32_16x16x32_bf16 v[228:231], v[180:183], a[200:203], v[228:231]
v_mfma_f32_16x16x32_bf16 v[224:227], v[184:187], a[204:207], v[224:227]
v_mfma_f32_16x16x32_bf16 v[228:231], v[188:191], a[204:207], v[228:231]
v_mfma_f32_16x16x32_bf16 v[224:227], v[192:195], a[208:211], v[224:227]
buffer_load_dwordx4 v11, s[8:11], s88 offen offset:3072 sc1 lds
v_mfma_f32_16x16x32_bf16 v[228:231], v[196:199], a[208:211], v[228:231]
v_mfma_f32_16x16x32_bf16 v[224:227], v[200:203], a[212:215], v[224:227]
v_mfma_f32_16x16x32_bf16 v[228:231], v[204:207], a[212:215], v[228:231]
s_nop 6
v_cvt_pk_bf16_f32 v56, v224, v225
v_cvt_pk_bf16_f32 v57, v226, v227
v_cvt_pk_bf16_f32 v58, v228, v229
v_cvt_pk_bf16_f32 v59, v230, v231
buffer_store_dwordx4 v[56:59], v21, s[4:7], s79 offen sc1
s_mov_b32 s79, 1879048192
s_waitcnt vmcnt(6)
s_branch g_go_40
g_notyet_39:
v_mfma_f32_16x16x32_bf16 v[228:231], v[140:143], a[180:183], v[228:231]
s_add_u32 m0, s74, 0
v_cvt_pk_bf16_f32 v53, v218, v219
v_mfma_f32_16x16x32_bf16 v[224:227], v[144:147], a[184:187], v[224:227]
buffer_load_dwordx4 v8, s[8:11], s88 offen offset:0 sc1 lds
v_mfma_f32_16x16x32_bf16 v[228:231], v[148:151], a[184:187], v[228:231]
v_cvt_pk_bf16_f32 v54, v220, v221
v_cvt_pk_bf16_f32 v55, v222, v223
v_mfma_f32_16x16x32_bf16 v[224:227], v[152:155], a[188:191], v[224:227]
buffer_store_dwordx4 v[52:55], v20, s[4:7], s79 offen sc1
v_mfma_f32_16x16x32_bf16 v[228:231], v[156:159], a[188:191], v[228:231]
v_mfma_f32_16x16x32_bf16 v[224:227], v[160:163], a[192:195], v[224:227]
buffer_load_dwordx4 v9, s[8:11], s88 offen offset:1024 sc1 lds
v_mfma_f32_16x16x32_bf16 v[228:231], v[164:167], a[192:195], v[228:231]
v_mfma_f32_16x16x32_bf16 v[224:227], v[168:171], a[196:199], v[224:227]
v_mfma_f32_16x16x32_bf16 v[228:231], v[172:175], a[196:199], v[228:231]
v_mfma_f32_16x16x32_bf16 v[224:227], v[176:179], a[200:203], v[224:227]
buffer_load_dwordx4 v10, s[8:11], s88 offen offset:2048 sc1 lds
v_mfma_f32_16x16x32_bf16 v[228:231], v[180:183], a[200:203], v[228:231]
v_mfma_f32_16x16x32_bf16 v[224:227], v[184:187], a[204:207], v[224:227]
v_mfma_f32_16x16x32_bf16 v[228:231], v[188:191], a[204:207], v[228:231]
v_mfma_f32_16x16x32_bf16 v[224:227], v[192:195], a[208:211], v[224:227]
buffer_load_dwordx4 v11, s[8:11], s88 offen offset:3072 sc1 lds
v_mfma_f32_16x16x32_bf16 v[228:231], v[196:199], a[208:211], v[228:231]
v_mfma_f32_16x16x32_bf16 v[224:227], v[200:203], a[212:215], v[224:227]
v_mfma_f32_16x16x32_bf16 v[228:231], v[204:207], a[212:215], v[228:231]
s_nop 6
v_cvt_pk_bf16_f32 v56, v224, v225
v_cvt_pk_bf16_f32 v57, v226, v227
v_cvt_pk_bf16_f32 v58, v228, v229
v_cvt_pk_bf16_f32 v59, v230, v231
buffer_store_dwordx4 v[56:59], v21, s[4:7], s79 offen sc1
s_mov_b32 s79, 1879048192
v_mov_b32 v27, s76
s_lshl_b32 s70, s77, 10
s_waitcnt vmcnt(0)
s_barrier
buffer_store_dword v27, v45, s[4:7], s70 offen
buffer_store_dword v27, v44, s[4:7], s70 offen sc1
s_mov_b32 s77, 1835008
s_cmp_eq_u32 s81, -1
s_cbranch_scc1 g_fin_25
s_cmp_lg_u32 s3, 0
s_cbranch_scc1 sp_ok_42
s_mov_b32 s55, 0
sp_loop_41:
s_lshl_b64 exec, s[56:57], s82
buffer_load_dword v26, v22, s[4:7], 0 offen sc1
s_mov_b64 exec, -1
s_add_u32 s55, s55, 1
s_cmp_gt_u32 s55, 150000
s_cbranch_scc1 sp_bad_43
s_waitcnt vmcnt(0)
v_cmp_gt_u32 vcc, s81, v26
s_nop 0
s_lshr_b64 s[58:59], vcc, s82
s_and_b32 s58, s58, s56
s_cbranch_scc0 sp_ok_42
s_sleep 1
s_branch sp_loop_41
sp_bad_43:
s_mov_b32 s98, 1025
s_branch L_fail
sp_ok_42:
s_barrier
s_add_u32 m0, s73, 0
s_nop 0
buffer_load_dwordx4 v8, s[4:7], s83 offen offset:0 sc1 lds
buffer_load_dwordx4 v9, s[4:7], s83 offen offset:1024 sc1 lds
buffer_load_dwordx4 v10, s[4:7], s83 offen offset:2048 sc1 lds
buffer_load_dwordx4 v11, s[4:7], s83 offen offset:3072 sc1 lds
s_add_u32 m0, s73, 4096
s_nop 0
buffer_load_dwordx4 v12, s[4:7], s83 offen offset:0 sc1 lds
buffer_load_dwordx4 v13, s[4:7], s83 offen offset:1024 sc1 lds
buffer_load_dwordx4 v14, s[4:7], s83 offen offset:2048 sc1 lds
buffer_load_dwordx4 v15, s[4:7], s83 offen offset:3072 sc1 lds
s_add_u32 m0, s73, 8192
s_nop 0
buffer_load_dwordx4 v16, s[4:7], s83 offen offset:0 sc1 lds
s_waitcnt vmcnt(0)
g_go_40:
g_join_22:
s_barrier
ds_read_b128 v[64:67], v29 offset:0
ds_read_b128 v[68:71], v29 offset:9216
ds_read_b128 v[72:75], v29 offset:18432
ds_read_b128 v[76:79], v29 offset:27648
ds_read_b128 v[80:83], v29 offset:1024
ds_read_b128 v[84:87], v29 offset:10240
ds_read_b128 v[88:91], v29 offset:19456
ds_read_b128 v[92:95], v29 offset:28672
s_branch g_body_18
g_slow_34:
v_cmp_gt_u32 vcc, s86, v33
s_nop 0
s_lshr_b64 s[58:59], vcc, s87
s_and_b32 s58, s58, s56
s_cbranch_scc1 g_notyet_44
s_add_u32 m0, s74, 0
s_nop 0
buffer_load_dwordx4 v8, s[4:7], s88 offen offset:0 sc1 lds
buffer_load_dwordx4 v9, s[4:7], s88 offen offset:1024 sc1 lds
buffer_load_dwordx4 v10, s[4:7], s88 offen offset:2048 sc1 lds
buffer_load_dwordx4 v11, s[4:7], s88 offen offset:3072 sc1 lds
s_add_u32 m0, s74, 4096
s_nop 0
buffer_load_dwordx4 v12, s[4:7], s88 offen offset:0 sc1 lds
buffer_load_dwordx4 v13, s[4:7], s88 offen offset:1024 sc1 lds
buffer_load_dwordx4 v14, s[4:7], s88 offen offset:2048 sc1 lds
buffer_load_dwordx4 v15, s[4:7], s88 offen offset:3072 sc1 lds
s_add_u32 m0, s74, 8192
s_nop 0
buffer_load_dwordx4 v16, s[4:7], s88 offen offset:0 sc1 lds
v_mfma_f32_16x16x32_bf16 v[228:231], v[140:143], a[180:183], v[228:231]
s_add_u32 m0, s75, 0
v_cvt_pk_bf16_f32 v53, v218, v219
v_mfma_f32_16x16x32_bf16 v[224:227], v[144:147], a[184:187], v[224:227]
buffer_load_dwordx4 v8, s[8:11], s93 offen offset:0 sc1 lds
v_mfma_f32_16x16x32_bf16 v[228:231], v[148:151], a[184:187], v[228:231]
v_cvt_pk_bf16_f32 v54, v220, v221
v_cvt_pk_bf16_f32 v55, v222, v223
v_mfma_f32_16x16x32_bf16 v[224:227], v[152:155], a[188:191], v[224:227]
buffer_store_dwordx4 v[52:55], v20, s[4:7], s84 offen sc1
v_mfma_f32_16x16x32_bf16 v[228:231], v[156:159], a[188:191], v[228:231]
v_mfma_f32_16x16x32_bf16 v[224:227], v[160:163], a[192:195], v[224:227]
buffer_load_dwordx4 v9, s[8:11], s93 offen offset:1024 sc1 lds
v_mfma_f32_16x16x32_bf16 v[228:231], v[164:167], a[192:195], v[228:231]
v_mfma_f32_16x16x32_bf16 v[224:227], v[168:171], a[196:199], v[224:227]
v_mfma_f32_16x16x32_bf16 v[228:231], v[172:175], a[196:199], v[228:231]
v_mfma_f32_16x16x32_bf16 v[224:227], v[176:179], a[200:203], v[224:227]
buffer_load_dwordx4 v10, s[8:11], s93 offen offset:2048 sc1 lds
v_mfma_f32_16x16x32_bf16 v[228:231], v[180:183], a[200:203], v[228:231]
v_mfma_f32_16x16x32_bf16 v[224:227], v[184:187], a[204:207], v[224:227]
v_mfma_f32_16x16x32_bf16 v[228:231], v[188:191], a[204:207], v[228:231]
v_mfma_f32_16x16x32_bf16 v[224:227], v[192:195], a[208:211], v[224:227]
buffer_load_dwordx4 v11, s[8:11], s93 offen offset:3072 sc1 lds
v_mfma_f32_16x16x32_bf16 v[228:231], v[196:199], a[208:211], v[228:231]
v_mfma_f32_16x16x32_bf16 v[224:227], v[200:203], a[212:215], v[224:227]
v_mfma_f32_16x16x32_bf16 v[228:231], v[204:207], a[212:215], v[228:231]
s_nop 6
v_cvt_pk_bf16_f32 v56, v224, v225
v_cvt_pk_bf16_f32 v57, v226, v227
v_cvt_pk_bf16_f32 v58, v228, v229
v_cvt_pk_bf16_f32 v59, v230, v231
buffer_store_dwordx4 v[56:59], v21, s[4:7], s84 offen sc1
s_mov_b32 s84, 1879048192
s_waitcnt vmcnt(6)
s_branch g_go_45
g_notyet_44:
v_mfma_f32_16x16x32_bf16 v[228:231], v[140:143], a[180:183], v[228:231]
s_add_u32 m0, s75, 0
v_cvt_pk_bf16_f32 v53, v218, v219
v_mfma_f32_16x16x32_bf16 v[224:227], v[144:147], a[184:187], v[224:227]
buffer_load_dwordx4 v8, s[8:11], s93 offen offset:0 sc1 lds
v_mfma_f32_16x16x32_bf16 v[228:231], v[148:151], a[184:187], v[228:231]
v_cvt_pk_bf16_f32 v54, v220, v221
v_cvt_pk_bf16_f32 v55, v222, v223
v_mfma_f32_16x16x32_bf16 v[224:227], v[152:155], a[188:191], v[224:227]
buffer_store_dwordx4 v[52:55], v20, s[4:7], s84 offen sc1
v_mfma_f32_16x16x32_bf16 v[228:231], v[156:159], a[188:191], v[228:231]
v_mfma_f32_16x16x32_bf16 v[224:227], v[160:163], a[192:195], v[224:227]
buffer_load_dwordx4 v9, s[8:11], s93 offen offset:1024 sc1 lds
v_mfma_f32_16x16x32_bf16 v[228:231], v[164:167], a[192:195], v[228:231]
v_mfma_f32_16x16x32_bf16 v[224:227], v[168:171], a[196:199], v[224:227]
v_mfma_f32_16x16x32_bf16 v[228:231], v[172:175], a[196:199], v[228:231]
v_mfma_f32_16x16x32_bf16 v[224:227], v[176:179], a[200:203], v[224:227]
buffer_load_dwordx4 v10, s[8:11], s93 offen offset:2048 sc1 lds
v_mfma_f32_16x16x32_bf16 v[228:231], v[180:183], a[200:203], v[228:231]
v_mfma_f32_16x16x32_bf16 v[224:227], v[184:187], a[204:207], v[224:227]
v_mfma_f32_16x16x32_bf16 v[228:231], v[188:191], a[204:207], v[228:231]
v_mfma_f32_16x16x32_bf16 v[224:227], v[192:195], a[208:211], v[224:227]
buffer_load_dwordx4 v11, s[8:11], s93 offen offset:3072 sc1 lds
v_mfma_f32_16x16x32_bf16 v[228:231], v[196:199], a[208:211], v[228:231]
v_mfma_f32_16x16x32_bf16 v[224:227], v[200:203], a[212:215], v[224:227]
v_mfma_f32_16x16x32_bf16 v[228:231], v[204:207], a[212:215], v[228:231]
s_nop 6
v_cvt_pk_bf16_f32 v56, v224, v225
v_cvt_pk_bf16_f32 v57, v226, v227
v_cvt_pk_bf16_f32 v58, v228, v229
v_cvt_pk_bf16_f32 v59, v230, v231
buffer_store_dwordx4 v[56:59], v21, s[4:7], s84 offen sc1
s_mov_b32 s84, 1879048192
v_mov_b32 v27, s81
s_lshl_b32 s70, s82, 10
s_waitcnt vmcnt(0)
s_barrier
buffer_store_dword v27, v45, s[4:7], s70 offen
buffer_store_dword v27, v44, s[4:7], s70 offen sc1
s_mov_b32 s82, 1835008
s_cmp_eq_u32 s86, -1
s_cbranch_scc1 g_fin_25
s_cmp_lg_u32 s3, 0
s_cbranch_scc1 sp_ok_47
s_mov_b32 s55, 0
sp_loop_46:
s_lshl_b64 exec, s[56:57], s87
buffer_load_dword v26, v22, s[4:7], 0 offen sc1
s_mov_b64 exec, -1
s_add_u32 s55, s55, 1
s_cmp_gt_u32 s55, 150000
s_cbranch_scc1 sp_bad_48
s_waitcnt vmcnt(0)
v_cmp_gt_u32 vcc, s86, v26
s_nop 0
s_lshr_b64 s[58:59], vcc, s87
s_and_b32 s58, s58, s56
s_cbranch_scc0 sp_ok_47
s_sleep 1
s_branch sp_loop_46
sp_bad_48:
s_mov_b32 s98, 1025
s_branch L_fail
sp_ok_47:
s_barrier
s_add_u32 m0, s74, 0
s_nop 0
buffer_load_dwordx4 v8, s[4:7], s88 offen offset:0 sc1 lds
buffer_load_dwordx4 v9, s[4:7], s88 offen offset:1024 sc1 lds
buffer_load_dwordx4 v10, s[4:7], s88 offen offset:2048 sc1 lds
buffer_load_dwordx4 v11, s[4:7], s88 offen offset:3072 sc1 lds
s_add_u32 m0, s74, 4096
s_nop 0
buffer_load_dwordx4 v12, s[4:7], s88 offen offset:0 sc1 lds
buffer_load_dwordx4 v13, s[4:7], s88 offen offset:1024 sc1 lds
buffer_load_dwordx4 v14, s[4:7], s88 offen offset:2048 sc1 lds
buffer_load_dwordx4 v15, s[4:7], s88 offen offset:3072 sc1 lds
s_add_u32 m0, s74, 8192
s_nop 0
buffer_load_dwordx4 v16, s[4:7], s88 offen offset:0 sc1 lds
s_waitcnt vmcnt(0)
g_go_45:
g_join_23:
s_barrier
ds_read_b128 v[64:67], v30 offset:0
ds_read_b128 v[68:71], v30 offset:9216
ds_read_b128 v[72:75], v30 offset:18432
ds_read_b128 v[76:79], v30 offset:27648
ds_read_b128 v[80:83], v30 offset:1024
ds_read_b128 v[84:87], v30 offset:10240
ds_read_b128 v[88:91], v30 offset:19456
ds_read_b128 v[92:95], v30 offset:28672
s_branch g_body_19
g_slow_35:
v_cmp_gt_u32 vcc, s91, v33
s_nop 0
s_lshr_b64 s[58:59], vcc, s92
s_and_b32 s58, s58, s56
s_cbranch_scc1 g_notyet_49
s_add_u32 m0, s75, 0
s_nop 0
buffer_load_dwordx4 v8, s[4:7], s93 offen offset:0 sc1 lds
buffer_load_dwordx4 v9, s[4:7], s93 offen offset:1024 sc1 lds
buffer_load_dwordx4 v10, s[4:7], s93 offen offset:2048 sc1 lds
buffer_load_dwordx4 v11, s[4:7], s93 offen offset:3072 sc1 lds
s_add_u32 m0, s75, 4096
s_nop 0
buffer_load_dwordx4 v12, s[4:7], s93 offen offset:0 sc1 lds
buffer_load_dwordx4 v13, s[4:7], s93 offen offset:1024 sc1 lds
buffer_load_dwordx4 v14, s[4:7], s93 offen offset:2048 sc1 lds
buffer_load_dwordx4 v15, s[4:7], s93 offen offset:3072 sc1 lds
s_add_u32 m0, s75, 8192
s_nop 0
buffer_load_dwordx4 v16, s[4:7], s93 offen offset:0 sc1 lds
v_mfma_f32_16x16x32_bf16 v[228:231], v[140:143], a[180:183], v[228:231]
s_add_u32 m0, s72, 0
v_cvt_pk_bf16_f32 v53, v218, v219
v_mfma_f32_16x16x32_bf16 v[224:227], v[144:147], a[184:187], v[224:227]
buffer_load_dwordx4 v8, s[8:11], s78 offen offset:0 sc1 lds
v_mfma_f32_16x16x32_bf16 v[228:231], v[148:151], a[184:187], v[228:231]
v_cvt_pk_bf16_f32 v54, v220, v221
v_cvt_pk_bf16_f32 v55, v222, v223
v_mfma_f32_16x16x32_bf16 v[224:227], v[152:155], a[188:191], v[224:227]
buffer_store_dwordx4 v[52:55], v20, s[4:7], s89 offen sc1
v_mfma_f32_16x16x32_bf16 v[228:231], v[156:159], a[188:191], v[228:231]
v_mfma_f32_16x16x32_bf16 v[224:227], v[160:163], a[192:195], v[224:227]
buffer_load_dwordx4 v9, s[8:11], s78 offen offset:1024 sc1 lds
v_mfma_f32_16x16x32_bf16 v[228:231], v[164:167], a[192:195], v[228:231]
v_mfma_f32_16x16x32_bf16 v[224:227], v[168:171], a[196:199], v[224:227]
v_mfma_f32_16x16x32_bf16 v[228:231], v[172:175], a[196:199], v[228:231]
v_mfma_f32_16x16x32_bf16 v[224:227], v[176:179], a[200:203], v[224:227]
buffer_load_dwordx4 v10, s[8:11], s78 offen offset:2048 sc1 lds
v_mfma_f32_16x16x32_bf16 v[228:231], v[180:183], a[200:203], v[228:231]
v_mfma_f32_16x16x32_bf16 v[224:227], v[184:187], a[204:207], v[224:227]
v_mfma_f32_16x16x32_bf16 v[228:231], v[188:191], a[204:207], v[228:231]
v_mfma_f32_16x16x32_bf16 v[224:227], v[192:195], a[208:211], v[224:227]
buffer_load_dwordx4 v11, s[8:11], s78 offen offset:3072 sc1 lds
v_mfma_f32_16x16x32_bf16 v[228:231], v[196:199], a[208:211], v[228:231]
v_mfma_f32_16x16x32_bf16 v[224:227], v[200:203], a[212:215], v[224:227]
v_mfma_f32_16x16x32_bf16 v[228:231], v[204:207], a[212:215], v[228:231]
s_nop 6
v_cvt_pk_bf16_f32 v56, v224, v225
v_cvt_pk_bf16_f32 v57, v226, v227
v_cvt_pk_bf16_f32 v58, v228, v229
v_cvt_pk_bf16_f32 v59, v230, v231
buffer_store_dwordx4 v[56:59], v21, s[4:7], s89 offen sc1
s_mov_b32 s89, 1879048192
s_waitcnt vmcnt(6)
s_branch g_go_50
g_notyet_49:
v_mfma_f32_16x16x32_bf16 v[228:231], v[140:143], a[180:183], v[228:231]
s_add_u32 m0, s72, 0
v_cvt_pk_bf16_f32 v53, v218, v219
v_mfma_f32_16x16x32_bf16 v[224:227], v[144:147], a[184:187], v[224:227]
buffer_load_dwordx4 v8, s[8:11], s78 offen offset:0 sc1 lds
v_mfma_f32_16x16x32_bf16 v[228:231], v[148:151], a[184:187], v[228:231]
v_cvt_pk_bf16_f32 v54, v220, v221
v_cvt_pk_bf16_f32 v55, v222, v223
v_mfma_f32_16x16x32_bf16 v[224:227], v[152:155], a[188:191], v[224:227]
buffer_store_dwordx4 v[52:55], v20, s[4:7], s89 offen sc1
v_mfma_f32_16x16x32_bf16 v[228:231], v[156:159], a[188:191], v[228:231]
v_mfma_f32_16x16x32_bf16 v[224:227], v[160:163], a[192:195], v[224:227]
buffer_load_dwordx4 v9, s[8:11], s78 offen offset:1024 sc1 lds
v_mfma_f32_16x16x32_bf16 v[228:231], v[164:167], a[192:195], v[228:231]
v_mfma_f32_16x16x32_bf16 v[224:227], v[168:171], a[196:199], v[224:227]
v_mfma_f32_16x16x32_bf16 v[228:231], v[172:175], a[196:199], v[228:231]
v_mfma_f32_16x16x32_bf16 v[224:227], v[176:179], a[200:203], v[224:227]
buffer_load_dwordx4 v10, s[8:11], s78 offen offset:2048 sc1 lds
v_mfma_f32_16x16x32_bf16 v[228:231], v[180:183], a[200:203], v[228:231]
v_mfma_f32_16x16x32_bf16 v[224:227], v[184:187], a[204:207], v[224:227]
v_mfma_f32_16x16x32_bf16 v[228:231], v[188:191], a[204:207], v[228:231]
v_mfma_f32_16x16x32_bf16 v[224:227], v[192:195], a[208:211], v[224:227]
buffer_load_dwordx4 v11, s[8:11], s78 offen offset:3072 sc1 lds
v_mfma_f32_16x16x32_bf16 v[228:231], v[196:199], a[208:211], v[228:231]
v_mfma_f32_16x16x32_bf16 v[224:227], v[200:203], a[212:215], v[224:227]
v_mfma_f32_16x16x32_bf16 v[228:231], v[204:207], a[212:215], v[228:231]
s_nop 6
v_cvt_pk_bf16_f32 v56, v224, v225
v_cvt_pk_bf16_f32 v57, v226, v227
v_cvt_pk_bf16_f32 v58, v228, v229
v_cvt_pk_bf16_f32 v59, v230, v231
buffer_store_dwordx4 v[56:59], v21, s[4:7], s89 offen sc1
s_mov_b32 s89, 1879048192
v_mov_b32 v27, s86
s_lshl_b32 s70, s87, 10
s_waitcnt vmcnt(0)
s_barrier
buffer_store_dword v27, v45, s[4:7], s70 offen
buffer_store_dword v27, v44, s[4:7], s70 offen sc1
s_mov_b32 s87, 1835008
s_cmp_eq_u32 s91, -1
s_cbranch_scc1 g_fin_25
s_cmp_lg_u32 s3, 0
s_cbranch_scc1 sp_ok_52
s_mov_b32 s55, 0
sp_loop_51:
s_lshl_b64 exec, s[56:57], s92
buffer_load_dword v26, v22, s[4:7], 0 offen sc1
s_mov_b64 exec, -1
s_add_u32 s55, s55, 1
s_cmp_gt_u32 s55, 150000
s_cbranch_scc1 sp_bad_53
s_waitcnt vmcnt(0)
v_cmp_gt_u32 vcc, s91, v26
s_nop 0
s_lshr_b64 s[58:59], vcc, s92
s_and_b32 s58, s58, s56
s_cbranch_scc0 sp_ok_52
s_sleep 1
s_branch sp_loop_51
sp_bad_53:
s_mov_b32 s98, 1025
s_branch L_fail
sp_ok_52:
s_barrier
s_add_u32 m0, s75, 0
s_nop 0
buffer_load_dwordx4 v8, s[4:7], s93 offen offset:0 sc1 lds
buffer_load_dwordx4 v9, s[4:7], s93 offen offset:1024 sc1 lds
buffer_load_dwordx4 v10, s[4:7], s93 offen offset:2048 sc1 lds
buffer_load_dwordx4 v11, s[4:7], s93 offen offset:3072 sc1 lds
s_add_u32 m0, s75, 4096
s_nop 0
buffer_load_dwordx4 v12, s[4:7], s93 offen offset:0 sc1 lds
buffer_load_dwordx4 v13, s[4:7], s93 offen offset:1024 sc1 lds
buffer_load_dwordx4 v14, s[4:7], s93 offen offset:2048 sc1 lds
buffer_load_dwordx4 v15, s[4:7], s93 offen offset:3072 sc1 lds
s_add_u32 m0, s75, 8192
s_nop 0
buffer_load_dwordx4 v16, s[4:7], s93 offen offset:0 sc1 lds
s_waitcnt vmcnt(0)
g_go_50:
g_join_24:
s_barrier
ds_read_b128 v[64:67], v31 offset:0
ds_read_b128 v[68:71], v31 offset:9216
ds_read_b128 v[72:75], v31 offset:18432
ds_read_b128 v[76:79], v31 offset:27648
ds_read_b128 v[80:83], v31 offset:1024
ds_read_b128 v[84:87], v31 offset:10240
ds_read_b128 v[88:91], v31 offset:19456
ds_read_b128 v[92:95], v31 offset:28672
s_branch g_body_20
g_slow_36:
v_cmp_gt_u32 vcc, s76, v33
s_nop 0
s_lshr_b64 s[58:59], vcc, s77
s_and_b32 s58, s58, s56
s_cbranch_scc1 g_notyet_54
s_add_u32 m0, s72, 0
s_nop 0
buffer_load_dwordx4 v8, s[4:7], s78 offen offset:0 sc1 lds
buffer_load_dwordx4 v9, s[4:7], s78 offen offset:1024 sc1 lds
buffer_load_dwordx4 v10, s[4:7], s78 offen offset:2048 sc1 lds
buffer_load_dwordx4 v11, s[4:7], s78 offen offset:3072 sc1 lds
s_add_u32 m0, s72, 4096
s_nop 0
buffer_load_dwordx4 v12, s[4:7], s78 offen offset:0 sc1 lds
buffer_load_dwordx4 v13, s[4:7], s78 offen offset:1024 sc1 lds
buffer_load_dwordx4 v14, s[4:7], s78 offen offset:2048 sc1 lds
buffer_load_dwordx4 v15, s[4:7], s78 offen offset:3072 sc1 lds
s_add_u32 m0, s72, 8192
s_nop 0
buffer_load_dwordx4 v16, s[4:7], s78 offen offset:0 sc1 lds
v_mfma_f32_16x16x32_bf16 v[228:231], v[140:143], a[180:183], v[228:231]
s_add_u32 m0, s73, 0
v_cvt_pk_bf16_f32 v53, v218, v219
v_mfma_f32_16x16x32_bf16 v[224:227], v[144:147], a[184:187], v[224:227]
buffer_load_dwordx4 v8, s[8:11], s83 offen offset:0 sc1 lds
v_mfma_f32_16x16x32_bf16 v[228:231], v[148:151], a[184:187], v[228:231]
v_cvt_pk_bf16_f32 v54, v220, v221
v_cvt_pk_bf16_f32 v55, v222, v223
v_mfma_f32_16x16x32_bf16 v[224:227], v[152:155], a[188:191], v[224:227]
buffer_store_dwordx4 v[52:55], v20, s[4:7], s94 offen sc1
v_mfma_f32_16x16x32_bf16 v[228:231], v[156:159], a[188:191], v[228:231]
v_mfma_f32_16x16x32_bf16 v[224:227], v[160:163], a[192:195], v[224:227]
buffer_load_dwordx4 v9, s[8:11], s83 offen offset:1024 sc1 lds
v_mfma_f32_16x16x32_bf16 v[228:231], v[164:167], a[192:195], v[228:231]
v_mfma_f32_16x16x32_bf16 v[224:227], v[168:171], a[196:199], v[224:227]
v_mfma_f32_16x16x32_bf16 v[228:231], v[172:175], a[196:199], v[228:231]
v_mfma_f32_16x16x32_bf16 v[224:227], v[176:179], a[200:203], v[224:227]
buffer_load_dwordx4 v10, s[8:11], s83 offen offset:2048 sc1 lds
v_mfma_f32_16x16x32_bf16 v[228:231], v[180:183], a[200:203], v[228:231]
v_mfma_f32_16x16x32_bf16 v[224:227], v[184:187], a[204:207], v[224:227]
v_mfma_f32_16x16x32_bf16 v[228:231], v[188:191], a[204:207], v[228:231]
v_mfma_f32_16x16x32_bf16 v[224:227], v[192:195], a[208:211], v[224:227]
buffer_load_dwordx4 v11, s[8:11], s83 offen offset:3072 sc1 lds
v_mfma_f32_16x16x32_bf16 v[228:231], v[196:199], a[208:211], v[228:231]
v_mfma_f32_16x16x32_bf16 v[224:227], v[200:203], a[212:215], v[224:227]
v_mfma_f32_16x16x32_bf16 v[228:231], v[204:207], a[212:215], v[228:231]
s_nop 6
v_cvt_pk_bf16_f32 v56, v224, v225
v_cvt_pk_bf16_f32 v57, v226, v227
v_cvt_pk_bf16_f32 v58, v228, v229
v_cvt_pk_bf16_f32 v59, v230, v231
buffer_store_dwordx4 v[56:59], v21, s[4:7], s94 offen sc1
s_mov_b32 s94, 1879048192
s_waitcnt vmcnt(6)
s_branch g_go_55
g_notyet_54:
v_mfma_f32_16x16x32_bf16 v[228:231], v[140:143], a[180:183], v[228:231]
s_add_u32 m0, s73, 0
v_cvt_pk_bf16_f32 v53, v218, v219
v_mfma_f32_16x16x32_bf16 v[224:227], v[144:147], a[184:187], v[224:227]
buffer_load_dwordx4 v8, s[8:11], s83 offen offset:0 sc1 lds
v_mfma_f32_16x16x32_bf16 v[228:231], v[148:151], a[184:187], v[228:231]
v_cvt_pk_bf16_f32 v54, v220, v221
v_cvt_pk_bf16_f32 v55, v222, v223
v_mfma_f32_16x16x32_bf16 v[224:227], v[152:155], a[188:191], v[224:227]
buffer_store_dwordx4 v[52:55], v20, s[4:7], s94 offen sc1
v_mfma_f32_16x16x32_bf16 v[228:231], v[156:159], a[188:191], v[228:231]
v_mfma_f32_16x16x32_bf16 v[224:227], v[160:163], a[192:195], v[224:227]
buffer_load_dwordx4 v9, s[8:11], s83 offen offset:1024 sc1 lds
v_mfma_f32_16x16x32_bf16 v[228:231], v[164:167], a[192:195], v[228:231]
v_mfma_f32_16x16x32_bf16 v[224:227], v[168:171], a[196:199], v[224:227]
v_mfma_f32_16x16x32_bf16 v[228:231], v[172:175], a[196:199], v[228:231]
v_mfma_f32_16x16x32_bf16 v[224:227], v[176:179], a[200:203], v[224:227]
buffer_load_dwordx4 v10, s[8:11], s83 offen offset:2048 sc1 lds
v_mfma_f32_16x16x32_bf16 v[228:231], v[180:183], a[200:203], v[228:231]
v_mfma_f32_16x16x32_bf16 v[224:227], v[184:187], a[204:207], v[224:227]
v_mfma_f32_16x16x32_bf16 v[228:231], v[188:191], a[204:207], v[228:231]
v_mfma_f32_16x16x32_bf16 v[224:227], v[192:195], a[208:211], v[224:227]
buffer_load_dwordx4 v11, s[8:11], s83 offen offset:3072 sc1 lds
v_mfma_f32_16x16x32_bf16 v[228:231], v[196:199], a[208:211], v[228:231]
v_mfma_f32_16x16x32_bf16 v[224:227], v[200:203], a[212:215], v[224:227]
v_mfma_f32_16x16x32_bf16 v[228:231], v[204:207], a[212:215], v[228:231]
s_nop 6
v_cvt_pk_bf16_f32 v56, v224, v225
v_cvt_pk_bf16_f32 v57, v226, v227
v_cvt_pk_bf16_f32 v58, v228, v229
v_cvt_pk_bf16_f32 v59, v230, v231
buffer_store_dwordx4 v[56:59], v21, s[4:7], s94 offen sc1
s_mov_b32 s94, 1879048192
v_mov_b32 v27, s91
s_lshl_b32 s70, s92, 10
s_waitcnt vmcnt(0)
s_barrier
buffer_store_dword v27, v45, s[4:7], s70 offen
buffer_store_dword v27, v44, s[4:7], s70 offen sc1
s_mov_b32 s92, 1835008
s_cmp_eq_u32 s76, -1
s_cbranch_scc1 g_fin_25
s_cmp_lg_u32 s3, 0
s_cbranch_scc1 sp_ok_57
s_mov_b32 s55, 0
sp_loop_56:
s_lshl_b64 exec, s[56:57], s77
buffer_load_dword v26, v22, s[4:7], 0 offen sc1
s_mov_b64 exec, -1
s_add_u32 s55, s55, 1
s_cmp_gt_u32 s55, 150000
s_cbranch_scc1 sp_bad_58
s_waitcnt vmcnt(0)
v_cmp_gt_u32 vcc, s76, v26
s_nop 0
s_lshr_b64 s[58:59], vcc, s77
s_and_b32 s58, s58, s56
s_cbranch_scc0 sp_ok_57
s_sleep 1
s_branch sp_loop_56
sp_bad_58:
s_mov_b32 s98, 1025
s_branch L_fail
sp_ok_57:
s_barrier
s_add_u32 m0, s72, 0
s_nop 0
buffer_load_dwordx4 v8, s[4:7], s78 offen offset:0 sc1 lds
buffer_load_dwordx4 v9, s[4:7], s78 offen offset:1024 sc1 lds
buffer_load_dwordx4 v10, s[4:7], s78 offen offset:2048 sc1 lds
buffer_load_dwordx4 v11, s[4:7], s78 offen offset:3072 sc1 lds
s_add_u32 m0, s72, 4096
s_nop 0
buffer_load_dwordx4 v12, s[4:7], s78 offen offset:0 sc1 lds
buffer_load_dwordx4 v13, s[4:7], s78 offen offset:1024 sc1 lds
buffer_load_dwordx4 v14, s[4:7], s78 offen offset:2048 sc1 lds
buffer_load_dwordx4 v15, s[4:7], s78 offen offset:3072 sc1 lds
s_add_u32 m0, s72, 8192
s_nop 0
buffer_load_dwordx4 v16, s[4:7], s78 offen offset:0 sc1 lds
s_waitcnt vmcnt(0)
g_go_55:
s_branch g_join_21
g_fin_25:
s_endpgm
rare_37:
v_mov_b32 v36, v40
v_mov_b32 v37, v41
v_mov_b32 v38, v42
v_mov_b32 v39, v43
s_branch back_38
G_ssv18:
s_mov_b32 s8, s42
s_and_b32 s9, s43, 0xffff
s_mov_b32 s10, 0
s_mov_b32 s11, 0x20000
s_mov_b32 s52, 0
s_mul_i32 s72, s3, 9216
s_add_u32 s73, s72, 36864
s_add_u32 s74, s72, 73728
s_add_u32 s75, s72, 110592
s_mov_b32 s54, 0xbfb8aa3b
v_add_u32 v28, 0, v17
v_add_u32 v29, 36864, v17
v_add_u32 v30, 73728, v17
v_add_u32 v31, 110592, v17
v_lshlrev_b32 v1, 2, v0
v_add_u32 v32, 147456, v1
s_lshl_b32 s70, s3, 8
v_add_u32 v18, s70, v32
v_mov_b64 v[224:225], 0
v_mov_b64 v[236:237], 0
v_mov_b64 v[226:227], 0
v_mov_b64 v[238:239], 0
v_mov_b64 v[228:229], 0
v_mov_b64 v[240:241], 0
v_mov_b64 v[230:231], 0
v_mov_b64 v[242:243], 0
s_mov_b32 s12, s40
s_and_b32 s13, s41, 0xffff
s_mov_b32 s14, 256
s_mov_b32 s15, 0x20000
v_lshlrev_b32 v26, 2, v0
v_add_u32 v27, 128, v26
v_cmp_le_u32 vcc, 2, v0
s_nop 1
v_cndmask_b32 v26, v26, v27, vcc
v_mov_b32 v27, 192
v_cmp_eq_u32 vcc, 8, v0
s_nop 1
v_cndmask_b32 v26, v26, v27, vcc
v_mov_b32 v27, 2147483632
v_cmp_lt_u32 vcc, 8, v0
s_nop 1
v_cndmask_b32 v26, v26, v27, vcc
s_mov_b32 s98, 0
wi_loop_68:
buffer_load_dword v27, v26, s[12:15], 0 offen sc1
s_add_u32 s98, s98, 1
s_cmp_gt_u32 s98, 150000
s_cbranch_scc1 wi_bad_70
s_waitcnt vmcnt(0)
v_cmp_eq_u32 vcc, 32, v27
s_nop 0
s_and_b32 s97, vcc_lo, 0x1ff
s_cmp_eq_u32 s97, 0x1ff
s_cbranch_scc1 wi_ok_69
v_cmp_lt_u32 vcc, 32, v27
s_nop 0
s_and_b32 s96, vcc_lo, 0xff
s_cselect_b32 s96, 0x100, 0
s_and_b32 s96, s96, s97
s_cbranch_scc1 wi_over_71
s_sleep 8
s_branch wi_loop_68
wi_bad_70:
s_mov_b32 s98, 512
s_branch L_fail
wi_over_71:
s_mov_b32 s100, 255
wi_ok_69:
v_add_u32 v26, 65536, v22
v_cmp_eq_u32 vcc, s100, v23
s_nop 1
v_cndmask_b32 v22, v22, v26, vcc
s_cmp_lg_u32 s3, 0
s_cbranch_scc1 sp_ok_73
s_mov_b32 s55, 0
sp_loop_72:
s_lshl_b64 exec, s[56:57], s77
buffer_load_dword v26, v22, s[4:7], 0 offen sc1
s_mov_b64 exec, -1
s_add_u32 s55, s55, 1
s_cmp_gt_u32 s55, 150000
s_cbranch_scc1 sp_bad_74
s_waitcnt vmcnt(0)
v_cmp_gt_u32 vcc, s76, v26
s_nop 0
s_lshr_b64 s[58:59], vcc, s77
s_and_b32 s58, s58, s56
s_cbranch_scc0 sp_ok_73
s_sleep 1
s_branch sp_loop_72
sp_bad_74:
s_mov_b32 s98, 1026
s_branch L_fail
sp_ok_73:
s_barrier
s_add_u32 m0, s72, 0
s_nop 0
buffer_load_dwordx4 v8, s[4:7], s78 offen offset:0 sc1 lds
buffer_load_dwordx4 v9, s[4:7], s78 offen offset:1024 sc1 lds
buffer_load_dwordx4 v10, s[4:7], s78 offen offset:2048 sc1 lds
buffer_load_dwordx4 v11, s[4:7], s78 offen offset:3072 sc1 lds
s_add_u32 m0, s72, 4096
s_nop 0
buffer_load_dwordx4 v12, s[4:7], s78 offen offset:0 sc1 lds
buffer_load_dwordx4 v13, s[4:7], s78 offen offset:1024 sc1 lds
buffer_load_dwordx4 v14, s[4:7], s78 offen offset:2048 sc1 lds
buffer_load_dwordx4 v15, s[4:7], s78 offen offset:3072 sc1 lds
s_add_u32 m0, s72, 8192
s_nop 0
buffer_load_dwordx4 v16, s[4:7], s78 offen offset:0 sc1 lds
s_waitcnt vmcnt(0)
g_join_63:
s_barrier
ds_read_b128 v[64:67], v28 offset:0
ds_read_b128 v[68:71], v28 offset:9216
ds_read_b128 v[72:75], v28 offset:18432
ds_read_b128 v[76:79], v28 offset:27648
ds_read_b128 v[80:83], v28 offset:1024
ds_read_b128 v[84:87], v28 offset:10240
ds_read_b128 v[88:91], v28 offset:19456
ds_read_b128 v[92:95], v28 offset:28672
g_body_59:
s_waitcnt lgkmcnt(4)
v_mfma_f32_16x16x32_bf16 v[208:211], a[0:3], v[64:67], 0
ds_read_b128 v[96:99], v28 offset:2048
s_add_u32 m0, s73, 4096
v_mfma_f32_16x16x32_bf16 v[212:215], a[0:3], v[68:71], 0
ds_read_b128 v[100:103], v28 offset:11264
buffer_load_dwordx4 v12, s[8:11], s83 offen offset:0 sc1 lds
v_mfma_f32_16x16x32_bf16 v[216:219], a[72:75], v[64:67], 0
v_mfma_f32_16x16x32_bf16 v[208:211], a[4:7], v[72:75], v[208:211]
ds_read_b128 v[104:107], v28 offset:20480
v_cvt_pk_bf16_f32 v56, v224, v225
v_mfma_f32_16x16x32_bf16 v[212:215], a[4:7], v[76:79], v[212:215]
ds_read_b128 v[108:111], v28 offset:29696
buffer_load_dwordx4 v13, s[8:11], s83 offen offset:1024 sc1 lds
v_mfma_f32_16x16x32_bf16 v[220:223], a[72:75], v[68:71], 0
v_cvt_pk_bf16_f32 v57, v226, v227
s_waitcnt lgkmcnt(4)
v_mfma_f32_16x16x32_bf16 v[208:211], a[8:11], v[80:83], v[208:211]
ds_read_b128 v[112:115], v28 offset:3072
v_cvt_pk_bf16_f32 v58, v228, v229
v_mfma_f32_16x16x32_bf16 v[212:215], a[8:11], v[84:87], v[212:215]
ds_read_b128 v[116:119], v28 offset:12288
v_cvt_pk_bf16_f32 v59, v230, v231
v_mfma_f32_16x16x32_bf16 v[216:219], a[76:79], v[72:75], v[216:219]
buffer_load_dwordx4 v14, s[8:11], s83 offen offset:2048 sc1 lds
v_mfma_f32_16x16x32_bf16 v[208:211], a[12:15], v[88:91], v[208:211]
ds_read_b128 v[120:123], v28 offset:21504
v_mfma_f32_16x16x32_bf16 v[212:215], a[12:15], v[92:95], v[212:215]
ds_read_b128 v[124:127], v28 offset:30720
v_mfma_f32_16x16x32_bf16 v[220:223], a[76:79], v[76:79], v[220:223]
s_waitcnt lgkmcnt(4)
v_mfma_f32_16x16x32_bf16 v[208:211], a[16:19], v[96:99], v[208:211]
ds_read_b128 v[128:131], v28 offset:4096
buffer_load_dwordx4 v15, s[8:11], s83 offen offset:3072 sc1 lds
v_mfma_f32_16x16x32_bf16 v[212:215], a[16:19], v[100:103], v[212:215]
ds_read_b128 v[132:135], v28 offset:13312
v_mfma_f32_16x16x32_bf16 v[216:219], a[80:83], v[80:83], v[216:219]
buffer_store_dwordx4 v[56:59], v21, s[4:7], s94 offen sc1
v_mfma_f32_16x16x32_bf16 v[208:211], a[20:23], v[104:107], v[208:211]
ds_read_b128 v[136:139], v28 offset:22528
s_add_u32 m0, s73, 8192
v_mfma_f32_16x16x32_bf16 v[212:215], a[20:23], v[108:111], v[212:215]
ds_read_b128 v[140:143], v28 offset:31744
buffer_load_dwordx4 v16, s[8:11], s83 offen offset:0 sc1 lds
v_mfma_f32_16x16x32_bf16 v[220:223], a[80:83], v[84:87], v[220:223]
s_and_b32 s70, s52, 63
s_waitcnt lgkmcnt(4)
v_mfma_f32_16x16x32_bf16 v[208:211], a[24:27], v[112:115], v[208:211]
ds_read_b128 v[144:147], v28 offset:5120
v_mfma_f32_16x16x32_bf16 v[212:215], a[24:27], v[116:119], v[212:215]
ds_read_b128 v[148:151], v28 offset:14336
v_mfma_f32_16x16x32_bf16 v[216:219], a[84:87], v[88:91], v[216:219]
v_readlane_b32 s86, v36, s70
v_mfma_f32_16x16x32_bf16 v[208:211], a[28:31], v[120:123], v[208:211]
ds_read_b128 v[152:155], v28 offset:23552
v_mfma_f32_16x16x32_bf16 v[212:215], a[28:31], v[124:127], v[212:215]
ds_read_b128 v[156:159], v28 offset:32768
v_mfma_f32_16x16x32_bf16 v[220:223], a[84:87], v[92:95], v[220:223]
s_waitcnt lgkmcnt(4)
v_mfma_f32_16x16x32_bf16 v[208:211], a[32:35], v[128:131], v[208:211]
ds_read_b128 v[160:163], v28 offset:6144
v_mfma_f32_16x16x32_bf16 v[212:215], a[32:35], v[132:135], v[212:215]
ds_read_b128 v[164:167], v28 offset:15360
v_mfma_f32_16x16x32_bf16 v[216:219], a[88:91], v[96:99], v[216:219]
v_readlane_b32 s87, v37, s70
v_mfma_f32_16x16x32_bf16 v[208:211], a[36:39], v[136:139], v[208:211]
ds_read_b128 v[168:171], v28 offset:24576
v_mfma_f32_16x16x32_bf16 v[212:215], a[36:39], v[140:143], v[212:215]
ds_read_b128 v[172:175], v28 offset:33792
v_mfma_f32_16x16x32_bf16 v[220:223], a[88:91], v[100:103], v[220:223]
s_waitcnt lgkmcnt(4)
v_mfma_f32_16x16x32_bf16 v[208:211], a[40:43], v[144:147], v[208:211]
ds_read_b128 v[176:179], v28 offset:7168
v_mfma_f32_16x16x32_bf16 v[212:215], a[40:43], v[148:151], v[212:215]
ds_read_b128 v[180:183], v28 offset:16384
v_mfma_f32_16x16x32_bf16 v[216:219], a[92:95], v[104:107], v[216:219]
v_readlane_b32 s88, v38, s70
v_mfma_f32_16x16x32_bf16 v[208:211], a[44:47], v[152:155], v[208:211]
ds_read_b128 v[184:187], v28 offset:25600
v_mfma_f32_16x16x32_bf16 v[212:215], a[44:47], v[156:159], v[212:215]
ds_read_b128 v[188:191], v28 offset:34816
v_mfma_f32_16x16x32_bf16 v[220:223], a[92:95], v[108:111], v[220:223]
s_waitcnt lgkmcnt(4)
v_mfma_f32_16x16x32_bf16 v[208:211], a[48:51], v[160:163], v[208:211]
ds_read_b128 v[192:195], v28 offset:8192
v_mfma_f32_16x16x32_bf16 v[212:215], a[48:51], v[164:167], v[212:215]
ds_read_b128 v[196:199], v28 offset:17408
v_mfma_f32_16x16x32_bf16 v[216:219], a[96:99], v[112:115], v[216:219]
buffer_load_dword v24, v22, s[4:7], 0 offen sc1
v_mfma_f32_16x16x32_bf16 v[208:211], a[52:55], v[168:171], v[208:211]
ds_read_b128 v[200:203], v28 offset:26624
v_mfma_f32_16x16x32_bf16 v[212:215], a[52:55], v[172:175], v[212:215]
ds_read_b128 v[204:207], v28 offset:35840
v_mfma_f32_16x16x32_bf16 v[220:223], a[96:99], v[116:119], v[220:223]
s_waitcnt lgkmcnt(4)
v_mfma_f32_16x16x32_bf16 v[208:211], a[56:59], v[176:179], v[208:211]
v_readlane_b32 s89, v39, s70
v_mfma_f32_16x16x32_bf16 v[212:215], a[56:59], v[180:183], v[212:215]
s_add_u32 s52, s52, 1
v_mov_b32 v27, s91
v_mfma_f32_16x16x32_bf16 v[216:219], a[100:103], v[120:123], v[216:219]
s_lshl_b32 s70, s92, 10
v_mfma_f32_16x16x32_bf16 v[208:211], a[60:63], v[184:187], v[208:211]
v_mfma_f32_16x16x32_bf16 v[212:215], a[60:63], v[188:191], v[212:215]
v_mfma_f32_16x16x32_bf16 v[220:223], a[100:103], v[124:127], v[220:223]
s_waitcnt lgkmcnt(0)
v_mfma_f32_16x16x32_bf16 v[208:211], a[64:67], v[192:195], v[208:211]
v_mfma_f32_16x16x32_bf16 v[212:215], a[64:67], v[196:199], v[212:215]
v_mfma_f32_16x16x32_bf16 v[216:219], a[104:107], v[128:131], v[216:219]
v_mfma_f32_16x16x32_bf16 v[208:211], a[68:71], v[200:203], v[208:211]
v_mfma_f32_16x16x32_bf16 v[212:215], a[68:71], v[204:207], v[212:215]
v_mfma_f32_16x16x32_bf16 v[220:223], a[104:107], v[132:135], v[220:223]
v_mfma_f32_16x16x32_bf16 v[216:219], a[108:111], v[136:139], v[216:219]
v_mfma_f32_16x16x32_bf16 v[220:223], a[108:111], v[140:143], v[220:223]
v_mfma_f32_16x16x32_bf16 v[224:227], v[64:67], a[144:147], 0
v_mfma_f32_16x16x32_bf16 v[216:219], a[112:115], v[144:147], v[216:219]
v_mfma_f32_16x16x32_bf16 v[220:223], a[112:115], v[148:151], v[220:223]
s_nop 0
v_cvt_pk_bf16_f32 v48, v208, v209
v_cvt_pk_bf16_f32 v49, v210, v211
v_mfma_f32_16x16x32_bf16 v[228:231], v[68:71], a[144:147], 0
v_cvt_pk_bf16_f32 v50, v212, v213
v_cvt_pk_bf16_f32 v51, v214, v215
v_mfma_f32_16x16x32_bf16 v[216:219], a[116:119], v[152:155], v[216:219]
v_permlane16_swap_b32 v48, v50
v_mfma_f32_16x16x32_bf16 v[220:223], a[116:119], v[156:159], v[220:223]
v_permlane16_swap_b32 v49, v51
v_mfma_f32_16x16x32_bf16 v[224:227], v[72:75], a[148:151], v[224:227]
buffer_store_dwordx4 v[48:51], v19, s[4:7], s79 offen sc1
v_mfma_f32_16x16x32_bf16 v[216:219], a[120:123], v[160:163], v[216:219]
v_mfma_f32_16x16x32_bf16 v[220:223], a[120:123], v[164:167], v[220:223]
v_mfma_f32_16x16x32_bf16 v[228:231], v[76:79], a[148:151], v[228:231]
v_mfma_f32_16x16x32_bf16 v[216:219], a[124:127], v[168:171], v[216:219]
v_mfma_f32_16x16x32_bf16 v[220:223], a[124:127], v[172:175], v[220:223]
v_mfma_f32_16x16x32_bf16 v[224:227], v[80:83], a[152:155], v[224:227]
v_mfma_f32_16x16x32_bf16 v[216:219], a[128:131], v[176:179], v[216:219]
v_mfma_f32_16x16x32_bf16 v[220:223], a[128:131], v[180:183], v[220:223]
v_mfma_f32_16x16x32_bf16 v[228:231], v[84:87], a[152:155], v[228:231]
v_mfma_f32_16x16x32_bf16 v[216:219], a[132:135], v[184:187], v[216:219]
v_mfma_f32_16x16x32_bf16 v[220:223], a[132:135], v[188:191], v[220:223]
v_mfma_f32_16x16x32_bf16 v[224:227], v[88:91], a[156:159], v[224:227]
v_mfma_f32_16x16x32_bf16 v[216:219], a[136:139], v[192:195], v[216:219]
v_mfma_f32_16x16x32_bf16 v[220:223], a[136:139], v[196:199], v[220:223]
v_mfma_f32_16x16x32_bf16 v[228:231], v[92:95], a[156:159], v[228:231]
v_mfma_f32_16x16x32_bf16 v[216:219], a[140:143], v[200:203], v[216:219]
v_mfma_f32_16x16x32_bf16 v[220:223], a[140:143], v[204:207], v[220:223]
v_mfma_f32_16x16x32_bf16 v[224:227], v[96:99], a[160:163], v[224:227]
v_mfma_f32_16x16x32_bf16 v[228:231], v[100:103], a[160:163], v[228:231]
s_waitcnt vmcnt(1)
ds_write_b32 v18, v24
v_mfma_f32_16x16x32_bf16 v[224:227], v[104:107], a[164:167], v[224:227]
v_mfma_f32_16x16x32_bf16 v[228:231], v[108:111], a[164:167], v[228:231]
v_mfma_f32_16x16x32_bf16 v[224:227], v[112:115], a[168:171], v[224:227]
s_waitcnt lgkmcnt(0)
s_barrier
v_mfma_f32_16x16x32_bf16 v[228:231], v[116:119], a[168:171], v[228:231]
ds_read_b32 v33, v32
v_cvt_pk_bf16_f32 v52, v216, v217
v_mfma_f32_16x16x32_bf16 v[224:227], v[120:123], a[172:175], v[224:227]
buffer_store_dword v27, v45, s[4:7], s70 offen
v_mfma_f32_16x16x32_bf16 v[228:231], v[124:127], a[172:175], v[228:231]
buffer_store_dword v27, v44, s[4:7], s70 offen sc1
v_mfma_f32_16x16x32_bf16 v[224:227], v[128:131], a[176:179], v[224:227]
s_waitcnt lgkmcnt(0)
v_cmp_gt_u32 vcc, s86, v33
v_mfma_f32_16x16x32_bf16 v[228:231], v[132:135], a[176:179], v[228:231]
s_lshr_b64 s[58:59], vcc, s87
s_and_b32 s58, s58, s56
s_cselect_b32 s10, 0, 268435456
s_cselect_b32 s90, 0, 1
v_mfma_f32_16x16x32_bf16 v[224:227], v[136:139], a[180:183], v[224:227]
s_cmp_eq_u32 s85, 0
s_cbranch_scc1 g_slow_75
v_mfma_f32_16x16x32_bf16 v[228:231], v[140:143], a[180:183], v[228:231]
s_add_u32 m0, s74, 0
v_cvt_pk_bf16_f32 v53, v218, v219
v_mfma_f32_16x16x32_bf16 v[224:227], v[144:147], a[184:187], v[224:227]
buffer_load_dwordx4 v8, s[8:11], s88 offen offset:0 sc1 lds
v_mfma_f32_16x16x32_bf16 v[228:231], v[148:151], a[184:187], v[228:231]
v_cvt_pk_bf16_f32 v54, v220, v221
v_cvt_pk_bf16_f32 v55, v222, v223
v_mfma_f32_16x16x32_bf16 v[224:227], v[152:155], a[188:191], v[224:227]
v_permlane16_swap_b32 v52, v54
v_mfma_f32_16x16x32_bf16 v[228:231], v[156:159], a[188:191], v[228:231]
v_permlane16_swap_b32 v53, v55
v_mfma_f32_16x16x32_bf16 v[224:227], v[160:163], a[192:195], v[224:227]
buffer_load_dwordx4 v9, s[8:11], s88 offen offset:1024 sc1 lds
v_mfma_f32_16x16x32_bf16 v[228:231], v[164:167], a[192:195], v[228:231]
buffer_store_dwordx4 v[52:55], v20, s[4:7], s79 offen sc1
v_mfma_f32_16x16x32_bf16 v[224:227], v[168:171], a[196:199], v[224:227]
ds_read_b128 v[64:67], v29 offset:0
v_mfma_f32_16x16x32_bf16 v[228:231], v[172:175], a[196:199], v[228:231]
ds_read_b128 v[68:71], v29 offset:9216
v_mfma_f32_16x16x32_bf16 v[224:227], v[176:179], a[200:203], v[224:227]
buffer_load_dwordx4 v10, s[8:11], s88 offen offset:2048 sc1 lds
ds_read_b128 v[72:75], v29 offset:18432
v_mfma_f32_16x16x32_bf16 v[228:231], v[180:183], a[200:203], v[228:231]
ds_read_b128 v[76:79], v29 offset:27648
v_mfma_f32_16x16x32_bf16 v[224:227], v[184:187], a[204:207], v[224:227]
ds_read_b128 v[80:83], v29 offset:1024
v_mfma_f32_16x16x32_bf16 v[228:231], v[188:191], a[204:207], v[228:231]
ds_read_b128 v[84:87], v29 offset:10240
v_mfma_f32_16x16x32_bf16 v[224:227], v[192:195], a[208:211], v[224:227]
buffer_load_dwordx4 v11, s[8:11], s88 offen offset:3072 sc1 lds
ds_read_b128 v[88:91], v29 offset:19456
v_mfma_f32_16x16x32_bf16 v[228:231], v[196:199], a[208:211], v[228:231]
ds_read_b128 v[92:95], v29 offset:28672
v_mfma_f32_16x16x32_bf16 v[224:227], v[200:203], a[212:215], v[224:227]
v_mfma_f32_16x16x32_bf16 v[228:231], v[204:207], a[212:215], v[228:231]
g_body_60:
s_waitcnt lgkmcnt(4)
v_mfma_f32_16x16x32_bf16 v[208:211], a[0:3], v[64:67], 0
ds_read_b128 v[96:99], v29 offset:2048
s_add_u32 m0, s74, 4096
v_mfma_f32_16x16x32_bf16 v[212:215], a[0:3], v[68:71], 0
ds_read_b128 v[100:103], v29 offset:11264
buffer_load_dwordx4 v12, s[8:11], s88 offen offset:0 sc1 lds
v_mfma_f32_16x16x32_bf16 v[216:219], a[72:75], v[64:67], 0
v_mfma_f32_16x16x32_bf16 v[208:211], a[4:7], v[72:75], v[208:211]
ds_read_b128 v[104:107], v29 offset:20480
v_cvt_pk_bf16_f32 v56, v224, v225
v_mfma_f32_16x16x32_bf16 v[212:215], a[4:7], v[76:79], v[212:215]
ds_read_b128 v[108:111], v29 offset:29696
buffer_load_dwordx4 v13, s[8:11], s88 offen offset:1024 sc1 lds
v_mfma_f32_16x16x32_bf16 v[220:223], a[72:75], v[68:71], 0
v_cvt_pk_bf16_f32 v57, v226, v227
s_waitcnt lgkmcnt(4)
v_mfma_f32_16x16x32_bf16 v[208:211], a[8:11], v[80:83], v[208:211]
ds_read_b128 v[112:115], v29 offset:3072
v_cvt_pk_bf16_f32 v58, v228, v229
v_mfma_f32_16x16x32_bf16 v[212:215], a[8:11], v[84:87], v[212:215]
ds_read_b128 v[116:119], v29 offset:12288
v_cvt_pk_bf16_f32 v59, v230, v231
v_mfma_f32_16x16x32_bf16 v[216:219], a[76:79], v[72:75], v[216:219]
buffer_load_dwordx4 v14, s[8:11], s88 offen offset:2048 sc1 lds
v_mfma_f32_16x16x32_bf16 v[208:211], a[12:15], v[88:91], v[208:211]
ds_read_b128 v[120:123], v29 offset:21504
v_mfma_f32_16x16x32_bf16 v[212:215], a[12:15], v[92:95], v[212:215]
ds_read_b128 v[124:127], v29 offset:30720
v_mfma_f32_16x16x32_bf16 v[220:223], a[76:79], v[76:79], v[220:223]
s_waitcnt lgkmcnt(4)
v_mfma_f32_16x16x32_bf16 v[208:211], a[16:19], v[96:99], v[208:211]
ds_read_b128 v[128:131], v29 offset:4096
buffer_load_dwordx4 v15, s[8:11], s88 offen offset:3072 sc1 lds
v_mfma_f32_16x16x32_bf16 v[212:215], a[16:19], v[100:103], v[212:215]
ds_read_b128 v[132:135], v29 offset:13312
v_mfma_f32_16x16x32_bf16 v[216:219], a[80:83], v[80:83], v[216:219]
buffer_store_dwordx4 v[56:59], v21, s[4:7], s79 offen sc1
v_mfma_f32_16x16x32_bf16 v[208:211], a[20:23], v[104:107], v[208:211]
ds_read_b128 v[136:139], v29 offset:22528
s_add_u32 m0, s74, 8192
v_mfma_f32_16x16x32_bf16 v[212:215], a[20:23], v[108:111], v[212:215]
ds_read_b128 v[140:143], v29 offset:31744
buffer_load_dwordx4 v16, s[8:11], s88 offen offset:0 sc1 lds
v_mfma_f32_16x16x32_bf16 v[220:223], a[80:83], v[84:87], v[220:223]
s_and_b32 s70, s52, 63
s_waitcnt lgkmcnt(4)
v_mfma_f32_16x16x32_bf16 v[208:211], a[24:27], v[112:115], v[208:211]
ds_read_b128 v[144:147], v29 offset:5120
v_mfma_f32_16x16x32_bf16 v[212:215], a[24:27], v[116:119], v[212:215]
ds_read_b128 v[148:151], v29 offset:14336
v_mfma_f32_16x16x32_bf16 v[216:219], a[84:87], v[88:91], v[216:219]
v_readlane_b32 s91, v36, s70
v_mfma_f32_16x16x32_bf16 v[208:211], a[28:31], v[120:123], v[208:211]
ds_read_b128 v[152:155], v29 offset:23552
v_mfma_f32_16x16x32_bf16 v[212:215], a[28:31], v[124:127], v[212:215]
ds_read_b128 v[156:159], v29 offset:32768
v_mfma_f32_16x16x32_bf16 v[220:223], a[84:87], v[92:95], v[220:223]
s_waitcnt lgkmcnt(4)
v_mfma_f32_16x16x32_bf16 v[208:211], a[32:35], v[128:131], v[208:211]
ds_read_b128 v[160:163], v29 offset:6144
v_mfma_f32_16x16x32_bf16 v[212:215], a[32:35], v[132:135], v[212:215]
ds_read_b128 v[164:167], v29 offset:15360
v_mfma_f32_16x16x32_bf16 v[216:219], a[88:91], v[96:99], v[216:219]
v_readlane_b32 s92, v37, s70
v_mfma_f32_16x16x32_bf16 v[208:211], a[36:39], v[136:139], v[208:211]
ds_read_b128 v[168:171], v29 offset:24576
v_mfma_f32_16x16x32_bf16 v[212:215], a[36:39], v[140:143], v[212:215]
ds_read_b128 v[172:175], v29 offset:33792
v_mfma_f32_16x16x32_bf16 v[220:223], a[88:91], v[100:103], v[220:223]
s_waitcnt lgkmcnt(4)
v_mfma_f32_16x16x32_bf16 v[208:211], a[40:43], v[144:147], v[208:211]
ds_read_b128 v[176:179], v29 offset:7168
v_mfma_f32_16x16x32_bf16 v[212:215], a[40:43], v[148:151], v[212:215]
ds_read_b128 v[180:183], v29 offset:16384
v_mfma_f32_16x16x32_bf16 v[216:219], a[92:95], v[104:107], v[216:219]
v_readlane_b32 s93, v38, s70
v_mfma_f32_16x16x32_bf16 v[208:211], a[44:47], v[152:155], v[208:211]
ds_read_b128 v[184:187], v29 offset:25600
v_mfma_f32_16x16x32_bf16 v[212:215], a[44:47], v[156:159], v[212:215]
ds_read_b128 v[188:191], v29 offset:34816
v_mfma_f32_16x16x32_bf16 v[220:223], a[92:95], v[108:111], v[220:223]
s_waitcnt lgkmcnt(4)
v_mfma_f32_16x16x32_bf16 v[208:211], a[48:51], v[160:163], v[208:211]
ds_read_b128 v[192:195], v29 offset:8192
v_mfma_f32_16x16x32_bf16 v[212:215], a[48:51], v[164:167], v[212:215]
ds_read_b128 v[196:199], v29 offset:17408
v_mfma_f32_16x16x32_bf16 v[216:219], a[96:99], v[112:115], v[216:219]
buffer_load_dword v24, v22, s[4:7], 0 offen sc1
v_mfma_f32_16x16x32_bf16 v[208:211], a[52:55], v[168:171], v[208:211]
ds_read_b128 v[200:203], v29 offset:26624
v_mfma_f32_16x16x32_bf16 v[212:215], a[52:55], v[172:175], v[212:215]
ds_read_b128 v[204:207], v29 offset:35840
v_mfma_f32_16x16x32_bf16 v[220:223], a[96:99], v[116:119], v[220:223]
s_waitcnt lgkmcnt(4)
v_mfma_f32_16x16x32_bf16 v[208:211], a[56:59], v[176:179], v[208:211]
v_readlane_b32 s94, v39, s70
v_mfma_f32_16x16x32_bf16 v[212:215], a[56:59], v[180:183], v[212:215]
s_add_u32 s52, s52, 1
v_mov_b32 v27, s76
v_mfma_f32_16x16x32_bf16 v[216:219], a[100:103], v[120:123], v[216:219]
s_lshl_b32 s70, s77, 10
v_mfma_f32_16x16x32_bf16 v[208:211], a[60:63], v[184:187], v[208:211]
v_mfma_f32_16x16x32_bf16 v[212:215], a[60:63], v[188:191], v[212:215]
v_mfma_f32_16x16x32_bf16 v[220:223], a[100:103], v[124:127], v[220:223]
s_waitcnt lgkmcnt(0)
v_mfma_f32_16x16x32_bf16 v[208:211], a[64:67], v[192:195], v[208:211]
v_mfma_f32_16x16x32_bf16 v[212:215], a[64:67], v[196:199], v[212:215]
v_mfma_f32_16x16x32_bf16 v[216:219], a[104:107], v[128:131], v[216:219]
v_mfma_f32_16x16x32_bf16 v[208:211], a[68:71], v[200:203], v[208:211]
v_mfma_f32_16x16x32_bf16 v[212:215], a[68:71], v[204:207], v[212:215]
v_mfma_f32_16x16x32_bf16 v[220:223], a[104:107], v[132:135], v[220:223]
v_mfma_f32_16x16x32_bf16 v[216:219], a[108:111], v[136:139], v[216:219]
v_mfma_f32_16x16x32_bf16 v[220:223], a[108:111], v[140:143], v[220:223]
v_mfma_f32_16x16x32_bf16 v[224:227], v[64:67], a[144:147], 0
v_mfma_f32_16x16x32_bf16 v[216:219], a[112:115], v[144:147], v[216:219]
v_mfma_f32_16x16x32_bf16 v[220:223], a[112:115], v[148:151], v[220:223]
s_nop 0
v_cvt_pk_bf16_f32 v48, v208, v209
v_cvt_pk_bf16_f32 v49, v210, v211
v_mfma_f32_16x16x32_bf16 v[228:231], v[68:71], a[144:147], 0
v_cvt_pk_bf16_f32 v50, v212, v213
v_cvt_pk_bf16_f32 v51, v214, v215
v_mfma_f32_16x16x32_bf16 v[216:219], a[116:119], v[152:155], v[216:219]
v_permlane16_swap_b32 v48, v50
v_mfma_f32_16x16x32_bf16 v[220:223], a[116:119], v[156:159], v[220:223]
v_permlane16_swap_b32 v49, v51
v_mfma_f32_16x16x32_bf16 v[224:227], v[72:75], a[148:151], v[224:227]
buffer_store_dwordx4 v[48:51], v19, s[4:7], s84 offen sc1
v_mfma_f32_16x16x32_bf16 v[216:219], a[120:123], v[160:163], v[216:219]
v_mfma_f32_16x16x32_bf16 v[220:223], a[120:123], v[164:167], v[220:223]
v_mfma_f32_16x16x32_bf16 v[228:231], v[76:79], a[148:151], v[228:231]
v_mfma_f32_16x16x32_bf16 v[216:219], a[124:127], v[168:171], v[216:219]
v_mfma_f32_16x16x32_bf16 v[220:223], a[124:127], v[172:175], v[220:223]
v_mfma_f32_16x16x32_bf16 v[224:227], v[80:83], a[152:155], v[224:227]
v_mfma_f32_16x16x32_bf16 v[216:219], a[128:131], v[176:179], v[216:219]
v_mfma_f32_16x16x32_bf16 v[220:223], a[128:131], v[180:183], v[220:223]
v_mfma_f32_16x16x32_bf16 v[228:231], v[84:87], a[152:155], v[228:231]
v_mfma_f32_16x16x32_bf16 v[216:219], a[132:135], v[184:187], v[216:219]
v_mfma_f32_16x16x32_bf16 v[220:223], a[132:135], v[188:191], v[220:223]
v_mfma_f32_16x16x32_bf16 v[224:227], v[88:91], a[156:159], v[224:227]
v_mfma_f32_16x16x32_bf16 v[216:219], a[136:139], v[192:195], v[216:219]
v_mfma_f32_16x16x32_bf16 v[220:223], a[136:139], v[196:199], v[220:223]
v_mfma_f32_16x16x32_bf16 v[228:231], v[92:95], a[156:159], v[228:231]
v_mfma_f32_16x16x32_bf16 v[216:219], a[140:143], v[200:203], v[216:219]
v_mfma_f32_16x16x32_bf16 v[220:223], a[140:143], v[204:207], v[220:223]
v_mfma_f32_16x16x32_bf16 v[224:227], v[96:99], a[160:163], v[224:227]
v_mfma_f32_16x16x32_bf16 v[228:231], v[100:103], a[160:163], v[228:231]
s_waitcnt vmcnt(1)
ds_write_b32 v18, v24
v_mfma_f32_16x16x32_bf16 v[224:227], v[104:107], a[164:167], v[224:227]
v_mfma_f32_16x16x32_bf16 v[228:231], v[108:111], a[164:167], v[228:231]
v_mfma_f32_16x16x32_bf16 v[224:227], v[112:115], a[168:171], v[224:227]
s_waitcnt lgkmcnt(0)
s_barrier
v_mfma_f32_16x16x32_bf16 v[228:231], v[116:119], a[168:171], v[228:231]
ds_read_b32 v33, v32
v_cvt_pk_bf16_f32 v52, v216, v217
v_mfma_f32_16x16x32_bf16 v[224:227], v[120:123], a[172:175], v[224:227]
buffer_store_dword v27, v45, s[4:7], s70 offen
v_mfma_f32_16x16x32_bf16 v[228:231], v[124:127], a[172:175], v[228:231]
buffer_store_dword v27, v44, s[4:7], s70 offen sc1
v_mfma_f32_16x16x32_bf16 v[224:227], v[128:131], a[176:179], v[224:227]
s_waitcnt lgkmcnt(0)
v_cmp_gt_u32 vcc, s91, v33
v_mfma_f32_16x16x32_bf16 v[228:231], v[132:135], a[176:179], v[228:231]
s_lshr_b64 s[58:59], vcc, s92
s_and_b32 s58, s58, s56
s_cselect_b32 s10, 0, 268435456
s_cselect_b32 s95, 0, 1
v_mfma_f32_16x16x32_bf16 v[224:227], v[136:139], a[180:183], v[224:227]
s_cmp_eq_u32 s90, 0
s_cbranch_scc1 g_slow_76
v_mfma_f32_16x16x32_bf16 v[228:231], v[140:143], a[180:183], v[228:231]
s_add_u32 m0, s75, 0
v_cvt_pk_bf16_f32 v53, v218, v219
v_mfma_f32_16x16x32_bf16 v[224:227], v[144:147], a[184:187], v[224:227]
buffer_load_dwordx4 v8, s[8:11], s93 offen offset:0 sc1 lds
v_mfma_f32_16x16x32_bf16 v[228:231], v[148:151], a[184:187], v[228:231]
v_cvt_pk_bf16_f32 v54, v220, v221
v_cvt_pk_bf16_f32 v55, v222, v223
v_mfma_f32_16x16x32_bf16 v[224:227], v[152:155], a[188:191], v[224:227]
v_permlane16_swap_b32 v52, v54
v_mfma_f32_16x16x32_bf16 v[228:231], v[156:159], a[188:191], v[228:231]
v_permlane16_swap_b32 v53, v55
v_mfma_f32_16x16x32_bf16 v[224:227], v[160:163], a[192:195], v[224:227]
buffer_load_dwordx4 v9, s[8:11], s93 offen offset:1024 sc1 lds
v_mfma_f32_16x16x32_bf16 v[228:231], v[164:167], a[192:195], v[228:231]
buffer_store_dwordx4 v[52:55], v20, s[4:7], s84 offen sc1
v_mfma_f32_16x16x32_bf16 v[224:227], v[168:171], a[196:199], v[224:227]
ds_read_b128 v[64:67], v30 offset:0
v_mfma_f32_16x16x32_bf16 v[228:231], v[172:175], a[196:199], v[228:231]
ds_read_b128 v[68:71], v30 offset:9216
v_mfma_f32_16x16x32_bf16 v[224:227], v[176:179], a[200:203], v[224:227]
buffer_load_dwordx4 v10, s[8:11], s93 offen offset:2048 sc1 lds
ds_read_b128 v[72:75], v30 offset:18432
v_mfma_f32_16x16x32_bf16 v[228:231], v[180:183], a[200:203], v[228:231]
ds_read_b128 v[76:79], v30 offset:27648
v_mfma_f32_16x16x32_bf16 v[224:227], v[184:187], a[204:207], v[224:227]
ds_read_b128 v[80:83], v30 offset:1024
v_mfma_f32_16x16x32_bf16 v[228:231], v[188:191], a[204:207], v[228:231]
ds_read_b128 v[84:87], v30 offset:10240
v_mfma_f32_16x16x32_bf16 v[224:227], v[192:195], a[208:211], v[224:227]
buffer_load_dwordx4 v11, s[8:11], s93 offen offset:3072 sc1 lds
ds_read_b128 v[88:91], v30 offset:19456
v_mfma_f32_16x16x32_bf16 v[228:231], v[196:199], a[208:211], v[228:231]
ds_read_b128 v[92:95], v30 offset:28672
v_mfma_f32_16x16x32_bf16 v[224:227], v[200:203], a[212:215], v[224:227]
v_mfma_f32_16x16x32_bf16 v[228:231], v[204:207], a[212:215], v[228:231]
g_body_61:
s_waitcnt lgkmcnt(4)
v_mfma_f32_16x16x32_bf16 v[208:211], a[0:3], v[64:67], 0
ds_read_b128 v[96:99], v30 offset:2048
s_add_u32 m0, s75, 4096
v_mfma_f32_16x16x32_bf16 v[212:215], a[0:3], v[68:71], 0
ds_read_b128 v[100:103], v30 offset:11264
buffer_load_dwordx4 v12, s[8:11], s93 offen offset:0 sc1 lds
v_mfma_f32_16x16x32_bf16 v[216:219], a[72:75], v[64:67], 0
v_mfma_f32_16x16x32_bf16 v[208:211], a[4:7], v[72:75], v[208:211]
ds_read_b128 v[104:107], v30 offset:20480
v_cvt_pk_bf16_f32 v56, v224, v225
v_mfma_f32_16x16x32_bf16 v[212:215], a[4:7], v[76:79], v[212:215]
ds_read_b128 v[108:111], v30 offset:29696
buffer_load_dwordx4 v13, s[8:11], s93 offen offset:1024 sc1 lds
v_mfma_f32_16x16x32_bf16 v[220:223], a[72:75], v[68:71], 0
v_cvt_pk_bf16_f32 v57, v226, v227
s_waitcnt lgkmcnt(4)
v_mfma_f32_16x16x32_bf16 v[208:211], a[8:11], v[80:83], v[208:211]
ds_read_b128 v[112:115], v30 offset:3072
v_cvt_pk_bf16_f32 v58, v228, v229
v_mfma_f32_16x16x32_bf16 v[212:215], a[8:11], v[84:87], v[212:215]
ds_read_b128 v[116:119], v30 offset:12288
v_cvt_pk_bf16_f32 v59, v230, v231
v_mfma_f32_16x16x32_bf16 v[216:219], a[76:79], v[72:75], v[216:219]
buffer_load_dwordx4 v14, s[8:11], s93 offen offset:2048 sc1 lds
v_mfma_f32_16x16x32_bf16 v[208:211], a[12:15], v[88:91], v[208:211]
ds_read_b128 v[120:123], v30 offset:21504
v_mfma_f32_16x16x32_bf16 v[212:215], a[12:15], v[92:95], v[212:215]
ds_read_b128 v[124:127], v30 offset:30720
v_mfma_f32_16x16x32_bf16 v[220:223], a[76:79], v[76:79], v[220:223]
s_waitcnt lgkmcnt(4)
v_mfma_f32_16x16x32_bf16 v[208:211], a[16:19], v[96:99], v[208:211]
ds_read_b128 v[128:131], v30 offset:4096
buffer_load_dwordx4 v15, s[8:11], s93 offen offset:3072 sc1 lds
v_mfma_f32_16x16x32_bf16 v[212:215], a[16:19], v[100:103], v[212:215]
ds_read_b128 v[132:135], v30 offset:13312
v_mfma_f32_16x16x32_bf16 v[216:219], a[80:83], v[80:83], v[216:219]
buffer_store_dwordx4 v[56:59], v21, s[4:7], s84 offen sc1
v_mfma_f32_16x16x32_bf16 v[208:211], a[20:23], v[104:107], v[208:211]
ds_read_b128 v[136:139], v30 offset:22528
s_add_u32 m0, s75, 8192
v_mfma_f32_16x16x32_bf16 v[212:215], a[20:23], v[108:111], v[212:215]
ds_read_b128 v[140:143], v30 offset:31744
buffer_load_dwordx4 v16, s[8:11], s93 offen offset:0 sc1 lds
v_mfma_f32_16x16x32_bf16 v[220:223], a[80:83], v[84:87], v[220:223]
s_and_b32 s70, s52, 63
s_waitcnt lgkmcnt(4)
v_mfma_f32_16x16x32_bf16 v[208:211], a[24:27], v[112:115], v[208:211]
ds_read_b128 v[144:147], v30 offset:5120
v_mfma_f32_16x16x32_bf16 v[212:215], a[24:27], v[116:119], v[212:215]
ds_read_b128 v[148:151], v30 offset:14336
v_mfma_f32_16x16x32_bf16 v[216:219], a[84:87], v[88:91], v[216:219]
v_readlane_b32 s76, v36, s70
v_mfma_f32_16x16x32_bf16 v[208:211], a[28:31], v[120:123], v[208:211]
ds_read_b128 v[152:155], v30 offset:23552
v_mfma_f32_16x16x32_bf16 v[212:215], a[28:31], v[124:127], v[212:215]
ds_read_b128 v[156:159], v30 offset:32768
v_mfma_f32_16x16x32_bf16 v[220:223], a[84:87], v[92:95], v[220:223]
s_waitcnt lgkmcnt(4)
v_mfma_f32_16x16x32_bf16 v[208:211], a[32:35], v[128:131], v[208:211]
ds_read_b128 v[160:163], v30 offset:6144
v_mfma_f32_16x16x32_bf16 v[212:215], a[32:35], v[132:135], v[212:215]
ds_read_b128 v[164:167], v30 offset:15360
v_mfma_f32_16x16x32_bf16 v[216:219], a[88:91], v[96:99], v[216:219]
v_readlane_b32 s77, v37, s70
v_mfma_f32_16x16x32_bf16 v[208:211], a[36:39], v[136:139], v[208:211]
ds_read_b128 v[168:171], v30 offset:24576
v_mfma_f32_16x16x32_bf16 v[212:215], a[36:39], v[140:143], v[212:215]
ds_read_b128 v[172:175], v30 offset:33792
v_mfma_f32_16x16x32_bf16 v[220:223], a[88:91], v[100:103], v[220:223]
s_waitcnt lgkmcnt(4)
v_mfma_f32_16x16x32_bf16 v[208:211], a[40:43], v[144:147], v[208:211]
ds_read_b128 v[176:179], v30 offset:7168
v_mfma_f32_16x16x32_bf16 v[212:215], a[40:43], v[148:151], v[212:215]
ds_read_b128 v[180:183], v30 offset:16384
v_mfma_f32_16x16x32_bf16 v[216:219], a[92:95], v[104:107], v[216:219]
v_readlane_b32 s78, v38, s70
v_mfma_f32_16x16x32_bf16 v[208:211], a[44:47], v[152:155], v[208:211]
ds_read_b128 v[184:187], v30 offset:25600
v_mfma_f32_16x16x32_bf16 v[212:215], a[44:47], v[156:159], v[212:215]
ds_read_b128 v[188:191], v30 offset:34816
v_mfma_f32_16x16x32_bf16 v[220:223], a[92:95], v[108:111], v[220:223]
s_waitcnt lgkmcnt(4)
v_mfma_f32_16x16x32_bf16 v[208:211], a[48:51], v[160:163], v[208:211]
ds_read_b128 v[192:195], v30 offset:8192
v_mfma_f32_16x16x32_bf16 v[212:215], a[48:51], v[164:167], v[212:215]
ds_read_b128 v[196:199], v30 offset:17408
v_mfma_f32_16x16x32_bf16 v[216:219], a[96:99], v[112:115], v[216:219]
buffer_load_dword v24, v22, s[4:7], 0 offen sc1
v_mfma_f32_16x16x32_bf16 v[208:211], a[52:55], v[168:171], v[208:211]
ds_read_b128 v[200:203], v30 offset:26624
v_mfma_f32_16x16x32_bf16 v[212:215], a[52:55], v[172:175], v[212:215]
ds_read_b128 v[204:207], v30 offset:35840
v_mfma_f32_16x16x32_bf16 v[220:223], a[96:99], v[116:119], v[220:223]
s_waitcnt lgkmcnt(4)
v_mfma_f32_16x16x32_bf16 v[208:211], a[56:59], v[176:179], v[208:211]
v_readlane_b32 s79, v39, s70
v_mfma_f32_16x16x32_bf16 v[212:215], a[56:59], v[180:183], v[212:215]
s_add_u32 s52, s52, 1
v_mov_b32 v27, s81
v_mfma_f32_16x16x32_bf16 v[216:219], a[100:103], v[120:123], v[216:219]
s_lshl_b32 s70, s82, 10
v_mfma_f32_16x16x32_bf16 v[208:211], a[60:63], v[184:187], v[208:211]
v_mfma_f32_16x16x32_bf16 v[212:215], a[60:63], v[188:191], v[212:215]
v_mfma_f32_16x16x32_bf16 v[220:223], a[100:103], v[124:127], v[220:223]
s_waitcnt lgkmcnt(0)
v_mfma_f32_16x16x32_bf16 v[208:211], a[64:67], v[192:195], v[208:211]
v_mfma_f32_16x16x32_bf16 v[212:215], a[64:67], v[196:199], v[212:215]
v_mfma_f32_16x16x32_bf16 v[216:219], a[104:107], v[128:131], v[216:219]
v_mfma_f32_16x16x32_bf16 v[208:211], a[68:71], v[200:203], v[208:211]
v_mfma_f32_16x16x32_bf16 v[212:215], a[68:71], v[204:207], v[212:215]
v_mfma_f32_16x16x32_bf16 v[220:223], a[104:107], v[132:135], v[220:223]
v_mfma_f32_16x16x32_bf16 v[216:219], a[108:111], v[136:139], v[216:219]
v_mfma_f32_16x16x32_bf16 v[220:223], a[108:111], v[140:143], v[220:223]
v_mfma_f32_16x16x32_bf16 v[224:227], v[64:67], a[144:147], 0
v_mfma_f32_16x16x32_bf16 v[216:219], a[112:115], v[144:147], v[216:219]
v_mfma_f32_16x16x32_bf16 v[220:223], a[112:115], v[148:151], v[220:223]
s_nop 0
v_cvt_pk_bf16_f32 v48, v208, v209
v_cvt_pk_bf16_f32 v49, v210, v211
v_mfma_f32_16x16x32_bf16 v[228:231], v[68:71], a[144:147], 0
v_cvt_pk_bf16_f32 v50, v212, v213
v_cvt_pk_bf16_f32 v51, v214, v215
v_mfma_f32_16x16x32_bf16 v[216:219], a[116:119], v[152:155], v[216:219]
v_permlane16_swap_b32 v48, v50
v_mfma_f32_16x16x32_bf16 v[220:223], a[116:119], v[156:159], v[220:223]
v_permlane16_swap_b32 v49, v51
v_mfma_f32_16x16x32_bf16 v[224:227], v[72:75], a[148:151], v[224:227]
buffer_store_dwordx4 v[48:51], v19, s[4:7], s89 offen sc1
v_mfma_f32_16x16x32_bf16 v[216:219], a[120:123], v[160:163], v[216:219]
v_mfma_f32_16x16x32_bf16 v[220:223], a[120:123], v[164:167], v[220:223]
v_mfma_f32_16x16x32_bf16 v[228:231], v[76:79], a[148:151], v[228:231]
v_mfma_f32_16x16x32_bf16 v[216:219], a[124:127], v[168:171], v[216:219]
v_mfma_f32_16x16x32_bf16 v[220:223], a[124:127], v[172:175], v[220:223]
v_mfma_f32_16x16x32_bf16 v[224:227], v[80:83], a[152:155], v[224:227]
v_mfma_f32_16x16x32_bf16 v[216:219], a[128:131], v[176:179], v[216:219]
v_mfma_f32_16x16x32_bf16 v[220:223], a[128:131], v[180:183], v[220:223]
v_mfma_f32_16x16x32_bf16 v[228:231], v[84:87], a[152:155], v[228:231]
v_mfma_f32_16x16x32_bf16 v[216:219], a[132:135], v[184:187], v[216:219]
v_mfma_f32_16x16x32_bf16 v[220:223], a[132:135], v[188:191], v[220:223]
v_mfma_f32_16x16x32_bf16 v[224:227], v[88:91], a[156:159], v[224:227]
v_mfma_f32_16x16x32_bf16 v[216:219], a[136:139], v[192:195], v[216:219]
v_mfma_f32_16x16x32_bf16 v[220:223], a[136:139], v[196:199], v[220:223]
v_mfma_f32_16x16x32_bf16 v[228:231], v[92:95], a[156:159], v[228:231]
v_mfma_f32_16x16x32_bf16 v[216:219], a[140:143], v[200:203], v[216:219]
v_mfma_f32_16x16x32_bf16 v[220:223], a[140:143], v[204:207], v[220:223]
v_mfma_f32_16x16x32_bf16 v[224:227], v[96:99], a[160:163], v[224:227]
v_mfma_f32_16x16x32_bf16 v[228:231], v[100:103], a[160:163], v[228:231]
s_waitcnt vmcnt(1)
ds_write_b32 v18, v24
v_mfma_f32_16x16x32_bf16 v[224:227], v[104:107], a[164:167], v[224:227]
v_mfma_f32_16x16x32_bf16 v[228:231], v[108:111], a[164:167], v[228:231]
v_mfma_f32_16x16x32_bf16 v[224:227], v[112:115], a[168:171], v[224:227]
s_waitcnt lgkmcnt(0)
s_barrier
v_mfma_f32_16x16x32_bf16 v[228:231], v[116:119], a[168:171], v[228:231]
ds_read_b32 v33, v32
v_cvt_pk_bf16_f32 v52, v216, v217
v_mfma_f32_16x16x32_bf16 v[224:227], v[120:123], a[172:175], v[224:227]
buffer_store_dword v27, v45, s[4:7], s70 offen
v_mfma_f32_16x16x32_bf16 v[228:231], v[124:127], a[172:175], v[228:231]
buffer_store_dword v27, v44, s[4:7], s70 offen sc1
v_mfma_f32_16x16x32_bf16 v[224:227], v[128:131], a[176:179], v[224:227]
s_waitcnt lgkmcnt(0)
v_cmp_gt_u32 vcc, s76, v33
v_mfma_f32_16x16x32_bf16 v[228:231], v[132:135], a[176:179], v[228:231]
s_lshr_b64 s[58:59], vcc, s77
s_and_b32 s58, s58, s56
s_cselect_b32 s10, 0, 268435456
s_cselect_b32 s80, 0, 1
v_mfma_f32_16x16x32_bf16 v[224:227], v[136:139], a[180:183], v[224:227]
s_cmp_eq_u32 s95, 0
s_cbranch_scc1 g_slow_77
v_mfma_f32_16x16x32_bf16 v[228:231], v[140:143], a[180:183], v[228:231]
s_add_u32 m0, s72, 0
v_cvt_pk_bf16_f32 v53, v218, v219
v_mfma_f32_16x16x32_bf16 v[224:227], v[144:147], a[184:187], v[224:227]
buffer_load_dwordx4 v8, s[8:11], s78 offen offset:0 sc1 lds
v_mfma_f32_16x16x32_bf16 v[228:231], v[148:151], a[184:187], v[228:231]
v_cvt_pk_bf16_f32 v54, v220, v221
v_cvt_pk_bf16_f32 v55, v222, v223
v_mfma_f32_16x16x32_bf16 v[224:227], v[152:155], a[188:191], v[224:227]
v_permlane16_swap_b32 v52, v54
v_mfma_f32_16x16x32_bf16 v[228:231], v[156:159], a[188:191], v[228:231]
v_permlane16_swap_b32 v53, v55
v_mfma_f32_16x16x32_bf16 v[224:227], v[160:163], a[192:195], v[224:227]
buffer_load_dwordx4 v9, s[8:11], s78 offen offset:1024 sc1 lds
v_mfma_f32_16x16x32_bf16 v[228:231], v[164:167], a[192:195], v[228:231]
buffer_store_dwordx4 v[52:55], v20, s[4:7], s89 offen sc1
v_mfma_f32_16x16x32_bf16 v[224:227], v[168:171], a[196:199], v[224:227]
ds_read_b128 v[64:67], v31 offset:0
v_mfma_f32_16x16x32_bf16 v[228:231], v[172:175], a[196:199], v[228:231]
ds_read_b128 v[68:71], v31 offset:9216
v_mfma_f32_16x16x32_bf16 v[224:227], v[176:179], a[200:203], v[224:227]
buffer_load_dwordx4 v10, s[8:11], s78 offen offset:2048 sc1 lds
ds_read_b128 v[72:75], v31 offset:18432
v_mfma_f32_16x16x32_bf16 v[228:231], v[180:183], a[200:203], v[228:231]
ds_read_b128 v[76:79], v31 offset:27648
v_mfma_f32_16x16x32_bf16 v[224:227], v[184:187], a[204:207], v[224:227]
ds_read_b128 v[80:83], v31 offset:1024
v_mfma_f32_16x16x32_bf16 v[228:231], v[188:191], a[204:207], v[228:231]
ds_read_b128 v[84:87], v31 offset:10240
v_mfma_f32_16x16x32_bf16 v[224:227], v[192:195], a[208:211], v[224:227]
buffer_load_dwordx4 v11, s[8:11], s78 offen offset:3072 sc1 lds
ds_read_b128 v[88:91], v31 offset:19456
v_mfma_f32_16x16x32_bf16 v[228:231], v[196:199], a[208:211], v[228:231]
ds_read_b128 v[92:95], v31 offset:28672
v_mfma_f32_16x16x32_bf16 v[224:227], v[200:203], a[212:215], v[224:227]
v_mfma_f32_16x16x32_bf16 v[228:231], v[204:207], a[212:215], v[228:231]
g_body_62:
s_waitcnt lgkmcnt(4)
v_mfma_f32_16x16x32_bf16 v[208:211], a[0:3], v[64:67], 0
ds_read_b128 v[96:99], v31 offset:2048
s_add_u32 m0, s72, 4096
v_mfma_f32_16x16x32_bf16 v[212:215], a[0:3], v[68:71], 0
ds_read_b128 v[100:103], v31 offset:11264
buffer_load_dwordx4 v12, s[8:11], s78 offen offset:0 sc1 lds
v_mfma_f32_16x16x32_bf16 v[216:219], a[72:75], v[64:67], 0
v_mfma_f32_16x16x32_bf16 v[208:211], a[4:7], v[72:75], v[208:211]
ds_read_b128 v[104:107], v31 offset:20480
v_cvt_pk_bf16_f32 v56, v224, v225
v_mfma_f32_16x16x32_bf16 v[212:215], a[4:7], v[76:79], v[212:215]
ds_read_b128 v[108:111], v31 offset:29696
buffer_load_dwordx4 v13, s[8:11], s78 offen offset:1024 sc1 lds
v_mfma_f32_16x16x32_bf16 v[220:223], a[72:75], v[68:71], 0
v_cvt_pk_bf16_f32 v57, v226, v227
s_waitcnt lgkmcnt(4)
v_mfma_f32_16x16x32_bf16 v[208:211], a[8:11], v[80:83], v[208:211]
ds_read_b128 v[112:115], v31 offset:3072
v_cvt_pk_bf16_f32 v58, v228, v229
v_mfma_f32_16x16x32_bf16 v[212:215], a[8:11], v[84:87], v[212:215]
ds_read_b128 v[116:119], v31 offset:12288
v_cvt_pk_bf16_f32 v59, v230, v231
v_mfma_f32_16x16x32_bf16 v[216:219], a[76:79], v[72:75], v[216:219]
buffer_load_dwordx4 v14, s[8:11], s78 offen offset:2048 sc1 lds
v_mfma_f32_16x16x32_bf16 v[208:211], a[12:15], v[88:91], v[208:211]
ds_read_b128 v[120:123], v31 offset:21504
v_mfma_f32_16x16x32_bf16 v[212:215], a[12:15], v[92:95], v[212:215]
ds_read_b128 v[124:127], v31 offset:30720
v_mfma_f32_16x16x32_bf16 v[220:223], a[76:79], v[76:79], v[220:223]
s_waitcnt lgkmcnt(4)
v_mfma_f32_16x16x32_bf16 v[208:211], a[16:19], v[96:99], v[208:211]
ds_read_b128 v[128:131], v31 offset:4096
buffer_load_dwordx4 v15, s[8:11], s78 offen offset:3072 sc1 lds
v_mfma_f32_16x16x32_bf16 v[212:215], a[16:19], v[100:103], v[212:215]
ds_read_b128 v[132:135], v31 offset:13312
v_mfma_f32_16x16x32_bf16 v[216:219], a[80:83], v[80:83], v[216:219]
buffer_store_dwordx4 v[56:59], v21, s[4:7], s89 offen sc1
v_mfma_f32_16x16x32_bf16 v[208:211], a[20:23], v[104:107], v[208:211]
ds_read_b128 v[136:139], v31 offset:22528
s_add_u32 m0, s72, 8192
v_mfma_f32_16x16x32_bf16 v[212:215], a[20:23], v[108:111], v[212:215]
ds_read_b128 v[140:143], v31 offset:31744
buffer_load_dwordx4 v16, s[8:11], s78 offen offset:0 sc1 lds
v_mfma_f32_16x16x32_bf16 v[220:223], a[80:83], v[84:87], v[220:223]
s_and_b32 s70, s52, 63
s_waitcnt lgkmcnt(4)
v_mfma_f32_16x16x32_bf16 v[208:211], a[24:27], v[112:115], v[208:211]
ds_read_b128 v[144:147], v31 offset:5120
v_mfma_f32_16x16x32_bf16 v[212:215], a[24:27], v[116:119], v[212:215]
ds_read_b128 v[148:151], v31 offset:14336
v_mfma_f32_16x16x32_bf16 v[216:219], a[84:87], v[88:91], v[216:219]
v_readlane_b32 s81, v36, s70
v_mfma_f32_16x16x32_bf16 v[208:211], a[28:31], v[120:123], v[208:211]
ds_read_b128 v[152:155], v31 offset:23552
v_mfma_f32_16x16x32_bf16 v[212:215], a[28:31], v[124:127], v[212:215]
ds_read_b128 v[156:159], v31 offset:32768
v_mfma_f32_16x16x32_bf16 v[220:223], a[84:87], v[92:95], v[220:223]
s_waitcnt lgkmcnt(4)
v_mfma_f32_16x16x32_bf16 v[208:211], a[32:35], v[128:131], v[208:211]
ds_read_b128 v[160:163], v31 offset:6144
v_mfma_f32_16x16x32_bf16 v[212:215], a[32:35], v[132:135], v[212:215]
ds_read_b128 v[164:167], v31 offset:15360
v_mfma_f32_16x16x32_bf16 v[216:219], a[88:91], v[96:99], v[216:219]
v_readlane_b32 s82, v37, s70
v_mfma_f32_16x16x32_bf16 v[208:211], a[36:39], v[136:139], v[208:211]
ds_read_b128 v[168:171], v31 offset:24576
v_mfma_f32_16x16x32_bf16 v[212:215], a[36:39], v[140:143], v[212:215]
ds_read_b128 v[172:175], v31 offset:33792
v_mfma_f32_16x16x32_bf16 v[220:223], a[88:91], v[100:103], v[220:223]
s_waitcnt lgkmcnt(4)
v_mfma_f32_16x16x32_bf16 v[208:211], a[40:43], v[144:147], v[208:211]
ds_read_b128 v[176:179], v31 offset:7168
v_mfma_f32_16x16x32_bf16 v[212:215], a[40:43], v[148:151], v[212:215]
ds_read_b128 v[180:183], v31 offset:16384
v_mfma_f32_16x16x32_bf16 v[216:219], a[92:95], v[104:107], v[216:219]
v_readlane_b32 s83, v38, s70
v_mfma_f32_16x16x32_bf16 v[208:211], a[44:47], v[152:155], v[208:211]
ds_read_b128 v[184:187], v31 offset:25600
v_mfma_f32_16x16x32_bf16 v[212:215], a[44:47], v[156:159], v[212:215]
ds_read_b128 v[188:191], v31 offset:34816
v_mfma_f32_16x16x32_bf16 v[220:223], a[92:95], v[108:111], v[220:223]
s_waitcnt lgkmcnt(4)
v_mfma_f32_16x16x32_bf16 v[208:211], a[48:51], v[160:163], v[208:211]
ds_read_b128 v[192:195], v31 offset:8192
v_mfma_f32_16x16x32_bf16 v[212:215], a[48:51], v[164:167], v[212:215]
ds_read_b128 v[196:199], v31 offset:17408
v_mfma_f32_16x16x32_bf16 v[216:219], a[96:99], v[112:115], v[216:219]
buffer_load_dword v24, v22, s[4:7], 0 offen sc1
v_mfma_f32_16x16x32_bf16 v[208:211], a[52:55], v[168:171], v[208:211]
ds_read_b128 v[200:203], v31 offset:26624
v_mfma_f32_16x16x32_bf16 v[212:215], a[52:55], v[172:175], v[212:215]
ds_read_b128 v[204:207], v31 offset:35840
v_mfma_f32_16x16x32_bf16 v[220:223], a[96:99], v[116:119], v[220:223]
s_waitcnt lgkmcnt(4)
v_mfma_f32_16x16x32_bf16 v[208:211], a[56:59], v[176:179], v[208:211]
v_readlane_b32 s84, v39, s70
v_mfma_f32_16x16x32_bf16 v[212:215], a[56:59], v[180:183], v[212:215]
s_add_u32 s52, s52, 1
v_mfma_f32_16x16x32_bf16 v[216:219], a[100:103], v[120:123], v[216:219]
s_cmp_eq_u32 s52, 64
s_cbranch_scc1 rare_79
back_80:
v_mfma_f32_16x16x32_bf16 v[208:211], a[60:63], v[184:187], v[208:211]
v_mov_b32 v27, s86
s_lshl_b32 s70, s87, 10
v_mfma_f32_16x16x32_bf16 v[212:215], a[60:63], v[188:191], v[212:215]
v_mfma_f32_16x16x32_bf16 v[220:223], a[100:103], v[124:127], v[220:223]
s_waitcnt lgkmcnt(0)
v_mfma_f32_16x16x32_bf16 v[208:211], a[64:67], v[192:195], v[208:211]
v_mfma_f32_16x16x32_bf16 v[212:215], a[64:67], v[196:199], v[212:215]
v_mfma_f32_16x16x32_bf16 v[216:219], a[104:107], v[128:131], v[216:219]
v_mfma_f32_16x16x32_bf16 v[208:211], a[68:71], v[200:203], v[208:211]
v_mfma_f32_16x16x32_bf16 v[212:215], a[68:71], v[204:207], v[212:215]
v_mfma_f32_16x16x32_bf16 v[220:223], a[104:107], v[132:135], v[220:223]
v_mfma_f32_16x16x32_bf16 v[216:219], a[108:111], v[136:139], v[216:219]
v_mfma_f32_16x16x32_bf16 v[220:223], a[108:111], v[140:143], v[220:223]
v_mfma_f32_16x16x32_bf16 v[224:227], v[64:67], a[144:147], 0
v_mfma_f32_16x16x32_bf16 v[216:219], a[112:115], v[144:147], v[216:219]
v_mfma_f32_16x16x32_bf16 v[220:223], a[112:115], v[148:151], v[220:223]
s_nop 0
v_cvt_pk_bf16_f32 v48, v208, v209
v_cvt_pk_bf16_f32 v49, v210, v211
v_mfma_f32_16x16x32_bf16 v[228:231], v[68:71], a[144:147], 0
v_cvt_pk_bf16_f32 v50, v212, v213
v_cvt_pk_bf16_f32 v51, v214, v215
v_mfma_f32_16x16x32_bf16 v[216:219], a[116:119], v[152:155], v[216:219]
v_permlane16_swap_b32 v48, v50
v_mfma_f32_16x16x32_bf16 v[220:223], a[116:119], v[156:159], v[220:223]
v_permlane16_swap_b32 v49, v51
v_mfma_f32_16x16x32_bf16 v[224:227], v[72:75], a[148:151], v[224:227]
buffer_store_dwordx4 v[48:51], v19, s[4:7], s94 offen sc1
v_mfma_f32_16x16x32_bf16 v[216:219], a[120:123], v[160:163], v[216:219]
v_mfma_f32_16x16x32_bf16 v[220:223], a[120:123], v[164:167], v[220:223]
v_mfma_f32_16x16x32_bf16 v[228:231], v[76:79], a[148:151], v[228:231]
v_mfma_f32_16x16x32_bf16 v[216:219], a[124:127], v[168:171], v[216:219]
v_mfma_f32_16x16x32_bf16 v[220:223], a[124:127], v[172:175], v[220:223]
v_mfma_f32_16x16x32_bf16 v[224:227], v[80:83], a[152:155], v[224:227]
v_mfma_f32_16x16x32_bf16 v[216:219], a[128:131], v[176:179], v[216:219]
v_mfma_f32_16x16x32_bf16 v[220:223], a[128:131], v[180:183], v[220:223]
v_mfma_f32_16x16x32_bf16 v[228:231], v[84:87], a[152:155], v[228:231]
v_mfma_f32_16x16x32_bf16 v[216:219], a[132:135], v[184:187], v[216:219]
v_mfma_f32_16x16x32_bf16 v[220:223], a[132:135], v[188:191], v[220:223]
v_mfma_f32_16x16x32_bf16 v[224:227], v[88:91], a[156:159], v[224:227]
v_mfma_f32_16x16x32_bf16 v[216:219], a[136:139], v[192:195], v[216:219]
v_mfma_f32_16x16x32_bf16 v[220:223], a[136:139], v[196:199], v[220:223]
v_mfma_f32_16x16x32_bf16 v[228:231], v[92:95], a[156:159], v[228:231]
v_mfma_f32_16x16x32_bf16 v[216:219], a[140:143], v[200:203], v[216:219]
v_mfma_f32_16x16x32_bf16 v[220:223], a[140:143], v[204:207], v[220:223]
v_mfma_f32_16x16x32_bf16 v[224:227], v[96:99], a[160:163], v[224:227]
v_mfma_f32_16x16x32_bf16 v[228:231], v[100:103], a[160:163], v[228:231]
s_waitcnt vmcnt(1)
ds_write_b32 v18, v24
v_mfma_f32_16x16x32_bf16 v[224:227], v[104:107], a[164:167], v[224:227]
v_mfma_f32_16x16x32_bf16 v[228:231], v[108:111], a[164:167], v[228:231]
v_mfma_f32_16x16x32_bf16 v[224:227], v[112:115], a[168:171], v[224:227]
s_waitcnt lgkmcnt(0)
s_barrier
v_mfma_f32_16x16x32_bf16 v[228:231], v[116:119], a[168:171], v[228:231]
ds_read_b32 v33, v32
v_cvt_pk_bf16_f32 v52, v216, v217
v_mfma_f32_16x16x32_bf16 v[224:227], v[120:123], a[172:175], v[224:227]
buffer_store_dword v27, v45, s[4:7], s70 offen
v_mfma_f32_16x16x32_bf16 v[228:231], v[124:127], a[172:175], v[228:231]
buffer_store_dword v27, v44, s[4:7], s70 offen sc1
v_mfma_f32_16x16x32_bf16 v[224:227], v[128:131], a[176:179], v[224:227]
s_waitcnt lgkmcnt(0)
v_cmp_gt_u32 vcc, s81, v33
v_mfma_f32_16x16x32_bf16 v[228:231], v[132:135], a[176:179], v[228:231]
s_lshr_b64 s[58:59], vcc, s82
s_and_b32 s58, s58, s56
s_cselect_b32 s10, 0, 268435456
s_cselect_b32 s85, 0, 1
v_mfma_f32_16x16x32_bf16 v[224:227], v[136:139], a[180:183], v[224:227]
s_cmp_eq_u32 s80, 0
s_cbranch_scc1 g_slow_78
v_mfma_f32_16x16x32_bf16 v[228:231], v[140:143], a[180:183], v[228:231]
s_add_u32 m0, s73, 0
v_cvt_pk_bf16_f32 v53, v218, v219
v_mfma_f32_16x16x32_bf16 v[224:227], v[144:147], a[184:187], v[224:227]
buffer_load_dwordx4 v8, s[8:11], s83 offen offset:0 sc1 lds
v_mfma_f32_16x16x32_bf16 v[228:231], v[148:151], a[184:187], v[228:231]
v_cvt_pk_bf16_f32 v54, v220, v221
v_cvt_pk_bf16_f32 v55, v222, v223
v_mfma_f32_16x16x32_bf16 v[224:227], v[152:155], a[188:191], v[224:227]
v_permlane16_swap_b32 v52, v54
v_mfma_f32_16x16x32_bf16 v[228:231], v[156:159], a[188:191], v[228:231]
v_permlane16_swap_b32 v53, v55
v_mfma_f32_16x16x32_bf16 v[224:227], v[160:163], a[192:195], v[224:227]
buffer_load_dwordx4 v9, s[8:11], s83 offen offset:1024 sc1 lds
v_mfma_f32_16x16x32_bf16 v[228:231], v[164:167], a[192:195], v[228:231]
buffer_store_dwordx4 v[52:55], v20, s[4:7], s94 offen sc1
v_mfma_f32_16x16x32_bf16 v[224:227], v[168:171], a[196:199], v[224:227]
ds_read_b128 v[64:67], v28 offset:0
v_mfma_f32_16x16x32_bf16 v[228:231], v[172:175], a[196:199], v[228:231]
ds_read_b128 v[68:71], v28 offset:9216
v_mfma_f32_16x16x32_bf16 v[224:227], v[176:179], a[200:203], v[224:227]
buffer_load_dwordx4 v10, s[8:11], s83 offen offset:2048 sc1 lds
ds_read_b128 v[72:75], v28 offset:18432
v_mfma_f32_16x16x32_bf16 v[228:231], v[180:183], a[200:203], v[228:231]
ds_read_b128 v[76:79], v28 offset:27648
v_mfma_f32_16x16x32_bf16 v[224:227], v[184:187], a[204:207], v[224:227]
ds_read_b128 v[80:83], v28 offset:1024
v_mfma_f32_16x16x32_bf16 v[228:231], v[188:191], a[204:207], v[228:231]
ds_read_b128 v[84:87], v28 offset:10240
v_mfma_f32_16x16x32_bf16 v[224:227], v[192:195], a[208:211], v[224:227]
buffer_load_dwordx4 v11, s[8:11], s83 offen offset:3072 sc1 lds
ds_read_b128 v[88:91], v28 offset:19456
v_mfma_f32_16x16x32_bf16 v[228:231], v[196:199], a[208:211], v[228:231]
ds_read_b128 v[92:95], v28 offset:28672
v_mfma_f32_16x16x32_bf16 v[224:227], v[200:203], a[212:215], v[224:227]
v_mfma_f32_16x16x32_bf16 v[228:231], v[204:207], a[212:215], v[228:231]
s_branch g_body_59
g_slow_75:
v_cmp_gt_u32 vcc, s81, v33
s_nop 0
s_lshr_b64 s[58:59], vcc, s82
s_and_b32 s58, s58, s56
s_cbranch_scc1 g_notyet_81
s_add_u32 m0, s73, 0
s_nop 0
buffer_load_dwordx4 v8, s[4:7], s83 offen offset:0 sc1 lds
buffer_load_dwordx4 v9, s[4:7], s83 offen offset:1024 sc1 lds
buffer_load_dwordx4 v10, s[4:7], s83 offen offset:2048 sc1 lds
buffer_load_dwordx4 v11, s[4:7], s83 offen offset:3072 sc1 lds
s_add_u32 m0, s73, 4096
s_nop 0
buffer_load_dwordx4 v12, s[4:7], s83 offen offset:0 sc1 lds
buffer_load_dwordx4 v13, s[4:7], s83 offen offset:1024 sc1 lds
buffer_load_dwordx4 v14, s[4:7], s83 offen offset:2048 sc1 lds
buffer_load_dwordx4 v15, s[4:7], s83 offen offset:3072 sc1 lds
s_add_u32 m0, s73, 8192
s_nop 0
buffer_load_dwordx4 v16, s[4:7], s83 offen offset:0 sc1 lds
v_mfma_f32_16x16x32_bf16 v[228:231], v[140:143], a[180:183], v[228:231]
s_add_u32 m0, s74, 0
v_cvt_pk_bf16_f32 v53, v218, v219
v_mfma_f32_16x16x32_bf16 v[224:227], v[144:147], a[184:187], v[224:227]
buffer_load_dwordx4 v8, s[8:11], s88 offen offset:0 sc1 lds
v_mfma_f32_16x16x32_bf16 v[228:231], v[148:151], a[184:187], v[228:231]
v_cvt_pk_bf16_f32 v54, v220, v221
v_cvt_pk_bf16_f32 v55, v222, v223
v_mfma_f32_16x16x32_bf16 v[224:227], v[152:155], a[188:191], v[224:227]
v_permlane16_swap_b32 v52, v54
v_mfma_f32_16x16x32_bf16 v[228:231], v[156:159], a[188:191], v[228:231]
v_permlane16_swap_b32 v53, v55
v_mfma_f32_16x16x32_bf16 v[224:227], v[160:163], a[192:195], v[224:227]
buffer_load_dwordx4 v9, s[8:11], s88 offen offset:1024 sc1 lds
v_mfma_f32_16x16x32_bf16 v[228:231], v[164:167], a[192:195], v[228:231]
buffer_store_dwordx4 v[52:55], v20, s[4:7], s79 offen sc1
v_mfma_f32_16x16x32_bf16 v[224:227], v[168:171], a[196:199], v[224:227]
v_mfma_f32_16x16x32_bf16 v[228:231], v[172:175], a[196:199], v[228:231]
v_mfma_f32_16x16x32_bf16 v[224:227], v[176:179], a[200:203], v[224:227]
buffer_load_dwordx4 v10, s[8:11], s88 offen offset:2048 sc1 lds
v_mfma_f32_16x16x32_bf16 v[228:231], v[180:183], a[200:203], v[228:231]
v_mfma_f32_16x16x32_bf16 v[224:227], v[184:187], a[204:207], v[224:227]
v_mfma_f32_16x16x32_bf16 v[228:231], v[188:191], a[204:207], v[228:231]
v_mfma_f32_16x16x32_bf16 v[224:227], v[192:195], a[208:211], v[224:227]
buffer_load_dwordx4 v11, s[8:11], s88 offen offset:3072 sc1 lds
v_mfma_f32_16x16x32_bf16 v[228:231], v[196:199], a[208:211], v[228:231]
v_mfma_f32_16x16x32_bf16 v[224:227], v[200:203], a[212:215], v[224:227]
v_mfma_f32_16x16x32_bf16 v[228:231], v[204:207], a[212:215], v[228:231]
s_nop 6
v_cvt_pk_bf16_f32 v56, v224, v225
v_cvt_pk_bf16_f32 v57, v226, v227
v_cvt_pk_bf16_f32 v58, v228, v229
v_cvt_pk_bf16_f32 v59, v230, v231
buffer_store_dwordx4 v[56:59], v21, s[4:7], s79 offen sc1
s_mov_b32 s79, 1879048192
s_waitcnt vmcnt(6)
s_branch g_go_82
g_notyet_81:
v_mfma_f32_16x16x32_bf16 v[228:231], v[140:143], a[180:183], v[228:231]
s_add_u32 m0, s74, 0
v_cvt_pk_bf16_f32 v53, v218, v219
v_mfma_f32_16x16x32_bf16 v[224:227], v[144:147], a[184:187], v[224:227]
buffer_load_dwordx4 v8, s[8:11], s88 offen offset:0 sc1 lds
v_mfma_f32_16x16x32_bf16 v[228:231], v[148:151], a[184:187], v[228:231]
v_cvt_pk_bf16_f32 v54, v220, v221
v_cvt_pk_bf16_f32 v55, v222, v223
v_mfma_f32_16x16x32_bf16 v[224:227], v[152:155], a[188:191], v[224:227]
v_permlane16_swap_b32 v52, v54
v_mfma_f32_16x16x32_bf16 v[228:231], v[156:159], a[188:191], v[228:231]
v_permlane16_swap_b32 v53, v55
v_mfma_f32_16x16x32_bf16 v[224:227], v[160:163], a[192:195], v[224:227]
buffer_load_dwordx4 v9, s[8:11], s88 offen offset:1024 sc1 lds
v_mfma_f32_16x16x32_bf16 v[228:231], v[164:167], a[192:195], v[228:231]
buffer_store_dwordx4 v[52:55], v20, s[4:7], s79 offen sc1
v_mfma_f32_16x16x32_bf16 v[224:227], v[168:171], a[196:199], v[224:227]
v_mfma_f32_16x16x32_bf16 v[228:231], v[172:175], a[196:199], v[228:231]
v_mfma_f32_16x16x32_bf16 v[224:227], v[176:179], a[200:203], v[224:227]
buffer_load_dwordx4 v10, s[8:11], s88 offen offset:2048 sc1 lds
v_mfma_f32_16x16x32_bf16 v[228:231], v[180:183], a[200:203], v[228:231]
v_mfma_f32_16x16x32_bf16 v[224:227], v[184:187], a[204:207], v[224:227]
v_mfma_f32_16x16x32_bf16 v[228:231], v[188:191], a[204:207], v[228:231]
v_mfma_f32_16x16x32_bf16 v[224:227], v[192:195], a[208:211], v[224:227]
buffer_load_dwordx4 v11, s[8:11], s88 offen offset:3072 sc1 lds
v_mfma_f32_16x16x32_bf16 v[228:231], v[196:199], a[208:211], v[228:231]
v_mfma_f32_16x16x32_bf16 v[224:227], v[200:203], a[212:215], v[224:227]
v_mfma_f32_16x16x32_bf16 v[228:231], v[204:207], a[212:215], v[228:231]
s_nop 6
v_cvt_pk_bf16_f32 v56, v224, v225
v_cvt_pk_bf16_f32 v57, v226, v227
v_cvt_pk_bf16_f32 v58, v228, v229
v_cvt_pk_bf16_f32 v59, v230, v231
buffer_store_dwordx4 v[56:59], v21, s[4:7], s79 offen sc1
s_mov_b32 s79, 1879048192
v_mov_b32 v27, s76
s_lshl_b32 s70, s77, 10
s_waitcnt vmcnt(0)
s_barrier
buffer_store_dword v27, v45, s[4:7], s70 offen
buffer_store_dword v27, v44, s[4:7], s70 offen sc1
s_mov_b32 s77, 1835008
s_cmp_eq_u32 s81, -1
s_cbranch_scc1 g_fin_67
s_cmp_lg_u32 s3, 0
s_cbranch_scc1 sp_ok_84
s_mov_b32 s55, 0
sp_loop_83:
s_lshl_b64 exec, s[56:57], s82
buffer_load_dword v26, v22, s[4:7], 0 offen sc1
s_mov_b64 exec, -1
s_add_u32 s55, s55, 1
s_cmp_gt_u32 s55, 150000
s_cbranch_scc1 sp_bad_85
s_waitcnt vmcnt(0)
v_cmp_gt_u32 vcc, s81, v26
s_nop 0
s_lshr_b64 s[58:59], vcc, s82
s_and_b32 s58, s58, s56
s_cbranch_scc0 sp_ok_84
s_sleep 1
s_branch sp_loop_83
sp_bad_85:
s_mov_b32 s98, 1026
s_branch L_fail
sp_ok_84:
s_barrier
s_add_u32 m0, s73, 0
s_nop 0
buffer_load_dwordx4 v8, s[4:7], s83 offen offset:0 sc1 lds
buffer_load_dwordx4 v9, s[4:7], s83 offen offset:1024 sc1 lds
buffer_load_dwordx4 v10, s[4:7], s83 offen offset:2048 sc1 lds
buffer_load_dwordx4 v11, s[4:7], s83 offen offset:3072 sc1 lds
s_add_u32 m0, s73, 4096
s_nop 0
buffer_load_dwordx4 v12, s[4:7], s83 offen offset:0 sc1 lds
buffer_load_dwordx4 v13, s[4:7], s83 offen offset:1024 sc1 lds
buffer_load_dwordx4 v14, s[4:7], s83 offen offset:2048 sc1 lds
buffer_load_dwordx4 v15, s[4:7], s83 offen offset:3072 sc1 lds
s_add_u32 m0, s73, 8192
s_nop 0
buffer_load_dwordx4 v16, s[4:7], s83 offen offset:0 sc1 lds
s_waitcnt vmcnt(0)
g_go_82:
g_join_64:
s_barrier
ds_read_b128 v[64:67], v29 offset:0
ds_read_b128 v[68:71], v29 offset:9216
ds_read_b128 v[72:75], v29 offset:18432
ds_read_b128 v[76:79], v29 offset:27648
ds_read_b128 v[80:83], v29 offset:1024
ds_read_b128 v[84:87], v29 offset:10240
ds_read_b128 v[88:91], v29 offset:19456
ds_read_b128 v[92:95], v29 offset:28672
s_branch g_body_60
g_slow_76:
v_cmp_gt_u32 vcc, s86, v33
s_nop 0
s_lshr_b64 s[58:59], vcc, s87
s_and_b32 s58, s58, s56
s_cbranch_scc1 g_notyet_86
s_add_u32 m0, s74, 0
s_nop 0
buffer_load_dwordx4 v8, s[4:7], s88 offen offset:0 sc1 lds
buffer_load_dwordx4 v9, s[4:7], s88 offen offset:1024 sc1 lds
buffer_load_dwordx4 v10, s[4:7], s88 offen offset:2048 sc1 lds
buffer_load_dwordx4 v11, s[4:7], s88 offen offset:3072 sc1 lds
s_add_u32 m0, s74, 4096
s_nop 0
buffer_load_dwordx4 v12, s[4:7], s88 offen offset:0 sc1 lds
buffer_load_dwordx4 v13, s[4:7], s88 offen offset:1024 sc1 lds
buffer_load_dwordx4 v14, s[4:7], s88 offen offset:2048 sc1 lds
buffer_load_dwordx4 v15, s[4:7], s88 offen offset:3072 sc1 lds
s_add_u32 m0, s74, 8192
s_nop 0
buffer_load_dwordx4 v16, s[4:7], s88 offen offset:0 sc1 lds
v_mfma_f32_16x16x32_bf16 v[228:231], v[140:143], a[180:183], v[228:231]
s_add_u32 m0, s75, 0
v_cvt_pk_bf16_f32 v53, v218, v219
v_mfma_f32_16x16x32_bf16 v[224:227], v[144:147], a[184:187], v[224:227]
buffer_load_dwordx4 v8, s[8:11], s93 offen offset:0 sc1 lds
v_mfma_f32_16x16x32_bf16 v[228:231], v[148:151], a[184:187], v[228:231]
v_cvt_pk_bf16_f32 v54, v220, v221
v_cvt_pk_bf16_f32 v55, v222, v223
v_mfma_f32_16x16x32_bf16 v[224:227], v[152:155], a[188:191], v[224:227]
v_permlane16_swap_b32 v52, v54
v_mfma_f32_16x16x32_bf16 v[228:231], v[156:159], a[188:191], v[228:231]
v_permlane16_swap_b32 v53, v55
v_mfma_f32_16x16x32_bf16 v[224:227], v[160:163], a[192:195], v[224:227]
buffer_load_dwordx4 v9, s[8:11], s93 offen offset:1024 sc1 lds
v_mfma_f32_16x16x32_bf16 v[228:231], v[164:167], a[192:195], v[228:231]
buffer_store_dwordx4 v[52:55], v20, s[4:7], s84 offen sc1
v_mfma_f32_16x16x32_bf16 v[224:227], v[168:171], a[196:199], v[224:227]
v_mfma_f32_16x16x32_bf16 v[228:231], v[172:175], a[196:199], v[228:231]
v_mfma_f32_16x16x32_bf16 v[224:227], v[176:179], a[200:203], v[224:227]
buffer_load_dwordx4 v10, s[8:11], s93 offen offset:2048 sc1 lds
v_mfma_f32_16x16x32_bf16 v[228:231], v[180:183], a[200:203], v[228:231]
v_mfma_f32_16x16x32_bf16 v[224:227], v[184:187], a[204:207], v[224:227]
v_mfma_f32_16x16x32_bf16 v[228:231], v[188:191], a[204:207], v[228:231]
v_mfma_f32_16x16x32_bf16 v[224:227], v[192:195], a[208:211], v[224:227]
buffer_load_dwordx4 v11, s[8:11], s93 offen offset:3072 sc1 lds
v_mfma_f32_16x16x32_bf16 v[228:231], v[196:199], a[208:211], v[228:231]
v_mfma_f32_16x16x32_bf16 v[224:227], v[200:203], a[212:215], v[224:227]
v_mfma_f32_16x16x32_bf16 v[228:231], v[204:207], a[212:215], v[228:231]
s_nop 6
v_cvt_pk_bf16_f32 v56, v224, v225
v_cvt_pk_bf16_f32 v57, v226, v227
v_cvt_pk_bf16_f32 v58, v228, v229
v_cvt_pk_bf16_f32 v59, v230, v231
buffer_store_dwordx4 v[56:59], v21, s[4:7], s84 offen sc1
s_mov_b32 s84, 1879048192
s_waitcnt vmcnt(6)
s_branch g_go_87
g_notyet_86:
v_mfma_f32_16x16x32_bf16 v[228:231], v[140:143], a[180:183], v[228:231]
s_add_u32 m0, s75, 0
v_cvt_pk_bf16_f32 v53, v218, v219
v_mfma_f32_16x16x32_bf16 v[224:227], v[144:147], a[184:187], v[224:227]
buffer_load_dwordx4 v8, s[8:11], s93 offen offset:0 sc1 lds
v_mfma_f32_16x16x32_bf16 v[228:231], v[148:151], a[184:187], v[228:231]
v_cvt_pk_bf16_f32 v54, v220, v221
v_cvt_pk_bf16_f32 v55, v222, v223
v_mfma_f32_16x16x32_bf16 v[224:227], v[152:155], a[188:191], v[224:227]
v_permlane16_swap_b32 v52, v54
v_mfma_f32_16x16x32_bf16 v[228:231], v[156:159], a[188:191], v[228:231]
v_permlane16_swap_b32 v53, v55
v_mfma_f32_16x16x32_bf16 v[224:227], v[160:163], a[192:195], v[224:227]
buffer_load_dwordx4 v9, s[8:11], s93 offen offset:1024 sc1 lds
v_mfma_f32_16x16x32_bf16 v[228:231], v[164:167], a[192:195], v[228:231]
buffer_store_dwordx4 v[52:55], v20, s[4:7], s84 offen sc1
v_mfma_f32_16x16x32_bf16 v[224:227], v[168:171], a[196:199], v[224:227]
v_mfma_f32_16x16x32_bf16 v[228:231], v[172:175], a[196:199], v[228:231]
v_mfma_f32_16x16x32_bf16 v[224:227], v[176:179], a[200:203], v[224:227]
buffer_load_dwordx4 v10, s[8:11], s93 offen offset:2048 sc1 lds
v_mfma_f32_16x16x32_bf16 v[228:231], v[180:183], a[200:203], v[228:231]
v_mfma_f32_16x16x32_bf16 v[224:227], v[184:187], a[204:207], v[224:227]
v_mfma_f32_16x16x32_bf16 v[228:231], v[188:191], a[204:207], v[228:231]
v_mfma_f32_16x16x32_bf16 v[224:227], v[192:195], a[208:211], v[224:227]
buffer_load_dwordx4 v11, s[8:11], s93 offen offset:3072 sc1 lds
v_mfma_f32_16x16x32_bf16 v[228:231], v[196:199], a[208:211], v[228:231]
v_mfma_f32_16x16x32_bf16 v[224:227], v[200:203], a[212:215], v[224:227]
v_mfma_f32_16x16x32_bf16 v[228:231], v[204:207], a[212:215], v[228:231]
s_nop 6
v_cvt_pk_bf16_f32 v56, v224, v225
v_cvt_pk_bf16_f32 v57, v226, v227
v_cvt_pk_bf16_f32 v58, v228, v229
v_cvt_pk_bf16_f32 v59, v230, v231
buffer_store_dwordx4 v[56:59], v21, s[4:7], s84 offen sc1
s_mov_b32 s84, 1879048192
v_mov_b32 v27, s81
s_lshl_b32 s70, s82, 10
s_waitcnt vmcnt(0)
s_barrier
buffer_store_dword v27, v45, s[4:7], s70 offen
buffer_store_dword v27, v44, s[4:7], s70 offen sc1
s_mov_b32 s82, 1835008
s_cmp_eq_u32 s86, -1
s_cbranch_scc1 g_fin_67
s_cmp_lg_u32 s3, 0
s_cbranch_scc1 sp_ok_89
s_mov_b32 s55, 0
sp_loop_88:
s_lshl_b64 exec, s[56:57], s87
buffer_load_dword v26, v22, s[4:7], 0 offen sc1
s_mov_b64 exec, -1
s_add_u32 s55, s55, 1
s_cmp_gt_u32 s55, 150000
s_cbranch_scc1 sp_bad_90
s_waitcnt vmcnt(0)
v_cmp_gt_u32 vcc, s86, v26
s_nop 0
s_lshr_b64 s[58:59], vcc, s87
s_and_b32 s58, s58, s56
s_cbranch_scc0 sp_ok_89
s_sleep 1
s_branch sp_loop_88
sp_bad_90:
s_mov_b32 s98, 1026
s_branch L_fail
sp_ok_89:
s_barrier
s_add_u32 m0, s74, 0
s_nop 0
buffer_load_dwordx4 v8, s[4:7], s88 offen offset:0 sc1 lds
buffer_load_dwordx4 v9, s[4:7], s88 offen offset:1024 sc1 lds
buffer_load_dwordx4 v10, s[4:7], s88 offen offset:2048 sc1 lds
buffer_load_dwordx4 v11, s[4:7], s88 offen offset:3072 sc1 lds
s_add_u32 m0, s74, 4096
s_nop 0
buffer_load_dwordx4 v12, s[4:7], s88 offen offset:0 sc1 lds
buffer_load_dwordx4 v13, s[4:7], s88 offen offset:1024 sc1 lds
buffer_load_dwordx4 v14, s[4:7], s88 offen offset:2048 sc1 lds
buffer_load_dwordx4 v15, s[4:7], s88 offen offset:3072 sc1 lds
s_add_u32 m0, s74, 8192
s_nop 0
buffer_load_dwordx4 v16, s[4:7], s88 offen offset:0 sc1 lds
s_waitcnt vmcnt(0)
g_go_87:
g_join_65:
s_barrier
ds_read_b128 v[64:67], v30 offset:0
ds_read_b128 v[68:71], v30 offset:9216
ds_read_b128 v[72:75], v30 offset:18432
ds_read_b128 v[76:79], v30 offset:27648
ds_read_b128 v[80:83], v30 offset:1024
ds_read_b128 v[84:87], v30 offset:10240
ds_read_b128 v[88:91], v30 offset:19456
ds_read_b128 v[92:95], v30 offset:28672
s_branch g_body_61
g_slow_77:
v_cmp_gt_u32 vcc, s91, v33
s_nop 0
s_lshr_b64 s[58:59], vcc, s92
s_and_b32 s58, s58, s56
s_cbranch_scc1 g_notyet_91
s_add_u32 m0, s75, 0
s_nop 0
buffer_load_dwordx4 v8, s[4:7], s93 offen offset:0 sc1 lds
buffer_load_dwordx4 v9, s[4:7], s93 offen offset:1024 sc1 lds
buffer_load_dwordx4 v10, s[4:7], s93 offen offset:2048 sc1 lds
buffer_load_dwordx4 v11, s[4:7], s93 offen offset:3072 sc1 lds
s_add_u32 m0, s75, 4096
s_nop 0
buffer_load_dwordx4 v12, s[4:7], s93 offen offset:0 sc1 lds
buffer_load_dwordx4 v13, s[4:7], s93 offen offset:1024 sc1 lds
buffer_load_dwordx4 v14, s[4:7], s93 offen offset:2048 sc1 lds
buffer_load_dwordx4 v15, s[4:7], s93 offen offset:3072 sc1 lds
s_add_u32 m0, s75, 8192
s_nop 0
buffer_load_dwordx4 v16, s[4:7], s93 offen offset:0 sc1 lds
v_mfma_f32_16x16x32_bf16 v[228:231], v[140:143], a[180:183], v[228:231]
s_add_u32 m0, s72, 0
v_cvt_pk_bf16_f32 v53, v218, v219
v_mfma_f32_16x16x32_bf16 v[224:227], v[144:147], a[184:187], v[224:227]
buffer_load_dwordx4 v8, s[8:11], s78 offen offset:0 sc1 lds
v_mfma_f32_16x16x32_bf16 v[228:231], v[148:151], a[184:187], v[228:231]
v_cvt_pk_bf16_f32 v54, v220, v221
v_cvt_pk_bf16_f32 v55, v222, v223
v_mfma_f32_16x16x32_bf16 v[224:227], v[152:155], a[188:191], v[224:227]
v_permlane16_swap_b32 v52, v54
v_mfma_f32_16x16x32_bf16 v[228:231], v[156:159], a[188:191], v[228:231]
v_permlane16_swap_b32 v53, v55
v_mfma_f32_16x16x32_bf16 v[224:227], v[160:163], a[192:195], v[224:227]
buffer_load_dwordx4 v9, s[8:11], s78 offen offset:1024 sc1 lds
v_mfma_f32_16x16x32_bf16 v[228:231], v[164:167], a[192:195], v[228:231]
buffer_store_dwordx4 v[52:55], v20, s[4:7], s89 offen sc1
v_mfma_f32_16x16x32_bf16 v[224:227], v[168:171], a[196:199], v[224:227]
v_mfma_f32_16x16x32_bf16 v[228:231], v[172:175], a[196:199], v[228:231]
v_mfma_f32_16x16x32_bf16 v[224:227], v[176:179], a[200:203], v[224:227]
buffer_load_dwordx4 v10, s[8:11], s78 offen offset:2048 sc1 lds
v_mfma_f32_16x16x32_bf16 v[228:231], v[180:183], a[200:203], v[228:231]
v_mfma_f32_16x16x32_bf16 v[224:227], v[184:187], a[204:207], v[224:227]
v_mfma_f32_16x16x32_bf16 v[228:231], v[188:191], a[204:207], v[228:231]
v_mfma_f32_16x16x32_bf16 v[224:227], v[192:195], a[208:211], v[224:227]
buffer_load_dwordx4 v11, s[8:11], s78 offen offset:3072 sc1 lds
v_mfma_f32_16x16x32_bf16 v[228:231], v[196:199], a[208:211], v[228:231]
v_mfma_f32_16x16x32_bf16 v[224:227], v[200:203], a[212:215], v[224:227]
v_mfma_f32_16x16x32_bf16 v[228:231], v[204:207], a[212:215], v[228:231]
s_nop 6
v_cvt_pk_bf16_f32 v56, v224, v225
v_cvt_pk_bf16_f32 v57, v226, v227
v_cvt_pk_bf16_f32 v58, v228, v229
v_cvt_pk_bf16_f32 v59, v230, v231
buffer_store_dwordx4 v[56:59], v21, s[4:7], s89 offen sc1
s_mov_b32 s89, 1879048192
s_waitcnt vmcnt(6)
s_branch g_go_92
g_notyet_91:
v_mfma_f32_16x16x32_bf16 v[228:231], v[140:143], a[180:183], v[228:231]
s_add_u32 m0, s72, 0
v_cvt_pk_bf16_f32 v53, v218, v219
v_mfma_f32_16x16x32_bf16 v[224:227], v[144:147], a[184:187], v[224:227]
buffer_load_dwordx4 v8, s[8:11], s78 offen offset:0 sc1 lds
v_mfma_f32_16x16x32_bf16 v[228:231], v[148:151], a[184:187], v[228:231]
v_cvt_pk_bf16_f32 v54, v220, v221
v_cvt_pk_bf16_f32 v55, v222, v223
v_mfma_f32_16x16x32_bf16 v[224:227], v[152:155], a[188:191], v[224:227]
v_permlane16_swap_b32 v52, v54
v_mfma_f32_16x16x32_bf16 v[228:231], v[156:159], a[188:191], v[228:231]
v_permlane16_swap_b32 v53, v55
v_mfma_f32_16x16x32_bf16 v[224:227], v[160:163], a[192:195], v[224:227]
buffer_load_dwordx4 v9, s[8:11], s78 offen offset:1024 sc1 lds
v_mfma_f32_16x16x32_bf16 v[228:231], v[164:167], a[192:195], v[228:231]
buffer_store_dwordx4 v[52:55], v20, s[4:7], s89 offen sc1
v_mfma_f32_16x16x32_bf16 v[224:227], v[168:171], a[196:199], v[224:227]
v_mfma_f32_16x16x32_bf16 v[228:231], v[172:175], a[196:199], v[228:231]
v_mfma_f32_16x16x32_bf16 v[224:227], v[176:179], a[200:203], v[224:227]
buffer_load_dwordx4 v10, s[8:11], s78 offen offset:2048 sc1 lds
v_mfma_f32_16x16x32_bf16 v[228:231], v[180:183], a[200:203], v[228:231]
v_mfma_f32_16x16x32_bf16 v[224:227], v[184:187], a[204:207], v[224:227]
v_mfma_f32_16x16x32_bf16 v[228:231], v[188:191], a[204:207], v[228:231]
v_mfma_f32_16x16x32_bf16 v[224:227], v[192:195], a[208:211], v[224:227]
buffer_load_dwordx4 v11, s[8:11], s78 offen offset:3072 sc1 lds
v_mfma_f32_16x16x32_bf16 v[228:231], v[196:199], a[208:211], v[228:231]
v_mfma_f32_16x16x32_bf16 v[224:227], v[200:203], a[212:215], v[224:227]
v_mfma_f32_16x16x32_bf16 v[228:231], v[204:207], a[212:215], v[228:231]
s_nop 6
v_cvt_pk_bf16_f32 v56, v224, v225
v_cvt_pk_bf16_f32 v57, v226, v227
v_cvt_pk_bf16_f32 v58, v228, v229
v_cvt_pk_bf16_f32 v59, v230, v231
buffer_store_dwordx4 v[56:59], v21, s[4:7], s89 offen sc1
s_mov_b32 s89, 1879048192
v_mov_b32 v27, s86
s_lshl_b32 s70, s87, 10
s_waitcnt vmcnt(0)
s_barrier
buffer_store_dword v27, v45, s[4:7], s70 offen
buffer_store_dword v27, v44, s[4:7], s70 offen sc1
s_mov_b32 s87, 1835008
s_cmp_eq_u32 s91, -1
s_cbranch_scc1 g_fin_67
s_cmp_lg_u32 s3, 0
s_cbranch_scc1 sp_ok_94
s_mov_b32 s55, 0
sp_loop_93:
s_lshl_b64 exec, s[56:57], s92
buffer_load_dword v26, v22, s[4:7], 0 offen sc1
s_mov_b64 exec, -1
s_add_u32 s55, s55, 1
s_cmp_gt_u32 s55, 150000
s_cbranch_scc1 sp_bad_95
s_waitcnt vmcnt(0)
v_cmp_gt_u32 vcc, s91, v26
s_nop 0
s_lshr_b64 s[58:59], vcc, s92
s_and_b32 s58, s58, s56
s_cbranch_scc0 sp_ok_94
s_sleep 1
s_branch sp_loop_93
sp_bad_95:
s_mov_b32 s98, 1026
s_branch L_fail
sp_ok_94:
s_barrier
s_add_u32 m0, s75, 0
s_nop 0
buffer_load_dwordx4 v8, s[4:7], s93 offen offset:0 sc1 lds
buffer_load_dwordx4 v9, s[4:7], s93 offen offset:1024 sc1 lds
buffer_load_dwordx4 v10, s[4:7], s93 offen offset:2048 sc1 lds
buffer_load_dwordx4 v11, s[4:7], s93 offen offset:3072 sc1 lds
s_add_u32 m0, s75, 4096
s_nop 0
buffer_load_dwordx4 v12, s[4:7], s93 offen offset:0 sc1 lds
buffer_load_dwordx4 v13, s[4:7], s93 offen offset:1024 sc1 lds
buffer_load_dwordx4 v14, s[4:7], s93 offen offset:2048 sc1 lds
buffer_load_dwordx4 v15, s[4:7], s93 offen offset:3072 sc1 lds
s_add_u32 m0, s75, 8192
s_nop 0
buffer_load_dwordx4 v16, s[4:7], s93 offen offset:0 sc1 lds
s_waitcnt vmcnt(0)
g_go_92:
g_join_66:
s_barrier
ds_read_b128 v[64:67], v31 offset:0
ds_read_b128 v[68:71], v31 offset:9216
ds_read_b128 v[72:75], v31 offset:18432
ds_read_b128 v[76:79], v31 offset:27648
ds_read_b128 v[80:83], v31 offset:1024
ds_read_b128 v[84:87], v31 offset:10240
ds_read_b128 v[88:91], v31 offset:19456
ds_read_b128 v[92:95], v31 offset:28672
s_branch g_body_62
g_slow_78:
v_cmp_gt_u32 vcc, s76, v33
s_nop 0
s_lshr_b64 s[58:59], vcc, s77
s_and_b32 s58, s58, s56
s_cbranch_scc1 g_notyet_96
s_add_u32 m0, s72, 0
s_nop 0
buffer_load_dwordx4 v8, s[4:7], s78 offen offset:0 sc1 lds
buffer_load_dwordx4 v9, s[4:7], s78 offen offset:1024 sc1 lds
buffer_load_dwordx4 v10, s[4:7], s78 offen offset:2048 sc1 lds
buffer_load_dwordx4 v11, s[4:7], s78 offen offset:3072 sc1 lds
s_add_u32 m0, s72, 4096
s_nop 0
buffer_load_dwordx4 v12, s[4:7], s78 offen offset:0 sc1 lds
buffer_load_dwordx4 v13, s[4:7], s78 offen offset:1024 sc1 lds
buffer_load_dwordx4 v14, s[4:7], s78 offen offset:2048 sc1 lds
buffer_load_dwordx4 v15, s[4:7], s78 offen offset:3072 sc1 lds
s_add_u32 m0, s72, 8192
s_nop 0
buffer_load_dwordx4 v16, s[4:7], s78 offen offset:0 sc1 lds
v_mfma_f32_16x16x32_bf16 v[228:231], v[140:143], a[180:183], v[228:231]
s_add_u32 m0, s73, 0
v_cvt_pk_bf16_f32 v53, v218, v219
v_mfma_f32_16x16x32_bf16 v[224:227], v[144:147], a[184:187], v[224:227]
buffer_load_dwordx4 v8, s[8:11], s83 offen offset:0 sc1 lds
v_mfma_f32_16x16x32_bf16 v[228:231], v[148:151], a[184:187], v[228:231]
v_cvt_pk_bf16_f32 v54, v220, v221
v_cvt_pk_bf16_f32 v55, v222, v223
v_mfma_f32_16x16x32_bf16 v[224:227], v[152:155], a[188:191], v[224:227]
v_permlane16_swap_b32 v52, v54
v_mfma_f32_16x16x32_bf16 v[228:231], v[156:159], a[188:191], v[228:231]
v_permlane16_swap_b32 v53, v55
v_mfma_f32_16x16x32_bf16 v[224:227], v[160:163], a[192:195], v[224:227]
buffer_load_dwordx4 v9, s[8:11], s83 offen offset:1024 sc1 lds
v_mfma_f32_16x16x32_bf16 v[228:231], v[164:167], a[192:195], v[228:231]
buffer_store_dwordx4 v[52:55], v20, s[4:7], s94 offen sc1
v_mfma_f32_16x16x32_bf16 v[224:227], v[168:171], a[196:199], v[224:227]
v_mfma_f32_16x16x32_bf16 v[228:231], v[172:175], a[196:199], v[228:231]
v_mfma_f32_16x16x32_bf16 v[224:227], v[176:179], a[200:203], v[224:227]
buffer_load_dwordx4 v10, s[8:11], s83 offen offset:2048 sc1 lds
v_mfma_f32_16x16x32_bf16 v[228:231], v[180:183], a[200:203], v[228:231]
v_mfma_f32_16x16x32_bf16 v[224:227], v[184:187], a[204:207], v[224:227]
v_mfma_f32_16x16x32_bf16 v[228:231], v[188:191], a[204:207], v[228:231]
v_mfma_f32_16x16x32_bf16 v[224:227], v[192:195], a[208:211], v[224:227]
buffer_load_dwordx4 v11, s[8:11], s83 offen offset:3072 sc1 lds
v_mfma_f32_16x16x32_bf16 v[228:231], v[196:199], a[208:211], v[228:231]
v_mfma_f32_16x16x32_bf16 v[224:227], v[200:203], a[212:215], v[224:227]
v_mfma_f32_16x16x32_bf16 v[228:231], v[204:207], a[212:215], v[228:231]
s_nop 6
v_cvt_pk_bf16_f32 v56, v224, v225
v_cvt_pk_bf16_f32 v57, v226, v227
v_cvt_pk_bf16_f32 v58, v228, v229
v_cvt_pk_bf16_f32 v59, v230, v231
buffer_store_dwordx4 v[56:59], v21, s[4:7], s94 offen sc1
s_mov_b32 s94, 1879048192
s_waitcnt vmcnt(6)
s_branch g_go_97
g_notyet_96:
v_mfma_f32_16x16x32_bf16 v[228:231], v[140:143], a[180:183], v[228:231]
s_add_u32 m0, s73, 0
v_cvt_pk_bf16_f32 v53, v218, v219
v_mfma_f32_16x16x32_bf16 v[224:227], v[144:147], a[184:187], v[224:227]
buffer_load_dwordx4 v8, s[8:11], s83 offen offset:0 sc1 lds
v_mfma_f32_16x16x32_bf16 v[228:231], v[148:151], a[184:187], v[228:231]
v_cvt_pk_bf16_f32 v54, v220, v221
v_cvt_pk_bf16_f32 v55, v222, v223
v_mfma_f32_16x16x32_bf16 v[224:227], v[152:155], a[188:191], v[224:227]
v_permlane16_swap_b32 v52, v54
v_mfma_f32_16x16x32_bf16 v[228:231], v[156:159], a[188:191], v[228:231]
v_permlane16_swap_b32 v53, v55
v_mfma_f32_16x16x32_bf16 v[224:227], v[160:163], a[192:195], v[224:227]
buffer_load_dwordx4 v9, s[8:11], s83 offen offset:1024 sc1 lds
v_mfma_f32_16x16x32_bf16 v[228:231], v[164:167], a[192:195], v[228:231]
buffer_store_dwordx4 v[52:55], v20, s[4:7], s94 offen sc1
v_mfma_f32_16x16x32_bf16 v[224:227], v[168:171], a[196:199], v[224:227]
v_mfma_f32_16x16x32_bf16 v[228:231], v[172:175], a[196:199], v[228:231]
v_mfma_f32_16x16x32_bf16 v[224:227], v[176:179], a[200:203], v[224:227]
buffer_load_dwordx4 v10, s[8:11], s83 offen offset:2048 sc1 lds
v_mfma_f32_16x16x32_bf16 v[228:231], v[180:183], a[200:203], v[228:231]
v_mfma_f32_16x16x32_bf16 v[224:227], v[184:187], a[204:207], v[224:227]
v_mfma_f32_16x16x32_bf16 v[228:231], v[188:191], a[204:207], v[228:231]
v_mfma_f32_16x16x32_bf16 v[224:227], v[192:195], a[208:211], v[224:227]
buffer_load_dwordx4 v11, s[8:11], s83 offen offset:3072 sc1 lds
v_mfma_f32_16x16x32_bf16 v[228:231], v[196:199], a[208:211], v[228:231]
v_mfma_f32_16x16x32_bf16 v[224:227], v[200:203], a[212:215], v[224:227]
v_mfma_f32_16x16x32_bf16 v[228:231], v[204:207], a[212:215], v[228:231]
s_nop 6
v_cvt_pk_bf16_f32 v56, v224, v225
v_cvt_pk_bf16_f32 v57, v226, v227
v_cvt_pk_bf16_f32 v58, v228, v229
v_cvt_pk_bf16_f32 v59, v230, v231
buffer_store_dwordx4 v[56:59], v21, s[4:7], s94 offen sc1
s_mov_b32 s94, 1879048192
v_mov_b32 v27, s91
s_lshl_b32 s70, s92, 10
s_waitcnt vmcnt(0)
s_barrier
buffer_store_dword v27, v45, s[4:7], s70 offen
buffer_store_dword v27, v44, s[4:7], s70 offen sc1
s_mov_b32 s92, 1835008
s_cmp_eq_u32 s76, -1
s_cbranch_scc1 g_fin_67
s_cmp_lg_u32 s3, 0
s_cbranch_scc1 sp_ok_99
s_mov_b32 s55, 0
sp_loop_98:
s_lshl_b64 exec, s[56:57], s77
buffer_load_dword v26, v22, s[4:7], 0 offen sc1
s_mov_b64 exec, -1
s_add_u32 s55, s55, 1
s_cmp_gt_u32 s55, 150000
s_cbranch_scc1 sp_bad_100
s_waitcnt vmcnt(0)
v_cmp_gt_u32 vcc, s76, v26
s_nop 0
s_lshr_b64 s[58:59], vcc, s77
s_and_b32 s58, s58, s56
s_cbranch_scc0 sp_ok_99
s_sleep 1
s_branch sp_loop_98
sp_bad_100:
s_mov_b32 s98, 1026
s_branch L_fail
sp_ok_99:
s_barrier
s_add_u32 m0, s72, 0
s_nop 0
buffer_load_dwordx4 v8, s[4:7], s78 offen offset:0 sc1 lds
buffer_load_dwordx4 v9, s[4:7], s78 offen offset:1024 sc1 lds
buffer_load_dwordx4 v10, s[4:7], s78 offen offset:2048 sc1 lds
buffer_load_dwordx4 v11, s[4:7], s78 offen offset:3072 sc1 lds
s_add_u32 m0, s72, 4096
s_nop 0
buffer_load_dwordx4 v12, s[4:7], s78 offen offset:0 sc1 lds
buffer_load_dwordx4 v13, s[4:7], s78 offen offset:1024 sc1 lds
buffer_load_dwordx4 v14, s[4:7], s78 offen offset:2048 sc1 lds
buffer_load_dwordx4 v15, s[4:7], s78 offen offset:3072 sc1 lds
s_add_u32 m0, s72, 8192
s_nop 0
buffer_load_dwordx4 v16, s[4:7], s78 offen offset:0 sc1 lds
s_waitcnt vmcnt(0)
g_go_97:
s_branch g_join_63
g_fin_67:
s_endpgm
rare_79:
v_mov_b32 v36, v40
v_mov_b32 v37, v41
v_mov_b32 v38, v42
v_mov_b32 v39, v43
s_branch back_80
G_sss18:
s_mov_b32 s8, s42
s_and_b32 s9, s43, 0xffff
s_mov_b32 s10, 0
s_mov_b32 s11, 0x20000
s_mov_b32 s52, 0
s_mul_i32 s72, s3, 9216
s_add_u32 s73, s72, 36864
s_add_u32 s74, s72, 73728
s_add_u32 s75, s72, 110592
s_mov_b32 s54, 0xbfb8aa3b
v_add_u32 v28, 0, v17
v_add_u32 v29, 36864, v17
v_add_u32 v30, 73728, v17
v_add_u32 v31, 110592, v17
v_lshlrev_b32 v1, 2, v0
v_add_u32 v32, 147456, v1
s_lshl_b32 s70, s3, 8
v_add_u32 v18, s70, v32
v_mov_b64 v[224:225], 0
v_mov_b64 v[236:237], 0
v_mov_b64 v[226:227], 0
v_mov_b64 v[238:239], 0
v_mov_b64 v[228:229], 0
v_mov_b64 v[240:241], 0
v_mov_b64 v[230:231], 0
v_mov_b64 v[242:243], 0
s_mov_b32 s12, s40
s_and_b32 s13, s41, 0xffff
s_mov_b32 s14, 256
s_mov_b32 s15, 0x20000
v_lshlrev_b32 v26, 2, v0
v_add_u32 v27, 128, v26
v_cmp_le_u32 vcc, 2, v0
s_nop 1
v_cndmask_b32 v26, v26, v27, vcc
v_mov_b32 v27, 192
v_cmp_eq_u32 vcc, 8, v0
s_nop 1
v_cndmask_b32 v26, v26, v27, vcc
v_mov_b32 v27, 2147483632
v_cmp_lt_u32 vcc, 8, v0
s_nop 1
v_cndmask_b32 v26, v26, v27, vcc
s_mov_b32 s98, 0
wi_loop_110:
buffer_load_dword v27, v26, s[12:15], 0 offen sc1
s_add_u32 s98, s98, 1
s_cmp_gt_u32 s98, 150000
s_cbranch_scc1 wi_bad_112
s_waitcnt vmcnt(0)
v_cmp_eq_u32 vcc, 32, v27
s_nop 0
s_and_b32 s97, vcc_lo, 0x1ff
s_cmp_eq_u32 s97, 0x1ff
s_cbranch_scc1 wi_ok_111
v_cmp_lt_u32 vcc, 32, v27
s_nop 0
s_and_b32 s96, vcc_lo, 0xff
s_cselect_b32 s96, 0x100, 0
s_and_b32 s96, s96, s97
s_cbranch_scc1 wi_over_113
s_sleep 8
s_branch wi_loop_110
wi_bad_112:
s_mov_b32 s98, 512
s_branch L_fail
wi_over_113:
s_mov_b32 s100, 255
wi_ok_111:
v_add_u32 v26, 65536, v22
v_cmp_eq_u32 vcc, s100, v23
s_nop 1
v_cndmask_b32 v22, v22, v26, vcc
s_cmp_lg_u32 s3, 0
s_cbranch_scc1 sp_ok_115
s_mov_b32 s55, 0
sp_loop_114:
s_lshl_b64 exec, s[56:57], s77
buffer_load_dword v26, v22, s[4:7], 0 offen sc1
s_mov_b64 exec, -1
s_add_u32 s55, s55, 1
s_cmp_gt_u32 s55, 150000
s_cbranch_scc1 sp_bad_116
s_waitcnt vmcnt(0)
v_cmp_gt_u32 vcc, s76, v26
s_nop 0
s_lshr_b64 s[58:59], vcc, s77
s_and_b32 s58, s58, s56
s_cbranch_scc0 sp_ok_115
s_sleep 1
s_branch sp_loop_114
sp_bad_116:
s_mov_b32 s98, 1027
s_branch L_fail
sp_ok_115:
s_barrier
s_add_u32 m0, s72, 0
s_nop 0
buffer_load_dwordx4 v8, s[4:7], s78 offen offset:0 sc1 lds
buffer_load_dwordx4 v9, s[4:7], s78 offen offset:1024 sc1 lds
buffer_load_dwordx4 v10, s[4:7], s78 offen offset:2048 sc1 lds
buffer_load_dwordx4 v11, s[4:7], s78 offen offset:3072 sc1 lds
s_add_u32 m0, s72, 4096
s_nop 0
buffer_load_dwordx4 v12, s[4:7], s78 offen offset:0 sc1 lds
buffer_load_dwordx4 v13, s[4:7], s78 offen offset:1024 sc1 lds
buffer_load_dwordx4 v14, s[4:7], s78 offen offset:2048 sc1 lds
buffer_load_dwordx4 v15, s[4:7], s78 offen offset:3072 sc1 lds
s_add_u32 m0, s72, 8192
s_nop 0
buffer_load_dwordx4 v16, s[4:7], s78 offen offset:0 sc1 lds
s_waitcnt vmcnt(0)
g_join_105:
s_barrier
ds_read_b128 v[64:67], v28 offset:0
ds_read_b128 v[68:71], v28 offset:9216
ds_read_b128 v[72:75], v28 offset:18432
ds_read_b128 v[76:79], v28 offset:27648
ds_read_b128 v[80:83], v28 offset:1024
ds_read_b128 v[84:87], v28 offset:10240
ds_read_b128 v[88:91], v28 offset:19456
ds_read_b128 v[92:95], v28 offset:28672
g_body_101:
s_waitcnt lgkmcnt(4)
v_mfma_f32_16x16x32_bf16 v[208:211], a[0:3], v[64:67], 0
ds_read_b128 v[96:99], v28 offset:2048
s_add_u32 m0, s73, 4096
v_mfma_f32_16x16x32_bf16 v[212:215], a[0:3], v[68:71], 0
ds_read_b128 v[100:103], v28 offset:11264
buffer_load_dwordx4 v12, s[8:11], s83 offen offset:0 sc1 lds
v_mfma_f32_16x16x32_bf16 v[216:219], a[72:75], v[64:67], 0
v_mfma_f32_16x16x32_bf16 v[208:211], a[4:7], v[72:75], v[208:211]
ds_read_b128 v[104:107], v28 offset:20480
v_cvt_pk_bf16_f32 v56, v224, v225
v_mfma_f32_16x16x32_bf16 v[212:215], a[4:7], v[76:79], v[212:215]
ds_read_b128 v[108:111], v28 offset:29696
buffer_load_dwordx4 v13, s[8:11], s83 offen offset:1024 sc1 lds
v_mfma_f32_16x16x32_bf16 v[220:223], a[72:75], v[68:71], 0
v_cvt_pk_bf16_f32 v57, v226, v227
s_waitcnt lgkmcnt(4)
v_mfma_f32_16x16x32_bf16 v[208:211], a[8:11], v[80:83], v[208:211]
ds_read_b128 v[112:115], v28 offset:3072
v_cvt_pk_bf16_f32 v58, v228, v229
v_mfma_f32_16x16x32_bf16 v[212:215], a[8:11], v[84:87], v[212:215]
ds_read_b128 v[116:119], v28 offset:12288
v_cvt_pk_bf16_f32 v59, v230, v231
v_mfma_f32_16x16x32_bf16 v[216:219], a[76:79], v[72:75], v[216:219]
buffer_load_dwordx4 v14, s[8:11], s83 offen offset:2048 sc1 lds
v_mfma_f32_16x16x32_bf16 v[208:211], a[12:15], v[88:91], v[208:211]
ds_read_b128 v[120:123], v28 offset:21504
v_permlane16_swap_b32 v56, v58
v_mfma_f32_16x16x32_bf16 v[212:215], a[12:15], v[92:95], v[212:215]
ds_read_b128 v[124:127], v28 offset:30720
v_permlane16_swap_b32 v57, v59
v_mfma_f32_16x16x32_bf16 v[220:223], a[76:79], v[76:79], v[220:223]
s_waitcnt lgkmcnt(4)
v_mfma_f32_16x16x32_bf16 v[208:211], a[16:19], v[96:99], v[208:211]
ds_read_b128 v[128:131], v28 offset:4096
buffer_load_dwordx4 v15, s[8:11], s83 offen offset:3072 sc1 lds
v_mfma_f32_16x16x32_bf16 v[212:215], a[16:19], v[100:103], v[212:215]
ds_read_b128 v[132:135], v28 offset:13312
v_mfma_f32_16x16x32_bf16 v[216:219], a[80:83], v[80:83], v[216:219]
buffer_store_dwordx4 v[56:59], v21, s[4:7], s94 offen sc1
v_mfma_f32_16x16x32_bf16 v[208:211], a[20:23], v[104:107], v[208:211]
ds_read_b128 v[136:139], v28 offset:22528
s_add_u32 m0, s73, 8192
v_mfma_f32_16x16x32_bf16 v[212:215], a[20:23], v[108:111], v[212:215]
ds_read_b128 v[140:143], v28 offset:31744
buffer_load_dwordx4 v16, s[8:11], s83 offen offset:0 sc1 lds
v_mfma_f32_16x16x32_bf16 v[220:223], a[80:83], v[84:87], v[220:223]
s_and_b32 s70, s52, 63
s_waitcnt lgkmcnt(4)
v_mfma_f32_16x16x32_bf16 v[208:211], a[24:27], v[112:115], v[208:211]
ds_read_b128 v[144:147], v28 offset:5120
v_mfma_f32_16x16x32_bf16 v[212:215], a[24:27], v[116:119], v[212:215]
ds_read_b128 v[148:151], v28 offset:14336
v_mfma_f32_16x16x32_bf16 v[216:219], a[84:87], v[88:91], v[216:219]
v_readlane_b32 s86, v36, s70
v_mfma_f32_16x16x32_bf16 v[208:211], a[28:31], v[120:123], v[208:211]
ds_read_b128 v[152:155], v28 offset:23552
v_mfma_f32_16x16x32_bf16 v[212:215], a[28:31], v[124:127], v[212:215]
ds_read_b128 v[156:159], v28 offset:32768
v_mfma_f32_16x16x32_bf16 v[220:223], a[84:87], v[92:95], v[220:223]
s_waitcnt lgkmcnt(4)
v_mfma_f32_16x16x32_bf16 v[208:211], a[32:35], v[128:131], v[208:211]
ds_read_b128 v[160:163], v28 offset:6144
v_mfma_f32_16x16x32_bf16 v[212:215], a[32:35], v[132:135], v[212:215]
ds_read_b128 v[164:167], v28 offset:15360
v_mfma_f32_16x16x32_bf16 v[216:219], a[88:91], v[96:99], v[216:219]
v_readlane_b32 s87, v37, s70
v_mfma_f32_16x16x32_bf16 v[208:211], a[36:39], v[136:139], v[208:211]
ds_read_b128 v[168:171], v28 offset:24576
v_mfma_f32_16x16x32_bf16 v[212:215], a[36:39], v[140:143], v[212:215]
ds_read_b128 v[172:175], v28 offset:33792
v_mfma_f32_16x16x32_bf16 v[220:223], a[88:91], v[100:103], v[220:223]
s_waitcnt lgkmcnt(4)
v_mfma_f32_16x16x32_bf16 v[208:211], a[40:43], v[144:147], v[208:211]
ds_read_b128 v[176:179], v28 offset:7168
v_mfma_f32_16x16x32_bf16 v[212:215], a[40:43], v[148:151], v[212:215]
ds_read_b128 v[180:183], v28 offset:16384
v_mfma_f32_16x16x32_bf16 v[216:219], a[92:95], v[104:107], v[216:219]
v_readlane_b32 s88, v38, s70
v_mfma_f32_16x16x32_bf16 v[208:211], a[44:47], v[152:155], v[208:211]
ds_read_b128 v[184:187], v28 offset:25600
v_mfma_f32_16x16x32_bf16 v[212:215], a[44:47], v[156:159], v[212:215]
ds_read_b128 v[188:191], v28 offset:34816
v_mfma_f32_16x16x32_bf16 v[220:223], a[92:95], v[108:111], v[220:223]
s_waitcnt lgkmcnt(4)
v_mfma_f32_16x16x32_bf16 v[208:211], a[48:51], v[160:163], v[208:211]
ds_read_b128 v[192:195], v28 offset:8192
v_mfma_f32_16x16x32_bf16 v[212:215], a[48:51], v[164:167], v[212:215]
ds_read_b128 v[196:199], v28 offset:17408
v_mfma_f32_16x16x32_bf16 v[216:219], a[96:99], v[112:115], v[216:219]
buffer_load_dword v24, v22, s[4:7], 0 offen sc1
v_mfma_f32_16x16x32_bf16 v[208:211], a[52:55], v[168:171], v[208:211]
ds_read_b128 v[200:203], v28 offset:26624
v_mfma_f32_16x16x32_bf16 v[212:215], a[52:55], v[172:175], v[212:215]
ds_read_b128 v[204:207], v28 offset:35840
v_mfma_f32_16x16x32_bf16 v[220:223], a[96:99], v[116:119], v[220:223]
s_waitcnt lgkmcnt(4)
v_mfma_f32_16x16x32_bf16 v[208:211], a[56:59], v[176:179], v[208:211]
v_readlane_b32 s89, v39, s70
v_mfma_f32_16x16x32_bf16 v[212:215], a[56:59], v[180:183], v[212:215]
s_add_u32 s52, s52, 1
v_mov_b32 v27, s91
v_mfma_f32_16x16x32_bf16 v[216:219], a[100:103], v[120:123], v[216:219]
s_lshl_b32 s70, s92, 10
v_mfma_f32_16x16x32_bf16 v[208:211], a[60:63], v[184:187], v[208:211]
v_mfma_f32_16x16x32_bf16 v[212:215], a[60:63], v[188:191], v[212:215]
v_mfma_f32_16x16x32_bf16 v[220:223], a[100:103], v[124:127], v[220:223]
s_waitcnt lgkmcnt(0)
v_mfma_f32_16x16x32_bf16 v[208:211], a[64:67], v[192:195], v[208:211]
v_mfma_f32_16x16x32_bf16 v[212:215], a[64:67], v[196:199], v[212:215]
v_mfma_f32_16x16x32_bf16 v[216:219], a[104:107], v[128:131], v[216:219]
v_mfma_f32_16x16x32_bf16 v[208:211], a[68:71], v[200:203], v[208:211]
v_mfma_f32_16x16x32_bf16 v[212:215], a[68:71], v[204:207], v[212:215]
v_mfma_f32_16x16x32_bf16 v[220:223], a[104:107], v[132:135], v[220:223]
v_mfma_f32_16x16x32_bf16 v[216:219], a[108:111], v[136:139], v[216:219]
v_mfma_f32_16x16x32_bf16 v[220:223], a[108:111], v[140:143], v[220:223]
v_mfma_f32_16x16x32_bf16 v[224:227], a[144:147], v[64:67], 0
v_mfma_f32_16x16x32_bf16 v[216:219], a[112:115], v[144:147], v[216:219]
v_mfma_f32_16x16x32_bf16 v[220:223], a[112:115], v[148:151], v[220:223]
s_nop 0
v_cvt_pk_bf16_f32 v48, v208, v209
v_cvt_pk_bf16_f32 v49, v210, v211
v_mfma_f32_16x16x32_bf16 v[228:231], a[144:147], v[68:71], 0
v_cvt_pk_bf16_f32 v50, v212, v213
v_cvt_pk_bf16_f32 v51, v214, v215
v_mfma_f32_16x16x32_bf16 v[216:219], a[116:119], v[152:155], v[216:219]
v_permlane16_swap_b32 v48, v50
v_mfma_f32_16x16x32_bf16 v[220:223], a[116:119], v[156:159], v[220:223]
v_permlane16_swap_b32 v49, v51
v_mfma_f32_16x16x32_bf16 v[224:227], a[148:151], v[72:75], v[224:227]
buffer_store_dwordx4 v[48:51], v19, s[4:7], s79 offen sc1
v_mfma_f32_16x16x32_bf16 v[216:219], a[120:123], v[160:163], v[216:219]
v_mfma_f32_16x16x32_bf16 v[220:223], a[120:123], v[164:167], v[220:223]
v_mfma_f32_16x16x32_bf16 v[228:231], a[148:151], v[76:79], v[228:231]
v_mfma_f32_16x16x32_bf16 v[216:219], a[124:127], v[168:171], v[216:219]
v_mfma_f32_16x16x32_bf16 v[220:223], a[124:127], v[172:175], v[220:223]
v_mfma_f32_16x16x32_bf16 v[224:227], a[152:155], v[80:83], v[224:227]
v_mfma_f32_16x16x32_bf16 v[216:219], a[128:131], v[176:179], v[216:219]
v_mfma_f32_16x16x32_bf16 v[220:223], a[128:131], v[180:183], v[220:223]
v_mfma_f32_16x16x32_bf16 v[228:231], a[152:155], v[84:87], v[228:231]
v_mfma_f32_16x16x32_bf16 v[216:219], a[132:135], v[184:187], v[216:219]
v_mfma_f32_16x16x32_bf16 v[220:223], a[132:135], v[188:191], v[220:223]
v_mfma_f32_16x16x32_bf16 v[224:227], a[156:159], v[88:91], v[224:227]
v_mfma_f32_16x16x32_bf16 v[216:219], a[136:139], v[192:195], v[216:219]
v_mfma_f32_16x16x32_bf16 v[220:223], a[136:139], v[196:199], v[220:223]
v_mfma_f32_16x16x32_bf16 v[228:231], a[156:159], v[92:95], v[228:231]
v_mfma_f32_16x16x32_bf16 v[216:219], a[140:143], v[200:203], v[216:219]
v_mfma_f32_16x16x32_bf16 v[220:223], a[140:143], v[204:207], v[220:223]
v_mfma_f32_16x16x32_bf16 v[224:227], a[160:163], v[96:99], v[224:227]
v_mfma_f32_16x16x32_bf16 v[228:231], a[160:163], v[100:103], v[228:231]
s_waitcnt vmcnt(1)
ds_write_b32 v18, v24
v_mfma_f32_16x16x32_bf16 v[224:227], a[164:167], v[104:107], v[224:227]
v_mfma_f32_16x16x32_bf16 v[228:231], a[164:167], v[108:111], v[228:231]
v_mfma_f32_16x16x32_bf16 v[224:227], a[168:171], v[112:115], v[224:227]
s_waitcnt lgkmcnt(0)
s_barrier
v_mfma_f32_16x16x32_bf16 v[228:231], a[168:171], v[116:119], v[228:231]
ds_read_b32 v33, v32
v_cvt_pk_bf16_f32 v52, v216, v217
v_mfma_f32_16x16x32_bf16 v[224:227], a[172:175], v[120:123], v[224:227]
buffer_store_dword v27, v45, s[4:7], s70 offen
v_mfma_f32_16x16x32_bf16 v[228:231], a[172:175], v[124:127], v[228:231]
buffer_store_dword v27, v44, s[4:7], s70 offen sc1
v_mfma_f32_16x16x32_bf16 v[224:227], a[176:179], v[128:131], v[224:227]
s_waitcnt lgkmcnt(0)
v_cmp_gt_u32 vcc, s86, v33
v_mfma_f32_16x16x32_bf16 v[228:231], a[176:179], v[132:135], v[228:231]
s_lshr_b64 s[58:59], vcc, s87
s_and_b32 s58, s58, s56
s_cselect_b32 s10, 0, 268435456
s_cselect_b32 s90, 0, 1
v_mfma_f32_16x16x32_bf16 v[224:227], a[180:183], v[136:139], v[224:227]
s_cmp_eq_u32 s85, 0
s_cbranch_scc1 g_slow_117
v_mfma_f32_16x16x32_bf16 v[228:231], a[180:183], v[140:143], v[228:231]
s_add_u32 m0, s74, 0
v_cvt_pk_bf16_f32 v53, v218, v219
v_mfma_f32_16x16x32_bf16 v[224:227], a[184:187], v[144:147], v[224:227]
buffer_load_dwordx4 v8, s[8:11], s88 offen offset:0 sc1 lds
v_mfma_f32_16x16x32_bf16 v[228:231], a[184:187], v[148:151], v[228:231]
v_cvt_pk_bf16_f32 v54, v220, v221
v_cvt_pk_bf16_f32 v55, v222, v223
v_mfma_f32_16x16x32_bf16 v[224:227], a[188:191], v[152:155], v[224:227]
v_permlane16_swap_b32 v52, v54
v_mfma_f32_16x16x32_bf16 v[228:231], a[188:191], v[156:159], v[228:231]
v_permlane16_swap_b32 v53, v55
v_mfma_f32_16x16x32_bf16 v[224:227], a[192:195], v[160:163], v[224:227]
buffer_load_dwordx4 v9, s[8:11], s88 offen offset:1024 sc1 lds
v_mfma_f32_16x16x32_bf16 v[228:231], a[192:195], v[164:167], v[228:231]
buffer_store_dwordx4 v[52:55], v20, s[4:7], s79 offen sc1
v_mfma_f32_16x16x32_bf16 v[224:227], a[196:199], v[168:171], v[224:227]
ds_read_b128 v[64:67], v29 offset:0
v_mfma_f32_16x16x32_bf16 v[228:231], a[196:199], v[172:175], v[228:231]
ds_read_b128 v[68:71], v29 offset:9216
v_mfma_f32_16x16x32_bf16 v[224:227], a[200:203], v[176:179], v[224:227]
buffer_load_dwordx4 v10, s[8:11], s88 offen offset:2048 sc1 lds
ds_read_b128 v[72:75], v29 offset:18432
v_mfma_f32_16x16x32_bf16 v[228:231], a[200:203], v[180:183], v[228:231]
ds_read_b128 v[76:79], v29 offset:27648
v_mfma_f32_16x16x32_bf16 v[224:227], a[204:207], v[184:187], v[224:227]
ds_read_b128 v[80:83], v29 offset:1024
v_mfma_f32_16x16x32_bf16 v[228:231], a[204:207], v[188:191], v[228:231]
ds_read_b128 v[84:87], v29 offset:10240
v_mfma_f32_16x16x32_bf16 v[224:227], a[208:211], v[192:195], v[224:227]
buffer_load_dwordx4 v11, s[8:11], s88 offen offset:3072 sc1 lds
ds_read_b128 v[88:91], v29 offset:19456
v_mfma_f32_16x16x32_bf16 v[228:231], a[208:211], v[196:199], v[228:231]
ds_read_b128 v[92:95], v29 offset:28672
v_mfma_f32_16x16x32_bf16 v[224:227], a[212:215], v[200:203], v[224:227]
v_mfma_f32_16x16x32_bf16 v[228:231], a[212:215], v[204:207], v[228:231]
g_body_102:
s_waitcnt lgkmcnt(4)
v_mfma_f32_16x16x32_bf16 v[208:211], a[0:3], v[64:67], 0
ds_read_b128 v[96:99], v29 offset:2048
s_add_u32 m0, s74, 4096
v_mfma_f32_16x16x32_bf16 v[212:215], a[0:3], v[68:71], 0
ds_read_b128 v[100:103], v29 offset:11264
buffer_load_dwordx4 v12, s[8:11], s88 offen offset:0 sc1 lds
v_mfma_f32_16x16x32_bf16 v[216:219], a[72:75], v[64:67], 0
v_mfma_f32_16x16x32_bf16 v[208:211], a[4:7], v[72:75], v[208:211]
ds_read_b128 v[104:107], v29 offset:20480
v_cvt_pk_bf16_f32 v56, v224, v225
v_mfma_f32_16x16x32_bf16 v[212:215], a[4:7], v[76:79], v[212:215]
ds_read_b128 v[108:111], v29 offset:29696
buffer_load_dwordx4 v13, s[8:11], s88 offen offset:1024 sc1 lds
v_mfma_f32_16x16x32_bf16 v[220:223], a[72:75], v[68:71], 0
v_cvt_pk_bf16_f32 v57, v226, v227
s_waitcnt lgkmcnt(4)
v_mfma_f32_16x16x32_bf16 v[208:211], a[8:11], v[80:83], v[208:211]
ds_read_b128 v[112:115], v29 offset:3072
v_cvt_pk_bf16_f32 v58, v228, v229
v_mfma_f32_16x16x32_bf16 v[212:215], a[8:11], v[84:87], v[212:215]
ds_read_b128 v[116:119], v29 offset:12288
v_cvt_pk_bf16_f32 v59, v230, v231
v_mfma_f32_16x16x32_bf16 v[216:219], a[76:79], v[72:75], v[216:219]
buffer_load_dwordx4 v14, s[8:11], s88 offen offset:2048 sc1 lds
v_mfma_f32_16x16x32_bf16 v[208:211], a[12:15], v[88:91], v[208:211]
ds_read_b128 v[120:123], v29 offset:21504
v_permlane16_swap_b32 v56, v58
v_mfma_f32_16x16x32_bf16 v[212:215], a[12:15], v[92:95], v[212:215]
ds_read_b128 v[124:127], v29 offset:30720
v_permlane16_swap_b32 v57, v59
v_mfma_f32_16x16x32_bf16 v[220:223], a[76:79], v[76:79], v[220:223]
s_waitcnt lgkmcnt(4)
v_mfma_f32_16x16x32_bf16 v[208:211], a[16:19], v[96:99], v[208:211]
ds_read_b128 v[128:131], v29 offset:4096
buffer_load_dwordx4 v15, s[8:11], s88 offen offset:3072 sc1 lds
v_mfma_f32_16x16x32_bf16 v[212:215], a[16:19], v[100:103], v[212:215]
ds_read_b128 v[132:135], v29 offset:13312
v_mfma_f32_16x16x32_bf16 v[216:219], a[80:83], v[80:83], v[216:219]
buffer_store_dwordx4 v[56:59], v21, s[4:7], s79 offen sc1
v_mfma_f32_16x16x32_bf16 v[208:211], a[20:23], v[104:107], v[208:211]
ds_read_b128 v[136:139], v29 offset:22528
s_add_u32 m0, s74, 8192
v_mfma_f32_16x16x32_bf16 v[212:215], a[20:23], v[108:111], v[212:215]
ds_read_b128 v[140:143], v29 offset:31744
buffer_load_dwordx4 v16, s[8:11], s88 offen offset:0 sc1 lds
v_mfma_f32_16x16x32_bf16 v[220:223], a[80:83], v[84:87], v[220:223]
s_and_b32 s70, s52, 63
s_waitcnt lgkmcnt(4)
v_mfma_f32_16x16x32_bf16 v[208:211], a[24:27], v[112:115], v[208:211]
ds_read_b128 v[144:147], v29 offset:5120
v_mfma_f32_16x16x32_bf16 v[212:215], a[24:27], v[116:119], v[212:215]
ds_read_b128 v[148:151], v29 offset:14336
v_mfma_f32_16x16x32_bf16 v[216:219], a[84:87], v[88:91], v[216:219]
v_readlane_b32 s91, v36, s70
v_mfma_f32_16x16x32_bf16 v[208:211], a[28:31], v[120:123], v[208:211]
ds_read_b128 v[152:155], v29 offset:23552
v_mfma_f32_16x16x32_bf16 v[212:215], a[28:31], v[124:127], v[212:215]
ds_read_b128 v[156:159], v29 offset:32768
v_mfma_f32_16x16x32_bf16 v[220:223], a[84:87], v[92:95], v[220:223]
s_waitcnt lgkmcnt(4)
v_mfma_f32_16x16x32_bf16 v[208:211], a[32:35], v[128:131], v[208:211]
ds_read_b128 v[160:163], v29 offset:6144
v_mfma_f32_16x16x32_bf16 v[212:215], a[32:35], v[132:135], v[212:215]
ds_read_b128 v[164:167], v29 offset:15360
v_mfma_f32_16x16x32_bf16 v[216:219], a[88:91], v[96:99], v[216:219]
v_readlane_b32 s92, v37, s70
v_mfma_f32_16x16x32_bf16 v[208:211], a[36:39], v[136:139], v[208:211]
ds_read_b128 v[168:171], v29 offset:24576
v_mfma_f32_16x16x32_bf16 v[212:215], a[36:39], v[140:143], v[212:215]
ds_read_b128 v[172:175], v29 offset:33792
v_mfma_f32_16x16x32_bf16 v[220:223], a[88:91], v[100:103], v[220:223]
s_waitcnt lgkmcnt(4)
v_mfma_f32_16x16x32_bf16 v[208:211], a[40:43], v[144:147], v[208:211]
ds_read_b128 v[176:179], v29 offset:7168
v_mfma_f32_16x16x32_bf16 v[212:215], a[40:43], v[148:151], v[212:215]
ds_read_b128 v[180:183], v29 offset:16384
v_mfma_f32_16x16x32_bf16 v[216:219], a[92:95], v[104:107], v[216:219]
v_readlane_b32 s93, v38, s70
v_mfma_f32_16x16x32_bf16 v[208:211], a[44:47], v[152:155], v[208:211]
ds_read_b128 v[184:187], v29 offset:25600
v_mfma_f32_16x16x32_bf16 v[212:215], a[44:47], v[156:159], v[212:215]
ds_read_b128 v[188:191], v29 offset:34816
v_mfma_f32_16x16x32_bf16 v[220:223], a[92:95], v[108:111], v[220:223]
s_waitcnt lgkmcnt(4)
v_mfma_f32_16x16x32_bf16 v[208:211], a[48:51], v[160:163], v[208:211]
ds_read_b128 v[192:195], v29 offset:8192
v_mfma_f32_16x16x32_bf16 v[212:215], a[48:51], v[164:167], v[212:215]
ds_read_b128 v[196:199], v29 offset:17408
v_mfma_f32_16x16x32_bf16 v[216:219], a[96:99], v[112:115], v[216:219]
buffer_load_dword v24, v22, s[4:7], 0 offen sc1
v_mfma_f32_16x16x32_bf16 v[208:211], a[52:55], v[168:171], v[208:211]
ds_read_b128 v[200:203], v29 offset:26624
v_mfma_f32_16x16x32_bf16 v[212:215], a[52:55], v[172:175], v[212:215]
ds_read_b128 v[204:207], v29 offset:35840
v_mfma_f32_16x16x32_bf16 v[220:223], a[96:99], v[116:119], v[220:223]
s_waitcnt lgkmcnt(4)
v_mfma_f32_16x16x32_bf16 v[208:211], a[56:59], v[176:179], v[208:211]
v_readlane_b32 s94, v39, s70
v_mfma_f32_16x16x32_bf16 v[212:215], a[56:59], v[180:183], v[212:215]
s_add_u32 s52, s52, 1
v_mov_b32 v27, s76
v_mfma_f32_16x16x32_bf16 v[216:219], a[100:103], v[120:123], v[216:219]
s_lshl_b32 s70, s77, 10
v_mfma_f32_16x16x32_bf16 v[208:211], a[60:63], v[184:187], v[208:211]
v_mfma_f32_16x16x32_bf16 v[212:215], a[60:63], v[188:191], v[212:215]
v_mfma_f32_16x16x32_bf16 v[220:223], a[100:103], v[124:127], v[220:223]
s_waitcnt lgkmcnt(0)
v_mfma_f32_16x16x32_bf16 v[208:211], a[64:67], v[192:195], v[208:211]
v_mfma_f32_16x16x32_bf16 v[212:215], a[64:67], v[196:199], v[212:215]
v_mfma_f32_16x16x32_bf16 v[216:219], a[104:107], v[128:131], v[216:219]
v_mfma_f32_16x16x32_bf16 v[208:211], a[68:71], v[200:203], v[208:211]
v_mfma_f32_16x16x32_bf16 v[212:215], a[68:71], v[204:207], v[212:215]
v_mfma_f32_16x16x32_bf16 v[220:223], a[104:107], v[132:135], v[220:223]
v_mfma_f32_16x16x32_bf16 v[216:219], a[108:111], v[136:139], v[216:219]
v_mfma_f32_16x16x32_bf16 v[220:223], a[108:111], v[140:143], v[220:223]
v_mfma_f32_16x16x32_bf16 v[224:227], a[144:147], v[64:67], 0
v_mfma_f32_16x16x32_bf16 v[216:219], a[112:115], v[144:147], v[216:219]
v_mfma_f32_16x16x32_bf16 v[220:223], a[112:115], v[148:151], v[220:223]
s_nop 0
v_cvt_pk_bf16_f32 v48, v208, v209
v_cvt_pk_bf16_f32 v49, v210, v211
v_mfma_f32_16x16x32_bf16 v[228:231], a[144:147], v[68:71], 0
v_cvt_pk_bf16_f32 v50, v212, v213
v_cvt_pk_bf16_f32 v51, v214, v215
v_mfma_f32_16x16x32_bf16 v[216:219], a[116:119], v[152:155], v[216:219]
v_permlane16_swap_b32 v48, v50
v_mfma_f32_16x16x32_bf16 v[220:223], a[116:119], v[156:159], v[220:223]
v_permlane16_swap_b32 v49, v51
v_mfma_f32_16x16x32_bf16 v[224:227], a[148:151], v[72:75], v[224:227]
buffer_store_dwordx4 v[48:51], v19, s[4:7], s84 offen sc1
v_mfma_f32_16x16x32_bf16 v[216:219], a[120:123], v[160:163], v[216:219]
v_mfma_f32_16x16x32_bf16 v[220:223], a[120:123], v[164:167], v[220:223]
v_mfma_f32_16x16x32_bf16 v[228:231], a[148:151], v[76:79], v[228:231]
v_mfma_f32_16x16x32_bf16 v[216:219], a[124:127], v[168:171], v[216:219]
v_mfma_f32_16x16x32_bf16 v[220:223], a[124:127], v[172:175], v[220:223]
v_mfma_f32_16x16x32_bf16 v[224:227], a[152:155], v[80:83], v[224:227]
v_mfma_f32_16x16x32_bf16 v[216:219], a[128:131], v[176:179], v[216:219]
v_mfma_f32_16x16x32_bf16 v[220:223], a[128:131], v[180:183], v[220:223]
v_mfma_f32_16x16x32_bf16 v[228:231], a[152:155], v[84:87], v[228:231]
v_mfma_f32_16x16x32_bf16 v[216:219], a[132:135], v[184:187], v[216:219]
v_mfma_f32_16x16x32_bf16 v[220:223], a[132:135], v[188:191], v[220:223]
v_mfma_f32_16x16x32_bf16 v[224:227], a[156:159], v[88:91], v[224:227]
v_mfma_f32_16x16x32_bf16 v[216:219], a[136:139], v[192:195], v[216:219]
v_mfma_f32_16x16x32_bf16 v[220:223], a[136:139], v[196:199], v[220:223]
v_mfma_f32_16x16x32_bf16 v[228:231], a[156:159], v[92:95], v[228:231]
v_mfma_f32_16x16x32_bf16 v[216:219], a[140:143], v[200:203], v[216:219]
v_mfma_f32_16x16x32_bf16 v[220:223], a[140:143], v[204:207], v[220:223]
v_mfma_f32_16x16x32_bf16 v[224:227], a[160:163], v[96:99], v[224:227]
v_mfma_f32_16x16x32_bf16 v[228:231], a[160:163], v[100:103], v[228:231]
s_waitcnt vmcnt(1)
ds_write_b32 v18, v24
v_mfma_f32_16x16x32_bf16 v[224:227], a[164:167], v[104:107], v[224:227]
v_mfma_f32_16x16x32_bf16 v[228:231], a[164:167], v[108:111], v[228:231]
v_mfma_f32_16x16x32_bf16 v[224:227], a[168:171], v[112:115], v[224:227]
s_waitcnt lgkmcnt(0)
s_barrier
v_mfma_f32_16x16x32_bf16 v[228:231], a[168:171], v[116:119], v[228:231]
ds_read_b32 v33, v32
v_cvt_pk_bf16_f32 v52, v216, v217
v_mfma_f32_16x16x32_bf16 v[224:227], a[172:175], v[120:123], v[224:227]
buffer_store_dword v27, v45, s[4:7], s70 offen
v_mfma_f32_16x16x32_bf16 v[228:231], a[172:175], v[124:127], v[228:231]
buffer_store_dword v27, v44, s[4:7], s70 offen sc1
v_mfma_f32_16x16x32_bf16 v[224:227], a[176:179], v[128:131], v[224:227]
s_waitcnt lgkmcnt(0)
v_cmp_gt_u32 vcc, s91, v33
v_mfma_f32_16x16x32_bf16 v[228:231], a[176:179], v[132:135], v[228:231]
s_lshr_b64 s[58:59], vcc, s92
s_and_b32 s58, s58, s56
s_cselect_b32 s10, 0, 268435456
s_cselect_b32 s95, 0, 1
v_mfma_f32_16x16x32_bf16 v[224:227], a[180:183], v[136:139], v[224:227]
s_cmp_eq_u32 s90, 0
s_cbranch_scc1 g_slow_118
v_mfma_f32_16x16x32_bf16 v[228:231], a[180:183], v[140:143], v[228:231]
s_add_u32 m0, s75, 0
v_cvt_pk_bf16_f32 v53, v218, v219
v_mfma_f32_16x16x32_bf16 v[224:227], a[184:187], v[144:147], v[224:227]
buffer_load_dwordx4 v8, s[8:11], s93 offen offset:0 sc1 lds
v_mfma_f32_16x16x32_bf16 v[228:231], a[184:187], v[148:151], v[228:231]
v_cvt_pk_bf16_f32 v54, v220, v221
v_cvt_pk_bf16_f32 v55, v222, v223
v_mfma_f32_16x16x32_bf16 v[224:227], a[188:191], v[152:155], v[224:227]
v_permlane16_swap_b32 v52, v54
v_mfma_f32_16x16x32_bf16 v[228:231], a[188:191], v[156:159], v[228:231]
v_permlane16_swap_b32 v53, v55
v_mfma_f32_16x16x32_bf16 v[224:227], a[192:195], v[160:163], v[224:227]
buffer_load_dwordx4 v9, s[8:11], s93 offen offset:1024 sc1 lds
v_mfma_f32_16x16x32_bf16 v[228:231], a[192:195], v[164:167], v[228:231]
buffer_store_dwordx4 v[52:55], v20, s[4:7], s84 offen sc1
v_mfma_f32_16x16x32_bf16 v[224:227], a[196:199], v[168:171], v[224:227]
ds_read_b128 v[64:67], v30 offset:0
v_mfma_f32_16x16x32_bf16 v[228:231], a[196:199], v[172:175], v[228:231]
ds_read_b128 v[68:71], v30 offset:9216
v_mfma_f32_16x16x32_bf16 v[224:227], a[200:203], v[176:179], v[224:227]
buffer_load_dwordx4 v10, s[8:11], s93 offen offset:2048 sc1 lds
ds_read_b128 v[72:75], v30 offset:18432
v_mfma_f32_16x16x32_bf16 v[228:231], a[200:203], v[180:183], v[228:231]
ds_read_b128 v[76:79], v30 offset:27648
v_mfma_f32_16x16x32_bf16 v[224:227], a[204:207], v[184:187], v[224:227]
ds_read_b128 v[80:83], v30 offset:1024
v_mfma_f32_16x16x32_bf16 v[228:231], a[204:207], v[188:191], v[228:231]
ds_read_b128 v[84:87], v30 offset:10240
v_mfma_f32_16x16x32_bf16 v[224:227], a[208:211], v[192:195], v[224:227]
buffer_load_dwordx4 v11, s[8:11], s93 offen offset:3072 sc1 lds
ds_read_b128 v[88:91], v30 offset:19456
v_mfma_f32_16x16x32_bf16 v[228:231], a[208:211], v[196:199], v[228:231]
ds_read_b128 v[92:95], v30 offset:28672
v_mfma_f32_16x16x32_bf16 v[224:227], a[212:215], v[200:203], v[224:227]
v_mfma_f32_16x16x32_bf16 v[228:231], a[212:215], v[204:207], v[228:231]
g_body_103:
s_waitcnt lgkmcnt(4)
v_mfma_f32_16x16x32_bf16 v[208:211], a[0:3], v[64:67], 0
ds_read_b128 v[96:99], v30 offset:2048
s_add_u32 m0, s75, 4096
v_mfma_f32_16x16x32_bf16 v[212:215], a[0:3], v[68:71], 0
ds_read_b128 v[100:103], v30 offset:11264
buffer_load_dwordx4 v12, s[8:11], s93 offen offset:0 sc1 lds
v_mfma_f32_16x16x32_bf16 v[216:219], a[72:75], v[64:67], 0
v_mfma_f32_16x16x32_bf16 v[208:211], a[4:7], v[72:75], v[208:211]
ds_read_b128 v[104:107], v30 offset:20480
v_cvt_pk_bf16_f32 v56, v224, v225
v_mfma_f32_16x16x32_bf16 v[212:215], a[4:7], v[76:79], v[212:215]
ds_read_b128 v[108:111], v30 offset:29696
buffer_load_dwordx4 v13, s[8:11], s93 offen offset:1024 sc1 lds
v_mfma_f32_16x16x32_bf16 v[220:223], a[72:75], v[68:71], 0
v_cvt_pk_bf16_f32 v57, v226, v227
s_waitcnt lgkmcnt(4)
v_mfma_f32_16x16x32_bf16 v[208:211], a[8:11], v[80:83], v[208:211]
ds_read_b128 v[112:115], v30 offset:3072
v_cvt_pk_bf16_f32 v58, v228, v229
v_mfma_f32_16x16x32_bf16 v[212:215], a[8:11], v[84:87], v[212:215]
ds_read_b128 v[116:119], v30 offset:12288
v_cvt_pk_bf16_f32 v59, v230, v231
v_mfma_f32_16x16x32_bf16 v[216:219], a[76:79], v[72:75], v[216:219]
buffer_load_dwordx4 v14, s[8:11], s93 offen offset:2048 sc1 lds
v_mfma_f32_16x16x32_bf16 v[208:211], a[12:15], v[88:91], v[208:211]
ds_read_b128 v[120:123], v30 offset:21504
v_permlane16_swap_b32 v56, v58
v_mfma_f32_16x16x32_bf16 v[212:215], a[12:15], v[92:95], v[212:215]
ds_read_b128 v[124:127], v30 offset:30720
v_permlane16_swap_b32 v57, v59
v_mfma_f32_16x16x32_bf16 v[220:223], a[76:79], v[76:79], v[220:223]
s_waitcnt lgkmcnt(4)
v_mfma_f32_16x16x32_bf16 v[208:211], a[16:19], v[96:99], v[208:211]
ds_read_b128 v[128:131], v30 offset:4096
buffer_load_dwordx4 v15, s[8:11], s93 offen offset:3072 sc1 lds
v_mfma_f32_16x16x32_bf16 v[212:215], a[16:19], v[100:103], v[212:215]
ds_read_b128 v[132:135], v30 offset:13312
v_mfma_f32_16x16x32_bf16 v[216:219], a[80:83], v[80:83], v[216:219]
buffer_store_dwordx4 v[56:59], v21, s[4:7], s84 offen sc1
v_mfma_f32_16x16x32_bf16 v[208:211], a[20:23], v[104:107], v[208:211]
ds_read_b128 v[136:139], v30 offset:22528
s_add_u32 m0, s75, 8192
v_mfma_f32_16x16x32_bf16 v[212:215], a[20:23], v[108:111], v[212:215]
ds_read_b128 v[140:143], v30 offset:31744
buffer_load_dwordx4 v16, s[8:11], s93 offen offset:0 sc1 lds
v_mfma_f32_16x16x32_bf16 v[220:223], a[80:83], v[84:87], v[220:223]
s_and_b32 s70, s52, 63
s_waitcnt lgkmcnt(4)
v_mfma_f32_16x16x32_bf16 v[208:211], a[24:27], v[112:115], v[208:211]
ds_read_b128 v[144:147], v30 offset:5120
v_mfma_f32_16x16x32_bf16 v[212:215], a[24:27], v[116:119], v[212:215]
ds_read_b128 v[148:151], v30 offset:14336
v_mfma_f32_16x16x32_bf16 v[216:219], a[84:87], v[88:91], v[216:219]
v_readlane_b32 s76, v36, s70
v_mfma_f32_16x16x32_bf16 v[208:211], a[28:31], v[120:123], v[208:211]
ds_read_b128 v[152:155], v30 offset:23552
v_mfma_f32_16x16x32_bf16 v[212:215], a[28:31], v[124:127], v[212:215]
ds_read_b128 v[156:159], v30 offset:32768
v_mfma_f32_16x16x32_bf16 v[220:223], a[84:87], v[92:95], v[220:223]
s_waitcnt lgkmcnt(4)
v_mfma_f32_16x16x32_bf16 v[208:211], a[32:35], v[128:131], v[208:211]
ds_read_b128 v[160:163], v30 offset:6144
v_mfma_f32_16x16x32_bf16 v[212:215], a[32:35], v[132:135], v[212:215]
ds_read_b128 v[164:167], v30 offset:15360
v_mfma_f32_16x16x32_bf16 v[216:219], a[88:91], v[96:99], v[216:219]
v_readlane_b32 s77, v37, s70
v_mfma_f32_16x16x32_bf16 v[208:211], a[36:39], v[136:139], v[208:211]
ds_read_b128 v[168:171], v30 offset:24576
v_mfma_f32_16x16x32_bf16 v[212:215], a[36:39], v[140:143], v[212:215]
ds_read_b128 v[172:175], v30 offset:33792
v_mfma_f32_16x16x32_bf16 v[220:223], a[88:91], v[100:103], v[220:223]
s_waitcnt lgkmcnt(4)
v_mfma_f32_16x16x32_bf16 v[208:211], a[40:43], v[144:147], v[208:211]
ds_read_b128 v[176:179], v30 offset:7168
v_mfma_f32_16x16x32_bf16 v[212:215], a[40:43], v[148:151], v[212:215]
ds_read_b128 v[180:183], v30 offset:16384
v_mfma_f32_16x16x32_bf16 v[216:219], a[92:95], v[104:107], v[216:219]
v_readlane_b32 s78, v38, s70
v_mfma_f32_16x16x32_bf16 v[208:211], a[44:47], v[152:155], v[208:211]
ds_read_b128 v[184:187], v30 offset:25600
v_mfma_f32_16x16x32_bf16 v[212:215], a[44:47], v[156:159], v[212:215]
ds_read_b128 v[188:191], v30 offset:34816
v_mfma_f32_16x16x32_bf16 v[220:223], a[92:95], v[108:111], v[220:223]
s_waitcnt lgkmcnt(4)
v_mfma_f32_16x16x32_bf16 v[208:211], a[48:51], v[160:163], v[208:211]
ds_read_b128 v[192:195], v30 offset:8192
v_mfma_f32_16x16x32_bf16 v[212:215], a[48:51], v[164:167], v[212:215]
ds_read_b128 v[196:199], v30 offset:17408
v_mfma_f32_16x16x32_bf16 v[216:219], a[96:99], v[112:115], v[216:219]
buffer_load_dword v24, v22, s[4:7], 0 offen sc1
v_mfma_f32_16x16x32_bf16 v[208:211], a[52:55], v[168:171], v[208:211]
ds_read_b128 v[200:203], v30 offset:26624
v_mfma_f32_16x16x32_bf16 v[212:215], a[52:55], v[172:175], v[212:215]
ds_read_b128 v[204:207], v30 offset:35840
v_mfma_f32_16x16x32_bf16 v[220:223], a[96:99], v[116:119], v[220:223]
s_waitcnt lgkmcnt(4)
v_mfma_f32_16x16x32_bf16 v[208:211], a[56:59], v[176:179], v[208:211]
v_readlane_b32 s79, v39, s70
v_mfma_f32_16x16x32_bf16 v[212:215], a[56:59], v[180:183], v[212:215]
s_add_u32 s52, s52, 1
v_mov_b32 v27, s81
v_mfma_f32_16x16x32_bf16 v[216:219], a[100:103], v[120:123], v[216:219]
s_lshl_b32 s70, s82, 10
v_mfma_f32_16x16x32_bf16 v[208:211], a[60:63], v[184:187], v[208:211]
v_mfma_f32_16x16x32_bf16 v[212:215], a[60:63], v[188:191], v[212:215]
v_mfma_f32_16x16x32_bf16 v[220:223], a[100:103], v[124:127], v[220:223]
s_waitcnt lgkmcnt(0)
v_mfma_f32_16x16x32_bf16 v[208:211], a[64:67], v[192:195], v[208:211]
v_mfma_f32_16x16x32_bf16 v[212:215], a[64:67], v[196:199], v[212:215]
v_mfma_f32_16x16x32_bf16 v[216:219], a[104:107], v[128:131], v[216:219]
v_mfma_f32_16x16x32_bf16 v[208:211], a[68:71], v[200:203], v[208:211]
v_mfma_f32_16x16x32_bf16 v[212:215], a[68:71], v[204:207], v[212:215]
v_mfma_f32_16x16x32_bf16 v[220:223], a[104:107], v[132:135], v[220:223]
v_mfma_f32_16x16x32_bf16 v[216:219], a[108:111], v[136:139], v[216:219]
v_mfma_f32_16x16x32_bf16 v[220:223], a[108:111], v[140:143], v[220:223]
v_mfma_f32_16x16x32_bf16 v[224:227], a[144:147], v[64:67], 0
v_mfma_f32_16x16x32_bf16 v[216:219], a[112:115], v[144:147], v[216:219]
v_mfma_f32_16x16x32_bf16 v[220:223], a[112:115], v[148:151], v[220:223]
s_nop 0
v_cvt_pk_bf16_f32 v48, v208, v209
v_cvt_pk_bf16_f32 v49, v210, v211
v_mfma_f32_16x16x32_bf16 v[228:231], a[144:147], v[68:71], 0
v_cvt_pk_bf16_f32 v50, v212, v213
v_cvt_pk_bf16_f32 v51, v214, v215
v_mfma_f32_16x16x32_bf16 v[216:219], a[116:119], v[152:155], v[216:219]
v_permlane16_swap_b32 v48, v50
v_mfma_f32_16x16x32_bf16 v[220:223], a[116:119], v[156:159], v[220:223]
v_permlane16_swap_b32 v49, v51
v_mfma_f32_16x16x32_bf16 v[224:227], a[148:151], v[72:75], v[224:227]
buffer_store_dwordx4 v[48:51], v19, s[4:7], s89 offen sc1
v_mfma_f32_16x16x32_bf16 v[216:219], a[120:123], v[160:163], v[216:219]
v_mfma_f32_16x16x32_bf16 v[220:223], a[120:123], v[164:167], v[220:223]
v_mfma_f32_16x16x32_bf16 v[228:231], a[148:151], v[76:79], v[228:231]
v_mfma_f32_16x16x32_bf16 v[216:219], a[124:127], v[168:171], v[216:219]
v_mfma_f32_16x16x32_bf16 v[220:223], a[124:127], v[172:175], v[220:223]
v_mfma_f32_16x16x32_bf16 v[224:227], a[152:155], v[80:83], v[224:227]
v_mfma_f32_16x16x32_bf16 v[216:219], a[128:131], v[176:179], v[216:219]
v_mfma_f32_16x16x32_bf16 v[220:223], a[128:131], v[180:183], v[220:223]
v_mfma_f32_16x16x32_bf16 v[228:231], a[152:155], v[84:87], v[228:231]
v_mfma_f32_16x16x32_bf16 v[216:219], a[132:135], v[184:187], v[216:219]
v_mfma_f32_16x16x32_bf16 v[220:223], a[132:135], v[188:191], v[220:223]
v_mfma_f32_16x16x32_bf16 v[224:227], a[156:159], v[88:91], v[224:227]
v_mfma_f32_16x16x32_bf16 v[216:219], a[136:139], v[192:195], v[216:219]
v_mfma_f32_16x16x32_bf16 v[220:223], a[136:139], v[196:199], v[220:223]
v_mfma_f32_16x16x32_bf16 v[228:231], a[156:159], v[92:95], v[228:231]
v_mfma_f32_16x16x32_bf16 v[216:219], a[140:143], v[200:203], v[216:219]
v_mfma_f32_16x16x32_bf16 v[220:223], a[140:143], v[204:207], v[220:223]
v_mfma_f32_16x16x32_bf16 v[224:227], a[160:163], v[96:99], v[224:227]
v_mfma_f32_16x16x32_bf16 v[228:231], a[160:163], v[100:103], v[228:231]
s_waitcnt vmcnt(1)
ds_write_b32 v18, v24
v_mfma_f32_16x16x32_bf16 v[224:227], a[164:167], v[104:107], v[224:227]
v_mfma_f32_16x16x32_bf16 v[228:231], a[164:167], v[108:111], v[228:231]
v_mfma_f32_16x16x32_bf16 v[224:227], a[168:171], v[112:115], v[224:227]
s_waitcnt lgkmcnt(0)
s_barrier
v_mfma_f32_16x16x32_bf16 v[228:231], a[168:171], v[116:119], v[228:231]
ds_read_b32 v33, v32
v_cvt_pk_bf16_f32 v52, v216, v217
v_mfma_f32_16x16x32_bf16 v[224:227], a[172:175], v[120:123], v[224:227]
buffer_store_dword v27, v45, s[4:7], s70 offen
v_mfma_f32_16x16x32_bf16 v[228:231], a[172:175], v[124:127], v[228:231]
buffer_store_dword v27, v44, s[4:7], s70 offen sc1
v_mfma_f32_16x16x32_bf16 v[224:227], a[176:179], v[128:131], v[224:227]
s_waitcnt lgkmcnt(0)
v_cmp_gt_u32 vcc, s76, v33
v_mfma_f32_16x16x32_bf16 v[228:231], a[176:179], v[132:135], v[228:231]
s_lshr_b64 s[58:59], vcc, s77
s_and_b32 s58, s58, s56
s_cselect_b32 s10, 0, 268435456
s_cselect_b32 s80, 0, 1
v_mfma_f32_16x16x32_bf16 v[224:227], a[180:183], v[136:139], v[224:227]
s_cmp_eq_u32 s95, 0
s_cbranch_scc1 g_slow_119
v_mfma_f32_16x16x32_bf16 v[228:231], a[180:183], v[140:143], v[228:231]
s_add_u32 m0, s72, 0
v_cvt_pk_bf16_f32 v53, v218, v219
v_mfma_f32_16x16x32_bf16 v[224:227], a[184:187], v[144:147], v[224:227]
buffer_load_dwordx4 v8, s[8:11], s78 offen offset:0 sc1 lds
v_mfma_f32_16x16x32_bf16 v[228:231], a[184:187], v[148:151], v[228:231]
v_cvt_pk_bf16_f32 v54, v220, v221
v_cvt_pk_bf16_f32 v55, v222, v223
v_mfma_f32_16x16x32_bf16 v[224:227], a[188:191], v[152:155], v[224:227]
v_permlane16_swap_b32 v52, v54
v_mfma_f32_16x16x32_bf16 v[228:231], a[188:191], v[156:159], v[228:231]
v_permlane16_swap_b32 v53, v55
v_mfma_f32_16x16x32_bf16 v[224:227], a[192:195], v[160:163], v[224:227]
buffer_load_dwordx4 v9, s[8:11], s78 offen offset:1024 sc1 lds
v_mfma_f32_16x16x32_bf16 v[228:231], a[192:195], v[164:167], v[228:231]
buffer_store_dwordx4 v[52:55], v20, s[4:7], s89 offen sc1
v_mfma_f32_16x16x32_bf16 v[224:227], a[196:199], v[168:171], v[224:227]
ds_read_b128 v[64:67], v31 offset:0
v_mfma_f32_16x16x32_bf16 v[228:231], a[196:199], v[172:175], v[228:231]
ds_read_b128 v[68:71], v31 offset:9216
v_mfma_f32_16x16x32_bf16 v[224:227], a[200:203], v[176:179], v[224:227]
buffer_load_dwordx4 v10, s[8:11], s78 offen offset:2048 sc1 lds
ds_read_b128 v[72:75], v31 offset:18432
v_mfma_f32_16x16x32_bf16 v[228:231], a[200:203], v[180:183], v[228:231]
ds_read_b128 v[76:79], v31 offset:27648
v_mfma_f32_16x16x32_bf16 v[224:227], a[204:207], v[184:187], v[224:227]
ds_read_b128 v[80:83], v31 offset:1024
v_mfma_f32_16x16x32_bf16 v[228:231], a[204:207], v[188:191], v[228:231]
ds_read_b128 v[84:87], v31 offset:10240
v_mfma_f32_16x16x32_bf16 v[224:227], a[208:211], v[192:195], v[224:227]
buffer_load_dwordx4 v11, s[8:11], s78 offen offset:3072 sc1 lds
ds_read_b128 v[88:91], v31 offset:19456
v_mfma_f32_16x16x32_bf16 v[228:231], a[208:211], v[196:199], v[228:231]
ds_read_b128 v[92:95], v31 offset:28672
v_mfma_f32_16x16x32_bf16 v[224:227], a[212:215], v[200:203], v[224:227]
v_mfma_f32_16x16x32_bf16 v[228:231], a[212:215], v[204:207], v[228:231]
g_body_104:
s_waitcnt lgkmcnt(4)
v_mfma_f32_16x16x32_bf16 v[208:211], a[0:3], v[64:67], 0
ds_read_b128 v[96:99], v31 offset:2048
s_add_u32 m0, s72, 4096
v_mfma_f32_16x16x32_bf16 v[212:215], a[0:3], v[68:71], 0
ds_read_b128 v[100:103], v31 offset:11264
buffer_load_dwordx4 v12, s[8:11], s78 offen offset:0 sc1 lds
v_mfma_f32_16x16x32_bf16 v[216:219], a[72:75], v[64:67], 0
v_mfma_f32_16x16x32_bf16 v[208:211], a[4:7], v[72:75], v[208:211]
ds_read_b128 v[104:107], v31 offset:20480
v_cvt_pk_bf16_f32 v56, v224, v225
v_mfma_f32_16x16x32_bf16 v[212:215], a[4:7], v[76:79], v[212:215]
ds_read_b128 v[108:111], v31 offset:29696
buffer_load_dwordx4 v13, s[8:11], s78 offen offset:1024 sc1 lds
v_mfma_f32_16x16x32_bf16 v[220:223], a[72:75], v[68:71], 0
v_cvt_pk_bf16_f32 v57, v226, v227
s_waitcnt lgkmcnt(4)
v_mfma_f32_16x16x32_bf16 v[208:211], a[8:11], v[80:83], v[208:211]
ds_read_b128 v[112:115], v31 offset:3072
v_cvt_pk_bf16_f32 v58, v228, v229
v_mfma_f32_16x16x32_bf16 v[212:215], a[8:11], v[84:87], v[212:215]
ds_read_b128 v[116:119], v31 offset:12288
v_cvt_pk_bf16_f32 v59, v230, v231
v_mfma_f32_16x16x32_bf16 v[216:219], a[76:79], v[72:75], v[216:219]
buffer_load_dwordx4 v14, s[8:11], s78 offen offset:2048 sc1 lds
v_mfma_f32_16x16x32_bf16 v[208:211], a[12:15], v[88:91], v[208:211]
ds_read_b128 v[120:123], v31 offset:21504
v_permlane16_swap_b32 v56, v58
v_mfma_f32_16x16x32_bf16 v[212:215], a[12:15], v[92:95], v[212:215]
ds_read_b128 v[124:127], v31 offset:30720
v_permlane16_swap_b32 v57, v59
v_mfma_f32_16x16x32_bf16 v[220:223], a[76:79], v[76:79], v[220:223]
s_waitcnt lgkmcnt(4)
v_mfma_f32_16x16x32_bf16 v[208:211], a[16:19], v[96:99], v[208:211]
ds_read_b128 v[128:131], v31 offset:4096
buffer_load_dwordx4 v15, s[8:11], s78 offen offset:3072 sc1 lds
v_mfma_f32_16x16x32_bf16 v[212:215], a[16:19], v[100:103], v[212:215]
ds_read_b128 v[132:135], v31 offset:13312
v_mfma_f32_16x16x32_bf16 v[216:219], a[80:83], v[80:83], v[216:219]
buffer_store_dwordx4 v[56:59], v21, s[4:7], s89 offen sc1
v_mfma_f32_16x16x32_bf16 v[208:211], a[20:23], v[104:107], v[208:211]
ds_read_b128 v[136:139], v31 offset:22528
s_add_u32 m0, s72, 8192
v_mfma_f32_16x16x32_bf16 v[212:215], a[20:23], v[108:111], v[212:215]
ds_read_b128 v[140:143], v31 offset:31744
buffer_load_dwordx4 v16, s[8:11], s78 offen offset:0 sc1 lds
v_mfma_f32_16x16x32_bf16 v[220:223], a[80:83], v[84:87], v[220:223]
s_and_b32 s70, s52, 63
s_waitcnt lgkmcnt(4)
v_mfma_f32_16x16x32_bf16 v[208:211], a[24:27], v[112:115], v[208:211]
ds_read_b128 v[144:147], v31 offset:5120
v_mfma_f32_16x16x32_bf16 v[212:215], a[24:27], v[116:119], v[212:215]
ds_read_b128 v[148:151], v31 offset:14336
v_mfma_f32_16x16x32_bf16 v[216:219], a[84:87], v[88:91], v[216:219]
v_readlane_b32 s81, v36, s70
v_mfma_f32_16x16x32_bf16 v[208:211], a[28:31], v[120:123], v[208:211]
ds_read_b128 v[152:155], v31 offset:23552
v_mfma_f32_16x16x32_bf16 v[212:215], a[28:31], v[124:127], v[212:215]
ds_read_b128 v[156:159], v31 offset:32768
v_mfma_f32_16x16x32_bf16 v[220:223], a[84:87], v[92:95], v[220:223]
s_waitcnt lgkmcnt(4)
v_mfma_f32_16x16x32_bf16 v[208:211], a[32:35], v[128:131], v[208:211]
ds_read_b128 v[160:163], v31 offset:6144
v_mfma_f32_16x16x32_bf16 v[212:215], a[32:35], v[132:135], v[212:215]
ds_read_b128 v[164:167], v31 offset:15360
v_mfma_f32_16x16x32_bf16 v[216:219], a[88:91], v[96:99], v[216:219]
v_readlane_b32 s82, v37, s70
v_mfma_f32_16x16x32_bf16 v[208:211], a[36:39], v[136:139], v[208:211]
ds_read_b128 v[168:171], v31 offset:24576
v_mfma_f32_16x16x32_bf16 v[212:215], a[36:39], v[140:143], v[212:215]
ds_read_b128 v[172:175], v31 offset:33792
v_mfma_f32_16x16x32_bf16 v[220:223], a[88:91], v[100:103], v[220:223]
s_waitcnt lgkmcnt(4)
v_mfma_f32_16x16x32_bf16 v[208:211], a[40:43], v[144:147], v[208:211]
ds_read_b128 v[176:179], v31 offset:7168
v_mfma_f32_16x16x32_bf16 v[212:215], a[40:43], v[148:151], v[212:215]
ds_read_b128 v[180:183], v31 offset:16384
v_mfma_f32_16x16x32_bf16 v[216:219], a[92:95], v[104:107], v[216:219]
v_readlane_b32 s83, v38, s70
v_mfma_f32_16x16x32_bf16 v[208:211], a[44:47], v[152:155], v[208:211]
ds_read_b128 v[184:187], v31 offset:25600
v_mfma_f32_16x16x32_bf16 v[212:215], a[44:47], v[156:159], v[212:215]
ds_read_b128 v[188:191], v31 offset:34816
v_mfma_f32_16x16x32_bf16 v[220:223], a[92:95], v[108:111], v[220:223]
s_waitcnt lgkmcnt(4)
v_mfma_f32_16x16x32_bf16 v[208:211], a[48:51], v[160:163], v[208:211]
ds_read_b128 v[192:195], v31 offset:8192
v_mfma_f32_16x16x32_bf16 v[212:215], a[48:51], v[164:167], v[212:215]
ds_read_b128 v[196:199], v31 offset:17408
v_mfma_f32_16x16x32_bf16 v[216:219], a[96:99], v[112:115], v[216:219]
buffer_load_dword v24, v22, s[4:7], 0 offen sc1
v_mfma_f32_16x16x32_bf16 v[208:211], a[52:55], v[168:171], v[208:211]
ds_read_b128 v[200:203], v31 offset:26624
v_mfma_f32_16x16x32_bf16 v[212:215], a[52:55], v[172:175], v[212:215]
ds_read_b128 v[204:207], v31 offset:35840
v_mfma_f32_16x16x32_bf16 v[220:223], a[96:99], v[116:119], v[220:223]
s_waitcnt lgkmcnt(4)
v_mfma_f32_16x16x32_bf16 v[208:211], a[56:59], v[176:179], v[208:211]
v_readlane_b32 s84, v39, s70
v_mfma_f32_16x16x32_bf16 v[212:215], a[56:59], v[180:183], v[212:215]
s_add_u32 s52, s52, 1
v_mfma_f32_16x16x32_bf16 v[216:219], a[100:103], v[120:123], v[216:219]
s_cmp_eq_u32 s52, 64
s_cbranch_scc1 rare_121
back_122:
v_mfma_f32_16x16x32_bf16 v[208:211], a[60:63], v[184:187], v[208:211]
v_mov_b32 v27, s86
s_lshl_b32 s70, s87, 10
v_mfma_f32_16x16x32_bf16 v[212:215], a[60:63], v[188:191], v[212:215]
v_mfma_f32_16x16x32_bf16 v[220:223], a[100:103], v[124:127], v[220:223]
s_waitcnt lgkmcnt(0)
v_mfma_f32_16x16x32_bf16 v[208:211], a[64:67], v[192:195], v[208:211]
v_mfma_f32_16x16x32_bf16 v[212:215], a[64:67], v[196:199], v[212:215]
v_mfma_f32_16x16x32_bf16 v[216:219], a[104:107], v[128:131], v[216:219]
v_mfma_f32_16x16x32_bf16 v[208:211], a[68:71], v[200:203], v[208:211]
v_mfma_f32_16x16x32_bf16 v[212:215], a[68:71], v[204:207], v[212:215]
v_mfma_f32_16x16x32_bf16 v[220:223], a[104:107], v[132:135], v[220:223]
v_mfma_f32_16x16x32_bf16 v[216:219], a[108:111], v[136:139], v[216:219]
v_mfma_f32_16x16x32_bf16 v[220:223], a[108:111], v[140:143], v[220:223]
v_mfma_f32_16x16x32_bf16 v[224:227], a[144:147], v[64:67], 0
v_mfma_f32_16x16x32_bf16 v[216:219], a[112:115], v[144:147], v[216:219]
v_mfma_f32_16x16x32_bf16 v[220:223], a[112:115], v[148:151], v[220:223]
s_nop 0
v_cvt_pk_bf16_f32 v48, v208, v209
v_cvt_pk_bf16_f32 v49, v210, v211
v_mfma_f32_16x16x32_bf16 v[228:231], a[144:147], v[68:71], 0
v_cvt_pk_bf16_f32 v50, v212, v213
v_cvt_pk_bf16_f32 v51, v214, v215
v_mfma_f32_16x16x32_bf16 v[216:219], a[116:119], v[152:155], v[216:219]
v_permlane16_swap_b32 v48, v50
v_mfma_f32_16x16x32_bf16 v[220:223], a[116:119], v[156:159], v[220:223]
v_permlane16_swap_b32 v49, v51
v_mfma_f32_16x16x32_bf16 v[224:227], a[148:151], v[72:75], v[224:227]
buffer_store_dwordx4 v[48:51], v19, s[4:7], s94 offen sc1
v_mfma_f32_16x16x32_bf16 v[216:219], a[120:123], v[160:163], v[216:219]
v_mfma_f32_16x16x32_bf16 v[220:223], a[120:123], v[164:167], v[220:223]
v_mfma_f32_16x16x32_bf16 v[228:231], a[148:151], v[76:79], v[228:231]
v_mfma_f32_16x16x32_bf16 v[216:219], a[124:127], v[168:171], v[216:219]
v_mfma_f32_16x16x32_bf16 v[220:223], a[124:127], v[172:175], v[220:223]
v_mfma_f32_16x16x32_bf16 v[224:227], a[152:155], v[80:83], v[224:227]
v_mfma_f32_16x16x32_bf16 v[216:219], a[128:131], v[176:179], v[216:219]
v_mfma_f32_16x16x32_bf16 v[220:223], a[128:131], v[180:183], v[220:223]
v_mfma_f32_16x16x32_bf16 v[228:231], a[152:155], v[84:87], v[228:231]
v_mfma_f32_16x16x32_bf16 v[216:219], a[132:135], v[184:187], v[216:219]
v_mfma_f32_16x16x32_bf16 v[220:223], a[132:135], v[188:191], v[220:223]
v_mfma_f32_16x16x32_bf16 v[224:227], a[156:159], v[88:91], v[224:227]
v_mfma_f32_16x16x32_bf16 v[216:219], a[136:139], v[192:195], v[216:219]
v_mfma_f32_16x16x32_bf16 v[220:223], a[136:139], v[196:199], v[220:223]
v_mfma_f32_16x16x32_bf16 v[228:231], a[156:159], v[92:95], v[228:231]
v_mfma_f32_16x16x32_bf16 v[216:219], a[140:143], v[200:203], v[216:219]
v_mfma_f32_16x16x32_bf16 v[220:223], a[140:143], v[204:207], v[220:223]
v_mfma_f32_16x16x32_bf16 v[224:227], a[160:163], v[96:99], v[224:227]
v_mfma_f32_16x16x32_bf16 v[228:231], a[160:163], v[100:103], v[228:231]
s_waitcnt vmcnt(1)
ds_write_b32 v18, v24
v_mfma_f32_16x16x32_bf16 v[224:227], a[164:167], v[104:107], v[224:227]
v_mfma_f32_16x16x32_bf16 v[228:231], a[164:167], v[108:111], v[228:231]
v_mfma_f32_16x16x32_bf16 v[224:227], a[168:171], v[112:115], v[224:227]
s_waitcnt lgkmcnt(0)
s_barrier
v_mfma_f32_16x16x32_bf16 v[228:231], a[168:171], v[116:119], v[228:231]
ds_read_b32 v33, v32
v_cvt_pk_bf16_f32 v52, v216, v217
v_mfma_f32_16x16x32_bf16 v[224:227], a[172:175], v[120:123], v[224:227]
buffer_store_dword v27, v45, s[4:7], s70 offen
v_mfma_f32_16x16x32_bf16 v[228:231], a[172:175], v[124:127], v[228:231]
buffer_store_dword v27, v44, s[4:7], s70 offen sc1
v_mfma_f32_16x16x32_bf16 v[224:227], a[176:179], v[128:131], v[224:227]
s_waitcnt lgkmcnt(0)
v_cmp_gt_u32 vcc, s81, v33
v_mfma_f32_16x16x32_bf16 v[228:231], a[176:179], v[132:135], v[228:231]
s_lshr_b64 s[58:59], vcc, s82
s_and_b32 s58, s58, s56
s_cselect_b32 s10, 0, 268435456
s_cselect_b32 s85, 0, 1
v_mfma_f32_16x16x32_bf16 v[224:227], a[180:183], v[136:139], v[224:227]
s_cmp_eq_u32 s80, 0
s_cbranch_scc1 g_slow_120
v_mfma_f32_16x16x32_bf16 v[228:231], a[180:183], v[140:143], v[228:231]
s_add_u32 m0, s73, 0
v_cvt_pk_bf16_f32 v53, v218, v219
v_mfma_f32_16x16x32_bf16 v[224:227], a[184:187], v[144:147], v[224:227]
buffer_load_dwordx4 v8, s[8:11], s83 offen offset:0 sc1 lds
v_mfma_f32_16x16x32_bf16 v[228:231], a[184:187], v[148:151], v[228:231]
v_cvt_pk_bf16_f32 v54, v220, v221
v_cvt_pk_bf16_f32 v55, v222, v223
v_mfma_f32_16x16x32_bf16 v[224:227], a[188:191], v[152:155], v[224:227]
v_permlane16_swap_b32 v52, v54
v_mfma_f32_16x16x32_bf16 v[228:231], a[188:191], v[156:159], v[228:231]
v_permlane16_swap_b32 v53, v55
v_mfma_f32_16x16x32_bf16 v[224:227], a[192:195], v[160:163], v[224:227]
buffer_load_dwordx4 v9, s[8:11], s83 offen offset:1024 sc1 lds
v_mfma_f32_16x16x32_bf16 v[228:231], a[192:195], v[164:167], v[228:231]
buffer_store_dwordx4 v[52:55], v20, s[4:7], s94 offen sc1
v_mfma_f32_16x16x32_bf16 v[224:227], a[196:199], v[168:171], v[224:227]
ds_read_b128 v[64:67], v28 offset:0
v_mfma_f32_16x16x32_bf16 v[228:231], a[196:199], v[172:175], v[228:231]
ds_read_b128 v[68:71], v28 offset:9216
v_mfma_f32_16x16x32_bf16 v[224:227], a[200:203], v[176:179], v[224:227]
buffer_load_dwordx4 v10, s[8:11], s83 offen offset:2048 sc1 lds
ds_read_b128 v[72:75], v28 offset:18432
v_mfma_f32_16x16x32_bf16 v[228:231], a[200:203], v[180:183], v[228:231]
ds_read_b128 v[76:79], v28 offset:27648
v_mfma_f32_16x16x32_bf16 v[224:227], a[204:207], v[184:187], v[224:227]
ds_read_b128 v[80:83], v28 offset:1024
v_mfma_f32_16x16x32_bf16 v[228:231], a[204:207], v[188:191], v[228:231]
ds_read_b128 v[84:87], v28 offset:10240
v_mfma_f32_16x16x32_bf16 v[224:227], a[208:211], v[192:195], v[224:227]
buffer_load_dwordx4 v11, s[8:11], s83 offen offset:3072 sc1 lds
ds_read_b128 v[88:91], v28 offset:19456
v_mfma_f32_16x16x32_bf16 v[228:231], a[208:211], v[196:199], v[228:231]
ds_read_b128 v[92:95], v28 offset:28672
v_mfma_f32_16x16x32_bf16 v[224:227], a[212:215], v[200:203], v[224:227]
v_mfma_f32_16x16x32_bf16 v[228:231], a[212:215], v[204:207], v[228:231]
s_branch g_body_101
g_slow_117:
v_cmp_gt_u32 vcc, s81, v33
s_nop 0
s_lshr_b64 s[58:59], vcc, s82
s_and_b32 s58, s58, s56
s_cbranch_scc1 g_notyet_123
s_add_u32 m0, s73, 0
s_nop 0
buffer_load_dwordx4 v8, s[4:7], s83 offen offset:0 sc1 lds
buffer_load_dwordx4 v9, s[4:7], s83 offen offset:1024 sc1 lds
buffer_load_dwordx4 v10, s[4:7], s83 offen offset:2048 sc1 lds
buffer_load_dwordx4 v11, s[4:7], s83 offen offset:3072 sc1 lds
s_add_u32 m0, s73, 4096
s_nop 0
buffer_load_dwordx4 v12, s[4:7], s83 offen offset:0 sc1 lds
buffer_load_dwordx4 v13, s[4:7], s83 offen offset:1024 sc1 lds
buffer_load_dwordx4 v14, s[4:7], s83 offen offset:2048 sc1 lds
buffer_load_dwordx4 v15, s[4:7], s83 offen offset:3072 sc1 lds
s_add_u32 m0, s73, 8192
s_nop 0
buffer_load_dwordx4 v16, s[4:7], s83 offen offset:0 sc1 lds
v_mfma_f32_16x16x32_bf16 v[228:231], a[180:183], v[140:143], v[228:231]
s_add_u32 m0, s74, 0
v_cvt_pk_bf16_f32 v53, v218, v219
v_mfma_f32_16x16x32_bf16 v[224:227], a[184:187], v[144:147], v[224:227]
buffer_load_dwordx4 v8, s[8:11], s88 offen offset:0 sc1 lds
v_mfma_f32_16x16x32_bf16 v[228:231], a[184:187], v[148:151], v[228:231]
v_cvt_pk_bf16_f32 v54, v220, v221
v_cvt_pk_bf16_f32 v55, v222, v223
v_mfma_f32_16x16x32_bf16 v[224:227], a[188:191], v[152:155], v[224:227]
v_permlane16_swap_b32 v52, v54
v_mfma_f32_16x16x32_bf16 v[228:231], a[188:191], v[156:159], v[228:231]
v_permlane16_swap_b32 v53, v55
v_mfma_f32_16x16x32_bf16 v[224:227], a[192:195], v[160:163], v[224:227]
buffer_load_dwordx4 v9, s[8:11], s88 offen offset:1024 sc1 lds
v_mfma_f32_16x16x32_bf16 v[228:231], a[192:195], v[164:167], v[228:231]
buffer_store_dwordx4 v[52:55], v20, s[4:7], s79 offen sc1
v_mfma_f32_16x16x32_bf16 v[224:227], a[196:199], v[168:171], v[224:227]
v_mfma_f32_16x16x32_bf16 v[228:231], a[196:199], v[172:175], v[228:231]
v_mfma_f32_16x16x32_bf16 v[224:227], a[200:203], v[176:179], v[224:227]
buffer_load_dwordx4 v10, s[8:11], s88 offen offset:2048 sc1 lds
v_mfma_f32_16x16x32_bf16 v[228:231], a[200:203], v[180:183], v[228:231]
v_mfma_f32_16x16x32_bf16 v[224:227], a[204:207], v[184:187], v[224:227]
v_mfma_f32_16x16x32_bf16 v[228:231], a[204:207], v[188:191], v[228:231]
v_mfma_f32_16x16x32_bf16 v[224:227], a[208:211], v[192:195], v[224:227]
buffer_load_dwordx4 v11, s[8:11], s88 offen offset:3072 sc1 lds
v_mfma_f32_16x16x32_bf16 v[228:231], a[208:211], v[196:199], v[228:231]
v_mfma_f32_16x16x32_bf16 v[224:227], a[212:215], v[200:203], v[224:227]
v_mfma_f32_16x16x32_bf16 v[228:231], a[212:215], v[204:207], v[228:231]
s_nop 6
v_cvt_pk_bf16_f32 v56, v224, v225
v_cvt_pk_bf16_f32 v57, v226, v227
v_cvt_pk_bf16_f32 v58, v228, v229
v_cvt_pk_bf16_f32 v59, v230, v231
s_nop 0
v_permlane16_swap_b32 v56, v58
v_permlane16_swap_b32 v57, v59
buffer_store_dwordx4 v[56:59], v21, s[4:7], s79 offen sc1
s_mov_b32 s79, 1879048192
s_waitcnt vmcnt(6)
s_branch g_go_124
g_notyet_123:
v_mfma_f32_16x16x32_bf16 v[228:231], a[180:183], v[140:143], v[228:231]
s_add_u32 m0, s74, 0
v_cvt_pk_bf16_f32 v53, v218, v219
v_mfma_f32_16x16x32_bf16 v[224:227], a[184:187], v[144:147], v[224:227]
buffer_load_dwordx4 v8, s[8:11], s88 offen offset:0 sc1 lds
v_mfma_f32_16x16x32_bf16 v[228:231], a[184:187], v[148:151], v[228:231]
v_cvt_pk_bf16_f32 v54, v220, v221
v_cvt_pk_bf16_f32 v55, v222, v223
v_mfma_f32_16x16x32_bf16 v[224:227], a[188:191], v[152:155], v[224:227]
v_permlane16_swap_b32 v52, v54
v_mfma_f32_16x16x32_bf16 v[228:231], a[188:191], v[156:159], v[228:231]
v_permlane16_swap_b32 v53, v55
v_mfma_f32_16x16x32_bf16 v[224:227], a[192:195], v[160:163], v[224:227]
buffer_load_dwordx4 v9, s[8:11], s88 offen offset:1024 sc1 lds
v_mfma_f32_16x16x32_bf16 v[228:231], a[192:195], v[164:167], v[228:231]
buffer_store_dwordx4 v[52:55], v20, s[4:7], s79 offen sc1
v_mfma_f32_16x16x32_bf16 v[224:227], a[196:199], v[168:171], v[224:227]
v_mfma_f32_16x16x32_bf16 v[228:231], a[196:199], v[172:175], v[228:231]
v_mfma_f32_16x16x32_bf16 v[224:227], a[200:203], v[176:179], v[224:227]
buffer_load_dwordx4 v10, s[8:11], s88 offen offset:2048 sc1 lds
v_mfma_f32_16x16x32_bf16 v[228:231], a[200:203], v[180:183], v[228:231]
v_mfma_f32_16x16x32_bf16 v[224:227], a[204:207], v[184:187], v[224:227]
v_mfma_f32_16x16x32_bf16 v[228:231], a[204:207], v[188:191], v[228:231]
v_mfma_f32_16x16x32_bf16 v[224:227], a[208:211], v[192:195], v[224:227]
buffer_load_dwordx4 v11, s[8:11], s88 offen offset:3072 sc1 lds
v_mfma_f32_16x16x32_bf16 v[228:231], a[208:211], v[196:199], v[228:231]
v_mfma_f32_16x16x32_bf16 v[224:227], a[212:215], v[200:203], v[224:227]
v_mfma_f32_16x16x32_bf16 v[228:231], a[212:215], v[204:207], v[228:231]
s_nop 6
v_cvt_pk_bf16_f32 v56, v224, v225
v_cvt_pk_bf16_f32 v57, v226, v227
v_cvt_pk_bf16_f32 v58, v228, v229
v_cvt_pk_bf16_f32 v59, v230, v231
s_nop 0
v_permlane16_swap_b32 v56, v58
v_permlane16_swap_b32 v57, v59
buffer_store_dwordx4 v[56:59], v21, s[4:7], s79 offen sc1
s_mov_b32 s79, 1879048192
v_mov_b32 v27, s76
s_lshl_b32 s70, s77, 10
s_waitcnt vmcnt(0)
s_barrier
buffer_store_dword v27, v45, s[4:7], s70 offen
buffer_store_dword v27, v44, s[4:7], s70 offen sc1
s_mov_b32 s77, 1835008
s_cmp_eq_u32 s81, -1
s_cbranch_scc1 g_fin_109
s_cmp_lg_u32 s3, 0
s_cbranch_scc1 sp_ok_126
s_mov_b32 s55, 0
sp_loop_125:
s_lshl_b64 exec, s[56:57], s82
buffer_load_dword v26, v22, s[4:7], 0 offen sc1
s_mov_b64 exec, -1
s_add_u32 s55, s55, 1
s_cmp_gt_u32 s55, 150000
s_cbranch_scc1 sp_bad_127
s_waitcnt vmcnt(0)
v_cmp_gt_u32 vcc, s81, v26
s_nop 0
s_lshr_b64 s[58:59], vcc, s82
s_and_b32 s58, s58, s56
s_cbranch_scc0 sp_ok_126
s_sleep 1
s_branch sp_loop_125
sp_bad_127:
s_mov_b32 s98, 1027
s_branch L_fail
sp_ok_126:
s_barrier
s_add_u32 m0, s73, 0
s_nop 0
buffer_load_dwordx4 v8, s[4:7], s83 offen offset:0 sc1 lds
buffer_load_dwordx4 v9, s[4:7], s83 offen offset:1024 sc1 lds
buffer_load_dwordx4 v10, s[4:7], s83 offen offset:2048 sc1 lds
buffer_load_dwordx4 v11, s[4:7], s83 offen offset:3072 sc1 lds
s_add_u32 m0, s73, 4096
s_nop 0
buffer_load_dwordx4 v12, s[4:7], s83 offen offset:0 sc1 lds
buffer_load_dwordx4 v13, s[4:7], s83 offen offset:1024 sc1 lds
buffer_load_dwordx4 v14, s[4:7], s83 offen offset:2048 sc1 lds
buffer_load_dwordx4 v15, s[4:7], s83 offen offset:3072 sc1 lds
s_add_u32 m0, s73, 8192
s_nop 0
buffer_load_dwordx4 v16, s[4:7], s83 offen offset:0 sc1 lds
s_waitcnt vmcnt(0)
g_go_124:
g_join_106:
s_barrier
ds_read_b128 v[64:67], v29 offset:0
ds_read_b128 v[68:71], v29 offset:9216
ds_read_b128 v[72:75], v29 offset:18432
ds_read_b128 v[76:79], v29 offset:27648
ds_read_b128 v[80:83], v29 offset:1024
ds_read_b128 v[84:87], v29 offset:10240
ds_read_b128 v[88:91], v29 offset:19456
ds_read_b128 v[92:95], v29 offset:28672
s_branch g_body_102
g_slow_118:
v_cmp_gt_u32 vcc, s86, v33
s_nop 0
s_lshr_b64 s[58:59], vcc, s87
s_and_b32 s58, s58, s56
s_cbranch_scc1 g_notyet_128
s_add_u32 m0, s74, 0
s_nop 0
buffer_load_dwordx4 v8, s[4:7], s88 offen offset:0 sc1 lds
buffer_load_dwordx4 v9, s[4:7], s88 offen offset:1024 sc1 lds
buffer_load_dwordx4 v10, s[4:7], s88 offen offset:2048 sc1 lds
buffer_load_dwordx4 v11, s[4:7], s88 offen offset:3072 sc1 lds
s_add_u32 m0, s74, 4096
s_nop 0
buffer_load_dwordx4 v12, s[4:7], s88 offen offset:0 sc1 lds
buffer_load_dwordx4 v13, s[4:7], s88 offen offset:1024 sc1 lds
buffer_load_dwordx4 v14, s[4:7], s88 offen offset:2048 sc1 lds
buffer_load_dwordx4 v15, s[4:7], s88 offen offset:3072 sc1 lds
s_add_u32 m0, s74, 8192
s_nop 0
buffer_load_dwordx4 v16, s[4:7], s88 offen offset:0 sc1 lds
v_mfma_f32_16x16x32_bf16 v[228:231], a[180:183], v[140:143], v[228:231]
s_add_u32 m0, s75, 0
v_cvt_pk_bf16_f32 v53, v218, v219
v_mfma_f32_16x16x32_bf16 v[224:227], a[184:187], v[144:147], v[224:227]
buffer_load_dwordx4 v8, s[8:11], s93 offen offset:0 sc1 lds
v_mfma_f32_16x16x32_bf16 v[228:231], a[184:187], v[148:151], v[228:231]
v_cvt_pk_bf16_f32 v54, v220, v221
v_cvt_pk_bf16_f32 v55, v222, v223
v_mfma_f32_16x16x32_bf16 v[224:227], a[188:191], v[152:155], v[224:227]
v_permlane16_swap_b32 v52, v54
v_mfma_f32_16x16x32_bf16 v[228:231], a[188:191], v[156:159], v[228:231]
v_permlane16_swap_b32 v53, v55
v_mfma_f32_16x16x32_bf16 v[224:227], a[192:195], v[160:163], v[224:227]
buffer_load_dwordx4 v9, s[8:11], s93 offen offset:1024 sc1 lds
v_mfma_f32_16x16x32_bf16 v[228:231], a[192:195], v[164:167], v[228:231]
buffer_store_dwordx4 v[52:55], v20, s[4:7], s84 offen sc1
v_mfma_f32_16x16x32_bf16 v[224:227], a[196:199], v[168:171], v[224:227]
v_mfma_f32_16x16x32_bf16 v[228:231], a[196:199], v[172:175], v[228:231]
v_mfma_f32_16x16x32_bf16 v[224:227], a[200:203], v[176:179], v[224:227]
buffer_load_dwordx4 v10, s[8:11], s93 offen offset:2048 sc1 lds
v_mfma_f32_16x16x32_bf16 v[228:231], a[200:203], v[180:183], v[228:231]
v_mfma_f32_16x16x32_bf16 v[224:227], a[204:207], v[184:187], v[224:227]
v_mfma_f32_16x16x32_bf16 v[228:231], a[204:207], v[188:191], v[228:231]
v_mfma_f32_16x16x32_bf16 v[224:227], a[208:211], v[192:195], v[224:227]
buffer_load_dwordx4 v11, s[8:11], s93 offen offset:3072 sc1 lds
v_mfma_f32_16x16x32_bf16 v[228:231], a[208:211], v[196:199], v[228:231]
v_mfma_f32_16x16x32_bf16 v[224:227], a[212:215], v[200:203], v[224:227]
v_mfma_f32_16x16x32_bf16 v[228:231], a[212:215], v[204:207], v[228:231]
s_nop 6
v_cvt_pk_bf16_f32 v56, v224, v225
v_cvt_pk_bf16_f32 v57, v226, v227
v_cvt_pk_bf16_f32 v58, v228, v229
v_cvt_pk_bf16_f32 v59, v230, v231
s_nop 0
v_permlane16_swap_b32 v56, v58
v_permlane16_swap_b32 v57, v59
buffer_store_dwordx4 v[56:59], v21, s[4:7], s84 offen sc1
s_mov_b32 s84, 1879048192
s_waitcnt vmcnt(6)
s_branch g_go_129
g_notyet_128:
v_mfma_f32_16x16x32_bf16 v[228:231], a[180:183], v[140:143], v[228:231]
s_add_u32 m0, s75, 0
v_cvt_pk_bf16_f32 v53, v218, v219
v_mfma_f32_16x16x32_bf16 v[224:227], a[184:187], v[144:147], v[224:227]
buffer_load_dwordx4 v8, s[8:11], s93 offen offset:0 sc1 lds
v_mfma_f32_16x16x32_bf16 v[228:231], a[184:187], v[148:151], v[228:231]
v_cvt_pk_bf16_f32 v54, v220, v221
v_cvt_pk_bf16_f32 v55, v222, v223
v_mfma_f32_16x16x32_bf16 v[224:227], a[188:191], v[152:155], v[224:227]
v_permlane16_swap_b32 v52, v54
v_mfma_f32_16x16x32_bf16 v[228:231], a[188:191], v[156:159], v[228:231]
v_permlane16_swap_b32 v53, v55
v_mfma_f32_16x16x32_bf16 v[224:227], a[192:195], v[160:163], v[224:227]
buffer_load_dwordx4 v9, s[8:11], s93 offen offset:1024 sc1 lds
v_mfma_f32_16x16x32_bf16 v[228:231], a[192:195], v[164:167], v[228:231]
buffer_store_dwordx4 v[52:55], v20, s[4:7], s84 offen sc1
v_mfma_f32_16x16x32_bf16 v[224:227], a[196:199], v[168:171], v[224:227]
v_mfma_f32_16x16x32_bf16 v[228:231], a[196:199], v[172:175], v[228:231]
v_mfma_f32_16x16x32_bf16 v[224:227], a[200:203], v[176:179], v[224:227]
buffer_load_dwordx4 v10, s[8:11], s93 offen offset:2048 sc1 lds
v_mfma_f32_16x16x32_bf16 v[228:231], a[200:203], v[180:183], v[228:231]
v_mfma_f32_16x16x32_bf16 v[224:227], a[204:207], v[184:187], v[224:227]
v_mfma_f32_16x16x32_bf16 v[228:231], a[204:207], v[188:191], v[228:231]
v_mfma_f32_16x16x32_bf16 v[224:227], a[208:211], v[192:195], v[224:227]
buffer_load_dwordx4 v11, s[8:11], s93 offen offset:3072 sc1 lds
v_mfma_f32_16x16x32_bf16 v[228:231], a[208:211], v[196:199], v[228:231]
v_mfma_f32_16x16x32_bf16 v[224:227], a[212:215], v[200:203], v[224:227]
v_mfma_f32_16x16x32_bf16 v[228:231], a[212:215], v[204:207], v[228:231]
s_nop 6
v_cvt_pk_bf16_f32 v56, v224, v225
v_cvt_pk_bf16_f32 v57, v226, v227
v_cvt_pk_bf16_f32 v58, v228, v229
v_cvt_pk_bf16_f32 v59, v230, v231
s_nop 0
v_permlane16_swap_b32 v56, v58
v_permlane16_swap_b32 v57, v59
buffer_store_dwordx4 v[56:59], v21, s[4:7], s84 offen sc1
s_mov_b32 s84, 1879048192
v_mov_b32 v27, s81
s_lshl_b32 s70, s82, 10
s_waitcnt vmcnt(0)
s_barrier
buffer_store_dword v27, v45, s[4:7], s70 offen
buffer_store_dword v27, v44, s[4:7], s70 offen sc1
s_mov_b32 s82, 1835008
s_cmp_eq_u32 s86, -1
s_cbranch_scc1 g_fin_109
s_cmp_lg_u32 s3, 0
s_cbranch_scc1 sp_ok_131
s_mov_b32 s55, 0
sp_loop_130:
s_lshl_b64 exec, s[56:57], s87
buffer_load_dword v26, v22, s[4:7], 0 offen sc1
s_mov_b64 exec, -1
s_add_u32 s55, s55, 1
s_cmp_gt_u32 s55, 150000
s_cbranch_scc1 sp_bad_132
s_waitcnt vmcnt(0)
v_cmp_gt_u32 vcc, s86, v26
s_nop 0
s_lshr_b64 s[58:59], vcc, s87
s_and_b32 s58, s58, s56
s_cbranch_scc0 sp_ok_131
s_sleep 1
s_branch sp_loop_130
sp_bad_132:
s_mov_b32 s98, 1027
s_branch L_fail
sp_ok_131:
s_barrier
s_add_u32 m0, s74, 0
s_nop 0
buffer_load_dwordx4 v8, s[4:7], s88 offen offset:0 sc1 lds
buffer_load_dwordx4 v9, s[4:7], s88 offen offset:1024 sc1 lds
buffer_load_dwordx4 v10, s[4:7], s88 offen offset:2048 sc1 lds
buffer_load_dwordx4 v11, s[4:7], s88 offen offset:3072 sc1 lds
s_add_u32 m0, s74, 4096
s_nop 0
buffer_load_dwordx4 v12, s[4:7], s88 offen offset:0 sc1 lds
buffer_load_dwordx4 v13, s[4:7], s88 offen offset:1024 sc1 lds
buffer_load_dwordx4 v14, s[4:7], s88 offen offset:2048 sc1 lds
buffer_load_dwordx4 v15, s[4:7], s88 offen offset:3072 sc1 lds
s_add_u32 m0, s74, 8192
s_nop 0
buffer_load_dwordx4 v16, s[4:7], s88 offen offset:0 sc1 lds
s_waitcnt vmcnt(0)
g_go_129:
g_join_107:
s_barrier
ds_read_b128 v[64:67], v30 offset:0
ds_read_b128 v[68:71], v30 offset:9216
ds_read_b128 v[72:75], v30 offset:18432
ds_read_b128 v[76:79], v30 offset:27648
ds_read_b128 v[80:83], v30 offset:1024
ds_read_b128 v[84:87], v30 offset:10240
ds_read_b128 v[88:91], v30 offset:19456
ds_read_b128 v[92:95], v30 offset:28672
s_branch g_body_103
g_slow_119:
v_cmp_gt_u32 vcc, s91, v33
s_nop 0
s_lshr_b64 s[58:59], vcc, s92
s_and_b32 s58, s58, s56
s_cbranch_scc1 g_notyet_133
s_add_u32 m0, s75, 0
s_nop 0
buffer_load_dwordx4 v8, s[4:7], s93 offen offset:0 sc1 lds
buffer_load_dwordx4 v9, s[4:7], s93 offen offset:1024 sc1 lds
buffer_load_dwordx4 v10, s[4:7], s93 offen offset:2048 sc1 lds
buffer_load_dwordx4 v11, s[4:7], s93 offen offset:3072 sc1 lds
s_add_u32 m0, s75, 4096
s_nop 0
buffer_load_dwordx4 v12, s[4:7], s93 offen offset:0 sc1 lds
buffer_load_dwordx4 v13, s[4:7], s93 offen offset:1024 sc1 lds
buffer_load_dwordx4 v14, s[4:7], s93 offen offset:2048 sc1 lds
buffer_load_dwordx4 v15, s[4:7], s93 offen offset:3072 sc1 lds
s_add_u32 m0, s75, 8192
s_nop 0
buffer_load_dwordx4 v16, s[4:7], s93 offen offset:0 sc1 lds
v_mfma_f32_16x16x32_bf16 v[228:231], a[180:183], v[140:143], v[228:231]
s_add_u32 m0, s72, 0
v_cvt_pk_bf16_f32 v53, v218, v219
v_mfma_f32_16x16x32_bf16 v[224:227], a[184:187], v[144:147], v[224:227]
buffer_load_dwordx4 v8, s[8:11], s78 offen offset:0 sc1 lds
v_mfma_f32_16x16x32_bf16 v[228:231], a[184:187], v[148:151], v[228:231]
v_cvt_pk_bf16_f32 v54, v220, v221
v_cvt_pk_bf16_f32 v55, v222, v223
v_mfma_f32_16x16x32_bf16 v[224:227], a[188:191], v[152:155], v[224:227]
v_permlane16_swap_b32 v52, v54
v_mfma_f32_16x16x32_bf16 v[228:231], a[188:191], v[156:159], v[228:231]
v_permlane16_swap_b32 v53, v55
v_mfma_f32_16x16x32_bf16 v[224:227], a[192:195], v[160:163], v[224:227]
buffer_load_dwordx4 v9, s[8:11], s78 offen offset:1024 sc1 lds
v_mfma_f32_16x16x32_bf16 v[228:231], a[192:195], v[164:167], v[228:231]
buffer_store_dwordx4 v[52:55], v20, s[4:7], s89 offen sc1
v_mfma_f32_16x16x32_bf16 v[224:227], a[196:199], v[168:171], v[224:227]
v_mfma_f32_16x16x32_bf16 v[228:231], a[196:199], v[172:175], v[228:231]
v_mfma_f32_16x16x32_bf16 v[224:227], a[200:203], v[176:179], v[224:227]
buffer_load_dwordx4 v10, s[8:11], s78 offen offset:2048 sc1 lds
v_mfma_f32_16x16x32_bf16 v[228:231], a[200:203], v[180:183], v[228:231]
v_mfma_f32_16x16x32_bf16 v[224:227], a[204:207], v[184:187], v[224:227]
v_mfma_f32_16x16x32_bf16 v[228:231], a[204:207], v[188:191], v[228:231]
v_mfma_f32_16x16x32_bf16 v[224:227], a[208:211], v[192:195], v[224:227]
buffer_load_dwordx4 v11, s[8:11], s78 offen offset:3072 sc1 lds
v_mfma_f32_16x16x32_bf16 v[228:231], a[208:211], v[196:199], v[228:231]
v_mfma_f32_16x16x32_bf16 v[224:227], a[212:215], v[200:203], v[224:227]
v_mfma_f32_16x16x32_bf16 v[228:231], a[212:215], v[204:207], v[228:231]
s_nop 6
v_cvt_pk_bf16_f32 v56, v224, v225
v_cvt_pk_bf16_f32 v57, v226, v227
v_cvt_pk_bf16_f32 v58, v228, v229
v_cvt_pk_bf16_f32 v59, v230, v231
s_nop 0
v_permlane16_swap_b32 v56, v58
v_permlane16_swap_b32 v57, v59
buffer_store_dwordx4 v[56:59], v21, s[4:7], s89 offen sc1
s_mov_b32 s89, 1879048192
s_waitcnt vmcnt(6)
s_branch g_go_134
g_notyet_133:
v_mfma_f32_16x16x32_bf16 v[228:231], a[180:183], v[140:143], v[228:231]
s_add_u32 m0, s72, 0
v_cvt_pk_bf16_f32 v53, v218, v219
v_mfma_f32_16x16x32_bf16 v[224:227], a[184:187], v[144:147], v[224:227]
buffer_load_dwordx4 v8, s[8:11], s78 offen offset:0 sc1 lds
v_mfma_f32_16x16x32_bf16 v[228:231], a[184:187], v[148:151], v[228:231]
v_cvt_pk_bf16_f32 v54, v220, v221
v_cvt_pk_bf16_f32 v55, v222, v223
v_mfma_f32_16x16x32_bf16 v[224:227], a[188:191], v[152:155], v[224:227]
v_permlane16_swap_b32 v52, v54
v_mfma_f32_16x16x32_bf16 v[228:231], a[188:191], v[156:159], v[228:231]
v_permlane16_swap_b32 v53, v55
v_mfma_f32_16x16x32_bf16 v[224:227], a[192:195], v[160:163], v[224:227]
buffer_load_dwordx4 v9, s[8:11], s78 offen offset:1024 sc1 lds
v_mfma_f32_16x16x32_bf16 v[228:231], a[192:195], v[164:167], v[228:231]
buffer_store_dwordx4 v[52:55], v20, s[4:7], s89 offen sc1
v_mfma_f32_16x16x32_bf16 v[224:227], a[196:199], v[168:171], v[224:227]
v_mfma_f32_16x16x32_bf16 v[228:231], a[196:199], v[172:175], v[228:231]
v_mfma_f32_16x16x32_bf16 v[224:227], a[200:203], v[176:179], v[224:227]
buffer_load_dwordx4 v10, s[8:11], s78 offen offset:2048 sc1 lds
v_mfma_f32_16x16x32_bf16 v[228:231], a[200:203], v[180:183], v[228:231]
v_mfma_f32_16x16x32_bf16 v[224:227], a[204:207], v[184:187], v[224:227]
v_mfma_f32_16x16x32_bf16 v[228:231], a[204:207], v[188:191], v[228:231]
v_mfma_f32_16x16x32_bf16 v[224:227], a[208:211], v[192:195], v[224:227]
buffer_load_dwordx4 v11, s[8:11], s78 offen offset:3072 sc1 lds
v_mfma_f32_16x16x32_bf16 v[228:231], a[208:211], v[196:199], v[228:231]
v_mfma_f32_16x16x32_bf16 v[224:227], a[212:215], v[200:203], v[224:227]
v_mfma_f32_16x16x32_bf16 v[228:231], a[212:215], v[204:207], v[228:231]
s_nop 6
v_cvt_pk_bf16_f32 v56, v224, v225
v_cvt_pk_bf16_f32 v57, v226, v227
v_cvt_pk_bf16_f32 v58, v228, v229
v_cvt_pk_bf16_f32 v59, v230, v231
s_nop 0
v_permlane16_swap_b32 v56, v58
v_permlane16_swap_b32 v57, v59
buffer_store_dwordx4 v[56:59], v21, s[4:7], s89 offen sc1
s_mov_b32 s89, 1879048192
v_mov_b32 v27, s86
s_lshl_b32 s70, s87, 10
s_waitcnt vmcnt(0)
s_barrier
buffer_store_dword v27, v45, s[4:7], s70 offen
buffer_store_dword v27, v44, s[4:7], s70 offen sc1
s_mov_b32 s87, 1835008
s_cmp_eq_u32 s91, -1
s_cbranch_scc1 g_fin_109
s_cmp_lg_u32 s3, 0
s_cbranch_scc1 sp_ok_136
s_mov_b32 s55, 0
sp_loop_135:
s_lshl_b64 exec, s[56:57], s92
buffer_load_dword v26, v22, s[4:7], 0 offen sc1
s_mov_b64 exec, -1
s_add_u32 s55, s55, 1
s_cmp_gt_u32 s55, 150000
s_cbranch_scc1 sp_bad_137
s_waitcnt vmcnt(0)
v_cmp_gt_u32 vcc, s91, v26
s_nop 0
s_lshr_b64 s[58:59], vcc, s92
s_and_b32 s58, s58, s56
s_cbranch_scc0 sp_ok_136
s_sleep 1
s_branch sp_loop_135
sp_bad_137:
s_mov_b32 s98, 1027
s_branch L_fail
sp_ok_136:
s_barrier
s_add_u32 m0, s75, 0
s_nop 0
buffer_load_dwordx4 v8, s[4:7], s93 offen offset:0 sc1 lds
buffer_load_dwordx4 v9, s[4:7], s93 offen offset:1024 sc1 lds
buffer_load_dwordx4 v10, s[4:7], s93 offen offset:2048 sc1 lds
buffer_load_dwordx4 v11, s[4:7], s93 offen offset:3072 sc1 lds
s_add_u32 m0, s75, 4096
s_nop 0
buffer_load_dwordx4 v12, s[4:7], s93 offen offset:0 sc1 lds
buffer_load_dwordx4 v13, s[4:7], s93 offen offset:1024 sc1 lds
buffer_load_dwordx4 v14, s[4:7], s93 offen offset:2048 sc1 lds
buffer_load_dwordx4 v15, s[4:7], s93 offen offset:3072 sc1 lds
s_add_u32 m0, s75, 8192
s_nop 0
buffer_load_dwordx4 v16, s[4:7], s93 offen offset:0 sc1 lds
s_waitcnt vmcnt(0)
g_go_134:
g_join_108:
s_barrier
ds_read_b128 v[64:67], v31 offset:0
ds_read_b128 v[68:71], v31 offset:9216
ds_read_b128 v[72:75], v31 offset:18432
ds_read_b128 v[76:79], v31 offset:27648
ds_read_b128 v[80:83], v31 offset:1024
ds_read_b128 v[84:87], v31 offset:10240
ds_read_b128 v[88:91], v31 offset:19456
ds_read_b128 v[92:95], v31 offset:28672
s_branch g_body_104
g_slow_120:
v_cmp_gt_u32 vcc, s76, v33
s_nop 0
s_lshr_b64 s[58:59], vcc, s77
s_and_b32 s58, s58, s56
s_cbranch_scc1 g_notyet_138
s_add_u32 m0, s72, 0
s_nop 0
buffer_load_dwordx4 v8, s[4:7], s78 offen offset:0 sc1 lds
buffer_load_dwordx4 v9, s[4:7], s78 offen offset:1024 sc1 lds
buffer_load_dwordx4 v10, s[4:7], s78 offen offset:2048 sc1 lds
buffer_load_dwordx4 v11, s[4:7], s78 offen offset:3072 sc1 lds
s_add_u32 m0, s72, 4096
s_nop 0
buffer_load_dwordx4 v12, s[4:7], s78 offen offset:0 sc1 lds
buffer_load_dwordx4 v13, s[4:7], s78 offen offset:1024 sc1 lds
buffer_load_dwordx4 v14, s[4:7], s78 offen offset:2048 sc1 lds
buffer_load_dwordx4 v15, s[4:7], s78 offen offset:3072 sc1 lds
s_add_u32 m0, s72, 8192
s_nop 0
buffer_load_dwordx4 v16, s[4:7], s78 offen offset:0 sc1 lds
v_mfma_f32_16x16x32_bf16 v[228:231], a[180:183], v[140:143], v[228:231]
s_add_u32 m0, s73, 0
v_cvt_pk_bf16_f32 v53, v218, v219
v_mfma_f32_16x16x32_bf16 v[224:227], a[184:187], v[144:147], v[224:227]
buffer_load_dwordx4 v8, s[8:11], s83 offen offset:0 sc1 lds
v_mfma_f32_16x16x32_bf16 v[228:231], a[184:187], v[148:151], v[228:231]
v_cvt_pk_bf16_f32 v54, v220, v221
v_cvt_pk_bf16_f32 v55, v222, v223
v_mfma_f32_16x16x32_bf16 v[224:227], a[188:191], v[152:155], v[224:227]
v_permlane16_swap_b32 v52, v54
v_mfma_f32_16x16x32_bf16 v[228:231], a[188:191], v[156:159], v[228:231]
v_permlane16_swap_b32 v53, v55
v_mfma_f32_16x16x32_bf16 v[224:227], a[192:195], v[160:163], v[224:227]
buffer_load_dwordx4 v9, s[8:11], s83 offen offset:1024 sc1 lds
v_mfma_f32_16x16x32_bf16 v[228:231], a[192:195], v[164:167], v[228:231]
buffer_store_dwordx4 v[52:55], v20, s[4:7], s94 offen sc1
v_mfma_f32_16x16x32_bf16 v[224:227], a[196:199], v[168:171], v[224:227]
v_mfma_f32_16x16x32_bf16 v[228:231], a[196:199], v[172:175], v[228:231]
v_mfma_f32_16x16x32_bf16 v[224:227], a[200:203], v[176:179], v[224:227]
buffer_load_dwordx4 v10, s[8:11], s83 offen offset:2048 sc1 lds
v_mfma_f32_16x16x32_bf16 v[228:231], a[200:203], v[180:183], v[228:231]
v_mfma_f32_16x16x32_bf16 v[224:227], a[204:207], v[184:187], v[224:227]
v_mfma_f32_16x16x32_bf16 v[228:231], a[204:207], v[188:191], v[228:231]
v_mfma_f32_16x16x32_bf16 v[224:227], a[208:211], v[192:195], v[224:227]
buffer_load_dwordx4 v11, s[8:11], s83 offen offset:3072 sc1 lds
v_mfma_f32_16x16x32_bf16 v[228:231], a[208:211], v[196:199], v[228:231]
v_mfma_f32_16x16x32_bf16 v[224:227], a[212:215], v[200:203], v[224:227]
v_mfma_f32_16x16x32_bf16 v[228:231], a[212:215], v[204:207], v[228:231]
s_nop 6
v_cvt_pk_bf16_f32 v56, v224, v225
v_cvt_pk_bf16_f32 v57, v226, v227
v_cvt_pk_bf16_f32 v58, v228, v229
v_cvt_pk_bf16_f32 v59, v230, v231
s_nop 0
v_permlane16_swap_b32 v56, v58
v_permlane16_swap_b32 v57, v59
buffer_store_dwordx4 v[56:59], v21, s[4:7], s94 offen sc1
s_mov_b32 s94, 1879048192
s_waitcnt vmcnt(6)
s_branch g_go_139
g_notyet_138:
v_mfma_f32_16x16x32_bf16 v[228:231], a[180:183], v[140:143], v[228:231]
s_add_u32 m0, s73, 0
v_cvt_pk_bf16_f32 v53, v218, v219
v_mfma_f32_16x16x32_bf16 v[224:227], a[184:187], v[144:147], v[224:227]
buffer_load_dwordx4 v8, s[8:11], s83 offen offset:0 sc1 lds
v_mfma_f32_16x16x32_bf16 v[228:231], a[184:187], v[148:151], v[228:231]
v_cvt_pk_bf16_f32 v54, v220, v221
v_cvt_pk_bf16_f32 v55, v222, v223
v_mfma_f32_16x16x32_bf16 v[224:227], a[188:191], v[152:155], v[224:227]
v_permlane16_swap_b32 v52, v54
v_mfma_f32_16x16x32_bf16 v[228:231], a[188:191], v[156:159], v[228:231]
v_permlane16_swap_b32 v53, v55
v_mfma_f32_16x16x32_bf16 v[224:227], a[192:195], v[160:163], v[224:227]
buffer_load_dwordx4 v9, s[8:11], s83 offen offset:1024 sc1 lds
v_mfma_f32_16x16x32_bf16 v[228:231], a[192:195], v[164:167], v[228:231]
buffer_store_dwordx4 v[52:55], v20, s[4:7], s94 offen sc1
v_mfma_f32_16x16x32_bf16 v[224:227], a[196:199], v[168:171], v[224:227]
v_mfma_f32_16x16x32_bf16 v[228:231], a[196:199], v[172:175], v[228:231]
v_mfma_f32_16x16x32_bf16 v[224:227], a[200:203], v[176:179], v[224:227]
buffer_load_dwordx4 v10, s[8:11], s83 offen offset:2048 sc1 lds
v_mfma_f32_16x16x32_bf16 v[228:231], a[200:203], v[180:183], v[228:231]
v_mfma_f32_16x16x32_bf16 v[224:227], a[204:207], v[184:187], v[224:227]
v_mfma_f32_16x16x32_bf16 v[228:231], a[204:207], v[188:191], v[228:231]
v_mfma_f32_16x16x32_bf16 v[224:227], a[208:211], v[192:195], v[224:227]
buffer_load_dwordx4 v11, s[8:11], s83 offen offset:3072 sc1 lds
v_mfma_f32_16x16x32_bf16 v[228:231], a[208:211], v[196:199], v[228:231]
v_mfma_f32_16x16x32_bf16 v[224:227], a[212:215], v[200:203], v[224:227]
v_mfma_f32_16x16x32_bf16 v[228:231], a[212:215], v[204:207], v[228:231]
s_nop 6
v_cvt_pk_bf16_f32 v56, v224, v225
v_cvt_pk_bf16_f32 v57, v226, v227
v_cvt_pk_bf16_f32 v58, v228, v229
v_cvt_pk_bf16_f32 v59, v230, v231
s_nop 0
v_permlane16_swap_b32 v56, v58
v_permlane16_swap_b32 v57, v59
buffer_store_dwordx4 v[56:59], v21, s[4:7], s94 offen sc1
s_mov_b32 s94, 1879048192
v_mov_b32 v27, s91
s_lshl_b32 s70, s92, 10
s_waitcnt vmcnt(0)
s_barrier
buffer_store_dword v27, v45, s[4:7], s70 offen
buffer_store_dword v27, v44, s[4:7], s70 offen sc1
s_mov_b32 s92, 1835008
s_cmp_eq_u32 s76, -1
s_cbranch_scc1 g_fin_109
s_cmp_lg_u32 s3, 0
s_cbranch_scc1 sp_ok_141
s_mov_b32 s55, 0
sp_loop_140:
s_lshl_b64 exec, s[56:57], s77
buffer_load_dword v26, v22, s[4:7], 0 offen sc1
s_mov_b64 exec, -1
s_add_u32 s55, s55, 1
s_cmp_gt_u32 s55, 150000
s_cbranch_scc1 sp_bad_142
s_waitcnt vmcnt(0)
v_cmp_gt_u32 vcc, s76, v26
s_nop 0
s_lshr_b64 s[58:59], vcc, s77
s_and_b32 s58, s58, s56
s_cbranch_scc0 sp_ok_141
s_sleep 1
s_branch sp_loop_140
sp_bad_142:
s_mov_b32 s98, 1027
s_branch L_fail
sp_ok_141:
s_barrier
s_add_u32 m0, s72, 0
s_nop 0
buffer_load_dwordx4 v8, s[4:7], s78 offen offset:0 sc1 lds
buffer_load_dwordx4 v9, s[4:7], s78 offen offset:1024 sc1 lds
buffer_load_dwordx4 v10, s[4:7], s78 offen offset:2048 sc1 lds
buffer_load_dwordx4 v11, s[4:7], s78 offen offset:3072 sc1 lds
s_add_u32 m0, s72, 4096
s_nop 0
buffer_load_dwordx4 v12, s[4:7], s78 offen offset:0 sc1 lds
buffer_load_dwordx4 v13, s[4:7], s78 offen offset:1024 sc1 lds
buffer_load_dwordx4 v14, s[4:7], s78 offen offset:2048 sc1 lds
buffer_load_dwordx4 v15, s[4:7], s78 offen offset:3072 sc1 lds
s_add_u32 m0, s72, 8192
s_nop 0
buffer_load_dwordx4 v16, s[4:7], s78 offen offset:0 sc1 lds
s_waitcnt vmcnt(0)
g_go_139:
s_branch g_join_105
g_fin_109:
s_endpgm
rare_121:
v_mov_b32 v36, v40
v_mov_b32 v37, v41
v_mov_b32 v38, v42
v_mov_b32 v39, v43
s_branch back_122
H_dn:
s_mul_i32 s75, s74, 43
s_lshr_b32 s75, s75, 7
s_mul_i32 s76, s75, 3
s_sub_u32 s76, s74, s76
s_mov_b32 s8, s36
s_and_b32 s9, s37, 0xffff
s_mov_b32 s10, 5308416
s_mov_b32 s11, 0x20000
s_mul_i32 s77, s76, 12
s_mul_i32 s78, s3, 3
s_add_u32 s77, s77, s78
s_mul_i32 s78, s75, 663552
v_bfe_u32 v1, v0, 4, 1
v_bfe_u32 v2, v0, 1, 3
v_lshl_add_u32 v1, v1, 3, v2
v_mul_u32_u24 v1, 2304, v1
v_lshrrev_b32 v2, 5, v0
v_lshl_add_u32 v1, v2, 5, v1
v_and_b32 v2, 1, v0
v_lshl_add_u32 v5, v2, 4, v1
s_mul_i32 s79, s75, 36864
s_add_u32 s80, s77, 0
s_lshl_b32 s81, s80, 5
s_add_u32 s48, s81, s78
s_lshl_b32 s81, s80, 6
s_add_u32 s81, s81, s79
v_add_u32 v19, s81, v5
s_add_u32 s80, s77, 1
s_lshl_b32 s81, s80, 5
s_add_u32 s49, s81, s78
s_lshl_b32 s81, s80, 6
s_add_u32 s81, s81, s79
v_add_u32 v20, s81, v5
s_add_u32 s80, s77, 2
s_lshl_b32 s81, s80, 5
s_add_u32 s50, s81, s78
s_lshl_b32 s81, s80, 6
s_add_u32 s81, s81, s79
v_add_u32 v21, s81, v5
s_getpc_b64 s[96:97]
pc_143:
s_add_u32 s96, s96, L_order_post-pc_143
s_addc_u32 s97, s97, 0
v_lshlrev_b32 v1, 2, v0
global_load_dword v36, v1, s[96:97]
global_load_dword v40, v1, s[96:97] offset:256
v_lshrrev_b32 v1, 5, v0
v_bfe_u32 v2, v0, 3, 1
v_lshl_add_u32 v1, v1, 1, v2
v_bfe_u32 v2, v0, 4, 1
v_bfe_u32 v3, v0, 1, 2
v_lshlrev_b32 v1, 3, v1
v_lshl_add_u32 v1, v2, 2, v1
v_add_u32 v1, v1, v3
v_mul_u32_u24 v1, 1152, v1
v_and_b32 v2, 1, v0
v_lshl_add_u32 v63, v2, 4, v1
s_mul_i32 s70, s3, 40960
v_lshrrev_b32 v1, 5, v0
v_lshlrev_b32 v1, 9, v1
v_bfe_u32 v2, v0, 4, 1
v_lshl_add_u32 v1, v2, 7, v1
v_add_u32 v1, s70, v1
v_and_b32 v2, 15, v0
v_lshl_add_u32 v2, v2, 3, v1
v_add_u32 v60, 0, v2
v_add_u32 v61, 1024, v2
v_add_u32 v62, 2048, v2
s_add_u32 m0, s70, 0
s_add_u32 s71, s48, 0
buffer_load_dwordx4 v63, s[8:11], s71 offen lds
s_add_u32 m0, s70, 1024
s_add_u32 s71, s49, 0
buffer_load_dwordx4 v63, s[8:11], s71 offen lds
s_add_u32 m0, s70, 2048
s_add_u32 s71, s50, 0
buffer_load_dwordx4 v63, s[8:11], s71 offen lds
s_add_u32 m0, s70, 3072
s_add_u32 s71, s48, 36864
buffer_load_dwordx4 v63, s[8:11], s71 offen lds
s_add_u32 m0, s70, 4096
s_add_u32 s71, s49, 36864
buffer_load_dwordx4 v63, s[8:11], s71 offen lds
s_add_u32 m0, s70, 5120
s_add_u32 s71, s50, 36864
buffer_load_dwordx4 v63, s[8:11], s71 offen lds
s_add_u32 m0, s70, 6144
s_add_u32 s71, s48, 73728
buffer_load_dwordx4 v63, s[8:11], s71 offen lds
s_add_u32 m0, s70, 7168
s_add_u32 s71, s49, 73728
buffer_load_dwordx4 v63, s[8:11], s71 offen lds
s_add_u32 m0, s70, 8192
s_add_u32 s71, s50, 73728
buffer_load_dwordx4 v63, s[8:11], s71 offen lds
s_add_u32 m0, s70, 9216
s_add_u32 s71, s48, 110592
buffer_load_dwordx4 v63, s[8:11], s71 offen lds
s_add_u32 m0, s70, 10240
s_add_u32 s71, s49, 110592
buffer_load_dwordx4 v63, s[8:11], s71 offen lds
s_add_u32 m0, s70, 11264
s_add_u32 s71, s50, 110592
buffer_load_dwordx4 v63, s[8:11], s71 offen lds
s_add_u32 m0, s70, 12288
s_add_u32 s71, s48, 147456
buffer_load_dwordx4 v63, s[8:11], s71 offen lds
s_add_u32 m0, s70, 13312
s_add_u32 s71, s49, 147456
buffer_load_dwordx4 v63, s[8:11], s71 offen lds
s_add_u32 m0, s70, 14336
s_add_u32 s71, s50, 147456
buffer_load_dwordx4 v63, s[8:11], s71 offen lds
s_add_u32 m0, s70, 15360
s_add_u32 s71, s48, 184320
buffer_load_dwordx4 v63, s[8:11], s71 offen lds
s_add_u32 m0, s70, 16384
s_add_u32 s71, s49, 184320
buffer_load_dwordx4 v63, s[8:11], s71 offen lds
s_add_u32 m0, s70, 17408
s_add_u32 s71, s50, 184320
buffer_load_dwordx4 v63, s[8:11], s71 offen lds
s_add_u32 m0, s70, 18432
s_add_u32 s71, s48, 221184
buffer_load_dwordx4 v63, s[8:11], s71 offen lds
s_add_u32 m0, s70, 19456
s_add_u32 s71, s49, 221184
buffer_load_dwordx4 v63, s[8:11], s71 offen lds
s_add_u32 m0, s70, 20480
s_add_u32 s71, s50, 221184
buffer_load_dwordx4 v63, s[8:11], s71 offen lds
s_add_u32 m0, s70, 21504
s_add_u32 s71, s48, 258048
buffer_load_dwordx4 v63, s[8:11], s71 offen lds
s_add_u32 m0, s70, 22528
s_add_u32 s71, s49, 258048
buffer_load_dwordx4 v63, s[8:11], s71 offen lds
s_add_u32 m0, s70, 23552
s_add_u32 s71, s50, 258048
buffer_load_dwordx4 v63, s[8:11], s71 offen lds
s_add_u32 m0, s70, 24576
s_add_u32 s71, s48, 294912
buffer_load_dwordx4 v63, s[8:11], s71 offen lds
s_add_u32 m0, s70, 25600
s_add_u32 s71, s49, 294912
buffer_load_dwordx4 v63, s[8:11], s71 offen lds
s_add_u32 m0, s70, 26624
s_add_u32 s71, s50, 294912
buffer_load_dwordx4 v63, s[8:11], s71 offen lds
s_add_u32 m0, s70, 27648
s_add_u32 s71, s48, 331776
buffer_load_dwordx4 v63, s[8:11], s71 offen lds
s_add_u32 m0, s70, 28672
s_add_u32 s71, s49, 331776
buffer_load_dwordx4 v63, s[8:11], s71 offen lds
s_add_u32 m0, s70, 29696
s_add_u32 s71, s50, 331776
buffer_load_dwordx4 v63, s[8:11], s71 offen lds
s_add_u32 m0, s70, 30720
s_add_u32 s71, s48, 368640
buffer_load_dwordx4 v63, s[8:11], s71 offen lds
s_add_u32 m0, s70, 31744
s_add_u32 s71, s49, 368640
buffer_load_dwordx4 v63, s[8:11], s71 offen lds
s_add_u32 m0, s70, 32768
s_add_u32 s71, s50, 368640
buffer_load_dwordx4 v63, s[8:11], s71 offen lds
s_add_u32 m0, s70, 33792
s_add_u32 s71, s48, 405504
buffer_load_dwordx4 v63, s[8:11], s71 offen lds
s_add_u32 m0, s70, 34816
s_add_u32 s71, s49, 405504
buffer_load_dwordx4 v63, s[8:11], s71 offen lds
s_add_u32 m0, s70, 35840
s_add_u32 s71, s50, 405504
buffer_load_dwordx4 v63, s[8:11], s71 offen lds
s_add_u32 m0, s70, 36864
s_add_u32 s71, s48, 442368
buffer_load_dwordx4 v63, s[8:11], s71 offen lds
s_add_u32 m0, s70, 37888
s_add_u32 s71, s49, 442368
buffer_load_dwordx4 v63, s[8:11], s71 offen lds
s_add_u32 m0, s70, 38912
s_add_u32 s71, s50, 442368
buffer_load_dwordx4 v63, s[8:11], s71 offen lds
s_waitcnt vmcnt(36)
ds_read_b64_tr_b16 a[0:1], v60 offset:0
ds_read_b64_tr_b16 a[2:3], v60 offset:256
ds_read_b64_tr_b16 a[72:73], v61 offset:0
ds_read_b64_tr_b16 a[74:75], v61 offset:256
ds_read_b64_tr_b16 a[144:145], v62 offset:0
ds_read_b64_tr_b16 a[146:147], v62 offset:256
s_waitcnt lgkmcnt(0)
s_add_u32 m0, s70, 0
s_add_u32 s71, s48, 479232
buffer_load_dwordx4 v63, s[8:11], s71 offen lds
s_add_u32 m0, s70, 1024
s_add_u32 s71, s49, 479232
buffer_load_dwordx4 v63, s[8:11], s71 offen lds
s_add_u32 m0, s70, 2048
s_add_u32 s71, s50, 479232
buffer_load_dwordx4 v63, s[8:11], s71 offen lds
s_waitcnt vmcnt(36)
ds_read_b64_tr_b16 a[4:5], v60 offset:3072
ds_read_b64_tr_b16 a[6:7], v60 offset:3328
ds_read_b64_tr_b16 a[76:77], v61 offset:3072
ds_read_b64_tr_b16 a[78:79], v61 offset:3328
ds_read_b64_tr_b16 a[148:149], v62 offset:3072
ds_read_b64_tr_b16 a[150:151], v62 offset:3328
s_waitcnt lgkmcnt(0)
s_add_u32 m0, s70, 3072
s_add_u32 s71, s48, 516096
buffer_load_dwordx4 v63, s[8:11], s71 offen lds
s_add_u32 m0, s70, 4096
s_add_u32 s71, s49, 516096
buffer_load_dwordx4 v63, s[8:11], s71 offen lds
s_add_u32 m0, s70, 5120
s_add_u32 s71, s50, 516096
buffer_load_dwordx4 v63, s[8:11], s71 offen lds
s_waitcnt vmcnt(36)
ds_read_b64_tr_b16 a[8:9], v60 offset:6144
ds_read_b64_tr_b16 a[10:11], v60 offset:6400
ds_read_b64_tr_b16 a[80:81], v61 offset:6144
ds_read_b64_tr_b16 a[82:83], v61 offset:6400
ds_read_b64_tr_b16 a[152:153], v62 offset:6144
ds_read_b64_tr_b16 a[154:155], v62 offset:6400
s_waitcnt lgkmcnt(0)
s_add_u32 m0, s70, 6144
s_add_u32 s71, s48, 552960
buffer_load_dwordx4 v63, s[8:11], s71 offen lds
s_add_u32 m0, s70, 7168
s_add_u32 s71, s49, 552960
buffer_load_dwordx4 v63, s[8:11], s71 offen lds
s_add_u32 m0, s70, 8192
s_add_u32 s71, s50, 552960
buffer_load_dwordx4 v63, s[8:11], s71 offen lds
s_waitcnt vmcnt(36)
ds_read_b64_tr_b16 a[12:13], v60 offset:9216
ds_read_b64_tr_b16 a[14:15], v60 offset:9472
ds_read_b64_tr_b16 a[84:85], v61 offset:9216
ds_read_b64_tr_b16 a[86:87], v61 offset:9472
ds_read_b64_tr_b16 a[156:157], v62 offset:9216
ds_read_b64_tr_b16 a[158:159], v62 offset:9472
s_waitcnt lgkmcnt(0)
s_add_u32 m0, s70, 9216
s_add_u32 s71, s48, 589824
buffer_load_dwordx4 v63, s[8:11], s71 offen lds
s_add_u32 m0, s70, 10240
s_add_u32 s71, s49, 589824
buffer_load_dwordx4 v63, s[8:11], s71 offen lds
s_add_u32 m0, s70, 11264
s_add_u32 s71, s50, 589824
buffer_load_dwordx4 v63, s[8:11], s71 offen lds
s_waitcnt vmcnt(36)
ds_read_b64_tr_b16 a[16:17], v60 offset:12288
ds_read_b64_tr_b16 a[18:19], v60 offset:12544
ds_read_b64_tr_b16 a[88:89], v61 offset:12288
ds_read_b64_tr_b16 a[90:91], v61 offset:12544
ds_read_b64_tr_b16 a[160:161], v62 offset:12288
ds_read_b64_tr_b16 a[162:163], v62 offset:12544
s_waitcnt lgkmcnt(0)
s_add_u32 m0, s70, 12288
s_add_u32 s71, s48, 626688
buffer_load_dwordx4 v63, s[8:11], s71 offen lds
s_add_u32 m0, s70, 13312
s_add_u32 s71, s49, 626688
buffer_load_dwordx4 v63, s[8:11], s71 offen lds
s_add_u32 m0, s70, 14336
s_add_u32 s71, s50, 626688
buffer_load_dwordx4 v63, s[8:11], s71 offen lds
s_waitcnt vmcnt(36)
ds_read_b64_tr_b16 a[20:21], v60 offset:15360
ds_read_b64_tr_b16 a[22:23], v60 offset:15616
ds_read_b64_tr_b16 a[92:93], v61 offset:15360
ds_read_b64_tr_b16 a[94:95], v61 offset:15616
ds_read_b64_tr_b16 a[164:165], v62 offset:15360
ds_read_b64_tr_b16 a[166:167], v62 offset:15616
s_waitcnt vmcnt(33)
ds_read_b64_tr_b16 a[24:25], v60 offset:18432
ds_read_b64_tr_b16 a[26:27], v60 offset:18688
ds_read_b64_tr_b16 a[96:97], v61 offset:18432
ds_read_b64_tr_b16 a[98:99], v61 offset:18688
ds_read_b64_tr_b16 a[168:169], v62 offset:18432
ds_read_b64_tr_b16 a[170:171], v62 offset:18688
s_waitcnt vmcnt(30)
ds_read_b64_tr_b16 a[28:29], v60 offset:21504
ds_read_b64_tr_b16 a[30:31], v60 offset:21760
ds_read_b64_tr_b16 a[100:101], v61 offset:21504
ds_read_b64_tr_b16 a[102:103], v61 offset:21760
ds_read_b64_tr_b16 a[172:173], v62 offset:21504
ds_read_b64_tr_b16 a[174:175], v62 offset:21760
s_waitcnt vmcnt(27)
ds_read_b64_tr_b16 a[32:33], v60 offset:24576
ds_read_b64_tr_b16 a[34:35], v60 offset:24832
ds_read_b64_tr_b16 a[104:105], v61 offset:24576
ds_read_b64_tr_b16 a[106:107], v61 offset:24832
ds_read_b64_tr_b16 a[176:177], v62 offset:24576
ds_read_b64_tr_b16 a[178:179], v62 offset:24832
s_waitcnt vmcnt(24)
ds_read_b64_tr_b16 a[36:37], v60 offset:27648
ds_read_b64_tr_b16 a[38:39], v60 offset:27904
ds_read_b64_tr_b16 a[108:109], v61 offset:27648
ds_read_b64_tr_b16 a[110:111], v61 offset:27904
ds_read_b64_tr_b16 a[180:181], v62 offset:27648
ds_read_b64_tr_b16 a[182:183], v62 offset:27904
s_waitcnt vmcnt(21)
ds_read_b64_tr_b16 a[40:41], v60 offset:30720
ds_read_b64_tr_b16 a[42:43], v60 offset:30976
ds_read_b64_tr_b16 a[112:113], v61 offset:30720
ds_read_b64_tr_b16 a[114:115], v61 offset:30976
ds_read_b64_tr_b16 a[184:185], v62 offset:30720
ds_read_b64_tr_b16 a[186:187], v62 offset:30976
s_waitcnt vmcnt(18)
ds_read_b64_tr_b16 a[44:45], v60 offset:33792
ds_read_b64_tr_b16 a[46:47], v60 offset:34048
ds_read_b64_tr_b16 a[116:117], v61 offset:33792
ds_read_b64_tr_b16 a[118:119], v61 offset:34048
ds_read_b64_tr_b16 a[188:189], v62 offset:33792
ds_read_b64_tr_b16 a[190:191], v62 offset:34048
s_waitcnt vmcnt(15)
ds_read_b64_tr_b16 a[48:49], v60 offset:36864
ds_read_b64_tr_b16 a[50:51], v60 offset:37120
ds_read_b64_tr_b16 a[120:121], v61 offset:36864
ds_read_b64_tr_b16 a[122:123], v61 offset:37120
ds_read_b64_tr_b16 a[192:193], v62 offset:36864
ds_read_b64_tr_b16 a[194:195], v62 offset:37120
s_waitcnt vmcnt(12)
ds_read_b64_tr_b16 a[52:53], v60 offset:0
ds_read_b64_tr_b16 a[54:55], v60 offset:256
ds_read_b64_tr_b16 a[124:125], v61 offset:0
ds_read_b64_tr_b16 a[126:127], v61 offset:256
ds_read_b64_tr_b16 a[196:197], v62 offset:0
ds_read_b64_tr_b16 a[198:199], v62 offset:256
s_waitcnt vmcnt(9)
ds_read_b64_tr_b16 a[56:57], v60 offset:3072
ds_read_b64_tr_b16 a[58:59], v60 offset:3328
ds_read_b64_tr_b16 a[128:129], v61 offset:3072
ds_read_b64_tr_b16 a[130:131], v61 offset:3328
ds_read_b64_tr_b16 a[200:201], v62 offset:3072
ds_read_b64_tr_b16 a[202:203], v62 offset:3328
s_waitcnt vmcnt(6)
ds_read_b64_tr_b16 a[60:61], v60 offset:6144
ds_read_b64_tr_b16 a[62:63], v60 offset:6400
ds_read_b64_tr_b16 a[132:133], v61 offset:6144
ds_read_b64_tr_b16 a[134:135], v61 offset:6400
ds_read_b64_tr_b16 a[204:205], v62 offset:6144
ds_read_b64_tr_b16 a[206:207], v62 offset:6400
s_waitcnt vmcnt(3)
ds_read_b64_tr_b16 a[64:65], v60 offset:9216
ds_read_b64_tr_b16 a[66:67], v60 offset:9472
ds_read_b64_tr_b16 a[136:137], v61 offset:9216
ds_read_b64_tr_b16 a[138:139], v61 offset:9472
ds_read_b64_tr_b16 a[208:209], v62 offset:9216
ds_read_b64_tr_b16 a[210:211], v62 offset:9472
s_waitcnt vmcnt(0)
ds_read_b64_tr_b16 a[68:69], v60 offset:12288
ds_read_b64_tr_b16 a[70:71], v60 offset:12544
ds_read_b64_tr_b16 a[140:141], v61 offset:12288
ds_read_b64_tr_b16 a[142:143], v61 offset:12544
ds_read_b64_tr_b16 a[212:213], v62 offset:12288
ds_read_b64_tr_b16 a[214:215], v62 offset:12544
s_waitcnt lgkmcnt(0)
v_lshlrev_b32 v17, 4, v0
s_lshl_b32 s70, s3, 10
v_add_u32 v1, s70, v17
v_add_u32 v8, 4096, v1
v_add_u32 v9, 7168, v1
v_add_u32 v10, 10240, v1
v_add_u32 v11, 13312, v1
v_add_u32 v12, 20480, v1
v_add_u32 v13, 23552, v1
v_add_u32 v14, 26624, v1
v_add_u32 v15, 29696, v1
v_add_u32 v16, 36864, v1
s_mul_i32 s77, s75, 6
v_and_b32 v2, 31, v0
v_add_u32 v1, s77, v2
v_mul_u32_u24 v1, 128, v1
v_lshrrev_b32 v3, 5, v0
v_mul_u32_u24 v3, 32768, v3
v_add_u32 v1, 23552, v1
v_add_u32 v1, v1, v3
v_mov_b32 v3, 2147483632
s_cmp_eq_u32 s3, 0
s_cselect_b32 s71, 6, 0
v_cmp_gt_u32 vcc, s71, v2
s_nop 1
v_cndmask_b32 v22, v3, v1, vcc
s_mov_b32 s56, 0x3f
s_mov_b32 s57, 0
s_mul_i32 s70, s74, 128
s_add_u32 s70, s70, 29696
v_mov_b32 v1, s70
s_min_u32 s71, s71, 1
v_cmp_gt_u32 vcc, s71, v0
s_nop 1
v_cndmask_b32 v44, v3, v1, vcc
v_add_u32 v45, 65536, v44
s_getpc_b64 s[96:97]
pc_144:
s_add_u32 s96, s96, L_writers-pc_144
s_addc_u32 s97, s97, 0
v_subrev_u32 v23, 0, v22
v_lshrrev_b32 v23, 7, v23
v_cmp_gt_u32 vcc, 0x200, v23
s_nop 1
v_cndmask_b32 v23, 0, v23, vcc
global_load_ubyte v23, v23, s[96:97]
s_mul_i32 s77, s75, 36864
s_add_u32 s44, s77, 161800192
s_mov_b32 s46, 218423296
s_add_u32 s45, s77, 180674560
s_mov_b32 s47, 218423296
v_lshrrev_b32 v1, 8, v36
v_and_b32 v2, 0xff, v36
v_add_u32 v3, 1, v2
v_cmp_gt_u32 vcc, 64, v2
s_nop 1
v_cndmask_b32 v36, -1, v3, vcc
v_lshlrev_b32 v37, 5, v1
v_min_u32 v2, 63, v2
v_cmp_eq_u32 vcc, 0, v1
v_mov_b32 v3, s45
v_mov_b32 v4, s44
v_cndmask_b32 v3, v3, v4, vcc
s_mov_b32 s70, 294912
v_mul_lo_u32 v4, v2, s70
v_add_u32 v38, v3, v4
v_mov_b32 v3, s47
v_mov_b32 v4, s46
v_cndmask_b32 v3, v3, v4, vcc
s_mov_b32 s70, 294912
v_mul_lo_u32 v4, v2, s70
v_add_u32 v39, v3, v4
v_subrev_u32 v38, 4096, v38
v_lshrrev_b32 v1, 8, v40
v_and_b32 v2, 0xff, v40
v_add_u32 v3, 1, v2
v_cmp_gt_u32 vcc, 64, v2
s_nop 1
v_cndmask_b32 v40, -1, v3, vcc
v_lshlrev_b32 v41, 5, v1
v_min_u32 v2, 63, v2
v_cmp_eq_u32 vcc, 0, v1
v_mov_b32 v3, s45
v_mov_b32 v4, s44
v_cndmask_b32 v3, v3, v4, vcc
s_mov_b32 s70, 294912
v_mul_lo_u32 v4, v2, s70
v_add_u32 v42, v3, v4
v_mov_b32 v3, s47
v_mov_b32 v4, s46
v_cndmask_b32 v3, v3, v4, vcc
s_mov_b32 s70, 294912
v_mul_lo_u32 v4, v2, s70
v_add_u32 v43, v3, v4
v_subrev_u32 v42, 4096, v42
s_mov_b32 s76, 1
s_mov_b32 s77, 0
s_add_u32 s78, s44, 4294963200
s_add_u32 s79, s46, 0
s_mov_b32 s80, 0
s_mov_b32 s81, 2
s_mov_b32 s82, 0
s_add_u32 s83, s44, 290816
s_add_u32 s84, s46, 294912
s_mov_b32 s85, 0
s_mov_b32 s91, 0
s_mov_b32 s92, 1835008
s_mov_b32 s94, 1879048192
s_branch G_sss18
H_wo:
s_mul_i32 s75, s74, 43
s_lshr_b32 s75, s75, 7
s_mul_i32 s76, s75, 3
s_sub_u32 s76, s74, s76
s_mov_b32 s8, s30
s_and_b32 s9, s31, 0xffff
s_mov_b32 s10, 4718592
s_mov_b32 s11, 0x20000
s_mul_i32 s77, s76, 12
s_mul_i32 s78, s3, 3
s_add_u32 s77, s77, s78
s_mul_i32 s78, s75, 589824
v_bfe_u32 v1, v0, 4, 1
v_bfe_u32 v2, v0, 1, 3
v_lshl_add_u32 v1, v1, 3, v2
v_mul_u32_u24 v1, 2304, v1
v_lshrrev_b32 v2, 5, v0
v_lshl_add_u32 v1, v2, 5, v1
v_and_b32 v2, 1, v0
v_lshl_add_u32 v5, v2, 4, v1
s_mul_i32 s79, s75, 36864
s_add_u32 s80, s77, 0
s_lshl_b32 s81, s80, 5
s_add_u32 s48, s81, s78
s_lshl_b32 s81, s80, 6
s_add_u32 s81, s81, s79
v_add_u32 v19, s81, v5
s_add_u32 s80, s77, 1
s_lshl_b32 s81, s80, 5
s_add_u32 s49, s81, s78
s_lshl_b32 s81, s80, 6
s_add_u32 s81, s81, s79
v_add_u32 v20, s81, v5
s_add_u32 s80, s77, 2
s_lshl_b32 s81, s80, 5
s_add_u32 s50, s81, s78
s_lshl_b32 s81, s80, 6
s_add_u32 s81, s81, s79
v_add_u32 v21, s81, v5
s_getpc_b64 s[96:97]
pc_145:
s_add_u32 s96, s96, L_order_post-pc_145
s_addc_u32 s97, s97, 0
v_lshlrev_b32 v1, 2, v0
global_load_dword v36, v1, s[96:97]
global_load_dword v40, v1, s[96:97] offset:256
v_lshrrev_b32 v1, 5, v0
v_bfe_u32 v2, v0, 3, 1
v_lshl_add_u32 v1, v1, 1, v2
v_bfe_u32 v2, v0, 4, 1
v_bfe_u32 v3, v0, 1, 2
v_lshlrev_b32 v1, 2, v1
v_lshl_add_u32 v1, v2, 4, v1
v_add_u32 v1, v1, v3
v_mul_u32_u24 v1, 1152, v1
v_and_b32 v2, 1, v0
v_lshl_add_u32 v63, v2, 4, v1
s_mul_i32 s70, s3, 40960
v_lshrrev_b32 v1, 5, v0
v_lshlrev_b32 v1, 9, v1
v_bfe_u32 v2, v0, 4, 1
v_lshl_add_u32 v1, v2, 7, v1
v_add_u32 v1, s70, v1
v_and_b32 v2, 15, v0
v_lshl_add_u32 v2, v2, 3, v1
v_add_u32 v60, 0, v2
v_add_u32 v61, 1024, v2
v_add_u32 v62, 2048, v2
s_add_u32 m0, s70, 0
s_add_u32 s71, s48, 0
buffer_load_dwordx4 v63, s[8:11], s71 offen lds
s_add_u32 m0, s70, 1024
s_add_u32 s71, s49, 0
buffer_load_dwordx4 v63, s[8:11], s71 offen lds
s_add_u32 m0, s70, 2048
s_add_u32 s71, s50, 0
buffer_load_dwordx4 v63, s[8:11], s71 offen lds
s_add_u32 m0, s70, 3072
s_add_u32 s71, s48, 36864
buffer_load_dwordx4 v63, s[8:11], s71 offen lds
s_add_u32 m0, s70, 4096
s_add_u32 s71, s49, 36864
buffer_load_dwordx4 v63, s[8:11], s71 offen lds
s_add_u32 m0, s70, 5120
s_add_u32 s71, s50, 36864
buffer_load_dwordx4 v63, s[8:11], s71 offen lds
s_add_u32 m0, s70, 6144
s_add_u32 s71, s48, 73728
buffer_load_dwordx4 v63, s[8:11], s71 offen lds
s_add_u32 m0, s70, 7168
s_add_u32 s71, s49, 73728
buffer_load_dwordx4 v63, s[8:11], s71 offen lds
s_add_u32 m0, s70, 8192
s_add_u32 s71, s50, 73728
buffer_load_dwordx4 v63, s[8:11], s71 offen lds
s_add_u32 m0, s70, 9216
s_add_u32 s71, s48, 110592
buffer_load_dwordx4 v63, s[8:11], s71 offen lds
s_add_u32 m0, s70, 10240
s_add_u32 s71, s49, 110592
buffer_load_dwordx4 v63, s[8:11], s71 offen lds
s_add_u32 m0, s70, 11264
s_add_u32 s71, s50, 110592
buffer_load_dwordx4 v63, s[8:11], s71 offen lds
s_add_u32 m0, s70, 12288
s_add_u32 s71, s48, 147456
buffer_load_dwordx4 v63, s[8:11], s71 offen lds
s_add_u32 m0, s70, 13312
s_add_u32 s71, s49, 147456
buffer_load_dwordx4 v63, s[8:11], s71 offen lds
s_add_u32 m0, s70, 14336
s_add_u32 s71, s50, 147456
buffer_load_dwordx4 v63, s[8:11], s71 offen lds
s_add_u32 m0, s70, 15360
s_add_u32 s71, s48, 184320
buffer_load_dwordx4 v63, s[8:11], s71 offen lds
s_add_u32 m0, s70, 16384
s_add_u32 s71, s49, 184320
buffer_load_dwordx4 v63, s[8:11], s71 offen lds
s_add_u32 m0, s70, 17408
s_add_u32 s71, s50, 184320
buffer_load_dwordx4 v63, s[8:11], s71 offen lds
s_add_u32 m0, s70, 18432
s_add_u32 s71, s48, 221184
buffer_load_dwordx4 v63, s[8:11], s71 offen lds
s_add_u32 m0, s70, 19456
s_add_u32 s71, s49, 221184
buffer_load_dwordx4 v63, s[8:11], s71 offen lds
s_add_u32 m0, s70, 20480
s_add_u32 s71, s50, 221184
buffer_load_dwordx4 v63, s[8:11], s71 offen lds
s_add_u32 m0, s70, 21504
s_add_u32 s71, s48, 258048
buffer_load_dwordx4 v63, s[8:11], s71 offen lds
s_add_u32 m0, s70, 22528
s_add_u32 s71, s49, 258048
buffer_load_dwordx4 v63, s[8:11], s71 offen lds
s_add_u32 m0, s70, 23552
s_add_u32 s71, s50, 258048
buffer_load_dwordx4 v63, s[8:11], s71 offen lds
s_add_u32 m0, s70, 24576
s_add_u32 s71, s48, 294912
buffer_load_dwordx4 v63, s[8:11], s71 offen lds
s_add_u32 m0, s70, 25600
s_add_u32 s71, s49, 294912
buffer_load_dwordx4 v63, s[8:11], s71 offen lds
s_add_u32 m0, s70, 26624
s_add_u32 s71, s50, 294912
buffer_load_dwordx4 v63, s[8:11], s71 offen lds
s_add_u32 m0, s70, 27648
s_add_u32 s71, s48, 331776
buffer_load_dwordx4 v63, s[8:11], s71 offen lds
s_add_u32 m0, s70, 28672
s_add_u32 s71, s49, 331776
buffer_load_dwordx4 v63, s[8:11], s71 offen lds
s_add_u32 m0, s70, 29696
s_add_u32 s71, s50, 331776
buffer_load_dwordx4 v63, s[8:11], s71 offen lds
s_add_u32 m0, s70, 30720
s_add_u32 s71, s48, 368640
buffer_load_dwordx4 v63, s[8:11], s71 offen lds
s_add_u32 m0, s70, 31744
s_add_u32 s71, s49, 368640
buffer_load_dwordx4 v63, s[8:11], s71 offen lds
s_add_u32 m0, s70, 32768
s_add_u32 s71, s50, 368640
buffer_load_dwordx4 v63, s[8:11], s71 offen lds
s_add_u32 m0, s70, 33792
s_add_u32 s71, s48, 405504
buffer_load_dwordx4 v63, s[8:11], s71 offen lds
s_add_u32 m0, s70, 34816
s_add_u32 s71, s49, 405504
buffer_load_dwordx4 v63, s[8:11], s71 offen lds
s_add_u32 m0, s70, 35840
s_add_u32 s71, s50, 405504
buffer_load_dwordx4 v63, s[8:11], s71 offen lds
s_add_u32 m0, s70, 36864
s_add_u32 s71, s48, 442368
buffer_load_dwordx4 v63, s[8:11], s71 offen lds
s_add_u32 m0, s70, 37888
s_add_u32 s71, s49, 442368
buffer_load_dwordx4 v63, s[8:11], s71 offen lds
s_add_u32 m0, s70, 38912
s_add_u32 s71, s50, 442368
buffer_load_dwordx4 v63, s[8:11], s71 offen lds
s_waitcnt vmcnt(36)
ds_read_b64_tr_b16 a[0:1], v60 offset:0
ds_read_b64_tr_b16 a[2:3], v60 offset:256
ds_read_b64_tr_b16 a[72:73], v61 offset:0
ds_read_b64_tr_b16 a[74:75], v61 offset:256
ds_read_b64_tr_b16 a[144:145], v62 offset:0
ds_read_b64_tr_b16 a[146:147], v62 offset:256
s_waitcnt lgkmcnt(0)
s_add_u32 m0, s70, 0
s_add_u32 s71, s48, 479232
buffer_load_dwordx4 v63, s[8:11], s71 offen lds
s_add_u32 m0, s70, 1024
s_add_u32 s71, s49, 479232
buffer_load_dwordx4 v63, s[8:11], s71 offen lds
s_add_u32 m0, s70, 2048
s_add_u32 s71, s50, 479232
buffer_load_dwordx4 v63, s[8:11], s71 offen lds
s_waitcnt vmcnt(36)
ds_read_b64_tr_b16 a[4:5], v60 offset:3072
ds_read_b64_tr_b16 a[6:7], v60 offset:3328
ds_read_b64_tr_b16 a[76:77], v61 offset:3072
ds_read_b64_tr_b16 a[78:79], v61 offset:3328
ds_read_b64_tr_b16 a[148:149], v62 offset:3072
ds_read_b64_tr_b16 a[150:151], v62 offset:3328
s_waitcnt lgkmcnt(0)
s_add_u32 m0, s70, 3072
s_add_u32 s71, s48, 516096
buffer_load_dwordx4 v63, s[8:11], s71 offen lds
s_add_u32 m0, s70, 4096
s_add_u32 s71, s49, 516096
buffer_load_dwordx4 v63, s[8:11], s71 offen lds
s_add_u32 m0, s70, 5120
s_add_u32 s71, s50, 516096
buffer_load_dwordx4 v63, s[8:11], s71 offen lds
s_waitcnt vmcnt(36)
ds_read_b64_tr_b16 a[8:9], v60 offset:6144
ds_read_b64_tr_b16 a[10:11], v60 offset:6400
ds_read_b64_tr_b16 a[80:81], v61 offset:6144
ds_read_b64_tr_b16 a[82:83], v61 offset:6400
ds_read_b64_tr_b16 a[152:153], v62 offset:6144
ds_read_b64_tr_b16 a[154:155], v62 offset:6400
s_waitcnt lgkmcnt(0)
s_add_u32 m0, s70, 6144
s_add_u32 s71, s48, 552960
buffer_load_dwordx4 v63, s[8:11], s71 offen lds
s_add_u32 m0, s70, 7168
s_add_u32 s71, s49, 552960
buffer_load_dwordx4 v63, s[8:11], s71 offen lds
s_add_u32 m0, s70, 8192
s_add_u32 s71, s50, 552960
buffer_load_dwordx4 v63, s[8:11], s71 offen lds
s_waitcnt vmcnt(36)
ds_read_b64_tr_b16 a[12:13], v60 offset:9216
ds_read_b64_tr_b16 a[14:15], v60 offset:9472
ds_read_b64_tr_b16 a[84:85], v61 offset:9216
ds_read_b64_tr_b16 a[86:87], v61 offset:9472
ds_read_b64_tr_b16 a[156:157], v62 offset:9216
ds_read_b64_tr_b16 a[158:159], v62 offset:9472
s_waitcnt vmcnt(33)
ds_read_b64_tr_b16 a[16:17], v60 offset:12288
ds_read_b64_tr_b16 a[18:19], v60 offset:12544
ds_read_b64_tr_b16 a[88:89], v61 offset:12288
ds_read_b64_tr_b16 a[90:91], v61 offset:12544
ds_read_b64_tr_b16 a[160:161], v62 offset:12288
ds_read_b64_tr_b16 a[162:163], v62 offset:12544
s_waitcnt vmcnt(30)
ds_read_b64_tr_b16 a[20:21], v60 offset:15360
ds_read_b64_tr_b16 a[22:23], v60 offset:15616
ds_read_b64_tr_b16 a[92:93], v61 offset:15360
ds_read_b64_tr_b16 a[94:95], v61 offset:15616
ds_read_b64_tr_b16 a[164:165], v62 offset:15360
ds_read_b64_tr_b16 a[166:167], v62 offset:15616
s_waitcnt vmcnt(27)
ds_read_b64_tr_b16 a[24:25], v60 offset:18432
ds_read_b64_tr_b16 a[26:27], v60 offset:18688
ds_read_b64_tr_b16 a[96:97], v61 offset:18432
ds_read_b64_tr_b16 a[98:99], v61 offset:18688
ds_read_b64_tr_b16 a[168:169], v62 offset:18432
ds_read_b64_tr_b16 a[170:171], v62 offset:18688
s_waitcnt vmcnt(24)
ds_read_b64_tr_b16 a[28:29], v60 offset:21504
ds_read_b64_tr_b16 a[30:31], v60 offset:21760
ds_read_b64_tr_b16 a[100:101], v61 offset:21504
ds_read_b64_tr_b16 a[102:103], v61 offset:21760
ds_read_b64_tr_b16 a[172:173], v62 offset:21504
ds_read_b64_tr_b16 a[174:175], v62 offset:21760
s_waitcnt vmcnt(21)
ds_read_b64_tr_b16 a[32:33], v60 offset:24576
ds_read_b64_tr_b16 a[34:35], v60 offset:24832
ds_read_b64_tr_b16 a[104:105], v61 offset:24576
ds_read_b64_tr_b16 a[106:107], v61 offset:24832
ds_read_b64_tr_b16 a[176:177], v62 offset:24576
ds_read_b64_tr_b16 a[178:179], v62 offset:24832
s_waitcnt vmcnt(18)
ds_read_b64_tr_b16 a[36:37], v60 offset:27648
ds_read_b64_tr_b16 a[38:39], v60 offset:27904
ds_read_b64_tr_b16 a[108:109], v61 offset:27648
ds_read_b64_tr_b16 a[110:111], v61 offset:27904
ds_read_b64_tr_b16 a[180:181], v62 offset:27648
ds_read_b64_tr_b16 a[182:183], v62 offset:27904
s_waitcnt vmcnt(15)
ds_read_b64_tr_b16 a[40:41], v60 offset:30720
ds_read_b64_tr_b16 a[42:43], v60 offset:30976
ds_read_b64_tr_b16 a[112:113], v61 offset:30720
ds_read_b64_tr_b16 a[114:115], v61 offset:30976
ds_read_b64_tr_b16 a[184:185], v62 offset:30720
ds_read_b64_tr_b16 a[186:187], v62 offset:30976
s_waitcnt vmcnt(12)
ds_read_b64_tr_b16 a[44:45], v60 offset:33792
ds_read_b64_tr_b16 a[46:47], v60 offset:34048
ds_read_b64_tr_b16 a[116:117], v61 offset:33792
ds_read_b64_tr_b16 a[118:119], v61 offset:34048
ds_read_b64_tr_b16 a[188:189], v62 offset:33792
ds_read_b64_tr_b16 a[190:191], v62 offset:34048
s_waitcnt vmcnt(9)
ds_read_b64_tr_b16 a[48:49], v60 offset:36864
ds_read_b64_tr_b16 a[50:51], v60 offset:37120
ds_read_b64_tr_b16 a[120:121], v61 offset:36864
ds_read_b64_tr_b16 a[122:123], v61 offset:37120
ds_read_b64_tr_b16 a[192:193], v62 offset:36864
ds_read_b64_tr_b16 a[194:195], v62 offset:37120
s_waitcnt vmcnt(6)
ds_read_b64_tr_b16 a[52:53], v60 offset:0
ds_read_b64_tr_b16 a[54:55], v60 offset:256
ds_read_b64_tr_b16 a[124:125], v61 offset:0
ds_read_b64_tr_b16 a[126:127], v61 offset:256
ds_read_b64_tr_b16 a[196:197], v62 offset:0
ds_read_b64_tr_b16 a[198:199], v62 offset:256
s_waitcnt vmcnt(3)
ds_read_b64_tr_b16 a[56:57], v60 offset:3072
ds_read_b64_tr_b16 a[58:59], v60 offset:3328
ds_read_b64_tr_b16 a[128:129], v61 offset:3072
ds_read_b64_tr_b16 a[130:131], v61 offset:3328
ds_read_b64_tr_b16 a[200:201], v62 offset:3072
ds_read_b64_tr_b16 a[202:203], v62 offset:3328
s_waitcnt vmcnt(0)
ds_read_b64_tr_b16 a[60:61], v60 offset:6144
ds_read_b64_tr_b16 a[62:63], v60 offset:6400
ds_read_b64_tr_b16 a[132:133], v61 offset:6144
ds_read_b64_tr_b16 a[134:135], v61 offset:6400
ds_read_b64_tr_b16 a[204:205], v62 offset:6144
ds_read_b64_tr_b16 a[206:207], v62 offset:6400
s_waitcnt lgkmcnt(0)
v_lshlrev_b32 v17, 4, v0
s_lshl_b32 s70, s3, 10
v_add_u32 v1, s70, v17
v_add_u32 v8, 4096, v1
v_add_u32 v9, 7168, v1
v_add_u32 v10, 10240, v1
v_add_u32 v11, 13312, v1
v_add_u32 v12, 20480, v1
v_add_u32 v13, 23552, v1
v_add_u32 v14, 26624, v1
v_add_u32 v15, 29696, v1
s_mul_i32 s77, s75, 4
v_and_b32 v2, 31, v0
v_add_u32 v1, s77, v2
v_mul_u32_u24 v1, 128, v1
v_lshrrev_b32 v3, 5, v0
v_mul_u32_u24 v3, 32768, v3
v_add_u32 v1, 14336, v1
v_add_u32 v1, v1, v3
v_mov_b32 v3, 2147483632
s_cmp_eq_u32 s3, 0
s_cselect_b32 s71, 4, 0
v_cmp_gt_u32 vcc, s71, v2
s_nop 1
v_cndmask_b32 v22, v3, v1, vcc
s_mov_b32 s56, 0xf
s_mov_b32 s57, 0
s_mul_i32 s70, s74, 128
s_add_u32 s70, s70, 18432
v_mov_b32 v1, s70
s_min_u32 s71, s71, 1
v_cmp_gt_u32 vcc, s71, v0
s_nop 1
v_cndmask_b32 v44, v3, v1, vcc
v_add_u32 v45, 65536, v44
s_getpc_b64 s[96:97]
pc_146:
s_add_u32 s96, s96, L_writers-pc_146
s_addc_u32 s97, s97, 0
v_subrev_u32 v23, 0, v22
v_lshrrev_b32 v23, 7, v23
v_cmp_gt_u32 vcc, 0x200, v23
s_nop 1
v_cndmask_b32 v23, 0, v23, vcc
global_load_ubyte v23, v23, s[96:97]
s_mul_i32 s77, s75, 32768
s_add_u32 s44, s77, 128245760
s_mov_b32 s46, 199548928
s_add_u32 s45, s77, 145022976
s_mov_b32 s47, 199548928
v_lshrrev_b32 v1, 8, v36
v_and_b32 v2, 0xff, v36
v_add_u32 v3, 1, v2
v_cmp_gt_u32 vcc, 64, v2
s_nop 1
v_cndmask_b32 v36, -1, v3, vcc
v_lshlrev_b32 v37, 5, v1
v_min_u32 v2, 63, v2
v_cmp_eq_u32 vcc, 0, v1
v_mov_b32 v3, s45
v_mov_b32 v4, s44
v_cndmask_b32 v3, v3, v4, vcc
s_mov_b32 s70, 262144
v_mul_lo_u32 v4, v2, s70
v_add_u32 v38, v3, v4
v_mov_b32 v3, s47
v_mov_b32 v4, s46
v_cndmask_b32 v3, v3, v4, vcc
s_mov_b32 s70, 294912
v_mul_lo_u32 v4, v2, s70
v_add_u32 v39, v3, v4
v_subrev_u32 v38, 4096, v38
v_lshrrev_b32 v1, 8, v40
v_and_b32 v2, 0xff, v40
v_add_u32 v3, 1, v2
v_cmp_gt_u32 vcc, 64, v2
s_nop 1
v_cndmask_b32 v40, -1, v3, vcc
v_lshlrev_b32 v41, 5, v1
v_min_u32 v2, 63, v2
v_cmp_eq_u32 vcc, 0, v1
v_mov_b32 v3, s45
v_mov_b32 v4, s44
v_cndmask_b32 v3, v3, v4, vcc
s_mov_b32 s70, 262144
v_mul_lo_u32 v4, v2, s70
v_add_u32 v42, v3, v4
v_mov_b32 v3, s47
v_mov_b32 v4, s46
v_cndmask_b32 v3, v3, v4, vcc
s_mov_b32 s70, 294912
v_mul_lo_u32 v4, v2, s70
v_add_u32 v43, v3, v4
v_subrev_u32 v42, 4096, v42
s_mov_b32 s76, 1
s_mov_b32 s77, 0
s_add_u32 s78, s44, 4294963200
s_add_u32 s79, s46, 0
s_mov_b32 s80, 0
s_mov_b32 s81, 2
s_mov_b32 s82, 0
s_add_u32 s83, s44, 258048
s_add_u32 s84, s46, 294912
s_mov_b32 s85, 0
s_mov_b32 s91, 0
s_mov_b32 s92, 1835008
s_mov_b32 s94, 1879048192
s_mov_b32 s8, s42
s_and_b32 s9, s43, 0xffff
s_mov_b32 s10, 0
s_mov_b32 s11, 0x20000
s_mov_b32 s52, 0
s_mul_i32 s72, s3, 8192
s_add_u32 s73, s72, 36864
s_add_u32 s74, s72, 73728
s_add_u32 s75, s72, 110592
s_mov_b32 s54, 0xbfb8aa3b
v_add_u32 v28, 0, v17
v_add_u32 v29, 36864, v17
v_add_u32 v30, 73728, v17
v_add_u32 v31, 110592, v17
v_lshlrev_b32 v1, 2, v0
v_add_u32 v32, 147456, v1
s_lshl_b32 s70, s3, 8
v_add_u32 v18, s70, v32
v_mov_b64 v[224:225], 0
v_mov_b64 v[236:237], 0
v_mov_b64 v[226:227], 0
v_mov_b64 v[238:239], 0
v_mov_b64 v[228:229], 0
v_mov_b64 v[240:241], 0
v_mov_b64 v[230:231], 0
v_mov_b64 v[242:243], 0
s_mov_b32 s12, s40
s_and_b32 s13, s41, 0xffff
s_mov_b32 s14, 256
s_mov_b32 s15, 0x20000
v_lshlrev_b32 v26, 2, v0
v_add_u32 v27, 128, v26
v_cmp_le_u32 vcc, 2, v0
s_nop 1
v_cndmask_b32 v26, v26, v27, vcc
v_mov_b32 v27, 192
v_cmp_eq_u32 vcc, 8, v0
s_nop 1
v_cndmask_b32 v26, v26, v27, vcc
v_mov_b32 v27, 2147483632
v_cmp_lt_u32 vcc, 8, v0
s_nop 1
v_cndmask_b32 v26, v26, v27, vcc
s_mov_b32 s98, 0
wi_loop_156:
buffer_load_dword v27, v26, s[12:15], 0 offen sc1
s_add_u32 s98, s98, 1
s_cmp_gt_u32 s98, 150000
s_cbranch_scc1 wi_bad_158
s_waitcnt vmcnt(0)
v_cmp_eq_u32 vcc, 32, v27
s_nop 0
s_and_b32 s97, vcc_lo, 0x1ff
s_cmp_eq_u32 s97, 0x1ff
s_cbranch_scc1 wi_ok_157
v_cmp_lt_u32 vcc, 32, v27
s_nop 0
s_and_b32 s96, vcc_lo, 0xff
s_cselect_b32 s96, 0x100, 0
s_and_b32 s96, s96, s97
s_cbranch_scc1 wi_over_159
s_sleep 8
s_branch wi_loop_156
wi_bad_158:
s_mov_b32 s98, 512
s_branch L_fail
wi_over_159:
s_mov_b32 s100, 255
wi_ok_157:
v_add_u32 v26, 65536, v22
v_cmp_eq_u32 vcc, s100, v23
s_nop 1
v_cndmask_b32 v22, v22, v26, vcc
s_cmp_lg_u32 s3, 0
s_cbranch_scc1 sp_ok_161
s_mov_b32 s55, 0
sp_loop_160:
s_lshl_b64 exec, s[56:57], s77
buffer_load_dword v26, v22, s[4:7], 0 offen sc1
s_mov_b64 exec, -1
s_add_u32 s55, s55, 1
s_cmp_gt_u32 s55, 150000
s_cbranch_scc1 sp_bad_162
s_waitcnt vmcnt(0)
v_cmp_gt_u32 vcc, s76, v26
s_nop 0
s_lshr_b64 s[58:59], vcc, s77
s_and_b32 s58, s58, s56
s_cbranch_scc0 sp_ok_161
s_sleep 1
s_branch sp_loop_160
sp_bad_162:
s_mov_b32 s98, 1029
s_branch L_fail
sp_ok_161:
s_barrier
s_add_u32 m0, s72, 0
s_nop 0
buffer_load_dwordx4 v8, s[4:7], s78 offen offset:0 sc1 lds
buffer_load_dwordx4 v9, s[4:7], s78 offen offset:1024 sc1 lds
buffer_load_dwordx4 v10, s[4:7], s78 offen offset:2048 sc1 lds
buffer_load_dwordx4 v11, s[4:7], s78 offen offset:3072 sc1 lds
s_add_u32 m0, s72, 4096
s_nop 0
buffer_load_dwordx4 v12, s[4:7], s78 offen offset:0 sc1 lds
buffer_load_dwordx4 v13, s[4:7], s78 offen offset:1024 sc1 lds
buffer_load_dwordx4 v14, s[4:7], s78 offen offset:2048 sc1 lds
buffer_load_dwordx4 v15, s[4:7], s78 offen offset:3072 sc1 lds
s_waitcnt vmcnt(0)
g_join_151:
s_barrier
ds_read_b128 v[64:67], v28 offset:0
ds_read_b128 v[68:71], v28 offset:8192
ds_read_b128 v[72:75], v28 offset:16384
ds_read_b128 v[76:79], v28 offset:24576
ds_read_b128 v[80:83], v28 offset:1024
ds_read_b128 v[84:87], v28 offset:9216
ds_read_b128 v[88:91], v28 offset:17408
ds_read_b128 v[92:95], v28 offset:25600
g_body_147:
s_waitcnt lgkmcnt(4)
v_mfma_f32_16x16x32_bf16 v[208:211], a[0:3], v[64:67], 0
ds_read_b128 v[96:99], v28 offset:2048
v_mfma_f32_16x16x32_bf16 v[212:215], a[0:3], v[68:71], 0
ds_read_b128 v[100:103], v28 offset:10240
s_add_u32 m0, s73, 4096
v_mfma_f32_16x16x32_bf16 v[216:219], a[72:75], v[64:67], 0
buffer_load_dwordx4 v12, s[8:11], s83 offen offset:0 sc1 lds
v_mfma_f32_16x16x32_bf16 v[208:211], a[4:7], v[72:75], v[208:211]
ds_read_b128 v[104:107], v28 offset:18432
v_cvt_pk_bf16_f32 v56, v224, v225
v_mfma_f32_16x16x32_bf16 v[212:215], a[4:7], v[76:79], v[212:215]
ds_read_b128 v[108:111], v28 offset:26624
v_cvt_pk_bf16_f32 v57, v226, v227
v_mfma_f32_16x16x32_bf16 v[220:223], a[72:75], v[68:71], 0
v_cvt_pk_bf16_f32 v58, v228, v229
s_waitcnt lgkmcnt(4)
v_mfma_f32_16x16x32_bf16 v[208:211], a[8:11], v[80:83], v[208:211]
ds_read_b128 v[112:115], v28 offset:3072
buffer_load_dwordx4 v13, s[8:11], s83 offen offset:1024 sc1 lds
v_mfma_f32_16x16x32_bf16 v[212:215], a[8:11], v[84:87], v[212:215]
ds_read_b128 v[116:119], v28 offset:11264
v_cvt_pk_bf16_f32 v59, v230, v231
v_mfma_f32_16x16x32_bf16 v[216:219], a[76:79], v[72:75], v[216:219]
v_permlane16_swap_b32 v56, v58
v_mfma_f32_16x16x32_bf16 v[208:211], a[12:15], v[88:91], v[208:211]
ds_read_b128 v[120:123], v28 offset:19456
v_permlane16_swap_b32 v57, v59
v_mfma_f32_16x16x32_bf16 v[212:215], a[12:15], v[92:95], v[212:215]
ds_read_b128 v[124:127], v28 offset:27648
buffer_load_dwordx4 v14, s[8:11], s83 offen offset:2048 sc1 lds
v_mfma_f32_16x16x32_bf16 v[220:223], a[76:79], v[76:79], v[220:223]
buffer_store_dwordx4 v[56:59], v21, s[4:7], s94 offen sc1
s_waitcnt lgkmcnt(4)
v_mfma_f32_16x16x32_bf16 v[208:211], a[16:19], v[96:99], v[208:211]
ds_read_b128 v[128:131], v28 offset:4096
s_and_b32 s70, s52, 63
v_mfma_f32_16x16x32_bf16 v[212:215], a[16:19], v[100:103], v[212:215]
ds_read_b128 v[132:135], v28 offset:12288
v_mfma_f32_16x16x32_bf16 v[216:219], a[80:83], v[80:83], v[216:219]
buffer_load_dwordx4 v15, s[8:11], s83 offen offset:3072 sc1 lds
v_mfma_f32_16x16x32_bf16 v[208:211], a[20:23], v[104:107], v[208:211]
ds_read_b128 v[136:139], v28 offset:20480
v_mfma_f32_16x16x32_bf16 v[212:215], a[20:23], v[108:111], v[212:215]
ds_read_b128 v[140:143], v28 offset:28672
v_mfma_f32_16x16x32_bf16 v[220:223], a[80:83], v[84:87], v[220:223]
s_waitcnt lgkmcnt(4)
v_mfma_f32_16x16x32_bf16 v[208:211], a[24:27], v[112:115], v[208:211]
ds_read_b128 v[144:147], v28 offset:5120
v_mfma_f32_16x16x32_bf16 v[212:215], a[24:27], v[116:119], v[212:215]
ds_read_b128 v[148:151], v28 offset:13312
v_mfma_f32_16x16x32_bf16 v[216:219], a[84:87], v[88:91], v[216:219]
v_readlane_b32 s86, v36, s70
v_mfma_f32_16x16x32_bf16 v[208:211], a[28:31], v[120:123], v[208:211]
ds_read_b128 v[152:155], v28 offset:21504
v_mfma_f32_16x16x32_bf16 v[212:215], a[28:31], v[124:127], v[212:215]
ds_read_b128 v[156:159], v28 offset:29696
v_mfma_f32_16x16x32_bf16 v[220:223], a[84:87], v[92:95], v[220:223]
s_waitcnt lgkmcnt(4)
v_mfma_f32_16x16x32_bf16 v[208:211], a[32:35], v[128:131], v[208:211]
ds_read_b128 v[160:163], v28 offset:6144
v_mfma_f32_16x16x32_bf16 v[212:215], a[32:35], v[132:135], v[212:215]
ds_read_b128 v[164:167], v28 offset:14336
v_mfma_f32_16x16x32_bf16 v[216:219], a[88:91], v[96:99], v[216:219]
v_readlane_b32 s87, v37, s70
v_mfma_f32_16x16x32_bf16 v[208:211], a[36:39], v[136:139], v[208:211]
ds_read_b128 v[168:171], v28 offset:22528
v_mfma_f32_16x16x32_bf16 v[212:215], a[36:39], v[140:143], v[212:215]
ds_read_b128 v[172:175], v28 offset:30720
v_mfma_f32_16x16x32_bf16 v[220:223], a[88:91], v[100:103], v[220:223]
s_waitcnt lgkmcnt(4)
v_mfma_f32_16x16x32_bf16 v[208:211], a[40:43], v[144:147], v[208:211]
ds_read_b128 v[176:179], v28 offset:7168
v_mfma_f32_16x16x32_bf16 v[212:215], a[40:43], v[148:151], v[212:215]
ds_read_b128 v[180:183], v28 offset:15360
v_mfma_f32_16x16x32_bf16 v[216:219], a[92:95], v[104:107], v[216:219]
v_readlane_b32 s88, v38, s70
v_mfma_f32_16x16x32_bf16 v[208:211], a[44:47], v[152:155], v[208:211]
ds_read_b128 v[184:187], v28 offset:23552
v_mfma_f32_16x16x32_bf16 v[212:215], a[44:47], v[156:159], v[212:215]
ds_read_b128 v[188:191], v28 offset:31744
v_mfma_f32_16x16x32_bf16 v[220:223], a[92:95], v[108:111], v[220:223]
s_waitcnt lgkmcnt(4)
v_mfma_f32_16x16x32_bf16 v[208:211], a[48:51], v[160:163], v[208:211]
buffer_load_dword v24, v22, s[4:7], 0 offen sc1
v_mfma_f32_16x16x32_bf16 v[212:215], a[48:51], v[164:167], v[212:215]
v_readlane_b32 s89, v39, s70
v_mfma_f32_16x16x32_bf16 v[216:219], a[96:99], v[112:115], v[216:219]
s_add_u32 s52, s52, 1
v_mov_b32 v27, s91
v_mfma_f32_16x16x32_bf16 v[208:211], a[52:55], v[168:171], v[208:211]
s_lshl_b32 s70, s92, 10
v_mfma_f32_16x16x32_bf16 v[212:215], a[52:55], v[172:175], v[212:215]
v_mfma_f32_16x16x32_bf16 v[220:223], a[96:99], v[116:119], v[220:223]
s_waitcnt lgkmcnt(0)
v_mfma_f32_16x16x32_bf16 v[208:211], a[56:59], v[176:179], v[208:211]
v_mfma_f32_16x16x32_bf16 v[212:215], a[56:59], v[180:183], v[212:215]
v_mfma_f32_16x16x32_bf16 v[216:219], a[100:103], v[120:123], v[216:219]
v_mfma_f32_16x16x32_bf16 v[208:211], a[60:63], v[184:187], v[208:211]
v_mfma_f32_16x16x32_bf16 v[212:215], a[60:63], v[188:191], v[212:215]
v_mfma_f32_16x16x32_bf16 v[220:223], a[100:103], v[124:127], v[220:223]
v_mfma_f32_16x16x32_bf16 v[216:219], a[104:107], v[128:131], v[216:219]
v_mfma_f32_16x16x32_bf16 v[220:223], a[104:107], v[132:135], v[220:223]
v_mfma_f32_16x16x32_bf16 v[224:227], a[144:147], v[64:67], 0
v_mfma_f32_16x16x32_bf16 v[216:219], a[108:111], v[136:139], v[216:219]
v_mfma_f32_16x16x32_bf16 v[220:223], a[108:111], v[140:143], v[220:223]
s_nop 0
v_cvt_pk_bf16_f32 v48, v208, v209
v_cvt_pk_bf16_f32 v49, v210, v211
v_mfma_f32_16x16x32_bf16 v[228:231], a[144:147], v[68:71], 0
v_cvt_pk_bf16_f32 v50, v212, v213
v_cvt_pk_bf16_f32 v51, v214, v215
v_mfma_f32_16x16x32_bf16 v[216:219], a[112:115], v[144:147], v[216:219]
v_permlane16_swap_b32 v48, v50
v_mfma_f32_16x16x32_bf16 v[220:223], a[112:115], v[148:151], v[220:223]
v_permlane16_swap_b32 v49, v51
v_mfma_f32_16x16x32_bf16 v[224:227], a[148:151], v[72:75], v[224:227]
buffer_store_dwordx4 v[48:51], v19, s[4:7], s79 offen sc1
v_mfma_f32_16x16x32_bf16 v[216:219], a[116:119], v[152:155], v[216:219]
v_mfma_f32_16x16x32_bf16 v[220:223], a[116:119], v[156:159], v[220:223]
v_mfma_f32_16x16x32_bf16 v[228:231], a[148:151], v[76:79], v[228:231]
v_mfma_f32_16x16x32_bf16 v[216:219], a[120:123], v[160:163], v[216:219]
v_mfma_f32_16x16x32_bf16 v[220:223], a[120:123], v[164:167], v[220:223]
v_mfma_f32_16x16x32_bf16 v[224:227], a[152:155], v[80:83], v[224:227]
v_mfma_f32_16x16x32_bf16 v[216:219], a[124:127], v[168:171], v[216:219]
v_mfma_f32_16x16x32_bf16 v[220:223], a[124:127], v[172:175], v[220:223]
v_mfma_f32_16x16x32_bf16 v[228:231], a[152:155], v[84:87], v[228:231]
v_mfma_f32_16x16x32_bf16 v[216:219], a[128:131], v[176:179], v[216:219]
v_mfma_f32_16x16x32_bf16 v[220:223], a[128:131], v[180:183], v[220:223]
v_mfma_f32_16x16x32_bf16 v[224:227], a[156:159], v[88:91], v[224:227]
v_mfma_f32_16x16x32_bf16 v[216:219], a[132:135], v[184:187], v[216:219]
v_mfma_f32_16x16x32_bf16 v[220:223], a[132:135], v[188:191], v[220:223]
v_mfma_f32_16x16x32_bf16 v[228:231], a[156:159], v[92:95], v[228:231]
s_waitcnt vmcnt(1)
ds_write_b32 v18, v24
v_mfma_f32_16x16x32_bf16 v[224:227], a[160:163], v[96:99], v[224:227]
v_mfma_f32_16x16x32_bf16 v[228:231], a[160:163], v[100:103], v[228:231]
v_mfma_f32_16x16x32_bf16 v[224:227], a[164:167], v[104:107], v[224:227]
s_waitcnt lgkmcnt(0)
s_barrier
v_mfma_f32_16x16x32_bf16 v[228:231], a[164:167], v[108:111], v[228:231]
ds_read_b32 v33, v32
v_mfma_f32_16x16x32_bf16 v[224:227], a[168:171], v[112:115], v[224:227]
buffer_store_dword v27, v45, s[4:7], s70 offen
v_cvt_pk_bf16_f32 v52, v216, v217
v_mfma_f32_16x16x32_bf16 v[228:231], a[168:171], v[116:119], v[228:231]
buffer_store_dword v27, v44, s[4:7], s70 offen sc1
v_mfma_f32_16x16x32_bf16 v[224:227], a[172:175], v[120:123], v[224:227]
s_waitcnt lgkmcnt(0)
v_cmp_gt_u32 vcc, s86, v33
v_mfma_f32_16x16x32_bf16 v[228:231], a[172:175], v[124:127], v[228:231]
s_lshr_b64 s[58:59], vcc, s87
s_and_b32 s58, s58, s56
s_cselect_b32 s10, 0, 268435456
s_cselect_b32 s90, 0, 1
v_mfma_f32_16x16x32_bf16 v[224:227], a[176:179], v[128:131], v[224:227]
s_cmp_eq_u32 s85, 0
s_cbranch_scc1 g_slow_163
v_mfma_f32_16x16x32_bf16 v[228:231], a[176:179], v[132:135], v[228:231]
s_add_u32 m0, s74, 0
v_cvt_pk_bf16_f32 v53, v218, v219
v_mfma_f32_16x16x32_bf16 v[224:227], a[180:183], v[136:139], v[224:227]
buffer_load_dwordx4 v8, s[8:11], s88 offen offset:0 sc1 lds
v_mfma_f32_16x16x32_bf16 v[228:231], a[180:183], v[140:143], v[228:231]
v_cvt_pk_bf16_f32 v54, v220, v221
v_cvt_pk_bf16_f32 v55, v222, v223
v_mfma_f32_16x16x32_bf16 v[224:227], a[184:187], v[144:147], v[224:227]
v_permlane16_swap_b32 v52, v54
v_mfma_f32_16x16x32_bf16 v[228:231], a[184:187], v[148:151], v[228:231]
v_permlane16_swap_b32 v53, v55
v_mfma_f32_16x16x32_bf16 v[224:227], a[188:191], v[152:155], v[224:227]
buffer_load_dwordx4 v9, s[8:11], s88 offen offset:1024 sc1 lds
ds_read_b128 v[64:67], v29 offset:0
v_mfma_f32_16x16x32_bf16 v[228:231], a[188:191], v[156:159], v[228:231]
buffer_store_dwordx4 v[52:55], v20, s[4:7], s79 offen sc1
ds_read_b128 v[68:71], v29 offset:8192
v_mfma_f32_16x16x32_bf16 v[224:227], a[192:195], v[160:163], v[224:227]
ds_read_b128 v[72:75], v29 offset:16384
v_mfma_f32_16x16x32_bf16 v[228:231], a[192:195], v[164:167], v[228:231]
ds_read_b128 v[76:79], v29 offset:24576
v_mfma_f32_16x16x32_bf16 v[224:227], a[196:199], v[168:171], v[224:227]
buffer_load_dwordx4 v10, s[8:11], s88 offen offset:2048 sc1 lds
ds_read_b128 v[80:83], v29 offset:1024
v_mfma_f32_16x16x32_bf16 v[228:231], a[196:199], v[172:175], v[228:231]
ds_read_b128 v[84:87], v29 offset:9216
v_mfma_f32_16x16x32_bf16 v[224:227], a[200:203], v[176:179], v[224:227]
ds_read_b128 v[88:91], v29 offset:17408
v_mfma_f32_16x16x32_bf16 v[228:231], a[200:203], v[180:183], v[228:231]
ds_read_b128 v[92:95], v29 offset:25600
v_mfma_f32_16x16x32_bf16 v[224:227], a[204:207], v[184:187], v[224:227]
buffer_load_dwordx4 v11, s[8:11], s88 offen offset:3072 sc1 lds
v_mfma_f32_16x16x32_bf16 v[228:231], a[204:207], v[188:191], v[228:231]
g_body_148:
s_waitcnt lgkmcnt(4)
v_mfma_f32_16x16x32_bf16 v[208:211], a[0:3], v[64:67], 0
ds_read_b128 v[96:99], v29 offset:2048
v_mfma_f32_16x16x32_bf16 v[212:215], a[0:3], v[68:71], 0
ds_read_b128 v[100:103], v29 offset:10240
s_add_u32 m0, s74, 4096
v_mfma_f32_16x16x32_bf16 v[216:219], a[72:75], v[64:67], 0
buffer_load_dwordx4 v12, s[8:11], s88 offen offset:0 sc1 lds
v_mfma_f32_16x16x32_bf16 v[208:211], a[4:7], v[72:75], v[208:211]
ds_read_b128 v[104:107], v29 offset:18432
v_cvt_pk_bf16_f32 v56, v224, v225
v_mfma_f32_16x16x32_bf16 v[212:215], a[4:7], v[76:79], v[212:215]
ds_read_b128 v[108:111], v29 offset:26624
v_cvt_pk_bf16_f32 v57, v226, v227
v_mfma_f32_16x16x32_bf16 v[220:223], a[72:75], v[68:71], 0
v_cvt_pk_bf16_f32 v58, v228, v229
s_waitcnt lgkmcnt(4)
v_mfma_f32_16x16x32_bf16 v[208:211], a[8:11], v[80:83], v[208:211]
ds_read_b128 v[112:115], v29 offset:3072
buffer_load_dwordx4 v13, s[8:11], s88 offen offset:1024 sc1 lds
v_mfma_f32_16x16x32_bf16 v[212:215], a[8:11], v[84:87], v[212:215]
ds_read_b128 v[116:119], v29 offset:11264
v_cvt_pk_bf16_f32 v59, v230, v231
v_mfma_f32_16x16x32_bf16 v[216:219], a[76:79], v[72:75], v[216:219]
v_permlane16_swap_b32 v56, v58
v_mfma_f32_16x16x32_bf16 v[208:211], a[12:15], v[88:91], v[208:211]
ds_read_b128 v[120:123], v29 offset:19456
v_permlane16_swap_b32 v57, v59
v_mfma_f32_16x16x32_bf16 v[212:215], a[12:15], v[92:95], v[212:215]
ds_read_b128 v[124:127], v29 offset:27648
buffer_load_dwordx4 v14, s[8:11], s88 offen offset:2048 sc1 lds
v_mfma_f32_16x16x32_bf16 v[220:223], a[76:79], v[76:79], v[220:223]
buffer_store_dwordx4 v[56:59], v21, s[4:7], s79 offen sc1
s_waitcnt lgkmcnt(4)
v_mfma_f32_16x16x32_bf16 v[208:211], a[16:19], v[96:99], v[208:211]
ds_read_b128 v[128:131], v29 offset:4096
s_and_b32 s70, s52, 63
v_mfma_f32_16x16x32_bf16 v[212:215], a[16:19], v[100:103], v[212:215]
ds_read_b128 v[132:135], v29 offset:12288
v_mfma_f32_16x16x32_bf16 v[216:219], a[80:83], v[80:83], v[216:219]
buffer_load_dwordx4 v15, s[8:11], s88 offen offset:3072 sc1 lds
v_mfma_f32_16x16x32_bf16 v[208:211], a[20:23], v[104:107], v[208:211]
ds_read_b128 v[136:139], v29 offset:20480
v_mfma_f32_16x16x32_bf16 v[212:215], a[20:23], v[108:111], v[212:215]
ds_read_b128 v[140:143], v29 offset:28672
v_mfma_f32_16x16x32_bf16 v[220:223], a[80:83], v[84:87], v[220:223]
s_waitcnt lgkmcnt(4)
v_mfma_f32_16x16x32_bf16 v[208:211], a[24:27], v[112:115], v[208:211]
ds_read_b128 v[144:147], v29 offset:5120
v_mfma_f32_16x16x32_bf16 v[212:215], a[24:27], v[116:119], v[212:215]
ds_read_b128 v[148:151], v29 offset:13312
v_mfma_f32_16x16x32_bf16 v[216:219], a[84:87], v[88:91], v[216:219]
v_readlane_b32 s91, v36, s70
v_mfma_f32_16x16x32_bf16 v[208:211], a[28:31], v[120:123], v[208:211]
ds_read_b128 v[152:155], v29 offset:21504
v_mfma_f32_16x16x32_bf16 v[212:215], a[28:31], v[124:127], v[212:215]
ds_read_b128 v[156:159], v29 offset:29696
v_mfma_f32_16x16x32_bf16 v[220:223], a[84:87], v[92:95], v[220:223]
s_waitcnt lgkmcnt(4)
v_mfma_f32_16x16x32_bf16 v[208:211], a[32:35], v[128:131], v[208:211]
ds_read_b128 v[160:163], v29 offset:6144
v_mfma_f32_16x16x32_bf16 v[212:215], a[32:35], v[132:135], v[212:215]
ds_read_b128 v[164:167], v29 offset:14336
v_mfma_f32_16x16x32_bf16 v[216:219], a[88:91], v[96:99], v[216:219]
v_readlane_b32 s92, v37, s70
v_mfma_f32_16x16x32_bf16 v[208:211], a[36:39], v[136:139], v[208:211]
ds_read_b128 v[168:171], v29 offset:22528
v_mfma_f32_16x16x32_bf16 v[212:215], a[36:39], v[140:143], v[212:215]
ds_read_b128 v[172:175], v29 offset:30720
v_mfma_f32_16x16x32_bf16 v[220:223], a[88:91], v[100:103], v[220:223]
s_waitcnt lgkmcnt(4)
v_mfma_f32_16x16x32_bf16 v[208:211], a[40:43], v[144:147], v[208:211]
ds_read_b128 v[176:179], v29 offset:7168
v_mfma_f32_16x16x32_bf16 v[212:215], a[40:43], v[148:151], v[212:215]
ds_read_b128 v[180:183], v29 offset:15360
v_mfma_f32_16x16x32_bf16 v[216:219], a[92:95], v[104:107], v[216:219]
v_readlane_b32 s93, v38, s70
v_mfma_f32_16x16x32_bf16 v[208:211], a[44:47], v[152:155], v[208:211]
ds_read_b128 v[184:187], v29 offset:23552
v_mfma_f32_16x16x32_bf16 v[212:215], a[44:47], v[156:159], v[212:215]
ds_read_b128 v[188:191], v29 offset:31744
v_mfma_f32_16x16x32_bf16 v[220:223], a[92:95], v[108:111], v[220:223]
s_waitcnt lgkmcnt(4)
v_mfma_f32_16x16x32_bf16 v[208:211], a[48:51], v[160:163], v[208:211]
buffer_load_dword v24, v22, s[4:7], 0 offen sc1
v_mfma_f32_16x16x32_bf16 v[212:215], a[48:51], v[164:167], v[212:215]
v_readlane_b32 s94, v39, s70
v_mfma_f32_16x16x32_bf16 v[216:219], a[96:99], v[112:115], v[216:219]
s_add_u32 s52, s52, 1
v_mov_b32 v27, s76
v_mfma_f32_16x16x32_bf16 v[208:211], a[52:55], v[168:171], v[208:211]
s_lshl_b32 s70, s77, 10
v_mfma_f32_16x16x32_bf16 v[212:215], a[52:55], v[172:175], v[212:215]
v_mfma_f32_16x16x32_bf16 v[220:223], a[96:99], v[116:119], v[220:223]
s_waitcnt lgkmcnt(0)
v_mfma_f32_16x16x32_bf16 v[208:211], a[56:59], v[176:179], v[208:211]
v_mfma_f32_16x16x32_bf16 v[212:215], a[56:59], v[180:183], v[212:215]
v_mfma_f32_16x16x32_bf16 v[216:219], a[100:103], v[120:123], v[216:219]
v_mfma_f32_16x16x32_bf16 v[208:211], a[60:63], v[184:187], v[208:211]
v_mfma_f32_16x16x32_bf16 v[212:215], a[60:63], v[188:191], v[212:215]
v_mfma_f32_16x16x32_bf16 v[220:223], a[100:103], v[124:127], v[220:223]
v_mfma_f32_16x16x32_bf16 v[216:219], a[104:107], v[128:131], v[216:219]
v_mfma_f32_16x16x32_bf16 v[220:223], a[104:107], v[132:135], v[220:223]
v_mfma_f32_16x16x32_bf16 v[224:227], a[144:147], v[64:67], 0
v_mfma_f32_16x16x32_bf16 v[216:219], a[108:111], v[136:139], v[216:219]
v_mfma_f32_16x16x32_bf16 v[220:223], a[108:111], v[140:143], v[220:223]
s_nop 0
v_cvt_pk_bf16_f32 v48, v208, v209
v_cvt_pk_bf16_f32 v49, v210, v211
v_mfma_f32_16x16x32_bf16 v[228:231], a[144:147], v[68:71], 0
v_cvt_pk_bf16_f32 v50, v212, v213
v_cvt_pk_bf16_f32 v51, v214, v215
v_mfma_f32_16x16x32_bf16 v[216:219], a[112:115], v[144:147], v[216:219]
v_permlane16_swap_b32 v48, v50
v_mfma_f32_16x16x32_bf16 v[220:223], a[112:115], v[148:151], v[220:223]
v_permlane16_swap_b32 v49, v51
v_mfma_f32_16x16x32_bf16 v[224:227], a[148:151], v[72:75], v[224:227]
buffer_store_dwordx4 v[48:51], v19, s[4:7], s84 offen sc1
v_mfma_f32_16x16x32_bf16 v[216:219], a[116:119], v[152:155], v[216:219]
v_mfma_f32_16x16x32_bf16 v[220:223], a[116:119], v[156:159], v[220:223]
v_mfma_f32_16x16x32_bf16 v[228:231], a[148:151], v[76:79], v[228:231]
v_mfma_f32_16x16x32_bf16 v[216:219], a[120:123], v[160:163], v[216:219]
v_mfma_f32_16x16x32_bf16 v[220:223], a[120:123], v[164:167], v[220:223]
v_mfma_f32_16x16x32_bf16 v[224:227], a[152:155], v[80:83], v[224:227]
v_mfma_f32_16x16x32_bf16 v[216:219], a[124:127], v[168:171], v[216:219]
v_mfma_f32_16x16x32_bf16 v[220:223], a[124:127], v[172:175], v[220:223]
v_mfma_f32_16x16x32_bf16 v[228:231], a[152:155], v[84:87], v[228:231]
v_mfma_f32_16x16x32_bf16 v[216:219], a[128:131], v[176:179], v[216:219]
v_mfma_f32_16x16x32_bf16 v[220:223], a[128:131], v[180:183], v[220:223]
v_mfma_f32_16x16x32_bf16 v[224:227], a[156:159], v[88:91], v[224:227]
v_mfma_f32_16x16x32_bf16 v[216:219], a[132:135], v[184:187], v[216:219]
v_mfma_f32_16x16x32_bf16 v[220:223], a[132:135], v[188:191], v[220:223]
v_mfma_f32_16x16x32_bf16 v[228:231], a[156:159], v[92:95], v[228:231]
s_waitcnt vmcnt(1)
ds_write_b32 v18, v24
v_mfma_f32_16x16x32_bf16 v[224:227], a[160:163], v[96:99], v[224:227]
v_mfma_f32_16x16x32_bf16 v[228:231], a[160:163], v[100:103], v[228:231]
v_mfma_f32_16x16x32_bf16 v[224:227], a[164:167], v[104:107], v[224:227]
s_waitcnt lgkmcnt(0)
s_barrier
v_mfma_f32_16x16x32_bf16 v[228:231], a[164:167], v[108:111], v[228:231]
ds_read_b32 v33, v32
v_mfma_f32_16x16x32_bf16 v[224:227], a[168:171], v[112:115], v[224:227]
buffer_store_dword v27, v45, s[4:7], s70 offen
v_cvt_pk_bf16_f32 v52, v216, v217
v_mfma_f32_16x16x32_bf16 v[228:231], a[168:171], v[116:119], v[228:231]
buffer_store_dword v27, v44, s[4:7], s70 offen sc1
v_mfma_f32_16x16x32_bf16 v[224:227], a[172:175], v[120:123], v[224:227]
s_waitcnt lgkmcnt(0)
v_cmp_gt_u32 vcc, s91, v33
v_mfma_f32_16x16x32_bf16 v[228:231], a[172:175], v[124:127], v[228:231]
s_lshr_b64 s[58:59], vcc, s92
s_and_b32 s58, s58, s56
s_cselect_b32 s10, 0, 268435456
s_cselect_b32 s95, 0, 1
v_mfma_f32_16x16x32_bf16 v[224:227], a[176:179], v[128:131], v[224:227]
s_cmp_eq_u32 s90, 0
s_cbranch_scc1 g_slow_164
v_mfma_f32_16x16x32_bf16 v[228:231], a[176:179], v[132:135], v[228:231]
s_add_u32 m0, s75, 0
v_cvt_pk_bf16_f32 v53, v218, v219
v_mfma_f32_16x16x32_bf16 v[224:227], a[180:183], v[136:139], v[224:227]
buffer_load_dwordx4 v8, s[8:11], s93 offen offset:0 sc1 lds
v_mfma_f32_16x16x32_bf16 v[228:231], a[180:183], v[140:143], v[228:231]
v_cvt_pk_bf16_f32 v54, v220, v221
v_cvt_pk_bf16_f32 v55, v222, v223
v_mfma_f32_16x16x32_bf16 v[224:227], a[184:187], v[144:147], v[224:227]
v_permlane16_swap_b32 v52, v54
v_mfma_f32_16x16x32_bf16 v[228:231], a[184:187], v[148:151], v[228:231]
v_permlane16_swap_b32 v53, v55
v_mfma_f32_16x16x32_bf16 v[224:227], a[188:191], v[152:155], v[224:227]
buffer_load_dwordx4 v9, s[8:11], s93 offen offset:1024 sc1 lds
ds_read_b128 v[64:67], v30 offset:0
v_mfma_f32_16x16x32_bf16 v[228:231], a[188:191], v[156:159], v[228:231]
buffer_store_dwordx4 v[52:55], v20, s[4:7], s84 offen sc1
ds_read_b128 v[68:71], v30 offset:8192
v_mfma_f32_16x16x32_bf16 v[224:227], a[192:195], v[160:163], v[224:227]
ds_read_b128 v[72:75], v30 offset:16384
v_mfma_f32_16x16x32_bf16 v[228:231], a[192:195], v[164:167], v[228:231]
ds_read_b128 v[76:79], v30 offset:24576
v_mfma_f32_16x16x32_bf16 v[224:227], a[196:199], v[168:171], v[224:227]
buffer_load_dwordx4 v10, s[8:11], s93 offen offset:2048 sc1 lds
ds_read_b128 v[80:83], v30 offset:1024
v_mfma_f32_16x16x32_bf16 v[228:231], a[196:199], v[172:175], v[228:231]
ds_read_b128 v[84:87], v30 offset:9216
v_mfma_f32_16x16x32_bf16 v[224:227], a[200:203], v[176:179], v[224:227]
ds_read_b128 v[88:91], v30 offset:17408
v_mfma_f32_16x16x32_bf16 v[228:231], a[200:203], v[180:183], v[228:231]
ds_read_b128 v[92:95], v30 offset:25600
v_mfma_f32_16x16x32_bf16 v[224:227], a[204:207], v[184:187], v[224:227]
buffer_load_dwordx4 v11, s[8:11], s93 offen offset:3072 sc1 lds
v_mfma_f32_16x16x32_bf16 v[228:231], a[204:207], v[188:191], v[228:231]
g_body_149:
s_waitcnt lgkmcnt(4)
v_mfma_f32_16x16x32_bf16 v[208:211], a[0:3], v[64:67], 0
ds_read_b128 v[96:99], v30 offset:2048
v_mfma_f32_16x16x32_bf16 v[212:215], a[0:3], v[68:71], 0
ds_read_b128 v[100:103], v30 offset:10240
s_add_u32 m0, s75, 4096
v_mfma_f32_16x16x32_bf16 v[216:219], a[72:75], v[64:67], 0
buffer_load_dwordx4 v12, s[8:11], s93 offen offset:0 sc1 lds
v_mfma_f32_16x16x32_bf16 v[208:211], a[4:7], v[72:75], v[208:211]
ds_read_b128 v[104:107], v30 offset:18432
v_cvt_pk_bf16_f32 v56, v224, v225
v_mfma_f32_16x16x32_bf16 v[212:215], a[4:7], v[76:79], v[212:215]
ds_read_b128 v[108:111], v30 offset:26624
v_cvt_pk_bf16_f32 v57, v226, v227
v_mfma_f32_16x16x32_bf16 v[220:223], a[72:75], v[68:71], 0
v_cvt_pk_bf16_f32 v58, v228, v229
s_waitcnt lgkmcnt(4)
v_mfma_f32_16x16x32_bf16 v[208:211], a[8:11], v[80:83], v[208:211]
ds_read_b128 v[112:115], v30 offset:3072
buffer_load_dwordx4 v13, s[8:11], s93 offen offset:1024 sc1 lds
v_mfma_f32_16x16x32_bf16 v[212:215], a[8:11], v[84:87], v[212:215]
ds_read_b128 v[116:119], v30 offset:11264
v_cvt_pk_bf16_f32 v59, v230, v231
v_mfma_f32_16x16x32_bf16 v[216:219], a[76:79], v[72:75], v[216:219]
v_permlane16_swap_b32 v56, v58
v_mfma_f32_16x16x32_bf16 v[208:211], a[12:15], v[88:91], v[208:211]
ds_read_b128 v[120:123], v30 offset:19456
v_permlane16_swap_b32 v57, v59
v_mfma_f32_16x16x32_bf16 v[212:215], a[12:15], v[92:95], v[212:215]
ds_read_b128 v[124:127], v30 offset:27648
buffer_load_dwordx4 v14, s[8:11], s93 offen offset:2048 sc1 lds
v_mfma_f32_16x16x32_bf16 v[220:223], a[76:79], v[76:79], v[220:223]
buffer_store_dwordx4 v[56:59], v21, s[4:7], s84 offen sc1
s_waitcnt lgkmcnt(4)
v_mfma_f32_16x16x32_bf16 v[208:211], a[16:19], v[96:99], v[208:211]
ds_read_b128 v[128:131], v30 offset:4096
s_and_b32 s70, s52, 63
v_mfma_f32_16x16x32_bf16 v[212:215], a[16:19], v[100:103], v[212:215]
ds_read_b128 v[132:135], v30 offset:12288
v_mfma_f32_16x16x32_bf16 v[216:219], a[80:83], v[80:83], v[216:219]
buffer_load_dwordx4 v15, s[8:11], s93 offen offset:3072 sc1 lds
v_mfma_f32_16x16x32_bf16 v[208:211], a[20:23], v[104:107], v[208:211]
ds_read_b128 v[136:139], v30 offset:20480
v_mfma_f32_16x16x32_bf16 v[212:215], a[20:23], v[108:111], v[212:215]
ds_read_b128 v[140:143], v30 offset:28672
v_mfma_f32_16x16x32_bf16 v[220:223], a[80:83], v[84:87], v[220:223]
s_waitcnt lgkmcnt(4)
v_mfma_f32_16x16x32_bf16 v[208:211], a[24:27], v[112:115], v[208:211]
ds_read_b128 v[144:147], v30 offset:5120
v_mfma_f32_16x16x32_bf16 v[212:215], a[24:27], v[116:119], v[212:215]
ds_read_b128 v[148:151], v30 offset:13312
v_mfma_f32_16x16x32_bf16 v[216:219], a[84:87], v[88:91], v[216:219]
v_readlane_b32 s76, v36, s70
v_mfma_f32_16x16x32_bf16 v[208:211], a[28:31], v[120:123], v[208:211]
ds_read_b128 v[152:155], v30 offset:21504
v_mfma_f32_16x16x32_bf16 v[212:215], a[28:31], v[124:127], v[212:215]
ds_read_b128 v[156:159], v30 offset:29696
v_mfma_f32_16x16x32_bf16 v[220:223], a[84:87], v[92:95], v[220:223]
s_waitcnt lgkmcnt(4)
v_mfma_f32_16x16x32_bf16 v[208:211], a[32:35], v[128:131], v[208:211]
ds_read_b128 v[160:163], v30 offset:6144
v_mfma_f32_16x16x32_bf16 v[212:215], a[32:35], v[132:135], v[212:215]
ds_read_b128 v[164:167], v30 offset:14336
v_mfma_f32_16x16x32_bf16 v[216:219], a[88:91], v[96:99], v[216:219]
v_readlane_b32 s77, v37, s70
v_mfma_f32_16x16x32_bf16 v[208:211], a[36:39], v[136:139], v[208:211]
ds_read_b128 v[168:171], v30 offset:22528
v_mfma_f32_16x16x32_bf16 v[212:215], a[36:39], v[140:143], v[212:215]
ds_read_b128 v[172:175], v30 offset:30720
v_mfma_f32_16x16x32_bf16 v[220:223], a[88:91], v[100:103], v[220:223]
s_waitcnt lgkmcnt(4)
v_mfma_f32_16x16x32_bf16 v[208:211], a[40:43], v[144:147], v[208:211]
ds_read_b128 v[176:179], v30 offset:7168
v_mfma_f32_16x16x32_bf16 v[212:215], a[40:43], v[148:151], v[212:215]
ds_read_b128 v[180:183], v30 offset:15360
v_mfma_f32_16x16x32_bf16 v[216:219], a[92:95], v[104:107], v[216:219]
v_readlane_b32 s78, v38, s70
v_mfma_f32_16x16x32_bf16 v[208:211], a[44:47], v[152:155], v[208:211]
ds_read_b128 v[184:187], v30 offset:23552
v_mfma_f32_16x16x32_bf16 v[212:215], a[44:47], v[156:159], v[212:215]
ds_read_b128 v[188:191], v30 offset:31744
v_mfma_f32_16x16x32_bf16 v[220:223], a[92:95], v[108:111], v[220:223]
s_waitcnt lgkmcnt(4)
v_mfma_f32_16x16x32_bf16 v[208:211], a[48:51], v[160:163], v[208:211]
buffer_load_dword v24, v22, s[4:7], 0 offen sc1
v_mfma_f32_16x16x32_bf16 v[212:215], a[48:51], v[164:167], v[212:215]
v_readlane_b32 s79, v39, s70
v_mfma_f32_16x16x32_bf16 v[216:219], a[96:99], v[112:115], v[216:219]
s_add_u32 s52, s52, 1
v_mov_b32 v27, s81
v_mfma_f32_16x16x32_bf16 v[208:211], a[52:55], v[168:171], v[208:211]
s_lshl_b32 s70, s82, 10
v_mfma_f32_16x16x32_bf16 v[212:215], a[52:55], v[172:175], v[212:215]
v_mfma_f32_16x16x32_bf16 v[220:223], a[96:99], v[116:119], v[220:223]
s_waitcnt lgkmcnt(0)
v_mfma_f32_16x16x32_bf16 v[208:211], a[56:59], v[176:179], v[208:211]
v_mfma_f32_16x16x32_bf16 v[212:215], a[56:59], v[180:183], v[212:215]
v_mfma_f32_16x16x32_bf16 v[216:219], a[100:103], v[120:123], v[216:219]
v_mfma_f32_16x16x32_bf16 v[208:211], a[60:63], v[184:187], v[208:211]
v_mfma_f32_16x16x32_bf16 v[212:215], a[60:63], v[188:191], v[212:215]
v_mfma_f32_16x16x32_bf16 v[220:223], a[100:103], v[124:127], v[220:223]
v_mfma_f32_16x16x32_bf16 v[216:219], a[104:107], v[128:131], v[216:219]
v_mfma_f32_16x16x32_bf16 v[220:223], a[104:107], v[132:135], v[220:223]
v_mfma_f32_16x16x32_bf16 v[224:227], a[144:147], v[64:67], 0
v_mfma_f32_16x16x32_bf16 v[216:219], a[108:111], v[136:139], v[216:219]
v_mfma_f32_16x16x32_bf16 v[220:223], a[108:111], v[140:143], v[220:223]
s_nop 0
v_cvt_pk_bf16_f32 v48, v208, v209
v_cvt_pk_bf16_f32 v49, v210, v211
v_mfma_f32_16x16x32_bf16 v[228:231], a[144:147], v[68:71], 0
v_cvt_pk_bf16_f32 v50, v212, v213
v_cvt_pk_bf16_f32 v51, v214, v215
v_mfma_f32_16x16x32_bf16 v[216:219], a[112:115], v[144:147], v[216:219]
v_permlane16_swap_b32 v48, v50
v_mfma_f32_16x16x32_bf16 v[220:223], a[112:115], v[148:151], v[220:223]
v_permlane16_swap_b32 v49, v51
v_mfma_f32_16x16x32_bf16 v[224:227], a[148:151], v[72:75], v[224:227]
buffer_store_dwordx4 v[48:51], v19, s[4:7], s89 offen sc1
v_mfma_f32_16x16x32_bf16 v[216:219], a[116:119], v[152:155], v[216:219]
v_mfma_f32_16x16x32_bf16 v[220:223], a[116:119], v[156:159], v[220:223]
v_mfma_f32_16x16x32_bf16 v[228:231], a[148:151], v[76:79], v[228:231]
v_mfma_f32_16x16x32_bf16 v[216:219], a[120:123], v[160:163], v[216:219]
v_mfma_f32_16x16x32_bf16 v[220:223], a[120:123], v[164:167], v[220:223]
v_mfma_f32_16x16x32_bf16 v[224:227], a[152:155], v[80:83], v[224:227]
v_mfma_f32_16x16x32_bf16 v[216:219], a[124:127], v[168:171], v[216:219]
v_mfma_f32_16x16x32_bf16 v[220:223], a[124:127], v[172:175], v[220:223]
v_mfma_f32_16x16x32_bf16 v[228:231], a[152:155], v[84:87], v[228:231]
v_mfma_f32_16x16x32_bf16 v[216:219], a[128:131], v[176:179], v[216:219]
v_mfma_f32_16x16x32_bf16 v[220:223], a[128:131], v[180:183], v[220:223]
v_mfma_f32_16x16x32_bf16 v[224:227], a[156:159], v[88:91], v[224:227]
v_mfma_f32_16x16x32_bf16 v[216:219], a[132:135], v[184:187], v[216:219]
v_mfma_f32_16x16x32_bf16 v[220:223], a[132:135], v[188:191], v[220:223]
v_mfma_f32_16x16x32_bf16 v[228:231], a[156:159], v[92:95], v[228:231]
s_waitcnt vmcnt(1)
ds_write_b32 v18, v24
v_mfma_f32_16x16x32_bf16 v[224:227], a[160:163], v[96:99], v[224:227]
v_mfma_f32_16x16x32_bf16 v[228:231], a[160:163], v[100:103], v[228:231]
v_mfma_f32_16x16x32_bf16 v[224:227], a[164:167], v[104:107], v[224:227]
s_waitcnt lgkmcnt(0)
s_barrier
v_mfma_f32_16x16x32_bf16 v[228:231], a[164:167], v[108:111], v[228:231]
ds_read_b32 v33, v32
v_mfma_f32_16x16x32_bf16 v[224:227], a[168:171], v[112:115], v[224:227]
buffer_store_dword v27, v45, s[4:7], s70 offen
v_cvt_pk_bf16_f32 v52, v216, v217
v_mfma_f32_16x16x32_bf16 v[228:231], a[168:171], v[116:119], v[228:231]
buffer_store_dword v27, v44, s[4:7], s70 offen sc1
v_mfma_f32_16x16x32_bf16 v[224:227], a[172:175], v[120:123], v[224:227]
s_waitcnt lgkmcnt(0)
v_cmp_gt_u32 vcc, s76, v33
v_mfma_f32_16x16x32_bf16 v[228:231], a[172:175], v[124:127], v[228:231]
s_lshr_b64 s[58:59], vcc, s77
s_and_b32 s58, s58, s56
s_cselect_b32 s10, 0, 268435456
s_cselect_b32 s80, 0, 1
v_mfma_f32_16x16x32_bf16 v[224:227], a[176:179], v[128:131], v[224:227]
s_cmp_eq_u32 s95, 0
s_cbranch_scc1 g_slow_165
v_mfma_f32_16x16x32_bf16 v[228:231], a[176:179], v[132:135], v[228:231]
s_add_u32 m0, s72, 0
v_cvt_pk_bf16_f32 v53, v218, v219
v_mfma_f32_16x16x32_bf16 v[224:227], a[180:183], v[136:139], v[224:227]
buffer_load_dwordx4 v8, s[8:11], s78 offen offset:0 sc1 lds
v_mfma_f32_16x16x32_bf16 v[228:231], a[180:183], v[140:143], v[228:231]
v_cvt_pk_bf16_f32 v54, v220, v221
v_cvt_pk_bf16_f32 v55, v222, v223
v_mfma_f32_16x16x32_bf16 v[224:227], a[184:187], v[144:147], v[224:227]
v_permlane16_swap_b32 v52, v54
v_mfma_f32_16x16x32_bf16 v[228:231], a[184:187], v[148:151], v[228:231]
v_permlane16_swap_b32 v53, v55
v_mfma_f32_16x16x32_bf16 v[224:227], a[188:191], v[152:155], v[224:227]
buffer_load_dwordx4 v9, s[8:11], s78 offen offset:1024 sc1 lds
ds_read_b128 v[64:67], v31 offset:0
v_mfma_f32_16x16x32_bf16 v[228:231], a[188:191], v[156:159], v[228:231]
buffer_store_dwordx4 v[52:55], v20, s[4:7], s89 offen sc1
ds_read_b128 v[68:71], v31 offset:8192
v_mfma_f32_16x16x32_bf16 v[224:227], a[192:195], v[160:163], v[224:227]
ds_read_b128 v[72:75], v31 offset:16384
v_mfma_f32_16x16x32_bf16 v[228:231], a[192:195], v[164:167], v[228:231]
ds_read_b128 v[76:79], v31 offset:24576
v_mfma_f32_16x16x32_bf16 v[224:227], a[196:199], v[168:171], v[224:227]
buffer_load_dwordx4 v10, s[8:11], s78 offen offset:2048 sc1 lds
ds_read_b128 v[80:83], v31 offset:1024
v_mfma_f32_16x16x32_bf16 v[228:231], a[196:199], v[172:175], v[228:231]
ds_read_b128 v[84:87], v31 offset:9216
v_mfma_f32_16x16x32_bf16 v[224:227], a[200:203], v[176:179], v[224:227]
ds_read_b128 v[88:91], v31 offset:17408
v_mfma_f32_16x16x32_bf16 v[228:231], a[200:203], v[180:183], v[228:231]
ds_read_b128 v[92:95], v31 offset:25600
v_mfma_f32_16x16x32_bf16 v[224:227], a[204:207], v[184:187], v[224:227]
buffer_load_dwordx4 v11, s[8:11], s78 offen offset:3072 sc1 lds
v_mfma_f32_16x16x32_bf16 v[228:231], a[204:207], v[188:191], v[228:231]
g_body_150:
s_waitcnt lgkmcnt(4)
v_mfma_f32_16x16x32_bf16 v[208:211], a[0:3], v[64:67], 0
ds_read_b128 v[96:99], v31 offset:2048
v_mfma_f32_16x16x32_bf16 v[212:215], a[0:3], v[68:71], 0
ds_read_b128 v[100:103], v31 offset:10240
s_add_u32 m0, s72, 4096
v_mfma_f32_16x16x32_bf16 v[216:219], a[72:75], v[64:67], 0
buffer_load_dwordx4 v12, s[8:11], s78 offen offset:0 sc1 lds
v_mfma_f32_16x16x32_bf16 v[208:211], a[4:7], v[72:75], v[208:211]
ds_read_b128 v[104:107], v31 offset:18432
v_cvt_pk_bf16_f32 v56, v224, v225
v_mfma_f32_16x16x32_bf16 v[212:215], a[4:7], v[76:79], v[212:215]
ds_read_b128 v[108:111], v31 offset:26624
v_cvt_pk_bf16_f32 v57, v226, v227
v_mfma_f32_16x16x32_bf16 v[220:223], a[72:75], v[68:71], 0
v_cvt_pk_bf16_f32 v58, v228, v229
s_waitcnt lgkmcnt(4)
v_mfma_f32_16x16x32_bf16 v[208:211], a[8:11], v[80:83], v[208:211]
ds_read_b128 v[112:115], v31 offset:3072
buffer_load_dwordx4 v13, s[8:11], s78 offen offset:1024 sc1 lds
v_mfma_f32_16x16x32_bf16 v[212:215], a[8:11], v[84:87], v[212:215]
ds_read_b128 v[116:119], v31 offset:11264
v_cvt_pk_bf16_f32 v59, v230, v231
v_mfma_f32_16x16x32_bf16 v[216:219], a[76:79], v[72:75], v[216:219]
v_permlane16_swap_b32 v56, v58
v_mfma_f32_16x16x32_bf16 v[208:211], a[12:15], v[88:91], v[208:211]
ds_read_b128 v[120:123], v31 offset:19456
v_permlane16_swap_b32 v57, v59
v_mfma_f32_16x16x32_bf16 v[212:215], a[12:15], v[92:95], v[212:215]
ds_read_b128 v[124:127], v31 offset:27648
buffer_load_dwordx4 v14, s[8:11], s78 offen offset:2048 sc1 lds
v_mfma_f32_16x16x32_bf16 v[220:223], a[76:79], v[76:79], v[220:223]
buffer_store_dwordx4 v[56:59], v21, s[4:7], s89 offen sc1
s_waitcnt lgkmcnt(4)
v_mfma_f32_16x16x32_bf16 v[208:211], a[16:19], v[96:99], v[208:211]
ds_read_b128 v[128:131], v31 offset:4096
s_and_b32 s70, s52, 63
v_mfma_f32_16x16x32_bf16 v[212:215], a[16:19], v[100:103], v[212:215]
ds_read_b128 v[132:135], v31 offset:12288
v_mfma_f32_16x16x32_bf16 v[216:219], a[80:83], v[80:83], v[216:219]
buffer_load_dwordx4 v15, s[8:11], s78 offen offset:3072 sc1 lds
v_mfma_f32_16x16x32_bf16 v[208:211], a[20:23], v[104:107], v[208:211]
ds_read_b128 v[136:139], v31 offset:20480
v_mfma_f32_16x16x32_bf16 v[212:215], a[20:23], v[108:111], v[212:215]
ds_read_b128 v[140:143], v31 offset:28672
v_mfma_f32_16x16x32_bf16 v[220:223], a[80:83], v[84:87], v[220:223]
s_waitcnt lgkmcnt(4)
v_mfma_f32_16x16x32_bf16 v[208:211], a[24:27], v[112:115], v[208:211]
ds_read_b128 v[144:147], v31 offset:5120
v_mfma_f32_16x16x32_bf16 v[212:215], a[24:27], v[116:119], v[212:215]
ds_read_b128 v[148:151], v31 offset:13312
v_mfma_f32_16x16x32_bf16 v[216:219], a[84:87], v[88:91], v[216:219]
v_readlane_b32 s81, v36, s70
v_mfma_f32_16x16x32_bf16 v[208:211], a[28:31], v[120:123], v[208:211]
ds_read_b128 v[152:155], v31 offset:21504
v_mfma_f32_16x16x32_bf16 v[212:215], a[28:31], v[124:127], v[212:215]
ds_read_b128 v[156:159], v31 offset:29696
v_mfma_f32_16x16x32_bf16 v[220:223], a[84:87], v[92:95], v[220:223]
s_waitcnt lgkmcnt(4)
v_mfma_f32_16x16x32_bf16 v[208:211], a[32:35], v[128:131], v[208:211]
ds_read_b128 v[160:163], v31 offset:6144
v_mfma_f32_16x16x32_bf16 v[212:215], a[32:35], v[132:135], v[212:215]
ds_read_b128 v[164:167], v31 offset:14336
v_mfma_f32_16x16x32_bf16 v[216:219], a[88:91], v[96:99], v[216:219]
v_readlane_b32 s82, v37, s70
v_mfma_f32_16x16x32_bf16 v[208:211], a[36:39], v[136:139], v[208:211]
ds_read_b128 v[168:171], v31 offset:22528
v_mfma_f32_16x16x32_bf16 v[212:215], a[36:39], v[140:143], v[212:215]
ds_read_b128 v[172:175], v31 offset:30720
v_mfma_f32_16x16x32_bf16 v[220:223], a[88:91], v[100:103], v[220:223]
s_waitcnt lgkmcnt(4)
v_mfma_f32_16x16x32_bf16 v[208:211], a[40:43], v[144:147], v[208:211]
ds_read_b128 v[176:179], v31 offset:7168
v_mfma_f32_16x16x32_bf16 v[212:215], a[40:43], v[148:151], v[212:215]
ds_read_b128 v[180:183], v31 offset:15360
v_mfma_f32_16x16x32_bf16 v[216:219], a[92:95], v[104:107], v[216:219]
v_readlane_b32 s83, v38, s70
v_mfma_f32_16x16x32_bf16 v[208:211], a[44:47], v[152:155], v[208:211]
ds_read_b128 v[184:187], v31 offset:23552
v_mfma_f32_16x16x32_bf16 v[212:215], a[44:47], v[156:159], v[212:215]
ds_read_b128 v[188:191], v31 offset:31744
v_mfma_f32_16x16x32_bf16 v[220:223], a[92:95], v[108:111], v[220:223]
s_waitcnt lgkmcnt(4)
v_mfma_f32_16x16x32_bf16 v[208:211], a[48:51], v[160:163], v[208:211]
buffer_load_dword v24, v22, s[4:7], 0 offen sc1
v_mfma_f32_16x16x32_bf16 v[212:215], a[48:51], v[164:167], v[212:215]
v_readlane_b32 s84, v39, s70
v_mfma_f32_16x16x32_bf16 v[216:219], a[96:99], v[112:115], v[216:219]
s_add_u32 s52, s52, 1
v_mfma_f32_16x16x32_bf16 v[208:211], a[52:55], v[168:171], v[208:211]
s_cmp_eq_u32 s52, 64
s_cbranch_scc1 rare_167
back_168:
v_mfma_f32_16x16x32_bf16 v[212:215], a[52:55], v[172:175], v[212:215]
v_mov_b32 v27, s86
s_lshl_b32 s70, s87, 10
v_mfma_f32_16x16x32_bf16 v[220:223], a[96:99], v[116:119], v[220:223]
s_waitcnt lgkmcnt(0)
v_mfma_f32_16x16x32_bf16 v[208:211], a[56:59], v[176:179], v[208:211]
v_mfma_f32_16x16x32_bf16 v[212:215], a[56:59], v[180:183], v[212:215]
v_mfma_f32_16x16x32_bf16 v[216:219], a[100:103], v[120:123], v[216:219]
v_mfma_f32_16x16x32_bf16 v[208:211], a[60:63], v[184:187], v[208:211]
v_mfma_f32_16x16x32_bf16 v[212:215], a[60:63], v[188:191], v[212:215]
v_mfma_f32_16x16x32_bf16 v[220:223], a[100:103], v[124:127], v[220:223]
v_mfma_f32_16x16x32_bf16 v[216:219], a[104:107], v[128:131], v[216:219]
v_mfma_f32_16x16x32_bf16 v[220:223], a[104:107], v[132:135], v[220:223]
v_mfma_f32_16x16x32_bf16 v[224:227], a[144:147], v[64:67], 0
v_mfma_f32_16x16x32_bf16 v[216:219], a[108:111], v[136:139], v[216:219]
v_mfma_f32_16x16x32_bf16 v[220:223], a[108:111], v[140:143], v[220:223]
s_nop 0
v_cvt_pk_bf16_f32 v48, v208, v209
v_cvt_pk_bf16_f32 v49, v210, v211
v_mfma_f32_16x16x32_bf16 v[228:231], a[144:147], v[68:71], 0
v_cvt_pk_bf16_f32 v50, v212, v213
v_cvt_pk_bf16_f32 v51, v214, v215
v_mfma_f32_16x16x32_bf16 v[216:219], a[112:115], v[144:147], v[216:219]
v_permlane16_swap_b32 v48, v50
v_mfma_f32_16x16x32_bf16 v[220:223], a[112:115], v[148:151], v[220:223]
v_permlane16_swap_b32 v49, v51
v_mfma_f32_16x16x32_bf16 v[224:227], a[148:151], v[72:75], v[224:227]
buffer_store_dwordx4 v[48:51], v19, s[4:7], s94 offen sc1
v_mfma_f32_16x16x32_bf16 v[216:219], a[116:119], v[152:155], v[216:219]
v_mfma_f32_16x16x32_bf16 v[220:223], a[116:119], v[156:159], v[220:223]
v_mfma_f32_16x16x32_bf16 v[228:231], a[148:151], v[76:79], v[228:231]
v_mfma_f32_16x16x32_bf16 v[216:219], a[120:123], v[160:163], v[216:219]
v_mfma_f32_16x16x32_bf16 v[220:223], a[120:123], v[164:167], v[220:223]
v_mfma_f32_16x16x32_bf16 v[224:227], a[152:155], v[80:83], v[224:227]
v_mfma_f32_16x16x32_bf16 v[216:219], a[124:127], v[168:171], v[216:219]
v_mfma_f32_16x16x32_bf16 v[220:223], a[124:127], v[172:175], v[220:223]
v_mfma_f32_16x16x32_bf16 v[228:231], a[152:155], v[84:87], v[228:231]
v_mfma_f32_16x16x32_bf16 v[216:219], a[128:131], v[176:179], v[216:219]
v_mfma_f32_16x16x32_bf16 v[220:223], a[128:131], v[180:183], v[220:223]
v_mfma_f32_16x16x32_bf16 v[224:227], a[156:159], v[88:91], v[224:227]
v_mfma_f32_16x16x32_bf16 v[216:219], a[132:135], v[184:187], v[216:219]
v_mfma_f32_16x16x32_bf16 v[220:223], a[132:135], v[188:191], v[220:223]
v_mfma_f32_16x16x32_bf16 v[228:231], a[156:159], v[92:95], v[228:231]
s_waitcnt vmcnt(1)
ds_write_b32 v18, v24
v_mfma_f32_16x16x32_bf16 v[224:227], a[160:163], v[96:99], v[224:227]
v_mfma_f32_16x16x32_bf16 v[228:231], a[160:163], v[100:103], v[228:231]
v_mfma_f32_16x16x32_bf16 v[224:227], a[164:167], v[104:107], v[224:227]
s_waitcnt lgkmcnt(0)
s_barrier
v_mfma_f32_16x16x32_bf16 v[228:231], a[164:167], v[108:111], v[228:231]
ds_read_b32 v33, v32
v_mfma_f32_16x16x32_bf16 v[224:227], a[168:171], v[112:115], v[224:227]
buffer_store_dword v27, v45, s[4:7], s70 offen
v_cvt_pk_bf16_f32 v52, v216, v217
v_mfma_f32_16x16x32_bf16 v[228:231], a[168:171], v[116:119], v[228:231]
buffer_store_dword v27, v44, s[4:7], s70 offen sc1
v_mfma_f32_16x16x32_bf16 v[224:227], a[172:175], v[120:123], v[224:227]
s_waitcnt lgkmcnt(0)
v_cmp_gt_u32 vcc, s81, v33
v_mfma_f32_16x16x32_bf16 v[228:231], a[172:175], v[124:127], v[228:231]
s_lshr_b64 s[58:59], vcc, s82
s_and_b32 s58, s58, s56
s_cselect_b32 s10, 0, 268435456
s_cselect_b32 s85, 0, 1
v_mfma_f32_16x16x32_bf16 v[224:227], a[176:179], v[128:131], v[224:227]
s_cmp_eq_u32 s80, 0
s_cbranch_scc1 g_slow_166
v_mfma_f32_16x16x32_bf16 v[228:231], a[176:179], v[132:135], v[228:231]
s_add_u32 m0, s73, 0
v_cvt_pk_bf16_f32 v53, v218, v219
v_mfma_f32_16x16x32_bf16 v[224:227], a[180:183], v[136:139], v[224:227]
buffer_load_dwordx4 v8, s[8:11], s83 offen offset:0 sc1 lds
v_mfma_f32_16x16x32_bf16 v[228:231], a[180:183], v[140:143], v[228:231]
v_cvt_pk_bf16_f32 v54, v220, v221
v_cvt_pk_bf16_f32 v55, v222, v223
v_mfma_f32_16x16x32_bf16 v[224:227], a[184:187], v[144:147], v[224:227]
v_permlane16_swap_b32 v52, v54
v_mfma_f32_16x16x32_bf16 v[228:231], a[184:187], v[148:151], v[228:231]
v_permlane16_swap_b32 v53, v55
v_mfma_f32_16x16x32_bf16 v[224:227], a[188:191], v[152:155], v[224:227]
buffer_load_dwordx4 v9, s[8:11], s83 offen offset:1024 sc1 lds
ds_read_b128 v[64:67], v28 offset:0
v_mfma_f32_16x16x32_bf16 v[228:231], a[188:191], v[156:159], v[228:231]
buffer_store_dwordx4 v[52:55], v20, s[4:7], s94 offen sc1
ds_read_b128 v[68:71], v28 offset:8192
v_mfma_f32_16x16x32_bf16 v[224:227], a[192:195], v[160:163], v[224:227]
ds_read_b128 v[72:75], v28 offset:16384
v_mfma_f32_16x16x32_bf16 v[228:231], a[192:195], v[164:167], v[228:231]
ds_read_b128 v[76:79], v28 offset:24576
v_mfma_f32_16x16x32_bf16 v[224:227], a[196:199], v[168:171], v[224:227]
buffer_load_dwordx4 v10, s[8:11], s83 offen offset:2048 sc1 lds
ds_read_b128 v[80:83], v28 offset:1024
v_mfma_f32_16x16x32_bf16 v[228:231], a[196:199], v[172:175], v[228:231]
ds_read_b128 v[84:87], v28 offset:9216
v_mfma_f32_16x16x32_bf16 v[224:227], a[200:203], v[176:179], v[224:227]
ds_read_b128 v[88:91], v28 offset:17408
v_mfma_f32_16x16x32_bf16 v[228:231], a[200:203], v[180:183], v[228:231]
ds_read_b128 v[92:95], v28 offset:25600
v_mfma_f32_16x16x32_bf16 v[224:227], a[204:207], v[184:187], v[224:227]
buffer_load_dwordx4 v11, s[8:11], s83 offen offset:3072 sc1 lds
v_mfma_f32_16x16x32_bf16 v[228:231], a[204:207], v[188:191], v[228:231]
s_branch g_body_147
g_slow_163:
v_cmp_gt_u32 vcc, s81, v33
s_nop 0
s_lshr_b64 s[58:59], vcc, s82
s_and_b32 s58, s58, s56
s_cbranch_scc1 g_notyet_169
s_add_u32 m0, s73, 0
s_nop 0
buffer_load_dwordx4 v8, s[4:7], s83 offen offset:0 sc1 lds
buffer_load_dwordx4 v9, s[4:7], s83 offen offset:1024 sc1 lds
buffer_load_dwordx4 v10, s[4:7], s83 offen offset:2048 sc1 lds
buffer_load_dwordx4 v11, s[4:7], s83 offen offset:3072 sc1 lds
s_add_u32 m0, s73, 4096
s_nop 0
buffer_load_dwordx4 v12, s[4:7], s83 offen offset:0 sc1 lds
buffer_load_dwordx4 v13, s[4:7], s83 offen offset:1024 sc1 lds
buffer_load_dwordx4 v14, s[4:7], s83 offen offset:2048 sc1 lds
buffer_load_dwordx4 v15, s[4:7], s83 offen offset:3072 sc1 lds
v_mfma_f32_16x16x32_bf16 v[228:231], a[176:179], v[132:135], v[228:231]
s_add_u32 m0, s74, 0
v_cvt_pk_bf16_f32 v53, v218, v219
v_mfma_f32_16x16x32_bf16 v[224:227], a[180:183], v[136:139], v[224:227]
buffer_load_dwordx4 v8, s[8:11], s88 offen offset:0 sc1 lds
v_mfma_f32_16x16x32_bf16 v[228:231], a[180:183], v[140:143], v[228:231]
v_cvt_pk_bf16_f32 v54, v220, v221
v_cvt_pk_bf16_f32 v55, v222, v223
v_mfma_f32_16x16x32_bf16 v[224:227], a[184:187], v[144:147], v[224:227]
v_permlane16_swap_b32 v52, v54
v_mfma_f32_16x16x32_bf16 v[228:231], a[184:187], v[148:151], v[228:231]
v_permlane16_swap_b32 v53, v55
v_mfma_f32_16x16x32_bf16 v[224:227], a[188:191], v[152:155], v[224:227]
buffer_load_dwordx4 v9, s[8:11], s88 offen offset:1024 sc1 lds
v_mfma_f32_16x16x32_bf16 v[228:231], a[188:191], v[156:159], v[228:231]
buffer_store_dwordx4 v[52:55], v20, s[4:7], s79 offen sc1
v_mfma_f32_16x16x32_bf16 v[224:227], a[192:195], v[160:163], v[224:227]
v_mfma_f32_16x16x32_bf16 v[228:231], a[192:195], v[164:167], v[228:231]
v_mfma_f32_16x16x32_bf16 v[224:227], a[196:199], v[168:171], v[224:227]
buffer_load_dwordx4 v10, s[8:11], s88 offen offset:2048 sc1 lds
v_mfma_f32_16x16x32_bf16 v[228:231], a[196:199], v[172:175], v[228:231]
v_mfma_f32_16x16x32_bf16 v[224:227], a[200:203], v[176:179], v[224:227]
v_mfma_f32_16x16x32_bf16 v[228:231], a[200:203], v[180:183], v[228:231]
v_mfma_f32_16x16x32_bf16 v[224:227], a[204:207], v[184:187], v[224:227]
buffer_load_dwordx4 v11, s[8:11], s88 offen offset:3072 sc1 lds
v_mfma_f32_16x16x32_bf16 v[228:231], a[204:207], v[188:191], v[228:231]
s_nop 5
v_cvt_pk_bf16_f32 v56, v224, v225
v_cvt_pk_bf16_f32 v57, v226, v227
v_cvt_pk_bf16_f32 v58, v228, v229
v_cvt_pk_bf16_f32 v59, v230, v231
s_nop 0
v_permlane16_swap_b32 v56, v58
v_permlane16_swap_b32 v57, v59
buffer_store_dwordx4 v[56:59], v21, s[4:7], s79 offen sc1
s_mov_b32 s79, 1879048192
s_waitcnt vmcnt(6)
s_branch g_go_170
g_notyet_169:
v_mfma_f32_16x16x32_bf16 v[228:231], a[176:179], v[132:135], v[228:231]
s_add_u32 m0, s74, 0
v_cvt_pk_bf16_f32 v53, v218, v219
v_mfma_f32_16x16x32_bf16 v[224:227], a[180:183], v[136:139], v[224:227]
buffer_load_dwordx4 v8, s[8:11], s88 offen offset:0 sc1 lds
v_mfma_f32_16x16x32_bf16 v[228:231], a[180:183], v[140:143], v[228:231]
v_cvt_pk_bf16_f32 v54, v220, v221
v_cvt_pk_bf16_f32 v55, v222, v223
v_mfma_f32_16x16x32_bf16 v[224:227], a[184:187], v[144:147], v[224:227]
v_permlane16_swap_b32 v52, v54
v_mfma_f32_16x16x32_bf16 v[228:231], a[184:187], v[148:151], v[228:231]
v_permlane16_swap_b32 v53, v55
v_mfma_f32_16x16x32_bf16 v[224:227], a[188:191], v[152:155], v[224:227]
buffer_load_dwordx4 v9, s[8:11], s88 offen offset:1024 sc1 lds
v_mfma_f32_16x16x32_bf16 v[228:231], a[188:191], v[156:159], v[228:231]
buffer_store_dwordx4 v[52:55], v20, s[4:7], s79 offen sc1
v_mfma_f32_16x16x32_bf16 v[224:227], a[192:195], v[160:163], v[224:227]
v_mfma_f32_16x16x32_bf16 v[228:231], a[192:195], v[164:167], v[228:231]
v_mfma_f32_16x16x32_bf16 v[224:227], a[196:199], v[168:171], v[224:227]
buffer_load_dwordx4 v10, s[8:11], s88 offen offset:2048 sc1 lds
v_mfma_f32_16x16x32_bf16 v[228:231], a[196:199], v[172:175], v[228:231]
v_mfma_f32_16x16x32_bf16 v[224:227], a[200:203], v[176:179], v[224:227]
v_mfma_f32_16x16x32_bf16 v[228:231], a[200:203], v[180:183], v[228:231]
v_mfma_f32_16x16x32_bf16 v[224:227], a[204:207], v[184:187], v[224:227]
buffer_load_dwordx4 v11, s[8:11], s88 offen offset:3072 sc1 lds
v_mfma_f32_16x16x32_bf16 v[228:231], a[204:207], v[188:191], v[228:231]
s_nop 5
v_cvt_pk_bf16_f32 v56, v224, v225
v_cvt_pk_bf16_f32 v57, v226, v227
v_cvt_pk_bf16_f32 v58, v228, v229
v_cvt_pk_bf16_f32 v59, v230, v231
s_nop 0
v_permlane16_swap_b32 v56, v58
v_permlane16_swap_b32 v57, v59
buffer_store_dwordx4 v[56:59], v21, s[4:7], s79 offen sc1
s_mov_b32 s79, 1879048192
v_mov_b32 v27, s76
s_lshl_b32 s70, s77, 10
s_waitcnt vmcnt(0)
s_barrier
buffer_store_dword v27, v45, s[4:7], s70 offen
buffer_store_dword v27, v44, s[4:7], s70 offen sc1
s_mov_b32 s77, 1835008
s_cmp_eq_u32 s81, -1
s_cbranch_scc1 g_fin_155
s_cmp_lg_u32 s3, 0
s_cbranch_scc1 sp_ok_172
s_mov_b32 s55, 0
sp_loop_171:
s_lshl_b64 exec, s[56:57], s82
buffer_load_dword v26, v22, s[4:7], 0 offen sc1
s_mov_b64 exec, -1
s_add_u32 s55, s55, 1
s_cmp_gt_u32 s55, 150000
s_cbranch_scc1 sp_bad_173
s_waitcnt vmcnt(0)
v_cmp_gt_u32 vcc, s81, v26
s_nop 0
s_lshr_b64 s[58:59], vcc, s82
s_and_b32 s58, s58, s56
s_cbranch_scc0 sp_ok_172
s_sleep 1
s_branch sp_loop_171
sp_bad_173:
s_mov_b32 s98, 1029
s_branch L_fail
sp_ok_172:
s_barrier
s_add_u32 m0, s73, 0
s_nop 0
buffer_load_dwordx4 v8, s[4:7], s83 offen offset:0 sc1 lds
buffer_load_dwordx4 v9, s[4:7], s83 offen offset:1024 sc1 lds
buffer_load_dwordx4 v10, s[4:7], s83 offen offset:2048 sc1 lds
buffer_load_dwordx4 v11, s[4:7], s83 offen offset:3072 sc1 lds
s_add_u32 m0, s73, 4096
s_nop 0
buffer_load_dwordx4 v12, s[4:7], s83 offen offset:0 sc1 lds
buffer_load_dwordx4 v13, s[4:7], s83 offen offset:1024 sc1 lds
buffer_load_dwordx4 v14, s[4:7], s83 offen offset:2048 sc1 lds
buffer_load_dwordx4 v15, s[4:7], s83 offen offset:3072 sc1 lds
s_waitcnt vmcnt(0)
g_go_170:
g_join_152:
s_barrier
ds_read_b128 v[64:67], v29 offset:0
ds_read_b128 v[68:71], v29 offset:8192
ds_read_b128 v[72:75], v29 offset:16384
ds_read_b128 v[76:79], v29 offset:24576
ds_read_b128 v[80:83], v29 offset:1024
ds_read_b128 v[84:87], v29 offset:9216
ds_read_b128 v[88:91], v29 offset:17408
ds_read_b128 v[92:95], v29 offset:25600
s_branch g_body_148
g_slow_164:
v_cmp_gt_u32 vcc, s86, v33
s_nop 0
s_lshr_b64 s[58:59], vcc, s87
s_and_b32 s58, s58, s56
s_cbranch_scc1 g_notyet_174
s_add_u32 m0, s74, 0
s_nop 0
buffer_load_dwordx4 v8, s[4:7], s88 offen offset:0 sc1 lds
buffer_load_dwordx4 v9, s[4:7], s88 offen offset:1024 sc1 lds
buffer_load_dwordx4 v10, s[4:7], s88 offen offset:2048 sc1 lds
buffer_load_dwordx4 v11, s[4:7], s88 offen offset:3072 sc1 lds
s_add_u32 m0, s74, 4096
s_nop 0
buffer_load_dwordx4 v12, s[4:7], s88 offen offset:0 sc1 lds
buffer_load_dwordx4 v13, s[4:7], s88 offen offset:1024 sc1 lds
buffer_load_dwordx4 v14, s[4:7], s88 offen offset:2048 sc1 lds
buffer_load_dwordx4 v15, s[4:7], s88 offen offset:3072 sc1 lds
v_mfma_f32_16x16x32_bf16 v[228:231], a[176:179], v[132:135], v[228:231]
s_add_u32 m0, s75, 0
v_cvt_pk_bf16_f32 v53, v218, v219
v_mfma_f32_16x16x32_bf16 v[224:227], a[180:183], v[136:139], v[224:227]
buffer_load_dwordx4 v8, s[8:11], s93 offen offset:0 sc1 lds
v_mfma_f32_16x16x32_bf16 v[228:231], a[180:183], v[140:143], v[228:231]
v_cvt_pk_bf16_f32 v54, v220, v221
v_cvt_pk_bf16_f32 v55, v222, v223
v_mfma_f32_16x16x32_bf16 v[224:227], a[184:187], v[144:147], v[224:227]
v_permlane16_swap_b32 v52, v54
v_mfma_f32_16x16x32_bf16 v[228:231], a[184:187], v[148:151], v[228:231]
v_permlane16_swap_b32 v53, v55
v_mfma_f32_16x16x32_bf16 v[224:227], a[188:191], v[152:155], v[224:227]
buffer_load_dwordx4 v9, s[8:11], s93 offen offset:1024 sc1 lds
v_mfma_f32_16x16x32_bf16 v[228:231], a[188:191], v[156:159], v[228:231]
buffer_store_dwordx4 v[52:55], v20, s[4:7], s84 offen sc1
v_mfma_f32_16x16x32_bf16 v[224:227], a[192:195], v[160:163], v[224:227]
v_mfma_f32_16x16x32_bf16 v[228:231], a[192:195], v[164:167], v[228:231]
v_mfma_f32_16x16x32_bf16 v[224:227], a[196:199], v[168:171], v[224:227]
buffer_load_dwordx4 v10, s[8:11], s93 offen offset:2048 sc1 lds
v_mfma_f32_16x16x32_bf16 v[228:231], a[196:199], v[172:175], v[228:231]
v_mfma_f32_16x16x32_bf16 v[224:227], a[200:203], v[176:179], v[224:227]
v_mfma_f32_16x16x32_bf16 v[228:231], a[200:203], v[180:183], v[228:231]
v_mfma_f32_16x16x32_bf16 v[224:227], a[204:207], v[184:187], v[224:227]
buffer_load_dwordx4 v11, s[8:11], s93 offen offset:3072 sc1 lds
v_mfma_f32_16x16x32_bf16 v[228:231], a[204:207], v[188:191], v[228:231]
s_nop 5
v_cvt_pk_bf16_f32 v56, v224, v225
v_cvt_pk_bf16_f32 v57, v226, v227
v_cvt_pk_bf16_f32 v58, v228, v229
v_cvt_pk_bf16_f32 v59, v230, v231
s_nop 0
v_permlane16_swap_b32 v56, v58
v_permlane16_swap_b32 v57, v59
buffer_store_dwordx4 v[56:59], v21, s[4:7], s84 offen sc1
s_mov_b32 s84, 1879048192
s_waitcnt vmcnt(6)
s_branch g_go_175
g_notyet_174:
v_mfma_f32_16x16x32_bf16 v[228:231], a[176:179], v[132:135], v[228:231]
s_add_u32 m0, s75, 0
v_cvt_pk_bf16_f32 v53, v218, v219
v_mfma_f32_16x16x32_bf16 v[224:227], a[180:183], v[136:139], v[224:227]
buffer_load_dwordx4 v8, s[8:11], s93 offen offset:0 sc1 lds
v_mfma_f32_16x16x32_bf16 v[228:231], a[180:183], v[140:143], v[228:231]
v_cvt_pk_bf16_f32 v54, v220, v221
v_cvt_pk_bf16_f32 v55, v222, v223
v_mfma_f32_16x16x32_bf16 v[224:227], a[184:187], v[144:147], v[224:227]
v_permlane16_swap_b32 v52, v54
v_mfma_f32_16x16x32_bf16 v[228:231], a[184:187], v[148:151], v[228:231]
v_permlane16_swap_b32 v53, v55
v_mfma_f32_16x16x32_bf16 v[224:227], a[188:191], v[152:155], v[224:227]
buffer_load_dwordx4 v9, s[8:11], s93 offen offset:1024 sc1 lds
v_mfma_f32_16x16x32_bf16 v[228:231], a[188:191], v[156:159], v[228:231]
buffer_store_dwordx4 v[52:55], v20, s[4:7], s84 offen sc1
v_mfma_f32_16x16x32_bf16 v[224:227], a[192:195], v[160:163], v[224:227]
v_mfma_f32_16x16x32_bf16 v[228:231], a[192:195], v[164:167], v[228:231]
v_mfma_f32_16x16x32_bf16 v[224:227], a[196:199], v[168:171], v[224:227]
buffer_load_dwordx4 v10, s[8:11], s93 offen offset:2048 sc1 lds
v_mfma_f32_16x16x32_bf16 v[228:231], a[196:199], v[172:175], v[228:231]
v_mfma_f32_16x16x32_bf16 v[224:227], a[200:203], v[176:179], v[224:227]
v_mfma_f32_16x16x32_bf16 v[228:231], a[200:203], v[180:183], v[228:231]
v_mfma_f32_16x16x32_bf16 v[224:227], a[204:207], v[184:187], v[224:227]
buffer_load_dwordx4 v11, s[8:11], s93 offen offset:3072 sc1 lds
v_mfma_f32_16x16x32_bf16 v[228:231], a[204:207], v[188:191], v[228:231]
s_nop 5
v_cvt_pk_bf16_f32 v56, v224, v225
v_cvt_pk_bf16_f32 v57, v226, v227
v_cvt_pk_bf16_f32 v58, v228, v229
v_cvt_pk_bf16_f32 v59, v230, v231
s_nop 0
v_permlane16_swap_b32 v56, v58
v_permlane16_swap_b32 v57, v59
buffer_store_dwordx4 v[56:59], v21, s[4:7], s84 offen sc1
s_mov_b32 s84, 1879048192
v_mov_b32 v27, s81
s_lshl_b32 s70, s82, 10
s_waitcnt vmcnt(0)
s_barrier
buffer_store_dword v27, v45, s[4:7], s70 offen
buffer_store_dword v27, v44, s[4:7], s70 offen sc1
s_mov_b32 s82, 1835008
s_cmp_eq_u32 s86, -1
s_cbranch_scc1 g_fin_155
s_cmp_lg_u32 s3, 0
s_cbranch_scc1 sp_ok_177
s_mov_b32 s55, 0
sp_loop_176:
s_lshl_b64 exec, s[56:57], s87
buffer_load_dword v26, v22, s[4:7], 0 offen sc1
s_mov_b64 exec, -1
s_add_u32 s55, s55, 1
s_cmp_gt_u32 s55, 150000
s_cbranch_scc1 sp_bad_178
s_waitcnt vmcnt(0)
v_cmp_gt_u32 vcc, s86, v26
s_nop 0
s_lshr_b64 s[58:59], vcc, s87
s_and_b32 s58, s58, s56
s_cbranch_scc0 sp_ok_177
s_sleep 1
s_branch sp_loop_176
sp_bad_178:
s_mov_b32 s98, 1029
s_branch L_fail
sp_ok_177:
s_barrier
s_add_u32 m0, s74, 0
s_nop 0
buffer_load_dwordx4 v8, s[4:7], s88 offen offset:0 sc1 lds
buffer_load_dwordx4 v9, s[4:7], s88 offen offset:1024 sc1 lds
buffer_load_dwordx4 v10, s[4:7], s88 offen offset:2048 sc1 lds
buffer_load_dwordx4 v11, s[4:7], s88 offen offset:3072 sc1 lds
s_add_u32 m0, s74, 4096
s_nop 0
buffer_load_dwordx4 v12, s[4:7], s88 offen offset:0 sc1 lds
buffer_load_dwordx4 v13, s[4:7], s88 offen offset:1024 sc1 lds
buffer_load_dwordx4 v14, s[4:7], s88 offen offset:2048 sc1 lds
buffer_load_dwordx4 v15, s[4:7], s88 offen offset:3072 sc1 lds
s_waitcnt vmcnt(0)
g_go_175:
g_join_153:
s_barrier
ds_read_b128 v[64:67], v30 offset:0
ds_read_b128 v[68:71], v30 offset:8192
ds_read_b128 v[72:75], v30 offset:16384
ds_read_b128 v[76:79], v30 offset:24576
ds_read_b128 v[80:83], v30 offset:1024
ds_read_b128 v[84:87], v30 offset:9216
ds_read_b128 v[88:91], v30 offset:17408
ds_read_b128 v[92:95], v30 offset:25600
s_branch g_body_149
g_slow_165:
v_cmp_gt_u32 vcc, s91, v33
s_nop 0
s_lshr_b64 s[58:59], vcc, s92
s_and_b32 s58, s58, s56
s_cbranch_scc1 g_notyet_179
s_add_u32 m0, s75, 0
s_nop 0
buffer_load_dwordx4 v8, s[4:7], s93 offen offset:0 sc1 lds
buffer_load_dwordx4 v9, s[4:7], s93 offen offset:1024 sc1 lds
buffer_load_dwordx4 v10, s[4:7], s93 offen offset:2048 sc1 lds
buffer_load_dwordx4 v11, s[4:7], s93 offen offset:3072 sc1 lds
s_add_u32 m0, s75, 4096
s_nop 0
buffer_load_dwordx4 v12, s[4:7], s93 offen offset:0 sc1 lds
buffer_load_dwordx4 v13, s[4:7], s93 offen offset:1024 sc1 lds
buffer_load_dwordx4 v14, s[4:7], s93 offen offset:2048 sc1 lds
buffer_load_dwordx4 v15, s[4:7], s93 offen offset:3072 sc1 lds
v_mfma_f32_16x16x32_bf16 v[228:231], a[176:179], v[132:135], v[228:231]
s_add_u32 m0, s72, 0
v_cvt_pk_bf16_f32 v53, v218, v219
v_mfma_f32_16x16x32_bf16 v[224:227], a[180:183], v[136:139], v[224:227]
buffer_load_dwordx4 v8, s[8:11], s78 offen offset:0 sc1 lds
v_mfma_f32_16x16x32_bf16 v[228:231], a[180:183], v[140:143], v[228:231]
v_cvt_pk_bf16_f32 v54, v220, v221
v_cvt_pk_bf16_f32 v55, v222, v223
v_mfma_f32_16x16x32_bf16 v[224:227], a[184:187], v[144:147], v[224:227]
v_permlane16_swap_b32 v52, v54
v_mfma_f32_16x16x32_bf16 v[228:231], a[184:187], v[148:151], v[228:231]
v_permlane16_swap_b32 v53, v55
v_mfma_f32_16x16x32_bf16 v[224:227], a[188:191], v[152:155], v[224:227]
buffer_load_dwordx4 v9, s[8:11], s78 offen offset:1024 sc1 lds
v_mfma_f32_16x16x32_bf16 v[228:231], a[188:191], v[156:159], v[228:231]
buffer_store_dwordx4 v[52:55], v20, s[4:7], s89 offen sc1
v_mfma_f32_16x16x32_bf16 v[224:227], a[192:195], v[160:163], v[224:227]
v_mfma_f32_16x16x32_bf16 v[228:231], a[192:195], v[164:167], v[228:231]
v_mfma_f32_16x16x32_bf16 v[224:227], a[196:199], v[168:171], v[224:227]
buffer_load_dwordx4 v10, s[8:11], s78 offen offset:2048 sc1 lds
v_mfma_f32_16x16x32_bf16 v[228:231], a[196:199], v[172:175], v[228:231]
v_mfma_f32_16x16x32_bf16 v[224:227], a[200:203], v[176:179], v[224:227]
v_mfma_f32_16x16x32_bf16 v[228:231], a[200:203], v[180:183], v[228:231]
v_mfma_f32_16x16x32_bf16 v[224:227], a[204:207], v[184:187], v[224:227]
buffer_load_dwordx4 v11, s[8:11], s78 offen offset:3072 sc1 lds
v_mfma_f32_16x16x32_bf16 v[228:231], a[204:207], v[188:191], v[228:231]
s_nop 5
v_cvt_pk_bf16_f32 v56, v224, v225
v_cvt_pk_bf16_f32 v57, v226, v227
v_cvt_pk_bf16_f32 v58, v228, v229
v_cvt_pk_bf16_f32 v59, v230, v231
s_nop 0
v_permlane16_swap_b32 v56, v58
v_permlane16_swap_b32 v57, v59
buffer_store_dwordx4 v[56:59], v21, s[4:7], s89 offen sc1
s_mov_b32 s89, 1879048192
s_waitcnt vmcnt(6)
s_branch g_go_180
g_notyet_179:
v_mfma_f32_16x16x32_bf16 v[228:231], a[176:179], v[132:135], v[228:231]
s_add_u32 m0, s72, 0
v_cvt_pk_bf16_f32 v53, v218, v219
v_mfma_f32_16x16x32_bf16 v[224:227], a[180:183], v[136:139], v[224:227]
buffer_load_dwordx4 v8, s[8:11], s78 offen offset:0 sc1 lds
v_mfma_f32_16x16x32_bf16 v[228:231], a[180:183], v[140:143], v[228:231]
v_cvt_pk_bf16_f32 v54, v220, v221
v_cvt_pk_bf16_f32 v55, v222, v223
v_mfma_f32_16x16x32_bf16 v[224:227], a[184:187], v[144:147], v[224:227]
v_permlane16_swap_b32 v52, v54
v_mfma_f32_16x16x32_bf16 v[228:231], a[184:187], v[148:151], v[228:231]
v_permlane16_swap_b32 v53, v55
v_mfma_f32_16x16x32_bf16 v[224:227], a[188:191], v[152:155], v[224:227]
buffer_load_dwordx4 v9, s[8:11], s78 offen offset:1024 sc1 lds
v_mfma_f32_16x16x32_bf16 v[228:231], a[188:191], v[156:159], v[228:231]
buffer_store_dwordx4 v[52:55], v20, s[4:7], s89 offen sc1
v_mfma_f32_16x16x32_bf16 v[224:227], a[192:195], v[160:163], v[224:227]
v_mfma_f32_16x16x32_bf16 v[228:231], a[192:195], v[164:167], v[228:231]
v_mfma_f32_16x16x32_bf16 v[224:227], a[196:199], v[168:171], v[224:227]
buffer_load_dwordx4 v10, s[8:11], s78 offen offset:2048 sc1 lds
v_mfma_f32_16x16x32_bf16 v[228:231], a[196:199], v[172:175], v[228:231]
v_mfma_f32_16x16x32_bf16 v[224:227], a[200:203], v[176:179], v[224:227]
v_mfma_f32_16x16x32_bf16 v[228:231], a[200:203], v[180:183], v[228:231]
v_mfma_f32_16x16x32_bf16 v[224:227], a[204:207], v[184:187], v[224:227]
buffer_load_dwordx4 v11, s[8:11], s78 offen offset:3072 sc1 lds
v_mfma_f32_16x16x32_bf16 v[228:231], a[204:207], v[188:191], v[228:231]
s_nop 5
v_cvt_pk_bf16_f32 v56, v224, v225
v_cvt_pk_bf16_f32 v57, v226, v227
v_cvt_pk_bf16_f32 v58, v228, v229
v_cvt_pk_bf16_f32 v59, v230, v231
s_nop 0
v_permlane16_swap_b32 v56, v58
v_permlane16_swap_b32 v57, v59
buffer_store_dwordx4 v[56:59], v21, s[4:7], s89 offen sc1
s_mov_b32 s89, 1879048192
v_mov_b32 v27, s86
s_lshl_b32 s70, s87, 10
s_waitcnt vmcnt(0)
s_barrier
buffer_store_dword v27, v45, s[4:7], s70 offen
buffer_store_dword v27, v44, s[4:7], s70 offen sc1
s_mov_b32 s87, 1835008
s_cmp_eq_u32 s91, -1
s_cbranch_scc1 g_fin_155
s_cmp_lg_u32 s3, 0
s_cbranch_scc1 sp_ok_182
s_mov_b32 s55, 0
sp_loop_181:
s_lshl_b64 exec, s[56:57], s92
buffer_load_dword v26, v22, s[4:7], 0 offen sc1
s_mov_b64 exec, -1
s_add_u32 s55, s55, 1
s_cmp_gt_u32 s55, 150000
s_cbranch_scc1 sp_bad_183
s_waitcnt vmcnt(0)
v_cmp_gt_u32 vcc, s91, v26
s_nop 0
s_lshr_b64 s[58:59], vcc, s92
s_and_b32 s58, s58, s56
s_cbranch_scc0 sp_ok_182
s_sleep 1
s_branch sp_loop_181
sp_bad_183:
s_mov_b32 s98, 1029
s_branch L_fail
sp_ok_182:
s_barrier
s_add_u32 m0, s75, 0
s_nop 0
buffer_load_dwordx4 v8, s[4:7], s93 offen offset:0 sc1 lds
buffer_load_dwordx4 v9, s[4:7], s93 offen offset:1024 sc1 lds
buffer_load_dwordx4 v10, s[4:7], s93 offen offset:2048 sc1 lds
buffer_load_dwordx4 v11, s[4:7], s93 offen offset:3072 sc1 lds
s_add_u32 m0, s75, 4096
s_nop 0
buffer_load_dwordx4 v12, s[4:7], s93 offen offset:0 sc1 lds
buffer_load_dwordx4 v13, s[4:7], s93 offen offset:1024 sc1 lds
buffer_load_dwordx4 v14, s[4:7], s93 offen offset:2048 sc1 lds
buffer_load_dwordx4 v15, s[4:7], s93 offen offset:3072 sc1 lds
s_waitcnt vmcnt(0)
g_go_180:
g_join_154:
s_barrier
ds_read_b128 v[64:67], v31 offset:0
ds_read_b128 v[68:71], v31 offset:8192
ds_read_b128 v[72:75], v31 offset:16384
ds_read_b128 v[76:79], v31 offset:24576
ds_read_b128 v[80:83], v31 offset:1024
ds_read_b128 v[84:87], v31 offset:9216
ds_read_b128 v[88:91], v31 offset:17408
ds_read_b128 v[92:95], v31 offset:25600
s_branch g_body_150
g_slow_166:
v_cmp_gt_u32 vcc, s76, v33
s_nop 0
s_lshr_b64 s[58:59], vcc, s77
s_and_b32 s58, s58, s56
s_cbranch_scc1 g_notyet_184
s_add_u32 m0, s72, 0
s_nop 0
buffer_load_dwordx4 v8, s[4:7], s78 offen offset:0 sc1 lds
buffer_load_dwordx4 v9, s[4:7], s78 offen offset:1024 sc1 lds
buffer_load_dwordx4 v10, s[4:7], s78 offen offset:2048 sc1 lds
buffer_load_dwordx4 v11, s[4:7], s78 offen offset:3072 sc1 lds
s_add_u32 m0, s72, 4096
s_nop 0
buffer_load_dwordx4 v12, s[4:7], s78 offen offset:0 sc1 lds
buffer_load_dwordx4 v13, s[4:7], s78 offen offset:1024 sc1 lds
buffer_load_dwordx4 v14, s[4:7], s78 offen offset:2048 sc1 lds
buffer_load_dwordx4 v15, s[4:7], s78 offen offset:3072 sc1 lds
v_mfma_f32_16x16x32_bf16 v[228:231], a[176:179], v[132:135], v[228:231]
s_add_u32 m0, s73, 0
v_cvt_pk_bf16_f32 v53, v218, v219
v_mfma_f32_16x16x32_bf16 v[224:227], a[180:183], v[136:139], v[224:227]
buffer_load_dwordx4 v8, s[8:11], s83 offen offset:0 sc1 lds
v_mfma_f32_16x16x32_bf16 v[228:231], a[180:183], v[140:143], v[228:231]
v_cvt_pk_bf16_f32 v54, v220, v221
v_cvt_pk_bf16_f32 v55, v222, v223
v_mfma_f32_16x16x32_bf16 v[224:227], a[184:187], v[144:147], v[224:227]
v_permlane16_swap_b32 v52, v54
v_mfma_f32_16x16x32_bf16 v[228:231], a[184:187], v[148:151], v[228:231]
v_permlane16_swap_b32 v53, v55
v_mfma_f32_16x16x32_bf16 v[224:227], a[188:191], v[152:155], v[224:227]
buffer_load_dwordx4 v9, s[8:11], s83 offen offset:1024 sc1 lds
v_mfma_f32_16x16x32_bf16 v[228:231], a[188:191], v[156:159], v[228:231]
buffer_store_dwordx4 v[52:55], v20, s[4:7], s94 offen sc1
v_mfma_f32_16x16x32_bf16 v[224:227], a[192:195], v[160:163], v[224:227]
v_mfma_f32_16x16x32_bf16 v[228:231], a[192:195], v[164:167], v[228:231]
v_mfma_f32_16x16x32_bf16 v[224:227], a[196:199], v[168:171], v[224:227]
buffer_load_dwordx4 v10, s[8:11], s83 offen offset:2048 sc1 lds
v_mfma_f32_16x16x32_bf16 v[228:231], a[196:199], v[172:175], v[228:231]
v_mfma_f32_16x16x32_bf16 v[224:227], a[200:203], v[176:179], v[224:227]
v_mfma_f32_16x16x32_bf16 v[228:231], a[200:203], v[180:183], v[228:231]
v_mfma_f32_16x16x32_bf16 v[224:227], a[204:207], v[184:187], v[224:227]
buffer_load_dwordx4 v11, s[8:11], s83 offen offset:3072 sc1 lds
v_mfma_f32_16x16x32_bf16 v[228:231], a[204:207], v[188:191], v[228:231]
s_nop 5
v_cvt_pk_bf16_f32 v56, v224, v225
v_cvt_pk_bf16_f32 v57, v226, v227
v_cvt_pk_bf16_f32 v58, v228, v229
v_cvt_pk_bf16_f32 v59, v230, v231
s_nop 0
v_permlane16_swap_b32 v56, v58
v_permlane16_swap_b32 v57, v59
buffer_store_dwordx4 v[56:59], v21, s[4:7], s94 offen sc1
s_mov_b32 s94, 1879048192
s_waitcnt vmcnt(6)
s_branch g_go_185
g_notyet_184:
v_mfma_f32_16x16x32_bf16 v[228:231], a[176:179], v[132:135], v[228:231]
s_add_u32 m0, s73, 0
v_cvt_pk_bf16_f32 v53, v218, v219
v_mfma_f32_16x16x32_bf16 v[224:227], a[180:183], v[136:139], v[224:227]
buffer_load_dwordx4 v8, s[8:11], s83 offen offset:0 sc1 lds
v_mfma_f32_16x16x32_bf16 v[228:231], a[180:183], v[140:143], v[228:231]
v_cvt_pk_bf16_f32 v54, v220, v221
v_cvt_pk_bf16_f32 v55, v222, v223
v_mfma_f32_16x16x32_bf16 v[224:227], a[184:187], v[144:147], v[224:227]
v_permlane16_swap_b32 v52, v54
v_mfma_f32_16x16x32_bf16 v[228:231], a[184:187], v[148:151], v[228:231]
v_permlane16_swap_b32 v53, v55
v_mfma_f32_16x16x32_bf16 v[224:227], a[188:191], v[152:155], v[224:227]
buffer_load_dwordx4 v9, s[8:11], s83 offen offset:1024 sc1 lds
v_mfma_f32_16x16x32_bf16 v[228:231], a[188:191], v[156:159], v[228:231]
buffer_store_dwordx4 v[52:55], v20, s[4:7], s94 offen sc1
v_mfma_f32_16x16x32_bf16 v[224:227], a[192:195], v[160:163], v[224:227]
v_mfma_f32_16x16x32_bf16 v[228:231], a[192:195], v[164:167], v[228:231]
v_mfma_f32_16x16x32_bf16 v[224:227], a[196:199], v[168:171], v[224:227]
buffer_load_dwordx4 v10, s[8:11], s83 offen offset:2048 sc1 lds
v_mfma_f32_16x16x32_bf16 v[228:231], a[196:199], v[172:175], v[228:231]
v_mfma_f32_16x16x32_bf16 v[224:227], a[200:203], v[176:179], v[224:227]
v_mfma_f32_16x16x32_bf16 v[228:231], a[200:203], v[180:183], v[228:231]
v_mfma_f32_16x16x32_bf16 v[224:227], a[204:207], v[184:187], v[224:227]
buffer_load_dwordx4 v11, s[8:11], s83 offen offset:3072 sc1 lds
v_mfma_f32_16x16x32_bf16 v[228:231], a[204:207], v[188:191], v[228:231]
s_nop 5
v_cvt_pk_bf16_f32 v56, v224, v225
v_cvt_pk_bf16_f32 v57, v226, v227
v_cvt_pk_bf16_f32 v58, v228, v229
v_cvt_pk_bf16_f32 v59, v230, v231
s_nop 0
v_permlane16_swap_b32 v56, v58
v_permlane16_swap_b32 v57, v59
buffer_store_dwordx4 v[56:59], v21, s[4:7], s94 offen sc1
s_mov_b32 s94, 1879048192
v_mov_b32 v27, s91
s_lshl_b32 s70, s92, 10
s_waitcnt vmcnt(0)
s_barrier
buffer_store_dword v27, v45, s[4:7], s70 offen
buffer_store_dword v27, v44, s[4:7], s70 offen sc1
s_mov_b32 s92, 1835008
s_cmp_eq_u32 s76, -1
s_cbranch_scc1 g_fin_155
s_cmp_lg_u32 s3, 0
s_cbranch_scc1 sp_ok_187
s_mov_b32 s55, 0
sp_loop_186:
s_lshl_b64 exec, s[56:57], s77
buffer_load_dword v26, v22, s[4:7], 0 offen sc1
s_mov_b64 exec, -1
s_add_u32 s55, s55, 1
s_cmp_gt_u32 s55, 150000
s_cbranch_scc1 sp_bad_188
s_waitcnt vmcnt(0)
v_cmp_gt_u32 vcc, s76, v26
s_nop 0
s_lshr_b64 s[58:59], vcc, s77
s_and_b32 s58, s58, s56
s_cbranch_scc0 sp_ok_187
s_sleep 1
s_branch sp_loop_186
sp_bad_188:
s_mov_b32 s98, 1029
s_branch L_fail
sp_ok_187:
s_barrier
s_add_u32 m0, s72, 0
s_nop 0
buffer_load_dwordx4 v8, s[4:7], s78 offen offset:0 sc1 lds
buffer_load_dwordx4 v9, s[4:7], s78 offen offset:1024 sc1 lds
buffer_load_dwordx4 v10, s[4:7], s78 offen offset:2048 sc1 lds
buffer_load_dwordx4 v11, s[4:7], s78 offen offset:3072 sc1 lds
s_add_u32 m0, s72, 4096
s_nop 0
buffer_load_dwordx4 v12, s[4:7], s78 offen offset:0 sc1 lds
buffer_load_dwordx4 v13, s[4:7], s78 offen offset:1024 sc1 lds
buffer_load_dwordx4 v14, s[4:7], s78 offen offset:2048 sc1 lds
buffer_load_dwordx4 v15, s[4:7], s78 offen offset:3072 sc1 lds
s_waitcnt vmcnt(0)
g_go_185:
s_branch g_join_151
g_fin_155:
s_endpgm
rare_167:
v_mov_b32 v36, v40
v_mov_b32 v37, v41
v_mov_b32 v38, v42
v_mov_b32 v39, v43
s_branch back_168
H_up:
s_mov_b32 s8, s32
s_and_b32 s9, s33, 0xffff
s_mov_b32 s10, 5308416
s_mov_b32 s11, 0x20000
s_mov_b32 s12, s34
s_and_b32 s13, s35, 0xffff
s_mov_b32 s14, 5308416
s_mov_b32 s15, 0x20000
s_mul_i32 s75, s74, 192
s_lshl_b32 s76, s3, 5
s_add_u32 s48, s75, s76
s_mov_b32 s49, s48
s_lshr_b32 s77, s3, 1
s_lshl_b32 s76, s77, 5
s_add_u32 s76, s76, s75
s_add_u32 s50, s76, 128
s_mov_b32 s51, s50
s_mul_i32 s75, s74, 6144
v_lshrrev_b32 v1, 5, v0
v_lshlrev_b32 v1, 10, v1
v_and_b32 v2, 15, v0
v_lshl_add_u32 v1, v2, 4, v1
v_bfe_u32 v2, v0, 4, 1
v_lshl_add_u32 v1, v2, 3, v1
s_lshl_b32 s76, s3, 8
s_add_u32 s76, s76, s75
s_add_u32 s76, s76, 4096
v_add_u32 v19, s76, v1
v_bfe_u32 v1, v0, 4, 1
v_lshlrev_b32 v1, 10, v1
v_lshrrev_b32 v2, 5, v0
v_lshl_add_u32 v1, v2, 8, v1
v_and_b32 v2, 15, v0
v_lshl_add_u32 v5, v2, 4, v1
s_lshl_b32 s76, s77, 11
s_add_u32 s76, s76, s75
s_and_b32 s77, s3, 1
s_lshl_b32 s77, s77, 9
s_add_u32 s76, s76, s77
v_add_u32 v20, s76, v5
s_getpc_b64 s[96:97]
pc_189:
s_add_u32 s96, s96, L_order_post-pc_189
s_addc_u32 s97, s97, 0
v_lshlrev_b32 v1, 2, v0
global_load_dword v36, v1, s[96:97]
global_load_dword v40, v1, s[96:97] offset:256
v_lshrrev_b32 v1, 5, v0
v_bfe_u32 v2, v0, 3, 1
v_lshl_add_u32 v1, v1, 1, v2
v_bfe_u32 v2, v0, 4, 1
v_bfe_u32 v3, v0, 1, 2
v_lshlrev_b32 v1, 3, v1
v_lshl_add_u32 v1, v2, 2, v1
v_add_u32 v1, v1, v3
v_mul_u32_u24 v1, 9216, v1
v_and_b32 v2, 1, v0
v_lshl_add_u32 v63, v2, 4, v1
s_mul_i32 s70, s3, 40960
v_lshrrev_b32 v1, 5, v0
v_lshlrev_b32 v1, 9, v1
v_bfe_u32 v2, v0, 4, 1
v_lshl_add_u32 v1, v2, 7, v1
v_add_u32 v1, s70, v1
v_and_b32 v2, 15, v0
v_lshl_add_u32 v2, v2, 3, v1
v_mov_b32 v61, v2
v_add_u32 v62, 1024, v2
v_bfe_u32 v2, v0, 2, 2
v_lshl_add_u32 v1, v2, 5, v1
v_bfe_u32 v2, v0, 1, 1
v_lshl_add_u32 v1, v2, 10, v1
v_and_b32 v2, 1, v0
v_lshl_add_u32 v1, v2, 3, v1
s_and_b32 s71, s3, 1
s_lshl_b32 s71, s71, 4
s_add_u32 s71, s71, 2048
v_add_u32 v60, s71, v1
s_add_u32 m0, s70, 0
s_add_u32 s71, s48, 0
buffer_load_dwordx4 v63, s[8:11], s71 offen lds
s_add_u32 m0, s70, 1024
s_add_u32 s71, s49, 0
buffer_load_dwordx4 v63, s[12:15], s71 offen lds
s_add_u32 m0, s70, 2048
s_add_u32 s71, s50, 0
buffer_load_dwordx4 v63, s[8:11], s71 offen lds
s_add_u32 m0, s70, 3072
s_add_u32 s71, s51, 0
buffer_load_dwordx4 v63, s[12:15], s71 offen lds
s_add_u32 m0, s70, 4096
s_add_u32 s71, s48, 294912
buffer_load_dwordx4 v63, s[8:11], s71 offen lds
s_add_u32 m0, s70, 5120
s_add_u32 s71, s49, 294912
buffer_load_dwordx4 v63, s[12:15], s71 offen lds
s_add_u32 m0, s70, 6144
s_add_u32 s71, s50, 294912
buffer_load_dwordx4 v63, s[8:11], s71 offen lds
s_add_u32 m0, s70, 7168
s_add_u32 s71, s51, 294912
buffer_load_dwordx4 v63, s[12:15], s71 offen lds
s_add_u32 m0, s70, 8192
s_add_u32 s71, s48, 589824
buffer_load_dwordx4 v63, s[8:11], s71 offen lds
s_add_u32 m0, s70, 9216
s_add_u32 s71, s49, 589824
buffer_load_dwordx4 v63, s[12:15], s71 offen lds
s_add_u32 m0, s70, 10240
s_add_u32 s71, s50, 589824
buffer_load_dwordx4 v63, s[8:11], s71 offen lds
s_add_u32 m0, s70, 11264
s_add_u32 s71, s51, 589824
buffer_load_dwordx4 v63, s[12:15], s71 offen lds
s_add_u32 m0, s70, 12288
s_add_u32 s71, s48, 884736
buffer_load_dwordx4 v63, s[8:11], s71 offen lds
s_add_u32 m0, s70, 13312
s_add_u32 s71, s49, 884736
buffer_load_dwordx4 v63, s[12:15], s71 offen lds
s_add_u32 m0, s70, 14336
s_add_u32 s71, s50, 884736
buffer_load_dwordx4 v63, s[8:11], s71 offen lds
s_add_u32 m0, s70, 15360
s_add_u32 s71, s51, 884736
buffer_load_dwordx4 v63, s[12:15], s71 offen lds
s_add_u32 m0, s70, 16384
s_add_u32 s71, s48, 1179648
buffer_load_dwordx4 v63, s[8:11], s71 offen lds
s_add_u32 m0, s70, 17408
s_add_u32 s71, s49, 1179648
buffer_load_dwordx4 v63, s[12:15], s71 offen lds
s_add_u32 m0, s70, 18432
s_add_u32 s71, s50, 1179648
buffer_load_dwordx4 v63, s[8:11], s71 offen lds
s_add_u32 m0, s70, 19456
s_add_u32 s71, s51, 1179648
buffer_load_dwordx4 v63, s[12:15], s71 offen lds
s_add_u32 m0, s70, 20480
s_add_u32 s71, s48, 1474560
buffer_load_dwordx4 v63, s[8:11], s71 offen lds
s_add_u32 m0, s70, 21504
s_add_u32 s71, s49, 1474560
buffer_load_dwordx4 v63, s[12:15], s71 offen lds
s_add_u32 m0, s70, 22528
s_add_u32 s71, s50, 1474560
buffer_load_dwordx4 v63, s[8:11], s71 offen lds
s_add_u32 m0, s70, 23552
s_add_u32 s71, s51, 1474560
buffer_load_dwordx4 v63, s[12:15], s71 offen lds
s_add_u32 m0, s70, 24576
s_add_u32 s71, s48, 1769472
buffer_load_dwordx4 v63, s[8:11], s71 offen lds
s_add_u32 m0, s70, 25600
s_add_u32 s71, s49, 1769472
buffer_load_dwordx4 v63, s[12:15], s71 offen lds
s_add_u32 m0, s70, 26624
s_add_u32 s71, s50, 1769472
buffer_load_dwordx4 v63, s[8:11], s71 offen lds
s_add_u32 m0, s70, 27648
s_add_u32 s71, s51, 1769472
buffer_load_dwordx4 v63, s[12:15], s71 offen lds
s_add_u32 m0, s70, 28672
s_add_u32 s71, s48, 2064384
buffer_load_dwordx4 v63, s[8:11], s71 offen lds
s_add_u32 m0, s70, 29696
s_add_u32 s71, s49, 2064384
buffer_load_dwordx4 v63, s[12:15], s71 offen lds
s_add_u32 m0, s70, 30720
s_add_u32 s71, s50, 2064384
buffer_load_dwordx4 v63, s[8:11], s71 offen lds
s_add_u32 m0, s70, 31744
s_add_u32 s71, s51, 2064384
buffer_load_dwordx4 v63, s[12:15], s71 offen lds
s_add_u32 m0, s70, 32768
s_add_u32 s71, s48, 2359296
buffer_load_dwordx4 v63, s[8:11], s71 offen lds
s_add_u32 m0, s70, 33792
s_add_u32 s71, s49, 2359296
buffer_load_dwordx4 v63, s[12:15], s71 offen lds
s_add_u32 m0, s70, 34816
s_add_u32 s71, s50, 2359296
buffer_load_dwordx4 v63, s[8:11], s71 offen lds
s_add_u32 m0, s70, 35840
s_add_u32 s71, s51, 2359296
buffer_load_dwordx4 v63, s[12:15], s71 offen lds
s_add_u32 m0, s70, 36864
s_add_u32 s71, s48, 2654208
buffer_load_dwordx4 v63, s[8:11], s71 offen lds
s_add_u32 m0, s70, 37888
s_add_u32 s71, s49, 2654208
buffer_load_dwordx4 v63, s[12:15], s71 offen lds
s_add_u32 m0, s70, 38912
s_add_u32 s71, s50, 2654208
buffer_load_dwordx4 v63, s[8:11], s71 offen lds
s_add_u32 m0, s70, 39936
s_add_u32 s71, s51, 2654208
buffer_load_dwordx4 v63, s[12:15], s71 offen lds
s_waitcnt vmcnt(36)
ds_read_b64_tr_b16 a[0:1], v60 offset:0
ds_read_b64_tr_b16 a[2:3], v60 offset:256
ds_read_b64_tr_b16 a[72:73], v61 offset:0
ds_read_b64_tr_b16 a[74:75], v61 offset:256
ds_read_b64_tr_b16 a[144:145], v62 offset:0
ds_read_b64_tr_b16 a[146:147], v62 offset:256
s_waitcnt lgkmcnt(0)
s_add_u32 m0, s70, 0
s_add_u32 s71, s48, 2949120
buffer_load_dwordx4 v63, s[8:11], s71 offen lds
s_add_u32 m0, s70, 1024
s_add_u32 s71, s49, 2949120
buffer_load_dwordx4 v63, s[12:15], s71 offen lds
s_add_u32 m0, s70, 2048
s_add_u32 s71, s50, 2949120
buffer_load_dwordx4 v63, s[8:11], s71 offen lds
s_add_u32 m0, s70, 3072
s_add_u32 s71, s51, 2949120
buffer_load_dwordx4 v63, s[12:15], s71 offen lds
s_waitcnt vmcnt(36)
ds_read_b64_tr_b16 a[4:5], v60 offset:4096
ds_read_b64_tr_b16 a[6:7], v60 offset:4352
ds_read_b64_tr_b16 a[76:77], v61 offset:4096
ds_read_b64_tr_b16 a[78:79], v61 offset:4352
ds_read_b64_tr_b16 a[148:149], v62 offset:4096
ds_read_b64_tr_b16 a[150:151], v62 offset:4352
s_waitcnt lgkmcnt(0)
s_add_u32 m0, s70, 4096
s_add_u32 s71, s48, 3244032
buffer_load_dwordx4 v63, s[8:11], s71 offen lds
s_add_u32 m0, s70, 5120
s_add_u32 s71, s49, 3244032
buffer_load_dwordx4 v63, s[12:15], s71 offen lds
s_add_u32 m0, s70, 6144
s_add_u32 s71, s50, 3244032
buffer_load_dwordx4 v63, s[8:11], s71 offen lds
s_add_u32 m0, s70, 7168
s_add_u32 s71, s51, 3244032
buffer_load_dwordx4 v63, s[12:15], s71 offen lds
s_waitcnt vmcnt(36)
ds_read_b64_tr_b16 a[8:9], v60 offset:8192
ds_read_b64_tr_b16 a[10:11], v60 offset:8448
ds_read_b64_tr_b16 a[80:81], v61 offset:8192
ds_read_b64_tr_b16 a[82:83], v61 offset:8448
ds_read_b64_tr_b16 a[152:153], v62 offset:8192
ds_read_b64_tr_b16 a[154:155], v62 offset:8448
s_waitcnt lgkmcnt(0)
s_add_u32 m0, s70, 8192
s_add_u32 s71, s48, 3538944
buffer_load_dwordx4 v63, s[8:11], s71 offen lds
s_add_u32 m0, s70, 9216
s_add_u32 s71, s49, 3538944
buffer_load_dwordx4 v63, s[12:15], s71 offen lds
s_add_u32 m0, s70, 10240
s_add_u32 s71, s50, 3538944
buffer_load_dwordx4 v63, s[8:11], s71 offen lds
s_add_u32 m0, s70, 11264
s_add_u32 s71, s51, 3538944
buffer_load_dwordx4 v63, s[12:15], s71 offen lds
s_waitcnt vmcnt(36)
ds_read_b64_tr_b16 a[12:13], v60 offset:12288
ds_read_b64_tr_b16 a[14:15], v60 offset:12544
ds_read_b64_tr_b16 a[84:85], v61 offset:12288
ds_read_b64_tr_b16 a[86:87], v61 offset:12544
ds_read_b64_tr_b16 a[156:157], v62 offset:12288
ds_read_b64_tr_b16 a[158:159], v62 offset:12544
s_waitcnt lgkmcnt(0)
s_add_u32 m0, s70, 12288
s_add_u32 s71, s48, 3833856
buffer_load_dwordx4 v63, s[8:11], s71 offen lds
s_add_u32 m0, s70, 13312
s_add_u32 s71, s49, 3833856
buffer_load_dwordx4 v63, s[12:15], s71 offen lds
s_add_u32 m0, s70, 14336
s_add_u32 s71, s50, 3833856
buffer_load_dwordx4 v63, s[8:11], s71 offen lds
s_add_u32 m0, s70, 15360
s_add_u32 s71, s51, 3833856
buffer_load_dwordx4 v63, s[12:15], s71 offen lds
s_waitcnt vmcnt(36)
ds_read_b64_tr_b16 a[16:17], v60 offset:16384
ds_read_b64_tr_b16 a[18:19], v60 offset:16640
ds_read_b64_tr_b16 a[88:89], v61 offset:16384
ds_read_b64_tr_b16 a[90:91], v61 offset:16640
ds_read_b64_tr_b16 a[160:161], v62 offset:16384
ds_read_b64_tr_b16 a[162:163], v62 offset:16640
s_waitcnt lgkmcnt(0)
s_add_u32 m0, s70, 16384
s_add_u32 s71, s48, 4128768
buffer_load_dwordx4 v63, s[8:11], s71 offen lds
s_add_u32 m0, s70, 17408
s_add_u32 s71, s49, 4128768
buffer_load_dwordx4 v63, s[12:15], s71 offen lds
s_add_u32 m0, s70, 18432
s_add_u32 s71, s50, 4128768
buffer_load_dwordx4 v63, s[8:11], s71 offen lds
s_add_u32 m0, s70, 19456
s_add_u32 s71, s51, 4128768
buffer_load_dwordx4 v63, s[12:15], s71 offen lds
s_waitcnt vmcnt(36)
ds_read_b64_tr_b16 a[20:21], v60 offset:20480
ds_read_b64_tr_b16 a[22:23], v60 offset:20736
ds_read_b64_tr_b16 a[92:93], v61 offset:20480
ds_read_b64_tr_b16 a[94:95], v61 offset:20736
ds_read_b64_tr_b16 a[164:165], v62 offset:20480
ds_read_b64_tr_b16 a[166:167], v62 offset:20736
s_waitcnt lgkmcnt(0)
s_add_u32 m0, s70, 20480
s_add_u32 s71, s48, 4423680
buffer_load_dwordx4 v63, s[8:11], s71 offen lds
s_add_u32 m0, s70, 21504
s_add_u32 s71, s49, 4423680
buffer_load_dwordx4 v63, s[12:15], s71 offen lds
s_add_u32 m0, s70, 22528
s_add_u32 s71, s50, 4423680
buffer_load_dwordx4 v63, s[8:11], s71 offen lds
s_add_u32 m0, s70, 23552
s_add_u32 s71, s51, 4423680
buffer_load_dwordx4 v63, s[12:15], s71 offen lds
s_waitcnt vmcnt(36)
ds_read_b64_tr_b16 a[24:25], v60 offset:24576
ds_read_b64_tr_b16 a[26:27], v60 offset:24832
ds_read_b64_tr_b16 a[96:97], v61 offset:24576
ds_read_b64_tr_b16 a[98:99], v61 offset:24832
ds_read_b64_tr_b16 a[168:169], v62 offset:24576
ds_read_b64_tr_b16 a[170:171], v62 offset:24832
s_waitcnt lgkmcnt(0)
s_add_u32 m0, s70, 24576
s_add_u32 s71, s48, 4718592
buffer_load_dwordx4 v63, s[8:11], s71 offen lds
s_add_u32 m0, s70, 25600
s_add_u32 s71, s49, 4718592
buffer_load_dwordx4 v63, s[12:15], s71 offen lds
s_add_u32 m0, s70, 26624
s_add_u32 s71, s50, 4718592
buffer_load_dwordx4 v63, s[8:11], s71 offen lds
s_add_u32 m0, s70, 27648
s_add_u32 s71, s51, 4718592
buffer_load_dwordx4 v63, s[12:15], s71 offen lds
s_waitcnt vmcnt(36)
ds_read_b64_tr_b16 a[28:29], v60 offset:28672
ds_read_b64_tr_b16 a[30:31], v60 offset:28928
ds_read_b64_tr_b16 a[100:101], v61 offset:28672
ds_read_b64_tr_b16 a[102:103], v61 offset:28928
ds_read_b64_tr_b16 a[172:173], v62 offset:28672
ds_read_b64_tr_b16 a[174:175], v62 offset:28928
s_waitcnt lgkmcnt(0)
s_add_u32 m0, s70, 28672
s_add_u32 s71, s48, 5013504
buffer_load_dwordx4 v63, s[8:11], s71 offen lds
s_add_u32 m0, s70, 29696
s_add_u32 s71, s49, 5013504
buffer_load_dwordx4 v63, s[12:15], s71 offen lds
s_add_u32 m0, s70, 30720
s_add_u32 s71, s50, 5013504
buffer_load_dwordx4 v63, s[8:11], s71 offen lds
s_add_u32 m0, s70, 31744
s_add_u32 s71, s51, 5013504
buffer_load_dwordx4 v63, s[12:15], s71 offen lds
s_waitcnt vmcnt(36)
ds_read_b64_tr_b16 a[32:33], v60 offset:32768
ds_read_b64_tr_b16 a[34:35], v60 offset:33024
ds_read_b64_tr_b16 a[104:105], v61 offset:32768
ds_read_b64_tr_b16 a[106:107], v61 offset:33024
ds_read_b64_tr_b16 a[176:177], v62 offset:32768
ds_read_b64_tr_b16 a[178:179], v62 offset:33024
s_waitcnt vmcnt(32)
ds_read_b64_tr_b16 a[36:37], v60 offset:36864
ds_read_b64_tr_b16 a[38:39], v60 offset:37120
ds_read_b64_tr_b16 a[108:109], v61 offset:36864
ds_read_b64_tr_b16 a[110:111], v61 offset:37120
ds_read_b64_tr_b16 a[180:181], v62 offset:36864
ds_read_b64_tr_b16 a[182:183], v62 offset:37120
s_waitcnt vmcnt(28)
ds_read_b64_tr_b16 a[40:41], v60 offset:0
ds_read_b64_tr_b16 a[42:43], v60 offset:256
ds_read_b64_tr_b16 a[112:113], v61 offset:0
ds_read_b64_tr_b16 a[114:115], v61 offset:256
ds_read_b64_tr_b16 a[184:185], v62 offset:0
ds_read_b64_tr_b16 a[186:187], v62 offset:256
s_waitcnt vmcnt(24)
ds_read_b64_tr_b16 a[44:45], v60 offset:4096
ds_read_b64_tr_b16 a[46:47], v60 offset:4352
ds_read_b64_tr_b16 a[116:117], v61 offset:4096
ds_read_b64_tr_b16 a[118:119], v61 offset:4352
ds_read_b64_tr_b16 a[188:189], v62 offset:4096
ds_read_b64_tr_b16 a[190:191], v62 offset:4352
s_waitcnt vmcnt(20)
ds_read_b64_tr_b16 a[48:49], v60 offset:8192
ds_read_b64_tr_b16 a[50:51], v60 offset:8448
ds_read_b64_tr_b16 a[120:121], v61 offset:8192
ds_read_b64_tr_b16 a[122:123], v61 offset:8448
ds_read_b64_tr_b16 a[192:193], v62 offset:8192
ds_read_b64_tr_b16 a[194:195], v62 offset:8448
s_waitcnt vmcnt(16)
ds_read_b64_tr_b16 a[52:53], v60 offset:12288
ds_read_b64_tr_b16 a[54:55], v60 offset:12544
ds_read_b64_tr_b16 a[124:125], v61 offset:12288
ds_read_b64_tr_b16 a[126:127], v61 offset:12544
ds_read_b64_tr_b16 a[196:197], v62 offset:12288
ds_read_b64_tr_b16 a[198:199], v62 offset:12544
s_waitcnt vmcnt(12)
ds_read_b64_tr_b16 a[56:57], v60 offset:16384
ds_read_b64_tr_b16 a[58:59], v60 offset:16640
ds_read_b64_tr_b16 a[128:129], v61 offset:16384
ds_read_b64_tr_b16 a[130:131], v61 offset:16640
ds_read_b64_tr_b16 a[200:201], v62 offset:16384
ds_read_b64_tr_b16 a[202:203], v62 offset:16640
s_waitcnt vmcnt(8)
ds_read_b64_tr_b16 a[60:61], v60 offset:20480
ds_read_b64_tr_b16 a[62:63], v60 offset:20736
ds_read_b64_tr_b16 a[132:133], v61 offset:20480
ds_read_b64_tr_b16 a[134:135], v61 offset:20736
ds_read_b64_tr_b16 a[204:205], v62 offset:20480
ds_read_b64_tr_b16 a[206:207], v62 offset:20736
s_waitcnt vmcnt(4)
ds_read_b64_tr_b16 a[64:65], v60 offset:24576
ds_read_b64_tr_b16 a[66:67], v60 offset:24832
ds_read_b64_tr_b16 a[136:137], v61 offset:24576
ds_read_b64_tr_b16 a[138:139], v61 offset:24832
ds_read_b64_tr_b16 a[208:209], v62 offset:24576
ds_read_b64_tr_b16 a[210:211], v62 offset:24832
s_waitcnt vmcnt(0)
ds_read_b64_tr_b16 a[68:69], v60 offset:28672
ds_read_b64_tr_b16 a[70:71], v60 offset:28928
ds_read_b64_tr_b16 a[140:141], v61 offset:28672
ds_read_b64_tr_b16 a[142:143], v61 offset:28928
ds_read_b64_tr_b16 a[212:213], v62 offset:28672
ds_read_b64_tr_b16 a[214:215], v62 offset:28928
s_waitcnt lgkmcnt(0)
v_lshrrev_b32 v1, 3, v0
v_bfe_u32 v2, v0, 1, 2
v_lshrrev_b32 v3, 5, v0
v_lshlrev_b32 v3, 1, v3
v_xor_b32 v2, v2, v3
v_mul_u32_u24 v1, 2304, v1
v_lshl_add_u32 v1, v2, 5, v1
v_and_b32 v2, 1, v0
v_lshl_add_u32 v1, v2, 4, v1
s_and_b32 s70, s3, 1
s_mul_i32 s70, s70, 18432
s_lshr_b32 s71, s3, 1
s_lshl_b32 s71, s71, 7
s_add_u32 s70, s70, s71
v_add_u32 v1, s70, v1
v_add_u32 v8, 4096, v1
v_add_u32 v9, 3328, v1
v_add_u32 v10, 2560, v1
v_add_u32 v11, 1792, v1
v_add_u32 v12, 5120, v1
v_add_u32 v13, 4352, v1
v_add_u32 v14, 3584, v1
v_add_u32 v15, 2816, v1
v_add_u32 v16, 6144, v1
v_bfe_u32 v1, v0, 1, 3
v_lshlrev_b32 v1, 7, v1
v_lshrrev_b32 v2, 4, v0
v_bfe_u32 v3, v0, 3, 1
v_lshlrev_b32 v3, 1, v3
v_xor_b32 v2, v2, v3
v_lshl_add_u32 v1, v2, 5, v1
v_and_b32 v2, 1, v0
v_lshl_add_u32 v17, v2, 4, v1
v_and_b32 v2, 31, v0
v_add_u32 v1, 0, v2
v_mul_u32_u24 v1, 128, v1
v_lshrrev_b32 v3, 5, v0
v_mul_u32_u24 v3, 32768, v3
v_add_u32 v1, 21504, v1
v_add_u32 v1, v1, v3
v_mov_b32 v3, 2147483632
s_cmp_eq_u32 s3, 0
s_cselect_b32 s71, 16, 0
v_cmp_gt_u32 vcc, s71, v2
s_nop 1
v_cndmask_b32 v22, v3, v1, vcc
s_mov_b32 s56, 0xffff
s_mov_b32 s57, 0
s_mul_i32 s70, s74, 128
s_add_u32 s70, s70, 23552
v_mov_b32 v1, s70
s_min_u32 s71, s71, 1
v_cmp_gt_u32 vcc, s71, v0
s_nop 1
v_cndmask_b32 v44, v3, v1, vcc
v_add_u32 v45, 65536, v44
s_getpc_b64 s[96:97]
pc_190:
s_add_u32 s96, s96, L_writers-pc_190
s_addc_u32 s97, s97, 0
v_subrev_u32 v23, 0, v22
v_lshrrev_b32 v23, 7, v23
v_cmp_gt_u32 vcc, 0x200, v23
s_nop 1
v_cndmask_b32 v23, 0, v23, vcc
global_load_ubyte v23, v23, s[96:97]
s_mov_b32 s44, 6086656
s_mov_b32 s46, 161800192
s_mov_b32 s45, 8445952
s_mov_b32 s47, 180674560
v_lshrrev_b32 v1, 8, v36
v_and_b32 v2, 0xff, v36
v_add_u32 v3, 1, v2
v_cmp_gt_u32 vcc, 64, v2
s_nop 1
v_cndmask_b32 v36, -1, v3, vcc
v_lshlrev_b32 v37, 5, v1
v_min_u32 v2, 63, v2
v_cmp_eq_u32 vcc, 0, v1
v_mov_b32 v3, s45
v_mov_b32 v4, s44
v_cndmask_b32 v3, v3, v4, vcc
s_mov_b32 s70, 36864
v_mul_lo_u32 v4, v2, s70
v_add_u32 v38, v3, v4
v_mov_b32 v3, s47
v_mov_b32 v4, s46
v_cndmask_b32 v3, v3, v4, vcc
s_mov_b32 s70, 294912
v_mul_lo_u32 v4, v2, s70
v_add_u32 v39, v3, v4
v_subrev_u32 v38, 4096, v38
v_lshrrev_b32 v1, 8, v40
v_and_b32 v2, 0xff, v40
v_add_u32 v3, 1, v2
v_cmp_gt_u32 vcc, 64, v2
s_nop 1
v_cndmask_b32 v40, -1, v3, vcc
v_lshlrev_b32 v41, 5, v1
v_min_u32 v2, 63, v2
v_cmp_eq_u32 vcc, 0, v1
v_mov_b32 v3, s45
v_mov_b32 v4, s44
v_cndmask_b32 v3, v3, v4, vcc
s_mov_b32 s70, 36864
v_mul_lo_u32 v4, v2, s70
v_add_u32 v42, v3, v4
v_mov_b32 v3, s47
v_mov_b32 v4, s46
v_cndmask_b32 v3, v3, v4, vcc
s_mov_b32 s70, 294912
v_mul_lo_u32 v4, v2, s70
v_add_u32 v43, v3, v4
v_subrev_u32 v42, 4096, v42
s_mov_b32 s76, 1
s_mov_b32 s77, 0
s_add_u32 s78, s44, 4294963200
s_add_u32 s79, s46, 0
s_mov_b32 s80, 0
s_mov_b32 s81, 2
s_mov_b32 s82, 0
s_add_u32 s83, s44, 32768
s_add_u32 s84, s46, 294912
s_mov_b32 s85, 0
s_mov_b32 s91, 0
s_mov_b32 s92, 1835008
s_mov_b32 s94, 1879048192
s_mov_b32 s8, s42
s_and_b32 s9, s43, 0xffff
s_mov_b32 s10, 0
s_mov_b32 s11, 0x20000
s_mov_b32 s52, 0
s_mul_i32 s72, s3, 9216
s_add_u32 s73, s72, 36864
s_add_u32 s74, s72, 73728
s_add_u32 s75, s72, 110592
s_mov_b32 s54, 0xbfb8aa3b
v_add_u32 v28, 0, v17
v_add_u32 v29, 36864, v17
v_add_u32 v30, 73728, v17
v_add_u32 v31, 110592, v17
v_lshlrev_b32 v1, 2, v0
v_add_u32 v32, 147456, v1
s_lshl_b32 s70, s3, 8
v_add_u32 v18, s70, v32
v_mov_b64 v[224:225], 0
v_mov_b64 v[236:237], 0
v_mov_b64 v[226:227], 0
v_mov_b64 v[238:239], 0
v_mov_b64 v[228:229], 0
v_mov_b64 v[240:241], 0
v_mov_b64 v[230:231], 0
v_mov_b64 v[242:243], 0
s_mov_b32 s12, s40
s_and_b32 s13, s41, 0xffff
s_mov_b32 s14, 256
s_mov_b32 s15, 0x20000
v_lshlrev_b32 v26, 2, v0
v_add_u32 v27, 128, v26
v_cmp_le_u32 vcc, 2, v0
s_nop 1
v_cndmask_b32 v26, v26, v27, vcc
v_mov_b32 v27, 192
v_cmp_eq_u32 vcc, 8, v0
s_nop 1
v_cndmask_b32 v26, v26, v27, vcc
v_mov_b32 v27, 2147483632
v_cmp_lt_u32 vcc, 8, v0
s_nop 1
v_cndmask_b32 v26, v26, v27, vcc
s_mov_b32 s98, 0
wi_loop_200:
buffer_load_dword v27, v26, s[12:15], 0 offen sc1
s_add_u32 s98, s98, 1
s_cmp_gt_u32 s98, 150000
s_cbranch_scc1 wi_bad_202
s_waitcnt vmcnt(0)
v_cmp_eq_u32 vcc, 32, v27
s_nop 0
s_and_b32 s97, vcc_lo, 0x1ff
s_cmp_eq_u32 s97, 0x1ff
s_cbranch_scc1 wi_ok_201
v_cmp_lt_u32 vcc, 32, v27
s_nop 0
s_and_b32 s96, vcc_lo, 0xff
s_cselect_b32 s96, 0x100, 0
s_and_b32 s96, s96, s97
s_cbranch_scc1 wi_over_203
s_sleep 8
s_branch wi_loop_200
wi_bad_202:
s_mov_b32 s98, 512
s_branch L_fail
wi_over_203:
s_mov_b32 s100, 255
wi_ok_201:
v_add_u32 v26, 65536, v22
v_cmp_eq_u32 vcc, s100, v23
s_nop 1
v_cndmask_b32 v22, v22, v26, vcc
s_cmp_lg_u32 s3, 0
s_cbranch_scc1 sp_ok_205
s_mov_b32 s55, 0
sp_loop_204:
s_lshl_b64 exec, s[56:57], s77
buffer_load_dword v26, v22, s[4:7], 0 offen sc1
s_mov_b64 exec, -1
s_add_u32 s55, s55, 1
s_cmp_gt_u32 s55, 150000
s_cbranch_scc1 sp_bad_206
s_waitcnt vmcnt(0)
v_cmp_gt_u32 vcc, s76, v26
s_nop 0
s_lshr_b64 s[58:59], vcc, s77
s_and_b32 s58, s58, s56
s_cbranch_scc0 sp_ok_205
s_sleep 1
s_branch sp_loop_204
sp_bad_206:
s_mov_b32 s98, 1028
s_branch L_fail
sp_ok_205:
s_barrier
s_add_u32 m0, s72, 0
s_nop 0
buffer_load_dwordx4 v8, s[4:7], s78 offen offset:0 sc1 lds
buffer_load_dwordx4 v9, s[4:7], s78 offen offset:1024 sc1 lds
buffer_load_dwordx4 v10, s[4:7], s78 offen offset:2048 sc1 lds
buffer_load_dwordx4 v11, s[4:7], s78 offen offset:3072 sc1 lds
s_add_u32 m0, s72, 4096
s_nop 0
buffer_load_dwordx4 v12, s[4:7], s78 offen offset:0 sc1 lds
buffer_load_dwordx4 v13, s[4:7], s78 offen offset:1024 sc1 lds
buffer_load_dwordx4 v14, s[4:7], s78 offen offset:2048 sc1 lds
buffer_load_dwordx4 v15, s[4:7], s78 offen offset:3072 sc1 lds
s_add_u32 m0, s72, 8192
s_nop 0
buffer_load_dwordx4 v16, s[4:7], s78 offen offset:0 sc1 lds
s_waitcnt vmcnt(0)
g_join_195:
s_barrier
ds_read_b128 v[64:67], v28 offset:0
ds_read_b128 v[68:71], v28 offset:9216
ds_read_b128 v[72:75], v28 offset:18432
ds_read_b128 v[76:79], v28 offset:27648
ds_read_b128 v[80:83], v28 offset:1024
ds_read_b128 v[84:87], v28 offset:10240
ds_read_b128 v[88:91], v28 offset:19456
ds_read_b128 v[92:95], v28 offset:28672
g_body_191:
s_waitcnt lgkmcnt(4)
v_mfma_f32_16x16x32_bf16 v[208:211], a[0:3], v[64:67], 0
ds_read_b128 v[96:99], v28 offset:2048
s_add_u32 m0, s73, 4096
v_mfma_f32_16x16x32_bf16 v[212:215], a[0:3], v[68:71], 0
ds_read_b128 v[100:103], v28 offset:11264
buffer_load_dwordx4 v12, s[8:11], s83 offen offset:0 sc1 lds
v_mfma_f32_16x16x32_bf16 v[208:211], a[4:7], v[72:75], v[208:211]
ds_read_b128 v[104:107], v28 offset:20480
v_mfma_f32_16x16x32_bf16 v[212:215], a[4:7], v[76:79], v[212:215]
ds_read_b128 v[108:111], v28 offset:29696
v_mul_f32 v224, v224, v236
v_mfma_f32_16x16x32_bf16 v[216:219], a[72:75], v[64:67], 0
buffer_load_dwordx4 v13, s[8:11], s83 offen offset:1024 sc1 lds
s_waitcnt lgkmcnt(4)
v_mfma_f32_16x16x32_bf16 v[208:211], a[8:11], v[80:83], v[208:211]
ds_read_b128 v[112:115], v28 offset:3072
v_mul_f32 v225, v225, v237
v_mfma_f32_16x16x32_bf16 v[212:215], a[8:11], v[84:87], v[212:215]
ds_read_b128 v[116:119], v28 offset:12288
v_mul_f32 v226, v226, v238
v_mfma_f32_16x16x32_bf16 v[208:211], a[12:15], v[88:91], v[208:211]
ds_read_b128 v[120:123], v28 offset:21504
v_mul_f32 v227, v227, v239
v_mfma_f32_16x16x32_bf16 v[212:215], a[12:15], v[92:95], v[212:215]
ds_read_b128 v[124:127], v28 offset:30720
buffer_load_dwordx4 v14, s[8:11], s83 offen offset:2048 sc1 lds
v_mfma_f32_16x16x32_bf16 v[220:223], a[72:75], v[68:71], 0
v_mul_f32 v228, v228, v240
s_waitcnt lgkmcnt(4)
v_mfma_f32_16x16x32_bf16 v[208:211], a[16:19], v[96:99], v[208:211]
ds_read_b128 v[128:131], v28 offset:4096
v_mul_f32 v229, v229, v241
v_mfma_f32_16x16x32_bf16 v[212:215], a[16:19], v[100:103], v[212:215]
ds_read_b128 v[132:135], v28 offset:13312
v_mul_f32 v230, v230, v242
v_mfma_f32_16x16x32_bf16 v[208:211], a[20:23], v[104:107], v[208:211]
ds_read_b128 v[136:139], v28 offset:22528
buffer_load_dwordx4 v15, s[8:11], s83 offen offset:3072 sc1 lds
v_mfma_f32_16x16x32_bf16 v[212:215], a[20:23], v[108:111], v[212:215]
ds_read_b128 v[140:143], v28 offset:31744
v_mul_f32 v231, v231, v243
v_mfma_f32_16x16x32_bf16 v[216:219], a[76:79], v[72:75], v[216:219]
v_cvt_pk_bf16_f32 v52, v224, v225
s_waitcnt lgkmcnt(4)
v_mfma_f32_16x16x32_bf16 v[208:211], a[24:27], v[112:115], v[208:211]
ds_read_b128 v[144:147], v28 offset:5120
s_add_u32 m0, s73, 8192
v_mfma_f32_16x16x32_bf16 v[212:215], a[24:27], v[116:119], v[212:215]
ds_read_b128 v[148:151], v28 offset:14336
buffer_load_dwordx4 v16, s[8:11], s83 offen offset:0 sc1 lds
v_mfma_f32_16x16x32_bf16 v[208:211], a[28:31], v[120:123], v[208:211]
ds_read_b128 v[152:155], v28 offset:23552
v_cvt_pk_bf16_f32 v53, v226, v227
v_mfma_f32_16x16x32_bf16 v[212:215], a[28:31], v[124:127], v[212:215]
ds_read_b128 v[156:159], v28 offset:32768
v_cvt_pk_bf16_f32 v54, v228, v229
v_mfma_f32_16x16x32_bf16 v[220:223], a[76:79], v[76:79], v[220:223]
v_cvt_pk_bf16_f32 v55, v230, v231
s_waitcnt lgkmcnt(4)
v_mfma_f32_16x16x32_bf16 v[208:211], a[32:35], v[128:131], v[208:211]
ds_read_b128 v[160:163], v28 offset:6144
v_permlane16_swap_b32 v52, v54
v_mfma_f32_16x16x32_bf16 v[212:215], a[32:35], v[132:135], v[212:215]
ds_read_b128 v[164:167], v28 offset:15360
v_permlane16_swap_b32 v53, v55
v_mfma_f32_16x16x32_bf16 v[208:211], a[36:39], v[136:139], v[208:211]
ds_read_b128 v[168:171], v28 offset:24576
buffer_store_dwordx4 v[52:55], v20, s[4:7], s94 offen sc1
v_mfma_f32_16x16x32_bf16 v[212:215], a[36:39], v[140:143], v[212:215]
ds_read_b128 v[172:175], v28 offset:33792
s_and_b32 s70, s52, 63
v_mfma_f32_16x16x32_bf16 v[216:219], a[80:83], v[80:83], v[216:219]
s_waitcnt lgkmcnt(4)
v_mfma_f32_16x16x32_bf16 v[208:211], a[40:43], v[144:147], v[208:211]
ds_read_b128 v[176:179], v28 offset:7168
v_mfma_f32_16x16x32_bf16 v[212:215], a[40:43], v[148:151], v[212:215]
ds_read_b128 v[180:183], v28 offset:16384
v_mfma_f32_16x16x32_bf16 v[208:211], a[44:47], v[152:155], v[208:211]
ds_read_b128 v[184:187], v28 offset:25600
v_mfma_f32_16x16x32_bf16 v[212:215], a[44:47], v[156:159], v[212:215]
ds_read_b128 v[188:191], v28 offset:34816
v_mfma_f32_16x16x32_bf16 v[220:223], a[80:83], v[84:87], v[220:223]
s_waitcnt lgkmcnt(4)
v_mfma_f32_16x16x32_bf16 v[208:211], a[48:51], v[160:163], v[208:211]
ds_read_b128 v[192:195], v28 offset:8192
v_mfma_f32_16x16x32_bf16 v[212:215], a[48:51], v[164:167], v[212:215]
ds_read_b128 v[196:199], v28 offset:17408
v_mfma_f32_16x16x32_bf16 v[208:211], a[52:55], v[168:171], v[208:211]
ds_read_b128 v[200:203], v28 offset:26624
v_mfma_f32_16x16x32_bf16 v[212:215], a[52:55], v[172:175], v[212:215]
ds_read_b128 v[204:207], v28 offset:35840
v_mfma_f32_16x16x32_bf16 v[216:219], a[84:87], v[88:91], v[216:219]
s_waitcnt lgkmcnt(4)
v_mfma_f32_16x16x32_bf16 v[208:211], a[56:59], v[176:179], v[208:211]
v_readlane_b32 s86, v36, s70
v_mfma_f32_16x16x32_bf16 v[212:215], a[56:59], v[180:183], v[212:215]
v_readlane_b32 s87, v37, s70
v_mfma_f32_16x16x32_bf16 v[208:211], a[60:63], v[184:187], v[208:211]
buffer_load_dword v24, v22, s[4:7], 0 offen sc1
v_mfma_f32_16x16x32_bf16 v[212:215], a[60:63], v[188:191], v[212:215]
v_readlane_b32 s88, v38, s70
v_mfma_f32_16x16x32_bf16 v[220:223], a[84:87], v[92:95], v[220:223]
s_waitcnt lgkmcnt(0)
v_mfma_f32_16x16x32_bf16 v[208:211], a[64:67], v[192:195], v[208:211]
v_readlane_b32 s89, v39, s70
v_mfma_f32_16x16x32_bf16 v[212:215], a[64:67], v[196:199], v[212:215]
s_add_u32 s52, s52, 1
v_mov_b32 v27, s91
v_mfma_f32_16x16x32_bf16 v[208:211], a[68:71], v[200:203], v[208:211]
s_lshl_b32 s70, s92, 10
v_mfma_f32_16x16x32_bf16 v[212:215], a[68:71], v[204:207], v[212:215]
v_mfma_f32_16x16x32_bf16 v[216:219], a[88:91], v[96:99], v[216:219]
v_mfma_f32_16x16x32_bf16 v[220:223], a[88:91], v[100:103], v[220:223]
v_mfma_f32_16x16x32_bf16 v[216:219], a[92:95], v[104:107], v[216:219]
v_mfma_f32_16x16x32_bf16 v[220:223], a[92:95], v[108:111], v[220:223]
v_mfma_f32_16x16x32_bf16 v[216:219], a[96:99], v[112:115], v[216:219]
v_mfma_f32_16x16x32_bf16 v[220:223], a[96:99], v[116:119], v[220:223]
s_nop 1
v_permlane32_swap_b32 v208, v212
v_mfma_f32_16x16x32_bf16 v[216:219], a[100:103], v[120:123], v[216:219]
v_permlane32_swap_b32 v209, v213
v_mfma_f32_16x16x32_bf16 v[220:223], a[100:103], v[124:127], v[220:223]
v_permlane32_swap_b32 v210, v214
v_mfma_f32_16x16x32_bf16 v[216:219], a[104:107], v[128:131], v[216:219]
v_permlane32_swap_b32 v211, v215
v_mfma_f32_16x16x32_bf16 v[220:223], a[104:107], v[132:135], v[220:223]
v_mul_f32 v232, s54, v208
v_mul_f32 v233, s54, v209
v_mfma_f32_16x16x32_bf16 v[216:219], a[108:111], v[136:139], v[216:219]
v_mul_f32 v234, s54, v210
v_mul_f32 v235, s54, v211
v_mfma_f32_16x16x32_bf16 v[220:223], a[108:111], v[140:143], v[220:223]
v_exp_f32 v232, v232
v_mfma_f32_16x16x32_bf16 v[216:219], a[112:115], v[144:147], v[216:219]
v_exp_f32 v233, v233
v_mfma_f32_16x16x32_bf16 v[220:223], a[112:115], v[148:151], v[220:223]
v_exp_f32 v234, v234
v_mfma_f32_16x16x32_bf16 v[216:219], a[116:119], v[152:155], v[216:219]
v_exp_f32 v235, v235
v_mfma_f32_16x16x32_bf16 v[220:223], a[116:119], v[156:159], v[220:223]
v_add_f32 v232, 1.0, v232
v_add_f32 v233, 1.0, v233
v_mfma_f32_16x16x32_bf16 v[216:219], a[120:123], v[160:163], v[216:219]
v_add_f32 v234, 1.0, v234
v_add_f32 v235, 1.0, v235
v_mfma_f32_16x16x32_bf16 v[220:223], a[120:123], v[164:167], v[220:223]
v_rcp_f32 v232, v232
v_mfma_f32_16x16x32_bf16 v[216:219], a[124:127], v[168:171], v[216:219]
v_rcp_f32 v233, v233
v_mfma_f32_16x16x32_bf16 v[220:223], a[124:127], v[172:175], v[220:223]
v_rcp_f32 v234, v234
v_mfma_f32_16x16x32_bf16 v[216:219], a[128:131], v[176:179], v[216:219]
v_rcp_f32 v235, v235
v_mfma_f32_16x16x32_bf16 v[220:223], a[128:131], v[180:183], v[220:223]
v_mul_f32 v212, v208, v212
v_mul_f32 v213, v209, v213
v_mfma_f32_16x16x32_bf16 v[216:219], a[132:135], v[184:187], v[216:219]
v_mul_f32 v214, v210, v214
v_mul_f32 v215, v211, v215
v_mfma_f32_16x16x32_bf16 v[220:223], a[132:135], v[188:191], v[220:223]
v_mul_f32 v212, v212, v232
v_mul_f32 v213, v213, v233
v_mfma_f32_16x16x32_bf16 v[216:219], a[136:139], v[192:195], v[216:219]
v_mul_f32 v214, v214, v234
v_mul_f32 v215, v215, v235
v_mfma_f32_16x16x32_bf16 v[220:223], a[136:139], v[196:199], v[220:223]
v_cvt_pk_bf16_f32 v48, v212, v213
v_cvt_pk_bf16_f32 v49, v214, v215
v_mfma_f32_16x16x32_bf16 v[216:219], a[140:143], v[200:203], v[216:219]
buffer_store_dwordx2 v[48:49], v19, s[4:7], s79 offen sc1
v_mfma_f32_16x16x32_bf16 v[220:223], a[140:143], v[204:207], v[220:223]
v_mfma_f32_16x16x32_bf16 v[224:227], a[144:147], v[64:67], 0
v_mfma_f32_16x16x32_bf16 v[228:231], a[144:147], v[68:71], 0
v_mfma_f32_16x16x32_bf16 v[224:227], a[148:151], v[72:75], v[224:227]
v_mfma_f32_16x16x32_bf16 v[228:231], a[148:151], v[76:79], v[228:231]
v_mfma_f32_16x16x32_bf16 v[224:227], a[152:155], v[80:83], v[224:227]
v_mfma_f32_16x16x32_bf16 v[228:231], a[152:155], v[84:87], v[228:231]
v_mul_f32 v236, s54, v216
v_mul_f32 v237, s54, v217
v_mul_f32 v238, s54, v218
v_mul_f32 v239, s54, v219
v_exp_f32 v236, v236
v_exp_f32 v237, v237
v_exp_f32 v238, v238
v_exp_f32 v239, v239
v_add_f32 v236, 1.0, v236
v_add_f32 v237, 1.0, v237
v_add_f32 v238, 1.0, v238
v_add_f32 v239, 1.0, v239
v_rcp_f32 v236, v236
v_rcp_f32 v237, v237
v_rcp_f32 v238, v238
v_mfma_f32_16x16x32_bf16 v[224:227], a[156:159], v[88:91], v[224:227]
v_rcp_f32 v239, v239
v_mfma_f32_16x16x32_bf16 v[228:231], a[156:159], v[92:95], v[228:231]
v_mul_f32 v240, s54, v220
v_mul_f32 v241, s54, v221
v_mfma_f32_16x16x32_bf16 v[224:227], a[160:163], v[96:99], v[224:227]
v_mul_f32 v242, s54, v222
v_mul_f32 v243, s54, v223
v_mfma_f32_16x16x32_bf16 v[228:231], a[160:163], v[100:103], v[228:231]
s_waitcnt vmcnt(1)
ds_write_b32 v18, v24
v_mfma_f32_16x16x32_bf16 v[224:227], a[164:167], v[104:107], v[224:227]
v_mul_f32 v236, v216, v236
v_mul_f32 v237, v217, v237
v_mfma_f32_16x16x32_bf16 v[228:231], a[164:167], v[108:111], v[228:231]
v_mul_f32 v238, v218, v238
v_mul_f32 v239, v219, v239
v_mfma_f32_16x16x32_bf16 v[224:227], a[168:171], v[112:115], v[224:227]
s_waitcnt lgkmcnt(0)
s_barrier
v_mfma_f32_16x16x32_bf16 v[228:231], a[168:171], v[116:119], v[228:231]
ds_read_b32 v33, v32
v_exp_f32 v240, v240
v_mfma_f32_16x16x32_bf16 v[224:227], a[172:175], v[120:123], v[224:227]
buffer_store_dword v27, v45, s[4:7], s70 offen
v_mfma_f32_16x16x32_bf16 v[228:231], a[172:175], v[124:127], v[228:231]
buffer_store_dword v27, v44, s[4:7], s70 offen sc1
v_mfma_f32_16x16x32_bf16 v[224:227], a[176:179], v[128:131], v[224:227]
s_waitcnt lgkmcnt(0)
v_cmp_gt_u32 vcc, s86, v33
v_mfma_f32_16x16x32_bf16 v[228:231], a[176:179], v[132:135], v[228:231]
s_lshr_b64 s[58:59], vcc, s87
s_and_b32 s58, s58, s56
s_cselect_b32 s10, 0, 268435456
s_cselect_b32 s90, 0, 1
v_mfma_f32_16x16x32_bf16 v[224:227], a[180:183], v[136:139], v[224:227]
s_cmp_eq_u32 s85, 0
s_cbranch_scc1 g_slow_207
v_mfma_f32_16x16x32_bf16 v[228:231], a[180:183], v[140:143], v[228:231]
s_add_u32 m0, s74, 0
v_exp_f32 v241, v241
v_mfma_f32_16x16x32_bf16 v[224:227], a[184:187], v[144:147], v[224:227]
buffer_load_dwordx4 v8, s[8:11], s88 offen offset:0 sc1 lds
v_mfma_f32_16x16x32_bf16 v[228:231], a[184:187], v[148:151], v[228:231]
v_exp_f32 v242, v242
v_mfma_f32_16x16x32_bf16 v[224:227], a[188:191], v[152:155], v[224:227]
v_exp_f32 v243, v243
v_mfma_f32_16x16x32_bf16 v[228:231], a[188:191], v[156:159], v[228:231]
v_add_f32 v240, 1.0, v240
v_add_f32 v241, 1.0, v241
v_mfma_f32_16x16x32_bf16 v[224:227], a[192:195], v[160:163], v[224:227]
buffer_load_dwordx4 v9, s[8:11], s88 offen offset:1024 sc1 lds
v_mfma_f32_16x16x32_bf16 v[228:231], a[192:195], v[164:167], v[228:231]
v_add_f32 v242, 1.0, v242
v_add_f32 v243, 1.0, v243
v_mfma_f32_16x16x32_bf16 v[224:227], a[196:199], v[168:171], v[224:227]
v_rcp_f32 v240, v240
ds_read_b128 v[64:67], v29 offset:0
v_mfma_f32_16x16x32_bf16 v[228:231], a[196:199], v[172:175], v[228:231]
v_rcp_f32 v241, v241
ds_read_b128 v[68:71], v29 offset:9216
v_mfma_f32_16x16x32_bf16 v[224:227], a[200:203], v[176:179], v[224:227]
buffer_load_dwordx4 v10, s[8:11], s88 offen offset:2048 sc1 lds
ds_read_b128 v[72:75], v29 offset:18432
v_mfma_f32_16x16x32_bf16 v[228:231], a[200:203], v[180:183], v[228:231]
v_rcp_f32 v242, v242
ds_read_b128 v[76:79], v29 offset:27648
v_mfma_f32_16x16x32_bf16 v[224:227], a[204:207], v[184:187], v[224:227]
v_rcp_f32 v243, v243
ds_read_b128 v[80:83], v29 offset:1024
v_mfma_f32_16x16x32_bf16 v[228:231], a[204:207], v[188:191], v[228:231]
v_mul_f32 v240, v220, v240
ds_read_b128 v[84:87], v29 offset:10240
v_mfma_f32_16x16x32_bf16 v[224:227], a[208:211], v[192:195], v[224:227]
buffer_load_dwordx4 v11, s[8:11], s88 offen offset:3072 sc1 lds
ds_read_b128 v[88:91], v29 offset:19456
v_mfma_f32_16x16x32_bf16 v[228:231], a[208:211], v[196:199], v[228:231]
v_mul_f32 v241, v221, v241
ds_read_b128 v[92:95], v29 offset:28672
v_mfma_f32_16x16x32_bf16 v[224:227], a[212:215], v[200:203], v[224:227]
v_mul_f32 v242, v222, v242
v_mul_f32 v243, v223, v243
v_mfma_f32_16x16x32_bf16 v[228:231], a[212:215], v[204:207], v[228:231]
g_body_192:
s_waitcnt lgkmcnt(4)
v_mfma_f32_16x16x32_bf16 v[208:211], a[0:3], v[64:67], 0
ds_read_b128 v[96:99], v29 offset:2048
s_add_u32 m0, s74, 4096
v_mfma_f32_16x16x32_bf16 v[212:215], a[0:3], v[68:71], 0
ds_read_b128 v[100:103], v29 offset:11264
buffer_load_dwordx4 v12, s[8:11], s88 offen offset:0 sc1 lds
v_mfma_f32_16x16x32_bf16 v[208:211], a[4:7], v[72:75], v[208:211]
ds_read_b128 v[104:107], v29 offset:20480
v_mfma_f32_16x16x32_bf16 v[212:215], a[4:7], v[76:79], v[212:215]
ds_read_b128 v[108:111], v29 offset:29696
v_mul_f32 v224, v224, v236
v_mfma_f32_16x16x32_bf16 v[216:219], a[72:75], v[64:67], 0
buffer_load_dwordx4 v13, s[8:11], s88 offen offset:1024 sc1 lds
s_waitcnt lgkmcnt(4)
v_mfma_f32_16x16x32_bf16 v[208:211], a[8:11], v[80:83], v[208:211]
ds_read_b128 v[112:115], v29 offset:3072
v_mul_f32 v225, v225, v237
v_mfma_f32_16x16x32_bf16 v[212:215], a[8:11], v[84:87], v[212:215]
ds_read_b128 v[116:119], v29 offset:12288
v_mul_f32 v226, v226, v238
v_mfma_f32_16x16x32_bf16 v[208:211], a[12:15], v[88:91], v[208:211]
ds_read_b128 v[120:123], v29 offset:21504
v_mul_f32 v227, v227, v239
v_mfma_f32_16x16x32_bf16 v[212:215], a[12:15], v[92:95], v[212:215]
ds_read_b128 v[124:127], v29 offset:30720
buffer_load_dwordx4 v14, s[8:11], s88 offen offset:2048 sc1 lds
v_mfma_f32_16x16x32_bf16 v[220:223], a[72:75], v[68:71], 0
v_mul_f32 v228, v228, v240
s_waitcnt lgkmcnt(4)
v_mfma_f32_16x16x32_bf16 v[208:211], a[16:19], v[96:99], v[208:211]
ds_read_b128 v[128:131], v29 offset:4096
v_mul_f32 v229, v229, v241
v_mfma_f32_16x16x32_bf16 v[212:215], a[16:19], v[100:103], v[212:215]
ds_read_b128 v[132:135], v29 offset:13312
v_mul_f32 v230, v230, v242
v_mfma_f32_16x16x32_bf16 v[208:211], a[20:23], v[104:107], v[208:211]
ds_read_b128 v[136:139], v29 offset:22528
buffer_load_dwordx4 v15, s[8:11], s88 offen offset:3072 sc1 lds
v_mfma_f32_16x16x32_bf16 v[212:215], a[20:23], v[108:111], v[212:215]
ds_read_b128 v[140:143], v29 offset:31744
v_mul_f32 v231, v231, v243
v_mfma_f32_16x16x32_bf16 v[216:219], a[76:79], v[72:75], v[216:219]
v_cvt_pk_bf16_f32 v52, v224, v225
s_waitcnt lgkmcnt(4)
v_mfma_f32_16x16x32_bf16 v[208:211], a[24:27], v[112:115], v[208:211]
ds_read_b128 v[144:147], v29 offset:5120
s_add_u32 m0, s74, 8192
v_mfma_f32_16x16x32_bf16 v[212:215], a[24:27], v[116:119], v[212:215]
ds_read_b128 v[148:151], v29 offset:14336
buffer_load_dwordx4 v16, s[8:11], s88 offen offset:0 sc1 lds
v_mfma_f32_16x16x32_bf16 v[208:211], a[28:31], v[120:123], v[208:211]
ds_read_b128 v[152:155], v29 offset:23552
v_cvt_pk_bf16_f32 v53, v226, v227
v_mfma_f32_16x16x32_bf16 v[212:215], a[28:31], v[124:127], v[212:215]
ds_read_b128 v[156:159], v29 offset:32768
v_cvt_pk_bf16_f32 v54, v228, v229
v_mfma_f32_16x16x32_bf16 v[220:223], a[76:79], v[76:79], v[220:223]
v_cvt_pk_bf16_f32 v55, v230, v231
s_waitcnt lgkmcnt(4)
v_mfma_f32_16x16x32_bf16 v[208:211], a[32:35], v[128:131], v[208:211]
ds_read_b128 v[160:163], v29 offset:6144
v_permlane16_swap_b32 v52, v54
v_mfma_f32_16x16x32_bf16 v[212:215], a[32:35], v[132:135], v[212:215]
ds_read_b128 v[164:167], v29 offset:15360
v_permlane16_swap_b32 v53, v55
v_mfma_f32_16x16x32_bf16 v[208:211], a[36:39], v[136:139], v[208:211]
ds_read_b128 v[168:171], v29 offset:24576
buffer_store_dwordx4 v[52:55], v20, s[4:7], s79 offen sc1
v_mfma_f32_16x16x32_bf16 v[212:215], a[36:39], v[140:143], v[212:215]
ds_read_b128 v[172:175], v29 offset:33792
s_and_b32 s70, s52, 63
v_mfma_f32_16x16x32_bf16 v[216:219], a[80:83], v[80:83], v[216:219]
s_waitcnt lgkmcnt(4)
v_mfma_f32_16x16x32_bf16 v[208:211], a[40:43], v[144:147], v[208:211]
ds_read_b128 v[176:179], v29 offset:7168
v_mfma_f32_16x16x32_bf16 v[212:215], a[40:43], v[148:151], v[212:215]
ds_read_b128 v[180:183], v29 offset:16384
v_mfma_f32_16x16x32_bf16 v[208:211], a[44:47], v[152:155], v[208:211]
ds_read_b128 v[184:187], v29 offset:25600
v_mfma_f32_16x16x32_bf16 v[212:215], a[44:47], v[156:159], v[212:215]
ds_read_b128 v[188:191], v29 offset:34816
v_mfma_f32_16x16x32_bf16 v[220:223], a[80:83], v[84:87], v[220:223]
s_waitcnt lgkmcnt(4)
v_mfma_f32_16x16x32_bf16 v[208:211], a[48:51], v[160:163], v[208:211]
ds_read_b128 v[192:195], v29 offset:8192
v_mfma_f32_16x16x32_bf16 v[212:215], a[48:51], v[164:167], v[212:215]
ds_read_b128 v[196:199], v29 offset:17408
v_mfma_f32_16x16x32_bf16 v[208:211], a[52:55], v[168:171], v[208:211]
ds_read_b128 v[200:203], v29 offset:26624
v_mfma_f32_16x16x32_bf16 v[212:215], a[52:55], v[172:175], v[212:215]
ds_read_b128 v[204:207], v29 offset:35840
v_mfma_f32_16x16x32_bf16 v[216:219], a[84:87], v[88:91], v[216:219]
s_waitcnt lgkmcnt(4)
v_mfma_f32_16x16x32_bf16 v[208:211], a[56:59], v[176:179], v[208:211]
v_readlane_b32 s91, v36, s70
v_mfma_f32_16x16x32_bf16 v[212:215], a[56:59], v[180:183], v[212:215]
v_readlane_b32 s92, v37, s70
v_mfma_f32_16x16x32_bf16 v[208:211], a[60:63], v[184:187], v[208:211]
buffer_load_dword v24, v22, s[4:7], 0 offen sc1
v_mfma_f32_16x16x32_bf16 v[212:215], a[60:63], v[188:191], v[212:215]
v_readlane_b32 s93, v38, s70
v_mfma_f32_16x16x32_bf16 v[220:223], a[84:87], v[92:95], v[220:223]
s_waitcnt lgkmcnt(0)
v_mfma_f32_16x16x32_bf16 v[208:211], a[64:67], v[192:195], v[208:211]
v_readlane_b32 s94, v39, s70
v_mfma_f32_16x16x32_bf16 v[212:215], a[64:67], v[196:199], v[212:215]
s_add_u32 s52, s52, 1
v_mov_b32 v27, s76
v_mfma_f32_16x16x32_bf16 v[208:211], a[68:71], v[200:203], v[208:211]
s_lshl_b32 s70, s77, 10
v_mfma_f32_16x16x32_bf16 v[212:215], a[68:71], v[204:207], v[212:215]
v_mfma_f32_16x16x32_bf16 v[216:219], a[88:91], v[96:99], v[216:219]
v_mfma_f32_16x16x32_bf16 v[220:223], a[88:91], v[100:103], v[220:223]
v_mfma_f32_16x16x32_bf16 v[216:219], a[92:95], v[104:107], v[216:219]
v_mfma_f32_16x16x32_bf16 v[220:223], a[92:95], v[108:111], v[220:223]
v_mfma_f32_16x16x32_bf16 v[216:219], a[96:99], v[112:115], v[216:219]
v_mfma_f32_16x16x32_bf16 v[220:223], a[96:99], v[116:119], v[220:223]
s_nop 1
v_permlane32_swap_b32 v208, v212
v_mfma_f32_16x16x32_bf16 v[216:219], a[100:103], v[120:123], v[216:219]
v_permlane32_swap_b32 v209, v213
v_mfma_f32_16x16x32_bf16 v[220:223], a[100:103], v[124:127], v[220:223]
v_permlane32_swap_b32 v210, v214
v_mfma_f32_16x16x32_bf16 v[216:219], a[104:107], v[128:131], v[216:219]
v_permlane32_swap_b32 v211, v215
v_mfma_f32_16x16x32_bf16 v[220:223], a[104:107], v[132:135], v[220:223]
v_mul_f32 v232, s54, v208
v_mul_f32 v233, s54, v209
v_mfma_f32_16x16x32_bf16 v[216:219], a[108:111], v[136:139], v[216:219]
v_mul_f32 v234, s54, v210
v_mul_f32 v235, s54, v211
v_mfma_f32_16x16x32_bf16 v[220:223], a[108:111], v[140:143], v[220:223]
v_exp_f32 v232, v232
v_mfma_f32_16x16x32_bf16 v[216:219], a[112:115], v[144:147], v[216:219]
v_exp_f32 v233, v233
v_mfma_f32_16x16x32_bf16 v[220:223], a[112:115], v[148:151], v[220:223]
v_exp_f32 v234, v234
v_mfma_f32_16x16x32_bf16 v[216:219], a[116:119], v[152:155], v[216:219]
v_exp_f32 v235, v235
v_mfma_f32_16x16x32_bf16 v[220:223], a[116:119], v[156:159], v[220:223]
v_add_f32 v232, 1.0, v232
v_add_f32 v233, 1.0, v233
v_mfma_f32_16x16x32_bf16 v[216:219], a[120:123], v[160:163], v[216:219]
v_add_f32 v234, 1.0, v234
v_add_f32 v235, 1.0, v235
v_mfma_f32_16x16x32_bf16 v[220:223], a[120:123], v[164:167], v[220:223]
v_rcp_f32 v232, v232
v_mfma_f32_16x16x32_bf16 v[216:219], a[124:127], v[168:171], v[216:219]
v_rcp_f32 v233, v233
v_mfma_f32_16x16x32_bf16 v[220:223], a[124:127], v[172:175], v[220:223]
v_rcp_f32 v234, v234
v_mfma_f32_16x16x32_bf16 v[216:219], a[128:131], v[176:179], v[216:219]
v_rcp_f32 v235, v235
v_mfma_f32_16x16x32_bf16 v[220:223], a[128:131], v[180:183], v[220:223]
v_mul_f32 v212, v208, v212
v_mul_f32 v213, v209, v213
v_mfma_f32_16x16x32_bf16 v[216:219], a[132:135], v[184:187], v[216:219]
v_mul_f32 v214, v210, v214
v_mul_f32 v215, v211, v215
v_mfma_f32_16x16x32_bf16 v[220:223], a[132:135], v[188:191], v[220:223]
v_mul_f32 v212, v212, v232
v_mul_f32 v213, v213, v233
v_mfma_f32_16x16x32_bf16 v[216:219], a[136:139], v[192:195], v[216:219]
v_mul_f32 v214, v214, v234
v_mul_f32 v215, v215, v235
v_mfma_f32_16x16x32_bf16 v[220:223], a[136:139], v[196:199], v[220:223]
v_cvt_pk_bf16_f32 v48, v212, v213
v_cvt_pk_bf16_f32 v49, v214, v215
v_mfma_f32_16x16x32_bf16 v[216:219], a[140:143], v[200:203], v[216:219]
buffer_store_dwordx2 v[48:49], v19, s[4:7], s84 offen sc1
v_mfma_f32_16x16x32_bf16 v[220:223], a[140:143], v[204:207], v[220:223]
v_mfma_f32_16x16x32_bf16 v[224:227], a[144:147], v[64:67], 0
v_mfma_f32_16x16x32_bf16 v[228:231], a[144:147], v[68:71], 0
v_mfma_f32_16x16x32_bf16 v[224:227], a[148:151], v[72:75], v[224:227]
v_mfma_f32_16x16x32_bf16 v[228:231], a[148:151], v[76:79], v[228:231]
v_mfma_f32_16x16x32_bf16 v[224:227], a[152:155], v[80:83], v[224:227]
v_mfma_f32_16x16x32_bf16 v[228:231], a[152:155], v[84:87], v[228:231]
v_mul_f32 v236, s54, v216
v_mul_f32 v237, s54, v217
v_mul_f32 v238, s54, v218
v_mul_f32 v239, s54, v219
v_exp_f32 v236, v236
v_exp_f32 v237, v237
v_exp_f32 v238, v238
v_exp_f32 v239, v239
v_add_f32 v236, 1.0, v236
v_add_f32 v237, 1.0, v237
v_add_f32 v238, 1.0, v238
v_add_f32 v239, 1.0, v239
v_rcp_f32 v236, v236
v_rcp_f32 v237, v237
v_rcp_f32 v238, v238
v_mfma_f32_16x16x32_bf16 v[224:227], a[156:159], v[88:91], v[224:227]
v_rcp_f32 v239, v239
v_mfma_f32_16x16x32_bf16 v[228:231], a[156:159], v[92:95], v[228:231]
v_mul_f32 v240, s54, v220
v_mul_f32 v241, s54, v221
v_mfma_f32_16x16x32_bf16 v[224:227], a[160:163], v[96:99], v[224:227]
v_mul_f32 v242, s54, v222
v_mul_f32 v243, s54, v223
v_mfma_f32_16x16x32_bf16 v[228:231], a[160:163], v[100:103], v[228:231]
s_waitcnt vmcnt(1)
ds_write_b32 v18, v24
v_mfma_f32_16x16x32_bf16 v[224:227], a[164:167], v[104:107], v[224:227]
v_mul_f32 v236, v216, v236
v_mul_f32 v237, v217, v237
v_mfma_f32_16x16x32_bf16 v[228:231], a[164:167], v[108:111], v[228:231]
v_mul_f32 v238, v218, v238
v_mul_f32 v239, v219, v239
v_mfma_f32_16x16x32_bf16 v[224:227], a[168:171], v[112:115], v[224:227]
s_waitcnt lgkmcnt(0)
s_barrier
v_mfma_f32_16x16x32_bf16 v[228:231], a[168:171], v[116:119], v[228:231]
ds_read_b32 v33, v32
v_exp_f32 v240, v240
v_mfma_f32_16x16x32_bf16 v[224:227], a[172:175], v[120:123], v[224:227]
buffer_store_dword v27, v45, s[4:7], s70 offen
v_mfma_f32_16x16x32_bf16 v[228:231], a[172:175], v[124:127], v[228:231]
buffer_store_dword v27, v44, s[4:7], s70 offen sc1
v_mfma_f32_16x16x32_bf16 v[224:227], a[176:179], v[128:131], v[224:227]
s_waitcnt lgkmcnt(0)
v_cmp_gt_u32 vcc, s91, v33
v_mfma_f32_16x16x32_bf16 v[228:231], a[176:179], v[132:135], v[228:231]
s_lshr_b64 s[58:59], vcc, s92
s_and_b32 s58, s58, s56
s_cselect_b32 s10, 0, 268435456
s_cselect_b32 s95, 0, 1
v_mfma_f32_16x16x32_bf16 v[224:227], a[180:183], v[136:139], v[224:227]
s_cmp_eq_u32 s90, 0
s_cbranch_scc1 g_slow_208
v_mfma_f32_16x16x32_bf16 v[228:231], a[180:183], v[140:143], v[228:231]
s_add_u32 m0, s75, 0
v_exp_f32 v241, v241
v_mfma_f32_16x16x32_bf16 v[224:227], a[184:187], v[144:147], v[224:227]
buffer_load_dwordx4 v8, s[8:11], s93 offen offset:0 sc1 lds
v_mfma_f32_16x16x32_bf16 v[228:231], a[184:187], v[148:151], v[228:231]
v_exp_f32 v242, v242
v_mfma_f32_16x16x32_bf16 v[224:227], a[188:191], v[152:155], v[224:227]
v_exp_f32 v243, v243
v_mfma_f32_16x16x32_bf16 v[228:231], a[188:191], v[156:159], v[228:231]
v_add_f32 v240, 1.0, v240
v_add_f32 v241, 1.0, v241
v_mfma_f32_16x16x32_bf16 v[224:227], a[192:195], v[160:163], v[224:227]
buffer_load_dwordx4 v9, s[8:11], s93 offen offset:1024 sc1 lds
v_mfma_f32_16x16x32_bf16 v[228:231], a[192:195], v[164:167], v[228:231]
v_add_f32 v242, 1.0, v242
v_add_f32 v243, 1.0, v243
v_mfma_f32_16x16x32_bf16 v[224:227], a[196:199], v[168:171], v[224:227]
v_rcp_f32 v240, v240
ds_read_b128 v[64:67], v30 offset:0
v_mfma_f32_16x16x32_bf16 v[228:231], a[196:199], v[172:175], v[228:231]
v_rcp_f32 v241, v241
ds_read_b128 v[68:71], v30 offset:9216
v_mfma_f32_16x16x32_bf16 v[224:227], a[200:203], v[176:179], v[224:227]
buffer_load_dwordx4 v10, s[8:11], s93 offen offset:2048 sc1 lds
ds_read_b128 v[72:75], v30 offset:18432
v_mfma_f32_16x16x32_bf16 v[228:231], a[200:203], v[180:183], v[228:231]
v_rcp_f32 v242, v242
ds_read_b128 v[76:79], v30 offset:27648
v_mfma_f32_16x16x32_bf16 v[224:227], a[204:207], v[184:187], v[224:227]
v_rcp_f32 v243, v243
ds_read_b128 v[80:83], v30 offset:1024
v_mfma_f32_16x16x32_bf16 v[228:231], a[204:207], v[188:191], v[228:231]
v_mul_f32 v240, v220, v240
ds_read_b128 v[84:87], v30 offset:10240
v_mfma_f32_16x16x32_bf16 v[224:227], a[208:211], v[192:195], v[224:227]
buffer_load_dwordx4 v11, s[8:11], s93 offen offset:3072 sc1 lds
ds_read_b128 v[88:91], v30 offset:19456
v_mfma_f32_16x16x32_bf16 v[228:231], a[208:211], v[196:199], v[228:231]
v_mul_f32 v241, v221, v241
ds_read_b128 v[92:95], v30 offset:28672
v_mfma_f32_16x16x32_bf16 v[224:227], a[212:215], v[200:203], v[224:227]
v_mul_f32 v242, v222, v242
v_mul_f32 v243, v223, v243
v_mfma_f32_16x16x32_bf16 v[228:231], a[212:215], v[204:207], v[228:231]
g_body_193:
s_waitcnt lgkmcnt(4)
v_mfma_f32_16x16x32_bf16 v[208:211], a[0:3], v[64:67], 0
ds_read_b128 v[96:99], v30 offset:2048
s_add_u32 m0, s75, 4096
v_mfma_f32_16x16x32_bf16 v[212:215], a[0:3], v[68:71], 0
ds_read_b128 v[100:103], v30 offset:11264
buffer_load_dwordx4 v12, s[8:11], s93 offen offset:0 sc1 lds
v_mfma_f32_16x16x32_bf16 v[208:211], a[4:7], v[72:75], v[208:211]
ds_read_b128 v[104:107], v30 offset:20480
v_mfma_f32_16x16x32_bf16 v[212:215], a[4:7], v[76:79], v[212:215]
ds_read_b128 v[108:111], v30 offset:29696
v_mul_f32 v224, v224, v236
v_mfma_f32_16x16x32_bf16 v[216:219], a[72:75], v[64:67], 0
buffer_load_dwordx4 v13, s[8:11], s93 offen offset:1024 sc1 lds
s_waitcnt lgkmcnt(4)
v_mfma_f32_16x16x32_bf16 v[208:211], a[8:11], v[80:83], v[208:211]
ds_read_b128 v[112:115], v30 offset:3072
v_mul_f32 v225, v225, v237
v_mfma_f32_16x16x32_bf16 v[212:215], a[8:11], v[84:87], v[212:215]
ds_read_b128 v[116:119], v30 offset:12288
v_mul_f32 v226, v226, v238
v_mfma_f32_16x16x32_bf16 v[208:211], a[12:15], v[88:91], v[208:211]
ds_read_b128 v[120:123], v30 offset:21504
v_mul_f32 v227, v227, v239
v_mfma_f32_16x16x32_bf16 v[212:215], a[12:15], v[92:95], v[212:215]
ds_read_b128 v[124:127], v30 offset:30720
buffer_load_dwordx4 v14, s[8:11], s93 offen offset:2048 sc1 lds
v_mfma_f32_16x16x32_bf16 v[220:223], a[72:75], v[68:71], 0
v_mul_f32 v228, v228, v240
s_waitcnt lgkmcnt(4)
v_mfma_f32_16x16x32_bf16 v[208:211], a[16:19], v[96:99], v[208:211]
ds_read_b128 v[128:131], v30 offset:4096
v_mul_f32 v229, v229, v241
v_mfma_f32_16x16x32_bf16 v[212:215], a[16:19], v[100:103], v[212:215]
ds_read_b128 v[132:135], v30 offset:13312
v_mul_f32 v230, v230, v242
v_mfma_f32_16x16x32_bf16 v[208:211], a[20:23], v[104:107], v[208:211]
ds_read_b128 v[136:139], v30 offset:22528
buffer_load_dwordx4 v15, s[8:11], s93 offen offset:3072 sc1 lds
v_mfma_f32_16x16x32_bf16 v[212:215], a[20:23], v[108:111], v[212:215]
ds_read_b128 v[140:143], v30 offset:31744
v_mul_f32 v231, v231, v243
v_mfma_f32_16x16x32_bf16 v[216:219], a[76:79], v[72:75], v[216:219]
v_cvt_pk_bf16_f32 v52, v224, v225
s_waitcnt lgkmcnt(4)
v_mfma_f32_16x16x32_bf16 v[208:211], a[24:27], v[112:115], v[208:211]
ds_read_b128 v[144:147], v30 offset:5120
s_add_u32 m0, s75, 8192
v_mfma_f32_16x16x32_bf16 v[212:215], a[24:27], v[116:119], v[212:215]
ds_read_b128 v[148:151], v30 offset:14336
buffer_load_dwordx4 v16, s[8:11], s93 offen offset:0 sc1 lds
v_mfma_f32_16x16x32_bf16 v[208:211], a[28:31], v[120:123], v[208:211]
ds_read_b128 v[152:155], v30 offset:23552
v_cvt_pk_bf16_f32 v53, v226, v227
v_mfma_f32_16x16x32_bf16 v[212:215], a[28:31], v[124:127], v[212:215]
ds_read_b128 v[156:159], v30 offset:32768
v_cvt_pk_bf16_f32 v54, v228, v229
v_mfma_f32_16x16x32_bf16 v[220:223], a[76:79], v[76:79], v[220:223]
v_cvt_pk_bf16_f32 v55, v230, v231
s_waitcnt lgkmcnt(4)
v_mfma_f32_16x16x32_bf16 v[208:211], a[32:35], v[128:131], v[208:211]
ds_read_b128 v[160:163], v30 offset:6144
v_permlane16_swap_b32 v52, v54
v_mfma_f32_16x16x32_bf16 v[212:215], a[32:35], v[132:135], v[212:215]
ds_read_b128 v[164:167], v30 offset:15360
v_permlane16_swap_b32 v53, v55
v_mfma_f32_16x16x32_bf16 v[208:211], a[36:39], v[136:139], v[208:211]
ds_read_b128 v[168:171], v30 offset:24576
buffer_store_dwordx4 v[52:55], v20, s[4:7], s84 offen sc1
v_mfma_f32_16x16x32_bf16 v[212:215], a[36:39], v[140:143], v[212:215]
ds_read_b128 v[172:175], v30 offset:33792
s_and_b32 s70, s52, 63
v_mfma_f32_16x16x32_bf16 v[216:219], a[80:83], v[80:83], v[216:219]
s_waitcnt lgkmcnt(4)
v_mfma_f32_16x16x32_bf16 v[208:211], a[40:43], v[144:147], v[208:211]
ds_read_b128 v[176:179], v30 offset:7168
v_mfma_f32_16x16x32_bf16 v[212:215], a[40:43], v[148:151], v[212:215]
ds_read_b128 v[180:183], v30 offset:16384
v_mfma_f32_16x16x32_bf16 v[208:211], a[44:47], v[152:155], v[208:211]
ds_read_b128 v[184:187], v30 offset:25600
v_mfma_f32_16x16x32_bf16 v[212:215], a[44:47], v[156:159], v[212:215]
ds_read_b128 v[188:191], v30 offset:34816
v_mfma_f32_16x16x32_bf16 v[220:223], a[80:83], v[84:87], v[220:223]
s_waitcnt lgkmcnt(4)
v_mfma_f32_16x16x32_bf16 v[208:211], a[48:51], v[160:163], v[208:211]
ds_read_b128 v[192:195], v30 offset:8192
v_mfma_f32_16x16x32_bf16 v[212:215], a[48:51], v[164:167], v[212:215]
ds_read_b128 v[196:199], v30 offset:17408
v_mfma_f32_16x16x32_bf16 v[208:211], a[52:55], v[168:171], v[208:211]
ds_read_b128 v[200:203], v30 offset:26624
v_mfma_f32_16x16x32_bf16 v[212:215], a[52:55], v[172:175], v[212:215]
ds_read_b128 v[204:207], v30 offset:35840
v_mfma_f32_16x16x32_bf16 v[216:219], a[84:87], v[88:91], v[216:219]
s_waitcnt lgkmcnt(4)
v_mfma_f32_16x16x32_bf16 v[208:211], a[56:59], v[176:179], v[208:211]
v_readlane_b32 s76, v36, s70
v_mfma_f32_16x16x32_bf16 v[212:215], a[56:59], v[180:183], v[212:215]
v_readlane_b32 s77, v37, s70
v_mfma_f32_16x16x32_bf16 v[208:211], a[60:63], v[184:187], v[208:211]
buffer_load_dword v24, v22, s[4:7], 0 offen sc1
v_mfma_f32_16x16x32_bf16 v[212:215], a[60:63], v[188:191], v[212:215]
v_readlane_b32 s78, v38, s70
v_mfma_f32_16x16x32_bf16 v[220:223], a[84:87], v[92:95], v[220:223]
s_waitcnt lgkmcnt(0)
v_mfma_f32_16x16x32_bf16 v[208:211], a[64:67], v[192:195], v[208:211]
v_readlane_b32 s79, v39, s70
v_mfma_f32_16x16x32_bf16 v[212:215], a[64:67], v[196:199], v[212:215]
s_add_u32 s52, s52, 1
v_mov_b32 v27, s81
v_mfma_f32_16x16x32_bf16 v[208:211], a[68:71], v[200:203], v[208:211]
s_lshl_b32 s70, s82, 10
v_mfma_f32_16x16x32_bf16 v[212:215], a[68:71], v[204:207], v[212:215]
v_mfma_f32_16x16x32_bf16 v[216:219], a[88:91], v[96:99], v[216:219]
v_mfma_f32_16x16x32_bf16 v[220:223], a[88:91], v[100:103], v[220:223]
v_mfma_f32_16x16x32_bf16 v[216:219], a[92:95], v[104:107], v[216:219]
v_mfma_f32_16x16x32_bf16 v[220:223], a[92:95], v[108:111], v[220:223]
v_mfma_f32_16x16x32_bf16 v[216:219], a[96:99], v[112:115], v[216:219]
v_mfma_f32_16x16x32_bf16 v[220:223], a[96:99], v[116:119], v[220:223]
s_nop 1
v_permlane32_swap_b32 v208, v212
v_mfma_f32_16x16x32_bf16 v[216:219], a[100:103], v[120:123], v[216:219]
v_permlane32_swap_b32 v209, v213
v_mfma_f32_16x16x32_bf16 v[220:223], a[100:103], v[124:127], v[220:223]
v_permlane32_swap_b32 v210, v214
v_mfma_f32_16x16x32_bf16 v[216:219], a[104:107], v[128:131], v[216:219]
v_permlane32_swap_b32 v211, v215
v_mfma_f32_16x16x32_bf16 v[220:223], a[104:107], v[132:135], v[220:223]
v_mul_f32 v232, s54, v208
v_mul_f32 v233, s54, v209
v_mfma_f32_16x16x32_bf16 v[216:219], a[108:111], v[136:139], v[216:219]
v_mul_f32 v234, s54, v210
v_mul_f32 v235, s54, v211
v_mfma_f32_16x16x32_bf16 v[220:223], a[108:111], v[140:143], v[220:223]
v_exp_f32 v232, v232
v_mfma_f32_16x16x32_bf16 v[216:219], a[112:115], v[144:147], v[216:219]
v_exp_f32 v233, v233
v_mfma_f32_16x16x32_bf16 v[220:223], a[112:115], v[148:151], v[220:223]
v_exp_f32 v234, v234
v_mfma_f32_16x16x32_bf16 v[216:219], a[116:119], v[152:155], v[216:219]
v_exp_f32 v235, v235
v_mfma_f32_16x16x32_bf16 v[220:223], a[116:119], v[156:159], v[220:223]
v_add_f32 v232, 1.0, v232
v_add_f32 v233, 1.0, v233
v_mfma_f32_16x16x32_bf16 v[216:219], a[120:123], v[160:163], v[216:219]
v_add_f32 v234, 1.0, v234
v_add_f32 v235, 1.0, v235
v_mfma_f32_16x16x32_bf16 v[220:223], a[120:123], v[164:167], v[220:223]
v_rcp_f32 v232, v232
v_mfma_f32_16x16x32_bf16 v[216:219], a[124:127], v[168:171], v[216:219]
v_rcp_f32 v233, v233
v_mfma_f32_16x16x32_bf16 v[220:223], a[124:127], v[172:175], v[220:223]
v_rcp_f32 v234, v234
v_mfma_f32_16x16x32_bf16 v[216:219], a[128:131], v[176:179], v[216:219]
v_rcp_f32 v235, v235
v_mfma_f32_16x16x32_bf16 v[220:223], a[128:131], v[180:183], v[220:223]
v_mul_f32 v212, v208, v212
v_mul_f32 v213, v209, v213
v_mfma_f32_16x16x32_bf16 v[216:219], a[132:135], v[184:187], v[216:219]
v_mul_f32 v214, v210, v214
v_mul_f32 v215, v211, v215
v_mfma_f32_16x16x32_bf16 v[220:223], a[132:135], v[188:191], v[220:223]
v_mul_f32 v212, v212, v232
v_mul_f32 v213, v213, v233
v_mfma_f32_16x16x32_bf16 v[216:219], a[136:139], v[192:195], v[216:219]
v_mul_f32 v214, v214, v234
v_mul_f32 v215, v215, v235
v_mfma_f32_16x16x32_bf16 v[220:223], a[136:139], v[196:199], v[220:223]
v_cvt_pk_bf16_f32 v48, v212, v213
v_cvt_pk_bf16_f32 v49, v214, v215
v_mfma_f32_16x16x32_bf16 v[216:219], a[140:143], v[200:203], v[216:219]
buffer_store_dwordx2 v[48:49], v19, s[4:7], s89 offen sc1
v_mfma_f32_16x16x32_bf16 v[220:223], a[140:143], v[204:207], v[220:223]
v_mfma_f32_16x16x32_bf16 v[224:227], a[144:147], v[64:67], 0
v_mfma_f32_16x16x32_bf16 v[228:231], a[144:147], v[68:71], 0
v_mfma_f32_16x16x32_bf16 v[224:227], a[148:151], v[72:75], v[224:227]
v_mfma_f32_16x16x32_bf16 v[228:231], a[148:151], v[76:79], v[228:231]
v_mfma_f32_16x16x32_bf16 v[224:227], a[152:155], v[80:83], v[224:227]
v_mfma_f32_16x16x32_bf16 v[228:231], a[152:155], v[84:87], v[228:231]
v_mul_f32 v236, s54, v216
v_mul_f32 v237, s54, v217
v_mul_f32 v238, s54, v218
v_mul_f32 v239, s54, v219
v_exp_f32 v236, v236
v_exp_f32 v237, v237
v_exp_f32 v238, v238
v_exp_f32 v239, v239
v_add_f32 v236, 1.0, v236
v_add_f32 v237, 1.0, v237
v_add_f32 v238, 1.0, v238
v_add_f32 v239, 1.0, v239
v_rcp_f32 v236, v236
v_rcp_f32 v237, v237
v_rcp_f32 v238, v238
v_mfma_f32_16x16x32_bf16 v[224:227], a[156:159], v[88:91], v[224:227]
v_rcp_f32 v239, v239
v_mfma_f32_16x16x32_bf16 v[228:231], a[156:159], v[92:95], v[228:231]
v_mul_f32 v240, s54, v220
v_mul_f32 v241, s54, v221
v_mfma_f32_16x16x32_bf16 v[224:227], a[160:163], v[96:99], v[224:227]
v_mul_f32 v242, s54, v222
v_mul_f32 v243, s54, v223
v_mfma_f32_16x16x32_bf16 v[228:231], a[160:163], v[100:103], v[228:231]
s_waitcnt vmcnt(1)
ds_write_b32 v18, v24
v_mfma_f32_16x16x32_bf16 v[224:227], a[164:167], v[104:107], v[224:227]
v_mul_f32 v236, v216, v236
v_mul_f32 v237, v217, v237
v_mfma_f32_16x16x32_bf16 v[228:231], a[164:167], v[108:111], v[228:231]
v_mul_f32 v238, v218, v238
v_mul_f32 v239, v219, v239
v_mfma_f32_16x16x32_bf16 v[224:227], a[168:171], v[112:115], v[224:227]
s_waitcnt lgkmcnt(0)
s_barrier
v_mfma_f32_16x16x32_bf16 v[228:231], a[168:171], v[116:119], v[228:231]
ds_read_b32 v33, v32
v_exp_f32 v240, v240
v_mfma_f32_16x16x32_bf16 v[224:227], a[172:175], v[120:123], v[224:227]
buffer_store_dword v27, v45, s[4:7], s70 offen
v_mfma_f32_16x16x32_bf16 v[228:231], a[172:175], v[124:127], v[228:231]
buffer_store_dword v27, v44, s[4:7], s70 offen sc1
v_mfma_f32_16x16x32_bf16 v[224:227], a[176:179], v[128:131], v[224:227]
s_waitcnt lgkmcnt(0)
v_cmp_gt_u32 vcc, s76, v33
v_mfma_f32_16x16x32_bf16 v[228:231], a[176:179], v[132:135], v[228:231]
s_lshr_b64 s[58:59], vcc, s77
s_and_b32 s58, s58, s56
s_cselect_b32 s10, 0, 268435456
s_cselect_b32 s80, 0, 1
v_mfma_f32_16x16x32_bf16 v[224:227], a[180:183], v[136:139], v[224:227]
s_cmp_eq_u32 s95, 0
s_cbranch_scc1 g_slow_209
v_mfma_f32_16x16x32_bf16 v[228:231], a[180:183], v[140:143], v[228:231]
s_add_u32 m0, s72, 0
v_exp_f32 v241, v241
v_mfma_f32_16x16x32_bf16 v[224:227], a[184:187], v[144:147], v[224:227]
buffer_load_dwordx4 v8, s[8:11], s78 offen offset:0 sc1 lds
v_mfma_f32_16x16x32_bf16 v[228:231], a[184:187], v[148:151], v[228:231]
v_exp_f32 v242, v242
v_mfma_f32_16x16x32_bf16 v[224:227], a[188:191], v[152:155], v[224:227]
v_exp_f32 v243, v243
v_mfma_f32_16x16x32_bf16 v[228:231], a[188:191], v[156:159], v[228:231]
v_add_f32 v240, 1.0, v240
v_add_f32 v241, 1.0, v241
v_mfma_f32_16x16x32_bf16 v[224:227], a[192:195], v[160:163], v[224:227]
buffer_load_dwordx4 v9, s[8:11], s78 offen offset:1024 sc1 lds
v_mfma_f32_16x16x32_bf16 v[228:231], a[192:195], v[164:167], v[228:231]
v_add_f32 v242, 1.0, v242
v_add_f32 v243, 1.0, v243
v_mfma_f32_16x16x32_bf16 v[224:227], a[196:199], v[168:171], v[224:227]
v_rcp_f32 v240, v240
ds_read_b128 v[64:67], v31 offset:0
v_mfma_f32_16x16x32_bf16 v[228:231], a[196:199], v[172:175], v[228:231]
v_rcp_f32 v241, v241
ds_read_b128 v[68:71], v31 offset:9216
v_mfma_f32_16x16x32_bf16 v[224:227], a[200:203], v[176:179], v[224:227]
buffer_load_dwordx4 v10, s[8:11], s78 offen offset:2048 sc1 lds
ds_read_b128 v[72:75], v31 offset:18432
v_mfma_f32_16x16x32_bf16 v[228:231], a[200:203], v[180:183], v[228:231]
v_rcp_f32 v242, v242
ds_read_b128 v[76:79], v31 offset:27648
v_mfma_f32_16x16x32_bf16 v[224:227], a[204:207], v[184:187], v[224:227]
v_rcp_f32 v243, v243
ds_read_b128 v[80:83], v31 offset:1024
v_mfma_f32_16x16x32_bf16 v[228:231], a[204:207], v[188:191], v[228:231]
v_mul_f32 v240, v220, v240
ds_read_b128 v[84:87], v31 offset:10240
v_mfma_f32_16x16x32_bf16 v[224:227], a[208:211], v[192:195], v[224:227]
buffer_load_dwordx4 v11, s[8:11], s78 offen offset:3072 sc1 lds
ds_read_b128 v[88:91], v31 offset:19456
v_mfma_f32_16x16x32_bf16 v[228:231], a[208:211], v[196:199], v[228:231]
v_mul_f32 v241, v221, v241
ds_read_b128 v[92:95], v31 offset:28672
v_mfma_f32_16x16x32_bf16 v[224:227], a[212:215], v[200:203], v[224:227]
v_mul_f32 v242, v222, v242
v_mul_f32 v243, v223, v243
v_mfma_f32_16x16x32_bf16 v[228:231], a[212:215], v[204:207], v[228:231]
g_body_194:
s_waitcnt lgkmcnt(4)
v_mfma_f32_16x16x32_bf16 v[208:211], a[0:3], v[64:67], 0
ds_read_b128 v[96:99], v31 offset:2048
s_add_u32 m0, s72, 4096
v_mfma_f32_16x16x32_bf16 v[212:215], a[0:3], v[68:71], 0
ds_read_b128 v[100:103], v31 offset:11264
buffer_load_dwordx4 v12, s[8:11], s78 offen offset:0 sc1 lds
v_mfma_f32_16x16x32_bf16 v[208:211], a[4:7], v[72:75], v[208:211]
ds_read_b128 v[104:107], v31 offset:20480
v_mfma_f32_16x16x32_bf16 v[212:215], a[4:7], v[76:79], v[212:215]
ds_read_b128 v[108:111], v31 offset:29696
v_mul_f32 v224, v224, v236
v_mfma_f32_16x16x32_bf16 v[216:219], a[72:75], v[64:67], 0
buffer_load_dwordx4 v13, s[8:11], s78 offen offset:1024 sc1 lds
s_waitcnt lgkmcnt(4)
v_mfma_f32_16x16x32_bf16 v[208:211], a[8:11], v[80:83], v[208:211]
ds_read_b128 v[112:115], v31 offset:3072
v_mul_f32 v225, v225, v237
v_mfma_f32_16x16x32_bf16 v[212:215], a[8:11], v[84:87], v[212:215]
ds_read_b128 v[116:119], v31 offset:12288
v_mul_f32 v226, v226, v238
v_mfma_f32_16x16x32_bf16 v[208:211], a[12:15], v[88:91], v[208:211]
ds_read_b128 v[120:123], v31 offset:21504
v_mul_f32 v227, v227, v239
v_mfma_f32_16x16x32_bf16 v[212:215], a[12:15], v[92:95], v[212:215]
ds_read_b128 v[124:127], v31 offset:30720
buffer_load_dwordx4 v14, s[8:11], s78 offen offset:2048 sc1 lds
v_mfma_f32_16x16x32_bf16 v[220:223], a[72:75], v[68:71], 0
v_mul_f32 v228, v228, v240
s_waitcnt lgkmcnt(4)
v_mfma_f32_16x16x32_bf16 v[208:211], a[16:19], v[96:99], v[208:211]
ds_read_b128 v[128:131], v31 offset:4096
v_mul_f32 v229, v229, v241
v_mfma_f32_16x16x32_bf16 v[212:215], a[16:19], v[100:103], v[212:215]
ds_read_b128 v[132:135], v31 offset:13312
v_mul_f32 v230, v230, v242
v_mfma_f32_16x16x32_bf16 v[208:211], a[20:23], v[104:107], v[208:211]
ds_read_b128 v[136:139], v31 offset:22528
buffer_load_dwordx4 v15, s[8:11], s78 offen offset:3072 sc1 lds
v_mfma_f32_16x16x32_bf16 v[212:215], a[20:23], v[108:111], v[212:215]
ds_read_b128 v[140:143], v31 offset:31744
v_mul_f32 v231, v231, v243
v_mfma_f32_16x16x32_bf16 v[216:219], a[76:79], v[72:75], v[216:219]
v_cvt_pk_bf16_f32 v52, v224, v225
s_waitcnt lgkmcnt(4)
v_mfma_f32_16x16x32_bf16 v[208:211], a[24:27], v[112:115], v[208:211]
ds_read_b128 v[144:147], v31 offset:5120
s_add_u32 m0, s72, 8192
v_mfma_f32_16x16x32_bf16 v[212:215], a[24:27], v[116:119], v[212:215]
ds_read_b128 v[148:151], v31 offset:14336
buffer_load_dwordx4 v16, s[8:11], s78 offen offset:0 sc1 lds
v_mfma_f32_16x16x32_bf16 v[208:211], a[28:31], v[120:123], v[208:211]
ds_read_b128 v[152:155], v31 offset:23552
v_cvt_pk_bf16_f32 v53, v226, v227
v_mfma_f32_16x16x32_bf16 v[212:215], a[28:31], v[124:127], v[212:215]
ds_read_b128 v[156:159], v31 offset:32768
v_cvt_pk_bf16_f32 v54, v228, v229
v_mfma_f32_16x16x32_bf16 v[220:223], a[76:79], v[76:79], v[220:223]
v_cvt_pk_bf16_f32 v55, v230, v231
s_waitcnt lgkmcnt(4)
v_mfma_f32_16x16x32_bf16 v[208:211], a[32:35], v[128:131], v[208:211]
ds_read_b128 v[160:163], v31 offset:6144
v_permlane16_swap_b32 v52, v54
v_mfma_f32_16x16x32_bf16 v[212:215], a[32:35], v[132:135], v[212:215]
ds_read_b128 v[164:167], v31 offset:15360
v_permlane16_swap_b32 v53, v55
v_mfma_f32_16x16x32_bf16 v[208:211], a[36:39], v[136:139], v[208:211]
ds_read_b128 v[168:171], v31 offset:24576
buffer_store_dwordx4 v[52:55], v20, s[4:7], s89 offen sc1
v_mfma_f32_16x16x32_bf16 v[212:215], a[36:39], v[140:143], v[212:215]
ds_read_b128 v[172:175], v31 offset:33792
s_and_b32 s70, s52, 63
v_mfma_f32_16x16x32_bf16 v[216:219], a[80:83], v[80:83], v[216:219]
s_waitcnt lgkmcnt(4)
v_mfma_f32_16x16x32_bf16 v[208:211], a[40:43], v[144:147], v[208:211]
ds_read_b128 v[176:179], v31 offset:7168
v_mfma_f32_16x16x32_bf16 v[212:215], a[40:43], v[148:151], v[212:215]
ds_read_b128 v[180:183], v31 offset:16384
v_mfma_f32_16x16x32_bf16 v[208:211], a[44:47], v[152:155], v[208:211]
ds_read_b128 v[184:187], v31 offset:25600
v_mfma_f32_16x16x32_bf16 v[212:215], a[44:47], v[156:159], v[212:215]
ds_read_b128 v[188:191], v31 offset:34816
v_mfma_f32_16x16x32_bf16 v[220:223], a[80:83], v[84:87], v[220:223]
s_waitcnt lgkmcnt(4)
v_mfma_f32_16x16x32_bf16 v[208:211], a[48:51], v[160:163], v[208:211]
ds_read_b128 v[192:195], v31 offset:8192
v_mfma_f32_16x16x32_bf16 v[212:215], a[48:51], v[164:167], v[212:215]
ds_read_b128 v[196:199], v31 offset:17408
v_mfma_f32_16x16x32_bf16 v[208:211], a[52:55], v[168:171], v[208:211]
ds_read_b128 v[200:203], v31 offset:26624
v_mfma_f32_16x16x32_bf16 v[212:215], a[52:55], v[172:175], v[212:215]
ds_read_b128 v[204:207], v31 offset:35840
v_mfma_f32_16x16x32_bf16 v[216:219], a[84:87], v[88:91], v[216:219]
s_waitcnt lgkmcnt(4)
v_mfma_f32_16x16x32_bf16 v[208:211], a[56:59], v[176:179], v[208:211]
v_readlane_b32 s81, v36, s70
v_mfma_f32_16x16x32_bf16 v[212:215], a[56:59], v[180:183], v[212:215]
v_readlane_b32 s82, v37, s70
v_mfma_f32_16x16x32_bf16 v[208:211], a[60:63], v[184:187], v[208:211]
buffer_load_dword v24, v22, s[4:7], 0 offen sc1
v_mfma_f32_16x16x32_bf16 v[212:215], a[60:63], v[188:191], v[212:215]
v_readlane_b32 s83, v38, s70
v_mfma_f32_16x16x32_bf16 v[220:223], a[84:87], v[92:95], v[220:223]
s_waitcnt lgkmcnt(0)
v_mfma_f32_16x16x32_bf16 v[208:211], a[64:67], v[192:195], v[208:211]
v_readlane_b32 s84, v39, s70
v_mfma_f32_16x16x32_bf16 v[212:215], a[64:67], v[196:199], v[212:215]
s_add_u32 s52, s52, 1
v_mfma_f32_16x16x32_bf16 v[208:211], a[68:71], v[200:203], v[208:211]
s_cmp_eq_u32 s52, 64
s_cbranch_scc1 rare_211
back_212:
v_mfma_f32_16x16x32_bf16 v[212:215], a[68:71], v[204:207], v[212:215]
v_mov_b32 v27, s86
s_lshl_b32 s70, s87, 10
v_mfma_f32_16x16x32_bf16 v[216:219], a[88:91], v[96:99], v[216:219]
v_mfma_f32_16x16x32_bf16 v[220:223], a[88:91], v[100:103], v[220:223]
v_mfma_f32_16x16x32_bf16 v[216:219], a[92:95], v[104:107], v[216:219]
v_mfma_f32_16x16x32_bf16 v[220:223], a[92:95], v[108:111], v[220:223]
v_mfma_f32_16x16x32_bf16 v[216:219], a[96:99], v[112:115], v[216:219]
v_mfma_f32_16x16x32_bf16 v[220:223], a[96:99], v[116:119], v[220:223]
v_permlane32_swap_b32 v208, v212
v_mfma_f32_16x16x32_bf16 v[216:219], a[100:103], v[120:123], v[216:219]
v_permlane32_swap_b32 v209, v213
v_mfma_f32_16x16x32_bf16 v[220:223], a[100:103], v[124:127], v[220:223]
v_permlane32_swap_b32 v210, v214
v_mfma_f32_16x16x32_bf16 v[216:219], a[104:107], v[128:131], v[216:219]
v_permlane32_swap_b32 v211, v215
v_mfma_f32_16x16x32_bf16 v[220:223], a[104:107], v[132:135], v[220:223]
v_mul_f32 v232, s54, v208
v_mul_f32 v233, s54, v209
v_mfma_f32_16x16x32_bf16 v[216:219], a[108:111], v[136:139], v[216:219]
v_mul_f32 v234, s54, v210
v_mul_f32 v235, s54, v211
v_mfma_f32_16x16x32_bf16 v[220:223], a[108:111], v[140:143], v[220:223]
v_exp_f32 v232, v232
v_mfma_f32_16x16x32_bf16 v[216:219], a[112:115], v[144:147], v[216:219]
v_exp_f32 v233, v233
v_mfma_f32_16x16x32_bf16 v[220:223], a[112:115], v[148:151], v[220:223]
v_exp_f32 v234, v234
v_mfma_f32_16x16x32_bf16 v[216:219], a[116:119], v[152:155], v[216:219]
v_exp_f32 v235, v235
v_mfma_f32_16x16x32_bf16 v[220:223], a[116:119], v[156:159], v[220:223]
v_add_f32 v232, 1.0, v232
v_add_f32 v233, 1.0, v233
v_mfma_f32_16x16x32_bf16 v[216:219], a[120:123], v[160:163], v[216:219]
v_add_f32 v234, 1.0, v234
v_add_f32 v235, 1.0, v235
v_mfma_f32_16x16x32_bf16 v[220:223], a[120:123], v[164:167], v[220:223]
v_rcp_f32 v232, v232
v_mfma_f32_16x16x32_bf16 v[216:219], a[124:127], v[168:171], v[216:219]
v_rcp_f32 v233, v233
v_mfma_f32_16x16x32_bf16 v[220:223], a[124:127], v[172:175], v[220:223]
v_rcp_f32 v234, v234
v_mfma_f32_16x16x32_bf16 v[216:219], a[128:131], v[176:179], v[216:219]
v_rcp_f32 v235, v235
v_mfma_f32_16x16x32_bf16 v[220:223], a[128:131], v[180:183], v[220:223]
v_mul_f32 v212, v208, v212
v_mul_f32 v213, v209, v213
v_mfma_f32_16x16x32_bf16 v[216:219], a[132:135], v[184:187], v[216:219]
v_mul_f32 v214, v210, v214
v_mul_f32 v215, v211, v215
v_mfma_f32_16x16x32_bf16 v[220:223], a[132:135], v[188:191], v[220:223]
v_mul_f32 v212, v212, v232
v_mul_f32 v213, v213, v233
v_mfma_f32_16x16x32_bf16 v[216:219], a[136:139], v[192:195], v[216:219]
v_mul_f32 v214, v214, v234
v_mul_f32 v215, v215, v235
v_mfma_f32_16x16x32_bf16 v[220:223], a[136:139], v[196:199], v[220:223]
v_cvt_pk_bf16_f32 v48, v212, v213
v_cvt_pk_bf16_f32 v49, v214, v215
v_mfma_f32_16x16x32_bf16 v[216:219], a[140:143], v[200:203], v[216:219]
buffer_store_dwordx2 v[48:49], v19, s[4:7], s94 offen sc1
v_mfma_f32_16x16x32_bf16 v[220:223], a[140:143], v[204:207], v[220:223]
v_mfma_f32_16x16x32_bf16 v[224:227], a[144:147], v[64:67], 0
v_mfma_f32_16x16x32_bf16 v[228:231], a[144:147], v[68:71], 0
v_mfma_f32_16x16x32_bf16 v[224:227], a[148:151], v[72:75], v[224:227]
v_mfma_f32_16x16x32_bf16 v[228:231], a[148:151], v[76:79], v[228:231]
v_mfma_f32_16x16x32_bf16 v[224:227], a[152:155], v[80:83], v[224:227]
v_mfma_f32_16x16x32_bf16 v[228:231], a[152:155], v[84:87], v[228:231]
v_mul_f32 v236, s54, v216
v_mul_f32 v237, s54, v217
v_mul_f32 v238, s54, v218
v_mul_f32 v239, s54, v219
v_exp_f32 v236, v236
v_exp_f32 v237, v237
v_exp_f32 v238, v238
v_exp_f32 v239, v239
v_add_f32 v236, 1.0, v236
v_add_f32 v237, 1.0, v237
v_add_f32 v238, 1.0, v238
v_add_f32 v239, 1.0, v239
v_rcp_f32 v236, v236
v_rcp_f32 v237, v237
v_rcp_f32 v238, v238
v_mfma_f32_16x16x32_bf16 v[224:227], a[156:159], v[88:91], v[224:227]
v_rcp_f32 v239, v239
v_mfma_f32_16x16x32_bf16 v[228:231], a[156:159], v[92:95], v[228:231]
v_mul_f32 v240, s54, v220
v_mul_f32 v241, s54, v221
v_mfma_f32_16x16x32_bf16 v[224:227], a[160:163], v[96:99], v[224:227]
v_mul_f32 v242, s54, v222
v_mul_f32 v243, s54, v223
v_mfma_f32_16x16x32_bf16 v[228:231], a[160:163], v[100:103], v[228:231]
s_waitcnt vmcnt(1)
ds_write_b32 v18, v24
v_mfma_f32_16x16x32_bf16 v[224:227], a[164:167], v[104:107], v[224:227]
v_mul_f32 v236, v216, v236
v_mul_f32 v237, v217, v237
v_mfma_f32_16x16x32_bf16 v[228:231], a[164:167], v[108:111], v[228:231]
v_mul_f32 v238, v218, v238
v_mul_f32 v239, v219, v239
v_mfma_f32_16x16x32_bf16 v[224:227], a[168:171], v[112:115], v[224:227]
s_waitcnt lgkmcnt(0)
s_barrier
v_mfma_f32_16x16x32_bf16 v[228:231], a[168:171], v[116:119], v[228:231]
ds_read_b32 v33, v32
v_exp_f32 v240, v240
v_mfma_f32_16x16x32_bf16 v[224:227], a[172:175], v[120:123], v[224:227]
buffer_store_dword v27, v45, s[4:7], s70 offen
v_mfma_f32_16x16x32_bf16 v[228:231], a[172:175], v[124:127], v[228:231]
buffer_store_dword v27, v44, s[4:7], s70 offen sc1
v_mfma_f32_16x16x32_bf16 v[224:227], a[176:179], v[128:131], v[224:227]
s_waitcnt lgkmcnt(0)
v_cmp_gt_u32 vcc, s81, v33
v_mfma_f32_16x16x32_bf16 v[228:231], a[176:179], v[132:135], v[228:231]
s_lshr_b64 s[58:59], vcc, s82
s_and_b32 s58, s58, s56
s_cselect_b32 s10, 0, 268435456
s_cselect_b32 s85, 0, 1
v_mfma_f32_16x16x32_bf16 v[224:227], a[180:183], v[136:139], v[224:227]
s_cmp_eq_u32 s80, 0
s_cbranch_scc1 g_slow_210
v_mfma_f32_16x16x32_bf16 v[228:231], a[180:183], v[140:143], v[228:231]
s_add_u32 m0, s73, 0
v_exp_f32 v241, v241
v_mfma_f32_16x16x32_bf16 v[224:227], a[184:187], v[144:147], v[224:227]
buffer_load_dwordx4 v8, s[8:11], s83 offen offset:0 sc1 lds
v_mfma_f32_16x16x32_bf16 v[228:231], a[184:187], v[148:151], v[228:231]
v_exp_f32 v242, v242
v_mfma_f32_16x16x32_bf16 v[224:227], a[188:191], v[152:155], v[224:227]
v_exp_f32 v243, v243
v_mfma_f32_16x16x32_bf16 v[228:231], a[188:191], v[156:159], v[228:231]
v_add_f32 v240, 1.0, v240
v_add_f32 v241, 1.0, v241
v_mfma_f32_16x16x32_bf16 v[224:227], a[192:195], v[160:163], v[224:227]
buffer_load_dwordx4 v9, s[8:11], s83 offen offset:1024 sc1 lds
v_mfma_f32_16x16x32_bf16 v[228:231], a[192:195], v[164:167], v[228:231]
v_add_f32 v242, 1.0, v242
v_add_f32 v243, 1.0, v243
v_mfma_f32_16x16x32_bf16 v[224:227], a[196:199], v[168:171], v[224:227]
v_rcp_f32 v240, v240
ds_read_b128 v[64:67], v28 offset:0
v_mfma_f32_16x16x32_bf16 v[228:231], a[196:199], v[172:175], v[228:231]
v_rcp_f32 v241, v241
ds_read_b128 v[68:71], v28 offset:9216
v_mfma_f32_16x16x32_bf16 v[224:227], a[200:203], v[176:179], v[224:227]
buffer_load_dwordx4 v10, s[8:11], s83 offen offset:2048 sc1 lds
ds_read_b128 v[72:75], v28 offset:18432
v_mfma_f32_16x16x32_bf16 v[228:231], a[200:203], v[180:183], v[228:231]
v_rcp_f32 v242, v242
ds_read_b128 v[76:79], v28 offset:27648
v_mfma_f32_16x16x32_bf16 v[224:227], a[204:207], v[184:187], v[224:227]
v_rcp_f32 v243, v243
ds_read_b128 v[80:83], v28 offset:1024
v_mfma_f32_16x16x32_bf16 v[228:231], a[204:207], v[188:191], v[228:231]
v_mul_f32 v240, v220, v240
ds_read_b128 v[84:87], v28 offset:10240
v_mfma_f32_16x16x32_bf16 v[224:227], a[208:211], v[192:195], v[224:227]
buffer_load_dwordx4 v11, s[8:11], s83 offen offset:3072 sc1 lds
ds_read_b128 v[88:91], v28 offset:19456
v_mfma_f32_16x16x32_bf16 v[228:231], a[208:211], v[196:199], v[228:231]
v_mul_f32 v241, v221, v241
ds_read_b128 v[92:95], v28 offset:28672
v_mfma_f32_16x16x32_bf16 v[224:227], a[212:215], v[200:203], v[224:227]
v_mul_f32 v242, v222, v242
v_mul_f32 v243, v223, v243
v_mfma_f32_16x16x32_bf16 v[228:231], a[212:215], v[204:207], v[228:231]
s_branch g_body_191
g_slow_207:
v_cmp_gt_u32 vcc, s81, v33
s_nop 0
s_lshr_b64 s[58:59], vcc, s82
s_and_b32 s58, s58, s56
s_cbranch_scc1 g_notyet_213
s_add_u32 m0, s73, 0
s_nop 0
buffer_load_dwordx4 v8, s[4:7], s83 offen offset:0 sc1 lds
buffer_load_dwordx4 v9, s[4:7], s83 offen offset:1024 sc1 lds
buffer_load_dwordx4 v10, s[4:7], s83 offen offset:2048 sc1 lds
buffer_load_dwordx4 v11, s[4:7], s83 offen offset:3072 sc1 lds
s_add_u32 m0, s73, 4096
s_nop 0
buffer_load_dwordx4 v12, s[4:7], s83 offen offset:0 sc1 lds
buffer_load_dwordx4 v13, s[4:7], s83 offen offset:1024 sc1 lds
buffer_load_dwordx4 v14, s[4:7], s83 offen offset:2048 sc1 lds
buffer_load_dwordx4 v15, s[4:7], s83 offen offset:3072 sc1 lds
s_add_u32 m0, s73, 8192
s_nop 0
buffer_load_dwordx4 v16, s[4:7], s83 offen offset:0 sc1 lds
v_mfma_f32_16x16x32_bf16 v[228:231], a[180:183], v[140:143], v[228:231]
s_add_u32 m0, s74, 0
v_exp_f32 v241, v241
v_mfma_f32_16x16x32_bf16 v[224:227], a[184:187], v[144:147], v[224:227]
buffer_load_dwordx4 v8, s[8:11], s88 offen offset:0 sc1 lds
v_mfma_f32_16x16x32_bf16 v[228:231], a[184:187], v[148:151], v[228:231]
v_exp_f32 v242, v242
v_mfma_f32_16x16x32_bf16 v[224:227], a[188:191], v[152:155], v[224:227]
v_exp_f32 v243, v243
v_mfma_f32_16x16x32_bf16 v[228:231], a[188:191], v[156:159], v[228:231]
v_add_f32 v240, 1.0, v240
v_add_f32 v241, 1.0, v241
v_mfma_f32_16x16x32_bf16 v[224:227], a[192:195], v[160:163], v[224:227]
buffer_load_dwordx4 v9, s[8:11], s88 offen offset:1024 sc1 lds
v_mfma_f32_16x16x32_bf16 v[228:231], a[192:195], v[164:167], v[228:231]
v_add_f32 v242, 1.0, v242
v_add_f32 v243, 1.0, v243
v_mfma_f32_16x16x32_bf16 v[224:227], a[196:199], v[168:171], v[224:227]
v_rcp_f32 v240, v240
v_mfma_f32_16x16x32_bf16 v[228:231], a[196:199], v[172:175], v[228:231]
v_rcp_f32 v241, v241
v_mfma_f32_16x16x32_bf16 v[224:227], a[200:203], v[176:179], v[224:227]
buffer_load_dwordx4 v10, s[8:11], s88 offen offset:2048 sc1 lds
v_mfma_f32_16x16x32_bf16 v[228:231], a[200:203], v[180:183], v[228:231]
v_rcp_f32 v242, v242
v_mfma_f32_16x16x32_bf16 v[224:227], a[204:207], v[184:187], v[224:227]
v_rcp_f32 v243, v243
v_mfma_f32_16x16x32_bf16 v[228:231], a[204:207], v[188:191], v[228:231]
v_mul_f32 v240, v220, v240
v_mfma_f32_16x16x32_bf16 v[224:227], a[208:211], v[192:195], v[224:227]
buffer_load_dwordx4 v11, s[8:11], s88 offen offset:3072 sc1 lds
v_mfma_f32_16x16x32_bf16 v[228:231], a[208:211], v[196:199], v[228:231]
v_mul_f32 v241, v221, v241
v_mfma_f32_16x16x32_bf16 v[224:227], a[212:215], v[200:203], v[224:227]
v_mul_f32 v242, v222, v242
v_mul_f32 v243, v223, v243
v_mfma_f32_16x16x32_bf16 v[228:231], a[212:215], v[204:207], v[228:231]
s_nop 4
v_mul_f32 v224, v224, v236
v_mul_f32 v225, v225, v237
v_mul_f32 v226, v226, v238
v_mul_f32 v227, v227, v239
v_mul_f32 v228, v228, v240
v_mul_f32 v229, v229, v241
v_mul_f32 v230, v230, v242
v_mul_f32 v231, v231, v243
v_cvt_pk_bf16_f32 v52, v224, v225
v_cvt_pk_bf16_f32 v53, v226, v227
v_cvt_pk_bf16_f32 v54, v228, v229
v_cvt_pk_bf16_f32 v55, v230, v231
s_nop 0
v_permlane16_swap_b32 v52, v54
v_permlane16_swap_b32 v53, v55
buffer_store_dwordx4 v[52:55], v20, s[4:7], s79 offen sc1
s_mov_b32 s79, 1879048192
s_waitcnt vmcnt(5)
s_branch g_go_214
g_notyet_213:
v_mfma_f32_16x16x32_bf16 v[228:231], a[180:183], v[140:143], v[228:231]
s_add_u32 m0, s74, 0
v_exp_f32 v241, v241
v_mfma_f32_16x16x32_bf16 v[224:227], a[184:187], v[144:147], v[224:227]
buffer_load_dwordx4 v8, s[8:11], s88 offen offset:0 sc1 lds
v_mfma_f32_16x16x32_bf16 v[228:231], a[184:187], v[148:151], v[228:231]
v_exp_f32 v242, v242
v_mfma_f32_16x16x32_bf16 v[224:227], a[188:191], v[152:155], v[224:227]
v_exp_f32 v243, v243
v_mfma_f32_16x16x32_bf16 v[228:231], a[188:191], v[156:159], v[228:231]
v_add_f32 v240, 1.0, v240
v_add_f32 v241, 1.0, v241
v_mfma_f32_16x16x32_bf16 v[224:227], a[192:195], v[160:163], v[224:227]
buffer_load_dwordx4 v9, s[8:11], s88 offen offset:1024 sc1 lds
v_mfma_f32_16x16x32_bf16 v[228:231], a[192:195], v[164:167], v[228:231]
v_add_f32 v242, 1.0, v242
v_add_f32 v243, 1.0, v243
v_mfma_f32_16x16x32_bf16 v[224:227], a[196:199], v[168:171], v[224:227]
v_rcp_f32 v240, v240
v_mfma_f32_16x16x32_bf16 v[228:231], a[196:199], v[172:175], v[228:231]
v_rcp_f32 v241, v241
v_mfma_f32_16x16x32_bf16 v[224:227], a[200:203], v[176:179], v[224:227]
buffer_load_dwordx4 v10, s[8:11], s88 offen offset:2048 sc1 lds
v_mfma_f32_16x16x32_bf16 v[228:231], a[200:203], v[180:183], v[228:231]
v_rcp_f32 v242, v242
v_mfma_f32_16x16x32_bf16 v[224:227], a[204:207], v[184:187], v[224:227]
v_rcp_f32 v243, v243
v_mfma_f32_16x16x32_bf16 v[228:231], a[204:207], v[188:191], v[228:231]
v_mul_f32 v240, v220, v240
v_mfma_f32_16x16x32_bf16 v[224:227], a[208:211], v[192:195], v[224:227]
buffer_load_dwordx4 v11, s[8:11], s88 offen offset:3072 sc1 lds
v_mfma_f32_16x16x32_bf16 v[228:231], a[208:211], v[196:199], v[228:231]
v_mul_f32 v241, v221, v241
v_mfma_f32_16x16x32_bf16 v[224:227], a[212:215], v[200:203], v[224:227]
v_mul_f32 v242, v222, v242
v_mul_f32 v243, v223, v243
v_mfma_f32_16x16x32_bf16 v[228:231], a[212:215], v[204:207], v[228:231]
s_nop 4
v_mul_f32 v224, v224, v236
v_mul_f32 v225, v225, v237
v_mul_f32 v226, v226, v238
v_mul_f32 v227, v227, v239
v_mul_f32 v228, v228, v240
v_mul_f32 v229, v229, v241
v_mul_f32 v230, v230, v242
v_mul_f32 v231, v231, v243
v_cvt_pk_bf16_f32 v52, v224, v225
v_cvt_pk_bf16_f32 v53, v226, v227
v_cvt_pk_bf16_f32 v54, v228, v229
v_cvt_pk_bf16_f32 v55, v230, v231
s_nop 0
v_permlane16_swap_b32 v52, v54
v_permlane16_swap_b32 v53, v55
buffer_store_dwordx4 v[52:55], v20, s[4:7], s79 offen sc1
s_mov_b32 s79, 1879048192
v_mov_b32 v27, s76
s_lshl_b32 s70, s77, 10
s_waitcnt vmcnt(0)
s_barrier
buffer_store_dword v27, v45, s[4:7], s70 offen
buffer_store_dword v27, v44, s[4:7], s70 offen sc1
s_mov_b32 s77, 1835008
s_cmp_eq_u32 s81, -1
s_cbranch_scc1 g_fin_199
s_cmp_lg_u32 s3, 0
s_cbranch_scc1 sp_ok_216
s_mov_b32 s55, 0
sp_loop_215:
s_lshl_b64 exec, s[56:57], s82
buffer_load_dword v26, v22, s[4:7], 0 offen sc1
s_mov_b64 exec, -1
s_add_u32 s55, s55, 1
s_cmp_gt_u32 s55, 150000
s_cbranch_scc1 sp_bad_217
s_waitcnt vmcnt(0)
v_cmp_gt_u32 vcc, s81, v26
s_nop 0
s_lshr_b64 s[58:59], vcc, s82
s_and_b32 s58, s58, s56
s_cbranch_scc0 sp_ok_216
s_sleep 1
s_branch sp_loop_215
sp_bad_217:
s_mov_b32 s98, 1028
s_branch L_fail
sp_ok_216:
s_barrier
s_add_u32 m0, s73, 0
s_nop 0
buffer_load_dwordx4 v8, s[4:7], s83 offen offset:0 sc1 lds
buffer_load_dwordx4 v9, s[4:7], s83 offen offset:1024 sc1 lds
buffer_load_dwordx4 v10, s[4:7], s83 offen offset:2048 sc1 lds
buffer_load_dwordx4 v11, s[4:7], s83 offen offset:3072 sc1 lds
s_add_u32 m0, s73, 4096
s_nop 0
buffer_load_dwordx4 v12, s[4:7], s83 offen offset:0 sc1 lds
buffer_load_dwordx4 v13, s[4:7], s83 offen offset:1024 sc1 lds
buffer_load_dwordx4 v14, s[4:7], s83 offen offset:2048 sc1 lds
buffer_load_dwordx4 v15, s[4:7], s83 offen offset:3072 sc1 lds
s_add_u32 m0, s73, 8192
s_nop 0
buffer_load_dwordx4 v16, s[4:7], s83 offen offset:0 sc1 lds
s_waitcnt vmcnt(0)
g_go_214:
g_join_196:
s_barrier
ds_read_b128 v[64:67], v29 offset:0
ds_read_b128 v[68:71], v29 offset:9216
ds_read_b128 v[72:75], v29 offset:18432
ds_read_b128 v[76:79], v29 offset:27648
ds_read_b128 v[80:83], v29 offset:1024
ds_read_b128 v[84:87], v29 offset:10240
ds_read_b128 v[88:91], v29 offset:19456
ds_read_b128 v[92:95], v29 offset:28672
s_branch g_body_192
g_slow_208:
v_cmp_gt_u32 vcc, s86, v33
s_nop 0
s_lshr_b64 s[58:59], vcc, s87
s_and_b32 s58, s58, s56
s_cbranch_scc1 g_notyet_218
s_add_u32 m0, s74, 0
s_nop 0
buffer_load_dwordx4 v8, s[4:7], s88 offen offset:0 sc1 lds
buffer_load_dwordx4 v9, s[4:7], s88 offen offset:1024 sc1 lds
buffer_load_dwordx4 v10, s[4:7], s88 offen offset:2048 sc1 lds
buffer_load_dwordx4 v11, s[4:7], s88 offen offset:3072 sc1 lds
s_add_u32 m0, s74, 4096
s_nop 0
buffer_load_dwordx4 v12, s[4:7], s88 offen offset:0 sc1 lds
buffer_load_dwordx4 v13, s[4:7], s88 offen offset:1024 sc1 lds
buffer_load_dwordx4 v14, s[4:7], s88 offen offset:2048 sc1 lds
buffer_load_dwordx4 v15, s[4:7], s88 offen offset:3072 sc1 lds
s_add_u32 m0, s74, 8192
s_nop 0
buffer_load_dwordx4 v16, s[4:7], s88 offen offset:0 sc1 lds
v_mfma_f32_16x16x32_bf16 v[228:231], a[180:183], v[140:143], v[228:231]
s_add_u32 m0, s75, 0
v_exp_f32 v241, v241
v_mfma_f32_16x16x32_bf16 v[224:227], a[184:187], v[144:147], v[224:227]
buffer_load_dwordx4 v8, s[8:11], s93 offen offset:0 sc1 lds
v_mfma_f32_16x16x32_bf16 v[228:231], a[184:187], v[148:151], v[228:231]
v_exp_f32 v242, v242
v_mfma_f32_16x16x32_bf16 v[224:227], a[188:191], v[152:155], v[224:227]
v_exp_f32 v243, v243
v_mfma_f32_16x16x32_bf16 v[228:231], a[188:191], v[156:159], v[228:231]
v_add_f32 v240, 1.0, v240
v_add_f32 v241, 1.0, v241
v_mfma_f32_16x16x32_bf16 v[224:227], a[192:195], v[160:163], v[224:227]
buffer_load_dwordx4 v9, s[8:11], s93 offen offset:1024 sc1 lds
v_mfma_f32_16x16x32_bf16 v[228:231], a[192:195], v[164:167], v[228:231]
v_add_f32 v242, 1.0, v242
v_add_f32 v243, 1.0, v243
v_mfma_f32_16x16x32_bf16 v[224:227], a[196:199], v[168:171], v[224:227]
v_rcp_f32 v240, v240
v_mfma_f32_16x16x32_bf16 v[228:231], a[196:199], v[172:175], v[228:231]
v_rcp_f32 v241, v241
v_mfma_f32_16x16x32_bf16 v[224:227], a[200:203], v[176:179], v[224:227]
buffer_load_dwordx4 v10, s[8:11], s93 offen offset:2048 sc1 lds
v_mfma_f32_16x16x32_bf16 v[228:231], a[200:203], v[180:183], v[228:231]
v_rcp_f32 v242, v242
v_mfma_f32_16x16x32_bf16 v[224:227], a[204:207], v[184:187], v[224:227]
v_rcp_f32 v243, v243
v_mfma_f32_16x16x32_bf16 v[228:231], a[204:207], v[188:191], v[228:231]
v_mul_f32 v240, v220, v240
v_mfma_f32_16x16x32_bf16 v[224:227], a[208:211], v[192:195], v[224:227]
buffer_load_dwordx4 v11, s[8:11], s93 offen offset:3072 sc1 lds
v_mfma_f32_16x16x32_bf16 v[228:231], a[208:211], v[196:199], v[228:231]
v_mul_f32 v241, v221, v241
v_mfma_f32_16x16x32_bf16 v[224:227], a[212:215], v[200:203], v[224:227]
v_mul_f32 v242, v222, v242
v_mul_f32 v243, v223, v243
v_mfma_f32_16x16x32_bf16 v[228:231], a[212:215], v[204:207], v[228:231]
s_nop 4
v_mul_f32 v224, v224, v236
v_mul_f32 v225, v225, v237
v_mul_f32 v226, v226, v238
v_mul_f32 v227, v227, v239
v_mul_f32 v228, v228, v240
v_mul_f32 v229, v229, v241
v_mul_f32 v230, v230, v242
v_mul_f32 v231, v231, v243
v_cvt_pk_bf16_f32 v52, v224, v225
v_cvt_pk_bf16_f32 v53, v226, v227
v_cvt_pk_bf16_f32 v54, v228, v229
v_cvt_pk_bf16_f32 v55, v230, v231
s_nop 0
v_permlane16_swap_b32 v52, v54
v_permlane16_swap_b32 v53, v55
buffer_store_dwordx4 v[52:55], v20, s[4:7], s84 offen sc1
s_mov_b32 s84, 1879048192
s_waitcnt vmcnt(5)
s_branch g_go_219
g_notyet_218:
v_mfma_f32_16x16x32_bf16 v[228:231], a[180:183], v[140:143], v[228:231]
s_add_u32 m0, s75, 0
v_exp_f32 v241, v241
v_mfma_f32_16x16x32_bf16 v[224:227], a[184:187], v[144:147], v[224:227]
buffer_load_dwordx4 v8, s[8:11], s93 offen offset:0 sc1 lds
v_mfma_f32_16x16x32_bf16 v[228:231], a[184:187], v[148:151], v[228:231]
v_exp_f32 v242, v242
v_mfma_f32_16x16x32_bf16 v[224:227], a[188:191], v[152:155], v[224:227]
v_exp_f32 v243, v243
v_mfma_f32_16x16x32_bf16 v[228:231], a[188:191], v[156:159], v[228:231]
v_add_f32 v240, 1.0, v240
v_add_f32 v241, 1.0, v241
v_mfma_f32_16x16x32_bf16 v[224:227], a[192:195], v[160:163], v[224:227]
buffer_load_dwordx4 v9, s[8:11], s93 offen offset:1024 sc1 lds
v_mfma_f32_16x16x32_bf16 v[228:231], a[192:195], v[164:167], v[228:231]
v_add_f32 v242, 1.0, v242
v_add_f32 v243, 1.0, v243
v_mfma_f32_16x16x32_bf16 v[224:227], a[196:199], v[168:171], v[224:227]
v_rcp_f32 v240, v240
v_mfma_f32_16x16x32_bf16 v[228:231], a[196:199], v[172:175], v[228:231]
v_rcp_f32 v241, v241
v_mfma_f32_16x16x32_bf16 v[224:227], a[200:203], v[176:179], v[224:227]
buffer_load_dwordx4 v10, s[8:11], s93 offen offset:2048 sc1 lds
v_mfma_f32_16x16x32_bf16 v[228:231], a[200:203], v[180:183], v[228:231]
v_rcp_f32 v242, v242
v_mfma_f32_16x16x32_bf16 v[224:227], a[204:207], v[184:187], v[224:227]
v_rcp_f32 v243, v243
v_mfma_f32_16x16x32_bf16 v[228:231], a[204:207], v[188:191], v[228:231]
v_mul_f32 v240, v220, v240
v_mfma_f32_16x16x32_bf16 v[224:227], a[208:211], v[192:195], v[224:227]
buffer_load_dwordx4 v11, s[8:11], s93 offen offset:3072 sc1 lds
v_mfma_f32_16x16x32_bf16 v[228:231], a[208:211], v[196:199], v[228:231]
v_mul_f32 v241, v221, v241
v_mfma_f32_16x16x32_bf16 v[224:227], a[212:215], v[200:203], v[224:227]
v_mul_f32 v242, v222, v242
v_mul_f32 v243, v223, v243
v_mfma_f32_16x16x32_bf16 v[228:231], a[212:215], v[204:207], v[228:231]
s_nop 4
v_mul_f32 v224, v224, v236
v_mul_f32 v225, v225, v237
v_mul_f32 v226, v226, v238
v_mul_f32 v227, v227, v239
v_mul_f32 v228, v228, v240
v_mul_f32 v229, v229, v241
v_mul_f32 v230, v230, v242
v_mul_f32 v231, v231, v243
v_cvt_pk_bf16_f32 v52, v224, v225
v_cvt_pk_bf16_f32 v53, v226, v227
v_cvt_pk_bf16_f32 v54, v228, v229
v_cvt_pk_bf16_f32 v55, v230, v231
s_nop 0
v_permlane16_swap_b32 v52, v54
v_permlane16_swap_b32 v53, v55
buffer_store_dwordx4 v[52:55], v20, s[4:7], s84 offen sc1
s_mov_b32 s84, 1879048192
v_mov_b32 v27, s81
s_lshl_b32 s70, s82, 10
s_waitcnt vmcnt(0)
s_barrier
buffer_store_dword v27, v45, s[4:7], s70 offen
buffer_store_dword v27, v44, s[4:7], s70 offen sc1
s_mov_b32 s82, 1835008
s_cmp_eq_u32 s86, -1
s_cbranch_scc1 g_fin_199
s_cmp_lg_u32 s3, 0
s_cbranch_scc1 sp_ok_221
s_mov_b32 s55, 0
sp_loop_220:
s_lshl_b64 exec, s[56:57], s87
buffer_load_dword v26, v22, s[4:7], 0 offen sc1
s_mov_b64 exec, -1
s_add_u32 s55, s55, 1
s_cmp_gt_u32 s55, 150000
s_cbranch_scc1 sp_bad_222
s_waitcnt vmcnt(0)
v_cmp_gt_u32 vcc, s86, v26
s_nop 0
s_lshr_b64 s[58:59], vcc, s87
s_and_b32 s58, s58, s56
s_cbranch_scc0 sp_ok_221
s_sleep 1
s_branch sp_loop_220
sp_bad_222:
s_mov_b32 s98, 1028
s_branch L_fail
sp_ok_221:
s_barrier
s_add_u32 m0, s74, 0
s_nop 0
buffer_load_dwordx4 v8, s[4:7], s88 offen offset:0 sc1 lds
buffer_load_dwordx4 v9, s[4:7], s88 offen offset:1024 sc1 lds
buffer_load_dwordx4 v10, s[4:7], s88 offen offset:2048 sc1 lds
buffer_load_dwordx4 v11, s[4:7], s88 offen offset:3072 sc1 lds
s_add_u32 m0, s74, 4096
s_nop 0
buffer_load_dwordx4 v12, s[4:7], s88 offen offset:0 sc1 lds
buffer_load_dwordx4 v13, s[4:7], s88 offen offset:1024 sc1 lds
buffer_load_dwordx4 v14, s[4:7], s88 offen offset:2048 sc1 lds
buffer_load_dwordx4 v15, s[4:7], s88 offen offset:3072 sc1 lds
s_add_u32 m0, s74, 8192
s_nop 0
buffer_load_dwordx4 v16, s[4:7], s88 offen offset:0 sc1 lds
s_waitcnt vmcnt(0)
g_go_219:
g_join_197:
s_barrier
ds_read_b128 v[64:67], v30 offset:0
ds_read_b128 v[68:71], v30 offset:9216
ds_read_b128 v[72:75], v30 offset:18432
ds_read_b128 v[76:79], v30 offset:27648
ds_read_b128 v[80:83], v30 offset:1024
ds_read_b128 v[84:87], v30 offset:10240
ds_read_b128 v[88:91], v30 offset:19456
ds_read_b128 v[92:95], v30 offset:28672
s_branch g_body_193
g_slow_209:
v_cmp_gt_u32 vcc, s91, v33
s_nop 0
s_lshr_b64 s[58:59], vcc, s92
s_and_b32 s58, s58, s56
s_cbranch_scc1 g_notyet_223
s_add_u32 m0, s75, 0
s_nop 0
buffer_load_dwordx4 v8, s[4:7], s93 offen offset:0 sc1 lds
buffer_load_dwordx4 v9, s[4:7], s93 offen offset:1024 sc1 lds
buffer_load_dwordx4 v10, s[4:7], s93 offen offset:2048 sc1 lds
buffer_load_dwordx4 v11, s[4:7], s93 offen offset:3072 sc1 lds
s_add_u32 m0, s75, 4096
s_nop 0
buffer_load_dwordx4 v12, s[4:7], s93 offen offset:0 sc1 lds
buffer_load_dwordx4 v13, s[4:7], s93 offen offset:1024 sc1 lds
buffer_load_dwordx4 v14, s[4:7], s93 offen offset:2048 sc1 lds
buffer_load_dwordx4 v15, s[4:7], s93 offen offset:3072 sc1 lds
s_add_u32 m0, s75, 8192
s_nop 0
buffer_load_dwordx4 v16, s[4:7], s93 offen offset:0 sc1 lds
v_mfma_f32_16x16x32_bf16 v[228:231], a[180:183], v[140:143], v[228:231]
s_add_u32 m0, s72, 0
v_exp_f32 v241, v241
v_mfma_f32_16x16x32_bf16 v[224:227], a[184:187], v[144:147], v[224:227]
buffer_load_dwordx4 v8, s[8:11], s78 offen offset:0 sc1 lds
v_mfma_f32_16x16x32_bf16 v[228:231], a[184:187], v[148:151], v[228:231]
v_exp_f32 v242, v242
v_mfma_f32_16x16x32_bf16 v[224:227], a[188:191], v[152:155], v[224:227]
v_exp_f32 v243, v243
v_mfma_f32_16x16x32_bf16 v[228:231], a[188:191], v[156:159], v[228:231]
v_add_f32 v240, 1.0, v240
v_add_f32 v241, 1.0, v241
v_mfma_f32_16x16x32_bf16 v[224:227], a[192:195], v[160:163], v[224:227]
buffer_load_dwordx4 v9, s[8:11], s78 offen offset:1024 sc1 lds
v_mfma_f32_16x16x32_bf16 v[228:231], a[192:195], v[164:167], v[228:231]
v_add_f32 v242, 1.0, v242
v_add_f32 v243, 1.0, v243
v_mfma_f32_16x16x32_bf16 v[224:227], a[196:199], v[168:171], v[224:227]
v_rcp_f32 v240, v240
v_mfma_f32_16x16x32_bf16 v[228:231], a[196:199], v[172:175], v[228:231]
v_rcp_f32 v241, v241
v_mfma_f32_16x16x32_bf16 v[224:227], a[200:203], v[176:179], v[224:227]
buffer_load_dwordx4 v10, s[8:11], s78 offen offset:2048 sc1 lds
v_mfma_f32_16x16x32_bf16 v[228:231], a[200:203], v[180:183], v[228:231]
v_rcp_f32 v242, v242
v_mfma_f32_16x16x32_bf16 v[224:227], a[204:207], v[184:187], v[224:227]
v_rcp_f32 v243, v243
v_mfma_f32_16x16x32_bf16 v[228:231], a[204:207], v[188:191], v[228:231]
v_mul_f32 v240, v220, v240
v_mfma_f32_16x16x32_bf16 v[224:227], a[208:211], v[192:195], v[224:227]
buffer_load_dwordx4 v11, s[8:11], s78 offen offset:3072 sc1 lds
v_mfma_f32_16x16x32_bf16 v[228:231], a[208:211], v[196:199], v[228:231]
v_mul_f32 v241, v221, v241
v_mfma_f32_16x16x32_bf16 v[224:227], a[212:215], v[200:203], v[224:227]
v_mul_f32 v242, v222, v242
v_mul_f32 v243, v223, v243
v_mfma_f32_16x16x32_bf16 v[228:231], a[212:215], v[204:207], v[228:231]
s_nop 4
v_mul_f32 v224, v224, v236
v_mul_f32 v225, v225, v237
v_mul_f32 v226, v226, v238
v_mul_f32 v227, v227, v239
v_mul_f32 v228, v228, v240
v_mul_f32 v229, v229, v241
v_mul_f32 v230, v230, v242
v_mul_f32 v231, v231, v243
v_cvt_pk_bf16_f32 v52, v224, v225
v_cvt_pk_bf16_f32 v53, v226, v227
v_cvt_pk_bf16_f32 v54, v228, v229
v_cvt_pk_bf16_f32 v55, v230, v231
s_nop 0
v_permlane16_swap_b32 v52, v54
v_permlane16_swap_b32 v53, v55
buffer_store_dwordx4 v[52:55], v20, s[4:7], s89 offen sc1
s_mov_b32 s89, 1879048192
s_waitcnt vmcnt(5)
s_branch g_go_224
g_notyet_223:
v_mfma_f32_16x16x32_bf16 v[228:231], a[180:183], v[140:143], v[228:231]
s_add_u32 m0, s72, 0
v_exp_f32 v241, v241
v_mfma_f32_16x16x32_bf16 v[224:227], a[184:187], v[144:147], v[224:227]
buffer_load_dwordx4 v8, s[8:11], s78 offen offset:0 sc1 lds
v_mfma_f32_16x16x32_bf16 v[228:231], a[184:187], v[148:151], v[228:231]
v_exp_f32 v242, v242
v_mfma_f32_16x16x32_bf16 v[224:227], a[188:191], v[152:155], v[224:227]
v_exp_f32 v243, v243
v_mfma_f32_16x16x32_bf16 v[228:231], a[188:191], v[156:159], v[228:231]
v_add_f32 v240, 1.0, v240
v_add_f32 v241, 1.0, v241
v_mfma_f32_16x16x32_bf16 v[224:227], a[192:195], v[160:163], v[224:227]
buffer_load_dwordx4 v9, s[8:11], s78 offen offset:1024 sc1 lds
v_mfma_f32_16x16x32_bf16 v[228:231], a[192:195], v[164:167], v[228:231]
v_add_f32 v242, 1.0, v242
v_add_f32 v243, 1.0, v243
v_mfma_f32_16x16x32_bf16 v[224:227], a[196:199], v[168:171], v[224:227]
v_rcp_f32 v240, v240
v_mfma_f32_16x16x32_bf16 v[228:231], a[196:199], v[172:175], v[228:231]
v_rcp_f32 v241, v241
v_mfma_f32_16x16x32_bf16 v[224:227], a[200:203], v[176:179], v[224:227]
buffer_load_dwordx4 v10, s[8:11], s78 offen offset:2048 sc1 lds
v_mfma_f32_16x16x32_bf16 v[228:231], a[200:203], v[180:183], v[228:231]
v_rcp_f32 v242, v242
v_mfma_f32_16x16x32_bf16 v[224:227], a[204:207], v[184:187], v[224:227]
v_rcp_f32 v243, v243
v_mfma_f32_16x16x32_bf16 v[228:231], a[204:207], v[188:191], v[228:231]
v_mul_f32 v240, v220, v240
v_mfma_f32_16x16x32_bf16 v[224:227], a[208:211], v[192:195], v[224:227]
buffer_load_dwordx4 v11, s[8:11], s78 offen offset:3072 sc1 lds
v_mfma_f32_16x16x32_bf16 v[228:231], a[208:211], v[196:199], v[228:231]
v_mul_f32 v241, v221, v241
v_mfma_f32_16x16x32_bf16 v[224:227], a[212:215], v[200:203], v[224:227]
v_mul_f32 v242, v222, v242
v_mul_f32 v243, v223, v243
v_mfma_f32_16x16x32_bf16 v[228:231], a[212:215], v[204:207], v[228:231]
s_nop 4
v_mul_f32 v224, v224, v236
v_mul_f32 v225, v225, v237
v_mul_f32 v226, v226, v238
v_mul_f32 v227, v227, v239
v_mul_f32 v228, v228, v240
v_mul_f32 v229, v229, v241
v_mul_f32 v230, v230, v242
v_mul_f32 v231, v231, v243
v_cvt_pk_bf16_f32 v52, v224, v225
v_cvt_pk_bf16_f32 v53, v226, v227
v_cvt_pk_bf16_f32 v54, v228, v229
v_cvt_pk_bf16_f32 v55, v230, v231
s_nop 0
v_permlane16_swap_b32 v52, v54
v_permlane16_swap_b32 v53, v55
buffer_store_dwordx4 v[52:55], v20, s[4:7], s89 offen sc1
s_mov_b32 s89, 1879048192
v_mov_b32 v27, s86
s_lshl_b32 s70, s87, 10
s_waitcnt vmcnt(0)
s_barrier
buffer_store_dword v27, v45, s[4:7], s70 offen
buffer_store_dword v27, v44, s[4:7], s70 offen sc1
s_mov_b32 s87, 1835008
s_cmp_eq_u32 s91, -1
s_cbranch_scc1 g_fin_199
s_cmp_lg_u32 s3, 0
s_cbranch_scc1 sp_ok_226
s_mov_b32 s55, 0
sp_loop_225:
s_lshl_b64 exec, s[56:57], s92
buffer_load_dword v26, v22, s[4:7], 0 offen sc1
s_mov_b64 exec, -1
s_add_u32 s55, s55, 1
s_cmp_gt_u32 s55, 150000
s_cbranch_scc1 sp_bad_227
s_waitcnt vmcnt(0)
v_cmp_gt_u32 vcc, s91, v26
s_nop 0
s_lshr_b64 s[58:59], vcc, s92
s_and_b32 s58, s58, s56
s_cbranch_scc0 sp_ok_226
s_sleep 1
s_branch sp_loop_225
sp_bad_227:
s_mov_b32 s98, 1028
s_branch L_fail
sp_ok_226:
s_barrier
s_add_u32 m0, s75, 0
s_nop 0
buffer_load_dwordx4 v8, s[4:7], s93 offen offset:0 sc1 lds
buffer_load_dwordx4 v9, s[4:7], s93 offen offset:1024 sc1 lds
buffer_load_dwordx4 v10, s[4:7], s93 offen offset:2048 sc1 lds
buffer_load_dwordx4 v11, s[4:7], s93 offen offset:3072 sc1 lds
s_add_u32 m0, s75, 4096
s_nop 0
buffer_load_dwordx4 v12, s[4:7], s93 offen offset:0 sc1 lds
buffer_load_dwordx4 v13, s[4:7], s93 offen offset:1024 sc1 lds
buffer_load_dwordx4 v14, s[4:7], s93 offen offset:2048 sc1 lds
buffer_load_dwordx4 v15, s[4:7], s93 offen offset:3072 sc1 lds
s_add_u32 m0, s75, 8192
s_nop 0
buffer_load_dwordx4 v16, s[4:7], s93 offen offset:0 sc1 lds
s_waitcnt vmcnt(0)
g_go_224:
g_join_198:
s_barrier
ds_read_b128 v[64:67], v31 offset:0
ds_read_b128 v[68:71], v31 offset:9216
ds_read_b128 v[72:75], v31 offset:18432
ds_read_b128 v[76:79], v31 offset:27648
ds_read_b128 v[80:83], v31 offset:1024
ds_read_b128 v[84:87], v31 offset:10240
ds_read_b128 v[88:91], v31 offset:19456
ds_read_b128 v[92:95], v31 offset:28672
s_branch g_body_194
g_slow_210:
v_cmp_gt_u32 vcc, s76, v33
s_nop 0
s_lshr_b64 s[58:59], vcc, s77
s_and_b32 s58, s58, s56
s_cbranch_scc1 g_notyet_228
s_add_u32 m0, s72, 0
s_nop 0
buffer_load_dwordx4 v8, s[4:7], s78 offen offset:0 sc1 lds
buffer_load_dwordx4 v9, s[4:7], s78 offen offset:1024 sc1 lds
buffer_load_dwordx4 v10, s[4:7], s78 offen offset:2048 sc1 lds
buffer_load_dwordx4 v11, s[4:7], s78 offen offset:3072 sc1 lds
s_add_u32 m0, s72, 4096
s_nop 0
buffer_load_dwordx4 v12, s[4:7], s78 offen offset:0 sc1 lds
buffer_load_dwordx4 v13, s[4:7], s78 offen offset:1024 sc1 lds
buffer_load_dwordx4 v14, s[4:7], s78 offen offset:2048 sc1 lds
buffer_load_dwordx4 v15, s[4:7], s78 offen offset:3072 sc1 lds
s_add_u32 m0, s72, 8192
s_nop 0
buffer_load_dwordx4 v16, s[4:7], s78 offen offset:0 sc1 lds
v_mfma_f32_16x16x32_bf16 v[228:231], a[180:183], v[140:143], v[228:231]
s_add_u32 m0, s73, 0
v_exp_f32 v241, v241
v_mfma_f32_16x16x32_bf16 v[224:227], a[184:187], v[144:147], v[224:227]
buffer_load_dwordx4 v8, s[8:11], s83 offen offset:0 sc1 lds
v_mfma_f32_16x16x32_bf16 v[228:231], a[184:187], v[148:151], v[228:231]
v_exp_f32 v242, v242
v_mfma_f32_16x16x32_bf16 v[224:227], a[188:191], v[152:155], v[224:227]
v_exp_f32 v243, v243
v_mfma_f32_16x16x32_bf16 v[228:231], a[188:191], v[156:159], v[228:231]
v_add_f32 v240, 1.0, v240
v_add_f32 v241, 1.0, v241
v_mfma_f32_16x16x32_bf16 v[224:227], a[192:195], v[160:163], v[224:227]
buffer_load_dwordx4 v9, s[8:11], s83 offen offset:1024 sc1 lds
v_mfma_f32_16x16x32_bf16 v[228:231], a[192:195], v[164:167], v[228:231]
v_add_f32 v242, 1.0, v242
v_add_f32 v243, 1.0, v243
v_mfma_f32_16x16x32_bf16 v[224:227], a[196:199], v[168:171], v[224:227]
v_rcp_f32 v240, v240
v_mfma_f32_16x16x32_bf16 v[228:231], a[196:199], v[172:175], v[228:231]
v_rcp_f32 v241, v241
v_mfma_f32_16x16x32_bf16 v[224:227], a[200:203], v[176:179], v[224:227]
buffer_load_dwordx4 v10, s[8:11], s83 offen offset:2048 sc1 lds
v_mfma_f32_16x16x32_bf16 v[228:231], a[200:203], v[180:183], v[228:231]
v_rcp_f32 v242, v242
v_mfma_f32_16x16x32_bf16 v[224:227], a[204:207], v[184:187], v[224:227]
v_rcp_f32 v243, v243
v_mfma_f32_16x16x32_bf16 v[228:231], a[204:207], v[188:191], v[228:231]
v_mul_f32 v240, v220, v240
v_mfma_f32_16x16x32_bf16 v[224:227], a[208:211], v[192:195], v[224:227]
buffer_load_dwordx4 v11, s[8:11], s83 offen offset:3072 sc1 lds
v_mfma_f32_16x16x32_bf16 v[228:231], a[208:211], v[196:199], v[228:231]
v_mul_f32 v241, v221, v241
v_mfma_f32_16x16x32_bf16 v[224:227], a[212:215], v[200:203], v[224:227]
v_mul_f32 v242, v222, v242
v_mul_f32 v243, v223, v243
v_mfma_f32_16x16x32_bf16 v[228:231], a[212:215], v[204:207], v[228:231]
s_nop 4
v_mul_f32 v224, v224, v236
v_mul_f32 v225, v225, v237
v_mul_f32 v226, v226, v238
v_mul_f32 v227, v227, v239
v_mul_f32 v228, v228, v240
v_mul_f32 v229, v229, v241
v_mul_f32 v230, v230, v242
v_mul_f32 v231, v231, v243
v_cvt_pk_bf16_f32 v52, v224, v225
v_cvt_pk_bf16_f32 v53, v226, v227
v_cvt_pk_bf16_f32 v54, v228, v229
v_cvt_pk_bf16_f32 v55, v230, v231
s_nop 0
v_permlane16_swap_b32 v52, v54
v_permlane16_swap_b32 v53, v55
buffer_store_dwordx4 v[52:55], v20, s[4:7], s94 offen sc1
s_mov_b32 s94, 1879048192
s_waitcnt vmcnt(5)
s_branch g_go_229
g_notyet_228:
v_mfma_f32_16x16x32_bf16 v[228:231], a[180:183], v[140:143], v[228:231]
s_add_u32 m0, s73, 0
v_exp_f32 v241, v241
v_mfma_f32_16x16x32_bf16 v[224:227], a[184:187], v[144:147], v[224:227]
buffer_load_dwordx4 v8, s[8:11], s83 offen offset:0 sc1 lds
v_mfma_f32_16x16x32_bf16 v[228:231], a[184:187], v[148:151], v[228:231]
v_exp_f32 v242, v242
v_mfma_f32_16x16x32_bf16 v[224:227], a[188:191], v[152:155], v[224:227]
v_exp_f32 v243, v243
v_mfma_f32_16x16x32_bf16 v[228:231], a[188:191], v[156:159], v[228:231]
v_add_f32 v240, 1.0, v240
v_add_f32 v241, 1.0, v241
v_mfma_f32_16x16x32_bf16 v[224:227], a[192:195], v[160:163], v[224:227]
buffer_load_dwordx4 v9, s[8:11], s83 offen offset:1024 sc1 lds
v_mfma_f32_16x16x32_bf16 v[228:231], a[192:195], v[164:167], v[228:231]
v_add_f32 v242, 1.0, v242
v_add_f32 v243, 1.0, v243
v_mfma_f32_16x16x32_bf16 v[224:227], a[196:199], v[168:171], v[224:227]
v_rcp_f32 v240, v240
v_mfma_f32_16x16x32_bf16 v[228:231], a[196:199], v[172:175], v[228:231]
v_rcp_f32 v241, v241
v_mfma_f32_16x16x32_bf16 v[224:227], a[200:203], v[176:179], v[224:227]
buffer_load_dwordx4 v10, s[8:11], s83 offen offset:2048 sc1 lds
v_mfma_f32_16x16x32_bf16 v[228:231], a[200:203], v[180:183], v[228:231]
v_rcp_f32 v242, v242
v_mfma_f32_16x16x32_bf16 v[224:227], a[204:207], v[184:187], v[224:227]
v_rcp_f32 v243, v243
v_mfma_f32_16x16x32_bf16 v[228:231], a[204:207], v[188:191], v[228:231]
v_mul_f32 v240, v220, v240
v_mfma_f32_16x16x32_bf16 v[224:227], a[208:211], v[192:195], v[224:227]
buffer_load_dwordx4 v11, s[8:11], s83 offen offset:3072 sc1 lds
v_mfma_f32_16x16x32_bf16 v[228:231], a[208:211], v[196:199], v[228:231]
v_mul_f32 v241, v221, v241
v_mfma_f32_16x16x32_bf16 v[224:227], a[212:215], v[200:203], v[224:227]
v_mul_f32 v242, v222, v242
v_mul_f32 v243, v223, v243
v_mfma_f32_16x16x32_bf16 v[228:231], a[212:215], v[204:207], v[228:231]
s_nop 4
v_mul_f32 v224, v224, v236
v_mul_f32 v225, v225, v237
v_mul_f32 v226, v226, v238
v_mul_f32 v227, v227, v239
v_mul_f32 v228, v228, v240
v_mul_f32 v229, v229, v241
v_mul_f32 v230, v230, v242
v_mul_f32 v231, v231, v243
v_cvt_pk_bf16_f32 v52, v224, v225
v_cvt_pk_bf16_f32 v53, v226, v227
v_cvt_pk_bf16_f32 v54, v228, v229
v_cvt_pk_bf16_f32 v55, v230, v231
s_nop 0
v_permlane16_swap_b32 v52, v54
v_permlane16_swap_b32 v53, v55
buffer_store_dwordx4 v[52:55], v20, s[4:7], s94 offen sc1
s_mov_b32 s94, 1879048192
v_mov_b32 v27, s91
s_lshl_b32 s70, s92, 10
s_waitcnt vmcnt(0)
s_barrier
buffer_store_dword v27, v45, s[4:7], s70 offen
buffer_store_dword v27, v44, s[4:7], s70 offen sc1
s_mov_b32 s92, 1835008
s_cmp_eq_u32 s76, -1
s_cbranch_scc1 g_fin_199
s_cmp_lg_u32 s3, 0
s_cbranch_scc1 sp_ok_231
s_mov_b32 s55, 0
sp_loop_230:
s_lshl_b64 exec, s[56:57], s77
buffer_load_dword v26, v22, s[4:7], 0 offen sc1
s_mov_b64 exec, -1
s_add_u32 s55, s55, 1
s_cmp_gt_u32 s55, 150000
s_cbranch_scc1 sp_bad_232
s_waitcnt vmcnt(0)
v_cmp_gt_u32 vcc, s76, v26
s_nop 0
s_lshr_b64 s[58:59], vcc, s77
s_and_b32 s58, s58, s56
s_cbranch_scc0 sp_ok_231
s_sleep 1
s_branch sp_loop_230
sp_bad_232:
s_mov_b32 s98, 1028
s_branch L_fail
sp_ok_231:
s_barrier
s_add_u32 m0, s72, 0
s_nop 0
buffer_load_dwordx4 v8, s[4:7], s78 offen offset:0 sc1 lds
buffer_load_dwordx4 v9, s[4:7], s78 offen offset:1024 sc1 lds
buffer_load_dwordx4 v10, s[4:7], s78 offen offset:2048 sc1 lds
buffer_load_dwordx4 v11, s[4:7], s78 offen offset:3072 sc1 lds
s_add_u32 m0, s72, 4096
s_nop 0
buffer_load_dwordx4 v12, s[4:7], s78 offen offset:0 sc1 lds
buffer_load_dwordx4 v13, s[4:7], s78 offen offset:1024 sc1 lds
buffer_load_dwordx4 v14, s[4:7], s78 offen offset:2048 sc1 lds
buffer_load_dwordx4 v15, s[4:7], s78 offen offset:3072 sc1 lds
s_add_u32 m0, s72, 8192
s_nop 0
buffer_load_dwordx4 v16, s[4:7], s78 offen offset:0 sc1 lds
s_waitcnt vmcnt(0)
g_go_229:
s_branch g_join_195
g_fin_199:
s_endpgm
rare_211:
v_mov_b32 v36, v40
v_mov_b32 v37, v41
v_mov_b32 v38, v42
v_mov_b32 v39, v43
s_branch back_212
H_att:
s_lshr_b32 s75, s74, 1
s_and_b32 s76, s74, 1
s_lshl_b32 s44, s75, 2
s_add_u32 s44, s44, s3
s_mul_i32 s52, s76, 32768
s_mul_i32 s46, s76, 50331648
s_add_u32 s46, s46, 10805248
s_mul_i32 s49, s44, 24576
s_add_u32 s46, s46, s49
s_mul_i32 s47, s76, 8388608
s_add_u32 s47, s47, 111468544
s_mul_i32 s49, s44, 4096
s_add_u32 s47, s47, s49
s_mul_i32 s48, s76, 16777216
s_add_u32 s48, s48, 128245760
s_mul_i32 s49, s44, 8192
s_add_u32 s48, s48, s49
s_mov_b32 s50, 0x3e0293ee
v_lshlrev_b32 v8, 4, v0
v_lshlrev_b32 v10, 3, v0
v_add_u32 v10, 2048, v10
v_bfe_u32 v1, v0, 2, 2
v_and_b32 v2, 1, v0
v_lshl_add_u32 v1, v1, 1, v2
v_lshlrev_b32 v1, 4, v1
v_lshrrev_b32 v2, 4, v0
v_lshl_add_u32 v9, v2, 7, v1
v_and_b32 v1, 15, v0
v_lshlrev_b32 v2, 2, v2
v_sub_u32 v1, v1, v2
v_cmp_le_i32 s[56:57], 0, v1
v_cmp_le_i32 s[58:59], 1, v1
v_cmp_le_i32 s[60:61], 2, v1
v_cmp_le_i32 s[62:63], 3, v1
v_mov_b32 v16, 0xff800000
v_mov_b64 v[50:51], 0
v_mov_b32 v57, 0
v_mov_b32 v58, 0
v_mov_b32 v61, 0
v_mov_b32 v62, 0
v_min_u32 v1, 5, v0
v_lshrrev_b32 v2, 1, v1
v_lshlrev_b32 v2, 8, v2
v_and_b32 v1, 1, v1
v_mul_u32_u24 v1, 7, v1
v_add_u32 v1, v1, v2
s_lshl_b32 s49, s44, 3
v_add_u32 v1, s49, v1
v_mul_u32_u24 v1, 43691, v1
v_lshrrev_b32 v1, 19, v1
v_mul_u32_u24 v1, 128, v1
v_add_u32 v1, 2048, v1
s_mul_i32 s49, s44, 128
s_add_u32 s49, s49, 10240
v_mov_b32 v2, s49
v_cmp_eq_u32 vcc, 6, v0
s_nop 1
v_cndmask_b32 v1, v1, v2, vcc
v_cndmask_b32 v20, 1, 0, vcc
v_mov_b32 v7, 2147483632
v_cmp_gt_u32 vcc, 7, v0
s_nop 1
v_cndmask_b32 v11, v7, v1, vcc
s_mul_i32 s49, s44, 128
s_add_u32 s49, s49, 14336
v_mov_b32 v1, s49
v_mov_b32 v2, 2147483632
v_cmp_eq_u32 vcc, 0, v0
s_nop 1
v_cndmask_b32 v22, v2, v1, vcc
v_add_u32 v23, 65536, v22
s_mov_b32 s45, 0
s_getpc_b64 s[96:97]
pc_233:
s_add_u32 s96, s96, L_writers-pc_233
s_addc_u32 s97, s97, 0
v_subrev_u32 v2, 0, v11
v_lshrrev_b32 v2, 7, v2
v_cmp_gt_u32 vcc, 0x200, v2
s_nop 1
v_cndmask_b32 v2, 0, v2, vcc
global_load_ubyte v2, v2, s[96:97]
s_mov_b32 s12, s40
s_and_b32 s13, s41, 0xffff
s_mov_b32 s14, 256
s_mov_b32 s15, 0x20000
v_lshlrev_b32 v14, 2, v0
v_add_u32 v15, 128, v14
v_cmp_le_u32 vcc, 2, v0
s_nop 1
v_cndmask_b32 v14, v14, v15, vcc
v_mov_b32 v15, 192
v_cmp_eq_u32 vcc, 8, v0
s_nop 1
v_cndmask_b32 v14, v14, v15, vcc
v_mov_b32 v15, 2147483632
v_cmp_lt_u32 vcc, 8, v0
s_nop 1
v_cndmask_b32 v14, v14, v15, vcc
s_mov_b32 s98, 0
wi_loop_234:
buffer_load_dword v15, v14, s[12:15], 0 offen sc1
s_add_u32 s98, s98, 1
s_cmp_gt_u32 s98, 150000
s_cbranch_scc1 wi_bad_236
s_waitcnt vmcnt(0)
v_cmp_eq_u32 vcc, 32, v15
s_nop 0
s_and_b32 s97, vcc_lo, 0x1ff
s_cmp_eq_u32 s97, 0x1ff
s_cbranch_scc1 wi_ok_235
v_cmp_lt_u32 vcc, 32, v15
s_nop 0
s_and_b32 s96, vcc_lo, 0xff
s_cselect_b32 s96, 0x100, 0
s_and_b32 s96, s96, s97
s_cbranch_scc1 wi_over_237
s_sleep 8
s_branch wi_loop_234
wi_bad_236:
s_mov_b32 s98, 512
s_branch L_fail
wi_over_237:
s_mov_b32 s100, 255
wi_ok_235:
v_add_u32 v3, 65536, v11
v_cmp_eq_u32 vcc, s100, v2
s_nop 1
v_cndmask_b32 v11, v11, v3, vcc
s_mov_b32 s8, s42
s_and_b32 s9, s43, 0xffff
s_mov_b32 s10, 0
s_mov_b32 s11, 0x20000
s_mov_b32 s98, 0
sp_loop_240:
buffer_load_dword v24, v11, s[4:7], s52 offen sc1
s_add_u32 s98, s98, 1
s_cmp_gt_u32 s98, 150000
s_cbranch_scc1 sp_bad_242
s_waitcnt vmcnt(0)
v_cmp_gt_u32 vcc, 1, v24
s_nop 0
s_and_b32 vcc_lo, vcc_lo, 0x3f
s_cbranch_scc0 sp_ok_241
s_sleep 2
s_branch sp_loop_240
sp_bad_242:
s_mov_b32 s98, 1536
s_branch L_fail
sp_ok_241:
s_add_u32 s54, s46, 0
buffer_load_dwordx4 a[0:3], v8, s[4:7], s54 offen offset:0 sc1
buffer_load_dwordx4 a[4:7], v8, s[4:7], s54 offen offset:1024 sc1
buffer_load_dwordx4 a[8:11], v8, s[4:7], s54 offen offset:2048 sc1
buffer_load_dwordx4 a[12:15], v8, s[4:7], s54 offen offset:3072 sc1
s_add_u32 s54, s46, 4096
buffer_load_dwordx4 a[16:19], v8, s[4:7], s54 offen offset:0 sc1
buffer_load_dwordx4 a[20:23], v8, s[4:7], s54 offen offset:1024 sc1
buffer_load_dwordx4 a[24:27], v8, s[4:7], s54 offen offset:2048 sc1
buffer_load_dwordx4 a[28:31], v8, s[4:7], s54 offen offset:3072 sc1
s_add_u32 s54, s46, 8192
buffer_load_dwordx4 a[32:35], v8, s[4:7], s54 offen offset:0 sc1
buffer_load_dwordx4 a[36:39], v8, s[4:7], s54 offen offset:1024 sc1
buffer_load_dwordx4 a[40:43], v8, s[4:7], s54 offen offset:2048 sc1
buffer_load_dwordx4 a[44:47], v8, s[4:7], s54 offen offset:3072 sc1
s_add_u32 s54, s46, 12288
buffer_load_dwordx4 a[48:51], v8, s[4:7], s54 offen offset:0 sc1
buffer_load_dwordx4 a[52:55], v8, s[4:7], s54 offen offset:1024 sc1
buffer_load_dwordx4 a[56:59], v8, s[4:7], s54 offen offset:2048 sc1
buffer_load_dwordx4 a[60:63], v8, s[4:7], s54 offen offset:3072 sc1
s_add_u32 s54, s46, 16384
buffer_load_dwordx4 a[64:67], v8, s[4:7], s54 offen offset:0 sc1
buffer_load_dwordx4 a[68:71], v8, s[4:7], s54 offen offset:1024 sc1
buffer_load_dwordx4 a[72:75], v8, s[4:7], s54 offen offset:2048 sc1
buffer_load_dwordx4 a[76:79], v8, s[4:7], s54 offen offset:3072 sc1
s_add_u32 s54, s46, 20480
buffer_load_dwordx4 a[80:83], v8, s[4:7], s54 offen offset:0 sc1
buffer_load_dwordx4 a[84:87], v8, s[4:7], s54 offen offset:1024 sc1
buffer_load_dwordx4 a[88:91], v8, s[4:7], s54 offen offset:2048 sc1
buffer_load_dwordx4 a[92:95], v8, s[4:7], s54 offen offset:3072 sc1
s_waitcnt vmcnt(0)
s_mov_b32 s55, 0
v_mfma_f32_16x16x32_bf16 v[28:31], a[32:35], a[0:3], 0
v_mfma_f32_16x16x32_bf16 v[32:35], a[32:35], a[4:7], 0
v_mfma_f32_16x16x32_bf16 v[36:39], a[36:39], a[4:7], 0
v_mfma_f32_16x16x32_bf16 v[28:31], a[40:43], a[8:11], v[28:31]
v_mfma_f32_16x16x32_bf16 v[32:35], a[40:43], a[12:15], v[32:35]
v_mfma_f32_16x16x32_bf16 v[36:39], a[44:47], a[12:15], v[36:39]
v_mfma_f32_16x16x32_bf16 v[28:31], a[48:51], a[16:19], v[28:31]
v_mfma_f32_16x16x32_bf16 v[32:35], a[48:51], a[20:23], v[32:35]
v_mfma_f32_16x16x32_bf16 v[36:39], a[52:55], a[20:23], v[36:39]
v_mfma_f32_16x16x32_bf16 v[28:31], a[56:59], a[24:27], v[28:31]
v_mfma_f32_16x16x32_bf16 v[32:35], a[56:59], a[28:31], v[32:35]
v_mfma_f32_16x16x32_bf16 v[36:39], a[60:63], a[28:31], v[36:39]
s_add_u32 s53, s45, 1
v_add_u32 v13, s53, v20
s_nop 3
v_cndmask_b32 v28, v16, v28, s[56:57]
v_cndmask_b32 v29, v16, v29, s[58:59]
v_cndmask_b32 v30, v16, v30, s[60:61]
v_cndmask_b32 v31, v16, v31, s[62:63]
v_cndmask_b32 v36, v16, v36, s[56:57]
v_cndmask_b32 v37, v16, v37, s[58:59]
v_cndmask_b32 v38, v16, v38, s[60:61]
v_cndmask_b32 v39, v16, v39, s[62:63]
v_max3_f32 v18, v32, v33, v34
v_max3_f32 v17, v28, v29, v30
v_max3_f32 v18, v18, v35, v36
v_max_f32 v17, v17, v31
v_max3_f32 v18, v18, v37, v38
v_max_f32 v18, v18, v39
att_loop_238:
v_cmp_gt_u32 vcc, v13, v24
s_nop 0
s_and_b32 vcc_lo, vcc_lo, 0x7f
s_cmp_lg_u32 s55, 0
s_cbranch_scc1 att_have_246
s_mov_b32 s98, 0
att_sp_243:
buffer_load_dword v24, v11, s[4:7], s52 offen sc1
s_add_u32 s98, s98, 1
s_cmp_gt_u32 s98, 150000
s_cbranch_scc1 att_bad_245
s_waitcnt vmcnt(0)
v_cmp_gt_u32 vcc, v13, v24
s_nop 0
s_and_b32 vcc_lo, vcc_lo, 0x7f
s_and_b32 s49, vcc_lo, 0x40
s_cbranch_scc0 att_ok_244
s_sleep 2
s_branch att_sp_243
att_bad_245:
s_mov_b32 s98, 1537
s_branch L_fail
att_ok_244:
buffer_load_dwordx4 v[64:67], v9, s[4:7], s47 offen offset:0 sc1
buffer_load_dwordx4 v[68:71], v9, s[4:7], s47 offen offset:512 sc1
buffer_load_dwordx4 v[72:75], v9, s[4:7], s47 offen offset:1024 sc1
buffer_load_dwordx4 v[76:79], v9, s[4:7], s47 offen offset:1536 sc1
buffer_load_dwordx2 v[80:81], v10, s[4:7], s47 offen offset:0 sc1
buffer_load_dwordx2 v[82:83], v10, s[4:7], s47 offen offset:512 sc1
buffer_load_dwordx2 v[84:85], v10, s[4:7], s47 offen offset:1024 sc1
buffer_load_dwordx2 v[86:87], v10, s[4:7], s47 offen offset:1536 sc1
att_have_246:
s_cmp_eq_u32 vcc_lo, 0
s_cselect_b32 s51, 1, 0
s_cselect_b32 s10, 268435456, 0
s_add_u32 s46, s46, 786432
s_add_u32 s47, s47, 131072
s_add_u32 s54, s46, 0
buffer_load_dwordx4 a[96:99], v8, s[8:11], s54 offen offset:0 sc1
buffer_load_dwordx4 a[100:103], v8, s[8:11], s54 offen offset:1024 sc1
buffer_load_dwordx4 a[104:107], v8, s[8:11], s54 offen offset:2048 sc1
buffer_load_dwordx4 a[108:111], v8, s[8:11], s54 offen offset:3072 sc1
s_add_u32 s54, s46, 4096
buffer_load_dwordx4 a[112:115], v8, s[8:11], s54 offen offset:0 sc1
buffer_load_dwordx4 a[116:119], v8, s[8:11], s54 offen offset:1024 sc1
buffer_load_dwordx4 a[120:123], v8, s[8:11], s54 offen offset:2048 sc1
buffer_load_dwordx4 a[124:127], v8, s[8:11], s54 offen offset:3072 sc1
s_waitcnt vmcnt(15)
v_mfma_f32_16x16x32_bf16 v[40:43], v[64:67], a[0:3], 0
v_mfma_f32_16x16x32_bf16 v[44:47], v[64:67], a[4:7], 0
s_waitcnt vmcnt(14)
v_mfma_f32_16x16x32_bf16 v[40:43], v[68:71], a[8:11], v[40:43]
v_mfma_f32_16x16x32_bf16 v[44:47], v[68:71], a[12:15], v[44:47]
s_waitcnt vmcnt(13)
v_mfma_f32_16x16x32_bf16 v[40:43], v[72:75], a[16:19], v[40:43]
v_mfma_f32_16x16x32_bf16 v[44:47], v[72:75], a[20:23], v[44:47]
s_waitcnt vmcnt(12)
v_mfma_f32_16x16x32_bf16 v[40:43], v[76:79], a[24:27], v[40:43]
v_mfma_f32_16x16x32_bf16 v[44:47], v[76:79], a[28:31], v[44:47]
s_add_u32 s54, s46, 8192
buffer_load_dwordx4 a[128:131], v8, s[8:11], s54 offen offset:0 sc1
buffer_load_dwordx4 a[132:135], v8, s[8:11], s54 offen offset:1024 sc1
s_nop 3
v_max3_f32 v17, v17, v40, v41
v_max3_f32 v18, v18, v44, v45
s_nop 1
v_permlane32_swap_b32 v17, v18
v_max_f32 v17, v17, v18
v_mov_b32 v19, v17
s_nop 1
v_permlane16_swap_b32 v17, v19
v_max_f32 v17, v17, v19
v_mul_f32 v17, s50, v17
v_mov_b32 v18, v17
buffer_load_dwordx4 a[136:139], v8, s[8:11], s54 offen offset:2048 sc1
s_nop 0
v_permlane32_swap_b32 v17, v18
v_fma_f32 v28, v28, s50, -v17
v_fma_f32 v29, v29, s50, -v17
v_fma_f32 v30, v30, s50, -v17
v_fma_f32 v31, v31, s50, -v17
v_fma_f32 v40, v40, s50, -v17
v_fma_f32 v41, v41, s50, -v17
v_fma_f32 v32, v32, s50, -v18
v_fma_f32 v33, v33, s50, -v18
v_fma_f32 v34, v34, s50, -v18
v_fma_f32 v35, v35, s50, -v18
v_fma_f32 v36, v36, s50, -v18
v_fma_f32 v37, v37, s50, -v18
v_fma_f32 v38, v38, s50, -v18
v_fma_f32 v39, v39, s50, -v18
v_fma_f32 v44, v44, s50, -v18
v_fma_f32 v45, v45, s50, -v18
buffer_load_dwordx4 a[140:143], v8, s[8:11], s54 offen offset:3072 sc1
v_exp_f32 v28, v28
v_exp_f32 v29, v29
v_exp_f32 v30, v30
v_exp_f32 v31, v31
v_exp_f32 v40, v40
v_exp_f32 v41, v41
s_add_u32 s54, s46, 12288
buffer_load_dwordx4 a[144:147], v8, s[8:11], s54 offen offset:0 sc1
v_exp_f32 v32, v32
v_exp_f32 v33, v33
v_exp_f32 v34, v34
v_exp_f32 v35, v35
v_exp_f32 v36, v36
v_exp_f32 v37, v37
v_exp_f32 v38, v38
v_exp_f32 v39, v39
v_exp_f32 v44, v44
v_exp_f32 v45, v45
buffer_load_dwordx4 a[148:151], v8, s[8:11], s54 offen offset:1024 sc1
v_add_f32 v17, v28, v29
v_add_f32 v18, v32, v33
v_add_f32 v17, v17, v30
v_add_f32 v18, v18, v34
v_add_f32 v17, v17, v31
v_add_f32 v18, v18, v35
v_add_f32 v17, v17, v40
v_add_f32 v18, v18, v36
v_add_f32 v17, v17, v41
v_add_f32 v18, v18, v37
v_add_f32 v18, v18, v38
v_add_f32 v18, v18, v39
v_add_f32 v18, v18, v44
v_add_f32 v18, v18, v45
buffer_load_dwordx4 a[152:155], v8, s[8:11], s54 offen offset:2048 sc1
s_nop 0
v_permlane32_swap_b32 v17, v18
v_add_f32 v17, v17, v18
v_mov_b32 v19, v17
s_nop 1
v_permlane16_swap_b32 v17, v19
v_add_f32 v17, v17, v19
v_rcp_f32 v17, v17
buffer_load_dwordx4 a[156:159], v8, s[8:11], s54 offen offset:3072 sc1
v_mov_b32 v18, v17
s_add_u32 s54, s46, 16384
buffer_load_dwordx4 a[160:163], v8, s[8:11], s54 offen offset:0 sc1
v_permlane32_swap_b32 v17, v18
v_mul_f32 v28, v28, v17
v_mul_f32 v29, v29, v17
v_mul_f32 v30, v30, v17
v_mul_f32 v31, v31, v17
v_mul_f32 v40, v40, v17
v_mul_f32 v41, v41, v17
v_cvt_pk_bf16_f32 v48, v28, v29
v_cvt_pk_bf16_f32 v49, v30, v31
v_cvt_pk_bf16_f32 v56, v40, v41
v_cvt_pk_bf16_f32 v59, v40, v41
buffer_load_dwordx4 a[164:167], v8, s[8:11], s54 offen offset:1024 sc1
v_mul_f32 v32, v32, v18
v_mul_f32 v33, v33, v18
v_mul_f32 v34, v34, v18
v_mul_f32 v35, v35, v18
v_mul_f32 v36, v36, v18
v_mul_f32 v37, v37, v18
v_mul_f32 v38, v38, v18
v_mul_f32 v39, v39, v18
v_mul_f32 v44, v44, v18
v_mul_f32 v45, v45, v18
v_cvt_pk_bf16_f32 v52, v32, v33
v_cvt_pk_bf16_f32 v53, v34, v35
v_cvt_pk_bf16_f32 v54, v36, v37
v_cvt_pk_bf16_f32 v55, v38, v39
v_cvt_pk_bf16_f32 v60, v44, v45
v_cvt_pk_bf16_f32 v63, v44, v45
buffer_load_dwordx4 a[168:171], v8, s[8:11], s54 offen offset:2048 sc1
s_add_u32 s49, s48, 4096
s_waitcnt vmcnt(19)
buffer_load_dword v24, v11, s[4:7], s52 offen sc1
v_mfma_f32_16x16x32_bf16 v[128:131], a[64:67], v[48:51], 0
v_mfma_f32_16x16x32_bf16 v[132:135], a[68:71], v[48:51], 0
v_mfma_f32_16x16x16_bf16 v[128:131], v[80:81], v[56:57], v[128:131]
v_mfma_f32_16x16x16_bf16 v[132:135], v[80:81], v[58:59], v[132:135]
v_mfma_f32_16x16x32_bf16 v[136:139], a[72:75], v[48:51], 0
v_mfma_f32_16x16x32_bf16 v[140:143], a[76:79], v[48:51], 0
v_mfma_f32_16x16x16_bf16 v[136:139], v[82:83], v[56:57], v[136:139]
v_mfma_f32_16x16x16_bf16 v[140:143], v[82:83], v[58:59], v[140:143]
v_mfma_f32_16x16x32_bf16 v[144:147], a[80:83], v[48:51], 0
s_nop 1
v_cvt_pk_bf16_f32 v88, v128, v129
v_mfma_f32_16x16x32_bf16 v[148:151], a[84:87], v[48:51], 0
v_cvt_pk_bf16_f32 v89, v130, v131
v_mfma_f32_16x16x16_bf16 v[144:147], v[84:85], v[56:57], v[144:147]
v_cvt_pk_bf16_f32 v90, v132, v133
v_mfma_f32_16x16x16_bf16 v[148:151], v[84:85], v[58:59], v[148:151]
v_cvt_pk_bf16_f32 v91, v134, v135
buffer_store_dwordx4 v[88:91], v8, s[4:7], s48 offen offset:0 sc1
v_mfma_f32_16x16x32_bf16 v[152:155], a[88:91], v[48:51], 0
v_cvt_pk_bf16_f32 v92, v136, v137
v_mfma_f32_16x16x32_bf16 v[156:159], a[92:95], v[48:51], 0
v_cvt_pk_bf16_f32 v93, v138, v139
v_mfma_f32_16x16x16_bf16 v[152:155], v[86:87], v[56:57], v[152:155]
v_cvt_pk_bf16_f32 v94, v140, v141
v_mfma_f32_16x16x16_bf16 v[156:159], v[86:87], v[58:59], v[156:159]
v_cvt_pk_bf16_f32 v95, v142, v143
buffer_store_dwordx4 v[92:95], v8, s[4:7], s48 offen offset:2048 sc1
v_mfma_f32_16x16x32_bf16 v[160:163], a[64:67], v[52:55], 0
v_cvt_pk_bf16_f32 v96, v144, v145
v_mfma_f32_16x16x32_bf16 v[164:167], a[68:71], v[52:55], 0
v_cvt_pk_bf16_f32 v97, v146, v147
v_mfma_f32_16x16x16_bf16 v[160:163], v[80:81], v[60:61], v[160:163]
v_cvt_pk_bf16_f32 v98, v148, v149
v_mfma_f32_16x16x16_bf16 v[164:167], v[80:81], v[62:63], v[164:167]
v_cvt_pk_bf16_f32 v99, v150, v151
buffer_store_dwordx4 v[96:99], v8, s[4:7], s49 offen offset:0 sc1
v_mfma_f32_16x16x32_bf16 v[168:171], a[72:75], v[52:55], 0
v_cvt_pk_bf16_f32 v100, v152, v153
v_mfma_f32_16x16x32_bf16 v[172:175], a[76:79], v[52:55], 0
v_cvt_pk_bf16_f32 v101, v154, v155
v_mfma_f32_16x16x16_bf16 v[168:171], v[82:83], v[60:61], v[168:171]
v_cvt_pk_bf16_f32 v102, v156, v157
v_mfma_f32_16x16x16_bf16 v[172:175], v[82:83], v[62:63], v[172:175]
v_cvt_pk_bf16_f32 v103, v158, v159
buffer_store_dwordx4 v[100:103], v8, s[4:7], s49 offen offset:2048 sc1
v_mfma_f32_16x16x32_bf16 v[176:179], a[80:83], v[52:55], 0
v_cvt_pk_bf16_f32 v104, v160, v161
v_mfma_f32_16x16x32_bf16 v[180:183], a[84:87], v[52:55], 0
v_cvt_pk_bf16_f32 v105, v162, v163
v_mfma_f32_16x16x16_bf16 v[176:179], v[84:85], v[60:61], v[176:179]
v_cvt_pk_bf16_f32 v106, v164, v165
v_mfma_f32_16x16x16_bf16 v[180:183], v[84:85], v[62:63], v[180:183]
v_cvt_pk_bf16_f32 v107, v166, v167
buffer_store_dwordx4 v[104:107], v8, s[4:7], s48 offen offset:1024 sc1
v_mfma_f32_16x16x32_bf16 v[184:187], a[88:91], v[52:55], 0
v_cvt_pk_bf16_f32 v108, v168, v169
v_mfma_f32_16x16x32_bf16 v[188:191], a[92:95], v[52:55], 0
v_cvt_pk_bf16_f32 v109, v170, v171
v_mfma_f32_16x16x16_bf16 v[184:187], v[86:87], v[60:61], v[184:187]
v_cvt_pk_bf16_f32 v110, v172, v173
v_mfma_f32_16x16x16_bf16 v[188:191], v[86:87], v[62:63], v[188:191]
v_cvt_pk_bf16_f32 v111, v174, v175
buffer_store_dwordx4 v[108:111], v8, s[4:7], s48 offen offset:3072 sc1
v_cvt_pk_bf16_f32 v112, v176, v177
v_cvt_pk_bf16_f32 v113, v178, v179
v_cvt_pk_bf16_f32 v114, v180, v181
v_cvt_pk_bf16_f32 v115, v182, v183
buffer_store_dwordx4 v[112:115], v8, s[4:7], s49 offen offset:1024 sc1
v_cvt_pk_bf16_f32 v116, v184, v185
v_cvt_pk_bf16_f32 v117, v186, v187
v_cvt_pk_bf16_f32 v118, v188, v189
v_cvt_pk_bf16_f32 v119, v190, v191
buffer_store_dwordx4 v[116:119], v8, s[4:7], s49 offen offset:3072 sc1
buffer_load_dwordx4 a[172:175], v8, s[8:11], s54 offen offset:3072 sc1
s_add_u32 s54, s46, 20480
buffer_load_dwordx4 a[176:179], v8, s[8:11], s54 offen offset:0 sc1
buffer_load_dwordx4 a[180:183], v8, s[8:11], s54 offen offset:1024 sc1
buffer_load_dwordx4 a[184:187], v8, s[8:11], s54 offen offset:2048 sc1
buffer_load_dwordx4 a[188:191], v8, s[8:11], s54 offen offset:3072 sc1
s_add_u32 s48, s48, 262144
v_mov_b32 v15, s53
s_mov_b32 s45, s53
s_cmp_eq_u32 s51, 0
s_cbranch_scc1 att_nopre_247
s_waitcnt vmcnt(13)
v_add_u32 v13, 1, v13
v_cmp_gt_u32 vcc, v13, v24
s_nop 0
s_and_b32 vcc_lo, vcc_lo, 0x40
s_cselect_b32 s55, 0, 1
s_cbranch_scc1 att_nokm_249
buffer_load_dwordx4 v[64:67], v9, s[4:7], s47 offen offset:0 sc1
buffer_load_dwordx4 v[68:71], v9, s[4:7], s47 offen offset:512 sc1
buffer_load_dwordx4 v[72:75], v9, s[4:7], s47 offen offset:1024 sc1
buffer_load_dwordx4 v[76:79], v9, s[4:7], s47 offen offset:1536 sc1
buffer_load_dwordx2 v[80:81], v10, s[4:7], s47 offen offset:0 sc1
buffer_load_dwordx2 v[82:83], v10, s[4:7], s47 offen offset:512 sc1
buffer_load_dwordx2 v[84:85], v10, s[4:7], s47 offen offset:1024 sc1
buffer_load_dwordx2 v[86:87], v10, s[4:7], s47 offen offset:1536 sc1
s_waitcnt vmcnt(13)
buffer_store_dword v15, v23, s[4:7], s52 offen
buffer_store_dword v15, v22, s[4:7], s52 offen sc1
s_waitcnt vmcnt(10)
s_branch att_nokm_249_j
att_nokm_249:
s_waitcnt vmcnt(5)
buffer_store_dword v15, v23, s[4:7], s52 offen
buffer_store_dword v15, v22, s[4:7], s52 offen sc1
s_waitcnt vmcnt(2)
att_nokm_249_j:
v_mfma_f32_16x16x32_bf16 v[28:31], a[128:131], a[96:99], 0
v_mfma_f32_16x16x32_bf16 v[32:35], a[128:131], a[100:103], 0
v_mfma_f32_16x16x32_bf16 v[36:39], a[132:135], a[100:103], 0
v_mfma_f32_16x16x32_bf16 v[28:31], a[136:139], a[104:107], v[28:31]
v_mfma_f32_16x16x32_bf16 v[32:35], a[136:139], a[108:111], v[32:35]
v_mfma_f32_16x16x32_bf16 v[36:39], a[140:143], a[108:111], v[36:39]
v_mfma_f32_16x16x32_bf16 v[28:31], a[144:147], a[112:115], v[28:31]
v_mfma_f32_16x16x32_bf16 v[32:35], a[144:147], a[116:119], v[32:35]
v_mfma_f32_16x16x32_bf16 v[36:39], a[148:151], a[116:119], v[36:39]
v_mfma_f32_16x16x32_bf16 v[28:31], a[152:155], a[120:123], v[28:31]
v_mfma_f32_16x16x32_bf16 v[32:35], a[152:155], a[124:127], v[32:35]
v_mfma_f32_16x16x32_bf16 v[36:39], a[156:159], a[124:127], v[36:39]
s_add_u32 s53, s45, 1
v_add_u32 v13, s53, v20
s_nop 3
v_cndmask_b32 v28, v16, v28, s[56:57]
v_cndmask_b32 v29, v16, v29, s[58:59]
v_cndmask_b32 v30, v16, v30, s[60:61]
v_cndmask_b32 v31, v16, v31, s[62:63]
v_cndmask_b32 v36, v16, v36, s[56:57]
v_cndmask_b32 v37, v16, v37, s[58:59]
v_cndmask_b32 v38, v16, v38, s[60:61]
v_cndmask_b32 v39, v16, v39, s[62:63]
v_max3_f32 v18, v32, v33, v34
v_max3_f32 v17, v28, v29, v30
v_max3_f32 v18, v18, v35, v36
v_max_f32 v17, v17, v31
v_max3_f32 v18, v18, v37, v38
v_max_f32 v18, v18, v39
att_j2_248:
v_cmp_gt_u32 vcc, v13, v24
s_nop 0
s_and_b32 vcc_lo, vcc_lo, 0x7f
s_cmp_lg_u32 s55, 0
s_cbranch_scc1 att_have_253
s_mov_b32 s98, 0
att_sp_250:
buffer_load_dword v24, v11, s[4:7], s52 offen sc1
s_add_u32 s98, s98, 1
s_cmp_gt_u32 s98, 150000
s_cbranch_scc1 att_bad_252
s_waitcnt vmcnt(0)
v_cmp_gt_u32 vcc, v13, v24
s_nop 0
s_and_b32 vcc_lo, vcc_lo, 0x7f
s_and_b32 s49, vcc_lo, 0x40
s_cbranch_scc0 att_ok_251
s_sleep 2
s_branch att_sp_250
att_bad_252:
s_mov_b32 s98, 1537
s_branch L_fail
att_ok_251:
buffer_load_dwordx4 v[64:67], v9, s[4:7], s47 offen offset:0 sc1
buffer_load_dwordx4 v[68:71], v9, s[4:7], s47 offen offset:512 sc1
buffer_load_dwordx4 v[72:75], v9, s[4:7], s47 offen offset:1024 sc1
buffer_load_dwordx4 v[76:79], v9, s[4:7], s47 offen offset:1536 sc1
buffer_load_dwordx2 v[80:81], v10, s[4:7], s47 offen offset:0 sc1
buffer_load_dwordx2 v[82:83], v10, s[4:7], s47 offen offset:512 sc1
buffer_load_dwordx2 v[84:85], v10, s[4:7], s47 offen offset:1024 sc1
buffer_load_dwordx2 v[86:87], v10, s[4:7], s47 offen offset:1536 sc1
att_have_253:
s_cmp_eq_u32 vcc_lo, 0
s_cselect_b32 s51, 1, 0
s_cselect_b32 s10, 268435456, 0
s_add_u32 s46, s46, 786432
s_add_u32 s47, s47, 131072
s_add_u32 s54, s46, 0
buffer_load_dwordx4 a[0:3], v8, s[8:11], s54 offen offset:0 sc1
buffer_load_dwordx4 a[4:7], v8, s[8:11], s54 offen offset:1024 sc1
buffer_load_dwordx4 a[8:11], v8, s[8:11], s54 offen offset:2048 sc1
buffer_load_dwordx4 a[12:15], v8, s[8:11], s54 offen offset:3072 sc1
s_add_u32 s54, s46, 4096
buffer_load_dwordx4 a[16:19], v8, s[8:11], s54 offen offset:0 sc1
buffer_load_dwordx4 a[20:23], v8, s[8:11], s54 offen offset:1024 sc1
buffer_load_dwordx4 a[24:27], v8, s[8:11], s54 offen offset:2048 sc1
buffer_load_dwordx4 a[28:31], v8, s[8:11], s54 offen offset:3072 sc1
s_waitcnt vmcnt(15)
v_mfma_f32_16x16x32_bf16 v[40:43], v[64:67], a[96:99], 0
v_mfma_f32_16x16x32_bf16 v[44:47], v[64:67], a[100:103], 0
s_waitcnt vmcnt(14)
v_mfma_f32_16x16x32_bf16 v[40:43], v[68:71], a[104:107], v[40:43]
v_mfma_f32_16x16x32_bf16 v[44:47], v[68:71], a[108:111], v[44:47]
s_waitcnt vmcnt(13)
v_mfma_f32_16x16x32_bf16 v[40:43], v[72:75], a[112:115], v[40:43]
v_mfma_f32_16x16x32_bf16 v[44:47], v[72:75], a[116:119], v[44:47]
s_waitcnt vmcnt(12)
v_mfma_f32_16x16x32_bf16 v[40:43], v[76:79], a[120:123], v[40:43]
v_mfma_f32_16x16x32_bf16 v[44:47], v[76:79], a[124:127], v[44:47]
s_add_u32 s54, s46, 8192
buffer_load_dwordx4 a[32:35], v8, s[8:11], s54 offen offset:0 sc1
buffer_load_dwordx4 a[36:39], v8, s[8:11], s54 offen offset:1024 sc1
s_nop 3
v_max3_f32 v17, v17, v40, v41
v_max3_f32 v18, v18, v44, v45
s_nop 1
v_permlane32_swap_b32 v17, v18
v_max_f32 v17, v17, v18
v_mov_b32 v19, v17
s_nop 1
v_permlane16_swap_b32 v17, v19
v_max_f32 v17, v17, v19
v_mul_f32 v17, s50, v17
v_mov_b32 v18, v17
buffer_load_dwordx4 a[40:43], v8, s[8:11], s54 offen offset:2048 sc1
s_nop 0
v_permlane32_swap_b32 v17, v18
v_fma_f32 v28, v28, s50, -v17
v_fma_f32 v29, v29, s50, -v17
v_fma_f32 v30, v30, s50, -v17
v_fma_f32 v31, v31, s50, -v17
v_fma_f32 v40, v40, s50, -v17
v_fma_f32 v41, v41, s50, -v17
v_fma_f32 v32, v32, s50, -v18
v_fma_f32 v33, v33, s50, -v18
v_fma_f32 v34, v34, s50, -v18
v_fma_f32 v35, v35, s50, -v18
v_fma_f32 v36, v36, s50, -v18
v_fma_f32 v37, v37, s50, -v18
v_fma_f32 v38, v38, s50, -v18
v_fma_f32 v39, v39, s50, -v18
v_fma_f32 v44, v44, s50, -v18
v_fma_f32 v45, v45, s50, -v18
buffer_load_dwordx4 a[44:47], v8, s[8:11], s54 offen offset:3072 sc1
v_exp_f32 v28, v28
v_exp_f32 v29, v29
v_exp_f32 v30, v30
v_exp_f32 v31, v31
v_exp_f32 v40, v40
v_exp_f32 v41, v41
s_add_u32 s54, s46, 12288
buffer_load_dwordx4 a[48:51], v8, s[8:11], s54 offen offset:0 sc1
v_exp_f32 v32, v32
v_exp_f32 v33, v33
v_exp_f32 v34, v34
v_exp_f32 v35, v35
v_exp_f32 v36, v36
v_exp_f32 v37, v37
v_exp_f32 v38, v38
v_exp_f32 v39, v39
v_exp_f32 v44, v44
v_exp_f32 v45, v45
buffer_load_dwordx4 a[52:55], v8, s[8:11], s54 offen offset:1024 sc1
v_add_f32 v17, v28, v29
v_add_f32 v18, v32, v33
v_add_f32 v17, v17, v30
v_add_f32 v18, v18, v34
v_add_f32 v17, v17, v31
v_add_f32 v18, v18, v35
v_add_f32 v17, v17, v40
v_add_f32 v18, v18, v36
v_add_f32 v17, v17, v41
v_add_f32 v18, v18, v37
v_add_f32 v18, v18, v38
v_add_f32 v18, v18, v39
v_add_f32 v18, v18, v44
v_add_f32 v18, v18, v45
buffer_load_dwordx4 a[56:59], v8, s[8:11], s54 offen offset:2048 sc1
s_nop 0
v_permlane32_swap_b32 v17, v18
v_add_f32 v17, v17, v18
v_mov_b32 v19, v17
s_nop 1
v_permlane16_swap_b32 v17, v19
v_add_f32 v17, v17, v19
v_rcp_f32 v17, v17
buffer_load_dwordx4 a[60:63], v8, s[8:11], s54 offen offset:3072 sc1
v_mov_b32 v18, v17
s_add_u32 s54, s46, 16384
buffer_load_dwordx4 a[64:67], v8, s[8:11], s54 offen offset:0 sc1
v_permlane32_swap_b32 v17, v18
v_mul_f32 v28, v28, v17
v_mul_f32 v29, v29, v17
v_mul_f32 v30, v30, v17
v_mul_f32 v31, v31, v17
v_mul_f32 v40, v40, v17
v_mul_f32 v41, v41, v17
v_cvt_pk_bf16_f32 v48, v28, v29
v_cvt_pk_bf16_f32 v49, v30, v31
v_cvt_pk_bf16_f32 v56, v40, v41
v_cvt_pk_bf16_f32 v59, v40, v41
buffer_load_dwordx4 a[68:71], v8, s[8:11], s54 offen offset:1024 sc1
v_mul_f32 v32, v32, v18
v_mul_f32 v33, v33, v18
v_mul_f32 v34, v34, v18
v_mul_f32 v35, v35, v18
v_mul_f32 v36, v36, v18
v_mul_f32 v37, v37, v18
v_mul_f32 v38, v38, v18
v_mul_f32 v39, v39, v18
v_mul_f32 v44, v44, v18
v_mul_f32 v45, v45, v18
v_cvt_pk_bf16_f32 v52, v32, v33
v_cvt_pk_bf16_f32 v53, v34, v35
v_cvt_pk_bf16_f32 v54, v36, v37
v_cvt_pk_bf16_f32 v55, v38, v39
v_cvt_pk_bf16_f32 v60, v44, v45
v_cvt_pk_bf16_f32 v63, v44, v45
buffer_load_dwordx4 a[72:75], v8, s[8:11], s54 offen offset:2048 sc1
s_add_u32 s49, s48, 4096
s_waitcnt vmcnt(19)
buffer_load_dword v24, v11, s[4:7], s52 offen sc1
v_mfma_f32_16x16x32_bf16 v[128:131], a[160:163], v[48:51], 0
v_mfma_f32_16x16x32_bf16 v[132:135], a[164:167], v[48:51], 0
v_mfma_f32_16x16x16_bf16 v[128:131], v[80:81], v[56:57], v[128:131]
v_mfma_f32_16x16x16_bf16 v[132:135], v[80:81], v[58:59], v[132:135]
v_mfma_f32_16x16x32_bf16 v[136:139], a[168:171], v[48:51], 0
v_mfma_f32_16x16x32_bf16 v[140:143], a[172:175], v[48:51], 0
v_mfma_f32_16x16x16_bf16 v[136:139], v[82:83], v[56:57], v[136:139]
v_mfma_f32_16x16x16_bf16 v[140:143], v[82:83], v[58:59], v[140:143]
v_mfma_f32_16x16x32_bf16 v[144:147], a[176:179], v[48:51], 0
s_nop 1
v_cvt_pk_bf16_f32 v88, v128, v129
v_mfma_f32_16x16x32_bf16 v[148:151], a[180:183], v[48:51], 0
v_cvt_pk_bf16_f32 v89, v130, v131
v_mfma_f32_16x16x16_bf16 v[144:147], v[84:85], v[56:57], v[144:147]
v_cvt_pk_bf16_f32 v90, v132, v133
v_mfma_f32_16x16x16_bf16 v[148:151], v[84:85], v[58:59], v[148:151]
v_cvt_pk_bf16_f32 v91, v134, v135
buffer_store_dwordx4 v[88:91], v8, s[4:7], s48 offen offset:0 sc1
v_mfma_f32_16x16x32_bf16 v[152:155], a[184:187], v[48:51], 0
v_cvt_pk_bf16_f32 v92, v136, v137
v_mfma_f32_16x16x32_bf16 v[156:159], a[188:191], v[48:51], 0
v_cvt_pk_bf16_f32 v93, v138, v139
v_mfma_f32_16x16x16_bf16 v[152:155], v[86:87], v[56:57], v[152:155]
v_cvt_pk_bf16_f32 v94, v140, v141
v_mfma_f32_16x16x16_bf16 v[156:159], v[86:87], v[58:59], v[156:159]
v_cvt_pk_bf16_f32 v95, v142, v143
buffer_store_dwordx4 v[92:95], v8, s[4:7], s48 offen offset:2048 sc1
v_mfma_f32_16x16x32_bf16 v[160:163], a[160:163], v[52:55], 0
v_cvt_pk_bf16_f32 v96, v144, v145
v_mfma_f32_16x16x32_bf16 v[164:167], a[164:167], v[52:55], 0
v_cvt_pk_bf16_f32 v97, v146, v147
v_mfma_f32_16x16x16_bf16 v[160:163], v[80:81], v[60:61], v[160:163]
v_cvt_pk_bf16_f32 v98, v148, v149
v_mfma_f32_16x16x16_bf16 v[164:167], v[80:81], v[62:63], v[164:167]
v_cvt_pk_bf16_f32 v99, v150, v151
buffer_store_dwordx4 v[96:99], v8, s[4:7], s49 offen offset:0 sc1
v_mfma_f32_16x16x32_bf16 v[168:171], a[168:171], v[52:55], 0
v_cvt_pk_bf16_f32 v100, v152, v153
v_mfma_f32_16x16x32_bf16 v[172:175], a[172:175], v[52:55], 0
v_cvt_pk_bf16_f32 v101, v154, v155
v_mfma_f32_16x16x16_bf16 v[168:171], v[82:83], v[60:61], v[168:171]
v_cvt_pk_bf16_f32 v102, v156, v157
v_mfma_f32_16x16x16_bf16 v[172:175], v[82:83], v[62:63], v[172:175]
v_cvt_pk_bf16_f32 v103, v158, v159
buffer_store_dwordx4 v[100:103], v8, s[4:7], s49 offen offset:2048 sc1
v_mfma_f32_16x16x32_bf16 v[176:179], a[176:179], v[52:55], 0
v_cvt_pk_bf16_f32 v104, v160, v161
v_mfma_f32_16x16x32_bf16 v[180:183], a[180:183], v[52:55], 0
v_cvt_pk_bf16_f32 v105, v162, v163
v_mfma_f32_16x16x16_bf16 v[176:179], v[84:85], v[60:61], v[176:179]
v_cvt_pk_bf16_f32 v106, v164, v165
v_mfma_f32_16x16x16_bf16 v[180:183], v[84:85], v[62:63], v[180:183]
v_cvt_pk_bf16_f32 v107, v166, v167
buffer_store_dwordx4 v[104:107], v8, s[4:7], s48 offen offset:1024 sc1
v_mfma_f32_16x16x32_bf16 v[184:187], a[184:187], v[52:55], 0
v_cvt_pk_bf16_f32 v108, v168, v169
v_mfma_f32_16x16x32_bf16 v[188:191], a[188:191], v[52:55], 0
v_cvt_pk_bf16_f32 v109, v170, v171
v_mfma_f32_16x16x16_bf16 v[184:187], v[86:87], v[60:61], v[184:187]
v_cvt_pk_bf16_f32 v110, v172, v173
v_mfma_f32_16x16x16_bf16 v[188:191], v[86:87], v[62:63], v[188:191]
v_cvt_pk_bf16_f32 v111, v174, v175
buffer_store_dwordx4 v[108:111], v8, s[4:7], s48 offen offset:3072 sc1
v_cvt_pk_bf16_f32 v112, v176, v177
v_cvt_pk_bf16_f32 v113, v178, v179
v_cvt_pk_bf16_f32 v114, v180, v181
v_cvt_pk_bf16_f32 v115, v182, v183
buffer_store_dwordx4 v[112:115], v8, s[4:7], s49 offen offset:1024 sc1
v_cvt_pk_bf16_f32 v116, v184, v185
v_cvt_pk_bf16_f32 v117, v186, v187
v_cvt_pk_bf16_f32 v118, v188, v189
v_cvt_pk_bf16_f32 v119, v190, v191
buffer_store_dwordx4 v[116:119], v8, s[4:7], s49 offen offset:3072 sc1
buffer_load_dwordx4 a[76:79], v8, s[8:11], s54 offen offset:3072 sc1
s_add_u32 s54, s46, 20480
buffer_load_dwordx4 a[80:83], v8, s[8:11], s54 offen offset:0 sc1
buffer_load_dwordx4 a[84:87], v8, s[8:11], s54 offen offset:1024 sc1
buffer_load_dwordx4 a[88:91], v8, s[8:11], s54 offen offset:2048 sc1
buffer_load_dwordx4 a[92:95], v8, s[8:11], s54 offen offset:3072 sc1
s_add_u32 s48, s48, 262144
v_mov_b32 v15, s53
s_mov_b32 s45, s53
s_cmp_eq_u32 s51, 0
s_cbranch_scc1 att_nopre_254
s_waitcnt vmcnt(13)
v_add_u32 v13, 1, v13
v_cmp_gt_u32 vcc, v13, v24
s_nop 0
s_and_b32 vcc_lo, vcc_lo, 0x40
s_cselect_b32 s55, 0, 1
s_cbranch_scc1 att_nokm_256
buffer_load_dwordx4 v[64:67], v9, s[4:7], s47 offen offset:0 sc1
buffer_load_dwordx4 v[68:71], v9, s[4:7], s47 offen offset:512 sc1
buffer_load_dwordx4 v[72:75], v9, s[4:7], s47 offen offset:1024 sc1
buffer_load_dwordx4 v[76:79], v9, s[4:7], s47 offen offset:1536 sc1
buffer_load_dwordx2 v[80:81], v10, s[4:7], s47 offen offset:0 sc1
buffer_load_dwordx2 v[82:83], v10, s[4:7], s47 offen offset:512 sc1
buffer_load_dwordx2 v[84:85], v10, s[4:7], s47 offen offset:1024 sc1
buffer_load_dwordx2 v[86:87], v10, s[4:7], s47 offen offset:1536 sc1
s_waitcnt vmcnt(13)
buffer_store_dword v15, v23, s[4:7], s52 offen
buffer_store_dword v15, v22, s[4:7], s52 offen sc1
s_waitcnt vmcnt(10)
s_branch att_nokm_256_j
att_nokm_256:
s_waitcnt vmcnt(5)
buffer_store_dword v15, v23, s[4:7], s52 offen
buffer_store_dword v15, v22, s[4:7], s52 offen sc1
s_waitcnt vmcnt(2)
att_nokm_256_j:
v_mfma_f32_16x16x32_bf16 v[28:31], a[32:35], a[0:3], 0
v_mfma_f32_16x16x32_bf16 v[32:35], a[32:35], a[4:7], 0
v_mfma_f32_16x16x32_bf16 v[36:39], a[36:39], a[4:7], 0
v_mfma_f32_16x16x32_bf16 v[28:31], a[40:43], a[8:11], v[28:31]
v_mfma_f32_16x16x32_bf16 v[32:35], a[40:43], a[12:15], v[32:35]
v_mfma_f32_16x16x32_bf16 v[36:39], a[44:47], a[12:15], v[36:39]
v_mfma_f32_16x16x32_bf16 v[28:31], a[48:51], a[16:19], v[28:31]
v_mfma_f32_16x16x32_bf16 v[32:35], a[48:51], a[20:23], v[32:35]
v_mfma_f32_16x16x32_bf16 v[36:39], a[52:55], a[20:23], v[36:39]
v_mfma_f32_16x16x32_bf16 v[28:31], a[56:59], a[24:27], v[28:31]
v_mfma_f32_16x16x32_bf16 v[32:35], a[56:59], a[28:31], v[32:35]
v_mfma_f32_16x16x32_bf16 v[36:39], a[60:63], a[28:31], v[36:39]
s_add_u32 s53, s45, 1
v_add_u32 v13, s53, v20
s_nop 3
v_cndmask_b32 v28, v16, v28, s[56:57]
v_cndmask_b32 v29, v16, v29, s[58:59]
v_cndmask_b32 v30, v16, v30, s[60:61]
v_cndmask_b32 v31, v16, v31, s[62:63]
v_cndmask_b32 v36, v16, v36, s[56:57]
v_cndmask_b32 v37, v16, v37, s[58:59]
v_cndmask_b32 v38, v16, v38, s[60:61]
v_cndmask_b32 v39, v16, v39, s[62:63]
v_max3_f32 v18, v32, v33, v34
v_max3_f32 v17, v28, v29, v30
v_max3_f32 v18, v18, v35, v36
v_max_f32 v17, v17, v31
v_max3_f32 v18, v18, v37, v38
v_max_f32 v18, v18, v39
att_j2_255:
s_branch att_loop_238
att_nopre_247:
s_waitcnt vmcnt(0)
buffer_store_dword v15, v23, s[4:7], s52 offen
buffer_store_dword v15, v22, s[4:7], s52 offen sc1
s_cmp_ge_u32 s45, 64
s_cbranch_scc1 att_done_239
s_add_u32 s49, s45, 1
s_mov_b32 s98, 0
sp_loop_257:
buffer_load_dword v24, v11, s[4:7], s52 offen sc1
s_add_u32 s98, s98, 1
s_cmp_gt_u32 s98, 150000
s_cbranch_scc1 sp_bad_259
s_waitcnt vmcnt(0)
v_cmp_gt_u32 vcc, s49, v24
s_nop 0
s_and_b32 vcc_lo, vcc_lo, 0x3f
s_cbranch_scc0 sp_ok_258
s_sleep 2
s_branch sp_loop_257
sp_bad_259:
s_mov_b32 s98, 1536
s_branch L_fail
sp_ok_258:
s_add_u32 s54, s46, 0
buffer_load_dwordx4 a[96:99], v8, s[4:7], s54 offen offset:0 sc1
buffer_load_dwordx4 a[100:103], v8, s[4:7], s54 offen offset:1024 sc1
buffer_load_dwordx4 a[104:107], v8, s[4:7], s54 offen offset:2048 sc1
buffer_load_dwordx4 a[108:111], v8, s[4:7], s54 offen offset:3072 sc1
s_add_u32 s54, s46, 4096
buffer_load_dwordx4 a[112:115], v8, s[4:7], s54 offen offset:0 sc1
buffer_load_dwordx4 a[116:119], v8, s[4:7], s54 offen offset:1024 sc1
buffer_load_dwordx4 a[120:123], v8, s[4:7], s54 offen offset:2048 sc1
buffer_load_dwordx4 a[124:127], v8, s[4:7], s54 offen offset:3072 sc1
s_add_u32 s54, s46, 8192
buffer_load_dwordx4 a[128:131], v8, s[4:7], s54 offen offset:0 sc1
buffer_load_dwordx4 a[132:135], v8, s[4:7], s54 offen offset:1024 sc1
buffer_load_dwordx4 a[136:139], v8, s[4:7], s54 offen offset:2048 sc1
buffer_load_dwordx4 a[140:143], v8, s[4:7], s54 offen offset:3072 sc1
s_add_u32 s54, s46, 12288
buffer_load_dwordx4 a[144:147], v8, s[4:7], s54 offen offset:0 sc1
buffer_load_dwordx4 a[148:151], v8, s[4:7], s54 offen offset:1024 sc1
buffer_load_dwordx4 a[152:155], v8, s[4:7], s54 offen offset:2048 sc1
buffer_load_dwordx4 a[156:159], v8, s[4:7], s54 offen offset:3072 sc1
s_add_u32 s54, s46, 16384
buffer_load_dwordx4 a[160:163], v8, s[4:7], s54 offen offset:0 sc1
buffer_load_dwordx4 a[164:167], v8, s[4:7], s54 offen offset:1024 sc1
buffer_load_dwordx4 a[168:171], v8, s[4:7], s54 offen offset:2048 sc1
buffer_load_dwordx4 a[172:175], v8, s[4:7], s54 offen offset:3072 sc1
s_add_u32 s54, s46, 20480
buffer_load_dwordx4 a[176:179], v8, s[4:7], s54 offen offset:0 sc1
buffer_load_dwordx4 a[180:183], v8, s[4:7], s54 offen offset:1024 sc1
buffer_load_dwordx4 a[184:187], v8, s[4:7], s54 offen offset:2048 sc1
buffer_load_dwordx4 a[188:191], v8, s[4:7], s54 offen offset:3072 sc1
s_waitcnt vmcnt(0)
s_mov_b32 s55, 0
v_mfma_f32_16x16x32_bf16 v[28:31], a[128:131], a[96:99], 0
v_mfma_f32_16x16x32_bf16 v[32:35], a[128:131], a[100:103], 0
v_mfma_f32_16x16x32_bf16 v[36:39], a[132:135], a[100:103], 0
v_mfma_f32_16x16x32_bf16 v[28:31], a[136:139], a[104:107], v[28:31]
v_mfma_f32_16x16x32_bf16 v[32:35], a[136:139], a[108:111], v[32:35]
v_mfma_f32_16x16x32_bf16 v[36:39], a[140:143], a[108:111], v[36:39]
v_mfma_f32_16x16x32_bf16 v[28:31], a[144:147], a[112:115], v[28:31]
v_mfma_f32_16x16x32_bf16 v[32:35], a[144:147], a[116:119], v[32:35]
v_mfma_f32_16x16x32_bf16 v[36:39], a[148:151], a[116:119], v[36:39]
v_mfma_f32_16x16x32_bf16 v[28:31], a[152:155], a[120:123], v[28:31]
v_mfma_f32_16x16x32_bf16 v[32:35], a[152:155], a[124:127], v[32:35]
v_mfma_f32_16x16x32_bf16 v[36:39], a[156:159], a[124:127], v[36:39]
s_add_u32 s53, s45, 1
v_add_u32 v13, s53, v20
s_nop 3
v_cndmask_b32 v28, v16, v28, s[56:57]
v_cndmask_b32 v29, v16, v29, s[58:59]
v_cndmask_b32 v30, v16, v30, s[60:61]
v_cndmask_b32 v31, v16, v31, s[62:63]
v_cndmask_b32 v36, v16, v36, s[56:57]
v_cndmask_b32 v37, v16, v37, s[58:59]
v_cndmask_b32 v38, v16, v38, s[60:61]
v_cndmask_b32 v39, v16, v39, s[62:63]
v_max3_f32 v18, v32, v33, v34
v_max3_f32 v17, v28, v29, v30
v_max3_f32 v18, v18, v35, v36
v_max_f32 v17, v17, v31
v_max3_f32 v18, v18, v37, v38
v_max_f32 v18, v18, v39
s_branch att_j2_248
att_nopre_254:
s_waitcnt vmcnt(0)
buffer_store_dword v15, v23, s[4:7], s52 offen
buffer_store_dword v15, v22, s[4:7], s52 offen sc1
s_cmp_ge_u32 s45, 64
s_cbranch_scc1 att_done_239
s_add_u32 s49, s45, 1
s_mov_b32 s98, 0
sp_loop_260:
buffer_load_dword v24, v11, s[4:7], s52 offen sc1
s_add_u32 s98, s98, 1
s_cmp_gt_u32 s98, 150000
s_cbranch_scc1 sp_bad_262
s_waitcnt vmcnt(0)
v_cmp_gt_u32 vcc, s49, v24
s_nop 0
s_and_b32 vcc_lo, vcc_lo, 0x3f
s_cbranch_scc0 sp_ok_261
s_sleep 2
s_branch sp_loop_260
sp_bad_262:
s_mov_b32 s98, 1536
s_branch L_fail
sp_ok_261:
s_add_u32 s54, s46, 0
buffer_load_dwordx4 a[0:3], v8, s[4:7], s54 offen offset:0 sc1
buffer_load_dwordx4 a[4:7], v8, s[4:7], s54 offen offset:1024 sc1
buffer_load_dwordx4 a[8:11], v8, s[4:7], s54 offen offset:2048 sc1
buffer_load_dwordx4 a[12:15], v8, s[4:7], s54 offen offset:3072 sc1
s_add_u32 s54, s46, 4096
buffer_load_dwordx4 a[16:19], v8, s[4:7], s54 offen offset:0 sc1
buffer_load_dwordx4 a[20:23], v8, s[4:7], s54 offen offset:1024 sc1
buffer_load_dwordx4 a[24:27], v8, s[4:7], s54 offen offset:2048 sc1
buffer_load_dwordx4 a[28:31], v8, s[4:7], s54 offen offset:3072 sc1
s_add_u32 s54, s46, 8192
buffer_load_dwordx4 a[32:35], v8, s[4:7], s54 offen offset:0 sc1
buffer_load_dwordx4 a[36:39], v8, s[4:7], s54 offen offset:1024 sc1
buffer_load_dwordx4 a[40:43], v8, s[4:7], s54 offen offset:2048 sc1
buffer_load_dwordx4 a[44:47], v8, s[4:7], s54 offen offset:3072 sc1
s_add_u32 s54, s46, 12288
buffer_load_dwordx4 a[48:51], v8, s[4:7], s54 offen offset:0 sc1
buffer_load_dwordx4 a[52:55], v8, s[4:7], s54 offen offset:1024 sc1
buffer_load_dwordx4 a[56:59], v8, s[4:7], s54 offen offset:2048 sc1
buffer_load_dwordx4 a[60:63], v8, s[4:7], s54 offen offset:3072 sc1
s_add_u32 s54, s46, 16384
buffer_load_dwordx4 a[64:67], v8, s[4:7], s54 offen offset:0 sc1
buffer_load_dwordx4 a[68:71], v8, s[4:7], s54 offen offset:1024 sc1
buffer_load_dwordx4 a[72:75], v8, s[4:7], s54 offen offset:2048 sc1
buffer_load_dwordx4 a[76:79], v8, s[4:7], s54 offen offset:3072 sc1
s_add_u32 s54, s46, 20480
buffer_load_dwordx4 a[80:83], v8, s[4:7], s54 offen offset:0 sc1
buffer_load_dwordx4 a[84:87], v8, s[4:7], s54 offen offset:1024 sc1
buffer_load_dwordx4 a[88:91], v8, s[4:7], s54 offen offset:2048 sc1
buffer_load_dwordx4 a[92:95], v8, s[4:7], s54 offen offset:3072 sc1
s_waitcnt vmcnt(0)
s_mov_b32 s55, 0
v_mfma_f32_16x16x32_bf16 v[28:31], a[32:35], a[0:3], 0
v_mfma_f32_16x16x32_bf16 v[32:35], a[32:35], a[4:7], 0
v_mfma_f32_16x16x32_bf16 v[36:39], a[36:39], a[4:7], 0
v_mfma_f32_16x16x32_bf16 v[28:31], a[40:43], a[8:11], v[28:31]
v_mfma_f32_16x16x32_bf16 v[32:35], a[40:43], a[12:15], v[32:35]
v_mfma_f32_16x16x32_bf16 v[36:39], a[44:47], a[12:15], v[36:39]
v_mfma_f32_16x16x32_bf16 v[28:31], a[48:51], a[16:19], v[28:31]
v_mfma_f32_16x16x32_bf16 v[32:35], a[48:51], a[20:23], v[32:35]
v_mfma_f32_16x16x32_bf16 v[36:39], a[52:55], a[20:23], v[36:39]
v_mfma_f32_16x16x32_bf16 v[28:31], a[56:59], a[24:27], v[28:31]
v_mfma_f32_16x16x32_bf16 v[32:35], a[56:59], a[28:31], v[32:35]
v_mfma_f32_16x16x32_bf16 v[36:39], a[60:63], a[28:31], v[36:39]
s_add_u32 s53, s45, 1
v_add_u32 v13, s53, v20
s_nop 3
v_cndmask_b32 v28, v16, v28, s[56:57]
v_cndmask_b32 v29, v16, v29, s[58:59]
v_cndmask_b32 v30, v16, v30, s[60:61]
v_cndmask_b32 v31, v16, v31, s[62:63]
v_cndmask_b32 v36, v16, v36, s[56:57]
v_cndmask_b32 v37, v16, v37, s[58:59]
v_cndmask_b32 v38, v16, v38, s[60:61]
v_cndmask_b32 v39, v16, v39, s[62:63]
v_max3_f32 v18, v32, v33, v34
v_max3_f32 v17, v28, v29, v30
v_max3_f32 v18, v18, v35, v36
v_max_f32 v17, v17, v31
v_max3_f32 v18, v18, v37, v38
v_max_f32 v18, v18, v39
s_branch att_j2_255
att_done_239:
s_endpgm
H_red:
s_mov_b32 s44, s74
s_cmp_lg_u32 s44, 0
s_cbranch_scc1 nozero_263
s_lshl_b32 s46, s3, 15
s_add_u32 s46, s46, 0
v_lshlrev_b32 v2, 4, v0
v_mov_b64 v[4:5], 0
v_mov_b64 v[6:7], 0
buffer_store_dwordx4 v[4:7], v2, s[4:7], s46 offen offset:0 sc1
buffer_store_dwordx4 v[4:7], v2, s[4:7], s46 offen offset:1024 sc1
buffer_store_dwordx4 v[4:7], v2, s[4:7], s46 offen offset:2048 sc1
buffer_store_dwordx4 v[4:7], v2, s[4:7], s46 offen offset:3072 sc1
s_add_u32 s46, s46, 4096
buffer_store_dwordx4 v[4:7], v2, s[4:7], s46 offen offset:0 sc1
buffer_store_dwordx4 v[4:7], v2, s[4:7], s46 offen offset:1024 sc1
buffer_store_dwordx4 v[4:7], v2, s[4:7], s46 offen offset:2048 sc1
buffer_store_dwordx4 v[4:7], v2, s[4:7], s46 offen offset:3072 sc1
s_add_u32 s46, s46, 4096
buffer_store_dwordx4 v[4:7], v2, s[4:7], s46 offen offset:0 sc1
buffer_store_dwordx4 v[4:7], v2, s[4:7], s46 offen offset:1024 sc1
buffer_store_dwordx4 v[4:7], v2, s[4:7], s46 offen offset:2048 sc1
buffer_store_dwordx4 v[4:7], v2, s[4:7], s46 offen offset:3072 sc1
s_add_u32 s46, s46, 4096
buffer_store_dwordx4 v[4:7], v2, s[4:7], s46 offen offset:0 sc1
buffer_store_dwordx4 v[4:7], v2, s[4:7], s46 offen offset:1024 sc1
buffer_store_dwordx4 v[4:7], v2, s[4:7], s46 offen offset:2048 sc1
buffer_store_dwordx4 v[4:7], v2, s[4:7], s46 offen offset:3072 sc1
s_add_u32 s46, s46, 4096
buffer_store_dwordx4 v[4:7], v2, s[4:7], s46 offen offset:0 sc1
buffer_store_dwordx4 v[4:7], v2, s[4:7], s46 offen offset:1024 sc1
buffer_store_dwordx4 v[4:7], v2, s[4:7], s46 offen offset:2048 sc1
buffer_store_dwordx4 v[4:7], v2, s[4:7], s46 offen offset:3072 sc1
s_add_u32 s46, s46, 4096
buffer_store_dwordx4 v[4:7], v2, s[4:7], s46 offen offset:0 sc1
buffer_store_dwordx4 v[4:7], v2, s[4:7], s46 offen offset:1024 sc1
buffer_store_dwordx4 v[4:7], v2, s[4:7], s46 offen offset:2048 sc1
buffer_store_dwordx4 v[4:7], v2, s[4:7], s46 offen offset:3072 sc1
s_add_u32 s46, s46, 4096
buffer_store_dwordx4 v[4:7], v2, s[4:7], s46 offen offset:0 sc1
buffer_store_dwordx4 v[4:7], v2, s[4:7], s46 offen offset:1024 sc1
buffer_store_dwordx4 v[4:7], v2, s[4:7], s46 offen offset:2048 sc1
buffer_store_dwordx4 v[4:7], v2, s[4:7], s46 offen offset:3072 sc1
s_add_u32 s46, s46, 4096
buffer_store_dwordx4 v[4:7], v2, s[4:7], s46 offen offset:0 sc1
buffer_store_dwordx4 v[4:7], v2, s[4:7], s46 offen offset:1024 sc1
buffer_store_dwordx4 v[4:7], v2, s[4:7], s46 offen offset:2048 sc1
buffer_store_dwordx4 v[4:7], v2, s[4:7], s46 offen offset:3072 sc1
s_add_u32 s46, s46, 4096
s_waitcnt vmcnt(0)
s_barrier
s_cmp_lg_u32 s3, 0
s_cbranch_scc1 nozero_263
s_mov_b32 s12, s40
s_and_b32 s13, s41, 0xffff
s_mov_b32 s14, 256
s_mov_b32 s15, 0x20000
v_mov_b32 v2, 32
v_mov_b32 v3, 192
s_mov_b64 exec, 1
buffer_store_dword v2, v3, s[12:15], 0 offen sc1
s_mov_b64 exec, -1
nozero_263:
v_and_b32 v1, 15, v0
v_lshrrev_b32 v2, 4, v0
v_and_b32 v3, 1, v0
v_bfe_u32 v4, v0, 1, 3
v_bfe_u32 v5, v0, 4, 1
v_lshrrev_b32 v6, 5, v0
s_mul_i32 s46, s44, 2304
v_mul_u32_u24 v7, 36864, v2
v_lshl_add_u32 v7, v1, 4, v7
v_add_u32 v8, s46, v7
v_lshlrev_b32 v7, 9, v5
v_lshl_add_u32 v7, v6, 8, v7
v_lshl_add_u32 v7, v1, 4, v7
v_add_u32 v10, s46, v7
v_lshlrev_b32 v7, 4, v1
v_lshl_add_u32 v7, v5, 3, v7
v_add_u32 v11, s46, v7
v_mul_u32_u24 v7, 1152, v3
v_lshl_add_u32 v7, v4, 4, v7
v_add_u32 v7, s46, v7
v_lshl_add_u32 v13, v5, 3, v7
v_lshl_add_u32 v9, v6, 7, v13
v_lshl_add_u32 v7, v6, 7, v7
v_lshl_add_u32 v12, v5, 8, v7
v_lshlrev_b32 v7, 4, v3
v_mov_b32 v22, 0x3f80
v_lshlrev_b32 v7, v7, v22
v_cmp_eq_u32 vcc, 0, v4
s_nop 1
v_cndmask_b32 v28, 0, v7, vcc
v_cmp_eq_u32 vcc, 1, v4
s_nop 1
v_cndmask_b32 v29, 0, v7, vcc
v_cmp_eq_u32 vcc, 2, v4
s_nop 1
v_cndmask_b32 v30, 0, v7, vcc
v_cmp_eq_u32 vcc, 3, v4
s_nop 1
v_cndmask_b32 v31, 0, v7, vcc
v_cmp_eq_u32 vcc, 4, v4
s_nop 1
v_cndmask_b32 v32, 0, v7, vcc
v_cmp_eq_u32 vcc, 5, v4
s_nop 1
v_cndmask_b32 v33, 0, v7, vcc
v_cmp_eq_u32 vcc, 6, v4
s_nop 1
v_cndmask_b32 v34, 0, v7, vcc
v_cmp_eq_u32 vcc, 7, v4
s_nop 1
v_cndmask_b32 v35, 0, v7, vcc
s_mul_i32 s46, s44, 128
v_mov_b32 v1, s46
v_mov_b32 v22, 2147483632
v_cmp_eq_u32 vcc, 0, v0
s_nop 1
v_cndmask_b32 v36, v22, v1, vcc
v_add_u32 v37, 65536, v36
v_lshlrev_b32 v1, 2, v0
v_add_u32 v1, 147456, v1
v_mov_b32 v2, 0
ds_write_b32 v1, v2
v_mov_b32 v14, 147460
s_mov_b32 s8, s20
s_and_b32 s9, s21, 0xffff
s_mov_b32 s10, 2359296
s_mov_b32 s11, 0x20000
s_mov_b32 s16, s38
s_and_b32 s17, s39, 0xffff
s_mov_b32 s18, 2359296
s_mov_b32 s19, 0x20000
s_mov_b32 s45, s3
s_mov_b32 s52, 1368064
s_mov_b32 s50, 0
s_mul_i32 s47, s45, 36864
buffer_load_dwordx2 v[60:61], v9, s[8:11], s47 offen offset:0
buffer_load_dwordx2 v[62:63], v9, s[8:11], s47 offen offset:256
buffer_load_dwordx2 v[64:65], v9, s[8:11], s47 offen offset:512
buffer_load_dwordx2 v[66:67], v9, s[8:11], s47 offen offset:768
v_mov_b64 v[68:69], 0
s_mov_b64 exec, 0xffffffff
buffer_load_dwordx2 v[68:69], v9, s[8:11], s47 offen offset:1024
s_mov_b64 exec, -1
s_waitcnt lgkmcnt(0)
s_barrier
s_mov_b32 s12, s40
s_and_b32 s13, s41, 0xffff
s_mov_b32 s14, 256
s_mov_b32 s15, 0x20000
v_lshlrev_b32 v17, 2, v0
v_add_u32 v18, 128, v17
v_cmp_le_u32 vcc, 2, v0
s_nop 1
v_cndmask_b32 v17, v17, v18, vcc
v_mov_b32 v18, 192
v_cmp_eq_u32 vcc, 8, v0
s_nop 1
v_cndmask_b32 v17, v17, v18, vcc
v_mov_b32 v18, 2147483632
v_cmp_lt_u32 vcc, 8, v0
s_nop 1
v_cndmask_b32 v17, v17, v18, vcc
s_mov_b32 s98, 0
wi_loop_264:
buffer_load_dword v18, v17, s[12:15], 0 offen sc1
s_add_u32 s98, s98, 1
s_cmp_gt_u32 s98, 150000
s_cbranch_scc1 wi_bad_266
s_waitcnt vmcnt(0)
v_cmp_eq_u32 vcc, 32, v18
s_nop 0
s_and_b32 s97, vcc_lo, 0x1ff
s_cmp_eq_u32 s97, 0x1ff
s_cbranch_scc1 wi_ok_265
v_cmp_lt_u32 vcc, 32, v18
s_nop 0
s_and_b32 s96, vcc_lo, 0xff
s_cselect_b32 s96, 0x100, 0
s_and_b32 s96, s96, s97
s_cbranch_scc1 wi_over_267
s_sleep 8
s_branch wi_loop_264
wi_bad_266:
s_mov_b32 s98, 512
s_branch L_fail
wi_over_267:
s_mov_b32 s100, 255
wi_ok_265:
ln0_268:
v_lshlrev_b32 v40, 16, v60
v_and_b32 v41, 0xffff0000, v60
v_lshlrev_b32 v42, 16, v61
v_and_b32 v43, 0xffff0000, v61
v_lshlrev_b32 v44, 16, v62
v_and_b32 v45, 0xffff0000, v62
v_lshlrev_b32 v46, 16, v63
v_and_b32 v47, 0xffff0000, v63
v_lshlrev_b32 v48, 16, v64
v_and_b32 v49, 0xffff0000, v64
v_lshlrev_b32 v50, 16, v65
v_and_b32 v51, 0xffff0000, v65
v_lshlrev_b32 v52, 16, v66
v_and_b32 v53, 0xffff0000, v66
v_lshlrev_b32 v54, 16, v67
v_and_b32 v55, 0xffff0000, v67
v_lshlrev_b32 v56, 16, v68
v_and_b32 v57, 0xffff0000, v68
v_lshlrev_b32 v58, 16, v69
v_and_b32 v59, 0xffff0000, v69
v_mul_f32 v20, v40, v40
v_add_f32 v19, v40, v41
v_fmac_f32 v20, v41, v41
v_add_f32 v19, v19, v42
v_fmac_f32 v20, v42, v42
v_add_f32 v19, v19, v43
v_fmac_f32 v20, v43, v43
v_add_f32 v19, v19, v44
v_fmac_f32 v20, v44, v44
v_add_f32 v19, v19, v45
v_fmac_f32 v20, v45, v45
v_add_f32 v19, v19, v46
v_fmac_f32 v20, v46, v46
v_add_f32 v19, v19, v47
v_fmac_f32 v20, v47, v47
v_add_f32 v19, v19, v48
v_fmac_f32 v20, v48, v48
v_add_f32 v19, v19, v49
v_fmac_f32 v20, v49, v49
v_add_f32 v19, v19, v50
v_fmac_f32 v20, v50, v50
v_add_f32 v19, v19, v51
v_fmac_f32 v20, v51, v51
v_add_f32 v19, v19, v52
v_fmac_f32 v20, v52, v52
v_add_f32 v19, v19, v53
v_fmac_f32 v20, v53, v53
v_add_f32 v19, v19, v54
v_fmac_f32 v20, v54, v54
v_add_f32 v19, v19, v55
v_fmac_f32 v20, v55, v55
v_add_f32 v19, v19, v56
v_fmac_f32 v20, v56, v56
v_add_f32 v19, v19, v57
v_fmac_f32 v20, v57, v57
v_add_f32 v19, v19, v58
v_fmac_f32 v20, v58, v58
v_add_f32 v19, v19, v59
v_fmac_f32 v20, v59, v59
s_mul_i32 s47, s45, 36864
s_add_u32 s47, s47, s52
v_permlane32_swap_b32 v19, v20
v_add_f32 v19, v19, v20
v_mov_b32 v21, v19
s_nop 1
v_permlane16_swap_b32 v19, v21
v_add_f32 v19, v19, v21
s_nop 1
v_add_f32_dpp v19, v19, v19 quad_perm:[2,3,0,1] row_mask:0xf bank_mask:0xf
s_nop 1
v_add_f32_dpp v19, v19, v19 row_ror:4 row_mask:0xf bank_mask:0xf
s_nop 1
v_add_f32_dpp v19, v19, v19 row_ror:8 row_mask:0xf bank_mask:0xf
v_mul_f32 v19, 0x3ae38e39, v19
v_mov_b32 v20, v19
s_nop 1
v_permlane32_swap_b32 v19, v20
v_fma_f32 v20, -v19, v19, v20
v_max_f32 v20, 0, v20
v_add_f32 v20, 0x3727c5ac, v20
v_rsq_f32 v20, v20
s_nop 0
v_mul_f32 v19, v19, v20
v_fma_f32 v40, v40, v20, -v19
v_fma_f32 v41, v41, v20, -v19
v_fma_f32 v42, v42, v20, -v19
v_fma_f32 v43, v43, v20, -v19
v_fma_f32 v44, v44, v20, -v19
v_fma_f32 v45, v45, v20, -v19
v_fma_f32 v46, v46, v20, -v19
v_fma_f32 v47, v47, v20, -v19
v_fma_f32 v48, v48, v20, -v19
v_fma_f32 v49, v49, v20, -v19
v_fma_f32 v50, v50, v20, -v19
v_fma_f32 v51, v51, v20, -v19
v_fma_f32 v52, v52, v20, -v19
v_fma_f32 v53, v53, v20, -v19
v_fma_f32 v54, v54, v20, -v19
v_fma_f32 v55, v55, v20, -v19
v_fma_f32 v56, v56, v20, -v19
v_fma_f32 v57, v57, v20, -v19
v_fma_f32 v58, v58, v20, -v19
v_fma_f32 v59, v59, v20, -v19
v_cvt_pk_bf16_f32 v72, v40, v41
v_cvt_pk_bf16_f32 v74, v44, v45
v_cvt_pk_bf16_f32 v73, v42, v43
v_cvt_pk_bf16_f32 v75, v46, v47
v_permlane16_swap_b32 v72, v74
s_nop 0
v_permlane16_swap_b32 v73, v75
buffer_store_dwordx4 v[72:75], v10, s[4:7], s47 offen offset:0 sc1
v_cvt_pk_bf16_f32 v76, v48, v49
v_cvt_pk_bf16_f32 v78, v52, v53
v_cvt_pk_bf16_f32 v77, v50, v51
v_cvt_pk_bf16_f32 v79, v54, v55
v_permlane16_swap_b32 v76, v78
s_nop 0
v_permlane16_swap_b32 v77, v79
buffer_store_dwordx4 v[76:79], v10, s[4:7], s47 offen offset:1024 sc1
v_cvt_pk_bf16_f32 v80, v56, v57
v_cvt_pk_bf16_f32 v81, v58, v59
s_mov_b64 exec, 0xffffffff
buffer_store_dwordx2 v[80:81], v11, s[4:7], s47 offen offset:2048 sc1
s_mov_b64 exec, -1
s_add_u32 s45, s45, 4
s_cmp_ge_u32 s45, 64
s_cbranch_scc1 ln0_done_269
s_mul_i32 s47, s45, 36864
buffer_load_dwordx2 v[60:61], v9, s[8:11], s47 offen offset:0
buffer_load_dwordx2 v[62:63], v9, s[8:11], s47 offen offset:256
buffer_load_dwordx2 v[64:65], v9, s[8:11], s47 offen offset:512
buffer_load_dwordx2 v[66:67], v9, s[8:11], s47 offen offset:768
v_mov_b64 v[68:69], 0
s_mov_b64 exec, 0xffffffff
buffer_load_dwordx2 v[68:69], v9, s[8:11], s47 offen offset:1024
s_mov_b64 exec, -1
s_waitcnt vmcnt(0)
v_mov_b32 v17, 1
s_mov_b64 exec, 1
ds_add_rtn_u32 v17, v14, v17
s_mov_b64 exec, -1
s_andn2_b32 s48, s45, 3
s_waitcnt lgkmcnt(0)
v_readfirstlane_b32 s47, v17
v_mov_b32 v18, s48
s_and_b32 s47, s47, 3
s_cmp_lg_u32 s47, 3
s_cbranch_scc1 nolast_270
buffer_store_dword v18, v36, s[4:7], s50 offen sc1
buffer_store_dword v18, v37, s[4:7], s50 offen
nolast_270:
v_add_u32 v14, 4, v14
s_branch ln0_268
ln0_done_269:
s_waitcnt vmcnt(0)
v_mov_b32 v17, 1
s_mov_b64 exec, 1
ds_add_rtn_u32 v17, v14, v17
s_mov_b64 exec, -1
s_andn2_b32 s48, s45, 3
s_waitcnt lgkmcnt(0)
v_readfirstlane_b32 s47, v17
v_mov_b32 v18, s48
s_and_b32 s47, s47, 3
s_cmp_lg_u32 s47, 3
s_cbranch_scc1 nolast_271
buffer_store_dword v18, v36, s[4:7], s50 offen sc1
buffer_store_dword v18, v37, s[4:7], s50 offen
nolast_271:
v_add_u32 v14, 4, v14
s_mov_b32 s99, 100
s_and_b32 s47, s3, 1
s_mul_i32 s51, s47, 18874368
s_add_u32 s51, s51, 199548928
s_mul_i32 s47, s47, 11264
s_add_u32 s47, s47, 18432
v_mul_u32_u24 v1, 128, v0
v_add_u32 v1, s47, v1
v_mov_b32 v7, 2147483632
v_cmp_gt_u32 vcc, 24, v0
s_nop 1
v_cndmask_b32 v15, v7, v1, vcc
s_getpc_b64 s[96:97]
pc_272:
s_add_u32 s96, s96, L_writers-pc_272
s_addc_u32 s97, s97, 0
v_subrev_u32 v2, 0, v15
v_lshrrev_b32 v2, 7, v2
v_cmp_gt_u32 vcc, 0x200, v2
s_nop 1
v_cndmask_b32 v2, 0, v2, vcc
global_load_ubyte v2, v2, s[96:97]
s_waitcnt vmcnt(0)
v_add_u32 v3, 65536, v15
v_cmp_eq_u32 vcc, s100, v2
s_nop 1
v_cndmask_b32 v15, v15, v3, vcc
s_lshr_b32 s47, s3, 1
s_mul_i32 s49, s47, 32768
s_mov_b32 s52, 6086656
s_mov_b32 s50, 21504
s_cmp_eq_u32 s3, 1
s_cselect_b32 s52, 3727360, s52
s_cselect_b32 s50, 32768, s50
s_cmp_eq_u32 s3, 2
s_cselect_b32 s52, 8445952, s52
s_cselect_b32 s50, 54272, s50
s_mov_b32 s45, 0
s_cmp_eq_u32 s3, 3
s_cbranch_scc1 red_fin_274
s_cmp_lg_u32 s3, 0
s_cbranch_scc1 red_mid_273
red_loop_275:
s_and_b32 s47, s45, 31
s_mul_i32 s47, s47, 4608
v_lshlrev_b32 v14, 4, v0
v_add_u32 v14, s47, v14
s_add_u32 s48, s45, 1
s_mul_i32 s47, s45, 36864
buffer_load_dwordx2 v[60:61], v9, s[8:11], s47 offen offset:0
buffer_load_dwordx2 v[62:63], v9, s[8:11], s47 offen offset:256
buffer_load_dwordx2 v[64:65], v9, s[8:11], s47 offen offset:512
buffer_load_dwordx2 v[66:67], v9, s[8:11], s47 offen offset:768
v_mov_b64 v[68:69], 0
s_mov_b64 exec, 0xffffffff
buffer_load_dwordx2 v[68:69], v9, s[8:11], s47 offen offset:1024
s_mov_b64 exec, -1
v_mov_b32 v1, 147456
s_mov_b32 s98, 0
grd_276:
ds_read_b32 v2, v1
s_add_u32 s98, s98, 1
s_cmp_gt_u32 s98, 600000
s_cbranch_scc1 grd_bad_278
s_waitcnt lgkmcnt(0)
v_readfirstlane_b32 s47, v2
s_nop 0
s_add_u32 s47, s47, 32
s_cmp_gt_u32 s47, s45
s_cbranch_scc1 grd_ok_277
s_sleep 2
s_branch grd_276
grd_bad_278:
s_mov_b32 s98, 1280
s_branch L_fail
grd_ok_277:
s_mov_b32 s98, 0
sp_loop_279:
buffer_load_dword v24, v15, s[4:7], s49 offen sc1
s_add_u32 s98, s98, 1
s_cmp_gt_u32 s98, 150000
s_cbranch_scc1 sp_bad_281
s_waitcnt vmcnt(0)
v_cmp_gt_u32 vcc, s48, v24
s_nop 0
s_and_b32 vcc_lo, vcc_lo, 0xffffff
s_cbranch_scc0 sp_ok_280
s_sleep 2
s_branch sp_loop_279
sp_bad_281:
s_mov_b32 s98, 1281
s_branch L_fail
sp_ok_280:
s_mul_i32 s47, s45, 294912
s_add_u32 s47, s47, s51
s_add_u32 s46, s47, 147456
buffer_load_dwordx4 v[96:99], v8, s[4:7], s47 offen offset:0 sc1
buffer_load_dwordx4 v[100:103], v8, s[4:7], s46 offen offset:0 sc1
buffer_load_dwordx4 v[104:107], v8, s[4:7], s47 offen offset:256 sc1
buffer_load_dwordx4 v[108:111], v8, s[4:7], s46 offen offset:256 sc1
buffer_load_dwordx4 v[112:115], v8, s[4:7], s47 offen offset:512 sc1
buffer_load_dwordx4 v[116:119], v8, s[4:7], s46 offen offset:512 sc1
buffer_load_dwordx4 v[120:123], v8, s[4:7], s47 offen offset:768 sc1
buffer_load_dwordx4 v[124:127], v8, s[4:7], s46 offen offset:768 sc1
buffer_load_dwordx4 v[128:131], v8, s[4:7], s47 offen offset:1024 sc1
buffer_load_dwordx4 v[132:135], v8, s[4:7], s46 offen offset:1024 sc1
buffer_load_dwordx4 v[136:139], v8, s[4:7], s47 offen offset:1280 sc1
buffer_load_dwordx4 v[140:143], v8, s[4:7], s46 offen offset:1280 sc1
buffer_load_dwordx4 v[144:147], v8, s[4:7], s47 offen offset:1536 sc1
buffer_load_dwordx4 v[148:151], v8, s[4:7], s46 offen offset:1536 sc1
buffer_load_dwordx4 v[152:155], v8, s[4:7], s47 offen offset:1792 sc1
buffer_load_dwordx4 v[156:159], v8, s[4:7], s46 offen offset:1792 sc1
buffer_load_dwordx4 v[160:163], v8, s[4:7], s47 offen offset:2048 sc1
buffer_load_dwordx4 v[164:167], v8, s[4:7], s46 offen offset:2048 sc1
v_lshlrev_b32 v40, 16, v60
v_and_b32 v41, 0xffff0000, v60
v_lshlrev_b32 v42, 16, v61
v_and_b32 v43, 0xffff0000, v61
v_lshlrev_b32 v44, 16, v62
v_and_b32 v45, 0xffff0000, v62
v_lshlrev_b32 v46, 16, v63
v_and_b32 v47, 0xffff0000, v63
v_lshlrev_b32 v48, 16, v64
v_and_b32 v49, 0xffff0000, v64
v_lshlrev_b32 v50, 16, v65
v_and_b32 v51, 0xffff0000, v65
v_lshlrev_b32 v52, 16, v66
v_and_b32 v53, 0xffff0000, v66
v_lshlrev_b32 v54, 16, v67
v_and_b32 v55, 0xffff0000, v67
v_lshlrev_b32 v56, 16, v68
v_and_b32 v57, 0xffff0000, v68
v_lshlrev_b32 v58, 16, v69
v_and_b32 v59, 0xffff0000, v69
s_waitcnt vmcnt(17)
v_mfma_f32_16x16x32_bf16 v[40:43], v[28:31], v[96:99], v[40:43]
s_waitcnt vmcnt(16)
v_mfma_f32_16x16x32_bf16 v[40:43], v[28:31], v[100:103], v[40:43]
s_waitcnt vmcnt(15)
v_mfma_f32_16x16x32_bf16 v[40:43], v[32:35], v[104:107], v[40:43]
s_waitcnt vmcnt(14)
v_mfma_f32_16x16x32_bf16 v[40:43], v[32:35], v[108:111], v[40:43]
s_waitcnt vmcnt(13)
v_mfma_f32_16x16x32_bf16 v[44:47], v[28:31], v[112:115], v[44:47]
s_waitcnt vmcnt(12)
v_mfma_f32_16x16x32_bf16 v[44:47], v[28:31], v[116:119], v[44:47]
s_nop 3
ds_write_b128 v14, v[40:43] offset:0
v_mul_f32 v20, v40, v40
v_add_f32 v19, v40, v41
v_fmac_f32 v20, v41, v41
v_add_f32 v19, v19, v42
v_fmac_f32 v20, v42, v42
v_add_f32 v19, v19, v43
v_fmac_f32 v20, v43, v43
s_waitcnt vmcnt(11)
v_mfma_f32_16x16x32_bf16 v[44:47], v[32:35], v[120:123], v[44:47]
s_waitcnt vmcnt(10)
v_mfma_f32_16x16x32_bf16 v[44:47], v[32:35], v[124:127], v[44:47]
s_waitcnt vmcnt(9)
v_mfma_f32_16x16x32_bf16 v[48:51], v[28:31], v[128:131], v[48:51]
s_waitcnt vmcnt(8)
v_mfma_f32_16x16x32_bf16 v[48:51], v[28:31], v[132:135], v[48:51]
s_nop 3
ds_write_b128 v14, v[44:47] offset:1024
v_add_f32 v19, v19, v44
v_fmac_f32 v20, v44, v44
v_add_f32 v19, v19, v45
v_fmac_f32 v20, v45, v45
v_add_f32 v19, v19, v46
v_fmac_f32 v20, v46, v46
v_add_f32 v19, v19, v47
v_fmac_f32 v20, v47, v47
s_waitcnt vmcnt(7)
v_mfma_f32_16x16x32_bf16 v[48:51], v[32:35], v[136:139], v[48:51]
s_waitcnt vmcnt(6)
v_mfma_f32_16x16x32_bf16 v[48:51], v[32:35], v[140:143], v[48:51]
s_waitcnt vmcnt(5)
v_mfma_f32_16x16x32_bf16 v[52:55], v[28:31], v[144:147], v[52:55]
s_waitcnt vmcnt(4)
v_mfma_f32_16x16x32_bf16 v[52:55], v[28:31], v[148:151], v[52:55]
s_nop 3
ds_write_b128 v14, v[48:51] offset:2048
v_add_f32 v19, v19, v48
v_fmac_f32 v20, v48, v48
v_add_f32 v19, v19, v49
v_fmac_f32 v20, v49, v49
v_add_f32 v19, v19, v50
v_fmac_f32 v20, v50, v50
v_add_f32 v19, v19, v51
v_fmac_f32 v20, v51, v51
s_waitcnt vmcnt(3)
v_mfma_f32_16x16x32_bf16 v[52:55], v[32:35], v[152:155], v[52:55]
s_waitcnt vmcnt(2)
v_mfma_f32_16x16x32_bf16 v[52:55], v[32:35], v[156:159], v[52:55]
s_waitcnt vmcnt(1)
v_mfma_f32_16x16x32_bf16 v[56:59], v[28:31], v[160:163], v[56:59]
s_waitcnt vmcnt(0)
v_mfma_f32_16x16x32_bf16 v[56:59], v[28:31], v[164:167], v[56:59]
s_nop 3
ds_write_b128 v14, v[52:55] offset:3072
v_add_f32 v19, v19, v52
v_fmac_f32 v20, v52, v52
v_add_f32 v19, v19, v53
v_fmac_f32 v20, v53, v53
v_add_f32 v19, v19, v54
v_fmac_f32 v20, v54, v54
v_add_f32 v19, v19, v55
v_fmac_f32 v20, v55, v55
s_mov_b64 exec, 0xffffffff
ds_write_b128 v14, v[56:59] offset:4096
s_mov_b64 exec, -1
v_add_f32 v19, v19, v56
v_fmac_f32 v20, v56, v56
v_add_f32 v19, v19, v57
v_fmac_f32 v20, v57, v57
v_add_f32 v19, v19, v58
v_fmac_f32 v20, v58, v58
v_add_f32 v19, v19, v59
v_fmac_f32 v20, v59, v59
s_mul_i32 s47, s45, 36864
s_add_u32 s47, s47, s52
v_permlane32_swap_b32 v19, v20
v_add_f32 v19, v19, v20
v_mov_b32 v21, v19
s_nop 1
v_permlane16_swap_b32 v19, v21
v_add_f32 v19, v19, v21
s_nop 1
v_add_f32_dpp v19, v19, v19 quad_perm:[2,3,0,1] row_mask:0xf bank_mask:0xf
s_nop 1
v_add_f32_dpp v19, v19, v19 row_ror:4 row_mask:0xf bank_mask:0xf
s_nop 1
v_add_f32_dpp v19, v19, v19 row_ror:8 row_mask:0xf bank_mask:0xf
v_mul_f32 v19, 0x3ae38e39, v19
v_mov_b32 v20, v19
s_nop 1
v_permlane32_swap_b32 v19, v20
v_fma_f32 v20, -v19, v19, v20
v_max_f32 v20, 0, v20
v_add_f32 v20, 0x3727c5ac, v20
v_rsq_f32 v20, v20
s_nop 0
v_mul_f32 v19, v19, v20
v_fma_f32 v40, v40, v20, -v19
v_fma_f32 v41, v41, v20, -v19
v_fma_f32 v42, v42, v20, -v19
v_fma_f32 v43, v43, v20, -v19
v_fma_f32 v44, v44, v20, -v19
v_fma_f32 v45, v45, v20, -v19
v_fma_f32 v46, v46, v20, -v19
v_fma_f32 v47, v47, v20, -v19
v_fma_f32 v48, v48, v20, -v19
v_fma_f32 v49, v49, v20, -v19
v_fma_f32 v50, v50, v20, -v19
v_fma_f32 v51, v51, v20, -v19
v_fma_f32 v52, v52, v20, -v19
v_fma_f32 v53, v53, v20, -v19
v_fma_f32 v54, v54, v20, -v19
v_fma_f32 v55, v55, v20, -v19
v_fma_f32 v56, v56, v20, -v19
v_fma_f32 v57, v57, v20, -v19
v_fma_f32 v58, v58, v20, -v19
v_fma_f32 v59, v59, v20, -v19
v_cvt_pk_bf16_f32 v72, v40, v41
v_cvt_pk_bf16_f32 v74, v44, v45
v_cvt_pk_bf16_f32 v73, v42, v43
v_cvt_pk_bf16_f32 v75, v46, v47
v_permlane16_swap_b32 v72, v74
s_nop 0
v_permlane16_swap_b32 v73, v75
buffer_store_dwordx4 v[72:75], v10, s[4:7], s47 offen offset:0 sc1
v_cvt_pk_bf16_f32 v76, v48, v49
v_cvt_pk_bf16_f32 v78, v52, v53
v_cvt_pk_bf16_f32 v77, v50, v51
v_cvt_pk_bf16_f32 v79, v54, v55
v_permlane16_swap_b32 v76, v78
s_nop 0
v_permlane16_swap_b32 v77, v79
buffer_store_dwordx4 v[76:79], v10, s[4:7], s47 offen offset:1024 sc1
v_cvt_pk_bf16_f32 v80, v56, v57
v_cvt_pk_bf16_f32 v81, v58, v59
s_mov_b64 exec, 0xffffffff
buffer_store_dwordx2 v[80:81], v11, s[4:7], s47 offen offset:2048 sc1
s_mov_b64 exec, -1
s_waitcnt vmcnt(0) lgkmcnt(0)
v_mov_b32 v18, s48
buffer_store_dword v18, v36, s[4:7], s50 offen sc1
buffer_store_dword v18, v37, s[4:7], s50 offen
s_add_u32 s45, s45, 1
s_cmp_lt_u32 s45, 64
s_cbranch_scc1 red_loop_275
s_endpgm
red_mid_273:
red_loop_282:
s_and_b32 s47, s45, 31
s_mul_i32 s47, s47, 4608
v_lshlrev_b32 v14, 4, v0
v_add_u32 v14, s47, v14
s_add_u32 s48, s45, 1
s_mov_b32 s98, 0
sp_loop_283:
buffer_load_dword v24, v15, s[4:7], s49 offen sc1
s_add_u32 s98, s98, 1
s_cmp_gt_u32 s98, 150000
s_cbranch_scc1 sp_bad_285
s_waitcnt vmcnt(0)
v_cmp_gt_u32 vcc, s48, v24
s_nop 0
s_and_b32 vcc_lo, vcc_lo, 0xffffff
s_cbranch_scc0 sp_ok_284
s_sleep 2
s_branch sp_loop_283
sp_bad_285:
s_mov_b32 s98, 1281
s_branch L_fail
sp_ok_284:
s_mul_i32 s47, s45, 294912
s_add_u32 s47, s47, s51
s_add_u32 s46, s47, 147456
buffer_load_dwordx4 v[96:99], v8, s[4:7], s47 offen offset:0 sc1
buffer_load_dwordx4 v[100:103], v8, s[4:7], s46 offen offset:0 sc1
buffer_load_dwordx4 v[104:107], v8, s[4:7], s47 offen offset:256 sc1
buffer_load_dwordx4 v[108:111], v8, s[4:7], s46 offen offset:256 sc1
buffer_load_dwordx4 v[112:115], v8, s[4:7], s47 offen offset:512 sc1
buffer_load_dwordx4 v[116:119], v8, s[4:7], s46 offen offset:512 sc1
buffer_load_dwordx4 v[120:123], v8, s[4:7], s47 offen offset:768 sc1
buffer_load_dwordx4 v[124:127], v8, s[4:7], s46 offen offset:768 sc1
buffer_load_dwordx4 v[128:131], v8, s[4:7], s47 offen offset:1024 sc1
buffer_load_dwordx4 v[132:135], v8, s[4:7], s46 offen offset:1024 sc1
buffer_load_dwordx4 v[136:139], v8, s[4:7], s47 offen offset:1280 sc1
buffer_load_dwordx4 v[140:143], v8, s[4:7], s46 offen offset:1280 sc1
buffer_load_dwordx4 v[144:147], v8, s[4:7], s47 offen offset:1536 sc1
buffer_load_dwordx4 v[148:151], v8, s[4:7], s46 offen offset:1536 sc1
buffer_load_dwordx4 v[152:155], v8, s[4:7], s47 offen offset:1792 sc1
buffer_load_dwordx4 v[156:159], v8, s[4:7], s46 offen offset:1792 sc1
buffer_load_dwordx4 v[160:163], v8, s[4:7], s47 offen offset:2048 sc1
buffer_load_dwordx4 v[164:167], v8, s[4:7], s46 offen offset:2048 sc1
ds_read_b128 v[40:43], v14 offset:0
ds_read_b128 v[44:47], v14 offset:1024
ds_read_b128 v[48:51], v14 offset:2048
ds_read_b128 v[52:55], v14 offset:3072
v_mov_b64 v[56:57], 0
v_mov_b64 v[58:59], 0
s_mov_b64 exec, 0xffffffff
ds_read_b128 v[56:59], v14 offset:4096
s_mov_b64 exec, -1
s_waitcnt lgkmcnt(0)
s_waitcnt vmcnt(17)
v_mfma_f32_16x16x32_bf16 v[40:43], v[28:31], v[96:99], v[40:43]
s_waitcnt vmcnt(16)
v_mfma_f32_16x16x32_bf16 v[40:43], v[28:31], v[100:103], v[40:43]
s_waitcnt vmcnt(15)
v_mfma_f32_16x16x32_bf16 v[40:43], v[32:35], v[104:107], v[40:43]
s_waitcnt vmcnt(14)
v_mfma_f32_16x16x32_bf16 v[40:43], v[32:35], v[108:111], v[40:43]
s_waitcnt vmcnt(13)
v_mfma_f32_16x16x32_bf16 v[44:47], v[28:31], v[112:115], v[44:47]
s_waitcnt vmcnt(12)
v_mfma_f32_16x16x32_bf16 v[44:47], v[28:31], v[116:119], v[44:47]
s_nop 3
ds_write_b128 v14, v[40:43] offset:0
v_mul_f32 v20, v40, v40
v_add_f32 v19, v40, v41
v_fmac_f32 v20, v41, v41
v_add_f32 v19, v19, v42
v_fmac_f32 v20, v42, v42
v_add_f32 v19, v19, v43
v_fmac_f32 v20, v43, v43
s_waitcnt vmcnt(11)
v_mfma_f32_16x16x32_bf16 v[44:47], v[32:35], v[120:123], v[44:47]
s_waitcnt vmcnt(10)
v_mfma_f32_16x16x32_bf16 v[44:47], v[32:35], v[124:127], v[44:47]
s_waitcnt vmcnt(9)
v_mfma_f32_16x16x32_bf16 v[48:51], v[28:31], v[128:131], v[48:51]
s_waitcnt vmcnt(8)
v_mfma_f32_16x16x32_bf16 v[48:51], v[28:31], v[132:135], v[48:51]
s_nop 3
ds_write_b128 v14, v[44:47] offset:1024
v_add_f32 v19, v19, v44
v_fmac_f32 v20, v44, v44
v_add_f32 v19, v19, v45
v_fmac_f32 v20, v45, v45
v_add_f32 v19, v19, v46
v_fmac_f32 v20, v46, v46
v_add_f32 v19, v19, v47
v_fmac_f32 v20, v47, v47
s_waitcnt vmcnt(7)
v_mfma_f32_16x16x32_bf16 v[48:51], v[32:35], v[136:139], v[48:51]
s_waitcnt vmcnt(6)
v_mfma_f32_16x16x32_bf16 v[48:51], v[32:35], v[140:143], v[48:51]
s_waitcnt vmcnt(5)
v_mfma_f32_16x16x32_bf16 v[52:55], v[28:31], v[144:147], v[52:55]
s_waitcnt vmcnt(4)
v_mfma_f32_16x16x32_bf16 v[52:55], v[28:31], v[148:151], v[52:55]
s_nop 3
ds_write_b128 v14, v[48:51] offset:2048
v_add_f32 v19, v19, v48
v_fmac_f32 v20, v48, v48
v_add_f32 v19, v19, v49
v_fmac_f32 v20, v49, v49
v_add_f32 v19, v19, v50
v_fmac_f32 v20, v50, v50
v_add_f32 v19, v19, v51
v_fmac_f32 v20, v51, v51
s_waitcnt vmcnt(3)
v_mfma_f32_16x16x32_bf16 v[52:55], v[32:35], v[152:155], v[52:55]
s_waitcnt vmcnt(2)
v_mfma_f32_16x16x32_bf16 v[52:55], v[32:35], v[156:159], v[52:55]
s_waitcnt vmcnt(1)
v_mfma_f32_16x16x32_bf16 v[56:59], v[28:31], v[160:163], v[56:59]
s_waitcnt vmcnt(0)
v_mfma_f32_16x16x32_bf16 v[56:59], v[28:31], v[164:167], v[56:59]
s_nop 3
ds_write_b128 v14, v[52:55] offset:3072
v_add_f32 v19, v19, v52
v_fmac_f32 v20, v52, v52
v_add_f32 v19, v19, v53
v_fmac_f32 v20, v53, v53
v_add_f32 v19, v19, v54
v_fmac_f32 v20, v54, v54
v_add_f32 v19, v19, v55
v_fmac_f32 v20, v55, v55
s_mov_b64 exec, 0xffffffff
ds_write_b128 v14, v[56:59] offset:4096
s_mov_b64 exec, -1
v_add_f32 v19, v19, v56
v_fmac_f32 v20, v56, v56
v_add_f32 v19, v19, v57
v_fmac_f32 v20, v57, v57
v_add_f32 v19, v19, v58
v_fmac_f32 v20, v58, v58
v_add_f32 v19, v19, v59
v_fmac_f32 v20, v59, v59
s_mul_i32 s47, s45, 36864
s_add_u32 s47, s47, s52
v_permlane32_swap_b32 v19, v20
v_add_f32 v19, v19, v20
v_mov_b32 v21, v19
s_nop 1
v_permlane16_swap_b32 v19, v21
v_add_f32 v19, v19, v21
s_nop 1
v_add_f32_dpp v19, v19, v19 quad_perm:[2,3,0,1] row_mask:0xf bank_mask:0xf
s_nop 1
v_add_f32_dpp v19, v19, v19 row_ror:4 row_mask:0xf bank_mask:0xf
s_nop 1
v_add_f32_dpp v19, v19, v19 row_ror:8 row_mask:0xf bank_mask:0xf
v_mul_f32 v19, 0x3ae38e39, v19
v_mov_b32 v20, v19
s_nop 1
v_permlane32_swap_b32 v19, v20
v_fma_f32 v20, -v19, v19, v20
v_max_f32 v20, 0, v20
v_add_f32 v20, 0x3727c5ac, v20
v_rsq_f32 v20, v20
s_nop 0
v_mul_f32 v19, v19, v20
v_fma_f32 v40, v40, v20, -v19
v_fma_f32 v41, v41, v20, -v19
v_fma_f32 v42, v42, v20, -v19
v_fma_f32 v43, v43, v20, -v19
v_fma_f32 v44, v44, v20, -v19
v_fma_f32 v45, v45, v20, -v19
v_fma_f32 v46, v46, v20, -v19
v_fma_f32 v47, v47, v20, -v19
v_fma_f32 v48, v48, v20, -v19
v_fma_f32 v49, v49, v20, -v19
v_fma_f32 v50, v50, v20, -v19
v_fma_f32 v51, v51, v20, -v19
v_fma_f32 v52, v52, v20, -v19
v_fma_f32 v53, v53, v20, -v19
v_fma_f32 v54, v54, v20, -v19
v_fma_f32 v55, v55, v20, -v19
v_fma_f32 v56, v56, v20, -v19
v_fma_f32 v57, v57, v20, -v19
v_fma_f32 v58, v58, v20, -v19
v_fma_f32 v59, v59, v20, -v19
v_cvt_pk_bf16_f32 v72, v40, v41
v_cvt_pk_bf16_f32 v74, v44, v45
v_cvt_pk_bf16_f32 v73, v42, v43
v_cvt_pk_bf16_f32 v75, v46, v47
v_permlane16_swap_b32 v72, v74
s_nop 0
v_permlane16_swap_b32 v73, v75
buffer_store_dwordx4 v[72:75], v10, s[4:7], s47 offen offset:0 sc1
v_cvt_pk_bf16_f32 v76, v48, v49
v_cvt_pk_bf16_f32 v78, v52, v53
v_cvt_pk_bf16_f32 v77, v50, v51
v_cvt_pk_bf16_f32 v79, v54, v55
v_permlane16_swap_b32 v76, v78
s_nop 0
v_permlane16_swap_b32 v77, v79
buffer_store_dwordx4 v[76:79], v10, s[4:7], s47 offen offset:1024 sc1
v_cvt_pk_bf16_f32 v80, v56, v57
v_cvt_pk_bf16_f32 v81, v58, v59
s_mov_b64 exec, 0xffffffff
buffer_store_dwordx2 v[80:81], v11, s[4:7], s47 offen offset:2048 sc1
s_mov_b64 exec, -1
s_waitcnt vmcnt(0) lgkmcnt(0)
v_mov_b32 v18, s48
buffer_store_dword v18, v36, s[4:7], s50 offen sc1
buffer_store_dword v18, v37, s[4:7], s50 offen
s_add_u32 s45, s45, 1
s_cmp_lt_u32 s45, 64
s_cbranch_scc1 red_loop_282
s_endpgm
red_fin_274:
red_loop_286:
s_and_b32 s47, s45, 31
s_mul_i32 s47, s47, 4608
v_lshlrev_b32 v14, 4, v0
v_add_u32 v14, s47, v14
s_add_u32 s48, s45, 1
s_mov_b32 s98, 0
sp_loop_287:
buffer_load_dword v24, v15, s[4:7], s49 offen sc1
s_add_u32 s98, s98, 1
s_cmp_gt_u32 s98, 150000
s_cbranch_scc1 sp_bad_289
s_waitcnt vmcnt(0)
v_cmp_gt_u32 vcc, s48, v24
s_nop 0
s_and_b32 vcc_lo, vcc_lo, 0xffffff
s_cbranch_scc0 sp_ok_288
s_sleep 2
s_branch sp_loop_287
sp_bad_289:
s_mov_b32 s98, 1281
s_branch L_fail
sp_ok_288:
s_mul_i32 s47, s45, 294912
s_add_u32 s47, s47, s51
s_add_u32 s46, s47, 147456
buffer_load_dwordx4 v[96:99], v8, s[4:7], s47 offen offset:0 sc1
buffer_load_dwordx4 v[100:103], v8, s[4:7], s46 offen offset:0 sc1
buffer_load_dwordx4 v[104:107], v8, s[4:7], s47 offen offset:256 sc1
buffer_load_dwordx4 v[108:111], v8, s[4:7], s46 offen offset:256 sc1
buffer_load_dwordx4 v[112:115], v8, s[4:7], s47 offen offset:512 sc1
buffer_load_dwordx4 v[116:119], v8, s[4:7], s46 offen offset:512 sc1
buffer_load_dwordx4 v[120:123], v8, s[4:7], s47 offen offset:768 sc1
buffer_load_dwordx4 v[124:127], v8, s[4:7], s46 offen offset:768 sc1
buffer_load_dwordx4 v[128:131], v8, s[4:7], s47 offen offset:1024 sc1
buffer_load_dwordx4 v[132:135], v8, s[4:7], s46 offen offset:1024 sc1
buffer_load_dwordx4 v[136:139], v8, s[4:7], s47 offen offset:1280 sc1
buffer_load_dwordx4 v[140:143], v8, s[4:7], s46 offen offset:1280 sc1
buffer_load_dwordx4 v[144:147], v8, s[4:7], s47 offen offset:1536 sc1
buffer_load_dwordx4 v[148:151], v8, s[4:7], s46 offen offset:1536 sc1
buffer_load_dwordx4 v[152:155], v8, s[4:7], s47 offen offset:1792 sc1
buffer_load_dwordx4 v[156:159], v8, s[4:7], s46 offen offset:1792 sc1
buffer_load_dwordx4 v[160:163], v8, s[4:7], s47 offen offset:2048 sc1
buffer_load_dwordx4 v[164:167], v8, s[4:7], s46 offen offset:2048 sc1
ds_read_b128 v[40:43], v14 offset:0
ds_read_b128 v[44:47], v14 offset:1024
ds_read_b128 v[48:51], v14 offset:2048
ds_read_b128 v[52:55], v14 offset:3072
v_mov_b64 v[56:57], 0
v_mov_b64 v[58:59], 0
s_mov_b64 exec, 0xffffffff
ds_read_b128 v[56:59], v14 offset:4096
s_mov_b64 exec, -1
s_waitcnt lgkmcnt(0)
v_mov_b32 v1, 147456
v_mov_b32 v2, s48
ds_write_b32 v1, v2
s_waitcnt vmcnt(17)
v_mfma_f32_16x16x32_bf16 v[40:43], v[28:31], v[96:99], v[40:43]
s_waitcnt vmcnt(16)
v_mfma_f32_16x16x32_bf16 v[40:43], v[28:31], v[100:103], v[40:43]
s_waitcnt vmcnt(15)
v_mfma_f32_16x16x32_bf16 v[40:43], v[32:35], v[104:107], v[40:43]
s_waitcnt vmcnt(14)
v_mfma_f32_16x16x32_bf16 v[40:43], v[32:35], v[108:111], v[40:43]
s_waitcnt vmcnt(13)
v_mfma_f32_16x16x32_bf16 v[44:47], v[28:31], v[112:115], v[44:47]
s_waitcnt vmcnt(12)
v_mfma_f32_16x16x32_bf16 v[44:47], v[28:31], v[116:119], v[44:47]
s_waitcnt vmcnt(11)
v_mfma_f32_16x16x32_bf16 v[44:47], v[32:35], v[120:123], v[44:47]
s_waitcnt vmcnt(10)
v_mfma_f32_16x16x32_bf16 v[44:47], v[32:35], v[124:127], v[44:47]
s_waitcnt vmcnt(9)
v_mfma_f32_16x16x32_bf16 v[48:51], v[28:31], v[128:131], v[48:51]
s_waitcnt vmcnt(8)
v_mfma_f32_16x16x32_bf16 v[48:51], v[28:31], v[132:135], v[48:51]
s_waitcnt vmcnt(7)
v_mfma_f32_16x16x32_bf16 v[48:51], v[32:35], v[136:139], v[48:51]
s_waitcnt vmcnt(6)
v_mfma_f32_16x16x32_bf16 v[48:51], v[32:35], v[140:143], v[48:51]
s_waitcnt vmcnt(5)
v_mfma_f32_16x16x32_bf16 v[52:55], v[28:31], v[144:147], v[52:55]
s_waitcnt vmcnt(4)
v_mfma_f32_16x16x32_bf16 v[52:55], v[28:31], v[148:151], v[52:55]
s_waitcnt vmcnt(3)
v_mfma_f32_16x16x32_bf16 v[52:55], v[32:35], v[152:155], v[52:55]
s_waitcnt vmcnt(2)
v_mfma_f32_16x16x32_bf16 v[52:55], v[32:35], v[156:159], v[52:55]
s_waitcnt vmcnt(1)
v_mfma_f32_16x16x32_bf16 v[56:59], v[28:31], v[160:163], v[56:59]
s_waitcnt vmcnt(0)
v_mfma_f32_16x16x32_bf16 v[56:59], v[28:31], v[164:167], v[56:59]
s_mul_i32 s47, s45, 36864
v_cvt_pk_bf16_f32 v72, v40, v41
v_cvt_pk_bf16_f32 v74, v44, v45
v_cvt_pk_bf16_f32 v73, v42, v43
v_cvt_pk_bf16_f32 v75, v46, v47
v_permlane16_swap_b32 v72, v74
s_nop 0
v_permlane16_swap_b32 v73, v75
buffer_store_dwordx4 v[72:75], v12, s[16:19], s47 offen offset:0
v_cvt_pk_bf16_f32 v76, v48, v49
v_cvt_pk_bf16_f32 v78, v52, v53
v_cvt_pk_bf16_f32 v77, v50, v51
v_cvt_pk_bf16_f32 v79, v54, v55
v_permlane16_swap_b32 v76, v78
s_nop 0
v_permlane16_swap_b32 v77, v79
buffer_store_dwordx4 v[76:79], v12, s[16:19], s47 offen offset:512
v_cvt_pk_bf16_f32 v80, v56, v57
v_cvt_pk_bf16_f32 v81, v58, v59
s_mov_b64 exec, 0xffffffff
buffer_store_dwordx2 v[80:81], v13, s[16:19], s47 offen offset:1024
s_mov_b64 exec, -1
s_add_u32 s45, s45, 1
s_cmp_lt_u32 s45, 64
s_cbranch_scc1 red_loop_286
s_endpgm
L_fail:
s_mov_b64 exec, -1
v_mov_b32 v2, s98
v_mov_b32 v3, 252
s_mov_b32 s12, s40
s_and_b32 s13, s41, 0xffff
s_mov_b32 s14, 256
s_mov_b32 s15, 0x20000
buffer_store_dword v2, v3, s[12:15], 0 offen
s_waitcnt vmcnt(0)
s_endpgm
L_chain:
s_mul_i32 s53, s50, 50331648
s_add_u32 s53, s53, 10805248
s_mul_i32 s54, s50, 8388608
s_add_u32 s54, s54, 111468544
s_mul_i32 s55, s50, 589824
s_add_u32 s55, s55, 131072
s_mul_i32 s56, s50, 28672
s_add_u32 s56, s56, 1310720
s_mul_i32 s57, s50, 4
s_add_u32 s57, s57, 48
s_mul_i32 s58, s50, 32768
s_add_u32 s58, s58, 0
v_lshlrev_b32 v1, 4, v0
v_lshlrev_b32 v15, 3, v0
v_add_u32 v2, 139264, v15
v_and_b32 v24, 1, v0
v_mov_b32 v25, 0x44444444
v_mov_b32 v26, 0xeeeeeeee
v_cmp_eq_u32 vcc, 1, v24
s_nop 1
v_cndmask_b32 v3, v25, v26, vcc
v_lshrrev_b32 v24, 5, v0
v_bfe_u32 v25, v0, 4, 1
v_and_b32 v26, 15, v0
v_lshrrev_b32 v27, 4, v0
s_lshl_b32 s60, s3, 5
v_bfe_u32 v28, v0, 2, 1
v_lshlrev_b32 v28, 3, v28
v_bfe_u32 v29, v0, 3, 1
v_lshl_add_u32 v28, v29, 2, v28
v_and_b32 v29, 3, v0
v_add3_u32 v28, v28, v29, s60
v_lshlrev_b32 v28, 5, v28
v_lshl_add_u32 v28, v27, 3, v28
v_add_u32 v4, 148480, v28
v_lshlrev_b32 v28, 3, v0
s_lshl_b32 s60, s3, 9
s_add_u32 s60, s60, 2048
v_add_u32 v11, s60, v28
v_lshlrev_b32 v28, 1, v27
v_bfe_u32 v29, v0, 3, 1
v_add_u32 v28, v28, v29
v_lshlrev_b32 v28, 12, v28
v_and_b32 v29, 7, v0
v_lshl_add_u32 v9, v29, 4, v28
v_lshlrev_b32 v28, 9, v24
v_lshl_add_u32 v28, v25, 7, v28
v_lshl_add_u32 v28, v26, 3, v28
v_add_u32 v5, 148480, v28
v_bfe_u32 v28, v0, 2, 2
v_lshlrev_b32 v28, 1, v28
v_and_b32 v30, 1, v0
v_add_u32 v30, v28, v30
v_lshlrev_b32 v28, 8, v24
v_lshl_add_u32 v28, v25, 7, v28
v_lshl_add_u32 v12, v30, 4, v28
v_mov_b32 v31, v30
v_min_u32 v28, 3, v0
v_lshrrev_b32 v29, 1, v28
v_lshlrev_b32 v29, 8, v29
v_and_b32 v28, 1, v28
v_mul_u32_u24 v28, 7, v28
s_lshl_b32 s60, s51, 3
s_add_u32 s60, s60, 256
v_add3_u32 v28, v28, v29, s60
v_mul_u32_u24 v28, 43691, v28
v_lshrrev_b32 v28, 19, v28
v_mul_u32_u24 v28, 128, v28
v_add_u32 v28, 2048, v28
v_mov_b32 v29, 2147483632
s_cmp_eq_u32 s3, 3
s_cselect_b32 s61, 4, 0
v_cmp_gt_u32 vcc, s61, v0
s_nop 1
v_cndmask_b32 v7, v29, v28, vcc
s_mul_i32 s60, s51, 128
s_add_u32 s60, s60, 10240
v_mov_b32 v28, s60
v_mov_b32 v29, 2147483632
s_lshr_b32 s61, s61, 2
v_cmp_gt_u32 vcc, s61, v0
s_nop 1
v_cndmask_b32 v8, v29, v28, vcc
s_lshr_b32 s60, s3, 1
s_lshl_b32 s60, s60, 10
s_and_b32 s61, s3, 1
s_lshl_b32 s61, s61, 9
s_add_u32 s60, s60, s61
s_add_u32 s60, s60, 152576
v_lshrrev_b32 v28, 4, v0
v_lshlrev_b32 v28, 2, v28
v_lshl_add_u32 v28, v31, 5, v28
v_add_u32 v6, s60, v28
v_lshlrev_b32 v28, 6, v25
v_lshl_add_u32 v28, v24, 5, v28
v_lshl_add_u32 v10, v26, 2, v28
s_mov_b32 s66, 0x3e0293ee
s_mov_b32 s70, 0xfffffffe
s_mov_b32 s98, 0xff800000
s_mov_b32 s99, 0xff800000
s_mul_i32 s60, s3, 73728
s_lshl_b32 s61, s51, 7
s_add_u32 s74, s60, s61
s_add_u32 s74, s74, s55
s_lshl_b32 s69, s51, 1
s_add_u32 s69, s69, s3
s_add_u32 s60, s51, 64
s_cmp_lt_u32 s3, 2
s_cselect_b32 s69, s69, s60
s_cselect_b32 s78, 1, 0
s_cmp_eq_u32 s3, 2
s_cselect_b32 s60, 1, 0
s_cmp_lt_u32 s51, 8
s_cselect_b32 s60, s60, 0
s_or_b32 s78, s78, s60
s_lshl_b32 s75, s69, 12
s_add_u32 s75, s75, s55
s_lshl_b32 s76, s69, 7
s_add_u32 s79, s56, 9216
s_add_u32 s71, s56, 18432
s_mov_b32 s73, s56
s_mov_b32 s72, 0x00ff00ff
s_cmp_eq_u32 s78, 0
s_cbranch_scc1 z2_292
v_mov_b64 v[24:25], 0
v_mov_b64 v[26:27], 0
buffer_store_dwordx4 v[24:27], v1, s[4:7], s75 offen offset:0 sc1
buffer_store_dwordx4 v[24:27], v1, s[4:7], s75 offen offset:1024 sc1
buffer_store_dwordx4 v[24:27], v1, s[4:7], s75 offen offset:2048 sc1
buffer_store_dwordx4 v[24:27], v1, s[4:7], s75 offen offset:3072 sc1
v_mov_b32 v28, -1
s_mov_b32 exec_lo, s72
s_mov_b32 exec_hi, s72
s_add_u32 s60, s76, s56
s_add_u32 s60, s60, 0
buffer_store_dword v28, v10, s[4:7], s60 offen sc1
s_add_u32 s60, s76, s56
s_add_u32 s60, s60, 9216
buffer_store_dword v28, v10, s[4:7], s60 offen sc1
s_add_u32 s60, s76, s56
s_add_u32 s60, s60, 18432
buffer_store_dword v28, v10, s[4:7], s60 offen sc1
s_mov_b64 exec, -1
z2_292:
s_mov_b32 s8, s22
s_and_b32 s9, s23, 0xffff
s_mov_b32 s10, 9216
s_mov_b32 s11, 0x20000
s_lshl_b32 s60, s3, 6
v_add_u32 v24, s60, v0
v_add_u32 v25, 0, v24
v_lshrrev_b32 v26, 5, v25
v_lshlrev_b32 v26, 3, v26
v_bfe_u32 v27, v25, 4, 1
v_lshl_add_u32 v26, v27, 2, v26
v_bfe_u32 v27, v25, 3, 1
v_add_u32 v26, v26, v27
v_lshlrev_b32 v26, 1, v26
v_and_b32 v27, 7, v25
v_mul_u32_u24 v27, 1152, v27
v_add_u32 v26, v26, v27
buffer_load_ushort v32, v26, s[8:11], 0 offen
buffer_load_ushort v33, v26, s[8:11], 0 offen offset:4
v_add_u32 v25, 256, v24
v_lshrrev_b32 v26, 5, v25
v_lshlrev_b32 v26, 3, v26
v_bfe_u32 v27, v25, 4, 1
v_lshl_add_u32 v26, v27, 2, v26
v_bfe_u32 v27, v25, 3, 1
v_add_u32 v26, v26, v27
v_lshlrev_b32 v26, 1, v26
v_and_b32 v27, 7, v25
v_mul_u32_u24 v27, 1152, v27
v_add_u32 v26, v26, v27
buffer_load_ushort v34, v26, s[8:11], 0 offen
buffer_load_ushort v35, v26, s[8:11], 0 offen offset:4
v_add_u32 v25, 512, v24
v_lshrrev_b32 v26, 5, v25
v_lshlrev_b32 v26, 3, v26
v_bfe_u32 v27, v25, 4, 1
v_lshl_add_u32 v26, v27, 2, v26
v_bfe_u32 v27, v25, 3, 1
v_add_u32 v26, v26, v27
v_lshlrev_b32 v26, 1, v26
v_and_b32 v27, 7, v25
v_mul_u32_u24 v27, 1152, v27
v_add_u32 v26, v26, v27
buffer_load_ushort v36, v26, s[8:11], 0 offen
buffer_load_ushort v37, v26, s[8:11], 0 offen offset:4
v_add_u32 v25, 768, v24
v_lshrrev_b32 v26, 5, v25
v_lshlrev_b32 v26, 3, v26
v_bfe_u32 v27, v25, 4, 1
v_lshl_add_u32 v26, v27, 2, v26
v_bfe_u32 v27, v25, 3, 1
v_add_u32 v26, v26, v27
v_lshlrev_b32 v26, 1, v26
v_and_b32 v27, 7, v25
v_mul_u32_u24 v27, 1152, v27
v_add_u32 v26, v26, v27
buffer_load_ushort v38, v26, s[8:11], 0 offen
buffer_load_ushort v39, v26, s[8:11], 0 offen offset:4
v_add_u32 v25, 1024, v24
v_lshrrev_b32 v26, 5, v25
v_lshlrev_b32 v26, 3, v26
v_bfe_u32 v27, v25, 4, 1
v_lshl_add_u32 v26, v27, 2, v26
v_bfe_u32 v27, v25, 3, 1
v_add_u32 v26, v26, v27
v_lshlrev_b32 v26, 1, v26
v_and_b32 v27, 7, v25
v_mul_u32_u24 v27, 1152, v27
v_add_u32 v26, v26, v27
buffer_load_ushort v40, v26, s[8:11], 0 offen
buffer_load_ushort v41, v26, s[8:11], 0 offen offset:4
v_add_u32 v25, 1280, v24
v_lshrrev_b32 v26, 5, v25
v_lshlrev_b32 v26, 3, v26
v_bfe_u32 v27, v25, 4, 1
v_lshl_add_u32 v26, v27, 2, v26
v_bfe_u32 v27, v25, 3, 1
v_add_u32 v26, v26, v27
v_lshlrev_b32 v26, 1, v26
v_and_b32 v27, 7, v25
v_mul_u32_u24 v27, 1152, v27
v_add_u32 v26, v26, v27
buffer_load_ushort v42, v26, s[8:11], 0 offen
buffer_load_ushort v43, v26, s[8:11], 0 offen offset:4
v_add_u32 v25, 1536, v24
v_lshrrev_b32 v26, 5, v25
v_lshlrev_b32 v26, 3, v26
v_bfe_u32 v27, v25, 4, 1
v_lshl_add_u32 v26, v27, 2, v26
v_bfe_u32 v27, v25, 3, 1
v_add_u32 v26, v26, v27
v_lshlrev_b32 v26, 1, v26
v_and_b32 v27, 7, v25
v_mul_u32_u24 v27, 1152, v27
v_add_u32 v26, v26, v27
buffer_load_ushort v44, v26, s[8:11], 0 offen
buffer_load_ushort v45, v26, s[8:11], 0 offen offset:4
v_add_u32 v25, 1792, v24
v_lshrrev_b32 v26, 5, v25
v_lshlrev_b32 v26, 3, v26
v_bfe_u32 v27, v25, 4, 1
v_lshl_add_u32 v26, v27, 2, v26
v_bfe_u32 v27, v25, 3, 1
v_add_u32 v26, v26, v27
v_lshlrev_b32 v26, 1, v26
v_and_b32 v27, 7, v25
v_mul_u32_u24 v27, 1152, v27
v_add_u32 v26, v26, v27
buffer_load_ushort v46, v26, s[8:11], 0 offen
buffer_load_ushort v47, v26, s[8:11], 0 offen offset:4
v_add_u32 v25, 2048, v24
v_lshrrev_b32 v26, 5, v25
v_lshlrev_b32 v26, 3, v26
v_bfe_u32 v27, v25, 4, 1
v_lshl_add_u32 v26, v27, 2, v26
v_bfe_u32 v27, v25, 3, 1
v_add_u32 v26, v26, v27
v_lshlrev_b32 v26, 1, v26
v_and_b32 v27, 7, v25
v_mul_u32_u24 v27, 1152, v27
v_add_u32 v26, v26, v27
buffer_load_ushort v48, v26, s[8:11], 0 offen
buffer_load_ushort v49, v26, s[8:11], 0 offen offset:4
v_lshrrev_b32 v28, 4, v0
v_lshlrev_b32 v29, 1, v28
v_and_b32 v30, 15, v0
v_xor_b32 v30, v30, v29
v_lshlrev_b32 v30, 4, v30
v_lshlrev_b32 v28, 13, v28
v_add_u32 v30, v28, v30
v_xor_b32 v31, 128, v30
s_mov_b32 s8, s24
s_and_b32 s9, s25, 0xffff
s_mov_b32 s10, 4718592
s_mov_b32 s11, 0x20000
s_lshl_b32 s61, s51, 8
s_mul_i32 s60, s3, 393216
s_add_u32 s61, s61, s60
s_add_u32 s61, s61, 0
s_mul_i32 s60, s3, 12288
s_add_u32 m0, s60, 0
s_mul_i32 s62, s3, 48
s_bitcmp1_b32 s62, 5
s_cbranch_scc1 sq_293
buffer_load_dwordx4 v30, s[8:11], s61 offen lds
s_branch sq_294
sq_293:
buffer_load_dwordx4 v31, s[8:11], s61 offen lds
sq_294:
s_add_u32 s62, s62, 4
s_add_u32 s61, s61, 32768
s_add_u32 m0, m0, 1024
s_bitcmp1_b32 s62, 5
s_cbranch_scc1 sq_295
buffer_load_dwordx4 v30, s[8:11], s61 offen lds
s_branch sq_296
sq_295:
buffer_load_dwordx4 v31, s[8:11], s61 offen lds
sq_296:
s_add_u32 s62, s62, 4
s_add_u32 s61, s61, 32768
s_add_u32 m0, m0, 1024
s_bitcmp1_b32 s62, 5
s_cbranch_scc1 sq_297
buffer_load_dwordx4 v30, s[8:11], s61 offen lds
s_branch sq_298
sq_297:
buffer_load_dwordx4 v31, s[8:11], s61 offen lds
sq_298:
s_add_u32 s62, s62, 4
s_add_u32 s61, s61, 32768
s_add_u32 m0, m0, 1024
s_bitcmp1_b32 s62, 5
s_cbranch_scc1 sq_299
buffer_load_dwordx4 v30, s[8:11], s61 offen lds
s_branch sq_300
sq_299:
buffer_load_dwordx4 v31, s[8:11], s61 offen lds
sq_300:
s_add_u32 s62, s62, 4
s_add_u32 s61, s61, 32768
s_add_u32 m0, m0, 1024
s_bitcmp1_b32 s62, 5
s_cbranch_scc1 sq_301
buffer_load_dwordx4 v30, s[8:11], s61 offen lds
s_branch sq_302
sq_301:
buffer_load_dwordx4 v31, s[8:11], s61 offen lds
sq_302:
s_add_u32 s62, s62, 4
s_add_u32 s61, s61, 32768
s_add_u32 m0, m0, 1024
s_bitcmp1_b32 s62, 5
s_cbranch_scc1 sq_303
buffer_load_dwordx4 v30, s[8:11], s61 offen lds
s_branch sq_304
sq_303:
buffer_load_dwordx4 v31, s[8:11], s61 offen lds
sq_304:
s_add_u32 s62, s62, 4
s_add_u32 s61, s61, 32768
s_add_u32 m0, m0, 1024
s_bitcmp1_b32 s62, 5
s_cbranch_scc1 sq_305
buffer_load_dwordx4 v30, s[8:11], s61 offen lds
s_branch sq_306
sq_305:
buffer_load_dwordx4 v31, s[8:11], s61 offen lds
sq_306:
s_add_u32 s62, s62, 4
s_add_u32 s61, s61, 32768
s_add_u32 m0, m0, 1024
s_bitcmp1_b32 s62, 5
s_cbranch_scc1 sq_307
buffer_load_dwordx4 v30, s[8:11], s61 offen lds
s_branch sq_308
sq_307:
buffer_load_dwordx4 v31, s[8:11], s61 offen lds
sq_308:
s_add_u32 s62, s62, 4
s_add_u32 s61, s61, 32768
s_add_u32 m0, m0, 1024
s_bitcmp1_b32 s62, 5
s_cbranch_scc1 sq_309
buffer_load_dwordx4 v30, s[8:11], s61 offen lds
s_branch sq_310
sq_309:
buffer_load_dwordx4 v31, s[8:11], s61 offen lds
sq_310:
s_add_u32 s62, s62, 4
s_add_u32 s61, s61, 32768
s_add_u32 m0, m0, 1024
s_bitcmp1_b32 s62, 5
s_cbranch_scc1 sq_311
buffer_load_dwordx4 v30, s[8:11], s61 offen lds
s_branch sq_312
sq_311:
buffer_load_dwordx4 v31, s[8:11], s61 offen lds
sq_312:
s_add_u32 s62, s62, 4
s_add_u32 s61, s61, 32768
s_add_u32 m0, m0, 1024
s_bitcmp1_b32 s62, 5
s_cbranch_scc1 sq_313
buffer_load_dwordx4 v30, s[8:11], s61 offen lds
s_branch sq_314
sq_313:
buffer_load_dwordx4 v31, s[8:11], s61 offen lds
sq_314:
s_add_u32 s62, s62, 4
s_add_u32 s61, s61, 32768
s_add_u32 m0, m0, 1024
s_bitcmp1_b32 s62, 5
s_cbranch_scc1 sq_315
buffer_load_dwordx4 v30, s[8:11], s61 offen lds
s_branch sq_316
sq_315:
buffer_load_dwordx4 v31, s[8:11], s61 offen lds
sq_316:
s_add_u32 s62, s62, 4
s_add_u32 s61, s61, 32768
s_add_u32 m0, m0, 1024
s_mov_b32 s8, s24
s_and_b32 s9, s25, 0xffff
s_mov_b32 s10, 4718592
s_mov_b32 s11, 0x20000
s_lshl_b32 s61, s51, 8
s_mul_i32 s60, s3, 393216
s_add_u32 s61, s61, s60
s_add_u32 s61, s61, 1572864
s_mul_i32 s60, s3, 12288
s_add_u32 m0, s60, 49152
s_mul_i32 s62, s3, 48
s_bitcmp1_b32 s62, 5
s_cbranch_scc1 sq_317
buffer_load_dwordx4 v30, s[8:11], s61 offen lds
s_branch sq_318
sq_317:
buffer_load_dwordx4 v31, s[8:11], s61 offen lds
sq_318:
s_add_u32 s62, s62, 4
s_add_u32 s61, s61, 32768
s_add_u32 m0, m0, 1024
s_bitcmp1_b32 s62, 5
s_cbranch_scc1 sq_319
buffer_load_dwordx4 v30, s[8:11], s61 offen lds
s_branch sq_320
sq_319:
buffer_load_dwordx4 v31, s[8:11], s61 offen lds
sq_320:
s_add_u32 s62, s62, 4
s_add_u32 s61, s61, 32768
s_add_u32 m0, m0, 1024
s_bitcmp1_b32 s62, 5
s_cbranch_scc1 sq_321
buffer_load_dwordx4 v30, s[8:11], s61 offen lds
s_branch sq_322
sq_321:
buffer_load_dwordx4 v31, s[8:11], s61 offen lds
sq_322:
s_add_u32 s62, s62, 4
s_add_u32 s61, s61, 32768
s_add_u32 m0, m0, 1024
s_bitcmp1_b32 s62, 5
s_cbranch_scc1 sq_323
buffer_load_dwordx4 v30, s[8:11], s61 offen lds
s_branch sq_324
sq_323:
buffer_load_dwordx4 v31, s[8:11], s61 offen lds
sq_324:
s_add_u32 s62, s62, 4
s_add_u32 s61, s61, 32768
s_add_u32 m0, m0, 1024
s_bitcmp1_b32 s62, 5
s_cbranch_scc1 sq_325
buffer_load_dwordx4 v30, s[8:11], s61 offen lds
s_branch sq_326
sq_325:
buffer_load_dwordx4 v31, s[8:11], s61 offen lds
sq_326:
s_add_u32 s62, s62, 4
s_add_u32 s61, s61, 32768
s_add_u32 m0, m0, 1024
s_bitcmp1_b32 s62, 5
s_cbranch_scc1 sq_327
buffer_load_dwordx4 v30, s[8:11], s61 offen lds
s_branch sq_328
sq_327:
buffer_load_dwordx4 v31, s[8:11], s61 offen lds
sq_328:
s_add_u32 s62, s62, 4
s_add_u32 s61, s61, 32768
s_add_u32 m0, m0, 1024
s_bitcmp1_b32 s62, 5
s_cbranch_scc1 sq_329
buffer_load_dwordx4 v30, s[8:11], s61 offen lds
s_branch sq_330
sq_329:
buffer_load_dwordx4 v31, s[8:11], s61 offen lds
sq_330:
s_add_u32 s62, s62, 4
s_add_u32 s61, s61, 32768
s_add_u32 m0, m0, 1024
s_bitcmp1_b32 s62, 5
s_cbranch_scc1 sq_331
buffer_load_dwordx4 v30, s[8:11], s61 offen lds
s_branch sq_332
sq_331:
buffer_load_dwordx4 v31, s[8:11], s61 offen lds
sq_332:
s_add_u32 s62, s62, 4
s_add_u32 s61, s61, 32768
s_add_u32 m0, m0, 1024
s_bitcmp1_b32 s62, 5
s_cbranch_scc1 sq_333
buffer_load_dwordx4 v30, s[8:11], s61 offen lds
s_branch sq_334
sq_333:
buffer_load_dwordx4 v31, s[8:11], s61 offen lds
sq_334:
s_add_u32 s62, s62, 4
s_add_u32 s61, s61, 32768
s_add_u32 m0, m0, 1024
s_bitcmp1_b32 s62, 5
s_cbranch_scc1 sq_335
buffer_load_dwordx4 v30, s[8:11], s61 offen lds
s_branch sq_336
sq_335:
buffer_load_dwordx4 v31, s[8:11], s61 offen lds
sq_336:
s_add_u32 s62, s62, 4
s_add_u32 s61, s61, 32768
s_add_u32 m0, m0, 1024
s_bitcmp1_b32 s62, 5
s_cbranch_scc1 sq_337
buffer_load_dwordx4 v30, s[8:11], s61 offen lds
s_branch sq_338
sq_337:
buffer_load_dwordx4 v31, s[8:11], s61 offen lds
sq_338:
s_add_u32 s62, s62, 4
s_add_u32 s61, s61, 32768
s_add_u32 m0, m0, 1024
s_bitcmp1_b32 s62, 5
s_cbranch_scc1 sq_339
buffer_load_dwordx4 v30, s[8:11], s61 offen lds
s_branch sq_340
sq_339:
buffer_load_dwordx4 v31, s[8:11], s61 offen lds
sq_340:
s_add_u32 s62, s62, 4
s_add_u32 s61, s61, 32768
s_add_u32 m0, m0, 1024
s_mov_b32 s8, s24
s_and_b32 s9, s25, 0xffff
s_mov_b32 s10, 4718592
s_mov_b32 s11, 0x20000
s_lshl_b32 s61, s51, 8
s_mul_i32 s60, s3, 393216
s_add_u32 s61, s61, s60
s_add_u32 s61, s61, 3145728
s_mul_i32 s60, s3, 12288
s_add_u32 m0, s60, 98304
s_mul_i32 s62, s3, 48
s_bitcmp1_b32 s62, 5
s_cbranch_scc1 sq_341
buffer_load_dwordx4 v30, s[8:11], s61 offen lds
s_branch sq_342
sq_341:
buffer_load_dwordx4 v31, s[8:11], s61 offen lds
sq_342:
s_add_u32 s62, s62, 4
s_add_u32 s61, s61, 32768
s_add_u32 m0, m0, 1024
s_bitcmp1_b32 s62, 5
s_cbranch_scc1 sq_343
buffer_load_dwordx4 v30, s[8:11], s61 offen lds
s_branch sq_344
sq_343:
buffer_load_dwordx4 v31, s[8:11], s61 offen lds
sq_344:
s_add_u32 s62, s62, 4
s_add_u32 s61, s61, 32768
s_add_u32 m0, m0, 1024
s_bitcmp1_b32 s62, 5
s_cbranch_scc1 sq_345
buffer_load_dwordx4 v30, s[8:11], s61 offen lds
s_branch sq_346
sq_345:
buffer_load_dwordx4 v31, s[8:11], s61 offen lds
sq_346:
s_add_u32 s62, s62, 4
s_add_u32 s61, s61, 32768
s_add_u32 m0, m0, 1024
s_bitcmp1_b32 s62, 5
s_cbranch_scc1 sq_347
buffer_load_dwordx4 v30, s[8:11], s61 offen lds
s_branch sq_348
sq_347:
buffer_load_dwordx4 v31, s[8:11], s61 offen lds
sq_348:
s_add_u32 s62, s62, 4
s_add_u32 s61, s61, 32768
s_add_u32 m0, m0, 1024
s_bitcmp1_b32 s62, 5
s_cbranch_scc1 sq_349
buffer_load_dwordx4 v30, s[8:11], s61 offen lds
s_branch sq_350
sq_349:
buffer_load_dwordx4 v31, s[8:11], s61 offen lds
sq_350:
s_add_u32 s62, s62, 4
s_add_u32 s61, s61, 32768
s_add_u32 m0, m0, 1024
s_bitcmp1_b32 s62, 5
s_cbranch_scc1 sq_351
buffer_load_dwordx4 v30, s[8:11], s61 offen lds
s_branch sq_352
sq_351:
buffer_load_dwordx4 v31, s[8:11], s61 offen lds
sq_352:
s_add_u32 s62, s62, 4
s_add_u32 s61, s61, 32768
s_add_u32 m0, m0, 1024
s_bitcmp1_b32 s62, 5
s_cbranch_scc1 sq_353
buffer_load_dwordx4 v30, s[8:11], s61 offen lds
s_branch sq_354
sq_353:
buffer_load_dwordx4 v31, s[8:11], s61 offen lds
sq_354:
s_add_u32 s62, s62, 4
s_add_u32 s61, s61, 32768
s_add_u32 m0, m0, 1024
s_bitcmp1_b32 s62, 5
s_cbranch_scc1 sq_355
buffer_load_dwordx4 v30, s[8:11], s61 offen lds
s_branch sq_356
sq_355:
buffer_load_dwordx4 v31, s[8:11], s61 offen lds
sq_356:
s_add_u32 s62, s62, 4
s_add_u32 s61, s61, 32768
s_add_u32 m0, m0, 1024
s_bitcmp1_b32 s62, 5
s_cbranch_scc1 sq_357
buffer_load_dwordx4 v30, s[8:11], s61 offen lds
s_branch sq_358
sq_357:
buffer_load_dwordx4 v31, s[8:11], s61 offen lds
sq_358:
s_add_u32 s62, s62, 4
s_add_u32 s61, s61, 32768
s_add_u32 m0, m0, 1024
s_bitcmp1_b32 s62, 5
s_cbranch_scc1 sq_359
buffer_load_dwordx4 v30, s[8:11], s61 offen lds
s_branch sq_360
sq_359:
buffer_load_dwordx4 v31, s[8:11], s61 offen lds
sq_360:
s_add_u32 s62, s62, 4
s_add_u32 s61, s61, 32768
s_add_u32 m0, m0, 1024
s_bitcmp1_b32 s62, 5
s_cbranch_scc1 sq_361
buffer_load_dwordx4 v30, s[8:11], s61 offen lds
s_branch sq_362
sq_361:
buffer_load_dwordx4 v31, s[8:11], s61 offen lds
sq_362:
s_add_u32 s62, s62, 4
s_add_u32 s61, s61, 32768
s_add_u32 m0, m0, 1024
s_bitcmp1_b32 s62, 5
s_cbranch_scc1 sq_363
buffer_load_dwordx4 v30, s[8:11], s61 offen lds
s_branch sq_364
sq_363:
buffer_load_dwordx4 v31, s[8:11], s61 offen lds
sq_364:
s_add_u32 s62, s62, 4
s_add_u32 s61, s61, 32768
s_add_u32 m0, m0, 1024
s_waitcnt vmcnt(24)
s_barrier
v_lshl_or_b32 v16, v33, 16, v32
v_lshl_or_b32 v17, v35, 16, v34
v_lshl_or_b32 v18, v37, 16, v36
v_lshl_or_b32 v19, v39, 16, v38
v_lshl_or_b32 v20, v41, 16, v40
v_lshl_or_b32 v21, v43, 16, v42
v_lshl_or_b32 v22, v45, 16, v44
v_lshl_or_b32 v23, v47, 16, v46
v_lshl_or_b32 v14, v49, 16, v48
s_cmp_lg_u32 s3, 0
s_cbranch_scc1 cb_365
v_mov_b32 v24, s52
v_mov_b32 v25, s57
s_mov_b64 exec, 1
buffer_atomic_add v24, v25, s[12:15], 0 offen
s_mov_b64 exec, -1
cb_365:
v_bfe_u32 v24, v0, 4, 1
v_lshrrev_b32 v25, 5, v0
v_bfe_u32 v26, v0, 2, 2
v_lshlrev_b32 v27, 5, v24
v_lshl_add_u32 v27, v25, 3, v27
v_add_u32 v27, v27, v26
v_lshlrev_b32 v27, 8, v27
v_lshl_add_u32 v26, v24, 2, v26
s_lshl_b32 s60, s3, 1
s_add_u32 s60, s60, 0
v_xor_b32 v26, s60, v26
v_lshl_add_u32 v27, v26, 5, v27
v_and_b32 v26, 3, v0
v_lshl_add_u32 v28, v26, 3, v27
v_bfe_u32 v24, v0, 4, 1
v_lshrrev_b32 v25, 5, v0
v_bfe_u32 v26, v0, 2, 2
v_lshlrev_b32 v27, 5, v24
v_lshl_add_u32 v27, v25, 3, v27
v_add_u32 v27, v27, v26
v_lshlrev_b32 v27, 8, v27
v_lshl_add_u32 v26, v24, 2, v26
s_lshl_b32 s60, s3, 1
s_add_u32 s60, s60, 1
v_xor_b32 v26, s60, v26
v_lshl_add_u32 v27, v26, 5, v27
v_and_b32 v26, 3, v0
v_lshl_add_u32 v29, v26, 3, v27
ds_read_b64_tr_b16 a[0:1], v28 offset:0
ds_read_b64_tr_b16 a[2:3], v28 offset:1024
ds_read_b64_tr_b16 a[4:5], v28 offset:4096
ds_read_b64_tr_b16 a[6:7], v28 offset:5120
ds_read_b64_tr_b16 a[72:73], v29 offset:0
ds_read_b64_tr_b16 a[74:75], v29 offset:1024
ds_read_b64_tr_b16 a[76:77], v29 offset:4096
ds_read_b64_tr_b16 a[78:79], v29 offset:5120
s_waitcnt lgkmcnt(0)
ds_read_b64_tr_b16 a[8:9], v28 offset:16384
ds_read_b64_tr_b16 a[10:11], v28 offset:17408
ds_read_b64_tr_b16 a[12:13], v28 offset:20480
ds_read_b64_tr_b16 a[14:15], v28 offset:21504
ds_read_b64_tr_b16 a[80:81], v29 offset:16384
ds_read_b64_tr_b16 a[82:83], v29 offset:17408
ds_read_b64_tr_b16 a[84:85], v29 offset:20480
ds_read_b64_tr_b16 a[86:87], v29 offset:21504
s_waitcnt lgkmcnt(0)
ds_read_b64_tr_b16 a[16:17], v28 offset:32768
ds_read_b64_tr_b16 a[18:19], v28 offset:33792
ds_read_b64_tr_b16 a[20:21], v28 offset:36864
ds_read_b64_tr_b16 a[22:23], v28 offset:37888
ds_read_b64_tr_b16 a[88:89], v29 offset:32768
ds_read_b64_tr_b16 a[90:91], v29 offset:33792
ds_read_b64_tr_b16 a[92:93], v29 offset:36864
ds_read_b64_tr_b16 a[94:95], v29 offset:37888
s_waitcnt lgkmcnt(0)
s_barrier
s_mov_b32 s8, s26
s_and_b32 s9, s27, 0xffff
s_mov_b32 s10, 4718592
s_mov_b32 s11, 0x20000
s_lshl_b32 s61, s51, 8
s_mul_i32 s60, s3, 393216
s_add_u32 s61, s61, s60
s_add_u32 s61, s61, 0
s_mul_i32 s60, s3, 12288
s_add_u32 m0, s60, 0
s_mul_i32 s62, s3, 48
s_bitcmp1_b32 s62, 5
s_cbranch_scc1 sq_366
buffer_load_dwordx4 v30, s[8:11], s61 offen lds
s_branch sq_367
sq_366:
buffer_load_dwordx4 v31, s[8:11], s61 offen lds
sq_367:
s_add_u32 s62, s62, 4
s_add_u32 s61, s61, 32768
s_add_u32 m0, m0, 1024
s_bitcmp1_b32 s62, 5
s_cbranch_scc1 sq_368
buffer_load_dwordx4 v30, s[8:11], s61 offen lds
s_branch sq_369
sq_368:
buffer_load_dwordx4 v31, s[8:11], s61 offen lds
sq_369:
s_add_u32 s62, s62, 4
s_add_u32 s61, s61, 32768
s_add_u32 m0, m0, 1024
s_bitcmp1_b32 s62, 5
s_cbranch_scc1 sq_370
buffer_load_dwordx4 v30, s[8:11], s61 offen lds
s_branch sq_371
sq_370:
buffer_load_dwordx4 v31, s[8:11], s61 offen lds
sq_371:
s_add_u32 s62, s62, 4
s_add_u32 s61, s61, 32768
s_add_u32 m0, m0, 1024
s_bitcmp1_b32 s62, 5
s_cbranch_scc1 sq_372
buffer_load_dwordx4 v30, s[8:11], s61 offen lds
s_branch sq_373
sq_372:
buffer_load_dwordx4 v31, s[8:11], s61 offen lds
sq_373:
s_add_u32 s62, s62, 4
s_add_u32 s61, s61, 32768
s_add_u32 m0, m0, 1024
s_bitcmp1_b32 s62, 5
s_cbranch_scc1 sq_374
buffer_load_dwordx4 v30, s[8:11], s61 offen lds
s_branch sq_375
sq_374:
buffer_load_dwordx4 v31, s[8:11], s61 offen lds
sq_375:
s_add_u32 s62, s62, 4
s_add_u32 s61, s61, 32768
s_add_u32 m0, m0, 1024
s_bitcmp1_b32 s62, 5
s_cbranch_scc1 sq_376
buffer_load_dwordx4 v30, s[8:11], s61 offen lds
s_branch sq_377
sq_376:
buffer_load_dwordx4 v31, s[8:11], s61 offen lds
sq_377:
s_add_u32 s62, s62, 4
s_add_u32 s61, s61, 32768
s_add_u32 m0, m0, 1024
s_bitcmp1_b32 s62, 5
s_cbranch_scc1 sq_378
buffer_load_dwordx4 v30, s[8:11], s61 offen lds
s_branch sq_379
sq_378:
buffer_load_dwordx4 v31, s[8:11], s61 offen lds
sq_379:
s_add_u32 s62, s62, 4
s_add_u32 s61, s61, 32768
s_add_u32 m0, m0, 1024
s_bitcmp1_b32 s62, 5
s_cbranch_scc1 sq_380
buffer_load_dwordx4 v30, s[8:11], s61 offen lds
s_branch sq_381
sq_380:
buffer_load_dwordx4 v31, s[8:11], s61 offen lds
sq_381:
s_add_u32 s62, s62, 4
s_add_u32 s61, s61, 32768
s_add_u32 m0, m0, 1024
s_bitcmp1_b32 s62, 5
s_cbranch_scc1 sq_382
buffer_load_dwordx4 v30, s[8:11], s61 offen lds
s_branch sq_383
sq_382:
buffer_load_dwordx4 v31, s[8:11], s61 offen lds
sq_383:
s_add_u32 s62, s62, 4
s_add_u32 s61, s61, 32768
s_add_u32 m0, m0, 1024
s_bitcmp1_b32 s62, 5
s_cbranch_scc1 sq_384
buffer_load_dwordx4 v30, s[8:11], s61 offen lds
s_branch sq_385
sq_384:
buffer_load_dwordx4 v31, s[8:11], s61 offen lds
sq_385:
s_add_u32 s62, s62, 4
s_add_u32 s61, s61, 32768
s_add_u32 m0, m0, 1024
s_bitcmp1_b32 s62, 5
s_cbranch_scc1 sq_386
buffer_load_dwordx4 v30, s[8:11], s61 offen lds
s_branch sq_387
sq_386:
buffer_load_dwordx4 v31, s[8:11], s61 offen lds
sq_387:
s_add_u32 s62, s62, 4
s_add_u32 s61, s61, 32768
s_add_u32 m0, m0, 1024
s_bitcmp1_b32 s62, 5
s_cbranch_scc1 sq_388
buffer_load_dwordx4 v30, s[8:11], s61 offen lds
s_branch sq_389
sq_388:
buffer_load_dwordx4 v31, s[8:11], s61 offen lds
sq_389:
s_add_u32 s62, s62, 4
s_add_u32 s61, s61, 32768
s_add_u32 m0, m0, 1024
s_waitcnt vmcnt(24)
s_barrier
v_bfe_u32 v24, v0, 4, 1
v_lshrrev_b32 v25, 5, v0
v_bfe_u32 v26, v0, 2, 2
v_lshlrev_b32 v27, 5, v24
v_lshl_add_u32 v27, v25, 3, v27
v_add_u32 v27, v27, v26
v_lshlrev_b32 v27, 8, v27
v_lshl_add_u32 v26, v24, 2, v26
s_lshl_b32 s60, s3, 1
s_add_u32 s60, s60, 0
v_xor_b32 v26, s60, v26
v_lshl_add_u32 v27, v26, 5, v27
v_and_b32 v26, 3, v0
v_lshl_add_u32 v28, v26, 3, v27
v_add_u32 v28, 49152, v28
v_bfe_u32 v24, v0, 4, 1
v_lshrrev_b32 v25, 5, v0
v_bfe_u32 v26, v0, 2, 2
v_lshlrev_b32 v27, 5, v24
v_lshl_add_u32 v27, v25, 3, v27
v_add_u32 v27, v27, v26
v_lshlrev_b32 v27, 8, v27
v_lshl_add_u32 v26, v24, 2, v26
s_lshl_b32 s60, s3, 1
s_add_u32 s60, s60, 1
v_xor_b32 v26, s60, v26
v_lshl_add_u32 v27, v26, 5, v27
v_and_b32 v26, 3, v0
v_lshl_add_u32 v29, v26, 3, v27
v_add_u32 v29, 49152, v29
ds_read_b64_tr_b16 a[24:25], v28 offset:0
ds_read_b64_tr_b16 a[26:27], v28 offset:1024
ds_read_b64_tr_b16 a[28:29], v28 offset:4096
ds_read_b64_tr_b16 a[30:31], v28 offset:5120
ds_read_b64_tr_b16 a[96:97], v29 offset:0
ds_read_b64_tr_b16 a[98:99], v29 offset:1024
ds_read_b64_tr_b16 a[100:101], v29 offset:4096
ds_read_b64_tr_b16 a[102:103], v29 offset:5120
s_waitcnt lgkmcnt(0)
ds_read_b64_tr_b16 a[32:33], v28 offset:16384
ds_read_b64_tr_b16 a[34:35], v28 offset:17408
ds_read_b64_tr_b16 a[36:37], v28 offset:20480
ds_read_b64_tr_b16 a[38:39], v28 offset:21504
ds_read_b64_tr_b16 a[104:105], v29 offset:16384
ds_read_b64_tr_b16 a[106:107], v29 offset:17408
ds_read_b64_tr_b16 a[108:109], v29 offset:20480
ds_read_b64_tr_b16 a[110:111], v29 offset:21504
s_waitcnt lgkmcnt(0)
ds_read_b64_tr_b16 a[40:41], v28 offset:32768
ds_read_b64_tr_b16 a[42:43], v28 offset:33792
ds_read_b64_tr_b16 a[44:45], v28 offset:36864
ds_read_b64_tr_b16 a[46:47], v28 offset:37888
ds_read_b64_tr_b16 a[112:113], v29 offset:32768
ds_read_b64_tr_b16 a[114:115], v29 offset:33792
ds_read_b64_tr_b16 a[116:117], v29 offset:36864
ds_read_b64_tr_b16 a[118:119], v29 offset:37888
s_waitcnt lgkmcnt(0)
s_barrier
s_mov_b32 s8, s26
s_and_b32 s9, s27, 0xffff
s_mov_b32 s10, 4718592
s_mov_b32 s11, 0x20000
s_lshl_b32 s61, s51, 8
s_mul_i32 s60, s3, 393216
s_add_u32 s61, s61, s60
s_add_u32 s61, s61, 1572864
s_mul_i32 s60, s3, 12288
s_add_u32 m0, s60, 49152
s_mul_i32 s62, s3, 48
s_bitcmp1_b32 s62, 5
s_cbranch_scc1 sq_390
buffer_load_dwordx4 v30, s[8:11], s61 offen lds
s_branch sq_391
sq_390:
buffer_load_dwordx4 v31, s[8:11], s61 offen lds
sq_391:
s_add_u32 s62, s62, 4
s_add_u32 s61, s61, 32768
s_add_u32 m0, m0, 1024
s_bitcmp1_b32 s62, 5
s_cbranch_scc1 sq_392
buffer_load_dwordx4 v30, s[8:11], s61 offen lds
s_branch sq_393
sq_392:
buffer_load_dwordx4 v31, s[8:11], s61 offen lds
sq_393:
s_add_u32 s62, s62, 4
s_add_u32 s61, s61, 32768
s_add_u32 m0, m0, 1024
s_bitcmp1_b32 s62, 5
s_cbranch_scc1 sq_394
buffer_load_dwordx4 v30, s[8:11], s61 offen lds
s_branch sq_395
sq_394:
buffer_load_dwordx4 v31, s[8:11], s61 offen lds
sq_395:
s_add_u32 s62, s62, 4
s_add_u32 s61, s61, 32768
s_add_u32 m0, m0, 1024
s_bitcmp1_b32 s62, 5
s_cbranch_scc1 sq_396
buffer_load_dwordx4 v30, s[8:11], s61 offen lds
s_branch sq_397
sq_396:
buffer_load_dwordx4 v31, s[8:11], s61 offen lds
sq_397:
s_add_u32 s62, s62, 4
s_add_u32 s61, s61, 32768
s_add_u32 m0, m0, 1024
s_bitcmp1_b32 s62, 5
s_cbranch_scc1 sq_398
buffer_load_dwordx4 v30, s[8:11], s61 offen lds
s_branch sq_399
sq_398:
buffer_load_dwordx4 v31, s[8:11], s61 offen lds
sq_399:
s_add_u32 s62, s62, 4
s_add_u32 s61, s61, 32768
s_add_u32 m0, m0, 1024
s_bitcmp1_b32 s62, 5
s_cbranch_scc1 sq_400
buffer_load_dwordx4 v30, s[8:11], s61 offen lds
s_branch sq_401
sq_400:
buffer_load_dwordx4 v31, s[8:11], s61 offen lds
sq_401:
s_add_u32 s62, s62, 4
s_add_u32 s61, s61, 32768
s_add_u32 m0, m0, 1024
s_bitcmp1_b32 s62, 5
s_cbranch_scc1 sq_402
buffer_load_dwordx4 v30, s[8:11], s61 offen lds
s_branch sq_403
sq_402:
buffer_load_dwordx4 v31, s[8:11], s61 offen lds
sq_403:
s_add_u32 s62, s62, 4
s_add_u32 s61, s61, 32768
s_add_u32 m0, m0, 1024
s_bitcmp1_b32 s62, 5
s_cbranch_scc1 sq_404
buffer_load_dwordx4 v30, s[8:11], s61 offen lds
s_branch sq_405
sq_404:
buffer_load_dwordx4 v31, s[8:11], s61 offen lds
sq_405:
s_add_u32 s62, s62, 4
s_add_u32 s61, s61, 32768
s_add_u32 m0, m0, 1024
s_bitcmp1_b32 s62, 5
s_cbranch_scc1 sq_406
buffer_load_dwordx4 v30, s[8:11], s61 offen lds
s_branch sq_407
sq_406:
buffer_load_dwordx4 v31, s[8:11], s61 offen lds
sq_407:
s_add_u32 s62, s62, 4
s_add_u32 s61, s61, 32768
s_add_u32 m0, m0, 1024
s_bitcmp1_b32 s62, 5
s_cbranch_scc1 sq_408
buffer_load_dwordx4 v30, s[8:11], s61 offen lds
s_branch sq_409
sq_408:
buffer_load_dwordx4 v31, s[8:11], s61 offen lds
sq_409:
s_add_u32 s62, s62, 4
s_add_u32 s61, s61, 32768
s_add_u32 m0, m0, 1024
s_bitcmp1_b32 s62, 5
s_cbranch_scc1 sq_410
buffer_load_dwordx4 v30, s[8:11], s61 offen lds
s_branch sq_411
sq_410:
buffer_load_dwordx4 v31, s[8:11], s61 offen lds
sq_411:
s_add_u32 s62, s62, 4
s_add_u32 s61, s61, 32768
s_add_u32 m0, m0, 1024
s_bitcmp1_b32 s62, 5
s_cbranch_scc1 sq_412
buffer_load_dwordx4 v30, s[8:11], s61 offen lds
s_branch sq_413
sq_412:
buffer_load_dwordx4 v31, s[8:11], s61 offen lds
sq_413:
s_add_u32 s62, s62, 4
s_add_u32 s61, s61, 32768
s_add_u32 m0, m0, 1024
s_waitcnt vmcnt(24)
s_barrier
v_bfe_u32 v24, v0, 4, 1
v_lshrrev_b32 v25, 5, v0
v_bfe_u32 v26, v0, 2, 2
v_lshlrev_b32 v27, 5, v24
v_lshl_add_u32 v27, v25, 3, v27
v_add_u32 v27, v27, v26
v_lshlrev_b32 v27, 8, v27
v_lshl_add_u32 v26, v24, 2, v26
s_lshl_b32 s60, s3, 1
s_add_u32 s60, s60, 0
v_xor_b32 v26, s60, v26
v_lshl_add_u32 v27, v26, 5, v27
v_and_b32 v26, 3, v0
v_lshl_add_u32 v28, v26, 3, v27
v_add_u32 v28, 98304, v28
v_bfe_u32 v24, v0, 4, 1
v_lshrrev_b32 v25, 5, v0
v_bfe_u32 v26, v0, 2, 2
v_lshlrev_b32 v27, 5, v24
v_lshl_add_u32 v27, v25, 3, v27
v_add_u32 v27, v27, v26
v_lshlrev_b32 v27, 8, v27
v_lshl_add_u32 v26, v24, 2, v26
s_lshl_b32 s60, s3, 1
s_add_u32 s60, s60, 1
v_xor_b32 v26, s60, v26
v_lshl_add_u32 v27, v26, 5, v27
v_and_b32 v26, 3, v0
v_lshl_add_u32 v29, v26, 3, v27
v_add_u32 v29, 98304, v29
ds_read_b64_tr_b16 a[48:49], v28 offset:0
ds_read_b64_tr_b16 a[50:51], v28 offset:1024
ds_read_b64_tr_b16 a[52:53], v28 offset:4096
ds_read_b64_tr_b16 a[54:55], v28 offset:5120
ds_read_b64_tr_b16 a[120:121], v29 offset:0
ds_read_b64_tr_b16 a[122:123], v29 offset:1024
ds_read_b64_tr_b16 a[124:125], v29 offset:4096
ds_read_b64_tr_b16 a[126:127], v29 offset:5120
s_waitcnt lgkmcnt(0)
ds_read_b64_tr_b16 a[56:57], v28 offset:16384
ds_read_b64_tr_b16 a[58:59], v28 offset:17408
ds_read_b64_tr_b16 a[60:61], v28 offset:20480
ds_read_b64_tr_b16 a[62:63], v28 offset:21504
ds_read_b64_tr_b16 a[128:129], v29 offset:16384
ds_read_b64_tr_b16 a[130:131], v29 offset:17408
ds_read_b64_tr_b16 a[132:133], v29 offset:20480
ds_read_b64_tr_b16 a[134:135], v29 offset:21504
s_waitcnt lgkmcnt(0)
ds_read_b64_tr_b16 a[64:65], v28 offset:32768
ds_read_b64_tr_b16 a[66:67], v28 offset:33792
ds_read_b64_tr_b16 a[68:69], v28 offset:36864
ds_read_b64_tr_b16 a[70:71], v28 offset:37888
ds_read_b64_tr_b16 a[136:137], v29 offset:32768
ds_read_b64_tr_b16 a[138:139], v29 offset:33792
ds_read_b64_tr_b16 a[140:141], v29 offset:36864
ds_read_b64_tr_b16 a[142:143], v29 offset:37888
s_waitcnt lgkmcnt(0)
s_barrier
s_mov_b32 s8, s26
s_and_b32 s9, s27, 0xffff
s_mov_b32 s10, 4718592
s_mov_b32 s11, 0x20000
s_lshl_b32 s61, s51, 8
s_mul_i32 s60, s3, 393216
s_add_u32 s61, s61, s60
s_add_u32 s61, s61, 3145728
s_mul_i32 s60, s3, 12288
s_add_u32 m0, s60, 98304
s_mul_i32 s62, s3, 48
s_bitcmp1_b32 s62, 5
s_cbranch_scc1 sq_414
buffer_load_dwordx4 v30, s[8:11], s61 offen lds
s_branch sq_415
sq_414:
buffer_load_dwordx4 v31, s[8:11], s61 offen lds
sq_415:
s_add_u32 s62, s62, 4
s_add_u32 s61, s61, 32768
s_add_u32 m0, m0, 1024
s_bitcmp1_b32 s62, 5
s_cbranch_scc1 sq_416
buffer_load_dwordx4 v30, s[8:11], s61 offen lds
s_branch sq_417
sq_416:
buffer_load_dwordx4 v31, s[8:11], s61 offen lds
sq_417:
s_add_u32 s62, s62, 4
s_add_u32 s61, s61, 32768
s_add_u32 m0, m0, 1024
s_bitcmp1_b32 s62, 5
s_cbranch_scc1 sq_418
buffer_load_dwordx4 v30, s[8:11], s61 offen lds
s_branch sq_419
sq_418:
buffer_load_dwordx4 v31, s[8:11], s61 offen lds
sq_419:
s_add_u32 s62, s62, 4
s_add_u32 s61, s61, 32768
s_add_u32 m0, m0, 1024
s_bitcmp1_b32 s62, 5
s_cbranch_scc1 sq_420
buffer_load_dwordx4 v30, s[8:11], s61 offen lds
s_branch sq_421
sq_420:
buffer_load_dwordx4 v31, s[8:11], s61 offen lds
sq_421:
s_add_u32 s62, s62, 4
s_add_u32 s61, s61, 32768
s_add_u32 m0, m0, 1024
s_bitcmp1_b32 s62, 5
s_cbranch_scc1 sq_422
buffer_load_dwordx4 v30, s[8:11], s61 offen lds
s_branch sq_423
sq_422:
buffer_load_dwordx4 v31, s[8:11], s61 offen lds
sq_423:
s_add_u32 s62, s62, 4
s_add_u32 s61, s61, 32768
s_add_u32 m0, m0, 1024
s_bitcmp1_b32 s62, 5
s_cbranch_scc1 sq_424
buffer_load_dwordx4 v30, s[8:11], s61 offen lds
s_branch sq_425
sq_424:
buffer_load_dwordx4 v31, s[8:11], s61 offen lds
sq_425:
s_add_u32 s62, s62, 4
s_add_u32 s61, s61, 32768
s_add_u32 m0, m0, 1024
s_bitcmp1_b32 s62, 5
s_cbranch_scc1 sq_426
buffer_load_dwordx4 v30, s[8:11], s61 offen lds
s_branch sq_427
sq_426:
buffer_load_dwordx4 v31, s[8:11], s61 offen lds
sq_427:
s_add_u32 s62, s62, 4
s_add_u32 s61, s61, 32768
s_add_u32 m0, m0, 1024
s_bitcmp1_b32 s62, 5
s_cbranch_scc1 sq_428
buffer_load_dwordx4 v30, s[8:11], s61 offen lds
s_branch sq_429
sq_428:
buffer_load_dwordx4 v31, s[8:11], s61 offen lds
sq_429:
s_add_u32 s62, s62, 4
s_add_u32 s61, s61, 32768
s_add_u32 m0, m0, 1024
s_bitcmp1_b32 s62, 5
s_cbranch_scc1 sq_430
buffer_load_dwordx4 v30, s[8:11], s61 offen lds
s_branch sq_431
sq_430:
buffer_load_dwordx4 v31, s[8:11], s61 offen lds
sq_431:
s_add_u32 s62, s62, 4
s_add_u32 s61, s61, 32768
s_add_u32 m0, m0, 1024
s_bitcmp1_b32 s62, 5
s_cbranch_scc1 sq_432
buffer_load_dwordx4 v30, s[8:11], s61 offen lds
s_branch sq_433
sq_432:
buffer_load_dwordx4 v31, s[8:11], s61 offen lds
sq_433:
s_add_u32 s62, s62, 4
s_add_u32 s61, s61, 32768
s_add_u32 m0, m0, 1024
s_bitcmp1_b32 s62, 5
s_cbranch_scc1 sq_434
buffer_load_dwordx4 v30, s[8:11], s61 offen lds
s_branch sq_435
sq_434:
buffer_load_dwordx4 v31, s[8:11], s61 offen lds
sq_435:
s_add_u32 s62, s62, 4
s_add_u32 s61, s61, 32768
s_add_u32 m0, m0, 1024
s_bitcmp1_b32 s62, 5
s_cbranch_scc1 sq_436
buffer_load_dwordx4 v30, s[8:11], s61 offen lds
s_branch sq_437
sq_436:
buffer_load_dwordx4 v31, s[8:11], s61 offen lds
sq_437:
s_add_u32 s62, s62, 4
s_add_u32 s61, s61, 32768
s_add_u32 m0, m0, 1024
s_waitcnt vmcnt(24)
s_barrier
v_bfe_u32 v24, v0, 4, 1
v_lshrrev_b32 v25, 5, v0
v_bfe_u32 v26, v0, 2, 2
v_lshlrev_b32 v27, 5, v24
v_lshl_add_u32 v27, v25, 3, v27
v_add_u32 v27, v27, v26
v_lshlrev_b32 v27, 8, v27
v_lshl_add_u32 v26, v24, 2, v26
s_lshl_b32 s60, s3, 1
s_add_u32 s60, s60, 0
v_xor_b32 v26, s60, v26
v_lshl_add_u32 v27, v26, 5, v27
v_and_b32 v26, 3, v0
v_lshl_add_u32 v28, v26, 3, v27
v_bfe_u32 v24, v0, 4, 1
v_lshrrev_b32 v25, 5, v0
v_bfe_u32 v26, v0, 2, 2
v_lshlrev_b32 v27, 5, v24
v_lshl_add_u32 v27, v25, 3, v27
v_add_u32 v27, v27, v26
v_lshlrev_b32 v27, 8, v27
v_lshl_add_u32 v26, v24, 2, v26
s_lshl_b32 s60, s3, 1
s_add_u32 s60, s60, 1
v_xor_b32 v26, s60, v26
v_lshl_add_u32 v27, v26, 5, v27
v_and_b32 v26, 3, v0
v_lshl_add_u32 v29, v26, 3, v27
ds_read_b64_tr_b16 a[144:145], v28 offset:0
ds_read_b64_tr_b16 a[146:147], v28 offset:1024
ds_read_b64_tr_b16 a[148:149], v28 offset:4096
ds_read_b64_tr_b16 a[150:151], v28 offset:5120
ds_read_b64_tr_b16 a[216:217], v29 offset:0
ds_read_b64_tr_b16 a[218:219], v29 offset:1024
ds_read_b64_tr_b16 a[220:221], v29 offset:4096
ds_read_b64_tr_b16 a[222:223], v29 offset:5120
s_waitcnt lgkmcnt(0)
ds_read_b64_tr_b16 a[152:153], v28 offset:16384
ds_read_b64_tr_b16 a[154:155], v28 offset:17408
ds_read_b64_tr_b16 a[156:157], v28 offset:20480
ds_read_b64_tr_b16 a[158:159], v28 offset:21504
ds_read_b64_tr_b16 a[224:225], v29 offset:16384
ds_read_b64_tr_b16 a[226:227], v29 offset:17408
ds_read_b64_tr_b16 a[228:229], v29 offset:20480
ds_read_b64_tr_b16 a[230:231], v29 offset:21504
s_waitcnt lgkmcnt(0)
ds_read_b64_tr_b16 a[160:161], v28 offset:32768
ds_read_b64_tr_b16 a[162:163], v28 offset:33792
ds_read_b64_tr_b16 a[164:165], v28 offset:36864
ds_read_b64_tr_b16 a[166:167], v28 offset:37888
ds_read_b64_tr_b16 a[232:233], v29 offset:32768
ds_read_b64_tr_b16 a[234:235], v29 offset:33792
ds_read_b64_tr_b16 a[236:237], v29 offset:36864
ds_read_b64_tr_b16 a[238:239], v29 offset:37888
s_waitcnt lgkmcnt(0)
s_barrier
s_mov_b32 s8, s30
s_and_b32 s9, s31, 0xffff
s_mov_b32 s10, 4718592
s_mov_b32 s11, 0x20000
s_mul_i32 s61, s51, 147456
s_mul_i32 s60, s3, 9216
s_add_u32 s61, s61, s60
s_add_u32 s61, s61, 0
s_add_u32 m0, s60, 0
s_nop 0
buffer_load_dwordx4 v1, s[8:11], s61 offen lds
s_add_u32 s61, s61, 1024
s_add_u32 m0, m0, 1024
s_nop 0
buffer_load_dwordx4 v1, s[8:11], s61 offen lds
s_add_u32 s61, s61, 1024
s_add_u32 m0, m0, 1024
s_nop 0
buffer_load_dwordx4 v1, s[8:11], s61 offen lds
s_add_u32 s61, s61, 1024
s_add_u32 m0, m0, 1024
s_nop 0
buffer_load_dwordx4 v1, s[8:11], s61 offen lds
s_add_u32 s61, s61, 1024
s_add_u32 m0, m0, 1024
s_nop 0
buffer_load_dwordx4 v1, s[8:11], s61 offen lds
s_add_u32 s61, s61, 1024
s_add_u32 m0, m0, 1024
s_nop 0
buffer_load_dwordx4 v1, s[8:11], s61 offen lds
s_add_u32 s61, s61, 1024
s_add_u32 m0, m0, 1024
s_nop 0
buffer_load_dwordx4 v1, s[8:11], s61 offen lds
s_add_u32 s61, s61, 1024
s_add_u32 m0, m0, 1024
s_nop 0
buffer_load_dwordx4 v1, s[8:11], s61 offen lds
s_add_u32 s61, s61, 1024
s_add_u32 m0, m0, 1024
s_nop 0
buffer_load_dwordx4 v1, s[8:11], s61 offen lds
s_add_u32 s61, s61, 1024
s_add_u32 m0, m0, 1024
s_waitcnt vmcnt(21)
s_barrier
v_bfe_u32 v24, v0, 4, 1
v_lshrrev_b32 v25, 5, v0
v_bfe_u32 v26, v0, 2, 2
v_lshlrev_b32 v27, 5, v24
v_lshl_add_u32 v27, v25, 3, v27
v_add_u32 v27, v27, v26
v_lshlrev_b32 v27, 8, v27
v_lshl_add_u32 v26, v24, 2, v26
s_lshl_b32 s60, s3, 1
s_add_u32 s60, s60, 0
v_xor_b32 v26, s60, v26
v_lshl_add_u32 v27, v26, 5, v27
v_and_b32 v26, 3, v0
v_lshl_add_u32 v28, v26, 3, v27
v_add_u32 v28, 49152, v28
v_bfe_u32 v24, v0, 4, 1
v_lshrrev_b32 v25, 5, v0
v_bfe_u32 v26, v0, 2, 2
v_lshlrev_b32 v27, 5, v24
v_lshl_add_u32 v27, v25, 3, v27
v_add_u32 v27, v27, v26
v_lshlrev_b32 v27, 8, v27
v_lshl_add_u32 v26, v24, 2, v26
s_lshl_b32 s60, s3, 1
s_add_u32 s60, s60, 1
v_xor_b32 v26, s60, v26
v_lshl_add_u32 v27, v26, 5, v27
v_and_b32 v26, 3, v0
v_lshl_add_u32 v29, v26, 3, v27
v_add_u32 v29, 49152, v29
ds_read_b64_tr_b16 a[168:169], v28 offset:0
ds_read_b64_tr_b16 a[170:171], v28 offset:1024
ds_read_b64_tr_b16 a[172:173], v28 offset:4096
ds_read_b64_tr_b16 a[174:175], v28 offset:5120
ds_read_b64_tr_b16 a[240:241], v29 offset:0
ds_read_b64_tr_b16 a[242:243], v29 offset:1024
ds_read_b64_tr_b16 a[244:245], v29 offset:4096
ds_read_b64_tr_b16 a[246:247], v29 offset:5120
s_waitcnt lgkmcnt(0)
ds_read_b64_tr_b16 a[176:177], v28 offset:16384
ds_read_b64_tr_b16 a[178:179], v28 offset:17408
ds_read_b64_tr_b16 a[180:181], v28 offset:20480
ds_read_b64_tr_b16 a[182:183], v28 offset:21504
ds_read_b64_tr_b16 a[248:249], v29 offset:16384
ds_read_b64_tr_b16 a[250:251], v29 offset:17408
ds_read_b64_tr_b16 a[252:253], v29 offset:20480
ds_read_b64_tr_b16 a[254:255], v29 offset:21504
s_waitcnt lgkmcnt(0)
ds_read_b64_tr_b16 a[184:185], v28 offset:32768
ds_read_b64_tr_b16 a[186:187], v28 offset:33792
ds_read_b64_tr_b16 a[188:189], v28 offset:36864
ds_read_b64_tr_b16 a[190:191], v28 offset:37888
ds_read_b64_tr_b16 v[72:73], v29 offset:32768
ds_read_b64_tr_b16 v[74:75], v29 offset:33792
ds_read_b64_tr_b16 v[76:77], v29 offset:36864
ds_read_b64_tr_b16 v[78:79], v29 offset:37888
s_waitcnt lgkmcnt(0)
s_barrier
s_mov_b32 s8, s30
s_and_b32 s9, s31, 0xffff
s_mov_b32 s10, 4718592
s_mov_b32 s11, 0x20000
s_mul_i32 s61, s51, 147456
s_mul_i32 s60, s3, 9216
s_add_u32 s61, s61, s60
s_add_u32 s61, s61, 36864
s_add_u32 m0, s60, 49152
s_nop 0
buffer_load_dwordx4 v1, s[8:11], s61 offen lds
s_add_u32 s61, s61, 1024
s_add_u32 m0, m0, 1024
s_nop 0
buffer_load_dwordx4 v1, s[8:11], s61 offen lds
s_add_u32 s61, s61, 1024
s_add_u32 m0, m0, 1024
s_nop 0
buffer_load_dwordx4 v1, s[8:11], s61 offen lds
s_add_u32 s61, s61, 1024
s_add_u32 m0, m0, 1024
s_nop 0
buffer_load_dwordx4 v1, s[8:11], s61 offen lds
s_add_u32 s61, s61, 1024
s_add_u32 m0, m0, 1024
s_nop 0
buffer_load_dwordx4 v1, s[8:11], s61 offen lds
s_add_u32 s61, s61, 1024
s_add_u32 m0, m0, 1024
s_nop 0
buffer_load_dwordx4 v1, s[8:11], s61 offen lds
s_add_u32 s61, s61, 1024
s_add_u32 m0, m0, 1024
s_nop 0
buffer_load_dwordx4 v1, s[8:11], s61 offen lds
s_add_u32 s61, s61, 1024
s_add_u32 m0, m0, 1024
s_nop 0
buffer_load_dwordx4 v1, s[8:11], s61 offen lds
s_add_u32 s61, s61, 1024
s_add_u32 m0, m0, 1024
s_nop 0
buffer_load_dwordx4 v1, s[8:11], s61 offen lds
s_add_u32 s61, s61, 1024
s_add_u32 m0, m0, 1024
s_waitcnt vmcnt(18)
s_barrier
v_bfe_u32 v24, v0, 4, 1
v_lshrrev_b32 v25, 5, v0
v_bfe_u32 v26, v0, 2, 2
v_lshlrev_b32 v27, 5, v24
v_lshl_add_u32 v27, v25, 3, v27
v_add_u32 v27, v27, v26
v_lshlrev_b32 v27, 8, v27
v_lshl_add_u32 v26, v24, 2, v26
s_lshl_b32 s60, s3, 1
s_add_u32 s60, s60, 0
v_xor_b32 v26, s60, v26
v_lshl_add_u32 v27, v26, 5, v27
v_and_b32 v26, 3, v0
v_lshl_add_u32 v28, v26, 3, v27
v_add_u32 v28, 98304, v28
v_bfe_u32 v24, v0, 4, 1
v_lshrrev_b32 v25, 5, v0
v_bfe_u32 v26, v0, 2, 2
v_lshlrev_b32 v27, 5, v24
v_lshl_add_u32 v27, v25, 3, v27
v_add_u32 v27, v27, v26
v_lshlrev_b32 v27, 8, v27
v_lshl_add_u32 v26, v24, 2, v26
s_lshl_b32 s60, s3, 1
s_add_u32 s60, s60, 1
v_xor_b32 v26, s60, v26
v_lshl_add_u32 v27, v26, 5, v27
v_and_b32 v26, 3, v0
v_lshl_add_u32 v29, v26, 3, v27
v_add_u32 v29, 98304, v29
ds_read_b64_tr_b16 a[192:193], v28 offset:0
ds_read_b64_tr_b16 a[194:195], v28 offset:1024
ds_read_b64_tr_b16 a[196:197], v28 offset:4096
ds_read_b64_tr_b16 a[198:199], v28 offset:5120
ds_read_b64_tr_b16 v[80:81], v29 offset:0
ds_read_b64_tr_b16 v[82:83], v29 offset:1024
ds_read_b64_tr_b16 v[84:85], v29 offset:4096
ds_read_b64_tr_b16 v[86:87], v29 offset:5120
s_waitcnt lgkmcnt(0)
ds_read_b64_tr_b16 a[200:201], v28 offset:16384
ds_read_b64_tr_b16 a[202:203], v28 offset:17408
ds_read_b64_tr_b16 a[204:205], v28 offset:20480
ds_read_b64_tr_b16 a[206:207], v28 offset:21504
ds_read_b64_tr_b16 v[88:89], v29 offset:16384
ds_read_b64_tr_b16 v[90:91], v29 offset:17408
ds_read_b64_tr_b16 v[92:93], v29 offset:20480
ds_read_b64_tr_b16 v[94:95], v29 offset:21504
s_waitcnt lgkmcnt(0)
ds_read_b64_tr_b16 a[208:209], v28 offset:32768
ds_read_b64_tr_b16 a[210:211], v28 offset:33792
ds_read_b64_tr_b16 a[212:213], v28 offset:36864
ds_read_b64_tr_b16 a[214:215], v28 offset:37888
ds_read_b64_tr_b16 v[96:97], v29 offset:32768
ds_read_b64_tr_b16 v[98:99], v29 offset:33792
ds_read_b64_tr_b16 v[100:101], v29 offset:36864
ds_read_b64_tr_b16 v[102:103], v29 offset:37888
s_waitcnt lgkmcnt(0)
s_barrier
s_mov_b32 s8, s30
s_and_b32 s9, s31, 0xffff
s_mov_b32 s10, 4718592
s_mov_b32 s11, 0x20000
s_mul_i32 s61, s51, 147456
s_mul_i32 s60, s3, 9216
s_add_u32 s61, s61, s60
s_add_u32 s61, s61, 73728
s_add_u32 m0, s60, 98304
s_nop 0
buffer_load_dwordx4 v1, s[8:11], s61 offen lds
s_add_u32 s61, s61, 1024
s_add_u32 m0, m0, 1024
s_nop 0
buffer_load_dwordx4 v1, s[8:11], s61 offen lds
s_add_u32 s61, s61, 1024
s_add_u32 m0, m0, 1024
s_nop 0
buffer_load_dwordx4 v1, s[8:11], s61 offen lds
s_add_u32 s61, s61, 1024
s_add_u32 m0, m0, 1024
s_nop 0
buffer_load_dwordx4 v1, s[8:11], s61 offen lds
s_add_u32 s61, s61, 1024
s_add_u32 m0, m0, 1024
s_nop 0
buffer_load_dwordx4 v1, s[8:11], s61 offen lds
s_add_u32 s61, s61, 1024
s_add_u32 m0, m0, 1024
s_nop 0
buffer_load_dwordx4 v1, s[8:11], s61 offen lds
s_add_u32 s61, s61, 1024
s_add_u32 m0, m0, 1024
s_nop 0
buffer_load_dwordx4 v1, s[8:11], s61 offen lds
s_add_u32 s61, s61, 1024
s_add_u32 m0, m0, 1024
s_nop 0
buffer_load_dwordx4 v1, s[8:11], s61 offen lds
s_add_u32 s61, s61, 1024
s_add_u32 m0, m0, 1024
s_nop 0
buffer_load_dwordx4 v1, s[8:11], s61 offen lds
s_add_u32 s61, s61, 1024
s_add_u32 m0, m0, 1024
s_waitcnt vmcnt(18)
s_barrier
v_lshrrev_b32 v24, 4, v0
v_lshlrev_b32 v24, 3, v24
v_bfe_u32 v25, v0, 2, 2
v_add_u32 v24, v24, v25
v_mul_u32_u24 v24, 1152, v24
v_and_b32 v25, 3, v0
v_lshl_add_u32 v24, v25, 3, v24
s_mul_i32 s60, s3, 288
s_add_u32 s60, s60, 0
v_add_u32 v28, s60, v24
ds_read_b64_tr_b16 v[104:105], v28 offset:0
ds_read_b64_tr_b16 v[106:107], v28 offset:4608
ds_read_b64_tr_b16 v[120:121], v28 offset:32
ds_read_b64_tr_b16 v[122:123], v28 offset:4640
ds_read_b64_tr_b16 v[136:137], v28 offset:64
ds_read_b64_tr_b16 v[138:139], v28 offset:4672
s_waitcnt lgkmcnt(0)
ds_read_b64_tr_b16 v[152:153], v28 offset:96
ds_read_b64_tr_b16 v[154:155], v28 offset:4704
ds_read_b64_tr_b16 v[168:169], v28 offset:128
ds_read_b64_tr_b16 v[170:171], v28 offset:4736
ds_read_b64_tr_b16 v[184:185], v28 offset:160
ds_read_b64_tr_b16 v[186:187], v28 offset:4768
s_waitcnt lgkmcnt(0)
ds_read_b64_tr_b16 v[200:201], v28 offset:192
ds_read_b64_tr_b16 v[202:203], v28 offset:4800
ds_read_b64_tr_b16 v[216:217], v28 offset:224
ds_read_b64_tr_b16 v[218:219], v28 offset:4832
ds_read_b64_tr_b16 v[232:233], v28 offset:256
ds_read_b64_tr_b16 v[234:235], v28 offset:4864
s_waitcnt lgkmcnt(0)
s_barrier
s_mov_b32 s8, s30
s_and_b32 s9, s31, 0xffff
s_mov_b32 s10, 4718592
s_mov_b32 s11, 0x20000
s_mul_i32 s61, s51, 147456
s_mul_i32 s60, s3, 9216
s_add_u32 s61, s61, s60
s_add_u32 s61, s61, 110592
s_add_u32 m0, s60, 0
s_nop 0
buffer_load_dwordx4 v1, s[8:11], s61 offen lds
s_add_u32 s61, s61, 1024
s_add_u32 m0, m0, 1024
s_nop 0
buffer_load_dwordx4 v1, s[8:11], s61 offen lds
s_add_u32 s61, s61, 1024
s_add_u32 m0, m0, 1024
s_nop 0
buffer_load_dwordx4 v1, s[8:11], s61 offen lds
s_add_u32 s61, s61, 1024
s_add_u32 m0, m0, 1024
s_nop 0
buffer_load_dwordx4 v1, s[8:11], s61 offen lds
s_add_u32 s61, s61, 1024
s_add_u32 m0, m0, 1024
s_nop 0
buffer_load_dwordx4 v1, s[8:11], s61 offen lds
s_add_u32 s61, s61, 1024
s_add_u32 m0, m0, 1024
s_nop 0
buffer_load_dwordx4 v1, s[8:11], s61 offen lds
s_add_u32 s61, s61, 1024
s_add_u32 m0, m0, 1024
s_nop 0
buffer_load_dwordx4 v1, s[8:11], s61 offen lds
s_add_u32 s61, s61, 1024
s_add_u32 m0, m0, 1024
s_nop 0
buffer_load_dwordx4 v1, s[8:11], s61 offen lds
s_add_u32 s61, s61, 1024
s_add_u32 m0, m0, 1024
s_nop 0
buffer_load_dwordx4 v1, s[8:11], s61 offen lds
s_add_u32 s61, s61, 1024
s_add_u32 m0, m0, 1024
s_waitcnt vmcnt(18)
s_barrier
v_lshrrev_b32 v24, 4, v0
v_lshlrev_b32 v24, 3, v24
v_bfe_u32 v25, v0, 2, 2
v_add_u32 v24, v24, v25
v_mul_u32_u24 v24, 1152, v24
v_and_b32 v25, 3, v0
v_lshl_add_u32 v24, v25, 3, v24
s_mul_i32 s60, s3, 288
s_add_u32 s60, s60, 49152
v_add_u32 v28, s60, v24
ds_read_b64_tr_b16 v[108:109], v28 offset:0
ds_read_b64_tr_b16 v[110:111], v28 offset:4608
ds_read_b64_tr_b16 v[124:125], v28 offset:32
ds_read_b64_tr_b16 v[126:127], v28 offset:4640
ds_read_b64_tr_b16 v[140:141], v28 offset:64
ds_read_b64_tr_b16 v[142:143], v28 offset:4672
s_waitcnt lgkmcnt(0)
ds_read_b64_tr_b16 v[156:157], v28 offset:96
ds_read_b64_tr_b16 v[158:159], v28 offset:4704
ds_read_b64_tr_b16 v[172:173], v28 offset:128
ds_read_b64_tr_b16 v[174:175], v28 offset:4736
ds_read_b64_tr_b16 v[188:189], v28 offset:160
ds_read_b64_tr_b16 v[190:191], v28 offset:4768
s_waitcnt lgkmcnt(0)
ds_read_b64_tr_b16 v[204:205], v28 offset:192
ds_read_b64_tr_b16 v[206:207], v28 offset:4800
ds_read_b64_tr_b16 v[220:221], v28 offset:224
ds_read_b64_tr_b16 v[222:223], v28 offset:4832
ds_read_b64_tr_b16 v[236:237], v28 offset:256
ds_read_b64_tr_b16 v[238:239], v28 offset:4864
s_waitcnt lgkmcnt(0)
s_barrier
s_mov_b32 s8, s28
s_and_b32 s9, s29, 0xffff
s_mov_b32 s10, 4718592
s_mov_b32 s11, 0x20000
s_lshl_b32 s61, s51, 8
s_mul_i32 s60, s3, 393216
s_add_u32 s61, s61, s60
s_add_u32 s61, s61, 1572864
s_mul_i32 s60, s3, 12288
s_add_u32 m0, s60, 49152
s_mul_i32 s62, s3, 48
s_bitcmp1_b32 s62, 5
s_cbranch_scc1 sq_438
buffer_load_dwordx4 v30, s[8:11], s61 offen lds
s_branch sq_439
sq_438:
buffer_load_dwordx4 v31, s[8:11], s61 offen lds
sq_439:
s_add_u32 s62, s62, 4
s_add_u32 s61, s61, 32768
s_add_u32 m0, m0, 1024
s_bitcmp1_b32 s62, 5
s_cbranch_scc1 sq_440
buffer_load_dwordx4 v30, s[8:11], s61 offen lds
s_branch sq_441
sq_440:
buffer_load_dwordx4 v31, s[8:11], s61 offen lds
sq_441:
s_add_u32 s62, s62, 4
s_add_u32 s61, s61, 32768
s_add_u32 m0, m0, 1024
s_bitcmp1_b32 s62, 5
s_cbranch_scc1 sq_442
buffer_load_dwordx4 v30, s[8:11], s61 offen lds
s_branch sq_443
sq_442:
buffer_load_dwordx4 v31, s[8:11], s61 offen lds
sq_443:
s_add_u32 s62, s62, 4
s_add_u32 s61, s61, 32768
s_add_u32 m0, m0, 1024
s_bitcmp1_b32 s62, 5
s_cbranch_scc1 sq_444
buffer_load_dwordx4 v30, s[8:11], s61 offen lds
s_branch sq_445
sq_444:
buffer_load_dwordx4 v31, s[8:11], s61 offen lds
sq_445:
s_add_u32 s62, s62, 4
s_add_u32 s61, s61, 32768
s_add_u32 m0, m0, 1024
s_bitcmp1_b32 s62, 5
s_cbranch_scc1 sq_446
buffer_load_dwordx4 v30, s[8:11], s61 offen lds
s_branch sq_447
sq_446:
buffer_load_dwordx4 v31, s[8:11], s61 offen lds
sq_447:
s_add_u32 s62, s62, 4
s_add_u32 s61, s61, 32768
s_add_u32 m0, m0, 1024
s_bitcmp1_b32 s62, 5
s_cbranch_scc1 sq_448
buffer_load_dwordx4 v30, s[8:11], s61 offen lds
s_branch sq_449
sq_448:
buffer_load_dwordx4 v31, s[8:11], s61 offen lds
sq_449:
s_add_u32 s62, s62, 4
s_add_u32 s61, s61, 32768
s_add_u32 m0, m0, 1024
s_bitcmp1_b32 s62, 5
s_cbranch_scc1 sq_450
buffer_load_dwordx4 v30, s[8:11], s61 offen lds
s_branch sq_451
sq_450:
buffer_load_dwordx4 v31, s[8:11], s61 offen lds
sq_451:
s_add_u32 s62, s62, 4
s_add_u32 s61, s61, 32768
s_add_u32 m0, m0, 1024
s_bitcmp1_b32 s62, 5
s_cbranch_scc1 sq_452
buffer_load_dwordx4 v30, s[8:11], s61 offen lds
s_branch sq_453
sq_452:
buffer_load_dwordx4 v31, s[8:11], s61 offen lds
sq_453:
s_add_u32 s62, s62, 4
s_add_u32 s61, s61, 32768
s_add_u32 m0, m0, 1024
s_bitcmp1_b32 s62, 5
s_cbranch_scc1 sq_454
buffer_load_dwordx4 v30, s[8:11], s61 offen lds
s_branch sq_455
sq_454:
buffer_load_dwordx4 v31, s[8:11], s61 offen lds
sq_455:
s_add_u32 s62, s62, 4
s_add_u32 s61, s61, 32768
s_add_u32 m0, m0, 1024
s_bitcmp1_b32 s62, 5
s_cbranch_scc1 sq_456
buffer_load_dwordx4 v30, s[8:11], s61 offen lds
s_branch sq_457
sq_456:
buffer_load_dwordx4 v31, s[8:11], s61 offen lds
sq_457:
s_add_u32 s62, s62, 4
s_add_u32 s61, s61, 32768
s_add_u32 m0, m0, 1024
s_bitcmp1_b32 s62, 5
s_cbranch_scc1 sq_458
buffer_load_dwordx4 v30, s[8:11], s61 offen lds
s_branch sq_459
sq_458:
buffer_load_dwordx4 v31, s[8:11], s61 offen lds
sq_459:
s_add_u32 s62, s62, 4
s_add_u32 s61, s61, 32768
s_add_u32 m0, m0, 1024
s_bitcmp1_b32 s62, 5
s_cbranch_scc1 sq_460
buffer_load_dwordx4 v30, s[8:11], s61 offen lds
s_branch sq_461
sq_460:
buffer_load_dwordx4 v31, s[8:11], s61 offen lds
sq_461:
s_add_u32 s62, s62, 4
s_add_u32 s61, s61, 32768
s_add_u32 m0, m0, 1024
s_waitcnt vmcnt(21)
s_barrier
v_lshrrev_b32 v24, 4, v0
v_lshlrev_b32 v24, 3, v24
v_bfe_u32 v25, v0, 2, 2
v_add_u32 v24, v24, v25
v_mul_u32_u24 v24, 1152, v24
v_and_b32 v25, 3, v0
v_lshl_add_u32 v24, v25, 3, v24
s_mul_i32 s60, s3, 288
s_add_u32 s60, s60, 98304
v_add_u32 v28, s60, v24
ds_read_b64_tr_b16 v[112:113], v28 offset:0
ds_read_b64_tr_b16 v[114:115], v28 offset:4608
ds_read_b64_tr_b16 v[128:129], v28 offset:32
ds_read_b64_tr_b16 v[130:131], v28 offset:4640
ds_read_b64_tr_b16 v[144:145], v28 offset:64
ds_read_b64_tr_b16 v[146:147], v28 offset:4672
s_waitcnt lgkmcnt(0)
ds_read_b64_tr_b16 v[160:161], v28 offset:96
ds_read_b64_tr_b16 v[162:163], v28 offset:4704
ds_read_b64_tr_b16 v[176:177], v28 offset:128
ds_read_b64_tr_b16 v[178:179], v28 offset:4736
ds_read_b64_tr_b16 v[192:193], v28 offset:160
ds_read_b64_tr_b16 v[194:195], v28 offset:4768
s_waitcnt lgkmcnt(0)
ds_read_b64_tr_b16 v[208:209], v28 offset:192
ds_read_b64_tr_b16 v[210:211], v28 offset:4800
ds_read_b64_tr_b16 v[224:225], v28 offset:224
ds_read_b64_tr_b16 v[226:227], v28 offset:4832
ds_read_b64_tr_b16 v[240:241], v28 offset:256
ds_read_b64_tr_b16 v[242:243], v28 offset:4864
s_waitcnt lgkmcnt(0)
s_barrier
s_mov_b32 s8, s28
s_and_b32 s9, s29, 0xffff
s_mov_b32 s10, 4718592
s_mov_b32 s11, 0x20000
s_lshl_b32 s61, s51, 8
s_mul_i32 s60, s3, 393216
s_add_u32 s61, s61, s60
s_add_u32 s61, s61, 3145728
s_mul_i32 s60, s3, 12288
s_add_u32 m0, s60, 98304
s_mul_i32 s62, s3, 48
s_bitcmp1_b32 s62, 5
s_cbranch_scc1 sq_462
buffer_load_dwordx4 v30, s[8:11], s61 offen lds
s_branch sq_463
sq_462:
buffer_load_dwordx4 v31, s[8:11], s61 offen lds
sq_463:
s_add_u32 s62, s62, 4
s_add_u32 s61, s61, 32768
s_add_u32 m0, m0, 1024
s_bitcmp1_b32 s62, 5
s_cbranch_scc1 sq_464
buffer_load_dwordx4 v30, s[8:11], s61 offen lds
s_branch sq_465
sq_464:
buffer_load_dwordx4 v31, s[8:11], s61 offen lds
sq_465:
s_add_u32 s62, s62, 4
s_add_u32 s61, s61, 32768
s_add_u32 m0, m0, 1024
s_bitcmp1_b32 s62, 5
s_cbranch_scc1 sq_466
buffer_load_dwordx4 v30, s[8:11], s61 offen lds
s_branch sq_467
sq_466:
buffer_load_dwordx4 v31, s[8:11], s61 offen lds
sq_467:
s_add_u32 s62, s62, 4
s_add_u32 s61, s61, 32768
s_add_u32 m0, m0, 1024
s_bitcmp1_b32 s62, 5
s_cbranch_scc1 sq_468
buffer_load_dwordx4 v30, s[8:11], s61 offen lds
s_branch sq_469
sq_468:
buffer_load_dwordx4 v31, s[8:11], s61 offen lds
sq_469:
s_add_u32 s62, s62, 4
s_add_u32 s61, s61, 32768
s_add_u32 m0, m0, 1024
s_bitcmp1_b32 s62, 5
s_cbranch_scc1 sq_470
buffer_load_dwordx4 v30, s[8:11], s61 offen lds
s_branch sq_471
sq_470:
buffer_load_dwordx4 v31, s[8:11], s61 offen lds
sq_471:
s_add_u32 s62, s62, 4
s_add_u32 s61, s61, 32768
s_add_u32 m0, m0, 1024
s_bitcmp1_b32 s62, 5
s_cbranch_scc1 sq_472
buffer_load_dwordx4 v30, s[8:11], s61 offen lds
s_branch sq_473
sq_472:
buffer_load_dwordx4 v31, s[8:11], s61 offen lds
sq_473:
s_add_u32 s62, s62, 4
s_add_u32 s61, s61, 32768
s_add_u32 m0, m0, 1024
s_bitcmp1_b32 s62, 5
s_cbranch_scc1 sq_474
buffer_load_dwordx4 v30, s[8:11], s61 offen lds
s_branch sq_475
sq_474:
buffer_load_dwordx4 v31, s[8:11], s61 offen lds
sq_475:
s_add_u32 s62, s62, 4
s_add_u32 s61, s61, 32768
s_add_u32 m0, m0, 1024
s_bitcmp1_b32 s62, 5
s_cbranch_scc1 sq_476
buffer_load_dwordx4 v30, s[8:11], s61 offen lds
s_branch sq_477
sq_476:
buffer_load_dwordx4 v31, s[8:11], s61 offen lds
sq_477:
s_add_u32 s62, s62, 4
s_add_u32 s61, s61, 32768
s_add_u32 m0, m0, 1024
s_bitcmp1_b32 s62, 5
s_cbranch_scc1 sq_478
buffer_load_dwordx4 v30, s[8:11], s61 offen lds
s_branch sq_479
sq_478:
buffer_load_dwordx4 v31, s[8:11], s61 offen lds
sq_479:
s_add_u32 s62, s62, 4
s_add_u32 s61, s61, 32768
s_add_u32 m0, m0, 1024
s_bitcmp1_b32 s62, 5
s_cbranch_scc1 sq_480
buffer_load_dwordx4 v30, s[8:11], s61 offen lds
s_branch sq_481
sq_480:
buffer_load_dwordx4 v31, s[8:11], s61 offen lds
sq_481:
s_add_u32 s62, s62, 4
s_add_u32 s61, s61, 32768
s_add_u32 m0, m0, 1024
s_bitcmp1_b32 s62, 5
s_cbranch_scc1 sq_482
buffer_load_dwordx4 v30, s[8:11], s61 offen lds
s_branch sq_483
sq_482:
buffer_load_dwordx4 v31, s[8:11], s61 offen lds
sq_483:
s_add_u32 s62, s62, 4
s_add_u32 s61, s61, 32768
s_add_u32 m0, m0, 1024
s_bitcmp1_b32 s62, 5
s_cbranch_scc1 sq_484
buffer_load_dwordx4 v30, s[8:11], s61 offen lds
s_branch sq_485
sq_484:
buffer_load_dwordx4 v31, s[8:11], s61 offen lds
sq_485:
s_add_u32 s62, s62, 4
s_add_u32 s61, s61, 32768
s_add_u32 m0, m0, 1024
s_waitcnt vmcnt(24)
s_barrier
v_lshrrev_b32 v24, 4, v0
v_lshlrev_b32 v24, 3, v24
v_bfe_u32 v25, v0, 2, 2
v_add_u32 v24, v24, v25
v_mul_u32_u24 v24, 1152, v24
v_and_b32 v25, 3, v0
v_lshl_add_u32 v24, v25, 3, v24
s_mul_i32 s60, s3, 288
s_add_u32 s60, s60, 0
v_add_u32 v28, s60, v24
ds_read_b64_tr_b16 v[116:117], v28 offset:0
ds_read_b64_tr_b16 v[118:119], v28 offset:4608
ds_read_b64_tr_b16 v[132:133], v28 offset:32
ds_read_b64_tr_b16 v[134:135], v28 offset:4640
ds_read_b64_tr_b16 v[148:149], v28 offset:64
ds_read_b64_tr_b16 v[150:151], v28 offset:4672
s_waitcnt lgkmcnt(0)
ds_read_b64_tr_b16 v[164:165], v28 offset:96
ds_read_b64_tr_b16 v[166:167], v28 offset:4704
ds_read_b64_tr_b16 v[180:181], v28 offset:128
ds_read_b64_tr_b16 v[182:183], v28 offset:4736
ds_read_b64_tr_b16 v[196:197], v28 offset:160
ds_read_b64_tr_b16 v[198:199], v28 offset:4768
s_waitcnt lgkmcnt(0)
ds_read_b64_tr_b16 v[212:213], v28 offset:192
ds_read_b64_tr_b16 v[214:215], v28 offset:4800
ds_read_b64_tr_b16 v[228:229], v28 offset:224
ds_read_b64_tr_b16 v[230:231], v28 offset:4832
ds_read_b64_tr_b16 v[244:245], v28 offset:256
ds_read_b64_tr_b16 v[246:247], v28 offset:4864
s_waitcnt lgkmcnt(0)
s_barrier
s_mov_b32 s8, s28
s_and_b32 s9, s29, 0xffff
s_mov_b32 s10, 4718592
s_mov_b32 s11, 0x20000
s_lshl_b32 s61, s51, 8
s_mul_i32 s60, s3, 393216
s_add_u32 s61, s61, s60
s_add_u32 s61, s61, 0
s_mul_i32 s60, s3, 12288
s_add_u32 m0, s60, 0
s_mul_i32 s62, s3, 48
s_bitcmp1_b32 s62, 5
s_cbranch_scc1 sq_486
buffer_load_dwordx4 v30, s[8:11], s61 offen lds
s_branch sq_487
sq_486:
buffer_load_dwordx4 v31, s[8:11], s61 offen lds
sq_487:
s_add_u32 s62, s62, 4
s_add_u32 s61, s61, 32768
s_add_u32 m0, m0, 1024
s_bitcmp1_b32 s62, 5
s_cbranch_scc1 sq_488
buffer_load_dwordx4 v30, s[8:11], s61 offen lds
s_branch sq_489
sq_488:
buffer_load_dwordx4 v31, s[8:11], s61 offen lds
sq_489:
s_add_u32 s62, s62, 4
s_add_u32 s61, s61, 32768
s_add_u32 m0, m0, 1024
s_bitcmp1_b32 s62, 5
s_cbranch_scc1 sq_490
buffer_load_dwordx4 v30, s[8:11], s61 offen lds
s_branch sq_491
sq_490:
buffer_load_dwordx4 v31, s[8:11], s61 offen lds
sq_491:
s_add_u32 s62, s62, 4
s_add_u32 s61, s61, 32768
s_add_u32 m0, m0, 1024
s_bitcmp1_b32 s62, 5
s_cbranch_scc1 sq_492
buffer_load_dwordx4 v30, s[8:11], s61 offen lds
s_branch sq_493
sq_492:
buffer_load_dwordx4 v31, s[8:11], s61 offen lds
sq_493:
s_add_u32 s62, s62, 4
s_add_u32 s61, s61, 32768
s_add_u32 m0, m0, 1024
s_bitcmp1_b32 s62, 5
s_cbranch_scc1 sq_494
buffer_load_dwordx4 v30, s[8:11], s61 offen lds
s_branch sq_495
sq_494:
buffer_load_dwordx4 v31, s[8:11], s61 offen lds
sq_495:
s_add_u32 s62, s62, 4
s_add_u32 s61, s61, 32768
s_add_u32 m0, m0, 1024
s_bitcmp1_b32 s62, 5
s_cbranch_scc1 sq_496
buffer_load_dwordx4 v30, s[8:11], s61 offen lds
s_branch sq_497
sq_496:
buffer_load_dwordx4 v31, s[8:11], s61 offen lds
sq_497:
s_add_u32 s62, s62, 4
s_add_u32 s61, s61, 32768
s_add_u32 m0, m0, 1024
s_bitcmp1_b32 s62, 5
s_cbranch_scc1 sq_498
buffer_load_dwordx4 v30, s[8:11], s61 offen lds
s_branch sq_499
sq_498:
buffer_load_dwordx4 v31, s[8:11], s61 offen lds
sq_499:
s_add_u32 s62, s62, 4
s_add_u32 s61, s61, 32768
s_add_u32 m0, m0, 1024
s_bitcmp1_b32 s62, 5
s_cbranch_scc1 sq_500
buffer_load_dwordx4 v30, s[8:11], s61 offen lds
s_branch sq_501
sq_500:
buffer_load_dwordx4 v31, s[8:11], s61 offen lds
sq_501:
s_add_u32 s62, s62, 4
s_add_u32 s61, s61, 32768
s_add_u32 m0, m0, 1024
s_bitcmp1_b32 s62, 5
s_cbranch_scc1 sq_502
buffer_load_dwordx4 v30, s[8:11], s61 offen lds
s_branch sq_503
sq_502:
buffer_load_dwordx4 v31, s[8:11], s61 offen lds
sq_503:
s_add_u32 s62, s62, 4
s_add_u32 s61, s61, 32768
s_add_u32 m0, m0, 1024
s_bitcmp1_b32 s62, 5
s_cbranch_scc1 sq_504
buffer_load_dwordx4 v30, s[8:11], s61 offen lds
s_branch sq_505
sq_504:
buffer_load_dwordx4 v31, s[8:11], s61 offen lds
sq_505:
s_add_u32 s62, s62, 4
s_add_u32 s61, s61, 32768
s_add_u32 m0, m0, 1024
s_bitcmp1_b32 s62, 5
s_cbranch_scc1 sq_506
buffer_load_dwordx4 v30, s[8:11], s61 offen lds
s_branch sq_507
sq_506:
buffer_load_dwordx4 v31, s[8:11], s61 offen lds
sq_507:
s_add_u32 s62, s62, 4
s_add_u32 s61, s61, 32768
s_add_u32 m0, m0, 1024
s_bitcmp1_b32 s62, 5
s_cbranch_scc1 sq_508
buffer_load_dwordx4 v30, s[8:11], s61 offen lds
s_branch sq_509
sq_508:
buffer_load_dwordx4 v31, s[8:11], s61 offen lds
sq_509:
s_add_u32 s62, s62, 4
s_add_u32 s61, s61, 32768
s_add_u32 m0, m0, 1024
s_waitcnt vmcnt(24)
s_barrier
v_bfe_u32 v24, v0, 4, 1
v_lshrrev_b32 v25, 5, v0
v_bfe_u32 v26, v0, 2, 2
v_lshlrev_b32 v27, 5, v24
v_lshl_add_u32 v27, v25, 3, v27
v_add_u32 v27, v27, v26
v_lshlrev_b32 v27, 8, v27
v_lshl_add_u32 v26, v24, 2, v26
s_lshl_b32 s60, s3, 1
s_add_u32 s60, s60, 0
v_xor_b32 v26, s60, v26
v_lshl_add_u32 v27, v26, 5, v27
v_and_b32 v26, 3, v0
v_lshl_add_u32 v28, v26, 3, v27
v_add_u32 v28, 49152, v28
v_bfe_u32 v24, v0, 4, 1
v_lshrrev_b32 v25, 5, v0
v_bfe_u32 v26, v0, 2, 2
v_lshlrev_b32 v27, 5, v24
v_lshl_add_u32 v27, v25, 3, v27
v_add_u32 v27, v27, v26
v_lshlrev_b32 v27, 8, v27
v_lshl_add_u32 v26, v24, 2, v26
s_lshl_b32 s60, s3, 1
s_add_u32 s60, s60, 1
v_xor_b32 v26, s60, v26
v_lshl_add_u32 v27, v26, 5, v27
v_and_b32 v26, 3, v0
v_lshl_add_u32 v29, v26, 3, v27
v_add_u32 v29, 49152, v29
ds_read_b64_tr_b16 v[32:33], v28 offset:0
ds_read_b64_tr_b16 v[34:35], v28 offset:1024
ds_read_b64_tr_b16 v[36:37], v28 offset:4096
ds_read_b64_tr_b16 v[38:39], v28 offset:5120
ds_read_b64_tr_b16 v[40:41], v29 offset:0
ds_read_b64_tr_b16 v[42:43], v29 offset:1024
ds_read_b64_tr_b16 v[44:45], v29 offset:4096
ds_read_b64_tr_b16 v[46:47], v29 offset:5120
s_waitcnt lgkmcnt(0)
ds_read_b64_tr_b16 v[48:49], v28 offset:16384
ds_read_b64_tr_b16 v[50:51], v28 offset:17408
ds_read_b64_tr_b16 v[52:53], v28 offset:20480
ds_read_b64_tr_b16 v[54:55], v28 offset:21504
ds_read_b64_tr_b16 v[56:57], v29 offset:16384
ds_read_b64_tr_b16 v[58:59], v29 offset:17408
ds_read_b64_tr_b16 v[60:61], v29 offset:20480
ds_read_b64_tr_b16 v[62:63], v29 offset:21504
s_waitcnt lgkmcnt(0)
ds_read_b64_tr_b16 v[64:65], v28 offset:32768
ds_read_b64_tr_b16 v[66:67], v28 offset:33792
ds_read_b64_tr_b16 v[68:69], v28 offset:36864
ds_read_b64_tr_b16 v[70:71], v28 offset:37888
ds_read_b64_tr_b16 v[248:249], v29 offset:32768
ds_read_b64_tr_b16 v[250:251], v29 offset:33792
ds_read_b64_tr_b16 v[252:253], v29 offset:36864
ds_read_b64_tr_b16 v[254:255], v29 offset:37888
s_waitcnt lgkmcnt(0)
s_barrier
s_lshl_b32 s60, s3, 12
s_add_u32 s60, s60, 49152
v_add_u32 v28, s60, v1
ds_write_b128 v28, v[32:35] offset:0
ds_write_b128 v28, v[36:39] offset:1024
ds_write_b128 v28, v[40:43] offset:2048
ds_write_b128 v28, v[44:47] offset:3072
ds_write_b128 v28, v[48:51] offset:16384
ds_write_b128 v28, v[52:55] offset:17408
ds_write_b128 v28, v[56:59] offset:18432
ds_write_b128 v28, v[60:63] offset:19456
ds_write_b128 v28, v[64:67] offset:32768
ds_write_b128 v28, v[68:71] offset:33792
ds_write_b128 v28, v[248:251] offset:34816
ds_write_b128 v28, v[252:255] offset:35840
s_waitcnt lgkmcnt(0)
s_barrier
s_waitcnt vmcnt(0)
s_barrier
v_bfe_u32 v24, v0, 4, 1
v_lshrrev_b32 v25, 5, v0
v_bfe_u32 v26, v0, 2, 2
v_lshlrev_b32 v27, 5, v24
v_lshl_add_u32 v27, v25, 3, v27
v_add_u32 v27, v27, v26
v_lshlrev_b32 v27, 8, v27
v_lshl_add_u32 v26, v24, 2, v26
s_lshl_b32 s60, s3, 1
s_add_u32 s60, s60, 0
v_xor_b32 v26, s60, v26
v_lshl_add_u32 v27, v26, 5, v27
v_and_b32 v26, 3, v0
v_lshl_add_u32 v28, v26, 3, v27
v_bfe_u32 v24, v0, 4, 1
v_lshrrev_b32 v25, 5, v0
v_bfe_u32 v26, v0, 2, 2
v_lshlrev_b32 v27, 5, v24
v_lshl_add_u32 v27, v25, 3, v27
v_add_u32 v27, v27, v26
v_lshlrev_b32 v27, 8, v27
v_lshl_add_u32 v26, v24, 2, v26
s_lshl_b32 s60, s3, 1
s_add_u32 s60, s60, 1
v_xor_b32 v26, s60, v26
v_lshl_add_u32 v27, v26, 5, v27
v_and_b32 v26, 3, v0
v_lshl_add_u32 v29, v26, 3, v27
ds_read_b64_tr_b16 v[32:33], v28 offset:0
ds_read_b64_tr_b16 v[34:35], v28 offset:1024
ds_read_b64_tr_b16 v[36:37], v28 offset:4096
ds_read_b64_tr_b16 v[38:39], v28 offset:5120
ds_read_b64_tr_b16 v[40:41], v29 offset:0
ds_read_b64_tr_b16 v[42:43], v29 offset:1024
ds_read_b64_tr_b16 v[44:45], v29 offset:4096
ds_read_b64_tr_b16 v[46:47], v29 offset:5120
s_waitcnt lgkmcnt(0)
ds_read_b64_tr_b16 v[48:49], v28 offset:16384
ds_read_b64_tr_b16 v[50:51], v28 offset:17408
ds_read_b64_tr_b16 v[52:53], v28 offset:20480
ds_read_b64_tr_b16 v[54:55], v28 offset:21504
ds_read_b64_tr_b16 v[56:57], v29 offset:16384
ds_read_b64_tr_b16 v[58:59], v29 offset:17408
ds_read_b64_tr_b16 v[60:61], v29 offset:20480
ds_read_b64_tr_b16 v[62:63], v29 offset:21504
s_waitcnt lgkmcnt(0)
ds_read_b64_tr_b16 v[64:65], v28 offset:32768
ds_read_b64_tr_b16 v[66:67], v28 offset:33792
ds_read_b64_tr_b16 v[68:69], v28 offset:36864
ds_read_b64_tr_b16 v[70:71], v28 offset:37888
ds_read_b64_tr_b16 v[248:249], v29 offset:32768
ds_read_b64_tr_b16 v[250:251], v29 offset:33792
ds_read_b64_tr_b16 v[252:253], v29 offset:36864
ds_read_b64_tr_b16 v[254:255], v29 offset:37888
s_waitcnt lgkmcnt(0)
s_barrier
s_lshl_b32 s60, s3, 12
s_add_u32 s60, s60, 0
v_add_u32 v28, s60, v1
ds_write_b128 v28, v[32:35] offset:0
ds_write_b128 v28, v[36:39] offset:1024
ds_write_b128 v28, v[40:43] offset:2048
ds_write_b128 v28, v[44:47] offset:3072
ds_write_b128 v28, v[48:51] offset:16384
ds_write_b128 v28, v[52:55] offset:17408
ds_write_b128 v28, v[56:59] offset:18432
ds_write_b128 v28, v[60:63] offset:19456
ds_write_b128 v28, v[64:67] offset:32768
ds_write_b128 v28, v[68:71] offset:33792
ds_write_b128 v28, v[248:251] offset:34816
ds_write_b128 v28, v[252:255] offset:35840
s_waitcnt lgkmcnt(0)
s_barrier
s_waitcnt vmcnt(12)
s_barrier
v_bfe_u32 v24, v0, 4, 1
v_lshrrev_b32 v25, 5, v0
v_bfe_u32 v26, v0, 2, 2
v_lshlrev_b32 v27, 5, v24
v_lshl_add_u32 v27, v25, 3, v27
v_add_u32 v27, v27, v26
v_lshlrev_b32 v27, 8, v27
v_lshl_add_u32 v26, v24, 2, v26
s_lshl_b32 s60, s3, 1
s_add_u32 s60, s60, 0
v_xor_b32 v26, s60, v26
v_lshl_add_u32 v27, v26, 5, v27
v_and_b32 v26, 3, v0
v_lshl_add_u32 v28, v26, 3, v27
v_add_u32 v28, 98304, v28
v_bfe_u32 v24, v0, 4, 1
v_lshrrev_b32 v25, 5, v0
v_bfe_u32 v26, v0, 2, 2
v_lshlrev_b32 v27, 5, v24
v_lshl_add_u32 v27, v25, 3, v27
v_add_u32 v27, v27, v26
v_lshlrev_b32 v27, 8, v27
v_lshl_add_u32 v26, v24, 2, v26
s_lshl_b32 s60, s3, 1
s_add_u32 s60, s60, 1
v_xor_b32 v26, s60, v26
v_lshl_add_u32 v27, v26, 5, v27
v_and_b32 v26, 3, v0
v_lshl_add_u32 v29, v26, 3, v27
v_add_u32 v29, 98304, v29
ds_read_b64_tr_b16 v[32:33], v28 offset:0
ds_read_b64_tr_b16 v[34:35], v28 offset:1024
ds_read_b64_tr_b16 v[36:37], v28 offset:4096
ds_read_b64_tr_b16 v[38:39], v28 offset:5120
ds_read_b64_tr_b16 v[40:41], v29 offset:0
ds_read_b64_tr_b16 v[42:43], v29 offset:1024
ds_read_b64_tr_b16 v[44:45], v29 offset:4096
ds_read_b64_tr_b16 v[46:47], v29 offset:5120
s_waitcnt lgkmcnt(0)
ds_read_b64_tr_b16 v[48:49], v28 offset:16384
ds_read_b64_tr_b16 v[50:51], v28 offset:17408
ds_read_b64_tr_b16 v[52:53], v28 offset:20480
ds_read_b64_tr_b16 v[54:55], v28 offset:21504
ds_read_b64_tr_b16 v[56:57], v29 offset:16384
ds_read_b64_tr_b16 v[58:59], v29 offset:17408
ds_read_b64_tr_b16 v[60:61], v29 offset:20480
ds_read_b64_tr_b16 v[62:63], v29 offset:21504
s_waitcnt lgkmcnt(0)
ds_read_b64_tr_b16 v[64:65], v28 offset:32768
ds_read_b64_tr_b16 v[66:67], v28 offset:33792
ds_read_b64_tr_b16 v[68:69], v28 offset:36864
ds_read_b64_tr_b16 v[70:71], v28 offset:37888
ds_read_b64_tr_b16 v[248:249], v29 offset:32768
ds_read_b64_tr_b16 v[250:251], v29 offset:33792
ds_read_b64_tr_b16 v[252:253], v29 offset:36864
ds_read_b64_tr_b16 v[254:255], v29 offset:37888
s_waitcnt lgkmcnt(0)
s_barrier
s_lshl_b32 s60, s3, 12
s_add_u32 s60, s60, 98304
v_add_u32 v28, s60, v1
ds_write_b128 v28, v[32:35] offset:0
ds_write_b128 v28, v[36:39] offset:1024
ds_write_b128 v28, v[40:43] offset:2048
ds_write_b128 v28, v[44:47] offset:3072
ds_write_b128 v28, v[48:51] offset:16384
ds_write_b128 v28, v[52:55] offset:17408
ds_write_b128 v28, v[56:59] offset:18432
ds_write_b128 v28, v[60:63] offset:19456
s_lshl_b32 s60, s3, 11
s_add_u32 s60, s60, 131072
v_add_u32 v29, s60, v1
ds_write_b128 v29, v[64:67] offset:0
ds_write_b128 v29, v[68:71] offset:1024
s_waitcnt lgkmcnt(0)
s_barrier
s_lshl_b32 s60, s3, 6
v_add_u32 v24, s60, v0
v_lshlrev_b32 v25, 2, v24
v_add_u32 v25, 139264, v25
ds_write_b32 v25, v16 offset:0
ds_write_b32 v25, v17 offset:1024
ds_write_b32 v25, v18 offset:2048
ds_write_b32 v25, v19 offset:3072
ds_write_b32 v25, v20 offset:4096
ds_write_b32 v25, v21 offset:5120
ds_write_b32 v25, v22 offset:6144
ds_write_b32 v25, v23 offset:7168
ds_write_b32 v25, v14 offset:8192
s_waitcnt lgkmcnt(0)
s_mov_b32 s67, 0
v_mov_b32 v25, s57
cbp_510:
buffer_load_dword v24, v25, s[12:15], 0 offen sc1
s_add_u32 s67, s67, 1
s_cmp_gt_u32 s67, 400000
s_cbranch_scc1 chain_fail_290
s_waitcnt vmcnt(0)
v_readfirstlane_b32 s61, v24
s_nop 0
s_and_b32 s60, s61, 0xffff
s_cmp_lt_u32 s60, 32
s_cbranch_scc1 cbp_510
s_lshr_b32 s47, s61, 16
s_mov_b32 s12, s40
s_and_b32 s13, s41, 0xffff
s_mov_b32 s14, 256
s_mov_b32 s15, 0x20000
v_lshlrev_b32 v24, 2, v0
v_add_u32 v25, 128, v24
v_cmp_le_u32 vcc, 2, v0
s_nop 1
v_cndmask_b32 v24, v24, v25, vcc
v_mov_b32 v25, 192
v_cmp_eq_u32 vcc, 8, v0
s_nop 1
v_cndmask_b32 v24, v24, v25, vcc
v_mov_b32 v25, 2147483632
v_cmp_lt_u32 vcc, 8, v0
s_nop 1
v_cndmask_b32 v24, v24, v25, vcc
s_mov_b32 s98, 0
wi_loop_511:
buffer_load_dword v25, v24, s[12:15], 0 offen sc1
s_add_u32 s98, s98, 1
s_cmp_gt_u32 s98, 150000
s_cbranch_scc1 wi_bad_513
s_waitcnt vmcnt(0)
v_cmp_eq_u32 vcc, 32, v25
s_nop 0
s_and_b32 s97, vcc_lo, 0x1ff
s_cmp_eq_u32 s97, 0x1ff
s_cbranch_scc1 wi_ok_512
v_cmp_lt_u32 vcc, 32, v25
s_nop 0
s_and_b32 s96, vcc_lo, 0xff
s_cselect_b32 s96, 0x100, 0
s_and_b32 s96, s96, s97
s_cbranch_scc1 wi_over_514
s_sleep 8
s_branch wi_loop_511
wi_bad_513:
s_mov_b32 s98, 512
s_branch L_fail
wi_over_514:
s_mov_b32 s100, 255
wi_ok_512:
s_mov_b32 s98, 0xff800000
s_mov_b32 s99, 0xff800000
s_cmp_lg_u32 s47, 0
s_cbranch_scc1 chain_foreign_515
s_mov_b32 s62, 0
s_lshl_b32 s65, s3, 11
s_add_u32 s65, s65, 16384
s_mul_i32 s63, s51, 24576
s_add_u32 s63, s63, s53
s_mul_i32 s77, s51, 4096
s_add_u32 s77, s77, s54
v_mov_b64 v[48:49], 0
v_mov_b64 v[50:51], 0
v_mov_b64 v[52:53], 0
v_mov_b64 v[54:55], 0
v_mov_b64 v[56:57], 0
v_mov_b64 v[58:59], 0
v_mov_b64 v[60:61], 0
v_mov_b64 v[62:63], 0
v_mov_b64 v[64:65], 0
v_mov_b64 v[66:67], 0
v_mov_b64 v[68:69], 0
v_mov_b64 v[70:71], 0
s_lshl_b32 s60, s3, 12
v_add_u32 v15, s60, v1
s_lshl_b32 s60, s3, 11
s_add_u32 s60, s60, 131072
v_add_u32 v14, s60, v1
s_cmp_lg_u32 s3, 3
s_cbranch_scc1 kx0_516
s_add_u32 s61, s62, 1
s_mov_b32 s67, 0
sp_loop_517:
buffer_load_dword v32, v7, s[4:7], s58 offen sc1
s_add_u32 s67, s67, 1
s_cmp_gt_u32 s67, 150000
s_cbranch_scc1 sp_bad_519
s_waitcnt vmcnt(0)
v_cmp_gt_u32 vcc, s61, v32
s_nop 0
s_and_b32 vcc_lo, vcc_lo, 15
s_cbranch_scc0 sp_ok_518
s_sleep 1
s_branch sp_loop_517
sp_bad_519:
s_mov_b32 s98, 1792
s_branch L_fail
sp_ok_518:
kx0_516:
s_barrier
chain_loop_520:
ds_read_b64_tr_b16 v[24:25], v2 offset:0
ds_read_b64_tr_b16 v[26:27], v2 offset:512
ds_read_b128 v[32:35], v15 offset:0
ds_read_b128 v[36:39], v15 offset:1024
ds_read_b64_tr_b16 v[28:29], v2 offset:1024
ds_read_b64_tr_b16 v[30:31], v2 offset:1536
s_sub_u32 s60, s65, 8192
s_add_u32 m0, s60, 146432
s_add_u32 s60, s60, s63
v_lshlrev_b32 v13, 5, v0
s_add_u32 s61, s63, s65
buffer_load_dwordx4 v1, s[4:7], s60 offen offset:0 sc1 lds
buffer_load_dwordx4 v1, s[4:7], s60 offen offset:1024 sc1 lds
buffer_load_dword v13, v13, s[4:7], s61 offen sc1
v_mov_b32 v42, s62
buffer_store_dword v42, v8, s[4:7], s58 offen sc1
s_waitcnt lgkmcnt(4)
v_smfmac_f32_16x16x64_bf16 v[48:51], v[24:27], a[0:7], v3
ds_read_b128 v[40:43], v15 offset:2048
v_smfmac_f32_16x16x64_bf16 v[52:55], v[24:27], a[72:79], v3
ds_read_b128 v[44:47], v15 offset:3072
v_smfmac_f32_16x16x64_bf16 v[56:59], v[24:27], a[144:151], v3
ds_read_b128 v[16:19], v15 offset:16384
v_smfmac_f32_16x16x64_bf16 v[60:63], v[24:27], a[216:223], v3
ds_read_b128 v[20:23], v15 offset:17408
s_waitcnt lgkmcnt(6)
v_smfmac_f32_16x16x64_bf16 v[64:67], v[24:27], v[32:39], v3
ds_read_b128 v[32:35], v15 offset:18432
s_waitcnt lgkmcnt(3)
v_smfmac_f32_16x16x64_bf16 v[68:71], v[24:27], v[40:47], v3
ds_read_b128 v[36:39], v15 offset:19456
v_smfmac_f32_16x16x64_bf16 v[48:51], v[28:31], a[8:15], v3
ds_read_b64_tr_b16 v[24:25], v2 offset:2048
v_smfmac_f32_16x16x64_bf16 v[52:55], v[28:31], a[80:87], v3
ds_read_b64_tr_b16 v[26:27], v2 offset:2560
v_smfmac_f32_16x16x64_bf16 v[56:59], v[28:31], a[152:159], v3
ds_read_b128 v[40:43], v15 offset:32768
v_smfmac_f32_16x16x64_bf16 v[60:63], v[28:31], a[224:231], v3
ds_read_b128 v[44:47], v15 offset:33792
s_waitcnt lgkmcnt(6)
v_smfmac_f32_16x16x64_bf16 v[64:67], v[28:31], v[16:23], v3
ds_read_b128 v[16:19], v15 offset:34816
s_waitcnt lgkmcnt(5)
v_smfmac_f32_16x16x64_bf16 v[68:71], v[28:31], v[32:39], v3
ds_read_b128 v[20:23], v15 offset:35840
s_waitcnt lgkmcnt(4)
v_smfmac_f32_16x16x64_bf16 v[48:51], v[24:27], a[16:23], v3
ds_read_b64_tr_b16 v[28:29], v2 offset:3072
v_smfmac_f32_16x16x64_bf16 v[52:55], v[24:27], a[88:95], v3
ds_read_b64_tr_b16 v[30:31], v2 offset:3584
v_smfmac_f32_16x16x64_bf16 v[56:59], v[24:27], a[160:167], v3
ds_read_b128 v[32:35], v15 offset:49152
v_smfmac_f32_16x16x64_bf16 v[60:63], v[24:27], a[232:239], v3
ds_read_b128 v[36:39], v15 offset:50176
s_waitcnt lgkmcnt(6)
v_smfmac_f32_16x16x64_bf16 v[64:67], v[24:27], v[40:47], v3
ds_read_b128 v[40:43], v15 offset:51200
s_waitcnt lgkmcnt(5)
v_smfmac_f32_16x16x64_bf16 v[68:71], v[24:27], v[16:23], v3
ds_read_b128 v[44:47], v15 offset:52224
s_waitcnt lgkmcnt(4)
v_smfmac_f32_16x16x64_bf16 v[48:51], v[28:31], a[24:31], v3
ds_read_b64_tr_b16 v[24:25], v2 offset:4096
v_smfmac_f32_16x16x64_bf16 v[52:55], v[28:31], a[96:103], v3
ds_read_b64_tr_b16 v[26:27], v2 offset:4608
v_smfmac_f32_16x16x64_bf16 v[56:59], v[28:31], a[168:175], v3
v_add_u32 v15, 65536, v15
ds_read_b128 v[16:19], v15 offset:0
v_smfmac_f32_16x16x64_bf16 v[60:63], v[28:31], a[240:247], v3
ds_read_b128 v[20:23], v15 offset:1024
s_waitcnt lgkmcnt(6)
v_smfmac_f32_16x16x64_bf16 v[64:67], v[28:31], v[32:39], v3
ds_read_b128 v[32:35], v15 offset:2048
s_waitcnt lgkmcnt(5)
v_smfmac_f32_16x16x64_bf16 v[68:71], v[28:31], v[40:47], v3
ds_read_b128 v[36:39], v15 offset:3072
s_waitcnt lgkmcnt(4)
v_smfmac_f32_16x16x64_bf16 v[48:51], v[24:27], a[32:39], v3
ds_read_b64_tr_b16 v[28:29], v2 offset:5120
v_smfmac_f32_16x16x64_bf16 v[52:55], v[24:27], a[104:111], v3
ds_read_b64_tr_b16 v[30:31], v2 offset:5632
v_smfmac_f32_16x16x64_bf16 v[56:59], v[24:27], a[176:183], v3
ds_read_b128 v[40:43], v15 offset:16384
v_smfmac_f32_16x16x64_bf16 v[60:63], v[24:27], a[248:255], v3
ds_read_b128 v[44:47], v15 offset:17408
s_waitcnt lgkmcnt(6)
v_smfmac_f32_16x16x64_bf16 v[64:67], v[24:27], v[16:23], v3
ds_read_b128 v[16:19], v15 offset:18432
s_waitcnt lgkmcnt(5)
v_smfmac_f32_16x16x64_bf16 v[68:71], v[24:27], v[32:39], v3
ds_read_b128 v[20:23], v15 offset:19456
s_waitcnt lgkmcnt(4)
v_smfmac_f32_16x16x64_bf16 v[48:51], v[28:31], a[40:47], v3
ds_read_b64_tr_b16 v[24:25], v2 offset:6144
v_smfmac_f32_16x16x64_bf16 v[52:55], v[28:31], a[112:119], v3
ds_read_b64_tr_b16 v[26:27], v2 offset:6656
v_smfmac_f32_16x16x64_bf16 v[56:59], v[28:31], a[184:191], v3
ds_read_b128 v[32:35], v15 offset:32768
v_smfmac_f32_16x16x64_bf16 v[60:63], v[28:31], v[72:79], v3
ds_read_b128 v[36:39], v15 offset:33792
s_waitcnt lgkmcnt(6)
v_smfmac_f32_16x16x64_bf16 v[64:67], v[28:31], v[40:47], v3
ds_read_b128 v[40:43], v15 offset:34816
s_waitcnt lgkmcnt(5)
v_smfmac_f32_16x16x64_bf16 v[68:71], v[28:31], v[16:23], v3
ds_read_b128 v[44:47], v15 offset:35840
s_waitcnt lgkmcnt(4)
v_smfmac_f32_16x16x64_bf16 v[48:51], v[24:27], a[48:55], v3
ds_read_b64_tr_b16 v[28:29], v2 offset:7168
v_smfmac_f32_16x16x64_bf16 v[52:55], v[24:27], a[120:127], v3
ds_read_b64_tr_b16 v[30:31], v2 offset:7680
v_smfmac_f32_16x16x64_bf16 v[56:59], v[24:27], a[192:199], v3
ds_read_b128 v[16:19], v15 offset:49152
v_smfmac_f32_16x16x64_bf16 v[60:63], v[24:27], v[80:87], v3
ds_read_b128 v[20:23], v15 offset:50176
s_waitcnt lgkmcnt(6)
v_smfmac_f32_16x16x64_bf16 v[64:67], v[24:27], v[32:39], v3
ds_read_b128 v[32:35], v15 offset:51200
s_waitcnt lgkmcnt(5)
v_smfmac_f32_16x16x64_bf16 v[68:71], v[24:27], v[40:47], v3
ds_read_b128 v[36:39], v15 offset:52224
s_waitcnt lgkmcnt(4)
v_smfmac_f32_16x16x64_bf16 v[48:51], v[28:31], a[56:63], v3
ds_read_b64_tr_b16 v[24:25], v2 offset:8192
v_smfmac_f32_16x16x64_bf16 v[52:55], v[28:31], a[128:135], v3
ds_read_b64_tr_b16 v[26:27], v2 offset:8704
v_smfmac_f32_16x16x64_bf16 v[56:59], v[28:31], a[200:207], v3
ds_read_b128 v[40:43], v14 offset:0
v_smfmac_f32_16x16x64_bf16 v[60:63], v[28:31], v[88:95], v3
ds_read_b128 v[44:47], v14 offset:1024
s_waitcnt lgkmcnt(6)
v_smfmac_f32_16x16x64_bf16 v[64:67], v[28:31], v[16:23], v3
v_add_u32 v15, 152576, v1
s_waitcnt lgkmcnt(4)
v_smfmac_f32_16x16x64_bf16 v[68:71], v[28:31], v[32:39], v3
s_waitcnt lgkmcnt(2)
v_smfmac_f32_16x16x64_bf16 v[48:51], v[24:27], a[64:71], v3
v_smfmac_f32_16x16x64_bf16 v[52:55], v[24:27], a[136:143], v3
v_smfmac_f32_16x16x64_bf16 v[56:59], v[24:27], a[208:215], v3
v_smfmac_f32_16x16x64_bf16 v[60:63], v[24:27], v[96:103], v3
s_waitcnt lgkmcnt(0)
v_smfmac_f32_16x16x64_bf16 v[64:67], v[24:27], v[40:47], v3
v_smfmac_f32_16x16x64_bf16 v[68:71], v[24:27], v[248:255], v3
s_nop 3
v_add_f32 v56, v56, v57
v_add_f32 v58, v58, v59
v_add_f32 v48, v48, v49
v_add_f32 v50, v50, v51
v_cvt_pk_bf16_f32 v24, v56, v58
v_cvt_pk_bf16_f32 v25, v48, v50
ds_write_b64 v4, v[24:25] offset:0
v_add_f32 v60, v60, v61
v_add_f32 v62, v62, v63
v_add_f32 v52, v52, v53
v_add_f32 v54, v54, v55
v_cvt_pk_bf16_f32 v26, v60, v62
v_cvt_pk_bf16_f32 v27, v52, v54
ds_write_b64 v4, v[26:27] offset:512
v_add_f32 v64, v64, v65
v_add_f32 v66, v66, v67
v_cvt_pk_bf16_f32 v28, v64, v66
v_add_f32 v68, v68, v69
v_add_f32 v70, v70, v71
v_cvt_pk_bf16_f32 v29, v68, v70
s_add_u32 s61, s63, s65
buffer_load_dwordx4 v[16:19], v1, s[4:7], s61 offen sc1
buffer_load_dwordx4 v[20:23], v1, s[4:7], s61 offen offset:1024 sc1
s_waitcnt vmcnt(3) lgkmcnt(0)
s_barrier
ds_read_b64_tr_b16 v[48:49], v5 offset:0
ds_read_b64_tr_b16 v[50:51], v5 offset:256
ds_read_b128 v[32:35], v15 offset:2048
ds_read_b128 v[36:39], v15 offset:3072
ds_read_b64_tr_b16 v[52:53], v5 offset:1024
ds_read_b64_tr_b16 v[54:55], v5 offset:1280
ds_read_b128 v[40:43], v15 offset:4096
ds_read_b128 v[44:47], v15 offset:5120
ds_read_b64_tr_b16 v[64:65], v5 offset:2048
ds_read_b64_tr_b16 v[66:67], v5 offset:2304
ds_read_b64_tr_b16 v[68:69], v5 offset:3072
ds_read_b64_tr_b16 v[70:71], v5 offset:3328
buffer_store_dwordx2 v[28:29], v11, s[4:7], s77 offen sc1
v_mov_b64 v[24:25], 0
v_mov_b64 v[26:27], s[98:99]
s_waitcnt lgkmcnt(10)
s_nop 0
v_mfma_f32_16x16x32_bf16 v[24:27], v[48:51], v[48:51], v[24:27]
s_waitcnt lgkmcnt(8)
v_mfma_f32_16x16x32_bf16 v[56:59], v[32:35], v[48:51], 0
v_mfma_f32_16x16x32_bf16 v[60:63], v[36:39], v[48:51], 0
ds_read_b128 v[32:35], v15 offset:6144
ds_read_b128 v[36:39], v15 offset:7168
s_waitcnt lgkmcnt(8)
v_mfma_f32_16x16x32_bf16 v[24:27], v[52:55], v[52:55], v[24:27]
s_waitcnt lgkmcnt(6)
v_mfma_f32_16x16x32_bf16 v[56:59], v[40:43], v[52:55], v[56:59]
v_mfma_f32_16x16x32_bf16 v[60:63], v[44:47], v[52:55], v[60:63]
ds_read_b128 v[40:43], v15 offset:8192
ds_read_b128 v[44:47], v15 offset:9216
s_waitcnt lgkmcnt(6)
v_mfma_f32_16x16x32_bf16 v[24:27], v[64:67], v[64:67], v[24:27]
s_waitcnt lgkmcnt(2)
v_mfma_f32_16x16x32_bf16 v[56:59], v[32:35], v[64:67], v[56:59]
v_mfma_f32_16x16x32_bf16 v[60:63], v[36:39], v[64:67], v[60:63]
v_mfma_f32_16x16x32_bf16 v[24:27], v[68:71], v[68:71], v[24:27]
s_waitcnt lgkmcnt(0)
v_mfma_f32_16x16x32_bf16 v[56:59], v[40:43], v[68:71], v[56:59]
v_mfma_f32_16x16x32_bf16 v[60:63], v[44:47], v[68:71], v[60:63]
s_mov_b32 exec_lo, 0x33333333
s_mov_b32 exec_hi, 0x33333333
s_cmp_ge_u32 s3, 2
s_cbranch_scc1 km23_522
s_bitcmp1_b32 s3, 0
s_cbranch_scc1 km_523
buffer_store_dwordx4 v[48:51], v12, s[4:7], s77 offen offset:0 sc1
s_branch kmd_521
km_523:
buffer_store_dwordx4 v[52:55], v12, s[4:7], s77 offen offset:512 sc1
s_branch kmd_521
km23_522:
s_bitcmp1_b32 s3, 0
s_cbranch_scc1 km_524
buffer_store_dwordx4 v[64:67], v12, s[4:7], s77 offen offset:1024 sc1
s_branch kmd_521
km_524:
buffer_store_dwordx4 v[68:71], v12, s[4:7], s77 offen offset:1536 sc1
kmd_521:
s_mov_b64 exec, -1
s_cmp_eq_u32 s62, 63
s_cbranch_scc1 chain_done_291
v_mov_b32 v36, 0x3f803f80
v_mov_b32 v37, 0x3f803f80
v_mov_b32 v45, 0
v_mov_b32 v46, 0
v_mov_b64 v[38:39], v[36:37]
v_max3_f32 v32, v24, v25, v56
v_max3_f32 v32, v32, v57, v58
v_max3_f32 v32, v32, v59, v60
v_max3_f32 v32, v32, v61, v62
v_max_f32 v32, v32, v63
v_mov_b32 v33, v32
s_add_u32 s63, s63, 786432
s_add_u32 s62, s62, 1
v_permlane16_swap_b32 v33, v32
v_max_f32 v32, v32, v33
v_mov_b32 v33, v32
s_and_b32 s64, s62, 1
s_nop 0
v_permlane32_swap_b32 v33, v32
v_max_f32 v32, v32, v33
v_mul_f32 v32, s66, v32
v_pk_fma_f32 v[24:25], v[24:25], s[66:67], v[32:33] op_sel_hi:[1,0,0] neg_lo:[0,0,1] neg_hi:[0,0,1]
v_pk_fma_f32 v[56:57], v[56:57], s[66:67], v[32:33] op_sel_hi:[1,0,0] neg_lo:[0,0,1] neg_hi:[0,0,1]
v_pk_fma_f32 v[58:59], v[58:59], s[66:67], v[32:33] op_sel_hi:[1,0,0] neg_lo:[0,0,1] neg_hi:[0,0,1]
v_pk_fma_f32 v[60:61], v[60:61], s[66:67], v[32:33] op_sel_hi:[1,0,0] neg_lo:[0,0,1] neg_hi:[0,0,1]
v_pk_fma_f32 v[62:63], v[62:63], s[66:67], v[32:33] op_sel_hi:[1,0,0] neg_lo:[0,0,1] neg_hi:[0,0,1]
v_exp_f32 v24, v24
v_exp_f32 v25, v25
v_exp_f32 v56, v56
v_exp_f32 v57, v57
v_cvt_pk_bf16_f32 v44, v24, v25
v_cvt_pk_bf16_f32 v47, v24, v25
v_exp_f32 v58, v58
v_exp_f32 v59, v59
v_mfma_f32_16x16x16_bf16 v[48:51], v[36:37], v[44:45], 0
v_exp_f32 v60, v60
v_mfma_f32_16x16x16_bf16 v[68:71], v[28:29], v[46:47], 0
v_exp_f32 v61, v61
v_mfma_f32_16x16x16_bf16 v[64:67], v[28:29], v[44:45], 0
v_exp_f32 v62, v62
v_exp_f32 v63, v63
v_cvt_pk_bf16_f32 v40, v56, v57
v_cvt_pk_bf16_f32 v41, v58, v59
v_cvt_pk_bf16_f32 v42, v60, v61
v_cvt_pk_bf16_f32 v43, v62, v63
s_waitcnt vmcnt(2)
s_nop 0
v_mfma_f32_16x16x32_bf16 v[48:51], v[36:39], v[40:43], v[48:51]
v_mfma_f32_16x16x32_bf16 v[68:71], v[20:23], v[40:43], v[68:71]
v_mfma_f32_16x16x32_bf16 v[64:67], v[16:19], v[40:43], v[64:67]
v_mov_b32 v13, s64
v_mov_b64 v[24:25], 0
v_mov_b64 v[26:27], 0
v_mov_b64 v[56:57], 0
v_mov_b64 v[58:59], 0
v_mov_b64 v[60:61], 0
v_mov_b64 v[62:63], 0
v_rcp_f32 v52, v48
s_nop 0
v_pk_mul_f32 v[68:69], v[68:69], v[52:53] op_sel_hi:[1,0]
v_pk_mul_f32 v[70:71], v[70:71], v[52:53] op_sel_hi:[1,0]
v_cvt_pk_bf16_f32 v50, v68, v69
v_cvt_pk_bf16_f32 v51, v70, v71
v_pk_mul_f32 v[64:65], v[64:65], v[52:53] op_sel_hi:[1,0]
v_pk_mul_f32 v[66:67], v[66:67], v[52:53] op_sel_hi:[1,0]
s_mov_b32 exec_lo, 0xcccccccc
s_mov_b32 exec_hi, 0xcccccccc
ds_write_b32 v6, v50 offset:256
ds_write_b32 v6, v51 offset:272
s_mov_b64 exec, -1
v_cvt_pk_bf16_f32 v48, v64, v65
v_cvt_pk_bf16_f32 v49, v66, v67
s_mov_b32 exec_lo, 0xcccccccc
s_mov_b32 exec_hi, 0xcccccccc
ds_write_b32 v6, v48
ds_write_b32 v6, v49 offset:16
s_mov_b64 exec, -1
v_mov_b64 v[32:33], 0
v_mov_b64 v[34:35], 0
v_mov_b64 v[36:37], 0
v_mov_b64 v[38:39], 0
v_mov_b64 v[40:41], 0
v_mov_b64 v[42:43], 0
v_mov_b64 v[44:45], 0
v_mov_b64 v[46:47], 0
v_add_u32 v20, 152576, v1
s_waitcnt lgkmcnt(0)
s_barrier
ds_read_b128 v[48:51], v20 offset:0
ds_read_b128 v[52:55], v20 offset:1024
v_mov_b64 v[64:65], 0
v_mov_b64 v[66:67], 0
v_mov_b64 v[68:69], 0
v_mov_b64 v[70:71], 0
buffer_load_dword v23, v7, s[4:7], s58 offen sc1
s_waitcnt lgkmcnt(0)
v_smfmac_f32_16x16x64_bf16 v[32:35], v[48:51], v[104:111], v3
v_smfmac_f32_16x16x64_bf16 v[36:39], v[48:51], v[120:127], v3
v_smfmac_f32_16x16x64_bf16 v[32:35], v[52:55], v[112:119], v3
v_smfmac_f32_16x16x64_bf16 v[36:39], v[52:55], v[128:135], v3
v_smfmac_f32_16x16x64_bf16 v[40:43], v[48:51], v[136:143], v3
v_smfmac_f32_16x16x64_bf16 v[44:47], v[48:51], v[152:159], v3
s_nop 4
v_add_f32 v32, v32, v33
v_smfmac_f32_16x16x64_bf16 v[40:43], v[52:55], v[144:151], v3
v_add_f32 v34, v34, v35
v_smfmac_f32_16x16x64_bf16 v[44:47], v[52:55], v[160:167], v3
v_cvt_pk_bf16_f32 v28, v32, v34
v_smfmac_f32_16x16x64_bf16 v[56:59], v[48:51], v[168:175], v3
v_add_f32 v36, v36, v37
v_smfmac_f32_16x16x64_bf16 v[60:63], v[48:51], v[184:191], v3
v_add_f32 v38, v38, v39
v_smfmac_f32_16x16x64_bf16 v[56:59], v[52:55], v[176:183], v3
v_cvt_pk_bf16_f32 v29, v36, v38
v_smfmac_f32_16x16x64_bf16 v[60:63], v[52:55], v[192:199], v3
v_add_f32 v40, v40, v41
v_add_f32 v42, v42, v43
v_smfmac_f32_16x16x64_bf16 v[64:67], v[48:51], v[200:207], v3
v_cvt_pk_bf16_f32 v30, v40, v42
v_smfmac_f32_16x16x64_bf16 v[68:71], v[48:51], v[216:223], v3
v_add_f32 v44, v44, v45
v_add_f32 v46, v46, v47
v_smfmac_f32_16x16x64_bf16 v[64:67], v[52:55], v[208:215], v3
v_cvt_pk_bf16_f32 v31, v44, v46
v_smfmac_f32_16x16x64_bf16 v[68:71], v[52:55], v[224:231], v3
v_permlane32_swap_b32 v28, v30
v_smfmac_f32_16x16x64_bf16 v[24:27], v[48:51], v[232:239], v3
v_permlane32_swap_b32 v29, v31
v_smfmac_f32_16x16x64_bf16 v[24:27], v[52:55], v[240:247], v3
s_nop 0
v_permlane16_swap_b32 v28, v29
v_permlane16_swap_b32 v30, v31
s_add_u32 s60, s74, 0
v_and_or_b32 v28, v28, s70, v13
buffer_store_dwordx4 v[28:31], v9, s[4:7], s60 offen
v_add_f32 v56, v56, v57
v_add_f32 v58, v58, v59
v_cvt_pk_bf16_f32 v32, v56, v58
v_add_f32 v60, v60, v61
v_add_f32 v62, v62, v63
v_cvt_pk_bf16_f32 v33, v60, v62
v_add_f32 v64, v64, v65
v_add_f32 v66, v66, v67
v_cvt_pk_bf16_f32 v34, v64, v66
v_add_f32 v68, v68, v69
v_add_f32 v70, v70, v71
v_cvt_pk_bf16_f32 v35, v68, v70
v_permlane32_swap_b32 v32, v34
s_nop 0
v_permlane32_swap_b32 v33, v35
s_nop 1
v_permlane16_swap_b32 v32, v33
v_permlane16_swap_b32 v34, v35
s_add_u32 s60, s74, 32768
v_and_or_b32 v32, v32, s70, v13
buffer_store_dwordx4 v[32:35], v9, s[4:7], s60 offen
v_add_f32 v24, v24, v25
v_add_f32 v26, v26, v27
v_cvt_pk_bf16_f32 v24, v24, v26
s_nop 1
v_permlane32_swap_b32 v24, v26
s_nop 1
v_permlane16_swap_b32 v24, v25
v_permlane16_swap_b32 v26, v27
s_add_u32 s60, s74, 65536
v_and_or_b32 v24, v24, s70, v13
s_mov_b64 exec, 0xffff
buffer_store_dwordx4 v[24:27], v9, s[4:7], s60 offen
s_mov_b64 exec, -1
s_cmp_lg_u32 s78, 0
s_cbranch_scc1 own_526
s_waitcnt vmcnt(3)
s_cmp_lg_u32 s3, 3
s_cbranch_scc1 noown_525
s_sub_u32 s62, s62, 1
s_add_u32 s62, s62, 1
s_branch noown_525
own_526:
v_and_b32 v20, 15, v0
v_and_b32 v21, 1, v0
v_lshlrev_b32 v21, 4, v21
v_mov_b32 v22, 0x3f80
v_lshlrev_b32 v21, v21, v22
v_lshrrev_b32 v22, 1, v20
v_cmp_eq_u32 vcc, 0, v22
s_nop 1
v_cndmask_b32 v16, 0, v21, vcc
v_cmp_eq_u32 vcc, 1, v22
s_nop 1
v_cndmask_b32 v17, 0, v21, vcc
v_cmp_eq_u32 vcc, 2, v22
s_nop 1
v_cndmask_b32 v18, 0, v21, vcc
v_cmp_eq_u32 vcc, 3, v22
s_nop 1
v_cndmask_b32 v19, 0, v21, vcc
s_sleep 2
s_mov_b32 s67, 0
s_mov_b32 s97, 15
h1_527:
buffer_load_dwordx4 v[32:35], v1, s[4:7], s75 offen offset:0 sc1
buffer_load_dwordx4 v[36:39], v1, s[4:7], s75 offen offset:1024 sc1
buffer_load_dwordx4 v[40:43], v1, s[4:7], s75 offen offset:2048 sc1
buffer_load_dwordx4 v[44:47], v1, s[4:7], s75 offen offset:3072 sc1
s_add_u32 s67, s67, 1
s_cmp_gt_u32 s67, 400000
s_cbranch_scc1 chain_fail_290
s_waitcnt vmcnt(3)
v_mfma_f32_16x16x32_bf16 v[24:27], v[32:35], v[16:19], 0
v_xor_b32 v28, v32, v13
s_waitcnt vmcnt(2)
v_mfma_f32_16x16x32_bf16 v[24:27], v[36:39], v[16:19], v[24:27]
v_bitop3_b32 v28, v28, v36, v13 bitop3:0xf6
s_waitcnt vmcnt(1)
v_mfma_f32_16x16x32_bf16 v[24:27], v[40:43], v[16:19], v[24:27]
v_bitop3_b32 v28, v28, v40, v13 bitop3:0xf6
s_waitcnt vmcnt(0)
v_mfma_f32_16x16x32_bf16 v[24:27], v[44:47], v[16:19], v[24:27]
v_bitop3_b32 v28, v28, v44, v13 bitop3:0xf6
v_and_b32 v28, 1, v28
v_cmp_ne_u32 vcc, 0, v28
s_nop 0
s_cbranch_vccnz h1_527
s_add_u32 s60, s79, s76
s_nop 1
v_permlane32_swap_b32 v24, v25
v_permlane32_swap_b32 v26, v27
v_add_f32 v24, v24, v25
v_add_f32 v26, v26, v27
v_cvt_pk_bf16_f32 v30, v24, v26
s_mov_b32 exec_lo, s72
s_mov_b32 exec_hi, s72
v_min_u32 v30, s70, v30
buffer_store_dword v30, v10, s[4:7], s60 offen
v_mov_b32 v28, -1
s_add_u32 s60, s73, s76
buffer_store_dword v28, v10, s[4:7], s60 offen
s_mov_b64 exec, -1
noown_525:
s_mul_i32 s45, s3, 3072
s_add_u32 s60, s45, 139264
s_add_u32 s45, s45, s79
v_add_u32 v21, s60, v1
v_mov_b64 v[48:49], 0
v_mov_b64 v[50:51], 0
v_mov_b64 v[52:53], 0
v_mov_b64 v[54:55], 0
v_mov_b64 v[56:57], 0
v_mov_b64 v[58:59], 0
v_mov_b64 v[60:61], 0
v_mov_b64 v[62:63], 0
v_mov_b64 v[64:65], 0
v_mov_b64 v[66:67], 0
v_mov_b64 v[68:69], 0
v_mov_b64 v[70:71], 0
s_lshl_b32 s60, s3, 12
v_add_u32 v15, s60, v1
s_add_u32 s77, s77, 131072
s_barrier
s_cmp_eq_u32 s3, 3
s_cbranch_scc1 io_528
s_sleep 1
s_mov_b32 s67, 0
h2_530:
buffer_load_dwordx4 v[24:27], v1, s[4:7], s45 offen offset:0 sc1
buffer_load_dwordx4 v[28:31], v1, s[4:7], s45 offen offset:1024 sc1
buffer_load_dwordx4 v[32:35], v1, s[4:7], s45 offen offset:2048 sc1
s_add_u32 s67, s67, 1
s_cmp_gt_u32 s67, 400000
s_cbranch_scc1 chain_fail_290
s_waitcnt vmcnt(0)
v_max3_u32 v40, v24, v25, v26
v_max3_u32 v41, v30, v31, v32
v_max3_u32 v40, v40, v27, v28
v_max3_u32 v41, v41, v33, v34
v_max3_u32 v40, v40, v29, v35
v_max_u32 v40, v40, v41
v_cmp_eq_u32 vcc, -1, v40
s_nop 0
s_cbranch_vccnz h2_530
ds_write_b128 v21, v[24:27] offset:0
ds_write_b128 v21, v[28:31] offset:1024
ds_write_b128 v21, v[32:35] offset:2048
io_end_529:
s_mov_b32 s60, s79
s_mov_b32 s79, s71
s_mov_b32 s71, s73
s_mov_b32 s73, s60
s_waitcnt lgkmcnt(0)
s_barrier
s_branch chain_loop_520
io_528:
s_add_u32 s61, s62, 1
v_cmp_gt_u32 vcc, s61, v23
s_nop 0
s_and_b32 vcc_lo, vcc_lo, 15
s_cbranch_scc0 io_end_529
s_add_u32 s61, s62, 1
s_mov_b32 s67, 0
sp_loop_531:
buffer_load_dword v32, v7, s[4:7], s58 offen sc1
s_add_u32 s67, s67, 1
s_cmp_gt_u32 s67, 150000
s_cbranch_scc1 sp_bad_533
s_waitcnt vmcnt(0)
v_cmp_gt_u32 vcc, s61, v32
s_nop 0
s_and_b32 vcc_lo, vcc_lo, 15
s_cbranch_scc0 sp_ok_532
s_sleep 1
s_branch sp_loop_531
sp_bad_533:
s_mov_b32 s98, 1792
s_branch L_fail
sp_ok_532:
s_branch io_end_529
chain_foreign_515:
s_mov_b32 s62, 0
s_lshl_b32 s65, s3, 11
s_add_u32 s65, s65, 16384
s_mul_i32 s63, s51, 24576
s_add_u32 s63, s63, s53
s_mul_i32 s77, s51, 4096
s_add_u32 s77, s77, s54
v_mov_b64 v[48:49], 0
v_mov_b64 v[50:51], 0
v_mov_b64 v[52:53], 0
v_mov_b64 v[54:55], 0
v_mov_b64 v[56:57], 0
v_mov_b64 v[58:59], 0
v_mov_b64 v[60:61], 0
v_mov_b64 v[62:63], 0
v_mov_b64 v[64:65], 0
v_mov_b64 v[66:67], 0
v_mov_b64 v[68:69], 0
v_mov_b64 v[70:71], 0
s_lshl_b32 s60, s3, 12
v_add_u32 v15, s60, v1
s_lshl_b32 s60, s3, 11
s_add_u32 s60, s60, 131072
v_add_u32 v14, s60, v1
s_cmp_lg_u32 s3, 3
s_cbranch_scc1 kx0_534
s_add_u32 s61, s62, 1
s_mov_b32 s67, 0
sp_loop_535:
buffer_load_dword v32, v7, s[4:7], s58 offen sc1
s_add_u32 s67, s67, 1
s_cmp_gt_u32 s67, 150000
s_cbranch_scc1 sp_bad_537
s_waitcnt vmcnt(0)
v_cmp_gt_u32 vcc, s61, v32
s_nop 0
s_and_b32 vcc_lo, vcc_lo, 15
s_cbranch_scc0 sp_ok_536
s_sleep 1
s_branch sp_loop_535
sp_bad_537:
s_mov_b32 s98, 1792
s_branch L_fail
sp_ok_536:
kx0_534:
s_barrier
chain_loop_538:
ds_read_b64_tr_b16 v[24:25], v2 offset:0
ds_read_b64_tr_b16 v[26:27], v2 offset:512
ds_read_b128 v[32:35], v15 offset:0
ds_read_b128 v[36:39], v15 offset:1024
ds_read_b64_tr_b16 v[28:29], v2 offset:1024
ds_read_b64_tr_b16 v[30:31], v2 offset:1536
s_sub_u32 s60, s65, 8192
s_add_u32 m0, s60, 146432
s_add_u32 s60, s60, s63
v_lshlrev_b32 v13, 5, v0
s_add_u32 s61, s63, s65
buffer_load_dwordx4 v1, s[4:7], s60 offen offset:0 sc1 lds
buffer_load_dwordx4 v1, s[4:7], s60 offen offset:1024 sc1 lds
buffer_load_dword v13, v13, s[4:7], s61 offen sc1
v_mov_b32 v42, s62
buffer_store_dword v42, v8, s[4:7], s58 offen sc1
s_waitcnt lgkmcnt(4)
v_smfmac_f32_16x16x64_bf16 v[48:51], v[24:27], a[0:7], v3
ds_read_b128 v[40:43], v15 offset:2048
v_smfmac_f32_16x16x64_bf16 v[52:55], v[24:27], a[72:79], v3
ds_read_b128 v[44:47], v15 offset:3072
v_smfmac_f32_16x16x64_bf16 v[56:59], v[24:27], a[144:151], v3
ds_read_b128 v[16:19], v15 offset:16384
v_smfmac_f32_16x16x64_bf16 v[60:63], v[24:27], a[216:223], v3
ds_read_b128 v[20:23], v15 offset:17408
s_waitcnt lgkmcnt(6)
v_smfmac_f32_16x16x64_bf16 v[64:67], v[24:27], v[32:39], v3
ds_read_b128 v[32:35], v15 offset:18432
s_waitcnt lgkmcnt(3)
v_smfmac_f32_16x16x64_bf16 v[68:71], v[24:27], v[40:47], v3
ds_read_b128 v[36:39], v15 offset:19456
v_smfmac_f32_16x16x64_bf16 v[48:51], v[28:31], a[8:15], v3
ds_read_b64_tr_b16 v[24:25], v2 offset:2048
v_smfmac_f32_16x16x64_bf16 v[52:55], v[28:31], a[80:87], v3
ds_read_b64_tr_b16 v[26:27], v2 offset:2560
v_smfmac_f32_16x16x64_bf16 v[56:59], v[28:31], a[152:159], v3
ds_read_b128 v[40:43], v15 offset:32768
v_smfmac_f32_16x16x64_bf16 v[60:63], v[28:31], a[224:231], v3
ds_read_b128 v[44:47], v15 offset:33792
s_waitcnt lgkmcnt(6)
v_smfmac_f32_16x16x64_bf16 v[64:67], v[28:31], v[16:23], v3
ds_read_b128 v[16:19], v15 offset:34816
s_waitcnt lgkmcnt(5)
v_smfmac_f32_16x16x64_bf16 v[68:71], v[28:31], v[32:39], v3
ds_read_b128 v[20:23], v15 offset:35840
s_waitcnt lgkmcnt(4)
v_smfmac_f32_16x16x64_bf16 v[48:51], v[24:27], a[16:23], v3
ds_read_b64_tr_b16 v[28:29], v2 offset:3072
v_smfmac_f32_16x16x64_bf16 v[52:55], v[24:27], a[88:95], v3
ds_read_b64_tr_b16 v[30:31], v2 offset:3584
v_smfmac_f32_16x16x64_bf16 v[56:59], v[24:27], a[160:167], v3
ds_read_b128 v[32:35], v15 offset:49152
v_smfmac_f32_16x16x64_bf16 v[60:63], v[24:27], a[232:239], v3
ds_read_b128 v[36:39], v15 offset:50176
s_waitcnt lgkmcnt(6)
v_smfmac_f32_16x16x64_bf16 v[64:67], v[24:27], v[40:47], v3
ds_read_b128 v[40:43], v15 offset:51200
s_waitcnt lgkmcnt(5)
v_smfmac_f32_16x16x64_bf16 v[68:71], v[24:27], v[16:23], v3
ds_read_b128 v[44:47], v15 offset:52224
s_waitcnt lgkmcnt(4)
v_smfmac_f32_16x16x64_bf16 v[48:51], v[28:31], a[24:31], v3
ds_read_b64_tr_b16 v[24:25], v2 offset:4096
v_smfmac_f32_16x16x64_bf16 v[52:55], v[28:31], a[96:103], v3
ds_read_b64_tr_b16 v[26:27], v2 offset:4608
v_smfmac_f32_16x16x64_bf16 v[56:59], v[28:31], a[168:175], v3
v_add_u32 v15, 65536, v15
ds_read_b128 v[16:19], v15 offset:0
v_smfmac_f32_16x16x64_bf16 v[60:63], v[28:31], a[240:247], v3
ds_read_b128 v[20:23], v15 offset:1024
s_waitcnt lgkmcnt(6)
v_smfmac_f32_16x16x64_bf16 v[64:67], v[28:31], v[32:39], v3
ds_read_b128 v[32:35], v15 offset:2048
s_waitcnt lgkmcnt(5)
v_smfmac_f32_16x16x64_bf16 v[68:71], v[28:31], v[40:47], v3
ds_read_b128 v[36:39], v15 offset:3072
s_waitcnt lgkmcnt(4)
v_smfmac_f32_16x16x64_bf16 v[48:51], v[24:27], a[32:39], v3
ds_read_b64_tr_b16 v[28:29], v2 offset:5120
v_smfmac_f32_16x16x64_bf16 v[52:55], v[24:27], a[104:111], v3
ds_read_b64_tr_b16 v[30:31], v2 offset:5632
v_smfmac_f32_16x16x64_bf16 v[56:59], v[24:27], a[176:183], v3
ds_read_b128 v[40:43], v15 offset:16384
v_smfmac_f32_16x16x64_bf16 v[60:63], v[24:27], a[248:255], v3
ds_read_b128 v[44:47], v15 offset:17408
s_waitcnt lgkmcnt(6)
v_smfmac_f32_16x16x64_bf16 v[64:67], v[24:27], v[16:23], v3
ds_read_b128 v[16:19], v15 offset:18432
s_waitcnt lgkmcnt(5)
v_smfmac_f32_16x16x64_bf16 v[68:71], v[24:27], v[32:39], v3
ds_read_b128 v[20:23], v15 offset:19456
s_waitcnt lgkmcnt(4)
v_smfmac_f32_16x16x64_bf16 v[48:51], v[28:31], a[40:47], v3
ds_read_b64_tr_b16 v[24:25], v2 offset:6144
v_smfmac_f32_16x16x64_bf16 v[52:55], v[28:31], a[112:119], v3
ds_read_b64_tr_b16 v[26:27], v2 offset:6656
v_smfmac_f32_16x16x64_bf16 v[56:59], v[28:31], a[184:191], v3
ds_read_b128 v[32:35], v15 offset:32768
v_smfmac_f32_16x16x64_bf16 v[60:63], v[28:31], v[72:79], v3
ds_read_b128 v[36:39], v15 offset:33792
s_waitcnt lgkmcnt(6)
v_smfmac_f32_16x16x64_bf16 v[64:67], v[28:31], v[40:47], v3
ds_read_b128 v[40:43], v15 offset:34816
s_waitcnt lgkmcnt(5)
v_smfmac_f32_16x16x64_bf16 v[68:71], v[28:31], v[16:23], v3
ds_read_b128 v[44:47], v15 offset:35840
s_waitcnt lgkmcnt(4)
v_smfmac_f32_16x16x64_bf16 v[48:51], v[24:27], a[48:55], v3
ds_read_b64_tr_b16 v[28:29], v2 offset:7168
v_smfmac_f32_16x16x64_bf16 v[52:55], v[24:27], a[120:127], v3
ds_read_b64_tr_b16 v[30:31], v2 offset:7680
v_smfmac_f32_16x16x64_bf16 v[56:59], v[24:27], a[192:199], v3
ds_read_b128 v[16:19], v15 offset:49152
v_smfmac_f32_16x16x64_bf16 v[60:63], v[24:27], v[80:87], v3
ds_read_b128 v[20:23], v15 offset:50176
s_waitcnt lgkmcnt(6)
v_smfmac_f32_16x16x64_bf16 v[64:67], v[24:27], v[32:39], v3
ds_read_b128 v[32:35], v15 offset:51200
s_waitcnt lgkmcnt(5)
v_smfmac_f32_16x16x64_bf16 v[68:71], v[24:27], v[40:47], v3
ds_read_b128 v[36:39], v15 offset:52224
s_waitcnt lgkmcnt(4)
v_smfmac_f32_16x16x64_bf16 v[48:51], v[28:31], a[56:63], v3
ds_read_b64_tr_b16 v[24:25], v2 offset:8192
v_smfmac_f32_16x16x64_bf16 v[52:55], v[28:31], a[128:135], v3
ds_read_b64_tr_b16 v[26:27], v2 offset:8704
v_smfmac_f32_16x16x64_bf16 v[56:59], v[28:31], a[200:207], v3
ds_read_b128 v[40:43], v14 offset:0
v_smfmac_f32_16x16x64_bf16 v[60:63], v[28:31], v[88:95], v3
ds_read_b128 v[44:47], v14 offset:1024
s_waitcnt lgkmcnt(6)
v_smfmac_f32_16x16x64_bf16 v[64:67], v[28:31], v[16:23], v3
v_add_u32 v15, 152576, v1
s_waitcnt lgkmcnt(4)
v_smfmac_f32_16x16x64_bf16 v[68:71], v[28:31], v[32:39], v3
s_waitcnt lgkmcnt(2)
v_smfmac_f32_16x16x64_bf16 v[48:51], v[24:27], a[64:71], v3
v_smfmac_f32_16x16x64_bf16 v[52:55], v[24:27], a[136:143], v3
v_smfmac_f32_16x16x64_bf16 v[56:59], v[24:27], a[208:215], v3
v_smfmac_f32_16x16x64_bf16 v[60:63], v[24:27], v[96:103], v3
s_waitcnt lgkmcnt(0)
v_smfmac_f32_16x16x64_bf16 v[64:67], v[24:27], v[40:47], v3
v_smfmac_f32_16x16x64_bf16 v[68:71], v[24:27], v[248:255], v3
s_nop 3
v_add_f32 v56, v56, v57
v_add_f32 v58, v58, v59
v_add_f32 v48, v48, v49
v_add_f32 v50, v50, v51
v_cvt_pk_bf16_f32 v24, v56, v58
v_cvt_pk_bf16_f32 v25, v48, v50
ds_write_b64 v4, v[24:25] offset:0
v_add_f32 v60, v60, v61
v_add_f32 v62, v62, v63
v_add_f32 v52, v52, v53
v_add_f32 v54, v54, v55
v_cvt_pk_bf16_f32 v26, v60, v62
v_cvt_pk_bf16_f32 v27, v52, v54
ds_write_b64 v4, v[26:27] offset:512
v_add_f32 v64, v64, v65
v_add_f32 v66, v66, v67
v_cvt_pk_bf16_f32 v28, v64, v66
v_add_f32 v68, v68, v69
v_add_f32 v70, v70, v71
v_cvt_pk_bf16_f32 v29, v68, v70
s_add_u32 s61, s63, s65
buffer_load_dwordx4 v[16:19], v1, s[4:7], s61 offen sc1
buffer_load_dwordx4 v[20:23], v1, s[4:7], s61 offen offset:1024 sc1
s_waitcnt vmcnt(3) lgkmcnt(0)
s_barrier
ds_read_b64_tr_b16 v[48:49], v5 offset:0
ds_read_b64_tr_b16 v[50:51], v5 offset:256
ds_read_b128 v[32:35], v15 offset:2048
ds_read_b128 v[36:39], v15 offset:3072
ds_read_b64_tr_b16 v[52:53], v5 offset:1024
ds_read_b64_tr_b16 v[54:55], v5 offset:1280
ds_read_b128 v[40:43], v15 offset:4096
ds_read_b128 v[44:47], v15 offset:5120
ds_read_b64_tr_b16 v[64:65], v5 offset:2048
ds_read_b64_tr_b16 v[66:67], v5 offset:2304
ds_read_b64_tr_b16 v[68:69], v5 offset:3072
ds_read_b64_tr_b16 v[70:71], v5 offset:3328
buffer_store_dwordx2 v[28:29], v11, s[4:7], s77 offen sc1
v_mov_b64 v[24:25], 0
v_mov_b64 v[26:27], s[98:99]
s_waitcnt lgkmcnt(10)
s_nop 0
v_mfma_f32_16x16x32_bf16 v[24:27], v[48:51], v[48:51], v[24:27]
s_waitcnt lgkmcnt(8)
v_mfma_f32_16x16x32_bf16 v[56:59], v[32:35], v[48:51], 0
v_mfma_f32_16x16x32_bf16 v[60:63], v[36:39], v[48:51], 0
ds_read_b128 v[32:35], v15 offset:6144
ds_read_b128 v[36:39], v15 offset:7168
s_waitcnt lgkmcnt(8)
v_mfma_f32_16x16x32_bf16 v[24:27], v[52:55], v[52:55], v[24:27]
s_waitcnt lgkmcnt(6)
v_mfma_f32_16x16x32_bf16 v[56:59], v[40:43], v[52:55], v[56:59]
v_mfma_f32_16x16x32_bf16 v[60:63], v[44:47], v[52:55], v[60:63]
ds_read_b128 v[40:43], v15 offset:8192
ds_read_b128 v[44:47], v15 offset:9216
s_waitcnt lgkmcnt(6)
v_mfma_f32_16x16x32_bf16 v[24:27], v[64:67], v[64:67], v[24:27]
s_waitcnt lgkmcnt(2)
v_mfma_f32_16x16x32_bf16 v[56:59], v[32:35], v[64:67], v[56:59]
v_mfma_f32_16x16x32_bf16 v[60:63], v[36:39], v[64:67], v[60:63]
v_mfma_f32_16x16x32_bf16 v[24:27], v[68:71], v[68:71], v[24:27]
s_waitcnt lgkmcnt(0)
v_mfma_f32_16x16x32_bf16 v[56:59], v[40:43], v[68:71], v[56:59]
v_mfma_f32_16x16x32_bf16 v[60:63], v[44:47], v[68:71], v[60:63]
s_mov_b32 exec_lo, 0x33333333
s_mov_b32 exec_hi, 0x33333333
s_cmp_ge_u32 s3, 2
s_cbranch_scc1 km23_540
s_bitcmp1_b32 s3, 0
s_cbranch_scc1 km_541
buffer_store_dwordx4 v[48:51], v12, s[4:7], s77 offen offset:0 sc1
s_branch kmd_539
km_541:
buffer_store_dwordx4 v[52:55], v12, s[4:7], s77 offen offset:512 sc1
s_branch kmd_539
km23_540:
s_bitcmp1_b32 s3, 0
s_cbranch_scc1 km_542
buffer_store_dwordx4 v[64:67], v12, s[4:7], s77 offen offset:1024 sc1
s_branch kmd_539
km_542:
buffer_store_dwordx4 v[68:71], v12, s[4:7], s77 offen offset:1536 sc1
kmd_539:
s_mov_b64 exec, -1
s_cmp_eq_u32 s62, 63
s_cbranch_scc1 chain_done_291
v_mov_b32 v36, 0x3f803f80
v_mov_b32 v37, 0x3f803f80
v_mov_b32 v45, 0
v_mov_b32 v46, 0
v_mov_b64 v[38:39], v[36:37]
v_max3_f32 v32, v24, v25, v56
v_max3_f32 v32, v32, v57, v58
v_max3_f32 v32, v32, v59, v60
v_max3_f32 v32, v32, v61, v62
v_max_f32 v32, v32, v63
v_mov_b32 v33, v32
s_add_u32 s63, s63, 786432
s_add_u32 s62, s62, 1
v_permlane16_swap_b32 v33, v32
v_max_f32 v32, v32, v33
v_mov_b32 v33, v32
s_and_b32 s64, s62, 1
s_nop 0
v_permlane32_swap_b32 v33, v32
v_max_f32 v32, v32, v33
v_mul_f32 v32, s66, v32
v_pk_fma_f32 v[24:25], v[24:25], s[66:67], v[32:33] op_sel_hi:[1,0,0] neg_lo:[0,0,1] neg_hi:[0,0,1]
v_pk_fma_f32 v[56:57], v[56:57], s[66:67], v[32:33] op_sel_hi:[1,0,0] neg_lo:[0,0,1] neg_hi:[0,0,1]
v_pk_fma_f32 v[58:59], v[58:59], s[66:67], v[32:33] op_sel_hi:[1,0,0] neg_lo:[0,0,1] neg_hi:[0,0,1]
v_pk_fma_f32 v[60:61], v[60:61], s[66:67], v[32:33] op_sel_hi:[1,0,0] neg_lo:[0,0,1] neg_hi:[0,0,1]
v_pk_fma_f32 v[62:63], v[62:63], s[66:67], v[32:33] op_sel_hi:[1,0,0] neg_lo:[0,0,1] neg_hi:[0,0,1]
v_exp_f32 v24, v24
v_exp_f32 v25, v25
v_exp_f32 v56, v56
v_exp_f32 v57, v57
v_cvt_pk_bf16_f32 v44, v24, v25
v_cvt_pk_bf16_f32 v47, v24, v25
v_exp_f32 v58, v58
v_exp_f32 v59, v59
v_mfma_f32_16x16x16_bf16 v[48:51], v[36:37], v[44:45], 0
v_exp_f32 v60, v60
v_mfma_f32_16x16x16_bf16 v[68:71], v[28:29], v[46:47], 0
v_exp_f32 v61, v61
v_mfma_f32_16x16x16_bf16 v[64:67], v[28:29], v[44:45], 0
v_exp_f32 v62, v62
v_exp_f32 v63, v63
v_cvt_pk_bf16_f32 v40, v56, v57
v_cvt_pk_bf16_f32 v41, v58, v59
v_cvt_pk_bf16_f32 v42, v60, v61
v_cvt_pk_bf16_f32 v43, v62, v63
s_waitcnt vmcnt(2)
s_nop 0
v_mfma_f32_16x16x32_bf16 v[48:51], v[36:39], v[40:43], v[48:51]
v_mfma_f32_16x16x32_bf16 v[68:71], v[20:23], v[40:43], v[68:71]
v_mfma_f32_16x16x32_bf16 v[64:67], v[16:19], v[40:43], v[64:67]
v_mov_b32 v13, s64
v_mov_b64 v[24:25], 0
v_mov_b64 v[26:27], 0
v_mov_b64 v[56:57], 0
v_mov_b64 v[58:59], 0
v_mov_b64 v[60:61], 0
v_mov_b64 v[62:63], 0
v_rcp_f32 v52, v48
s_nop 0
v_pk_mul_f32 v[68:69], v[68:69], v[52:53] op_sel_hi:[1,0]
v_pk_mul_f32 v[70:71], v[70:71], v[52:53] op_sel_hi:[1,0]
v_cvt_pk_bf16_f32 v50, v68, v69
v_cvt_pk_bf16_f32 v51, v70, v71
v_pk_mul_f32 v[64:65], v[64:65], v[52:53] op_sel_hi:[1,0]
v_pk_mul_f32 v[66:67], v[66:67], v[52:53] op_sel_hi:[1,0]
s_mov_b32 exec_lo, 0xcccccccc
s_mov_b32 exec_hi, 0xcccccccc
ds_write_b32 v6, v50 offset:256
ds_write_b32 v6, v51 offset:272
s_mov_b64 exec, -1
v_cvt_pk_bf16_f32 v48, v64, v65
v_cvt_pk_bf16_f32 v49, v66, v67
s_mov_b32 exec_lo, 0xcccccccc
s_mov_b32 exec_hi, 0xcccccccc
ds_write_b32 v6, v48
ds_write_b32 v6, v49 offset:16
s_mov_b64 exec, -1
v_mov_b64 v[32:33], 0
v_mov_b64 v[34:35], 0
v_mov_b64 v[36:37], 0
v_mov_b64 v[38:39], 0
v_mov_b64 v[40:41], 0
v_mov_b64 v[42:43], 0
v_mov_b64 v[44:45], 0
v_mov_b64 v[46:47], 0
v_add_u32 v20, 152576, v1
s_waitcnt lgkmcnt(0)
s_barrier
ds_read_b128 v[48:51], v20 offset:0
ds_read_b128 v[52:55], v20 offset:1024
v_mov_b64 v[64:65], 0
v_mov_b64 v[66:67], 0
v_mov_b64 v[68:69], 0
v_mov_b64 v[70:71], 0
buffer_load_dword v23, v7, s[4:7], s58 offen sc1
s_waitcnt lgkmcnt(0)
v_smfmac_f32_16x16x64_bf16 v[32:35], v[48:51], v[104:111], v3
v_smfmac_f32_16x16x64_bf16 v[36:39], v[48:51], v[120:127], v3
v_smfmac_f32_16x16x64_bf16 v[32:35], v[52:55], v[112:119], v3
v_smfmac_f32_16x16x64_bf16 v[36:39], v[52:55], v[128:135], v3
v_smfmac_f32_16x16x64_bf16 v[40:43], v[48:51], v[136:143], v3
v_smfmac_f32_16x16x64_bf16 v[44:47], v[48:51], v[152:159], v3
s_nop 4
v_add_f32 v32, v32, v33
v_smfmac_f32_16x16x64_bf16 v[40:43], v[52:55], v[144:151], v3
v_add_f32 v34, v34, v35
v_smfmac_f32_16x16x64_bf16 v[44:47], v[52:55], v[160:167], v3
v_cvt_pk_bf16_f32 v28, v32, v34
v_smfmac_f32_16x16x64_bf16 v[56:59], v[48:51], v[168:175], v3
v_add_f32 v36, v36, v37
v_smfmac_f32_16x16x64_bf16 v[60:63], v[48:51], v[184:191], v3
v_add_f32 v38, v38, v39
v_smfmac_f32_16x16x64_bf16 v[56:59], v[52:55], v[176:183], v3
v_cvt_pk_bf16_f32 v29, v36, v38
v_smfmac_f32_16x16x64_bf16 v[60:63], v[52:55], v[192:199], v3
v_add_f32 v40, v40, v41
v_add_f32 v42, v42, v43
v_smfmac_f32_16x16x64_bf16 v[64:67], v[48:51], v[200:207], v3
v_cvt_pk_bf16_f32 v30, v40, v42
v_smfmac_f32_16x16x64_bf16 v[68:71], v[48:51], v[216:223], v3
v_add_f32 v44, v44, v45
v_add_f32 v46, v46, v47
v_smfmac_f32_16x16x64_bf16 v[64:67], v[52:55], v[208:215], v3
v_cvt_pk_bf16_f32 v31, v44, v46
v_smfmac_f32_16x16x64_bf16 v[68:71], v[52:55], v[224:231], v3
v_permlane32_swap_b32 v28, v30
v_smfmac_f32_16x16x64_bf16 v[24:27], v[48:51], v[232:239], v3
v_permlane32_swap_b32 v29, v31
v_smfmac_f32_16x16x64_bf16 v[24:27], v[52:55], v[240:247], v3
s_nop 0
v_permlane16_swap_b32 v28, v29
v_permlane16_swap_b32 v30, v31
s_add_u32 s60, s74, 0
v_and_or_b32 v28, v28, s70, v13
buffer_store_dwordx4 v[28:31], v9, s[4:7], s60 offen sc1
v_add_f32 v56, v56, v57
v_add_f32 v58, v58, v59
v_cvt_pk_bf16_f32 v32, v56, v58
v_add_f32 v60, v60, v61
v_add_f32 v62, v62, v63
v_cvt_pk_bf16_f32 v33, v60, v62
v_add_f32 v64, v64, v65
v_add_f32 v66, v66, v67
v_cvt_pk_bf16_f32 v34, v64, v66
v_add_f32 v68, v68, v69
v_add_f32 v70, v70, v71
v_cvt_pk_bf16_f32 v35, v68, v70
v_permlane32_swap_b32 v32, v34
s_nop 0
v_permlane32_swap_b32 v33, v35
s_nop 1
v_permlane16_swap_b32 v32, v33
v_permlane16_swap_b32 v34, v35
s_add_u32 s60, s74, 32768
v_and_or_b32 v32, v32, s70, v13
buffer_store_dwordx4 v[32:35], v9, s[4:7], s60 offen sc1
v_add_f32 v24, v24, v25
v_add_f32 v26, v26, v27
v_cvt_pk_bf16_f32 v24, v24, v26
s_nop 1
v_permlane32_swap_b32 v24, v26
s_nop 1
v_permlane16_swap_b32 v24, v25
v_permlane16_swap_b32 v26, v27
s_add_u32 s60, s74, 65536
v_and_or_b32 v24, v24, s70, v13
s_mov_b64 exec, 0xffff
buffer_store_dwordx4 v[24:27], v9, s[4:7], s60 offen sc1
s_mov_b64 exec, -1
s_cmp_lg_u32 s78, 0
s_cbranch_scc1 own_544
s_waitcnt vmcnt(3)
s_cmp_lg_u32 s3, 3
s_cbranch_scc1 noown_543
s_sub_u32 s62, s62, 1
s_add_u32 s62, s62, 1
s_branch noown_543
own_544:
v_and_b32 v20, 15, v0
v_and_b32 v21, 1, v0
v_lshlrev_b32 v21, 4, v21
v_mov_b32 v22, 0x3f80
v_lshlrev_b32 v21, v21, v22
v_lshrrev_b32 v22, 1, v20
v_cmp_eq_u32 vcc, 0, v22
s_nop 1
v_cndmask_b32 v16, 0, v21, vcc
v_cmp_eq_u32 vcc, 1, v22
s_nop 1
v_cndmask_b32 v17, 0, v21, vcc
v_cmp_eq_u32 vcc, 2, v22
s_nop 1
v_cndmask_b32 v18, 0, v21, vcc
v_cmp_eq_u32 vcc, 3, v22
s_nop 1
v_cndmask_b32 v19, 0, v21, vcc
s_sleep 2
s_mov_b32 s67, 0
s_mov_b32 s97, 15
h1_545:
buffer_load_dwordx4 v[32:35], v1, s[4:7], s75 offen offset:0 sc1
buffer_load_dwordx4 v[36:39], v1, s[4:7], s75 offen offset:1024 sc1
buffer_load_dwordx4 v[40:43], v1, s[4:7], s75 offen offset:2048 sc1
buffer_load_dwordx4 v[44:47], v1, s[4:7], s75 offen offset:3072 sc1
s_add_u32 s67, s67, 1
s_cmp_gt_u32 s67, 400000
s_cbranch_scc1 chain_fail_290
s_waitcnt vmcnt(3)
v_mfma_f32_16x16x32_bf16 v[24:27], v[32:35], v[16:19], 0
v_xor_b32 v28, v32, v13
s_waitcnt vmcnt(2)
v_mfma_f32_16x16x32_bf16 v[24:27], v[36:39], v[16:19], v[24:27]
v_bitop3_b32 v28, v28, v36, v13 bitop3:0xf6
s_waitcnt vmcnt(1)
v_mfma_f32_16x16x32_bf16 v[24:27], v[40:43], v[16:19], v[24:27]
v_bitop3_b32 v28, v28, v40, v13 bitop3:0xf6
s_waitcnt vmcnt(0)
v_mfma_f32_16x16x32_bf16 v[24:27], v[44:47], v[16:19], v[24:27]
v_bitop3_b32 v28, v28, v44, v13 bitop3:0xf6
v_and_b32 v28, 1, v28
v_cmp_ne_u32 vcc, 0, v28
s_nop 0
s_cbranch_vccnz h1_545
s_add_u32 s60, s79, s76
s_nop 1
v_permlane32_swap_b32 v24, v25
v_permlane32_swap_b32 v26, v27
v_add_f32 v24, v24, v25
v_add_f32 v26, v26, v27
v_cvt_pk_bf16_f32 v30, v24, v26
s_mov_b32 exec_lo, s72
s_mov_b32 exec_hi, s72
v_min_u32 v30, s70, v30
buffer_store_dword v30, v10, s[4:7], s60 offen sc1
v_mov_b32 v28, -1
s_add_u32 s60, s73, s76
buffer_store_dword v28, v10, s[4:7], s60 offen sc1
s_mov_b64 exec, -1
noown_543:
s_mul_i32 s45, s3, 3072
s_add_u32 s60, s45, 139264
s_add_u32 s45, s45, s79
v_add_u32 v21, s60, v1
v_mov_b64 v[48:49], 0
v_mov_b64 v[50:51], 0
v_mov_b64 v[52:53], 0
v_mov_b64 v[54:55], 0
v_mov_b64 v[56:57], 0
v_mov_b64 v[58:59], 0
v_mov_b64 v[60:61], 0
v_mov_b64 v[62:63], 0
v_mov_b64 v[64:65], 0
v_mov_b64 v[66:67], 0
v_mov_b64 v[68:69], 0
v_mov_b64 v[70:71], 0
s_lshl_b32 s60, s3, 12
v_add_u32 v15, s60, v1
s_add_u32 s77, s77, 131072
s_barrier
s_cmp_eq_u32 s3, 3
s_cbranch_scc1 io_546
s_sleep 1
s_mov_b32 s67, 0
h2_548:
buffer_load_dwordx4 v[24:27], v1, s[4:7], s45 offen offset:0 sc1
buffer_load_dwordx4 v[28:31], v1, s[4:7], s45 offen offset:1024 sc1
buffer_load_dwordx4 v[32:35], v1, s[4:7], s45 offen offset:2048 sc1
s_add_u32 s67, s67, 1
s_cmp_gt_u32 s67, 400000
s_cbranch_scc1 chain_fail_290
s_waitcnt vmcnt(0)
v_max3_u32 v40, v24, v25, v26
v_max3_u32 v41, v30, v31, v32
v_max3_u32 v40, v40, v27, v28
v_max3_u32 v41, v41, v33, v34
v_max3_u32 v40, v40, v29, v35
v_max_u32 v40, v40, v41
v_cmp_eq_u32 vcc, -1, v40
s_nop 0
s_cbranch_vccnz h2_548
ds_write_b128 v21, v[24:27] offset:0
ds_write_b128 v21, v[28:31] offset:1024
ds_write_b128 v21, v[32:35] offset:2048
io_end_547:
s_mov_b32 s60, s79
s_mov_b32 s79, s71
s_mov_b32 s71, s73
s_mov_b32 s73, s60
s_waitcnt lgkmcnt(0)
s_barrier
s_branch chain_loop_538
io_546:
s_add_u32 s61, s62, 1
v_cmp_gt_u32 vcc, s61, v23
s_nop 0
s_and_b32 vcc_lo, vcc_lo, 15
s_cbranch_scc0 io_end_547
s_add_u32 s61, s62, 1
s_mov_b32 s67, 0
sp_loop_549:
buffer_load_dword v32, v7, s[4:7], s58 offen sc1
s_add_u32 s67, s67, 1
s_cmp_gt_u32 s67, 150000
s_cbranch_scc1 sp_bad_551
s_waitcnt vmcnt(0)
v_cmp_gt_u32 vcc, s61, v32
s_nop 0
s_and_b32 vcc_lo, vcc_lo, 15
s_cbranch_scc0 sp_ok_550
s_sleep 1
s_branch sp_loop_549
sp_bad_551:
s_mov_b32 s98, 1792
s_branch L_fail
sp_ok_550:
s_branch io_end_547
chain_fail_290:
v_mov_b32 v24, 0xdead
v_mov_b32 v25, 252
buffer_store_dword v24, v25, s[12:15], 0 offen
s_waitcnt vmcnt(0)
s_endpgm
chain_done_291:
s_mov_b32 s62, 64
s_waitcnt vmcnt(0)
s_barrier
v_mov_b32 v24, s62
buffer_store_dword v24, v8, s[4:7], s58 offen sc1
L_end:
s_endpgm
.p2align 2
L_order_qkv:
.long 0x2,0x3,0x4,0x5,0x6,0x7,0x8,0x9,0xa,0xb,0xc,0xd,0xe,0xf,0x10,0x11
.long 0x12,0x100,0x13,0x101,0x14,0x102,0x15,0x103,0x16,0x104,0x17,0x105,0x18,0x106,0x19,0x107
.long 0x1a,0x108,0x1b,0x109,0x1c,0x10a,0x1d,0x10b,0x1e,0x10c,0x1f,0x10d,0x20,0x10e,0x21,0x10f
.long 0x22,0x110,0x23,0x111,0x24,0x112,0x25,0x113,0x26,0x114,0x27,0x115,0x28,0x116,0x29,0x117
.long 0x2a,0x118,0x2b,0x119,0x2c,0x11a,0x2d,0x11b,0x2e,0x11c,0x2f,0x11d,0x30,0x11e,0x31,0x11f
.long 0x32,0x120,0x33,0x121,0x34,0x122,0x35,0x123,0x36,0x124,0x37,0x125,0x38,0x126,0x39,0x127
.long 0x3a,0x128,0x3b,0x129,0x3c,0x12a,0x3d,0x12b,0x3e,0x12c,0x3f,0x12d,0x12e,0x12f,0x130,0x131
.long 0x132,0x133,0x134,0x135,0x136,0x137,0x138,0x139,0x13a,0x13b,0x13c,0x13d,0x13e,0x13f,0x1ff,0x1ff
.p2align 2
L_order_post:
.long 0x2,0x3,0x4,0x5,0x6,0x7,0x8,0x9,0xa,0xb,0xc,0xd,0x100,0xe,0x101,0xf
.long 0x102,0x10,0x103,0x11,0x104,0x12,0x105,0x13,0x106,0x14,0x107,0x15,0x108,0x16,0x109,0x17
.long 0x18,0x10a,0x19,0x10b,0x1a,0x10c,0x1b,0x10d,0x1c,0x10e,0x1d,0x10f,0x1e,0x110,0x1f,0x111
.long 0x20,0x112,0x21,0x113,0x22,0x23,0x114,0x24,0x115,0x25,0x116,0x26,0x117,0x27,0x118,0x28
.long 0x119,0x29,0x11a,0x2a,0x11b,0x2b,0x11c,0x2c,0x11d,0x2d,0x2e,0x11e,0x2f,0x11f,0x30,0x120
.long 0x31,0x121,0x32,0x122,0x33,0x123,0x34,0x124,0x35,0x125,0x36,0x126,0x37,0x127,0x38,0x39
.long 0x128,0x3a,0x129,0x3b,0x12a,0x3c,0x12b,0x3d,0x12c,0x3e,0x12d,0x3f,0x12e,0x12f,0x130,0x131
.long 0x132,0x133,0x134,0x135,0x136,0x137,0x138,0x139,0x13a,0x13b,0x13c,0x13d,0x13e,0x13f,0x1ff,0x1ff
L_roles:
.short 0,0,0,0,0,0,0,0,0,0,0,0,0,0,0,0,0,0,0,0,0,0,0,0,0,0,0,0,0,0,0,0
.short 0,0,0,0,0,0,0,0,0,0,0,0,0,0,0,0,0,0,0,0,0,0,0,0,0,0,0,0,0,0,0,0
.short 0,1,2,3,4,5,256,257,258,6,7,8,9,10,11,259,260,261,512,513,514,768,769,1024,1025,1280,1281,1282,1283,1284,1285,1286
.short 12,13,14,15,16,17,262,263,264,18,19,20,21,22,23,265,266,267,515,516,517,770,771,1026,1027,1287,1288,1289,1290,1291,1292,1293
.short 24,25,26,27,28,29,268,269,270,518,519,520,772,773,521,522,523,774,775,1028,1029,1294,1295,1296,1297,1298,1299,1300,1301,1302,1303,1304
.short 30,31,32,33,34,35,271,272,273,524,525,526,776,777,527,528,529,778,779,1030,1031,1305,1306,1307,1308,1309,1310,1311,1312,1313,1314,1315
.short 36,37,38,39,40,41,274,275,276,530,531,532,780,781,1032,1033,1034,1035,1316,1317,1318,1319,1320,1321,1322,1323,1324,1325,1326,1327,1328,1329
.short 42,43,44,45,46,47,277,278,279,533,534,535,782,783,1036,1037,1038,1039,1330,1331,1332,1333,1334,1335,1336,1337,1338,1339,1340,1341,1342,1343
L_writers:
.byte 2,2,3,3,4,4,5,5,6,6,6,6,7,7,7,7,2,2,2,2,2,2,2,3,3,3,3,3,3,3,4,4,4,4,4,4,4,4,4,4,4,5,5,5,5,5,5,5,5,5,5,5,6,6,6,6,6,6,6,6,6,6,6,6
.byte 6,6,7,7,7,7,7,7,7,7,7,7,7,7,7,7,0,0,0,0,0,0,0,0,0,0,0,0,0,0,0,0,0,0,0,0,0,0,0,0,0,0,0,0,0,0,0,0,2,2,2,2,3,3,3,3,4,4,4,4,4,4,4,4
.byte 5,5,5,5,5,5,5,5,6,6,6,6,7,7,7,7,2,2,2,3,3,3,4,4,4,4,4,4,5,5,5,5,5,5,6,6,6,7,7,7,2,2,3,3,4,4,5,5,6,6,6,6,7,7,7,7,2,2,2,2,2,2,2,2
.byte 2,2,2,2,3,3,3,3,3,3,3,3,3,3,3,3,4,4,4,4,4,4,5,5,5,5,5,5,6,6,6,6,6,6,7,7,7,7,7,7,2,2,2,2,2,2,3,3,3,3,3,3,4,4,4,5,5,5,6,6,6,7,7,7
.byte 2,2,3,3,4,4,5,5,6,6,6,6,7,7,7,7,2,2,2,2,2,2,2,3,3,3,3,3,3,3,4,4,4,4,4,4,4,4,4,4,4,5,5,5,5,5,5,5,5,5,5,5,6,6,6,6,6,6,6,6,6,6,6,6
.byte 6,6,7,7,7,7,7,7,7,7,7,7,7,7,7,7,1,1,1,1,1,1,1,1,1,1,1,1,1,1,1,1,1,1,1,1,1,1,1,1,1,1,1,1,1,1,1,1,2,2,2,2,3,3,3,3,4,4,4,4,4,4,4,4
.byte 5,5,5,5,5,5,5,5,6,6,6,6,7,7,7,7,2,2,2,3,3,3,4,4,4,4,4,4,5,5,5,5,5,5,6,6,6,7,7,7,2,2,3,3,4,4,5,5,6,6,6,6,7,7,7,7,2,2,2,2,2,2,2,2
.byte 2,2,2,2,3,3,3,3,3,3,3,3,3,3,3,3,4,4,4,4,4,4,5,5,5,5,5,5,6,6,6,6,6,6,7,7,7,7,7,7,2,2,2,2,2,2,3,3,3,3,3,3,4,4,4,5,5,5,6,6,6,7,7,7
L_code_end:
.section .rodata,"a"
.p2align 6
.amdhsa_kernel interleave_layers__memory_aug_recurrent_mem_tr__glu_gated_swiglu__prompt_kernel
  .amdhsa_next_free_vgpr 512
  .amdhsa_next_free_sgpr 102
  .amdhsa_accum_offset 256
  .amdhsa_group_segment_fixed_size 0
  .amdhsa_kernarg_size 112
  .amdhsa_user_sgpr_count 2
  .amdhsa_user_sgpr_kernarg_segment_ptr 1
  .amdhsa_system_sgpr_workgroup_id_x 1
  .amdhsa_float_denorm_mode_32 3
.end_amdhsa_kernel
```

```asm
; @launch grid=(256,1,1) block=(256,1,1) lds=163840
.amdgcn_target "amdgcn-amd-amdhsa--gfx950"
.text
.globl interleave_layers__memory_aug_recurrent_mem_tr__glu_gated_swiglu__prompt_kernel
.p2align 8
.type interleave_layers__memory_aug_recurrent_mem_tr__glu_gated_swiglu__prompt_kernel,@function
interleave_layers__memory_aug_recurrent_mem_tr__glu_gated_swiglu__prompt_kernel:
s_cmp_lt_u32 s2, 256
s_cbranch_scc1 L_go
L_end:
s_endpgm
L_go:
s_getpc_b64 s[56:57]
L_pc0:
s_sub_u32 s56, s56, L_pc0-interleave_layers__memory_aug_recurrent_mem_tr__glu_gated_swiglu__prompt_kernel
s_subb_u32 s57, s57, 0
s_lshr_b32 s58, s2, 3
s_and_b32 s58, s58, 31
s_mul_i32 s58, s58, (L_code_end-interleave_layers__memory_aug_recurrent_mem_tr__glu_gated_swiglu__prompt_kernel+32*4096-1)/(32*4096)*4096
v_lshlrev_b32 v2, 4, v0
v_add_u32 v2, s58, v2
v_add_u32 v3, 0, v2
v_min_u32 v3, L_code_end-interleave_layers__memory_aug_recurrent_mem_tr__glu_gated_swiglu__prompt_kernel-16, v3
global_load_dwordx4 v[200:203], v3, s[56:57]
v_add_u32 v3, 4096, v2
v_min_u32 v3, L_code_end-interleave_layers__memory_aug_recurrent_mem_tr__glu_gated_swiglu__prompt_kernel-16, v3
global_load_dwordx4 v[204:207], v3, s[56:57]
s_load_dwordx4 s[20:23], s[0:1], 0
s_load_dwordx4 s[24:27], s[0:1], 16
s_load_dwordx4 s[28:31], s[0:1], 32
s_load_dwordx4 s[32:35], s[0:1], 64
s_load_dwordx4 s[36:39], s[0:1], 80
s_load_dwordx4 s[40:43], s[0:1], 96
v_lshrrev_b32 v1, 6, v0
v_and_b32 v0, 63, v0
v_readfirstlane_b32 s3, v1
s_waitcnt lgkmcnt(0)
s_mov_b32 s4, s42
s_and_b32 s5, s43, 0xffff
s_mov_b32 s6, 268435456
s_mov_b32 s7, 0x20000
s_mov_b32 s12, s40
s_and_b32 s13, s41, 0xffff
s_mov_b32 s14, 256
s_mov_b32 s15, 0x20000
s_getreg_b32 s50, hwreg(HW_REG_XCC_ID, 0, 4)
s_and_b32 s50, s50, 7
s_cmp_lg_u32 s3, 0
s_cbranch_scc1 tk_1
v_mov_b32 v2, 1
s_lshl_b32 s51, s50, 2
s_cmp_ge_u32 s50, 2
s_cselect_b32 s52, 128, 0
s_add_u32 s51, s51, s52
v_mov_b32 v3, s51
s_mov_b64 exec, 1
buffer_atomic_add v2, v3, s[12:15], 0 offen sc0
s_waitcnt vmcnt(0)
v_readfirstlane_b32 s51, v2
s_mov_b32 s52, 1
s_cmp_lt_u32 s51, 32
s_cbranch_scc1 native_2
v_mov_b32 v2, 1
v_mov_b32 v3, 32
buffer_atomic_add v2, v3, s[12:15], 0 offen sc0
s_waitcnt vmcnt(0)
v_readfirstlane_b32 s53, v2
s_mov_b64 exec, 0xff
v_lshlrev_b32 v3, 2, v0
v_add_u32 v5, 128, v3
v_cmp_le_u32 vcc, 2, v0
s_nop 1
v_cndmask_b32 v3, v3, v5, vcc
s_mov_b32 s98, 0
olp_3:
buffer_load_dword v4, v3, s[12:15], 0 offen sc1
s_add_u32 s98, s98, 1
s_cmp_gt_u32 s98, 150000
s_cbranch_scc1 obad_4
s_waitcnt vmcnt(0)
s_mov_b32 s54, 0
v_readlane_b32 s55, v4, 0
s_nop 0
s_add_u32 s54, s54, s55
v_readlane_b32 s55, v4, 1
s_nop 0
s_add_u32 s54, s54, s55
v_readlane_b32 s55, v4, 2
s_nop 0
s_add_u32 s54, s54, s55
v_readlane_b32 s55, v4, 3
s_nop 0
s_add_u32 s54, s54, s55
v_readlane_b32 s55, v4, 4
s_nop 0
s_add_u32 s54, s54, s55
v_readlane_b32 s55, v4, 5
s_nop 0
s_add_u32 s54, s54, s55
v_readlane_b32 s55, v4, 6
s_nop 0
s_add_u32 s54, s54, s55
v_readlane_b32 s55, v4, 7
s_nop 0
s_add_u32 s54, s54, s55
s_cmp_lt_u32 s54, 256
s_cbranch_scc1 olp_3
v_readlane_b32 s55, v4, 0
s_nop 0
s_min_u32 s55, s55, 32
s_sub_u32 s54, 32, s55
s_cmp_ge_u32 s53, s54
s_cbranch_scc1 onx_6
s_mov_b32 s50, 0
s_add_u32 s51, s55, s53
s_branch ofin_5
onx_6:
s_sub_u32 s53, s53, s54
v_readlane_b32 s55, v4, 1
s_nop 0
s_min_u32 s55, s55, 32
s_sub_u32 s54, 32, s55
s_cmp_ge_u32 s53, s54
s_cbranch_scc1 onx_7
s_mov_b32 s50, 1
s_add_u32 s51, s55, s53
s_branch ofin_5
onx_7:
s_sub_u32 s53, s53, s54
v_readlane_b32 s55, v4, 2
s_nop 0
s_min_u32 s55, s55, 32
s_sub_u32 s54, 32, s55
s_cmp_ge_u32 s53, s54
s_cbranch_scc1 onx_8
s_mov_b32 s50, 2
s_add_u32 s51, s55, s53
s_branch ofin_5
onx_8:
s_sub_u32 s53, s53, s54
v_readlane_b32 s55, v4, 3
s_nop 0
s_min_u32 s55, s55, 32
s_sub_u32 s54, 32, s55
s_cmp_ge_u32 s53, s54
s_cbranch_scc1 onx_9
s_mov_b32 s50, 3
s_add_u32 s51, s55, s53
s_branch ofin_5
onx_9:
s_sub_u32 s53, s53, s54
v_readlane_b32 s55, v4, 4
s_nop 0
s_min_u32 s55, s55, 32
s_sub_u32 s54, 32, s55
s_cmp_ge_u32 s53, s54
s_cbranch_scc1 onx_10
s_mov_b32 s50, 4
s_add_u32 s51, s55, s53
s_branch ofin_5
onx_10:
s_sub_u32 s53, s53, s54
v_readlane_b32 s55, v4, 5
s_nop 0
s_min_u32 s55, s55, 32
s_sub_u32 s54, 32, s55
s_cmp_ge_u32 s53, s54
s_cbranch_scc1 onx_11
s_mov_b32 s50, 5
s_add_u32 s51, s55, s53
s_branch ofin_5
onx_11:
s_sub_u32 s53, s53, s54
v_readlane_b32 s55, v4, 6
s_nop 0
s_min_u32 s55, s55, 32
s_sub_u32 s54, 32, s55
s_cmp_ge_u32 s53, s54
s_cbranch_scc1 onx_12
s_mov_b32 s50, 6
s_add_u32 s51, s55, s53
s_branch ofin_5
onx_12:
s_sub_u32 s53, s53, s54
v_readlane_b32 s55, v4, 7
s_nop 0
s_min_u32 s55, s55, 32
s_sub_u32 s54, 32, s55
s_cmp_ge_u32 s53, s54
s_cbranch_scc1 onx_13
s_mov_b32 s50, 7
s_add_u32 s51, s55, s53
s_branch ofin_5
onx_13:
s_sub_u32 s53, s53, s54
obad_4:
s_mov_b32 s50, 8
ofin_5:
s_mov_b32 s52, 0x10001
native_2:
s_mov_b64 exec, 1
v_mov_b32 v3, 0
v_mov_b32 v4, s50
v_mov_b32 v5, s51
v_mov_b32 v6, s52
v_mov_b32 v7, 0
ds_write_b128 v3, v[4:7]
s_mov_b64 exec, -1
s_waitcnt lgkmcnt(0)
tk_1:
s_barrier
v_mov_b32 v3, 0
ds_read_b128 v[4:7], v3
s_waitcnt lgkmcnt(0)
v_readfirstlane_b32 s50, v4
v_readfirstlane_b32 s51, v5
v_readfirstlane_b32 s52, v6
s_barrier
s_cmp_ge_u32 s50, 8
s_cbranch_scc1 L_end
s_cmp_ge_u32 s51, 32
s_cbranch_scc1 L_end
s_mov_b32 s100, s50
s_cmp_lt_u32 s50, 2
s_cbranch_scc1 L_chain
s_getpc_b64 s[96:97]
pc_14:
s_add_u32 s96, s96, L_roles-pc_14
s_addc_u32 s97, s97, 0
s_lshl_b32 s53, s50, 5
s_add_u32 s53, s53, s51
s_lshl_b32 s53, s53, 1
v_mov_b32 v1, s53
global_load_ushort v1, v1, s[96:97]
s_waitcnt vmcnt(0)
v_readfirstlane_b32 s53, v1
s_nop 0
s_and_b32 s74, s53, 0xff
s_lshr_b32 s53, s53, 8
s_cmp_eq_u32 s53, 0
s_cbranch_scc1 H_up
s_cmp_eq_u32 s53, 1
s_cbranch_scc1 H_dn
s_cmp_eq_u32 s53, 2
s_cbranch_scc1 H_wo
s_cmp_eq_u32 s53, 3
s_cbranch_scc1 H_att
s_cmp_eq_u32 s53, 4
s_cbranch_scc1 H_red
H_qkv:
s_lshl_b32 s75, s74, 2
s_add_u32 s75, s75, s3
s_mul_i32 s76, s75, 3
v_bfe_u32 v1, v0, 4, 1
v_lshlrev_b32 v1, 10, v1
v_lshrrev_b32 v2, 5, v0
v_lshl_add_u32 v1, v2, 8, v1
v_and_b32 v2, 15, v0
v_lshl_add_u32 v5, v2, 4, v1
v_lshlrev_b32 v6, 4, v0
s_add_u32 s77, s76, 0
s_lshr_b32 s78, s77, 8
s_and_b32 s77, s77, 255
s_lshl_b32 s48, s77, 5
s_cmp_eq_u32 s78, 0
s_cselect_b32 s80, s24, s26
s_cselect_b32 s81, s25, s27
s_cmp_eq_u32 s78, 2
s_cselect_b32 s80, s28, s80
s_cselect_b32 s81, s29, s81
s_mov_b32 s8, s80
s_and_b32 s9, s81, 0xffff
s_mov_b32 s10, 4718592
s_mov_b32 s11, 0x20000
s_lshr_b32 s79, s77, 3
s_mul_i32 s79, s79, 24576
s_lshl_b32 s82, s78, 13
s_add_u32 s79, s79, s82
s_and_b32 s82, s77, 7
s_lshl_b32 s83, s82, 10
s_and_b32 s84, s82, 1
s_lshl_b32 s84, s84, 9
s_andn2_b32 s82, s83, 1024
s_add_u32 s82, s82, s84
s_cmp_eq_u32 s78, 2
s_cselect_b32 s82, s83, s82
s_cselect_b64 vcc, -1, 0
s_add_u32 s79, s79, s82
v_cndmask_b32 v7, v5, v6, vcc
v_add_u32 v19, s79, v7
s_add_u32 s77, s76, 1
s_lshr_b32 s78, s77, 8
s_and_b32 s77, s77, 255
s_lshl_b32 s49, s77, 5
s_cmp_eq_u32 s78, 0
s_cselect_b32 s80, s24, s26
s_cselect_b32 s81, s25, s27
s_cmp_eq_u32 s78, 2
s_cselect_b32 s80, s28, s80
s_cselect_b32 s81, s29, s81
s_mov_b32 s12, s80
s_and_b32 s13, s81, 0xffff
s_mov_b32 s14, 4718592
s_mov_b32 s15, 0x20000
s_lshr_b32 s79, s77, 3
s_mul_i32 s79, s79, 24576
s_lshl_b32 s82, s78, 13
s_add_u32 s79, s79, s82
s_and_b32 s82, s77, 7
s_lshl_b32 s83, s82, 10
s_and_b32 s84, s82, 1
s_lshl_b32 s84, s84, 9
s_andn2_b32 s82, s83, 1024
s_add_u32 s82, s82, s84
s_cmp_eq_u32 s78, 2
s_cselect_b32 s82, s83, s82
s_cselect_b64 vcc, -1, 0
s_add_u32 s79, s79, s82
v_cndmask_b32 v7, v5, v6, vcc
v_add_u32 v20, s79, v7
s_add_u32 s77, s76, 2
s_lshr_b32 s78, s77, 8
s_and_b32 s77, s77, 255
s_lshl_b32 s50, s77, 5
s_cmp_eq_u32 s78, 0
s_cselect_b32 s80, s24, s26
s_cselect_b32 s81, s25, s27
s_cmp_eq_u32 s78, 2
s_cselect_b32 s80, s28, s80
s_cselect_b32 s81, s29, s81
s_mov_b32 s16, s80
s_and_b32 s17, s81, 0xffff
s_mov_b32 s18, 4718592
s_mov_b32 s19, 0x20000
s_lshr_b32 s79, s77, 3
s_mul_i32 s79, s79, 24576
s_lshl_b32 s82, s78, 13
s_add_u32 s79, s79, s82
s_and_b32 s82, s77, 7
s_lshl_b32 s83, s82, 10
s_and_b32 s84, s82, 1
s_lshl_b32 s84, s84, 9
s_andn2_b32 s82, s83, 1024
s_add_u32 s82, s82, s84
s_cmp_eq_u32 s78, 2
s_cselect_b32 s82, s83, s82
s_cselect_b64 vcc, -1, 0
s_add_u32 s79, s79, s82
v_cndmask_b32 v7, v5, v6, vcc
v_add_u32 v21, s79, v7
v_lshrrev_b32 v1, 5, v0
v_bfe_u32 v2, v0, 3, 1
v_lshl_add_u32 v1, v1, 1, v2
v_bfe_u32 v2, v0, 4, 1
v_bfe_u32 v3, v0, 1, 2
v_lshlrev_b32 v1, 3, v1
v_lshl_add_u32 v1, v2, 2, v1
v_add_u32 v1, v1, v3
v_mul_u32_u24 v1, 8192, v1
v_and_b32 v2, 1, v0
v_lshl_add_u32 v63, v2, 4, v1
s_mul_i32 s70, s3, 40960
v_lshrrev_b32 v1, 5, v0
v_lshlrev_b32 v1, 9, v1
v_bfe_u32 v2, v0, 4, 1
v_lshl_add_u32 v1, v2, 7, v1
v_add_u32 v1, s70, v1
v_and_b32 v2, 15, v0
v_lshl_add_u32 v2, v2, 3, v1
v_add_u32 v60, 0, v2
v_add_u32 v61, 1024, v2
v_add_u32 v62, 2048, v2
s_add_u32 m0, s70, 0
s_add_u32 s71, s48, 0
buffer_load_dwordx4 v63, s[8:11], s71 offen lds
s_add_u32 m0, s70, 1024
s_add_u32 s71, s49, 0
buffer_load_dwordx4 v63, s[12:15], s71 offen lds
s_add_u32 m0, s70, 2048
s_add_u32 s71, s50, 0
buffer_load_dwordx4 v63, s[16:19], s71 offen lds
s_add_u32 m0, s70, 3072
s_add_u32 s71, s48, 262144
buffer_load_dwordx4 v63, s[8:11], s71 offen lds
s_add_u32 m0, s70, 4096
s_add_u32 s71, s49, 262144
buffer_load_dwordx4 v63, s[12:15], s71 offen lds
s_add_u32 m0, s70, 5120
s_add_u32 s71, s50, 262144
buffer_load_dwordx4 v63, s[16:19], s71 offen lds
s_add_u32 m0, s70, 6144
s_add_u32 s71, s48, 524288
buffer_load_dwordx4 v63, s[8:11], s71 offen lds
s_add_u32 m0, s70, 7168
s_add_u32 s71, s49, 524288
buffer_load_dwordx4 v63, s[12:15], s71 offen lds
s_add_u32 m0, s70, 8192
s_add_u32 s71, s50, 524288
buffer_load_dwordx4 v63, s[16:19], s71 offen lds
s_add_u32 m0, s70, 9216
s_add_u32 s71, s48, 786432
buffer_load_dwordx4 v63, s[8:11], s71 offen lds
s_add_u32 m0, s70, 10240
s_add_u32 s71, s49, 786432
buffer_load_dwordx4 v63, s[12:15], s71 offen lds
s_add_u32 m0, s70, 11264
s_add_u32 s71, s50, 786432
buffer_load_dwordx4 v63, s[16:19], s71 offen lds
s_add_u32 m0, s70, 12288
s_add_u32 s71, s48, 1048576
buffer_load_dwordx4 v63, s[8:11], s71 offen lds
s_add_u32 m0, s70, 13312
s_add_u32 s71, s49, 1048576
buffer_load_dwordx4 v63, s[12:15], s71 offen lds
s_add_u32 m0, s70, 14336
s_add_u32 s71, s50, 1048576
buffer_load_dwordx4 v63, s[16:19], s71 offen lds
s_add_u32 m0, s70, 15360
s_add_u32 s71, s48, 1310720
buffer_load_dwordx4 v63, s[8:11], s71 offen lds
s_add_u32 m0, s70, 16384
s_add_u32 s71, s49, 1310720
buffer_load_dwordx4 v63, s[12:15], s71 offen lds
s_add_u32 m0, s70, 17408
s_add_u32 s71, s50, 1310720
buffer_load_dwordx4 v63, s[16:19], s71 offen lds
s_add_u32 m0, s70, 18432
s_add_u32 s71, s48, 1572864
buffer_load_dwordx4 v63, s[8:11], s71 offen lds
s_add_u32 m0, s70, 19456
s_add_u32 s71, s49, 1572864
buffer_load_dwordx4 v63, s[12:15], s71 offen lds
s_add_u32 m0, s70, 20480
s_add_u32 s71, s50, 1572864
buffer_load_dwordx4 v63, s[16:19], s71 offen lds
s_add_u32 m0, s70, 21504
s_add_u32 s71, s48, 1835008
buffer_load_dwordx4 v63, s[8:11], s71 offen lds
s_add_u32 m0, s70, 22528
s_add_u32 s71, s49, 1835008
buffer_load_dwordx4 v63, s[12:15], s71 offen lds
s_add_u32 m0, s70, 23552
s_add_u32 s71, s50, 1835008
buffer_load_dwordx4 v63, s[16:19], s71 offen lds
s_add_u32 m0, s70, 24576
s_add_u32 s71, s48, 2097152
buffer_load_dwordx4 v63, s[8:11], s71 offen lds
s_add_u32 m0, s70, 25600
s_add_u32 s71, s49, 2097152
buffer_load_dwordx4 v63, s[12:15], s71 offen lds
s_add_u32 m0, s70, 26624
s_add_u32 s71, s50, 2097152
buffer_load_dwordx4 v63, s[16:19], s71 offen lds
s_add_u32 m0, s70, 27648
s_add_u32 s71, s48, 2359296
buffer_load_dwordx4 v63, s[8:11], s71 offen lds
s_add_u32 m0, s70, 28672
s_add_u32 s71, s49, 2359296
buffer_load_dwordx4 v63, s[12:15], s71 offen lds
s_add_u32 m0, s70, 29696
s_add_u32 s71, s50, 2359296
buffer_load_dwordx4 v63, s[16:19], s71 offen lds
s_add_u32 m0, s70, 30720
s_add_u32 s71, s48, 2621440
buffer_load_dwordx4 v63, s[8:11], s71 offen lds
s_add_u32 m0, s70, 31744
s_add_u32 s71, s49, 2621440
buffer_load_dwordx4 v63, s[12:15], s71 offen lds
s_add_u32 m0, s70, 32768
s_add_u32 s71, s50, 2621440
buffer_load_dwordx4 v63, s[16:19], s71 offen lds
s_add_u32 m0, s70, 33792
s_add_u32 s71, s48, 2883584
buffer_load_dwordx4 v63, s[8:11], s71 offen lds
s_add_u32 m0, s70, 34816
s_add_u32 s71, s49, 2883584
buffer_load_dwordx4 v63, s[12:15], s71 offen lds
s_add_u32 m0, s70, 35840
s_add_u32 s71, s50, 2883584
buffer_load_dwordx4 v63, s[16:19], s71 offen lds
s_add_u32 m0, s70, 36864
s_add_u32 s71, s48, 3145728
buffer_load_dwordx4 v63, s[8:11], s71 offen lds
s_add_u32 m0, s70, 37888
s_add_u32 s71, s49, 3145728
buffer_load_dwordx4 v63, s[12:15], s71 offen lds
s_add_u32 m0, s70, 38912
s_add_u32 s71, s50, 3145728
buffer_load_dwordx4 v63, s[16:19], s71 offen lds
s_waitcnt vmcnt(36)
ds_read_b64_tr_b16 a[0:1], v60 offset:0
ds_read_b64_tr_b16 a[2:3], v60 offset:256
ds_read_b64_tr_b16 a[72:73], v61 offset:0
ds_read_b64_tr_b16 a[74:75], v61 offset:256
ds_read_b64_tr_b16 a[144:145], v62 offset:0
ds_read_b64_tr_b16 a[146:147], v62 offset:256
s_waitcnt lgkmcnt(0)
s_add_u32 m0, s70, 0
s_add_u32 s71, s48, 3407872
buffer_load_dwordx4 v63, s[8:11], s71 offen lds
s_add_u32 m0, s70, 1024
s_add_u32 s71, s49, 3407872
buffer_load_dwordx4 v63, s[12:15], s71 offen lds
s_add_u32 m0, s70, 2048
s_add_u32 s71, s50, 3407872
buffer_load_dwordx4 v63, s[16:19], s71 offen lds
s_waitcnt vmcnt(36)
ds_read_b64_tr_b16 a[4:5], v60 offset:3072
ds_read_b64_tr_b16 a[6:7], v60 offset:3328
ds_read_b64_tr_b16 a[76:77], v61 offset:3072
ds_read_b64_tr_b16 a[78:79], v61 offset:3328
ds_read_b64_tr_b16 a[148:149], v62 offset:3072
ds_read_b64_tr_b16 a[150:151], v62 offset:3328
s_waitcnt lgkmcnt(0)
s_add_u32 m0, s70, 3072
s_add_u32 s71, s48, 3670016
buffer_load_dwordx4 v63, s[8:11], s71 offen lds
s_add_u32 m0, s70, 4096
s_add_u32 s71, s49, 3670016
buffer_load_dwordx4 v63, s[12:15], s71 offen lds
s_add_u32 m0, s70, 5120
s_add_u32 s71, s50, 3670016
buffer_load_dwordx4 v63, s[16:19], s71 offen lds
s_waitcnt vmcnt(36)
ds_read_b64_tr_b16 a[8:9], v60 offset:6144
ds_read_b64_tr_b16 a[10:11], v60 offset:6400
ds_read_b64_tr_b16 a[80:81], v61 offset:6144
ds_read_b64_tr_b16 a[82:83], v61 offset:6400
ds_read_b64_tr_b16 a[152:153], v62 offset:6144
ds_read_b64_tr_b16 a[154:155], v62 offset:6400
s_waitcnt lgkmcnt(0)
s_add_u32 m0, s70, 6144
s_add_u32 s71, s48, 3932160
buffer_load_dwordx4 v63, s[8:11], s71 offen lds
s_add_u32 m0, s70, 7168
s_add_u32 s71, s49, 3932160
buffer_load_dwordx4 v63, s[12:15], s71 offen lds
s_add_u32 m0, s70, 8192
s_add_u32 s71, s50, 3932160
buffer_load_dwordx4 v63, s[16:19], s71 offen lds
s_waitcnt vmcnt(36)
ds_read_b64_tr_b16 a[12:13], v60 offset:9216
ds_read_b64_tr_b16 a[14:15], v60 offset:9472
ds_read_b64_tr_b16 a[84:85], v61 offset:9216
ds_read_b64_tr_b16 a[86:87], v61 offset:9472
ds_read_b64_tr_b16 a[156:157], v62 offset:9216
ds_read_b64_tr_b16 a[158:159], v62 offset:9472
s_waitcnt lgkmcnt(0)
s_add_u32 m0, s70, 9216
s_add_u32 s71, s48, 4194304
buffer_load_dwordx4 v63, s[8:11], s71 offen lds
s_add_u32 m0, s70, 10240
s_add_u32 s71, s49, 4194304
buffer_load_dwordx4 v63, s[12:15], s71 offen lds
s_add_u32 m0, s70, 11264
s_add_u32 s71, s50, 4194304
buffer_load_dwordx4 v63, s[16:19], s71 offen lds
s_waitcnt vmcnt(36)
ds_read_b64_tr_b16 a[16:17], v60 offset:12288
ds_read_b64_tr_b16 a[18:19], v60 offset:12544
ds_read_b64_tr_b16 a[88:89], v61 offset:12288
ds_read_b64_tr_b16 a[90:91], v61 offset:12544
ds_read_b64_tr_b16 a[160:161], v62 offset:12288
ds_read_b64_tr_b16 a[162:163], v62 offset:12544
s_waitcnt lgkmcnt(0)
s_add_u32 m0, s70, 12288
s_add_u32 s71, s48, 4456448
buffer_load_dwordx4 v63, s[8:11], s71 offen lds
s_add_u32 m0, s70, 13312
s_add_u32 s71, s49, 4456448
buffer_load_dwordx4 v63, s[12:15], s71 offen lds
s_add_u32 m0, s70, 14336
s_add_u32 s71, s50, 4456448
buffer_load_dwordx4 v63, s[16:19], s71 offen lds
s_waitcnt vmcnt(36)
ds_read_b64_tr_b16 a[20:21], v60 offset:15360
ds_read_b64_tr_b16 a[22:23], v60 offset:15616
ds_read_b64_tr_b16 a[92:93], v61 offset:15360
ds_read_b64_tr_b16 a[94:95], v61 offset:15616
ds_read_b64_tr_b16 a[164:165], v62 offset:15360
ds_read_b64_tr_b16 a[166:167], v62 offset:15616
s_waitcnt vmcnt(33)
ds_read_b64_tr_b16 a[24:25], v60 offset:18432
ds_read_b64_tr_b16 a[26:27], v60 offset:18688
ds_read_b64_tr_b16 a[96:97], v61 offset:18432
ds_read_b64_tr_b16 a[98:99], v61 offset:18688
ds_read_b64_tr_b16 a[168:169], v62 offset:18432
ds_read_b64_tr_b16 a[170:171], v62 offset:18688
s_waitcnt vmcnt(30)
ds_read_b64_tr_b16 a[28:29], v60 offset:21504
ds_read_b64_tr_b16 a[30:31], v60 offset:21760
ds_read_b64_tr_b16 a[100:101], v61 offset:21504
ds_read_b64_tr_b16 a[102:103], v61 offset:21760
ds_read_b64_tr_b16 a[172:173], v62 offset:21504
ds_read_b64_tr_b16 a[174:175], v62 offset:21760
s_waitcnt vmcnt(27)
ds_read_b64_tr_b16 a[32:33], v60 offset:24576
ds_read_b64_tr_b16 a[34:35], v60 offset:24832
ds_read_b64_tr_b16 a[104:105], v61 offset:24576
ds_read_b64_tr_b16 a[106:107], v61 offset:24832
ds_read_b64_tr_b16 a[176:177], v62 offset:24576
ds_read_b64_tr_b16 a[178:179], v62 offset:24832
s_waitcnt vmcnt(24)
ds_read_b64_tr_b16 a[36:37], v60 offset:27648
ds_read_b64_tr_b16 a[38:39], v60 offset:27904
ds_read_b64_tr_b16 a[108:109], v61 offset:27648
ds_read_b64_tr_b16 a[110:111], v61 offset:27904
ds_read_b64_tr_b16 a[180:181], v62 offset:27648
ds_read_b64_tr_b16 a[182:183], v62 offset:27904
s_waitcnt vmcnt(21)
ds_read_b64_tr_b16 a[40:41], v60 offset:30720
ds_read_b64_tr_b16 a[42:43], v60 offset:30976
ds_read_b64_tr_b16 a[112:113], v61 offset:30720
ds_read_b64_tr_b16 a[114:115], v61 offset:30976
ds_read_b64_tr_b16 a[184:185], v62 offset:30720
ds_read_b64_tr_b16 a[186:187], v62 offset:30976
s_waitcnt vmcnt(18)
ds_read_b64_tr_b16 a[44:45], v60 offset:33792
ds_read_b64_tr_b16 a[46:47], v60 offset:34048
ds_read_b64_tr_b16 a[116:117], v61 offset:33792
ds_read_b64_tr_b16 a[118:119], v61 offset:34048
ds_read_b64_tr_b16 a[188:189], v62 offset:33792
ds_read_b64_tr_b16 a[190:191], v62 offset:34048
s_waitcnt vmcnt(15)
ds_read_b64_tr_b16 a[48:49], v60 offset:36864
ds_read_b64_tr_b16 a[50:51], v60 offset:37120
ds_read_b64_tr_b16 a[120:121], v61 offset:36864
ds_read_b64_tr_b16 a[122:123], v61 offset:37120
ds_read_b64_tr_b16 a[192:193], v62 offset:36864
ds_read_b64_tr_b16 a[194:195], v62 offset:37120
s_waitcnt vmcnt(12)
ds_read_b64_tr_b16 a[52:53], v60 offset:0
ds_read_b64_tr_b16 a[54:55], v60 offset:256
ds_read_b64_tr_b16 a[124:125], v61 offset:0
ds_read_b64_tr_b16 a[126:127], v61 offset:256
ds_read_b64_tr_b16 a[196:197], v62 offset:0
ds_read_b64_tr_b16 a[198:199], v62 offset:256
s_waitcnt vmcnt(9)
ds_read_b64_tr_b16 a[56:57], v60 offset:3072
ds_read_b64_tr_b16 a[58:59], v60 offset:3328
ds_read_b64_tr_b16 a[128:129], v61 offset:3072
ds_read_b64_tr_b16 a[130:131], v61 offset:3328
ds_read_b64_tr_b16 a[200:201], v62 offset:3072
ds_read_b64_tr_b16 a[202:203], v62 offset:3328
s_waitcnt vmcnt(6)
ds_read_b64_tr_b16 a[60:61], v60 offset:6144
ds_read_b64_tr_b16 a[62:63], v60 offset:6400
ds_read_b64_tr_b16 a[132:133], v61 offset:6144
ds_read_b64_tr_b16 a[134:135], v61 offset:6400
ds_read_b64_tr_b16 a[204:205], v62 offset:6144
ds_read_b64_tr_b16 a[206:207], v62 offset:6400
s_waitcnt vmcnt(3)
ds_read_b64_tr_b16 a[64:65], v60 offset:9216
ds_read_b64_tr_b16 a[66:67], v60 offset:9472
ds_read_b64_tr_b16 a[136:137], v61 offset:9216
ds_read_b64_tr_b16 a[138:139], v61 offset:9472
ds_read_b64_tr_b16 a[208:209], v62 offset:9216
ds_read_b64_tr_b16 a[210:211], v62 offset:9472
s_waitcnt vmcnt(0)
ds_read_b64_tr_b16 a[68:69], v60 offset:12288
ds_read_b64_tr_b16 a[70:71], v60 offset:12544
ds_read_b64_tr_b16 a[140:141], v61 offset:12288
ds_read_b64_tr_b16 a[142:143], v61 offset:12544
ds_read_b64_tr_b16 a[212:213], v62 offset:12288
ds_read_b64_tr_b16 a[214:215], v62 offset:12544
s_waitcnt lgkmcnt(0)
v_lshrrev_b32 v1, 3, v0
v_bfe_u32 v2, v0, 1, 2
v_lshrrev_b32 v3, 5, v0
v_lshlrev_b32 v3, 1, v3
v_xor_b32 v2, v2, v3
v_mul_u32_u24 v1, 2304, v1
v_lshl_add_u32 v1, v2, 5, v1
v_and_b32 v2, 1, v0
v_lshl_add_u32 v1, v2, 4, v1
s_and_b32 s70, s3, 1
s_mul_i32 s70, s70, 18432
s_lshr_b32 s71, s3, 1
s_lshl_b32 s71, s71, 7
s_add_u32 s70, s70, s71
v_add_u32 v1, s70, v1
v_add_u32 v8, 4096, v1
v_add_u32 v9, 3328, v1
v_add_u32 v10, 2560, v1
v_add_u32 v11, 1792, v1
v_add_u32 v12, 5120, v1
v_add_u32 v13, 4352, v1
v_add_u32 v14, 3584, v1
v_add_u32 v15, 2816, v1
v_add_u32 v16, 6144, v1
v_bfe_u32 v1, v0, 1, 3
v_lshlrev_b32 v1, 7, v1
v_lshrrev_b32 v2, 4, v0
v_bfe_u32 v3, v0, 3, 1
v_lshlrev_b32 v3, 1, v3
v_xor_b32 v2, v2, v3
v_lshl_add_u32 v1, v2, 5, v1
v_and_b32 v2, 1, v0
v_lshl_add_u32 v17, v2, 4, v1
v_and_b32 v2, 31, v0
v_add_u32 v1, 0, v2
v_mul_u32_u24 v1, 128, v1
v_lshrrev_b32 v3, 5, v0
v_xor_b32 v3, 1, v3
v_mul_u32_u24 v3, 32768, v3
v_add_u32 v1, 0, v1
v_add_u32 v1, v1, v3
v_mov_b32 v3, 2147483632
s_cmp_eq_u32 s3, 0
s_cselect_b32 s71, 16, 0
v_cmp_gt_u32 vcc, s71, v2
s_nop 1
v_cndmask_b32 v22, v3, v1, vcc
s_mov_b32 s56, 0xffff
s_mul_i32 s70, s74, 128
s_add_u32 s70, s70, 2048
v_mov_b32 v1, s70
s_min_u32 s71, s71, 1
v_cmp_gt_u32 vcc, s71, v0
s_nop 1
v_cndmask_b32 v44, v3, v1, vcc
v_add_u32 v45, 65536, v44
s_getpc_b64 s[96:97]
pc_15:
s_add_u32 s96, s96, L_writers-pc_15
s_addc_u32 s97, s97, 0
v_subrev_u32 v23, 0, v22
v_lshrrev_b32 v23, 7, v23
v_cmp_gt_u32 vcc, 0x200, v23
s_nop 1
v_cndmask_b32 v23, 0, v23, vcc
global_load_ubyte v23, v23, s[96:97]
s_mov_b32 s44, 3702784
s_mov_b32 s45, 60366848
s_mov_b32 s52, 1
s_mov_b32 s53, 32768
s_mov_b32 s46, 1343488
s_mov_b32 s47, 10035200
s_mov_b32 s54, 1
s_mov_b32 s55, 0
s_mov_b32 s25, 64
s_mov_b32 s20, 36864
s_mov_b32 s21, 786432
s_cmp_lt_u32 s75, 170
s_cbranch_scc1 G_sss18
s_cmp_eq_u32 s75, 170
s_cbranch_scc1 G_ssv18
s_mov_b32 s8, s42
s_and_b32 s9, s43, 0xffff
s_mov_b32 s10, 0
s_mov_b32 s11, 0x20000
s_mov_b32 s22, 0
s_mul_i32 s48, s3, 9216
s_add_u32 s49, s48, 36864
s_add_u32 s50, s48, 73728
s_add_u32 s51, s48, 110592
s_mov_b32 s57, 0xbfb8aa3b
v_add_u32 v28, 0, v17
v_add_u32 v29, 36864, v17
v_add_u32 v30, 73728, v17
v_add_u32 v31, 110592, v17
v_lshlrev_b32 v1, 2, v0
v_add_u32 v32, 147456, v1
s_lshl_b32 s70, s3, 8
v_add_u32 v18, s70, v32
v_mov_b64 v[224:225], 0
v_mov_b64 v[236:237], 0
v_mov_b64 v[226:227], 0
v_mov_b64 v[238:239], 0
v_mov_b64 v[228:229], 0
v_mov_b64 v[240:241], 0
v_mov_b64 v[230:231], 0
v_mov_b64 v[242:243], 0
s_mov_b32 s12, s40
s_and_b32 s13, s41, 0xffff
s_mov_b32 s14, 256
s_mov_b32 s15, 0x20000
v_lshlrev_b32 v26, 2, v0
v_add_u32 v27, 128, v26
v_cmp_le_u32 vcc, 2, v0
s_nop 1
v_cndmask_b32 v26, v26, v27, vcc
v_mov_b32 v27, 192
v_cmp_eq_u32 vcc, 8, v0
s_nop 1
v_cndmask_b32 v26, v26, v27, vcc
v_mov_b32 v27, 2147483632
v_cmp_lt_u32 vcc, 8, v0
s_nop 1
v_cndmask_b32 v26, v26, v27, vcc
s_mov_b32 s98, 0
wi_loop_21:
buffer_load_dword v27, v26, s[12:15], 0 offen sc1
s_add_u32 s98, s98, 1
s_cmp_gt_u32 s98, 150000
s_cbranch_scc1 wi_bad_23
s_waitcnt vmcnt(0)
v_cmp_eq_u32 vcc, 32, v27
s_nop 0
s_and_b32 s97, vcc_lo, 0x1ff
s_cmp_eq_u32 s97, 0x1ff
s_cbranch_scc1 wi_ok_22
v_cmp_lt_u32 vcc, 32, v27
s_nop 0
s_and_b32 s96, vcc_lo, 0xff
s_cselect_b32 s96, 0x100, 0
s_and_b32 s96, s96, s97
s_cbranch_scc1 wi_over_24
s_sleep 8
s_branch wi_loop_21
wi_bad_23:
s_mov_b32 s98, 512
s_branch L_fail
wi_over_24:
s_mov_b32 s100, 255
wi_ok_22:
v_add_u32 v26, 65536, v22
v_cmp_eq_u32 vcc, s100, v23
s_nop 1
v_cndmask_b32 v22, v22, v26, vcc
s_mov_b32 s90, 0
s_mov_b32 s91, 1879048192
s_mov_b32 s93, 1879048192
v_mov_b32 v34, 2147483632
s_barrier
s_mov_b32 s95, 1
s_cmp_lg_u32 s3, 0
s_cbranch_scc1 sp_ok_26_j
s_mov_b32 s23, 0
sp_loop_25:
buffer_load_dword v33, v22, s[4:7], 0 offen sc1
s_add_u32 s23, s23, 1
s_cmp_gt_u32 s23, 150000
s_cbranch_scc1 sp_bad_27
s_waitcnt vmcnt(0)
sp_loop_25_e:
v_cmp_gt_u32 vcc, s52, v33
v_cmp_gt_u32 s[58:59], s54, v33
s_and_b32 vcc_lo, vcc_lo, s56
s_cbranch_scc0 sp_ok_26
s_cmp_gt_u32 s23, 4
s_cselect_b32 s70, 0, s56
s_cmp_lg_u32 s95, 0
s_cselect_b32 s70, 0, s70
s_or_b32 s59, s59, s70
s_and_b32 s59, s59, s56
s_cbranch_scc0 sp_ok_26
s_sleep 1
s_branch sp_loop_25
sp_bad_27:
s_mov_b32 s98, 1025
s_branch L_fail
sp_ok_26:
ds_write_b32 v18, v33
s_waitcnt lgkmcnt(0)
sp_ok_26_j:
s_barrier
ds_read_b32 v33, v32
s_waitcnt lgkmcnt(0)
v_cmp_gt_u32 vcc, s52, v33
v_cmp_gt_u32 s[58:59], s54, v33
s_and_b32 vcc_lo, vcc_lo, s56
s_cselect_b32 s70, 0, 1
s_and_b32 s59, s59, s56
s_cselect_b32 s71, 0, 1
s_or_b32 s76, s70, s71
s_cselect_b32 s10, 268435456, 0
s_cmp_lg_u32 s70, 0
s_cselect_b64 s[72:73], s[52:53], s[54:55]
s_cselect_b64 s[58:59], s[44:45], s[46:47]
s_mul_i32 s74, s72, s20
s_add_u32 s74, s74, s58
s_mul_i32 s75, s72, s21
s_add_u32 s75, s75, s59
s_andn2_b32 s71, s71, s70
s_add_u32 s52, s52, s70
s_add_u32 s54, s54, s71
s_mov_b32 s77, s76
s_add_u32 m0, s48, 0
s_nop 0
buffer_load_dwordx4 v8, s[4:7], s74 offen offset:0 sc1 lds
buffer_load_dwordx4 v9, s[4:7], s74 offen offset:1024 sc1 lds
buffer_load_dwordx4 v10, s[4:7], s74 offen offset:2048 sc1 lds
buffer_load_dwordx4 v11, s[4:7], s74 offen offset:3072 sc1 lds
s_add_u32 m0, s48, 4096
s_nop 0
buffer_load_dwordx4 v12, s[4:7], s74 offen offset:0 sc1 lds
buffer_load_dwordx4 v13, s[4:7], s74 offen offset:1024 sc1 lds
buffer_load_dwordx4 v14, s[4:7], s74 offen offset:2048 sc1 lds
buffer_load_dwordx4 v15, s[4:7], s74 offen offset:3072 sc1 lds
s_add_u32 m0, s48, 8192
s_nop 0
buffer_load_dwordx4 v16, s[4:7], s74 offen offset:0 sc1 lds
buffer_store_dword v27, v34, s[4:7], 0 offen
buffer_load_dword v24, v22, s[4:7], 0 offen sc1
v_mov_b32 v27, s90
s_waitcnt vmcnt(9)
s_barrier
buffer_store_dword v27, v45, s[4:7], s91 offen
buffer_store_dword v27, v44, s[4:7], s91 offen sc1
s_mov_b32 s91, 1879048192
ds_read_b128 v[64:67], v28 offset:0
ds_read_b128 v[68:71], v28 offset:9216
ds_read_b128 v[72:75], v28 offset:18432
ds_read_b128 v[76:79], v28 offset:27648
ds_read_b128 v[80:83], v28 offset:1024
ds_read_b128 v[84:87], v28 offset:10240
ds_read_b128 v[88:91], v28 offset:19456
ds_read_b128 v[92:95], v28 offset:28672
s_waitcnt vmcnt(8)
s_barrier
s_branch g_body_16
g_body_16:
s_waitcnt lgkmcnt(4)
v_mfma_f32_16x16x32_bf16 v[208:211], v[64:67], a[0:3], 0
ds_read_b128 v[96:99], v28 offset:2048
v_mfma_f32_16x16x32_bf16 v[212:215], v[68:71], a[0:3], 0
ds_read_b128 v[100:103], v28 offset:11264
v_mfma_f32_16x16x32_bf16 v[216:219], v[64:67], a[72:75], 0
v_mfma_f32_16x16x32_bf16 v[208:211], v[72:75], a[4:7], v[208:211]
ds_read_b128 v[104:107], v28 offset:20480
v_cvt_pk_bf16_f32 v56, v224, v225
v_mfma_f32_16x16x32_bf16 v[212:215], v[76:79], a[4:7], v[212:215]
ds_read_b128 v[108:111], v28 offset:29696
v_cvt_pk_bf16_f32 v57, v226, v227
v_mfma_f32_16x16x32_bf16 v[220:223], v[68:71], a[72:75], 0
v_cvt_pk_bf16_f32 v58, v228, v229
s_waitcnt lgkmcnt(4)
v_mfma_f32_16x16x32_bf16 v[208:211], v[80:83], a[8:11], v[208:211]
ds_read_b128 v[112:115], v28 offset:3072
v_cvt_pk_bf16_f32 v59, v230, v231
v_mfma_f32_16x16x32_bf16 v[212:215], v[84:87], a[8:11], v[212:215]
ds_read_b128 v[116:119], v28 offset:12288
v_mfma_f32_16x16x32_bf16 v[216:219], v[72:75], a[76:79], v[216:219]
buffer_store_dwordx4 v[56:59], v21, s[4:7], s93 offen sc1
v_mfma_f32_16x16x32_bf16 v[208:211], v[88:91], a[12:15], v[208:211]
ds_read_b128 v[120:123], v28 offset:21504
v_mfma_f32_16x16x32_bf16 v[212:215], v[92:95], a[12:15], v[212:215]
ds_read_b128 v[124:127], v28 offset:30720
v_mfma_f32_16x16x32_bf16 v[220:223], v[76:79], a[76:79], v[220:223]
s_waitcnt lgkmcnt(4)
v_mfma_f32_16x16x32_bf16 v[208:211], v[96:99], a[16:19], v[208:211]
ds_read_b128 v[128:131], v28 offset:4096
v_mfma_f32_16x16x32_bf16 v[212:215], v[100:103], a[16:19], v[212:215]
ds_read_b128 v[132:135], v28 offset:13312
v_mfma_f32_16x16x32_bf16 v[216:219], v[80:83], a[80:83], v[216:219]
v_mfma_f32_16x16x32_bf16 v[208:211], v[104:107], a[20:23], v[208:211]
ds_read_b128 v[136:139], v28 offset:22528
v_mfma_f32_16x16x32_bf16 v[212:215], v[108:111], a[20:23], v[212:215]
ds_read_b128 v[140:143], v28 offset:31744
v_mfma_f32_16x16x32_bf16 v[220:223], v[84:87], a[80:83], v[220:223]
s_waitcnt vmcnt(5)
s_barrier
s_waitcnt lgkmcnt(4)
v_mfma_f32_16x16x32_bf16 v[208:211], v[112:115], a[24:27], v[208:211]
ds_read_b128 v[144:147], v28 offset:5120
v_mov_b32 v27, s90
v_mfma_f32_16x16x32_bf16 v[212:215], v[116:119], a[24:27], v[212:215]
ds_read_b128 v[148:151], v28 offset:14336
v_mfma_f32_16x16x32_bf16 v[216:219], v[88:91], a[84:87], v[216:219]
v_mfma_f32_16x16x32_bf16 v[208:211], v[120:123], a[28:31], v[208:211]
ds_read_b128 v[152:155], v28 offset:23552
v_mfma_f32_16x16x32_bf16 v[212:215], v[124:127], a[28:31], v[212:215]
ds_read_b128 v[156:159], v28 offset:32768
v_mfma_f32_16x16x32_bf16 v[220:223], v[92:95], a[84:87], v[220:223]
s_waitcnt lgkmcnt(4)
v_mfma_f32_16x16x32_bf16 v[208:211], v[128:131], a[32:35], v[208:211]
ds_read_b128 v[160:163], v28 offset:6144
v_mfma_f32_16x16x32_bf16 v[212:215], v[132:135], a[32:35], v[212:215]
ds_read_b128 v[164:167], v28 offset:15360
v_mfma_f32_16x16x32_bf16 v[216:219], v[96:99], a[88:91], v[216:219]
v_mfma_f32_16x16x32_bf16 v[208:211], v[136:139], a[36:39], v[208:211]
ds_read_b128 v[168:171], v28 offset:24576
v_mfma_f32_16x16x32_bf16 v[212:215], v[140:143], a[36:39], v[212:215]
ds_read_b128 v[172:175], v28 offset:33792
v_mfma_f32_16x16x32_bf16 v[220:223], v[100:103], a[88:91], v[220:223]
s_waitcnt lgkmcnt(4)
v_mfma_f32_16x16x32_bf16 v[208:211], v[144:147], a[40:43], v[208:211]
ds_read_b128 v[176:179], v28 offset:7168
v_mfma_f32_16x16x32_bf16 v[212:215], v[148:151], a[40:43], v[212:215]
ds_read_b128 v[180:183], v28 offset:16384
s_waitcnt vmcnt(3)
ds_write_b32 v18, v24
v_mfma_f32_16x16x32_bf16 v[216:219], v[104:107], a[92:95], v[216:219]
v_mfma_f32_16x16x32_bf16 v[208:211], v[152:155], a[44:47], v[208:211]
ds_read_b128 v[184:187], v28 offset:25600
v_mfma_f32_16x16x32_bf16 v[212:215], v[156:159], a[44:47], v[212:215]
ds_read_b128 v[188:191], v28 offset:34816
s_waitcnt lgkmcnt(2)
s_barrier
v_mfma_f32_16x16x32_bf16 v[220:223], v[108:111], a[92:95], v[220:223]
ds_read_b32 v33, v32
v_mfma_f32_16x16x32_bf16 v[208:211], v[160:163], a[48:51], v[208:211]
ds_read_b128 v[192:195], v28 offset:8192
v_mfma_f32_16x16x32_bf16 v[212:215], v[164:167], a[48:51], v[212:215]
ds_read_b128 v[196:199], v28 offset:17408
v_mfma_f32_16x16x32_bf16 v[216:219], v[112:115], a[96:99], v[216:219]
s_waitcnt lgkmcnt(2)
v_cmp_gt_u32 vcc, s52, v33
v_mfma_f32_16x16x32_bf16 v[208:211], v[168:171], a[52:55], v[208:211]
ds_read_b128 v[200:203], v28 offset:26624
v_cmp_gt_u32 s[58:59], s54, v33
v_mfma_f32_16x16x32_bf16 v[212:215], v[172:175], a[52:55], v[212:215]
ds_read_b128 v[204:207], v28 offset:35840
s_and_b32 vcc_lo, vcc_lo, s56
s_cselect_b32 s70, 0, 1
v_mfma_f32_16x16x32_bf16 v[220:223], v[116:119], a[96:99], v[220:223]
v_mfma_f32_16x16x32_bf16 v[208:211], v[176:179], a[56:59], v[208:211]
s_and_b32 s59, s59, s56
s_cselect_b32 s71, 0, s77
v_mfma_f32_16x16x32_bf16 v[212:215], v[180:183], a[56:59], v[212:215]
s_or_b32 s82, s70, s71
s_cselect_b32 s10, 268435456, 0
v_mfma_f32_16x16x32_bf16 v[216:219], v[120:123], a[100:103], v[216:219]
s_cmp_lg_u32 s70, 0
s_cselect_b64 s[78:79], s[52:53], s[54:55]
s_cselect_b64 s[58:59], s[44:45], s[46:47]
v_mfma_f32_16x16x32_bf16 v[208:211], v[184:187], a[60:63], v[208:211]
s_mul_i32 s80, s78, s20
s_add_u32 s80, s80, s58
v_mfma_f32_16x16x32_bf16 v[212:215], v[188:191], a[60:63], v[212:215]
s_add_u32 m0, s49, 0
s_mul_i32 s81, s78, s21
s_add_u32 s81, s81, s59
v_mfma_f32_16x16x32_bf16 v[220:223], v[124:127], a[100:103], v[220:223]
buffer_load_dwordx4 v8, s[8:11], s80 offen offset:0 sc1 lds
s_waitcnt lgkmcnt(0)
v_mfma_f32_16x16x32_bf16 v[208:211], v[192:195], a[64:67], v[208:211]
s_andn2_b32 s71, s71, s70
s_add_u32 s52, s52, s70
s_add_u32 s54, s54, s71
v_mfma_f32_16x16x32_bf16 v[212:215], v[196:199], a[64:67], v[212:215]
s_mov_b32 s83, s82
v_mfma_f32_16x16x32_bf16 v[216:219], v[128:131], a[104:107], v[216:219]
buffer_load_dwordx4 v9, s[8:11], s80 offen offset:1024 sc1 lds
v_mfma_f32_16x16x32_bf16 v[208:211], v[200:203], a[68:71], v[208:211]
v_mfma_f32_16x16x32_bf16 v[212:215], v[204:207], a[68:71], v[212:215]
v_mfma_f32_16x16x32_bf16 v[220:223], v[132:135], a[104:107], v[220:223]
buffer_load_dwordx4 v10, s[8:11], s80 offen offset:2048 sc1 lds
v_mfma_f32_16x16x32_bf16 v[216:219], v[136:139], a[108:111], v[216:219]
v_mfma_f32_16x16x32_bf16 v[220:223], v[140:143], a[108:111], v[220:223]
v_mfma_f32_16x16x32_bf16 v[216:219], v[144:147], a[112:115], v[216:219]
buffer_load_dwordx4 v11, s[8:11], s80 offen offset:3072 sc1 lds
v_mfma_f32_16x16x32_bf16 v[220:223], v[148:151], a[112:115], v[220:223]
v_mfma_f32_16x16x32_bf16 v[216:219], v[152:155], a[116:119], v[216:219]
s_add_u32 m0, s49, 4096
v_cvt_pk_bf16_f32 v48, v208, v209
v_mfma_f32_16x16x32_bf16 v[220:223], v[156:159], a[116:119], v[220:223]
buffer_load_dwordx4 v12, s[8:11], s80 offen offset:0 sc1 lds
v_mfma_f32_16x16x32_bf16 v[216:219], v[160:163], a[120:123], v[216:219]
v_cvt_pk_bf16_f32 v49, v210, v211
v_cvt_pk_bf16_f32 v50, v212, v213
v_mfma_f32_16x16x32_bf16 v[220:223], v[164:167], a[120:123], v[220:223]
v_cvt_pk_bf16_f32 v51, v214, v215
v_mfma_f32_16x16x32_bf16 v[216:219], v[168:171], a[124:127], v[216:219]
buffer_load_dwordx4 v13, s[8:11], s80 offen offset:1024 sc1 lds
v_mfma_f32_16x16x32_bf16 v[220:223], v[172:175], a[124:127], v[220:223]
buffer_store_dwordx4 v[48:51], v19, s[4:7], s75 offen sc1
v_mfma_f32_16x16x32_bf16 v[216:219], v[176:179], a[128:131], v[216:219]
v_mfma_f32_16x16x32_bf16 v[220:223], v[180:183], a[128:131], v[220:223]
buffer_load_dwordx4 v14, s[8:11], s80 offen offset:2048 sc1 lds
v_mfma_f32_16x16x32_bf16 v[216:219], v[184:187], a[132:135], v[216:219]
v_mfma_f32_16x16x32_bf16 v[220:223], v[188:191], a[132:135], v[220:223]
v_mfma_f32_16x16x32_bf16 v[216:219], v[192:195], a[136:139], v[216:219]
buffer_load_dwordx4 v15, s[8:11], s80 offen offset:3072 sc1 lds
v_mfma_f32_16x16x32_bf16 v[220:223], v[196:199], a[136:139], v[220:223]
v_mfma_f32_16x16x32_bf16 v[216:219], v[200:203], a[140:143], v[216:219]
s_add_u32 m0, s49, 8192
v_mfma_f32_16x16x32_bf16 v[220:223], v[204:207], a[140:143], v[220:223]
buffer_load_dwordx4 v16, s[8:11], s80 offen offset:0 sc1 lds
v_mfma_f32_16x16x32_bf16 v[224:227], v[64:67], a[144:147], 0
v_mfma_f32_16x16x32_bf16 v[228:231], v[68:71], a[144:147], 0
v_mfma_f32_16x16x32_bf16 v[224:227], v[72:75], a[148:151], v[224:227]
v_mfma_f32_16x16x32_bf16 v[228:231], v[76:79], a[148:151], v[228:231]
v_mfma_f32_16x16x32_bf16 v[224:227], v[80:83], a[152:155], v[224:227]
v_mfma_f32_16x16x32_bf16 v[228:231], v[84:87], a[152:155], v[228:231]
v_cvt_pk_bf16_f32 v52, v216, v217
v_cvt_pk_bf16_f32 v53, v218, v219
v_mfma_f32_16x16x32_bf16 v[224:227], v[88:91], a[156:159], v[224:227]
v_cvt_pk_bf16_f32 v54, v220, v221
v_cvt_pk_bf16_f32 v55, v222, v223
v_mfma_f32_16x16x32_bf16 v[228:231], v[92:95], a[156:159], v[228:231]
buffer_store_dwordx4 v[52:55], v20, s[4:7], s75 offen sc1
v_mfma_f32_16x16x32_bf16 v[224:227], v[96:99], a[160:163], v[224:227]
v_mfma_f32_16x16x32_bf16 v[228:231], v[100:103], a[160:163], v[228:231]
v_mfma_f32_16x16x32_bf16 v[224:227], v[104:107], a[164:167], v[224:227]
v_mfma_f32_16x16x32_bf16 v[228:231], v[108:111], a[164:167], v[228:231]
v_mfma_f32_16x16x32_bf16 v[224:227], v[112:115], a[168:171], v[224:227]
v_mfma_f32_16x16x32_bf16 v[228:231], v[116:119], a[168:171], v[228:231]
v_mfma_f32_16x16x32_bf16 v[224:227], v[120:123], a[172:175], v[224:227]
v_mfma_f32_16x16x32_bf16 v[228:231], v[124:127], a[172:175], v[228:231]
v_mfma_f32_16x16x32_bf16 v[224:227], v[128:131], a[176:179], v[224:227]
v_mfma_f32_16x16x32_bf16 v[228:231], v[132:135], a[176:179], v[228:231]
v_mfma_f32_16x16x32_bf16 v[224:227], v[136:139], a[180:183], v[224:227]
v_mfma_f32_16x16x32_bf16 v[228:231], v[140:143], a[180:183], v[228:231]
v_mfma_f32_16x16x32_bf16 v[224:227], v[144:147], a[184:187], v[224:227]
v_mfma_f32_16x16x32_bf16 v[228:231], v[148:151], a[184:187], v[228:231]
v_mfma_f32_16x16x32_bf16 v[224:227], v[152:155], a[188:191], v[224:227]
buffer_load_dword v24, v22, s[4:7], 0 offen sc1
v_mfma_f32_16x16x32_bf16 v[228:231], v[156:159], a[188:191], v[228:231]
v_mfma_f32_16x16x32_bf16 v[224:227], v[160:163], a[192:195], v[224:227]
s_waitcnt vmcnt(10)
s_barrier
v_mfma_f32_16x16x32_bf16 v[228:231], v[164:167], a[192:195], v[228:231]
buffer_store_dword v27, v45, s[4:7], s91 offen
v_mfma_f32_16x16x32_bf16 v[224:227], v[168:171], a[196:199], v[224:227]
buffer_store_dword v27, v44, s[4:7], s91 offen sc1
s_cmp_eq_u32 s82, 0
s_cbranch_scc1 g_slow_28
v_mfma_f32_16x16x32_bf16 v[228:231], v[172:175], a[196:199], v[228:231]
ds_read_b128 v[64:67], v29 offset:0
v_mfma_f32_16x16x32_bf16 v[224:227], v[176:179], a[200:203], v[224:227]
ds_read_b128 v[68:71], v29 offset:9216
v_mfma_f32_16x16x32_bf16 v[228:231], v[180:183], a[200:203], v[228:231]
ds_read_b128 v[72:75], v29 offset:18432
v_mfma_f32_16x16x32_bf16 v[224:227], v[184:187], a[204:207], v[224:227]
ds_read_b128 v[76:79], v29 offset:27648
v_mfma_f32_16x16x32_bf16 v[228:231], v[188:191], a[204:207], v[228:231]
ds_read_b128 v[80:83], v29 offset:1024
v_mfma_f32_16x16x32_bf16 v[224:227], v[192:195], a[208:211], v[224:227]
ds_read_b128 v[84:87], v29 offset:10240
v_mfma_f32_16x16x32_bf16 v[228:231], v[196:199], a[208:211], v[228:231]
ds_read_b128 v[88:91], v29 offset:19456
v_mfma_f32_16x16x32_bf16 v[224:227], v[200:203], a[212:215], v[224:227]
ds_read_b128 v[92:95], v29 offset:28672
v_mfma_f32_16x16x32_bf16 v[228:231], v[204:207], a[212:215], v[228:231]
s_waitcnt vmcnt(9)
s_barrier
g_body_17:
s_waitcnt lgkmcnt(4)
v_mfma_f32_16x16x32_bf16 v[208:211], v[64:67], a[0:3], 0
ds_read_b128 v[96:99], v29 offset:2048
v_mfma_f32_16x16x32_bf16 v[212:215], v[68:71], a[0:3], 0
ds_read_b128 v[100:103], v29 offset:11264
v_mfma_f32_16x16x32_bf16 v[216:219], v[64:67], a[72:75], 0
v_mfma_f32_16x16x32_bf16 v[208:211], v[72:75], a[4:7], v[208:211]
ds_read_b128 v[104:107], v29 offset:20480
v_cvt_pk_bf16_f32 v56, v224, v225
v_mfma_f32_16x16x32_bf16 v[212:215], v[76:79], a[4:7], v[212:215]
ds_read_b128 v[108:111], v29 offset:29696
v_cvt_pk_bf16_f32 v57, v226, v227
v_mfma_f32_16x16x32_bf16 v[220:223], v[68:71], a[72:75], 0
v_cvt_pk_bf16_f32 v58, v228, v229
s_waitcnt lgkmcnt(4)
v_mfma_f32_16x16x32_bf16 v[208:211], v[80:83], a[8:11], v[208:211]
ds_read_b128 v[112:115], v29 offset:3072
v_cvt_pk_bf16_f32 v59, v230, v231
v_mfma_f32_16x16x32_bf16 v[212:215], v[84:87], a[8:11], v[212:215]
ds_read_b128 v[116:119], v29 offset:12288
v_mfma_f32_16x16x32_bf16 v[216:219], v[72:75], a[76:79], v[216:219]
buffer_store_dwordx4 v[56:59], v21, s[4:7], s75 offen sc1
v_mfma_f32_16x16x32_bf16 v[208:211], v[88:91], a[12:15], v[208:211]
ds_read_b128 v[120:123], v29 offset:21504
v_mfma_f32_16x16x32_bf16 v[212:215], v[92:95], a[12:15], v[212:215]
ds_read_b128 v[124:127], v29 offset:30720
v_mfma_f32_16x16x32_bf16 v[220:223], v[76:79], a[76:79], v[220:223]
s_waitcnt lgkmcnt(4)
v_mfma_f32_16x16x32_bf16 v[208:211], v[96:99], a[16:19], v[208:211]
ds_read_b128 v[128:131], v29 offset:4096
v_mfma_f32_16x16x32_bf16 v[212:215], v[100:103], a[16:19], v[212:215]
ds_read_b128 v[132:135], v29 offset:13312
v_mfma_f32_16x16x32_bf16 v[216:219], v[80:83], a[80:83], v[216:219]
v_mfma_f32_16x16x32_bf16 v[208:211], v[104:107], a[20:23], v[208:211]
ds_read_b128 v[136:139], v29 offset:22528
v_mfma_f32_16x16x32_bf16 v[212:215], v[108:111], a[20:23], v[212:215]
ds_read_b128 v[140:143], v29 offset:31744
v_mfma_f32_16x16x32_bf16 v[220:223], v[84:87], a[80:83], v[220:223]
s_waitcnt vmcnt(5)
s_barrier
s_waitcnt lgkmcnt(4)
v_mfma_f32_16x16x32_bf16 v[208:211], v[112:115], a[24:27], v[208:211]
ds_read_b128 v[144:147], v29 offset:5120
v_mov_b32 v27, s72
v_mfma_f32_16x16x32_bf16 v[212:215], v[116:119], a[24:27], v[212:215]
ds_read_b128 v[148:151], v29 offset:14336
v_mfma_f32_16x16x32_bf16 v[216:219], v[88:91], a[84:87], v[216:219]
v_mfma_f32_16x16x32_bf16 v[208:211], v[120:123], a[28:31], v[208:211]
ds_read_b128 v[152:155], v29 offset:23552
v_mfma_f32_16x16x32_bf16 v[212:215], v[124:127], a[28:31], v[212:215]
ds_read_b128 v[156:159], v29 offset:32768
v_mfma_f32_16x16x32_bf16 v[220:223], v[92:95], a[84:87], v[220:223]
s_waitcnt lgkmcnt(4)
v_mfma_f32_16x16x32_bf16 v[208:211], v[128:131], a[32:35], v[208:211]
ds_read_b128 v[160:163], v29 offset:6144
v_mfma_f32_16x16x32_bf16 v[212:215], v[132:135], a[32:35], v[212:215]
ds_read_b128 v[164:167], v29 offset:15360
v_mfma_f32_16x16x32_bf16 v[216:219], v[96:99], a[88:91], v[216:219]
v_mfma_f32_16x16x32_bf16 v[208:211], v[136:139], a[36:39], v[208:211]
ds_read_b128 v[168:171], v29 offset:24576
v_mfma_f32_16x16x32_bf16 v[212:215], v[140:143], a[36:39], v[212:215]
ds_read_b128 v[172:175], v29 offset:33792
v_mfma_f32_16x16x32_bf16 v[220:223], v[100:103], a[88:91], v[220:223]
s_waitcnt lgkmcnt(4)
v_mfma_f32_16x16x32_bf16 v[208:211], v[144:147], a[40:43], v[208:211]
ds_read_b128 v[176:179], v29 offset:7168
v_mfma_f32_16x16x32_bf16 v[212:215], v[148:151], a[40:43], v[212:215]
ds_read_b128 v[180:183], v29 offset:16384
s_waitcnt vmcnt(3)
ds_write_b32 v18, v24
v_mfma_f32_16x16x32_bf16 v[216:219], v[104:107], a[92:95], v[216:219]
v_mfma_f32_16x16x32_bf16 v[208:211], v[152:155], a[44:47], v[208:211]
ds_read_b128 v[184:187], v29 offset:25600
v_mfma_f32_16x16x32_bf16 v[212:215], v[156:159], a[44:47], v[212:215]
ds_read_b128 v[188:191], v29 offset:34816
s_waitcnt lgkmcnt(2)
s_barrier
v_mfma_f32_16x16x32_bf16 v[220:223], v[108:111], a[92:95], v[220:223]
ds_read_b32 v33, v32
v_mfma_f32_16x16x32_bf16 v[208:211], v[160:163], a[48:51], v[208:211]
ds_read_b128 v[192:195], v29 offset:8192
v_mfma_f32_16x16x32_bf16 v[212:215], v[164:167], a[48:51], v[212:215]
ds_read_b128 v[196:199], v29 offset:17408
v_mfma_f32_16x16x32_bf16 v[216:219], v[112:115], a[96:99], v[216:219]
s_waitcnt lgkmcnt(2)
v_cmp_gt_u32 vcc, s52, v33
v_mfma_f32_16x16x32_bf16 v[208:211], v[168:171], a[52:55], v[208:211]
ds_read_b128 v[200:203], v29 offset:26624
v_cmp_gt_u32 s[58:59], s54, v33
v_mfma_f32_16x16x32_bf16 v[212:215], v[172:175], a[52:55], v[212:215]
ds_read_b128 v[204:207], v29 offset:35840
s_and_b32 vcc_lo, vcc_lo, s56
s_cselect_b32 s70, 0, 1
v_mfma_f32_16x16x32_bf16 v[220:223], v[116:119], a[96:99], v[220:223]
v_mfma_f32_16x16x32_bf16 v[208:211], v[176:179], a[56:59], v[208:211]
s_and_b32 s59, s59, s56
s_cselect_b32 s71, 0, s83
v_mfma_f32_16x16x32_bf16 v[212:215], v[180:183], a[56:59], v[212:215]
s_or_b32 s88, s70, s71
s_cselect_b32 s10, 268435456, 0
v_mfma_f32_16x16x32_bf16 v[216:219], v[120:123], a[100:103], v[216:219]
s_cmp_lg_u32 s70, 0
s_cselect_b64 s[84:85], s[52:53], s[54:55]
s_cselect_b64 s[58:59], s[44:45], s[46:47]
v_mfma_f32_16x16x32_bf16 v[208:211], v[184:187], a[60:63], v[208:211]
s_mul_i32 s86, s84, s20
s_add_u32 s86, s86, s58
v_mfma_f32_16x16x32_bf16 v[212:215], v[188:191], a[60:63], v[212:215]
s_add_u32 m0, s50, 0
s_mul_i32 s87, s84, s21
s_add_u32 s87, s87, s59
v_mfma_f32_16x16x32_bf16 v[220:223], v[124:127], a[100:103], v[220:223]
buffer_load_dwordx4 v8, s[8:11], s86 offen offset:0 sc1 lds
s_waitcnt lgkmcnt(0)
v_mfma_f32_16x16x32_bf16 v[208:211], v[192:195], a[64:67], v[208:211]
s_andn2_b32 s71, s71, s70
s_add_u32 s52, s52, s70
s_add_u32 s54, s54, s71
v_mfma_f32_16x16x32_bf16 v[212:215], v[196:199], a[64:67], v[212:215]
s_mov_b32 s89, s88
v_mfma_f32_16x16x32_bf16 v[216:219], v[128:131], a[104:107], v[216:219]
buffer_load_dwordx4 v9, s[8:11], s86 offen offset:1024 sc1 lds
v_mfma_f32_16x16x32_bf16 v[208:211], v[200:203], a[68:71], v[208:211]
v_mfma_f32_16x16x32_bf16 v[212:215], v[204:207], a[68:71], v[212:215]
v_mfma_f32_16x16x32_bf16 v[220:223], v[132:135], a[104:107], v[220:223]
buffer_load_dwordx4 v10, s[8:11], s86 offen offset:2048 sc1 lds
v_mfma_f32_16x16x32_bf16 v[216:219], v[136:139], a[108:111], v[216:219]
v_mfma_f32_16x16x32_bf16 v[220:223], v[140:143], a[108:111], v[220:223]
v_mfma_f32_16x16x32_bf16 v[216:219], v[144:147], a[112:115], v[216:219]
buffer_load_dwordx4 v11, s[8:11], s86 offen offset:3072 sc1 lds
v_mfma_f32_16x16x32_bf16 v[220:223], v[148:151], a[112:115], v[220:223]
v_mfma_f32_16x16x32_bf16 v[216:219], v[152:155], a[116:119], v[216:219]
s_add_u32 m0, s50, 4096
v_cvt_pk_bf16_f32 v48, v208, v209
v_mfma_f32_16x16x32_bf16 v[220:223], v[156:159], a[116:119], v[220:223]
buffer_load_dwordx4 v12, s[8:11], s86 offen offset:0 sc1 lds
v_mfma_f32_16x16x32_bf16 v[216:219], v[160:163], a[120:123], v[216:219]
v_cvt_pk_bf16_f32 v49, v210, v211
v_cvt_pk_bf16_f32 v50, v212, v213
v_mfma_f32_16x16x32_bf16 v[220:223], v[164:167], a[120:123], v[220:223]
v_cvt_pk_bf16_f32 v51, v214, v215
v_mfma_f32_16x16x32_bf16 v[216:219], v[168:171], a[124:127], v[216:219]
buffer_load_dwordx4 v13, s[8:11], s86 offen offset:1024 sc1 lds
v_mfma_f32_16x16x32_bf16 v[220:223], v[172:175], a[124:127], v[220:223]
buffer_store_dwordx4 v[48:51], v19, s[4:7], s81 offen sc1
v_mfma_f32_16x16x32_bf16 v[216:219], v[176:179], a[128:131], v[216:219]
v_mfma_f32_16x16x32_bf16 v[220:223], v[180:183], a[128:131], v[220:223]
buffer_load_dwordx4 v14, s[8:11], s86 offen offset:2048 sc1 lds
v_mfma_f32_16x16x32_bf16 v[216:219], v[184:187], a[132:135], v[216:219]
v_mfma_f32_16x16x32_bf16 v[220:223], v[188:191], a[132:135], v[220:223]
v_mfma_f32_16x16x32_bf16 v[216:219], v[192:195], a[136:139], v[216:219]
buffer_load_dwordx4 v15, s[8:11], s86 offen offset:3072 sc1 lds
v_mfma_f32_16x16x32_bf16 v[220:223], v[196:199], a[136:139], v[220:223]
v_mfma_f32_16x16x32_bf16 v[216:219], v[200:203], a[140:143], v[216:219]
s_add_u32 m0, s50, 8192
v_mfma_f32_16x16x32_bf16 v[220:223], v[204:207], a[140:143], v[220:223]
buffer_load_dwordx4 v16, s[8:11], s86 offen offset:0 sc1 lds
v_mfma_f32_16x16x32_bf16 v[224:227], v[64:67], a[144:147], 0
v_mfma_f32_16x16x32_bf16 v[228:231], v[68:71], a[144:147], 0
v_mfma_f32_16x16x32_bf16 v[224:227], v[72:75], a[148:151], v[224:227]
v_mfma_f32_16x16x32_bf16 v[228:231], v[76:79], a[148:151], v[228:231]
v_mfma_f32_16x16x32_bf16 v[224:227], v[80:83], a[152:155], v[224:227]
v_mfma_f32_16x16x32_bf16 v[228:231], v[84:87], a[152:155], v[228:231]
v_cvt_pk_bf16_f32 v52, v216, v217
v_cvt_pk_bf16_f32 v53, v218, v219
v_mfma_f32_16x16x32_bf16 v[224:227], v[88:91], a[156:159], v[224:227]
v_cvt_pk_bf16_f32 v54, v220, v221
v_cvt_pk_bf16_f32 v55, v222, v223
v_mfma_f32_16x16x32_bf16 v[228:231], v[92:95], a[156:159], v[228:231]
buffer_store_dwordx4 v[52:55], v20, s[4:7], s81 offen sc1
v_mfma_f32_16x16x32_bf16 v[224:227], v[96:99], a[160:163], v[224:227]
v_mfma_f32_16x16x32_bf16 v[228:231], v[100:103], a[160:163], v[228:231]
v_mfma_f32_16x16x32_bf16 v[224:227], v[104:107], a[164:167], v[224:227]
v_mfma_f32_16x16x32_bf16 v[228:231], v[108:111], a[164:167], v[228:231]
v_mfma_f32_16x16x32_bf16 v[224:227], v[112:115], a[168:171], v[224:227]
v_mfma_f32_16x16x32_bf16 v[228:231], v[116:119], a[168:171], v[228:231]
v_mfma_f32_16x16x32_bf16 v[224:227], v[120:123], a[172:175], v[224:227]
v_mfma_f32_16x16x32_bf16 v[228:231], v[124:127], a[172:175], v[228:231]
v_mfma_f32_16x16x32_bf16 v[224:227], v[128:131], a[176:179], v[224:227]
v_mfma_f32_16x16x32_bf16 v[228:231], v[132:135], a[176:179], v[228:231]
v_mfma_f32_16x16x32_bf16 v[224:227], v[136:139], a[180:183], v[224:227]
v_mfma_f32_16x16x32_bf16 v[228:231], v[140:143], a[180:183], v[228:231]
v_mfma_f32_16x16x32_bf16 v[224:227], v[144:147], a[184:187], v[224:227]
v_mfma_f32_16x16x32_bf16 v[228:231], v[148:151], a[184:187], v[228:231]
v_mfma_f32_16x16x32_bf16 v[224:227], v[152:155], a[188:191], v[224:227]
buffer_load_dword v24, v22, s[4:7], 0 offen sc1
v_mfma_f32_16x16x32_bf16 v[228:231], v[156:159], a[188:191], v[228:231]
v_mfma_f32_16x16x32_bf16 v[224:227], v[160:163], a[192:195], v[224:227]
s_waitcnt vmcnt(10)
s_barrier
v_mfma_f32_16x16x32_bf16 v[228:231], v[164:167], a[192:195], v[228:231]
buffer_store_dword v27, v45, s[4:7], s73 offen
v_mfma_f32_16x16x32_bf16 v[224:227], v[168:171], a[196:199], v[224:227]
buffer_store_dword v27, v44, s[4:7], s73 offen sc1
s_cmp_eq_u32 s88, 0
s_cbranch_scc1 g_slow_29
v_mfma_f32_16x16x32_bf16 v[228:231], v[172:175], a[196:199], v[228:231]
ds_read_b128 v[64:67], v30 offset:0
v_mfma_f32_16x16x32_bf16 v[224:227], v[176:179], a[200:203], v[224:227]
ds_read_b128 v[68:71], v30 offset:9216
v_mfma_f32_16x16x32_bf16 v[228:231], v[180:183], a[200:203], v[228:231]
ds_read_b128 v[72:75], v30 offset:18432
v_mfma_f32_16x16x32_bf16 v[224:227], v[184:187], a[204:207], v[224:227]
ds_read_b128 v[76:79], v30 offset:27648
v_mfma_f32_16x16x32_bf16 v[228:231], v[188:191], a[204:207], v[228:231]
ds_read_b128 v[80:83], v30 offset:1024
v_mfma_f32_16x16x32_bf16 v[224:227], v[192:195], a[208:211], v[224:227]
ds_read_b128 v[84:87], v30 offset:10240
v_mfma_f32_16x16x32_bf16 v[228:231], v[196:199], a[208:211], v[228:231]
ds_read_b128 v[88:91], v30 offset:19456
v_mfma_f32_16x16x32_bf16 v[224:227], v[200:203], a[212:215], v[224:227]
ds_read_b128 v[92:95], v30 offset:28672
v_mfma_f32_16x16x32_bf16 v[228:231], v[204:207], a[212:215], v[228:231]
s_waitcnt vmcnt(9)
s_barrier
g_body_18:
s_waitcnt lgkmcnt(4)
v_mfma_f32_16x16x32_bf16 v[208:211], v[64:67], a[0:3], 0
ds_read_b128 v[96:99], v30 offset:2048
v_mfma_f32_16x16x32_bf16 v[212:215], v[68:71], a[0:3], 0
ds_read_b128 v[100:103], v30 offset:11264
v_mfma_f32_16x16x32_bf16 v[216:219], v[64:67], a[72:75], 0
v_mfma_f32_16x16x32_bf16 v[208:211], v[72:75], a[4:7], v[208:211]
ds_read_b128 v[104:107], v30 offset:20480
v_cvt_pk_bf16_f32 v56, v224, v225
v_mfma_f32_16x16x32_bf16 v[212:215], v[76:79], a[4:7], v[212:215]
ds_read_b128 v[108:111], v30 offset:29696
v_cvt_pk_bf16_f32 v57, v226, v227
v_mfma_f32_16x16x32_bf16 v[220:223], v[68:71], a[72:75], 0
v_cvt_pk_bf16_f32 v58, v228, v229
s_waitcnt lgkmcnt(4)
v_mfma_f32_16x16x32_bf16 v[208:211], v[80:83], a[8:11], v[208:211]
ds_read_b128 v[112:115], v30 offset:3072
v_cvt_pk_bf16_f32 v59, v230, v231
v_mfma_f32_16x16x32_bf16 v[212:215], v[84:87], a[8:11], v[212:215]
ds_read_b128 v[116:119], v30 offset:12288
v_mfma_f32_16x16x32_bf16 v[216:219], v[72:75], a[76:79], v[216:219]
buffer_store_dwordx4 v[56:59], v21, s[4:7], s81 offen sc1
v_mfma_f32_16x16x32_bf16 v[208:211], v[88:91], a[12:15], v[208:211]
ds_read_b128 v[120:123], v30 offset:21504
v_mfma_f32_16x16x32_bf16 v[212:215], v[92:95], a[12:15], v[212:215]
ds_read_b128 v[124:127], v30 offset:30720
v_mfma_f32_16x16x32_bf16 v[220:223], v[76:79], a[76:79], v[220:223]
s_waitcnt lgkmcnt(4)
v_mfma_f32_16x16x32_bf16 v[208:211], v[96:99], a[16:19], v[208:211]
ds_read_b128 v[128:131], v30 offset:4096
v_mfma_f32_16x16x32_bf16 v[212:215], v[100:103], a[16:19], v[212:215]
ds_read_b128 v[132:135], v30 offset:13312
v_mfma_f32_16x16x32_bf16 v[216:219], v[80:83], a[80:83], v[216:219]
v_mfma_f32_16x16x32_bf16 v[208:211], v[104:107], a[20:23], v[208:211]
ds_read_b128 v[136:139], v30 offset:22528
v_mfma_f32_16x16x32_bf16 v[212:215], v[108:111], a[20:23], v[212:215]
ds_read_b128 v[140:143], v30 offset:31744
v_mfma_f32_16x16x32_bf16 v[220:223], v[84:87], a[80:83], v[220:223]
s_waitcnt vmcnt(5)
s_barrier
s_waitcnt lgkmcnt(4)
v_mfma_f32_16x16x32_bf16 v[208:211], v[112:115], a[24:27], v[208:211]
ds_read_b128 v[144:147], v30 offset:5120
v_mov_b32 v27, s78
v_mfma_f32_16x16x32_bf16 v[212:215], v[116:119], a[24:27], v[212:215]
ds_read_b128 v[148:151], v30 offset:14336
v_mfma_f32_16x16x32_bf16 v[216:219], v[88:91], a[84:87], v[216:219]
v_mfma_f32_16x16x32_bf16 v[208:211], v[120:123], a[28:31], v[208:211]
ds_read_b128 v[152:155], v30 offset:23552
v_mfma_f32_16x16x32_bf16 v[212:215], v[124:127], a[28:31], v[212:215]
ds_read_b128 v[156:159], v30 offset:32768
v_mfma_f32_16x16x32_bf16 v[220:223], v[92:95], a[84:87], v[220:223]
s_waitcnt lgkmcnt(4)
v_mfma_f32_16x16x32_bf16 v[208:211], v[128:131], a[32:35], v[208:211]
ds_read_b128 v[160:163], v30 offset:6144
v_mfma_f32_16x16x32_bf16 v[212:215], v[132:135], a[32:35], v[212:215]
ds_read_b128 v[164:167], v30 offset:15360
v_mfma_f32_16x16x32_bf16 v[216:219], v[96:99], a[88:91], v[216:219]
v_mfma_f32_16x16x32_bf16 v[208:211], v[136:139], a[36:39], v[208:211]
ds_read_b128 v[168:171], v30 offset:24576
v_mfma_f32_16x16x32_bf16 v[212:215], v[140:143], a[36:39], v[212:215]
ds_read_b128 v[172:175], v30 offset:33792
v_mfma_f32_16x16x32_bf16 v[220:223], v[100:103], a[88:91], v[220:223]
s_waitcnt lgkmcnt(4)
v_mfma_f32_16x16x32_bf16 v[208:211], v[144:147], a[40:43], v[208:211]
ds_read_b128 v[176:179], v30 offset:7168
v_mfma_f32_16x16x32_bf16 v[212:215], v[148:151], a[40:43], v[212:215]
ds_read_b128 v[180:183], v30 offset:16384
s_waitcnt vmcnt(3)
ds_write_b32 v18, v24
v_mfma_f32_16x16x32_bf16 v[216:219], v[104:107], a[92:95], v[216:219]
v_mfma_f32_16x16x32_bf16 v[208:211], v[152:155], a[44:47], v[208:211]
ds_read_b128 v[184:187], v30 offset:25600
v_mfma_f32_16x16x32_bf16 v[212:215], v[156:159], a[44:47], v[212:215]
ds_read_b128 v[188:191], v30 offset:34816
s_waitcnt lgkmcnt(2)
s_barrier
v_mfma_f32_16x16x32_bf16 v[220:223], v[108:111], a[92:95], v[220:223]
ds_read_b32 v33, v32
v_mfma_f32_16x16x32_bf16 v[208:211], v[160:163], a[48:51], v[208:211]
ds_read_b128 v[192:195], v30 offset:8192
v_mfma_f32_16x16x32_bf16 v[212:215], v[164:167], a[48:51], v[212:215]
ds_read_b128 v[196:199], v30 offset:17408
v_mfma_f32_16x16x32_bf16 v[216:219], v[112:115], a[96:99], v[216:219]
s_waitcnt lgkmcnt(2)
v_cmp_gt_u32 vcc, s52, v33
v_mfma_f32_16x16x32_bf16 v[208:211], v[168:171], a[52:55], v[208:211]
ds_read_b128 v[200:203], v30 offset:26624
v_cmp_gt_u32 s[58:59], s54, v33
v_mfma_f32_16x16x32_bf16 v[212:215], v[172:175], a[52:55], v[212:215]
ds_read_b128 v[204:207], v30 offset:35840
s_and_b32 vcc_lo, vcc_lo, s56
s_cselect_b32 s70, 0, 1
v_mfma_f32_16x16x32_bf16 v[220:223], v[116:119], a[96:99], v[220:223]
v_mfma_f32_16x16x32_bf16 v[208:211], v[176:179], a[56:59], v[208:211]
s_and_b32 s59, s59, s56
s_cselect_b32 s71, 0, s89
v_mfma_f32_16x16x32_bf16 v[212:215], v[180:183], a[56:59], v[212:215]
s_or_b32 s94, s70, s71
s_cselect_b32 s10, 268435456, 0
v_mfma_f32_16x16x32_bf16 v[216:219], v[120:123], a[100:103], v[216:219]
s_cmp_lg_u32 s70, 0
s_cselect_b64 s[90:91], s[52:53], s[54:55]
s_cselect_b64 s[58:59], s[44:45], s[46:47]
v_mfma_f32_16x16x32_bf16 v[208:211], v[184:187], a[60:63], v[208:211]
s_mul_i32 s92, s90, s20
s_add_u32 s92, s92, s58
v_mfma_f32_16x16x32_bf16 v[212:215], v[188:191], a[60:63], v[212:215]
s_add_u32 m0, s51, 0
s_mul_i32 s93, s90, s21
s_add_u32 s93, s93, s59
v_mfma_f32_16x16x32_bf16 v[220:223], v[124:127], a[100:103], v[220:223]
buffer_load_dwordx4 v8, s[8:11], s92 offen offset:0 sc1 lds
s_waitcnt lgkmcnt(0)
v_mfma_f32_16x16x32_bf16 v[208:211], v[192:195], a[64:67], v[208:211]
s_andn2_b32 s71, s71, s70
s_add_u32 s52, s52, s70
s_add_u32 s54, s54, s71
v_mfma_f32_16x16x32_bf16 v[212:215], v[196:199], a[64:67], v[212:215]
s_mov_b32 s95, s94
v_mfma_f32_16x16x32_bf16 v[216:219], v[128:131], a[104:107], v[216:219]
buffer_load_dwordx4 v9, s[8:11], s92 offen offset:1024 sc1 lds
v_mfma_f32_16x16x32_bf16 v[208:211], v[200:203], a[68:71], v[208:211]
v_mfma_f32_16x16x32_bf16 v[212:215], v[204:207], a[68:71], v[212:215]
v_mfma_f32_16x16x32_bf16 v[220:223], v[132:135], a[104:107], v[220:223]
buffer_load_dwordx4 v10, s[8:11], s92 offen offset:2048 sc1 lds
v_mfma_f32_16x16x32_bf16 v[216:219], v[136:139], a[108:111], v[216:219]
v_mfma_f32_16x16x32_bf16 v[220:223], v[140:143], a[108:111], v[220:223]
v_mfma_f32_16x16x32_bf16 v[216:219], v[144:147], a[112:115], v[216:219]
buffer_load_dwordx4 v11, s[8:11], s92 offen offset:3072 sc1 lds
v_mfma_f32_16x16x32_bf16 v[220:223], v[148:151], a[112:115], v[220:223]
v_mfma_f32_16x16x32_bf16 v[216:219], v[152:155], a[116:119], v[216:219]
s_add_u32 m0, s51, 4096
v_cvt_pk_bf16_f32 v48, v208, v209
v_mfma_f32_16x16x32_bf16 v[220:223], v[156:159], a[116:119], v[220:223]
buffer_load_dwordx4 v12, s[8:11], s92 offen offset:0 sc1 lds
v_mfma_f32_16x16x32_bf16 v[216:219], v[160:163], a[120:123], v[216:219]
v_cvt_pk_bf16_f32 v49, v210, v211
v_cvt_pk_bf16_f32 v50, v212, v213
v_mfma_f32_16x16x32_bf16 v[220:223], v[164:167], a[120:123], v[220:223]
v_cvt_pk_bf16_f32 v51, v214, v215
v_mfma_f32_16x16x32_bf16 v[216:219], v[168:171], a[124:127], v[216:219]
buffer_load_dwordx4 v13, s[8:11], s92 offen offset:1024 sc1 lds
v_mfma_f32_16x16x32_bf16 v[220:223], v[172:175], a[124:127], v[220:223]
buffer_store_dwordx4 v[48:51], v19, s[4:7], s87 offen sc1
v_mfma_f32_16x16x32_bf16 v[216:219], v[176:179], a[128:131], v[216:219]
v_mfma_f32_16x16x32_bf16 v[220:223], v[180:183], a[128:131], v[220:223]
buffer_load_dwordx4 v14, s[8:11], s92 offen offset:2048 sc1 lds
v_mfma_f32_16x16x32_bf16 v[216:219], v[184:187], a[132:135], v[216:219]
v_mfma_f32_16x16x32_bf16 v[220:223], v[188:191], a[132:135], v[220:223]
v_mfma_f32_16x16x32_bf16 v[216:219], v[192:195], a[136:139], v[216:219]
buffer_load_dwordx4 v15, s[8:11], s92 offen offset:3072 sc1 lds
v_mfma_f32_16x16x32_bf16 v[220:223], v[196:199], a[136:139], v[220:223]
v_mfma_f32_16x16x32_bf16 v[216:219], v[200:203], a[140:143], v[216:219]
s_add_u32 m0, s51, 8192
v_mfma_f32_16x16x32_bf16 v[220:223], v[204:207], a[140:143], v[220:223]
buffer_load_dwordx4 v16, s[8:11], s92 offen offset:0 sc1 lds
v_mfma_f32_16x16x32_bf16 v[224:227], v[64:67], a[144:147], 0
v_mfma_f32_16x16x32_bf16 v[228:231], v[68:71], a[144:147], 0
v_mfma_f32_16x16x32_bf16 v[224:227], v[72:75], a[148:151], v[224:227]
v_mfma_f32_16x16x32_bf16 v[228:231], v[76:79], a[148:151], v[228:231]
v_mfma_f32_16x16x32_bf16 v[224:227], v[80:83], a[152:155], v[224:227]
v_mfma_f32_16x16x32_bf16 v[228:231], v[84:87], a[152:155], v[228:231]
v_cvt_pk_bf16_f32 v52, v216, v217
v_cvt_pk_bf16_f32 v53, v218, v219
v_mfma_f32_16x16x32_bf16 v[224:227], v[88:91], a[156:159], v[224:227]
v_cvt_pk_bf16_f32 v54, v220, v221
v_cvt_pk_bf16_f32 v55, v222, v223
v_mfma_f32_16x16x32_bf16 v[228:231], v[92:95], a[156:159], v[228:231]
buffer_store_dwordx4 v[52:55], v20, s[4:7], s87 offen sc1
v_mfma_f32_16x16x32_bf16 v[224:227], v[96:99], a[160:163], v[224:227]
v_mfma_f32_16x16x32_bf16 v[228:231], v[100:103], a[160:163], v[228:231]
v_mfma_f32_16x16x32_bf16 v[224:227], v[104:107], a[164:167], v[224:227]
v_mfma_f32_16x16x32_bf16 v[228:231], v[108:111], a[164:167], v[228:231]
v_mfma_f32_16x16x32_bf16 v[224:227], v[112:115], a[168:171], v[224:227]
v_mfma_f32_16x16x32_bf16 v[228:231], v[116:119], a[168:171], v[228:231]
v_mfma_f32_16x16x32_bf16 v[224:227], v[120:123], a[172:175], v[224:227]
v_mfma_f32_16x16x32_bf16 v[228:231], v[124:127], a[172:175], v[228:231]
v_mfma_f32_16x16x32_bf16 v[224:227], v[128:131], a[176:179], v[224:227]
v_mfma_f32_16x16x32_bf16 v[228:231], v[132:135], a[176:179], v[228:231]
v_mfma_f32_16x16x32_bf16 v[224:227], v[136:139], a[180:183], v[224:227]
v_mfma_f32_16x16x32_bf16 v[228:231], v[140:143], a[180:183], v[228:231]
v_mfma_f32_16x16x32_bf16 v[224:227], v[144:147], a[184:187], v[224:227]
v_mfma_f32_16x16x32_bf16 v[228:231], v[148:151], a[184:187], v[228:231]
v_mfma_f32_16x16x32_bf16 v[224:227], v[152:155], a[188:191], v[224:227]
buffer_load_dword v24, v22, s[4:7], 0 offen sc1
v_mfma_f32_16x16x32_bf16 v[228:231], v[156:159], a[188:191], v[228:231]
v_mfma_f32_16x16x32_bf16 v[224:227], v[160:163], a[192:195], v[224:227]
s_waitcnt vmcnt(10)
s_barrier
v_mfma_f32_16x16x32_bf16 v[228:231], v[164:167], a[192:195], v[228:231]
buffer_store_dword v27, v45, s[4:7], s79 offen
v_mfma_f32_16x16x32_bf16 v[224:227], v[168:171], a[196:199], v[224:227]
buffer_store_dword v27, v44, s[4:7], s79 offen sc1
s_cmp_eq_u32 s94, 0
s_cbranch_scc1 g_slow_30
v_mfma_f32_16x16x32_bf16 v[228:231], v[172:175], a[196:199], v[228:231]
ds_read_b128 v[64:67], v31 offset:0
v_mfma_f32_16x16x32_bf16 v[224:227], v[176:179], a[200:203], v[224:227]
ds_read_b128 v[68:71], v31 offset:9216
v_mfma_f32_16x16x32_bf16 v[228:231], v[180:183], a[200:203], v[228:231]
ds_read_b128 v[72:75], v31 offset:18432
v_mfma_f32_16x16x32_bf16 v[224:227], v[184:187], a[204:207], v[224:227]
ds_read_b128 v[76:79], v31 offset:27648
v_mfma_f32_16x16x32_bf16 v[228:231], v[188:191], a[204:207], v[228:231]
ds_read_b128 v[80:83], v31 offset:1024
v_mfma_f32_16x16x32_bf16 v[224:227], v[192:195], a[208:211], v[224:227]
ds_read_b128 v[84:87], v31 offset:10240
v_mfma_f32_16x16x32_bf16 v[228:231], v[196:199], a[208:211], v[228:231]
ds_read_b128 v[88:91], v31 offset:19456
v_mfma_f32_16x16x32_bf16 v[224:227], v[200:203], a[212:215], v[224:227]
ds_read_b128 v[92:95], v31 offset:28672
v_mfma_f32_16x16x32_bf16 v[228:231], v[204:207], a[212:215], v[228:231]
s_waitcnt vmcnt(9)
s_barrier
g_body_19:
s_waitcnt lgkmcnt(4)
v_mfma_f32_16x16x32_bf16 v[208:211], v[64:67], a[0:3], 0
ds_read_b128 v[96:99], v31 offset:2048
v_mfma_f32_16x16x32_bf16 v[212:215], v[68:71], a[0:3], 0
ds_read_b128 v[100:103], v31 offset:11264
v_mfma_f32_16x16x32_bf16 v[216:219], v[64:67], a[72:75], 0
v_mfma_f32_16x16x32_bf16 v[208:211], v[72:75], a[4:7], v[208:211]
ds_read_b128 v[104:107], v31 offset:20480
v_cvt_pk_bf16_f32 v56, v224, v225
v_mfma_f32_16x16x32_bf16 v[212:215], v[76:79], a[4:7], v[212:215]
ds_read_b128 v[108:111], v31 offset:29696
v_cvt_pk_bf16_f32 v57, v226, v227
v_mfma_f32_16x16x32_bf16 v[220:223], v[68:71], a[72:75], 0
v_cvt_pk_bf16_f32 v58, v228, v229
s_waitcnt lgkmcnt(4)
v_mfma_f32_16x16x32_bf16 v[208:211], v[80:83], a[8:11], v[208:211]
ds_read_b128 v[112:115], v31 offset:3072
v_cvt_pk_bf16_f32 v59, v230, v231
v_mfma_f32_16x16x32_bf16 v[212:215], v[84:87], a[8:11], v[212:215]
ds_read_b128 v[116:119], v31 offset:12288
v_mfma_f32_16x16x32_bf16 v[216:219], v[72:75], a[76:79], v[216:219]
buffer_store_dwordx4 v[56:59], v21, s[4:7], s87 offen sc1
v_mfma_f32_16x16x32_bf16 v[208:211], v[88:91], a[12:15], v[208:211]
ds_read_b128 v[120:123], v31 offset:21504
v_mfma_f32_16x16x32_bf16 v[212:215], v[92:95], a[12:15], v[212:215]
ds_read_b128 v[124:127], v31 offset:30720
v_mfma_f32_16x16x32_bf16 v[220:223], v[76:79], a[76:79], v[220:223]
s_waitcnt lgkmcnt(4)
v_mfma_f32_16x16x32_bf16 v[208:211], v[96:99], a[16:19], v[208:211]
ds_read_b128 v[128:131], v31 offset:4096
v_mfma_f32_16x16x32_bf16 v[212:215], v[100:103], a[16:19], v[212:215]
ds_read_b128 v[132:135], v31 offset:13312
v_mfma_f32_16x16x32_bf16 v[216:219], v[80:83], a[80:83], v[216:219]
v_mfma_f32_16x16x32_bf16 v[208:211], v[104:107], a[20:23], v[208:211]
ds_read_b128 v[136:139], v31 offset:22528
v_mfma_f32_16x16x32_bf16 v[212:215], v[108:111], a[20:23], v[212:215]
ds_read_b128 v[140:143], v31 offset:31744
v_mfma_f32_16x16x32_bf16 v[220:223], v[84:87], a[80:83], v[220:223]
s_waitcnt vmcnt(5)
s_barrier
s_waitcnt lgkmcnt(4)
v_mfma_f32_16x16x32_bf16 v[208:211], v[112:115], a[24:27], v[208:211]
ds_read_b128 v[144:147], v31 offset:5120
v_mov_b32 v27, s84
v_mfma_f32_16x16x32_bf16 v[212:215], v[116:119], a[24:27], v[212:215]
ds_read_b128 v[148:151], v31 offset:14336
v_mfma_f32_16x16x32_bf16 v[216:219], v[88:91], a[84:87], v[216:219]
v_mfma_f32_16x16x32_bf16 v[208:211], v[120:123], a[28:31], v[208:211]
ds_read_b128 v[152:155], v31 offset:23552
v_mfma_f32_16x16x32_bf16 v[212:215], v[124:127], a[28:31], v[212:215]
ds_read_b128 v[156:159], v31 offset:32768
v_mfma_f32_16x16x32_bf16 v[220:223], v[92:95], a[84:87], v[220:223]
s_waitcnt lgkmcnt(4)
v_mfma_f32_16x16x32_bf16 v[208:211], v[128:131], a[32:35], v[208:211]
ds_read_b128 v[160:163], v31 offset:6144
v_mfma_f32_16x16x32_bf16 v[212:215], v[132:135], a[32:35], v[212:215]
ds_read_b128 v[164:167], v31 offset:15360
v_mfma_f32_16x16x32_bf16 v[216:219], v[96:99], a[88:91], v[216:219]
v_mfma_f32_16x16x32_bf16 v[208:211], v[136:139], a[36:39], v[208:211]
ds_read_b128 v[168:171], v31 offset:24576
v_mfma_f32_16x16x32_bf16 v[212:215], v[140:143], a[36:39], v[212:215]
ds_read_b128 v[172:175], v31 offset:33792
v_mfma_f32_16x16x32_bf16 v[220:223], v[100:103], a[88:91], v[220:223]
s_waitcnt lgkmcnt(4)
v_mfma_f32_16x16x32_bf16 v[208:211], v[144:147], a[40:43], v[208:211]
ds_read_b128 v[176:179], v31 offset:7168
v_mfma_f32_16x16x32_bf16 v[212:215], v[148:151], a[40:43], v[212:215]
ds_read_b128 v[180:183], v31 offset:16384
s_waitcnt vmcnt(3)
ds_write_b32 v18, v24
v_mfma_f32_16x16x32_bf16 v[216:219], v[104:107], a[92:95], v[216:219]
v_mfma_f32_16x16x32_bf16 v[208:211], v[152:155], a[44:47], v[208:211]
ds_read_b128 v[184:187], v31 offset:25600
v_mfma_f32_16x16x32_bf16 v[212:215], v[156:159], a[44:47], v[212:215]
ds_read_b128 v[188:191], v31 offset:34816
s_waitcnt lgkmcnt(2)
s_barrier
v_mfma_f32_16x16x32_bf16 v[220:223], v[108:111], a[92:95], v[220:223]
ds_read_b32 v33, v32
v_mfma_f32_16x16x32_bf16 v[208:211], v[160:163], a[48:51], v[208:211]
ds_read_b128 v[192:195], v31 offset:8192
v_mfma_f32_16x16x32_bf16 v[212:215], v[164:167], a[48:51], v[212:215]
ds_read_b128 v[196:199], v31 offset:17408
v_mfma_f32_16x16x32_bf16 v[216:219], v[112:115], a[96:99], v[216:219]
s_waitcnt lgkmcnt(2)
v_cmp_gt_u32 vcc, s52, v33
v_mfma_f32_16x16x32_bf16 v[208:211], v[168:171], a[52:55], v[208:211]
ds_read_b128 v[200:203], v31 offset:26624
v_cmp_gt_u32 s[58:59], s54, v33
v_mfma_f32_16x16x32_bf16 v[212:215], v[172:175], a[52:55], v[212:215]
ds_read_b128 v[204:207], v31 offset:35840
s_and_b32 vcc_lo, vcc_lo, s56
s_cselect_b32 s70, 0, 1
v_mfma_f32_16x16x32_bf16 v[220:223], v[116:119], a[96:99], v[220:223]
v_mfma_f32_16x16x32_bf16 v[208:211], v[176:179], a[56:59], v[208:211]
s_and_b32 s59, s59, s56
s_cselect_b32 s71, 0, s95
v_mfma_f32_16x16x32_bf16 v[212:215], v[180:183], a[56:59], v[212:215]
s_or_b32 s76, s70, s71
s_cselect_b32 s10, 268435456, 0
v_mfma_f32_16x16x32_bf16 v[216:219], v[120:123], a[100:103], v[216:219]
s_cmp_lg_u32 s70, 0
s_cselect_b64 s[72:73], s[52:53], s[54:55]
s_cselect_b64 s[58:59], s[44:45], s[46:47]
v_mfma_f32_16x16x32_bf16 v[208:211], v[184:187], a[60:63], v[208:211]
s_mul_i32 s74, s72, s20
s_add_u32 s74, s74, s58
v_mfma_f32_16x16x32_bf16 v[212:215], v[188:191], a[60:63], v[212:215]
s_add_u32 m0, s48, 0
s_mul_i32 s75, s72, s21
s_add_u32 s75, s75, s59
v_mfma_f32_16x16x32_bf16 v[220:223], v[124:127], a[100:103], v[220:223]
buffer_load_dwordx4 v8, s[8:11], s74 offen offset:0 sc1 lds
s_waitcnt lgkmcnt(0)
v_mfma_f32_16x16x32_bf16 v[208:211], v[192:195], a[64:67], v[208:211]
s_andn2_b32 s71, s71, s70
s_add_u32 s52, s52, s70
s_add_u32 s54, s54, s71
v_mfma_f32_16x16x32_bf16 v[212:215], v[196:199], a[64:67], v[212:215]
s_mov_b32 s77, s76
v_mfma_f32_16x16x32_bf16 v[216:219], v[128:131], a[104:107], v[216:219]
buffer_load_dwordx4 v9, s[8:11], s74 offen offset:1024 sc1 lds
v_mfma_f32_16x16x32_bf16 v[208:211], v[200:203], a[68:71], v[208:211]
v_mfma_f32_16x16x32_bf16 v[212:215], v[204:207], a[68:71], v[212:215]
v_mfma_f32_16x16x32_bf16 v[220:223], v[132:135], a[104:107], v[220:223]
buffer_load_dwordx4 v10, s[8:11], s74 offen offset:2048 sc1 lds
v_mfma_f32_16x16x32_bf16 v[216:219], v[136:139], a[108:111], v[216:219]
v_mfma_f32_16x16x32_bf16 v[220:223], v[140:143], a[108:111], v[220:223]
v_mfma_f32_16x16x32_bf16 v[216:219], v[144:147], a[112:115], v[216:219]
buffer_load_dwordx4 v11, s[8:11], s74 offen offset:3072 sc1 lds
v_mfma_f32_16x16x32_bf16 v[220:223], v[148:151], a[112:115], v[220:223]
v_mfma_f32_16x16x32_bf16 v[216:219], v[152:155], a[116:119], v[216:219]
s_add_u32 m0, s48, 4096
v_cvt_pk_bf16_f32 v48, v208, v209
v_mfma_f32_16x16x32_bf16 v[220:223], v[156:159], a[116:119], v[220:223]
buffer_load_dwordx4 v12, s[8:11], s74 offen offset:0 sc1 lds
v_mfma_f32_16x16x32_bf16 v[216:219], v[160:163], a[120:123], v[216:219]
v_cvt_pk_bf16_f32 v49, v210, v211
v_cvt_pk_bf16_f32 v50, v212, v213
v_mfma_f32_16x16x32_bf16 v[220:223], v[164:167], a[120:123], v[220:223]
v_cvt_pk_bf16_f32 v51, v214, v215
v_mfma_f32_16x16x32_bf16 v[216:219], v[168:171], a[124:127], v[216:219]
buffer_load_dwordx4 v13, s[8:11], s74 offen offset:1024 sc1 lds
v_mfma_f32_16x16x32_bf16 v[220:223], v[172:175], a[124:127], v[220:223]
buffer_store_dwordx4 v[48:51], v19, s[4:7], s93 offen sc1
v_mfma_f32_16x16x32_bf16 v[216:219], v[176:179], a[128:131], v[216:219]
v_mfma_f32_16x16x32_bf16 v[220:223], v[180:183], a[128:131], v[220:223]
buffer_load_dwordx4 v14, s[8:11], s74 offen offset:2048 sc1 lds
v_mfma_f32_16x16x32_bf16 v[216:219], v[184:187], a[132:135], v[216:219]
v_mfma_f32_16x16x32_bf16 v[220:223], v[188:191], a[132:135], v[220:223]
v_mfma_f32_16x16x32_bf16 v[216:219], v[192:195], a[136:139], v[216:219]
buffer_load_dwordx4 v15, s[8:11], s74 offen offset:3072 sc1 lds
v_mfma_f32_16x16x32_bf16 v[220:223], v[196:199], a[136:139], v[220:223]
v_mfma_f32_16x16x32_bf16 v[216:219], v[200:203], a[140:143], v[216:219]
s_add_u32 m0, s48, 8192
v_mfma_f32_16x16x32_bf16 v[220:223], v[204:207], a[140:143], v[220:223]
buffer_load_dwordx4 v16, s[8:11], s74 offen offset:0 sc1 lds
v_mfma_f32_16x16x32_bf16 v[224:227], v[64:67], a[144:147], 0
v_mfma_f32_16x16x32_bf16 v[228:231], v[68:71], a[144:147], 0
v_mfma_f32_16x16x32_bf16 v[224:227], v[72:75], a[148:151], v[224:227]
v_mfma_f32_16x16x32_bf16 v[228:231], v[76:79], a[148:151], v[228:231]
v_mfma_f32_16x16x32_bf16 v[224:227], v[80:83], a[152:155], v[224:227]
v_mfma_f32_16x16x32_bf16 v[228:231], v[84:87], a[152:155], v[228:231]
v_cvt_pk_bf16_f32 v52, v216, v217
v_cvt_pk_bf16_f32 v53, v218, v219
v_mfma_f32_16x16x32_bf16 v[224:227], v[88:91], a[156:159], v[224:227]
v_cvt_pk_bf16_f32 v54, v220, v221
v_cvt_pk_bf16_f32 v55, v222, v223
v_mfma_f32_16x16x32_bf16 v[228:231], v[92:95], a[156:159], v[228:231]
buffer_store_dwordx4 v[52:55], v20, s[4:7], s93 offen sc1
v_mfma_f32_16x16x32_bf16 v[224:227], v[96:99], a[160:163], v[224:227]
v_mfma_f32_16x16x32_bf16 v[228:231], v[100:103], a[160:163], v[228:231]
v_mfma_f32_16x16x32_bf16 v[224:227], v[104:107], a[164:167], v[224:227]
v_mfma_f32_16x16x32_bf16 v[228:231], v[108:111], a[164:167], v[228:231]
v_mfma_f32_16x16x32_bf16 v[224:227], v[112:115], a[168:171], v[224:227]
v_mfma_f32_16x16x32_bf16 v[228:231], v[116:119], a[168:171], v[228:231]
v_mfma_f32_16x16x32_bf16 v[224:227], v[120:123], a[172:175], v[224:227]
v_mfma_f32_16x16x32_bf16 v[228:231], v[124:127], a[172:175], v[228:231]
v_mfma_f32_16x16x32_bf16 v[224:227], v[128:131], a[176:179], v[224:227]
v_mfma_f32_16x16x32_bf16 v[228:231], v[132:135], a[176:179], v[228:231]
v_mfma_f32_16x16x32_bf16 v[224:227], v[136:139], a[180:183], v[224:227]
v_mfma_f32_16x16x32_bf16 v[228:231], v[140:143], a[180:183], v[228:231]
v_mfma_f32_16x16x32_bf16 v[224:227], v[144:147], a[184:187], v[224:227]
v_mfma_f32_16x16x32_bf16 v[228:231], v[148:151], a[184:187], v[228:231]
v_mfma_f32_16x16x32_bf16 v[224:227], v[152:155], a[188:191], v[224:227]
buffer_load_dword v24, v22, s[4:7], 0 offen sc1
v_mfma_f32_16x16x32_bf16 v[228:231], v[156:159], a[188:191], v[228:231]
v_mfma_f32_16x16x32_bf16 v[224:227], v[160:163], a[192:195], v[224:227]
s_waitcnt vmcnt(10)
s_barrier
v_mfma_f32_16x16x32_bf16 v[228:231], v[164:167], a[192:195], v[228:231]
buffer_store_dword v27, v45, s[4:7], s85 offen
v_mfma_f32_16x16x32_bf16 v[224:227], v[168:171], a[196:199], v[224:227]
buffer_store_dword v27, v44, s[4:7], s85 offen sc1
s_cmp_eq_u32 s76, 0
s_cbranch_scc1 g_slow_31
v_mfma_f32_16x16x32_bf16 v[228:231], v[172:175], a[196:199], v[228:231]
ds_read_b128 v[64:67], v28 offset:0
v_mfma_f32_16x16x32_bf16 v[224:227], v[176:179], a[200:203], v[224:227]
ds_read_b128 v[68:71], v28 offset:9216
v_mfma_f32_16x16x32_bf16 v[228:231], v[180:183], a[200:203], v[228:231]
ds_read_b128 v[72:75], v28 offset:18432
v_mfma_f32_16x16x32_bf16 v[224:227], v[184:187], a[204:207], v[224:227]
ds_read_b128 v[76:79], v28 offset:27648
v_mfma_f32_16x16x32_bf16 v[228:231], v[188:191], a[204:207], v[228:231]
ds_read_b128 v[80:83], v28 offset:1024
v_mfma_f32_16x16x32_bf16 v[224:227], v[192:195], a[208:211], v[224:227]
ds_read_b128 v[84:87], v28 offset:10240
v_mfma_f32_16x16x32_bf16 v[228:231], v[196:199], a[208:211], v[228:231]
ds_read_b128 v[88:91], v28 offset:19456
v_mfma_f32_16x16x32_bf16 v[224:227], v[200:203], a[212:215], v[224:227]
ds_read_b128 v[92:95], v28 offset:28672
v_mfma_f32_16x16x32_bf16 v[228:231], v[204:207], a[212:215], v[228:231]
s_waitcnt vmcnt(9)
s_barrier
s_branch g_body_16
g_slow_28:
v_mfma_f32_16x16x32_bf16 v[228:231], v[172:175], a[196:199], v[228:231]
v_mfma_f32_16x16x32_bf16 v[224:227], v[176:179], a[200:203], v[224:227]
v_mfma_f32_16x16x32_bf16 v[228:231], v[180:183], a[200:203], v[228:231]
v_mfma_f32_16x16x32_bf16 v[224:227], v[184:187], a[204:207], v[224:227]
v_mfma_f32_16x16x32_bf16 v[228:231], v[188:191], a[204:207], v[228:231]
v_mfma_f32_16x16x32_bf16 v[224:227], v[192:195], a[208:211], v[224:227]
v_mfma_f32_16x16x32_bf16 v[228:231], v[196:199], a[208:211], v[228:231]
v_mfma_f32_16x16x32_bf16 v[224:227], v[200:203], a[212:215], v[224:227]
v_mfma_f32_16x16x32_bf16 v[228:231], v[204:207], a[212:215], v[228:231]
s_nop 6
v_cvt_pk_bf16_f32 v56, v224, v225
v_cvt_pk_bf16_f32 v57, v226, v227
v_cvt_pk_bf16_f32 v58, v228, v229
v_cvt_pk_bf16_f32 v59, v230, v231
buffer_store_dwordx4 v[56:59], v21, s[4:7], s75 offen sc1
s_mov_b32 s75, 1879048192
s_waitcnt vmcnt(3)
ds_write_b32 v18, v24
s_waitcnt lgkmcnt(0)
s_barrier
ds_read_b32 v33, v32
s_waitcnt lgkmcnt(0)
v_cmp_gt_u32 vcc, s52, v33
v_cmp_gt_u32 s[58:59], s54, v33
s_and_b32 vcc_lo, vcc_lo, s56
s_cselect_b32 s70, 0, 1
s_and_b32 s59, s59, s56
s_cselect_b32 s71, 0, s77
s_or_b32 s82, s70, s71
s_cselect_b32 s10, 268435456, 0
s_cmp_lg_u32 s70, 0
s_cselect_b64 s[78:79], s[52:53], s[54:55]
s_cselect_b64 s[58:59], s[44:45], s[46:47]
s_mul_i32 s80, s78, s20
s_add_u32 s80, s80, s58
s_mul_i32 s81, s78, s21
s_add_u32 s81, s81, s59
s_andn2_b32 s71, s71, s70
s_add_u32 s52, s52, s70
s_add_u32 s54, s54, s71
s_mov_b32 s83, s82
s_cmp_lg_u32 s82, 0
s_cbranch_scc1 g_go_32
v_mov_b32 v27, s72
s_waitcnt vmcnt(0)
s_barrier
s_add_u32 s70, s52, s54
s_cmp_eq_u32 s70, 130
s_cbranch_scc1 g_fin_20
s_cmp_lg_u32 s3, 0
s_cbranch_scc1 sp_ok_34_j
s_mov_b32 s23, 0
buffer_load_dword v33, v22, s[4:7], 0 offen sc1
buffer_store_dword v27, v45, s[4:7], s73 offen
buffer_store_dword v27, v44, s[4:7], s73 offen sc1
s_waitcnt vmcnt(2)
s_branch sp_loop_33_e
sp_loop_33:
buffer_load_dword v33, v22, s[4:7], 0 offen sc1
s_add_u32 s23, s23, 1
s_cmp_gt_u32 s23, 150000
s_cbranch_scc1 sp_bad_35
s_waitcnt vmcnt(0)
sp_loop_33_e:
v_cmp_gt_u32 vcc, s52, v33
v_cmp_gt_u32 s[58:59], s54, v33
s_and_b32 vcc_lo, vcc_lo, s56
s_cbranch_scc0 sp_ok_34
s_cmp_gt_u32 s23, 4
s_cselect_b32 s70, 0, s56
s_cmp_lg_u32 s77, 0
s_cselect_b32 s70, 0, s70
s_or_b32 s59, s59, s70
s_and_b32 s59, s59, s56
s_cbranch_scc0 sp_ok_34
s_sleep 1
s_branch sp_loop_33
sp_bad_35:
s_mov_b32 s98, 1025
s_branch L_fail
sp_ok_34:
ds_write_b32 v18, v33
s_waitcnt lgkmcnt(0)
sp_ok_34_j:
s_barrier
ds_read_b32 v33, v32
s_waitcnt lgkmcnt(0)
s_mov_b32 s73, 1879048192
v_cmp_gt_u32 vcc, s52, v33
v_cmp_gt_u32 s[58:59], s54, v33
s_and_b32 vcc_lo, vcc_lo, s56
s_cselect_b32 s70, 0, 1
s_and_b32 s59, s59, s56
s_cselect_b32 s71, 0, 1
s_or_b32 s82, s70, s71
s_cselect_b32 s10, 268435456, 0
s_cmp_lg_u32 s70, 0
s_cselect_b64 s[78:79], s[52:53], s[54:55]
s_cselect_b64 s[58:59], s[44:45], s[46:47]
s_mul_i32 s80, s78, s20
s_add_u32 s80, s80, s58
s_mul_i32 s81, s78, s21
s_add_u32 s81, s81, s59
s_andn2_b32 s71, s71, s70
s_add_u32 s52, s52, s70
s_add_u32 s54, s54, s71
s_mov_b32 s83, s82
g_go_32:
s_add_u32 m0, s49, 0
s_nop 0
buffer_load_dwordx4 v8, s[4:7], s80 offen offset:0 sc1 lds
buffer_load_dwordx4 v9, s[4:7], s80 offen offset:1024 sc1 lds
buffer_load_dwordx4 v10, s[4:7], s80 offen offset:2048 sc1 lds
buffer_load_dwordx4 v11, s[4:7], s80 offen offset:3072 sc1 lds
s_add_u32 m0, s49, 4096
s_nop 0
buffer_load_dwordx4 v12, s[4:7], s80 offen offset:0 sc1 lds
buffer_load_dwordx4 v13, s[4:7], s80 offen offset:1024 sc1 lds
buffer_load_dwordx4 v14, s[4:7], s80 offen offset:2048 sc1 lds
buffer_load_dwordx4 v15, s[4:7], s80 offen offset:3072 sc1 lds
s_add_u32 m0, s49, 8192
s_nop 0
buffer_load_dwordx4 v16, s[4:7], s80 offen offset:0 sc1 lds
buffer_store_dword v27, v34, s[4:7], 0 offen
buffer_load_dword v24, v22, s[4:7], 0 offen sc1
v_mov_b32 v27, s72
s_waitcnt vmcnt(9)
s_barrier
buffer_store_dword v27, v45, s[4:7], s73 offen
buffer_store_dword v27, v44, s[4:7], s73 offen sc1
s_mov_b32 s73, 1879048192
ds_read_b128 v[64:67], v29 offset:0
ds_read_b128 v[68:71], v29 offset:9216
ds_read_b128 v[72:75], v29 offset:18432
ds_read_b128 v[76:79], v29 offset:27648
ds_read_b128 v[80:83], v29 offset:1024
ds_read_b128 v[84:87], v29 offset:10240
ds_read_b128 v[88:91], v29 offset:19456
ds_read_b128 v[92:95], v29 offset:28672
s_waitcnt vmcnt(8)
s_barrier
s_branch g_body_17
g_slow_29:
v_mfma_f32_16x16x32_bf16 v[228:231], v[172:175], a[196:199], v[228:231]
v_mfma_f32_16x16x32_bf16 v[224:227], v[176:179], a[200:203], v[224:227]
v_mfma_f32_16x16x32_bf16 v[228:231], v[180:183], a[200:203], v[228:231]
v_mfma_f32_16x16x32_bf16 v[224:227], v[184:187], a[204:207], v[224:227]
v_mfma_f32_16x16x32_bf16 v[228:231], v[188:191], a[204:207], v[228:231]
v_mfma_f32_16x16x32_bf16 v[224:227], v[192:195], a[208:211], v[224:227]
v_mfma_f32_16x16x32_bf16 v[228:231], v[196:199], a[208:211], v[228:231]
v_mfma_f32_16x16x32_bf16 v[224:227], v[200:203], a[212:215], v[224:227]
v_mfma_f32_16x16x32_bf16 v[228:231], v[204:207], a[212:215], v[228:231]
s_nop 6
v_cvt_pk_bf16_f32 v56, v224, v225
v_cvt_pk_bf16_f32 v57, v226, v227
v_cvt_pk_bf16_f32 v58, v228, v229
v_cvt_pk_bf16_f32 v59, v230, v231
buffer_store_dwordx4 v[56:59], v21, s[4:7], s81 offen sc1
s_mov_b32 s81, 1879048192
s_waitcnt vmcnt(3)
ds_write_b32 v18, v24
s_waitcnt lgkmcnt(0)
s_barrier
ds_read_b32 v33, v32
s_waitcnt lgkmcnt(0)
v_cmp_gt_u32 vcc, s52, v33
v_cmp_gt_u32 s[58:59], s54, v33
s_and_b32 vcc_lo, vcc_lo, s56
s_cselect_b32 s70, 0, 1
s_and_b32 s59, s59, s56
s_cselect_b32 s71, 0, s83
s_or_b32 s88, s70, s71
s_cselect_b32 s10, 268435456, 0
s_cmp_lg_u32 s70, 0
s_cselect_b64 s[84:85], s[52:53], s[54:55]
s_cselect_b64 s[58:59], s[44:45], s[46:47]
s_mul_i32 s86, s84, s20
s_add_u32 s86, s86, s58
s_mul_i32 s87, s84, s21
s_add_u32 s87, s87, s59
s_andn2_b32 s71, s71, s70
s_add_u32 s52, s52, s70
s_add_u32 s54, s54, s71
s_mov_b32 s89, s88
s_cmp_lg_u32 s88, 0
s_cbranch_scc1 g_go_36
v_mov_b32 v27, s78
s_waitcnt vmcnt(0)
s_barrier
s_add_u32 s70, s52, s54
s_cmp_eq_u32 s70, 130
s_cbranch_scc1 g_fin_20
s_cmp_lg_u32 s3, 0
s_cbranch_scc1 sp_ok_38_j
s_mov_b32 s23, 0
buffer_load_dword v33, v22, s[4:7], 0 offen sc1
buffer_store_dword v27, v45, s[4:7], s79 offen
buffer_store_dword v27, v44, s[4:7], s79 offen sc1
s_waitcnt vmcnt(2)
s_branch sp_loop_37_e
sp_loop_37:
buffer_load_dword v33, v22, s[4:7], 0 offen sc1
s_add_u32 s23, s23, 1
s_cmp_gt_u32 s23, 150000
s_cbranch_scc1 sp_bad_39
s_waitcnt vmcnt(0)
sp_loop_37_e:
v_cmp_gt_u32 vcc, s52, v33
v_cmp_gt_u32 s[58:59], s54, v33
s_and_b32 vcc_lo, vcc_lo, s56
s_cbranch_scc0 sp_ok_38
s_cmp_gt_u32 s23, 4
s_cselect_b32 s70, 0, s56
s_cmp_lg_u32 s83, 0
s_cselect_b32 s70, 0, s70
s_or_b32 s59, s59, s70
s_and_b32 s59, s59, s56
s_cbranch_scc0 sp_ok_38
s_sleep 1
s_branch sp_loop_37
sp_bad_39:
s_mov_b32 s98, 1025
s_branch L_fail
sp_ok_38:
ds_write_b32 v18, v33
s_waitcnt lgkmcnt(0)
sp_ok_38_j:
s_barrier
ds_read_b32 v33, v32
s_waitcnt lgkmcnt(0)
s_mov_b32 s79, 1879048192
v_cmp_gt_u32 vcc, s52, v33
v_cmp_gt_u32 s[58:59], s54, v33
s_and_b32 vcc_lo, vcc_lo, s56
s_cselect_b32 s70, 0, 1
s_and_b32 s59, s59, s56
s_cselect_b32 s71, 0, 1
s_or_b32 s88, s70, s71
s_cselect_b32 s10, 268435456, 0
s_cmp_lg_u32 s70, 0
s_cselect_b64 s[84:85], s[52:53], s[54:55]
s_cselect_b64 s[58:59], s[44:45], s[46:47]
s_mul_i32 s86, s84, s20
s_add_u32 s86, s86, s58
s_mul_i32 s87, s84, s21
s_add_u32 s87, s87, s59
s_andn2_b32 s71, s71, s70
s_add_u32 s52, s52, s70
s_add_u32 s54, s54, s71
s_mov_b32 s89, s88
g_go_36:
s_add_u32 m0, s50, 0
s_nop 0
buffer_load_dwordx4 v8, s[4:7], s86 offen offset:0 sc1 lds
buffer_load_dwordx4 v9, s[4:7], s86 offen offset:1024 sc1 lds
buffer_load_dwordx4 v10, s[4:7], s86 offen offset:2048 sc1 lds
buffer_load_dwordx4 v11, s[4:7], s86 offen offset:3072 sc1 lds
s_add_u32 m0, s50, 4096
s_nop 0
buffer_load_dwordx4 v12, s[4:7], s86 offen offset:0 sc1 lds
buffer_load_dwordx4 v13, s[4:7], s86 offen offset:1024 sc1 lds
buffer_load_dwordx4 v14, s[4:7], s86 offen offset:2048 sc1 lds
buffer_load_dwordx4 v15, s[4:7], s86 offen offset:3072 sc1 lds
s_add_u32 m0, s50, 8192
s_nop 0
buffer_load_dwordx4 v16, s[4:7], s86 offen offset:0 sc1 lds
buffer_store_dword v27, v34, s[4:7], 0 offen
buffer_load_dword v24, v22, s[4:7], 0 offen sc1
v_mov_b32 v27, s78
s_waitcnt vmcnt(9)
s_barrier
buffer_store_dword v27, v45, s[4:7], s79 offen
buffer_store_dword v27, v44, s[4:7], s79 offen sc1
s_mov_b32 s79, 1879048192
ds_read_b128 v[64:67], v30 offset:0
ds_read_b128 v[68:71], v30 offset:9216
ds_read_b128 v[72:75], v30 offset:18432
ds_read_b128 v[76:79], v30 offset:27648
ds_read_b128 v[80:83], v30 offset:1024
ds_read_b128 v[84:87], v30 offset:10240
ds_read_b128 v[88:91], v30 offset:19456
ds_read_b128 v[92:95], v30 offset:28672
s_waitcnt vmcnt(8)
s_barrier
s_branch g_body_18
g_slow_30:
v_mfma_f32_16x16x32_bf16 v[228:231], v[172:175], a[196:199], v[228:231]
v_mfma_f32_16x16x32_bf16 v[224:227], v[176:179], a[200:203], v[224:227]
v_mfma_f32_16x16x32_bf16 v[228:231], v[180:183], a[200:203], v[228:231]
v_mfma_f32_16x16x32_bf16 v[224:227], v[184:187], a[204:207], v[224:227]
v_mfma_f32_16x16x32_bf16 v[228:231], v[188:191], a[204:207], v[228:231]
v_mfma_f32_16x16x32_bf16 v[224:227], v[192:195], a[208:211], v[224:227]
v_mfma_f32_16x16x32_bf16 v[228:231], v[196:199], a[208:211], v[228:231]
v_mfma_f32_16x16x32_bf16 v[224:227], v[200:203], a[212:215], v[224:227]
v_mfma_f32_16x16x32_bf16 v[228:231], v[204:207], a[212:215], v[228:231]
s_nop 6
v_cvt_pk_bf16_f32 v56, v224, v225
v_cvt_pk_bf16_f32 v57, v226, v227
v_cvt_pk_bf16_f32 v58, v228, v229
v_cvt_pk_bf16_f32 v59, v230, v231
buffer_store_dwordx4 v[56:59], v21, s[4:7], s87 offen sc1
s_mov_b32 s87, 1879048192
s_waitcnt vmcnt(3)
ds_write_b32 v18, v24
s_waitcnt lgkmcnt(0)
s_barrier
ds_read_b32 v33, v32
s_waitcnt lgkmcnt(0)
v_cmp_gt_u32 vcc, s52, v33
v_cmp_gt_u32 s[58:59], s54, v33
s_and_b32 vcc_lo, vcc_lo, s56
s_cselect_b32 s70, 0, 1
s_and_b32 s59, s59, s56
s_cselect_b32 s71, 0, s89
s_or_b32 s94, s70, s71
s_cselect_b32 s10, 268435456, 0
s_cmp_lg_u32 s70, 0
s_cselect_b64 s[90:91], s[52:53], s[54:55]
s_cselect_b64 s[58:59], s[44:45], s[46:47]
s_mul_i32 s92, s90, s20
s_add_u32 s92, s92, s58
s_mul_i32 s93, s90, s21
s_add_u32 s93, s93, s59
s_andn2_b32 s71, s71, s70
s_add_u32 s52, s52, s70
s_add_u32 s54, s54, s71
s_mov_b32 s95, s94
s_cmp_lg_u32 s94, 0
s_cbranch_scc1 g_go_40
v_mov_b32 v27, s84
s_waitcnt vmcnt(0)
s_barrier
s_add_u32 s70, s52, s54
s_cmp_eq_u32 s70, 130
s_cbranch_scc1 g_fin_20
s_cmp_lg_u32 s3, 0
s_cbranch_scc1 sp_ok_42_j
s_mov_b32 s23, 0
buffer_load_dword v33, v22, s[4:7], 0 offen sc1
buffer_store_dword v27, v45, s[4:7], s85 offen
buffer_store_dword v27, v44, s[4:7], s85 offen sc1
s_waitcnt vmcnt(2)
s_branch sp_loop_41_e
sp_loop_41:
buffer_load_dword v33, v22, s[4:7], 0 offen sc1
s_add_u32 s23, s23, 1
s_cmp_gt_u32 s23, 150000
s_cbranch_scc1 sp_bad_43
s_waitcnt vmcnt(0)
sp_loop_41_e:
v_cmp_gt_u32 vcc, s52, v33
v_cmp_gt_u32 s[58:59], s54, v33
s_and_b32 vcc_lo, vcc_lo, s56
s_cbranch_scc0 sp_ok_42
s_cmp_gt_u32 s23, 4
s_cselect_b32 s70, 0, s56
s_cmp_lg_u32 s89, 0
s_cselect_b32 s70, 0, s70
s_or_b32 s59, s59, s70
s_and_b32 s59, s59, s56
s_cbranch_scc0 sp_ok_42
s_sleep 1
s_branch sp_loop_41
sp_bad_43:
s_mov_b32 s98, 1025
s_branch L_fail
sp_ok_42:
ds_write_b32 v18, v33
s_waitcnt lgkmcnt(0)
sp_ok_42_j:
s_barrier
ds_read_b32 v33, v32
s_waitcnt lgkmcnt(0)
s_mov_b32 s85, 1879048192
v_cmp_gt_u32 vcc, s52, v33
v_cmp_gt_u32 s[58:59], s54, v33
s_and_b32 vcc_lo, vcc_lo, s56
s_cselect_b32 s70, 0, 1
s_and_b32 s59, s59, s56
s_cselect_b32 s71, 0, 1
s_or_b32 s94, s70, s71
s_cselect_b32 s10, 268435456, 0
s_cmp_lg_u32 s70, 0
s_cselect_b64 s[90:91], s[52:53], s[54:55]
s_cselect_b64 s[58:59], s[44:45], s[46:47]
s_mul_i32 s92, s90, s20
s_add_u32 s92, s92, s58
s_mul_i32 s93, s90, s21
s_add_u32 s93, s93, s59
s_andn2_b32 s71, s71, s70
s_add_u32 s52, s52, s70
s_add_u32 s54, s54, s71
s_mov_b32 s95, s94
g_go_40:
s_add_u32 m0, s51, 0
s_nop 0
buffer_load_dwordx4 v8, s[4:7], s92 offen offset:0 sc1 lds
buffer_load_dwordx4 v9, s[4:7], s92 offen offset:1024 sc1 lds
buffer_load_dwordx4 v10, s[4:7], s92 offen offset:2048 sc1 lds
buffer_load_dwordx4 v11, s[4:7], s92 offen offset:3072 sc1 lds
s_add_u32 m0, s51, 4096
s_nop 0
buffer_load_dwordx4 v12, s[4:7], s92 offen offset:0 sc1 lds
buffer_load_dwordx4 v13, s[4:7], s92 offen offset:1024 sc1 lds
buffer_load_dwordx4 v14, s[4:7], s92 offen offset:2048 sc1 lds
buffer_load_dwordx4 v15, s[4:7], s92 offen offset:3072 sc1 lds
s_add_u32 m0, s51, 8192
s_nop 0
buffer_load_dwordx4 v16, s[4:7], s92 offen offset:0 sc1 lds
buffer_store_dword v27, v34, s[4:7], 0 offen
buffer_load_dword v24, v22, s[4:7], 0 offen sc1
v_mov_b32 v27, s84
s_waitcnt vmcnt(9)
s_barrier
buffer_store_dword v27, v45, s[4:7], s85 offen
buffer_store_dword v27, v44, s[4:7], s85 offen sc1
s_mov_b32 s85, 1879048192
ds_read_b128 v[64:67], v31 offset:0
ds_read_b128 v[68:71], v31 offset:9216
ds_read_b128 v[72:75], v31 offset:18432
ds_read_b128 v[76:79], v31 offset:27648
ds_read_b128 v[80:83], v31 offset:1024
ds_read_b128 v[84:87], v31 offset:10240
ds_read_b128 v[88:91], v31 offset:19456
ds_read_b128 v[92:95], v31 offset:28672
s_waitcnt vmcnt(8)
s_barrier
s_branch g_body_19
g_slow_31:
v_mfma_f32_16x16x32_bf16 v[228:231], v[172:175], a[196:199], v[228:231]
v_mfma_f32_16x16x32_bf16 v[224:227], v[176:179], a[200:203], v[224:227]
v_mfma_f32_16x16x32_bf16 v[228:231], v[180:183], a[200:203], v[228:231]
v_mfma_f32_16x16x32_bf16 v[224:227], v[184:187], a[204:207], v[224:227]
v_mfma_f32_16x16x32_bf16 v[228:231], v[188:191], a[204:207], v[228:231]
v_mfma_f32_16x16x32_bf16 v[224:227], v[192:195], a[208:211], v[224:227]
v_mfma_f32_16x16x32_bf16 v[228:231], v[196:199], a[208:211], v[228:231]
v_mfma_f32_16x16x32_bf16 v[224:227], v[200:203], a[212:215], v[224:227]
v_mfma_f32_16x16x32_bf16 v[228:231], v[204:207], a[212:215], v[228:231]
s_nop 6
v_cvt_pk_bf16_f32 v56, v224, v225
v_cvt_pk_bf16_f32 v57, v226, v227
v_cvt_pk_bf16_f32 v58, v228, v229
v_cvt_pk_bf16_f32 v59, v230, v231
buffer_store_dwordx4 v[56:59], v21, s[4:7], s93 offen sc1
s_mov_b32 s93, 1879048192
s_waitcnt vmcnt(3)
ds_write_b32 v18, v24
s_waitcnt lgkmcnt(0)
s_barrier
ds_read_b32 v33, v32
s_waitcnt lgkmcnt(0)
v_cmp_gt_u32 vcc, s52, v33
v_cmp_gt_u32 s[58:59], s54, v33
s_and_b32 vcc_lo, vcc_lo, s56
s_cselect_b32 s70, 0, 1
s_and_b32 s59, s59, s56
s_cselect_b32 s71, 0, s95
s_or_b32 s76, s70, s71
s_cselect_b32 s10, 268435456, 0
s_cmp_lg_u32 s70, 0
s_cselect_b64 s[72:73], s[52:53], s[54:55]
s_cselect_b64 s[58:59], s[44:45], s[46:47]
s_mul_i32 s74, s72, s20
s_add_u32 s74, s74, s58
s_mul_i32 s75, s72, s21
s_add_u32 s75, s75, s59
s_andn2_b32 s71, s71, s70
s_add_u32 s52, s52, s70
s_add_u32 s54, s54, s71
s_mov_b32 s77, s76
s_cmp_lg_u32 s76, 0
s_cbranch_scc1 g_go_44
v_mov_b32 v27, s90
s_waitcnt vmcnt(0)
s_barrier
s_add_u32 s70, s52, s54
s_cmp_eq_u32 s70, 130
s_cbranch_scc1 g_fin_20
s_cmp_lg_u32 s3, 0
s_cbranch_scc1 sp_ok_46_j
s_mov_b32 s23, 0
buffer_load_dword v33, v22, s[4:7], 0 offen sc1
buffer_store_dword v27, v45, s[4:7], s91 offen
buffer_store_dword v27, v44, s[4:7], s91 offen sc1
s_waitcnt vmcnt(2)
s_branch sp_loop_45_e
sp_loop_45:
buffer_load_dword v33, v22, s[4:7], 0 offen sc1
s_add_u32 s23, s23, 1
s_cmp_gt_u32 s23, 150000
s_cbranch_scc1 sp_bad_47
s_waitcnt vmcnt(0)
sp_loop_45_e:
v_cmp_gt_u32 vcc, s52, v33
v_cmp_gt_u32 s[58:59], s54, v33
s_and_b32 vcc_lo, vcc_lo, s56
s_cbranch_scc0 sp_ok_46
s_cmp_gt_u32 s23, 4
s_cselect_b32 s70, 0, s56
s_cmp_lg_u32 s95, 0
s_cselect_b32 s70, 0, s70
s_or_b32 s59, s59, s70
s_and_b32 s59, s59, s56
s_cbranch_scc0 sp_ok_46
s_sleep 1
s_branch sp_loop_45
sp_bad_47:
s_mov_b32 s98, 1025
s_branch L_fail
sp_ok_46:
ds_write_b32 v18, v33
s_waitcnt lgkmcnt(0)
sp_ok_46_j:
s_barrier
ds_read_b32 v33, v32
s_waitcnt lgkmcnt(0)
s_mov_b32 s91, 1879048192
v_cmp_gt_u32 vcc, s52, v33
v_cmp_gt_u32 s[58:59], s54, v33
s_and_b32 vcc_lo, vcc_lo, s56
s_cselect_b32 s70, 0, 1
s_and_b32 s59, s59, s56
s_cselect_b32 s71, 0, 1
s_or_b32 s76, s70, s71
s_cselect_b32 s10, 268435456, 0
s_cmp_lg_u32 s70, 0
s_cselect_b64 s[72:73], s[52:53], s[54:55]
s_cselect_b64 s[58:59], s[44:45], s[46:47]
s_mul_i32 s74, s72, s20
s_add_u32 s74, s74, s58
s_mul_i32 s75, s72, s21
s_add_u32 s75, s75, s59
s_andn2_b32 s71, s71, s70
s_add_u32 s52, s52, s70
s_add_u32 s54, s54, s71
s_mov_b32 s77, s76
g_go_44:
s_add_u32 m0, s48, 0
s_nop 0
buffer_load_dwordx4 v8, s[4:7], s74 offen offset:0 sc1 lds
buffer_load_dwordx4 v9, s[4:7], s74 offen offset:1024 sc1 lds
buffer_load_dwordx4 v10, s[4:7], s74 offen offset:2048 sc1 lds
buffer_load_dwordx4 v11, s[4:7], s74 offen offset:3072 sc1 lds
s_add_u32 m0, s48, 4096
s_nop 0
buffer_load_dwordx4 v12, s[4:7], s74 offen offset:0 sc1 lds
buffer_load_dwordx4 v13, s[4:7], s74 offen offset:1024 sc1 lds
buffer_load_dwordx4 v14, s[4:7], s74 offen offset:2048 sc1 lds
buffer_load_dwordx4 v15, s[4:7], s74 offen offset:3072 sc1 lds
s_add_u32 m0, s48, 8192
s_nop 0
buffer_load_dwordx4 v16, s[4:7], s74 offen offset:0 sc1 lds
buffer_store_dword v27, v34, s[4:7], 0 offen
buffer_load_dword v24, v22, s[4:7], 0 offen sc1
v_mov_b32 v27, s90
s_waitcnt vmcnt(9)
s_barrier
buffer_store_dword v27, v45, s[4:7], s91 offen
buffer_store_dword v27, v44, s[4:7], s91 offen sc1
s_mov_b32 s91, 1879048192
ds_read_b128 v[64:67], v28 offset:0
ds_read_b128 v[68:71], v28 offset:9216
ds_read_b128 v[72:75], v28 offset:18432
ds_read_b128 v[76:79], v28 offset:27648
ds_read_b128 v[80:83], v28 offset:1024
ds_read_b128 v[84:87], v28 offset:10240
ds_read_b128 v[88:91], v28 offset:19456
ds_read_b128 v[92:95], v28 offset:28672
s_waitcnt vmcnt(8)
s_barrier
s_branch g_body_16
g_fin_20:
buffer_store_dword v27, v45, s[4:7], s91 offen
buffer_store_dword v27, v44, s[4:7], s91 offen sc1
s_endpgm
G_ssv18:
s_mov_b32 s8, s42
s_and_b32 s9, s43, 0xffff
s_mov_b32 s10, 0
s_mov_b32 s11, 0x20000
s_mov_b32 s22, 0
s_mul_i32 s48, s3, 9216
s_add_u32 s49, s48, 36864
s_add_u32 s50, s48, 73728
s_add_u32 s51, s48, 110592
s_mov_b32 s57, 0xbfb8aa3b
v_add_u32 v28, 0, v17
v_add_u32 v29, 36864, v17
v_add_u32 v30, 73728, v17
v_add_u32 v31, 110592, v17
v_lshlrev_b32 v1, 2, v0
v_add_u32 v32, 147456, v1
s_lshl_b32 s70, s3, 8
v_add_u32 v18, s70, v32
v_mov_b64 v[224:225], 0
v_mov_b64 v[236:237], 0
v_mov_b64 v[226:227], 0
v_mov_b64 v[238:239], 0
v_mov_b64 v[228:229], 0
v_mov_b64 v[240:241], 0
v_mov_b64 v[230:231], 0
v_mov_b64 v[242:243], 0
s_mov_b32 s12, s40
s_and_b32 s13, s41, 0xffff
s_mov_b32 s14, 256
s_mov_b32 s15, 0x20000
v_lshlrev_b32 v26, 2, v0
v_add_u32 v27, 128, v26
v_cmp_le_u32 vcc, 2, v0
s_nop 1
v_cndmask_b32 v26, v26, v27, vcc
v_mov_b32 v27, 192
v_cmp_eq_u32 vcc, 8, v0
s_nop 1
v_cndmask_b32 v26, v26, v27, vcc
v_mov_b32 v27, 2147483632
v_cmp_lt_u32 vcc, 8, v0
s_nop 1
v_cndmask_b32 v26, v26, v27, vcc
s_mov_b32 s98, 0
wi_loop_53:
buffer_load_dword v27, v26, s[12:15], 0 offen sc1
s_add_u32 s98, s98, 1
s_cmp_gt_u32 s98, 150000
s_cbranch_scc1 wi_bad_55
s_waitcnt vmcnt(0)
v_cmp_eq_u32 vcc, 32, v27
s_nop 0
s_and_b32 s97, vcc_lo, 0x1ff
s_cmp_eq_u32 s97, 0x1ff
s_cbranch_scc1 wi_ok_54
v_cmp_lt_u32 vcc, 32, v27
s_nop 0
s_and_b32 s96, vcc_lo, 0xff
s_cselect_b32 s96, 0x100, 0
s_and_b32 s96, s96, s97
s_cbranch_scc1 wi_over_56
s_sleep 8
s_branch wi_loop_53
wi_bad_55:
s_mov_b32 s98, 512
s_branch L_fail
wi_over_56:
s_mov_b32 s100, 255
wi_ok_54:
v_add_u32 v26, 65536, v22
v_cmp_eq_u32 vcc, s100, v23
s_nop 1
v_cndmask_b32 v22, v22, v26, vcc
s_mov_b32 s90, 0
s_mov_b32 s91, 1879048192
s_mov_b32 s93, 1879048192
v_mov_b32 v34, 2147483632
s_barrier
s_mov_b32 s95, 1
s_cmp_lg_u32 s3, 0
s_cbranch_scc1 sp_ok_58_j
s_mov_b32 s23, 0
sp_loop_57:
buffer_load_dword v33, v22, s[4:7], 0 offen sc1
s_add_u32 s23, s23, 1
s_cmp_gt_u32 s23, 150000
s_cbranch_scc1 sp_bad_59
s_waitcnt vmcnt(0)
sp_loop_57_e:
v_cmp_gt_u32 vcc, s52, v33
v_cmp_gt_u32 s[58:59], s54, v33
s_and_b32 vcc_lo, vcc_lo, s56
s_cbranch_scc0 sp_ok_58
s_cmp_gt_u32 s23, 4
s_cselect_b32 s70, 0, s56
s_cmp_lg_u32 s95, 0
s_cselect_b32 s70, 0, s70
s_or_b32 s59, s59, s70
s_and_b32 s59, s59, s56
s_cbranch_scc0 sp_ok_58
s_sleep 1
s_branch sp_loop_57
sp_bad_59:
s_mov_b32 s98, 1026
s_branch L_fail
sp_ok_58:
ds_write_b32 v18, v33
s_waitcnt lgkmcnt(0)
sp_ok_58_j:
s_barrier
ds_read_b32 v33, v32
s_waitcnt lgkmcnt(0)
v_cmp_gt_u32 vcc, s52, v33
v_cmp_gt_u32 s[58:59], s54, v33
s_and_b32 vcc_lo, vcc_lo, s56
s_cselect_b32 s70, 0, 1
s_and_b32 s59, s59, s56
s_cselect_b32 s71, 0, 1
s_or_b32 s76, s70, s71
s_cselect_b32 s10, 268435456, 0
s_cmp_lg_u32 s70, 0
s_cselect_b64 s[72:73], s[52:53], s[54:55]
s_cselect_b64 s[58:59], s[44:45], s[46:47]
s_mul_i32 s74, s72, s20
s_add_u32 s74, s74, s58
s_mul_i32 s75, s72, s21
s_add_u32 s75, s75, s59
s_andn2_b32 s71, s71, s70
s_add_u32 s52, s52, s70
s_add_u32 s54, s54, s71
s_mov_b32 s77, s76
s_add_u32 m0, s48, 0
s_nop 0
buffer_load_dwordx4 v8, s[4:7], s74 offen offset:0 sc1 lds
buffer_load_dwordx4 v9, s[4:7], s74 offen offset:1024 sc1 lds
buffer_load_dwordx4 v10, s[4:7], s74 offen offset:2048 sc1 lds
buffer_load_dwordx4 v11, s[4:7], s74 offen offset:3072 sc1 lds
s_add_u32 m0, s48, 4096
s_nop 0
buffer_load_dwordx4 v12, s[4:7], s74 offen offset:0 sc1 lds
buffer_load_dwordx4 v13, s[4:7], s74 offen offset:1024 sc1 lds
buffer_load_dwordx4 v14, s[4:7], s74 offen offset:2048 sc1 lds
buffer_load_dwordx4 v15, s[4:7], s74 offen offset:3072 sc1 lds
s_add_u32 m0, s48, 8192
s_nop 0
buffer_load_dwordx4 v16, s[4:7], s74 offen offset:0 sc1 lds
buffer_store_dword v27, v34, s[4:7], 0 offen
buffer_load_dword v24, v22, s[4:7], 0 offen sc1
v_mov_b32 v27, s90
s_waitcnt vmcnt(9)
s_barrier
buffer_store_dword v27, v45, s[4:7], s91 offen
buffer_store_dword v27, v44, s[4:7], s91 offen sc1
s_mov_b32 s91, 1879048192
ds_read_b128 v[64:67], v28 offset:0
ds_read_b128 v[68:71], v28 offset:9216
ds_read_b128 v[72:75], v28 offset:18432
ds_read_b128 v[76:79], v28 offset:27648
ds_read_b128 v[80:83], v28 offset:1024
ds_read_b128 v[84:87], v28 offset:10240
ds_read_b128 v[88:91], v28 offset:19456
ds_read_b128 v[92:95], v28 offset:28672
s_waitcnt vmcnt(8)
s_barrier
s_branch g_body_48
g_body_48:
s_waitcnt lgkmcnt(4)
v_mfma_f32_16x16x32_bf16 v[208:211], a[0:3], v[64:67], 0
ds_read_b128 v[96:99], v28 offset:2048
v_mfma_f32_16x16x32_bf16 v[212:215], a[0:3], v[68:71], 0
ds_read_b128 v[100:103], v28 offset:11264
v_mfma_f32_16x16x32_bf16 v[216:219], a[72:75], v[64:67], 0
v_mfma_f32_16x16x32_bf16 v[208:211], a[4:7], v[72:75], v[208:211]
ds_read_b128 v[104:107], v28 offset:20480
v_cvt_pk_bf16_f32 v56, v224, v225
v_mfma_f32_16x16x32_bf16 v[212:215], a[4:7], v[76:79], v[212:215]
ds_read_b128 v[108:111], v28 offset:29696
v_cvt_pk_bf16_f32 v57, v226, v227
v_mfma_f32_16x16x32_bf16 v[220:223], a[72:75], v[68:71], 0
v_cvt_pk_bf16_f32 v58, v228, v229
s_waitcnt lgkmcnt(4)
v_mfma_f32_16x16x32_bf16 v[208:211], a[8:11], v[80:83], v[208:211]
ds_read_b128 v[112:115], v28 offset:3072
v_cvt_pk_bf16_f32 v59, v230, v231
v_mfma_f32_16x16x32_bf16 v[212:215], a[8:11], v[84:87], v[212:215]
ds_read_b128 v[116:119], v28 offset:12288
v_mfma_f32_16x16x32_bf16 v[216:219], a[76:79], v[72:75], v[216:219]
buffer_store_dwordx4 v[56:59], v21, s[4:7], s93 offen sc1
v_mfma_f32_16x16x32_bf16 v[208:211], a[12:15], v[88:91], v[208:211]
ds_read_b128 v[120:123], v28 offset:21504
v_mfma_f32_16x16x32_bf16 v[212:215], a[12:15], v[92:95], v[212:215]
ds_read_b128 v[124:127], v28 offset:30720
v_mfma_f32_16x16x32_bf16 v[220:223], a[76:79], v[76:79], v[220:223]
s_waitcnt lgkmcnt(4)
v_mfma_f32_16x16x32_bf16 v[208:211], a[16:19], v[96:99], v[208:211]
ds_read_b128 v[128:131], v28 offset:4096
v_mfma_f32_16x16x32_bf16 v[212:215], a[16:19], v[100:103], v[212:215]
ds_read_b128 v[132:135], v28 offset:13312
v_mfma_f32_16x16x32_bf16 v[216:219], a[80:83], v[80:83], v[216:219]
v_mfma_f32_16x16x32_bf16 v[208:211], a[20:23], v[104:107], v[208:211]
ds_read_b128 v[136:139], v28 offset:22528
v_mfma_f32_16x16x32_bf16 v[212:215], a[20:23], v[108:111], v[212:215]
ds_read_b128 v[140:143], v28 offset:31744
v_mfma_f32_16x16x32_bf16 v[220:223], a[80:83], v[84:87], v[220:223]
s_waitcnt vmcnt(5)
s_barrier
s_waitcnt lgkmcnt(4)
v_mfma_f32_16x16x32_bf16 v[208:211], a[24:27], v[112:115], v[208:211]
ds_read_b128 v[144:147], v28 offset:5120
v_mov_b32 v27, s90
v_mfma_f32_16x16x32_bf16 v[212:215], a[24:27], v[116:119], v[212:215]
ds_read_b128 v[148:151], v28 offset:14336
v_mfma_f32_16x16x32_bf16 v[216:219], a[84:87], v[88:91], v[216:219]
v_mfma_f32_16x16x32_bf16 v[208:211], a[28:31], v[120:123], v[208:211]
ds_read_b128 v[152:155], v28 offset:23552
v_mfma_f32_16x16x32_bf16 v[212:215], a[28:31], v[124:127], v[212:215]
ds_read_b128 v[156:159], v28 offset:32768
v_mfma_f32_16x16x32_bf16 v[220:223], a[84:87], v[92:95], v[220:223]
s_waitcnt lgkmcnt(4)
v_mfma_f32_16x16x32_bf16 v[208:211], a[32:35], v[128:131], v[208:211]
ds_read_b128 v[160:163], v28 offset:6144
v_mfma_f32_16x16x32_bf16 v[212:215], a[32:35], v[132:135], v[212:215]
ds_read_b128 v[164:167], v28 offset:15360
v_mfma_f32_16x16x32_bf16 v[216:219], a[88:91], v[96:99], v[216:219]
v_mfma_f32_16x16x32_bf16 v[208:211], a[36:39], v[136:139], v[208:211]
ds_read_b128 v[168:171], v28 offset:24576
v_mfma_f32_16x16x32_bf16 v[212:215], a[36:39], v[140:143], v[212:215]
ds_read_b128 v[172:175], v28 offset:33792
v_mfma_f32_16x16x32_bf16 v[220:223], a[88:91], v[100:103], v[220:223]
s_waitcnt lgkmcnt(4)
v_mfma_f32_16x16x32_bf16 v[208:211], a[40:43], v[144:147], v[208:211]
ds_read_b128 v[176:179], v28 offset:7168
v_mfma_f32_16x16x32_bf16 v[212:215], a[40:43], v[148:151], v[212:215]
ds_read_b128 v[180:183], v28 offset:16384
s_waitcnt vmcnt(3)
ds_write_b32 v18, v24
v_mfma_f32_16x16x32_bf16 v[216:219], a[92:95], v[104:107], v[216:219]
v_mfma_f32_16x16x32_bf16 v[208:211], a[44:47], v[152:155], v[208:211]
ds_read_b128 v[184:187], v28 offset:25600
v_mfma_f32_16x16x32_bf16 v[212:215], a[44:47], v[156:159], v[212:215]
ds_read_b128 v[188:191], v28 offset:34816
s_waitcnt lgkmcnt(2)
s_barrier
v_mfma_f32_16x16x32_bf16 v[220:223], a[92:95], v[108:111], v[220:223]
ds_read_b32 v33, v32
v_mfma_f32_16x16x32_bf16 v[208:211], a[48:51], v[160:163], v[208:211]
ds_read_b128 v[192:195], v28 offset:8192
v_mfma_f32_16x16x32_bf16 v[212:215], a[48:51], v[164:167], v[212:215]
ds_read_b128 v[196:199], v28 offset:17408
v_mfma_f32_16x16x32_bf16 v[216:219], a[96:99], v[112:115], v[216:219]
s_waitcnt lgkmcnt(2)
v_cmp_gt_u32 vcc, s52, v33
v_mfma_f32_16x16x32_bf16 v[208:211], a[52:55], v[168:171], v[208:211]
ds_read_b128 v[200:203], v28 offset:26624
v_cmp_gt_u32 s[58:59], s54, v33
v_mfma_f32_16x16x32_bf16 v[212:215], a[52:55], v[172:175], v[212:215]
ds_read_b128 v[204:207], v28 offset:35840
s_and_b32 vcc_lo, vcc_lo, s56
s_cselect_b32 s70, 0, 1
v_mfma_f32_16x16x32_bf16 v[220:223], a[96:99], v[116:119], v[220:223]
v_mfma_f32_16x16x32_bf16 v[208:211], a[56:59], v[176:179], v[208:211]
s_and_b32 s59, s59, s56
s_cselect_b32 s71, 0, s77
v_mfma_f32_16x16x32_bf16 v[212:215], a[56:59], v[180:183], v[212:215]
s_or_b32 s82, s70, s71
s_cselect_b32 s10, 268435456, 0
v_mfma_f32_16x16x32_bf16 v[216:219], a[100:103], v[120:123], v[216:219]
s_cmp_lg_u32 s70, 0
s_cselect_b64 s[78:79], s[52:53], s[54:55]
s_cselect_b64 s[58:59], s[44:45], s[46:47]
v_mfma_f32_16x16x32_bf16 v[208:211], a[60:63], v[184:187], v[208:211]
s_mul_i32 s80, s78, s20
s_add_u32 s80, s80, s58
v_mfma_f32_16x16x32_bf16 v[212:215], a[60:63], v[188:191], v[212:215]
s_add_u32 m0, s49, 0
s_mul_i32 s81, s78, s21
s_add_u32 s81, s81, s59
v_mfma_f32_16x16x32_bf16 v[220:223], a[100:103], v[124:127], v[220:223]
buffer_load_dwordx4 v8, s[8:11], s80 offen offset:0 sc1 lds
s_waitcnt lgkmcnt(0)
v_mfma_f32_16x16x32_bf16 v[208:211], a[64:67], v[192:195], v[208:211]
s_andn2_b32 s71, s71, s70
s_add_u32 s52, s52, s70
s_add_u32 s54, s54, s71
v_mfma_f32_16x16x32_bf16 v[212:215], a[64:67], v[196:199], v[212:215]
s_mov_b32 s83, s82
v_mfma_f32_16x16x32_bf16 v[216:219], a[104:107], v[128:131], v[216:219]
buffer_load_dwordx4 v9, s[8:11], s80 offen offset:1024 sc1 lds
v_mfma_f32_16x16x32_bf16 v[208:211], a[68:71], v[200:203], v[208:211]
v_mfma_f32_16x16x32_bf16 v[212:215], a[68:71], v[204:207], v[212:215]
v_mfma_f32_16x16x32_bf16 v[220:223], a[104:107], v[132:135], v[220:223]
buffer_load_dwordx4 v10, s[8:11], s80 offen offset:2048 sc1 lds
v_mfma_f32_16x16x32_bf16 v[216:219], a[108:111], v[136:139], v[216:219]
v_mfma_f32_16x16x32_bf16 v[220:223], a[108:111], v[140:143], v[220:223]
v_mfma_f32_16x16x32_bf16 v[216:219], a[112:115], v[144:147], v[216:219]
buffer_load_dwordx4 v11, s[8:11], s80 offen offset:3072 sc1 lds
v_mfma_f32_16x16x32_bf16 v[220:223], a[112:115], v[148:151], v[220:223]
v_mfma_f32_16x16x32_bf16 v[216:219], a[116:119], v[152:155], v[216:219]
s_add_u32 m0, s49, 4096
v_cvt_pk_bf16_f32 v48, v208, v209
v_mfma_f32_16x16x32_bf16 v[220:223], a[116:119], v[156:159], v[220:223]
buffer_load_dwordx4 v12, s[8:11], s80 offen offset:0 sc1 lds
v_mfma_f32_16x16x32_bf16 v[216:219], a[120:123], v[160:163], v[216:219]
v_cvt_pk_bf16_f32 v49, v210, v211
v_cvt_pk_bf16_f32 v50, v212, v213
v_mfma_f32_16x16x32_bf16 v[220:223], a[120:123], v[164:167], v[220:223]
v_cvt_pk_bf16_f32 v51, v214, v215
v_mfma_f32_16x16x32_bf16 v[216:219], a[124:127], v[168:171], v[216:219]
buffer_load_dwordx4 v13, s[8:11], s80 offen offset:1024 sc1 lds
v_mfma_f32_16x16x32_bf16 v[220:223], a[124:127], v[172:175], v[220:223]
v_permlane16_swap_b32 v48, v50
v_mfma_f32_16x16x32_bf16 v[216:219], a[128:131], v[176:179], v[216:219]
v_permlane16_swap_b32 v49, v51
v_mfma_f32_16x16x32_bf16 v[220:223], a[128:131], v[180:183], v[220:223]
buffer_load_dwordx4 v14, s[8:11], s80 offen offset:2048 sc1 lds
v_mfma_f32_16x16x32_bf16 v[216:219], a[132:135], v[184:187], v[216:219]
buffer_store_dwordx4 v[48:51], v19, s[4:7], s75 offen sc1
v_mfma_f32_16x16x32_bf16 v[220:223], a[132:135], v[188:191], v[220:223]
v_mfma_f32_16x16x32_bf16 v[216:219], a[136:139], v[192:195], v[216:219]
buffer_load_dwordx4 v15, s[8:11], s80 offen offset:3072 sc1 lds
v_mfma_f32_16x16x32_bf16 v[220:223], a[136:139], v[196:199], v[220:223]
v_mfma_f32_16x16x32_bf16 v[216:219], a[140:143], v[200:203], v[216:219]
s_add_u32 m0, s49, 8192
v_mfma_f32_16x16x32_bf16 v[220:223], a[140:143], v[204:207], v[220:223]
buffer_load_dwordx4 v16, s[8:11], s80 offen offset:0 sc1 lds
v_mfma_f32_16x16x32_bf16 v[224:227], v[64:67], a[144:147], 0
v_mfma_f32_16x16x32_bf16 v[228:231], v[68:71], a[144:147], 0
v_mfma_f32_16x16x32_bf16 v[224:227], v[72:75], a[148:151], v[224:227]
v_mfma_f32_16x16x32_bf16 v[228:231], v[76:79], a[148:151], v[228:231]
v_mfma_f32_16x16x32_bf16 v[224:227], v[80:83], a[152:155], v[224:227]
v_mfma_f32_16x16x32_bf16 v[228:231], v[84:87], a[152:155], v[228:231]
v_cvt_pk_bf16_f32 v52, v216, v217
v_cvt_pk_bf16_f32 v53, v218, v219
v_mfma_f32_16x16x32_bf16 v[224:227], v[88:91], a[156:159], v[224:227]
v_cvt_pk_bf16_f32 v54, v220, v221
v_cvt_pk_bf16_f32 v55, v222, v223
v_mfma_f32_16x16x32_bf16 v[228:231], v[92:95], a[156:159], v[228:231]
v_permlane16_swap_b32 v52, v54
v_mfma_f32_16x16x32_bf16 v[224:227], v[96:99], a[160:163], v[224:227]
v_permlane16_swap_b32 v53, v55
v_mfma_f32_16x16x32_bf16 v[228:231], v[100:103], a[160:163], v[228:231]
buffer_store_dwordx4 v[52:55], v20, s[4:7], s75 offen sc1
v_mfma_f32_16x16x32_bf16 v[224:227], v[104:107], a[164:167], v[224:227]
v_mfma_f32_16x16x32_bf16 v[228:231], v[108:111], a[164:167], v[228:231]
v_mfma_f32_16x16x32_bf16 v[224:227], v[112:115], a[168:171], v[224:227]
v_mfma_f32_16x16x32_bf16 v[228:231], v[116:119], a[168:171], v[228:231]
v_mfma_f32_16x16x32_bf16 v[224:227], v[120:123], a[172:175], v[224:227]
v_mfma_f32_16x16x32_bf16 v[228:231], v[124:127], a[172:175], v[228:231]
v_mfma_f32_16x16x32_bf16 v[224:227], v[128:131], a[176:179], v[224:227]
v_mfma_f32_16x16x32_bf16 v[228:231], v[132:135], a[176:179], v[228:231]
v_mfma_f32_16x16x32_bf16 v[224:227], v[136:139], a[180:183], v[224:227]
v_mfma_f32_16x16x32_bf16 v[228:231], v[140:143], a[180:183], v[228:231]
v_mfma_f32_16x16x32_bf16 v[224:227], v[144:147], a[184:187], v[224:227]
v_mfma_f32_16x16x32_bf16 v[228:231], v[148:151], a[184:187], v[228:231]
v_mfma_f32_16x16x32_bf16 v[224:227], v[152:155], a[188:191], v[224:227]
buffer_load_dword v24, v22, s[4:7], 0 offen sc1
v_mfma_f32_16x16x32_bf16 v[228:231], v[156:159], a[188:191], v[228:231]
v_mfma_f32_16x16x32_bf16 v[224:227], v[160:163], a[192:195], v[224:227]
s_waitcnt vmcnt(10)
s_barrier
v_mfma_f32_16x16x32_bf16 v[228:231], v[164:167], a[192:195], v[228:231]
buffer_store_dword v27, v45, s[4:7], s91 offen
v_mfma_f32_16x16x32_bf16 v[224:227], v[168:171], a[196:199], v[224:227]
buffer_store_dword v27, v44, s[4:7], s91 offen sc1
s_cmp_eq_u32 s82, 0
s_cbranch_scc1 g_slow_60
v_mfma_f32_16x16x32_bf16 v[228:231], v[172:175], a[196:199], v[228:231]
ds_read_b128 v[64:67], v29 offset:0
v_mfma_f32_16x16x32_bf16 v[224:227], v[176:179], a[200:203], v[224:227]
ds_read_b128 v[68:71], v29 offset:9216
v_mfma_f32_16x16x32_bf16 v[228:231], v[180:183], a[200:203], v[228:231]
ds_read_b128 v[72:75], v29 offset:18432
v_mfma_f32_16x16x32_bf16 v[224:227], v[184:187], a[204:207], v[224:227]
ds_read_b128 v[76:79], v29 offset:27648
v_mfma_f32_16x16x32_bf16 v[228:231], v[188:191], a[204:207], v[228:231]
ds_read_b128 v[80:83], v29 offset:1024
v_mfma_f32_16x16x32_bf16 v[224:227], v[192:195], a[208:211], v[224:227]
ds_read_b128 v[84:87], v29 offset:10240
v_mfma_f32_16x16x32_bf16 v[228:231], v[196:199], a[208:211], v[228:231]
ds_read_b128 v[88:91], v29 offset:19456
v_mfma_f32_16x16x32_bf16 v[224:227], v[200:203], a[212:215], v[224:227]
ds_read_b128 v[92:95], v29 offset:28672
v_mfma_f32_16x16x32_bf16 v[228:231], v[204:207], a[212:215], v[228:231]
s_waitcnt vmcnt(9)
s_barrier
g_body_49:
s_waitcnt lgkmcnt(4)
v_mfma_f32_16x16x32_bf16 v[208:211], a[0:3], v[64:67], 0
ds_read_b128 v[96:99], v29 offset:2048
v_mfma_f32_16x16x32_bf16 v[212:215], a[0:3], v[68:71], 0
ds_read_b128 v[100:103], v29 offset:11264
v_mfma_f32_16x16x32_bf16 v[216:219], a[72:75], v[64:67], 0
v_mfma_f32_16x16x32_bf16 v[208:211], a[4:7], v[72:75], v[208:211]
ds_read_b128 v[104:107], v29 offset:20480
v_cvt_pk_bf16_f32 v56, v224, v225
v_mfma_f32_16x16x32_bf16 v[212:215], a[4:7], v[76:79], v[212:215]
ds_read_b128 v[108:111], v29 offset:29696
v_cvt_pk_bf16_f32 v57, v226, v227
v_mfma_f32_16x16x32_bf16 v[220:223], a[72:75], v[68:71], 0
v_cvt_pk_bf16_f32 v58, v228, v229
s_waitcnt lgkmcnt(4)
v_mfma_f32_16x16x32_bf16 v[208:211], a[8:11], v[80:83], v[208:211]
ds_read_b128 v[112:115], v29 offset:3072
v_cvt_pk_bf16_f32 v59, v230, v231
v_mfma_f32_16x16x32_bf16 v[212:215], a[8:11], v[84:87], v[212:215]
ds_read_b128 v[116:119], v29 offset:12288
v_mfma_f32_16x16x32_bf16 v[216:219], a[76:79], v[72:75], v[216:219]
buffer_store_dwordx4 v[56:59], v21, s[4:7], s75 offen sc1
v_mfma_f32_16x16x32_bf16 v[208:211], a[12:15], v[88:91], v[208:211]
ds_read_b128 v[120:123], v29 offset:21504
v_mfma_f32_16x16x32_bf16 v[212:215], a[12:15], v[92:95], v[212:215]
ds_read_b128 v[124:127], v29 offset:30720
v_mfma_f32_16x16x32_bf16 v[220:223], a[76:79], v[76:79], v[220:223]
s_waitcnt lgkmcnt(4)
v_mfma_f32_16x16x32_bf16 v[208:211], a[16:19], v[96:99], v[208:211]
ds_read_b128 v[128:131], v29 offset:4096
v_mfma_f32_16x16x32_bf16 v[212:215], a[16:19], v[100:103], v[212:215]
ds_read_b128 v[132:135], v29 offset:13312
v_mfma_f32_16x16x32_bf16 v[216:219], a[80:83], v[80:83], v[216:219]
v_mfma_f32_16x16x32_bf16 v[208:211], a[20:23], v[104:107], v[208:211]
ds_read_b128 v[136:139], v29 offset:22528
v_mfma_f32_16x16x32_bf16 v[212:215], a[20:23], v[108:111], v[212:215]
ds_read_b128 v[140:143], v29 offset:31744
v_mfma_f32_16x16x32_bf16 v[220:223], a[80:83], v[84:87], v[220:223]
s_waitcnt vmcnt(5)
s_barrier
s_waitcnt lgkmcnt(4)
v_mfma_f32_16x16x32_bf16 v[208:211], a[24:27], v[112:115], v[208:211]
ds_read_b128 v[144:147], v29 offset:5120
v_mov_b32 v27, s72
v_mfma_f32_16x16x32_bf16 v[212:215], a[24:27], v[116:119], v[212:215]
ds_read_b128 v[148:151], v29 offset:14336
v_mfma_f32_16x16x32_bf16 v[216:219], a[84:87], v[88:91], v[216:219]
v_mfma_f32_16x16x32_bf16 v[208:211], a[28:31], v[120:123], v[208:211]
ds_read_b128 v[152:155], v29 offset:23552
v_mfma_f32_16x16x32_bf16 v[212:215], a[28:31], v[124:127], v[212:215]
ds_read_b128 v[156:159], v29 offset:32768
v_mfma_f32_16x16x32_bf16 v[220:223], a[84:87], v[92:95], v[220:223]
s_waitcnt lgkmcnt(4)
v_mfma_f32_16x16x32_bf16 v[208:211], a[32:35], v[128:131], v[208:211]
ds_read_b128 v[160:163], v29 offset:6144
v_mfma_f32_16x16x32_bf16 v[212:215], a[32:35], v[132:135], v[212:215]
ds_read_b128 v[164:167], v29 offset:15360
v_mfma_f32_16x16x32_bf16 v[216:219], a[88:91], v[96:99], v[216:219]
v_mfma_f32_16x16x32_bf16 v[208:211], a[36:39], v[136:139], v[208:211]
ds_read_b128 v[168:171], v29 offset:24576
v_mfma_f32_16x16x32_bf16 v[212:215], a[36:39], v[140:143], v[212:215]
ds_read_b128 v[172:175], v29 offset:33792
v_mfma_f32_16x16x32_bf16 v[220:223], a[88:91], v[100:103], v[220:223]
s_waitcnt lgkmcnt(4)
v_mfma_f32_16x16x32_bf16 v[208:211], a[40:43], v[144:147], v[208:211]
ds_read_b128 v[176:179], v29 offset:7168
v_mfma_f32_16x16x32_bf16 v[212:215], a[40:43], v[148:151], v[212:215]
ds_read_b128 v[180:183], v29 offset:16384
s_waitcnt vmcnt(3)
ds_write_b32 v18, v24
v_mfma_f32_16x16x32_bf16 v[216:219], a[92:95], v[104:107], v[216:219]
v_mfma_f32_16x16x32_bf16 v[208:211], a[44:47], v[152:155], v[208:211]
ds_read_b128 v[184:187], v29 offset:25600
v_mfma_f32_16x16x32_bf16 v[212:215], a[44:47], v[156:159], v[212:215]
ds_read_b128 v[188:191], v29 offset:34816
s_waitcnt lgkmcnt(2)
s_barrier
v_mfma_f32_16x16x32_bf16 v[220:223], a[92:95], v[108:111], v[220:223]
ds_read_b32 v33, v32
v_mfma_f32_16x16x32_bf16 v[208:211], a[48:51], v[160:163], v[208:211]
ds_read_b128 v[192:195], v29 offset:8192
v_mfma_f32_16x16x32_bf16 v[212:215], a[48:51], v[164:167], v[212:215]
ds_read_b128 v[196:199], v29 offset:17408
v_mfma_f32_16x16x32_bf16 v[216:219], a[96:99], v[112:115], v[216:219]
s_waitcnt lgkmcnt(2)
v_cmp_gt_u32 vcc, s52, v33
v_mfma_f32_16x16x32_bf16 v[208:211], a[52:55], v[168:171], v[208:211]
ds_read_b128 v[200:203], v29 offset:26624
v_cmp_gt_u32 s[58:59], s54, v33
v_mfma_f32_16x16x32_bf16 v[212:215], a[52:55], v[172:175], v[212:215]
ds_read_b128 v[204:207], v29 offset:35840
s_and_b32 vcc_lo, vcc_lo, s56
s_cselect_b32 s70, 0, 1
v_mfma_f32_16x16x32_bf16 v[220:223], a[96:99], v[116:119], v[220:223]
v_mfma_f32_16x16x32_bf16 v[208:211], a[56:59], v[176:179], v[208:211]
s_and_b32 s59, s59, s56
s_cselect_b32 s71, 0, s83
v_mfma_f32_16x16x32_bf16 v[212:215], a[56:59], v[180:183], v[212:215]
s_or_b32 s88, s70, s71
s_cselect_b32 s10, 268435456, 0
v_mfma_f32_16x16x32_bf16 v[216:219], a[100:103], v[120:123], v[216:219]
s_cmp_lg_u32 s70, 0
s_cselect_b64 s[84:85], s[52:53], s[54:55]
s_cselect_b64 s[58:59], s[44:45], s[46:47]
v_mfma_f32_16x16x32_bf16 v[208:211], a[60:63], v[184:187], v[208:211]
s_mul_i32 s86, s84, s20
s_add_u32 s86, s86, s58
v_mfma_f32_16x16x32_bf16 v[212:215], a[60:63], v[188:191], v[212:215]
s_add_u32 m0, s50, 0
s_mul_i32 s87, s84, s21
s_add_u32 s87, s87, s59
v_mfma_f32_16x16x32_bf16 v[220:223], a[100:103], v[124:127], v[220:223]
buffer_load_dwordx4 v8, s[8:11], s86 offen offset:0 sc1 lds
s_waitcnt lgkmcnt(0)
v_mfma_f32_16x16x32_bf16 v[208:211], a[64:67], v[192:195], v[208:211]
s_andn2_b32 s71, s71, s70
s_add_u32 s52, s52, s70
s_add_u32 s54, s54, s71
v_mfma_f32_16x16x32_bf16 v[212:215], a[64:67], v[196:199], v[212:215]
s_mov_b32 s89, s88
v_mfma_f32_16x16x32_bf16 v[216:219], a[104:107], v[128:131], v[216:219]
buffer_load_dwordx4 v9, s[8:11], s86 offen offset:1024 sc1 lds
v_mfma_f32_16x16x32_bf16 v[208:211], a[68:71], v[200:203], v[208:211]
v_mfma_f32_16x16x32_bf16 v[212:215], a[68:71], v[204:207], v[212:215]
v_mfma_f32_16x16x32_bf16 v[220:223], a[104:107], v[132:135], v[220:223]
buffer_load_dwordx4 v10, s[8:11], s86 offen offset:2048 sc1 lds
v_mfma_f32_16x16x32_bf16 v[216:219], a[108:111], v[136:139], v[216:219]
v_mfma_f32_16x16x32_bf16 v[220:223], a[108:111], v[140:143], v[220:223]
v_mfma_f32_16x16x32_bf16 v[216:219], a[112:115], v[144:147], v[216:219]
buffer_load_dwordx4 v11, s[8:11], s86 offen offset:3072 sc1 lds
v_mfma_f32_16x16x32_bf16 v[220:223], a[112:115], v[148:151], v[220:223]
v_mfma_f32_16x16x32_bf16 v[216:219], a[116:119], v[152:155], v[216:219]
s_add_u32 m0, s50, 4096
v_cvt_pk_bf16_f32 v48, v208, v209
v_mfma_f32_16x16x32_bf16 v[220:223], a[116:119], v[156:159], v[220:223]
buffer_load_dwordx4 v12, s[8:11], s86 offen offset:0 sc1 lds
v_mfma_f32_16x16x32_bf16 v[216:219], a[120:123], v[160:163], v[216:219]
v_cvt_pk_bf16_f32 v49, v210, v211
v_cvt_pk_bf16_f32 v50, v212, v213
v_mfma_f32_16x16x32_bf16 v[220:223], a[120:123], v[164:167], v[220:223]
v_cvt_pk_bf16_f32 v51, v214, v215
v_mfma_f32_16x16x32_bf16 v[216:219], a[124:127], v[168:171], v[216:219]
buffer_load_dwordx4 v13, s[8:11], s86 offen offset:1024 sc1 lds
v_mfma_f32_16x16x32_bf16 v[220:223], a[124:127], v[172:175], v[220:223]
v_permlane16_swap_b32 v48, v50
v_mfma_f32_16x16x32_bf16 v[216:219], a[128:131], v[176:179], v[216:219]
v_permlane16_swap_b32 v49, v51
v_mfma_f32_16x16x32_bf16 v[220:223], a[128:131], v[180:183], v[220:223]
buffer_load_dwordx4 v14, s[8:11], s86 offen offset:2048 sc1 lds
v_mfma_f32_16x16x32_bf16 v[216:219], a[132:135], v[184:187], v[216:219]
buffer_store_dwordx4 v[48:51], v19, s[4:7], s81 offen sc1
v_mfma_f32_16x16x32_bf16 v[220:223], a[132:135], v[188:191], v[220:223]
v_mfma_f32_16x16x32_bf16 v[216:219], a[136:139], v[192:195], v[216:219]
buffer_load_dwordx4 v15, s[8:11], s86 offen offset:3072 sc1 lds
v_mfma_f32_16x16x32_bf16 v[220:223], a[136:139], v[196:199], v[220:223]
v_mfma_f32_16x16x32_bf16 v[216:219], a[140:143], v[200:203], v[216:219]
s_add_u32 m0, s50, 8192
v_mfma_f32_16x16x32_bf16 v[220:223], a[140:143], v[204:207], v[220:223]
buffer_load_dwordx4 v16, s[8:11], s86 offen offset:0 sc1 lds
v_mfma_f32_16x16x32_bf16 v[224:227], v[64:67], a[144:147], 0
v_mfma_f32_16x16x32_bf16 v[228:231], v[68:71], a[144:147], 0
v_mfma_f32_16x16x32_bf16 v[224:227], v[72:75], a[148:151], v[224:227]
v_mfma_f32_16x16x32_bf16 v[228:231], v[76:79], a[148:151], v[228:231]
v_mfma_f32_16x16x32_bf16 v[224:227], v[80:83], a[152:155], v[224:227]
v_mfma_f32_16x16x32_bf16 v[228:231], v[84:87], a[152:155], v[228:231]
v_cvt_pk_bf16_f32 v52, v216, v217
v_cvt_pk_bf16_f32 v53, v218, v219
v_mfma_f32_16x16x32_bf16 v[224:227], v[88:91], a[156:159], v[224:227]
v_cvt_pk_bf16_f32 v54, v220, v221
v_cvt_pk_bf16_f32 v55, v222, v223
v_mfma_f32_16x16x32_bf16 v[228:231], v[92:95], a[156:159], v[228:231]
v_permlane16_swap_b32 v52, v54
v_mfma_f32_16x16x32_bf16 v[224:227], v[96:99], a[160:163], v[224:227]
v_permlane16_swap_b32 v53, v55
v_mfma_f32_16x16x32_bf16 v[228:231], v[100:103], a[160:163], v[228:231]
buffer_store_dwordx4 v[52:55], v20, s[4:7], s81 offen sc1
v_mfma_f32_16x16x32_bf16 v[224:227], v[104:107], a[164:167], v[224:227]
v_mfma_f32_16x16x32_bf16 v[228:231], v[108:111], a[164:167], v[228:231]
v_mfma_f32_16x16x32_bf16 v[224:227], v[112:115], a[168:171], v[224:227]
v_mfma_f32_16x16x32_bf16 v[228:231], v[116:119], a[168:171], v[228:231]
v_mfma_f32_16x16x32_bf16 v[224:227], v[120:123], a[172:175], v[224:227]
v_mfma_f32_16x16x32_bf16 v[228:231], v[124:127], a[172:175], v[228:231]
v_mfma_f32_16x16x32_bf16 v[224:227], v[128:131], a[176:179], v[224:227]
v_mfma_f32_16x16x32_bf16 v[228:231], v[132:135], a[176:179], v[228:231]
v_mfma_f32_16x16x32_bf16 v[224:227], v[136:139], a[180:183], v[224:227]
v_mfma_f32_16x16x32_bf16 v[228:231], v[140:143], a[180:183], v[228:231]
v_mfma_f32_16x16x32_bf16 v[224:227], v[144:147], a[184:187], v[224:227]
v_mfma_f32_16x16x32_bf16 v[228:231], v[148:151], a[184:187], v[228:231]
v_mfma_f32_16x16x32_bf16 v[224:227], v[152:155], a[188:191], v[224:227]
buffer_load_dword v24, v22, s[4:7], 0 offen sc1
v_mfma_f32_16x16x32_bf16 v[228:231], v[156:159], a[188:191], v[228:231]
v_mfma_f32_16x16x32_bf16 v[224:227], v[160:163], a[192:195], v[224:227]
s_waitcnt vmcnt(10)
s_barrier
v_mfma_f32_16x16x32_bf16 v[228:231], v[164:167], a[192:195], v[228:231]
buffer_store_dword v27, v45, s[4:7], s73 offen
v_mfma_f32_16x16x32_bf16 v[224:227], v[168:171], a[196:199], v[224:227]
buffer_store_dword v27, v44, s[4:7], s73 offen sc1
s_cmp_eq_u32 s88, 0
s_cbranch_scc1 g_slow_61
v_mfma_f32_16x16x32_bf16 v[228:231], v[172:175], a[196:199], v[228:231]
ds_read_b128 v[64:67], v30 offset:0
v_mfma_f32_16x16x32_bf16 v[224:227], v[176:179], a[200:203], v[224:227]
ds_read_b128 v[68:71], v30 offset:9216
v_mfma_f32_16x16x32_bf16 v[228:231], v[180:183], a[200:203], v[228:231]
ds_read_b128 v[72:75], v30 offset:18432
v_mfma_f32_16x16x32_bf16 v[224:227], v[184:187], a[204:207], v[224:227]
ds_read_b128 v[76:79], v30 offset:27648
v_mfma_f32_16x16x32_bf16 v[228:231], v[188:191], a[204:207], v[228:231]
ds_read_b128 v[80:83], v30 offset:1024
v_mfma_f32_16x16x32_bf16 v[224:227], v[192:195], a[208:211], v[224:227]
ds_read_b128 v[84:87], v30 offset:10240
v_mfma_f32_16x16x32_bf16 v[228:231], v[196:199], a[208:211], v[228:231]
ds_read_b128 v[88:91], v30 offset:19456
v_mfma_f32_16x16x32_bf16 v[224:227], v[200:203], a[212:215], v[224:227]
ds_read_b128 v[92:95], v30 offset:28672
v_mfma_f32_16x16x32_bf16 v[228:231], v[204:207], a[212:215], v[228:231]
s_waitcnt vmcnt(9)
s_barrier
g_body_50:
s_waitcnt lgkmcnt(4)
v_mfma_f32_16x16x32_bf16 v[208:211], a[0:3], v[64:67], 0
ds_read_b128 v[96:99], v30 offset:2048
v_mfma_f32_16x16x32_bf16 v[212:215], a[0:3], v[68:71], 0
ds_read_b128 v[100:103], v30 offset:11264
v_mfma_f32_16x16x32_bf16 v[216:219], a[72:75], v[64:67], 0
v_mfma_f32_16x16x32_bf16 v[208:211], a[4:7], v[72:75], v[208:211]
ds_read_b128 v[104:107], v30 offset:20480
v_cvt_pk_bf16_f32 v56, v224, v225
v_mfma_f32_16x16x32_bf16 v[212:215], a[4:7], v[76:79], v[212:215]
ds_read_b128 v[108:111], v30 offset:29696
v_cvt_pk_bf16_f32 v57, v226, v227
v_mfma_f32_16x16x32_bf16 v[220:223], a[72:75], v[68:71], 0
v_cvt_pk_bf16_f32 v58, v228, v229
s_waitcnt lgkmcnt(4)
v_mfma_f32_16x16x32_bf16 v[208:211], a[8:11], v[80:83], v[208:211]
ds_read_b128 v[112:115], v30 offset:3072
v_cvt_pk_bf16_f32 v59, v230, v231
v_mfma_f32_16x16x32_bf16 v[212:215], a[8:11], v[84:87], v[212:215]
ds_read_b128 v[116:119], v30 offset:12288
v_mfma_f32_16x16x32_bf16 v[216:219], a[76:79], v[72:75], v[216:219]
buffer_store_dwordx4 v[56:59], v21, s[4:7], s81 offen sc1
v_mfma_f32_16x16x32_bf16 v[208:211], a[12:15], v[88:91], v[208:211]
ds_read_b128 v[120:123], v30 offset:21504
v_mfma_f32_16x16x32_bf16 v[212:215], a[12:15], v[92:95], v[212:215]
ds_read_b128 v[124:127], v30 offset:30720
v_mfma_f32_16x16x32_bf16 v[220:223], a[76:79], v[76:79], v[220:223]
s_waitcnt lgkmcnt(4)
v_mfma_f32_16x16x32_bf16 v[208:211], a[16:19], v[96:99], v[208:211]
ds_read_b128 v[128:131], v30 offset:4096
v_mfma_f32_16x16x32_bf16 v[212:215], a[16:19], v[100:103], v[212:215]
ds_read_b128 v[132:135], v30 offset:13312
v_mfma_f32_16x16x32_bf16 v[216:219], a[80:83], v[80:83], v[216:219]
v_mfma_f32_16x16x32_bf16 v[208:211], a[20:23], v[104:107], v[208:211]
ds_read_b128 v[136:139], v30 offset:22528
v_mfma_f32_16x16x32_bf16 v[212:215], a[20:23], v[108:111], v[212:215]
ds_read_b128 v[140:143], v30 offset:31744
v_mfma_f32_16x16x32_bf16 v[220:223], a[80:83], v[84:87], v[220:223]
s_waitcnt vmcnt(5)
s_barrier
s_waitcnt lgkmcnt(4)
v_mfma_f32_16x16x32_bf16 v[208:211], a[24:27], v[112:115], v[208:211]
ds_read_b128 v[144:147], v30 offset:5120
v_mov_b32 v27, s78
v_mfma_f32_16x16x32_bf16 v[212:215], a[24:27], v[116:119], v[212:215]
ds_read_b128 v[148:151], v30 offset:14336
v_mfma_f32_16x16x32_bf16 v[216:219], a[84:87], v[88:91], v[216:219]
v_mfma_f32_16x16x32_bf16 v[208:211], a[28:31], v[120:123], v[208:211]
ds_read_b128 v[152:155], v30 offset:23552
v_mfma_f32_16x16x32_bf16 v[212:215], a[28:31], v[124:127], v[212:215]
ds_read_b128 v[156:159], v30 offset:32768
v_mfma_f32_16x16x32_bf16 v[220:223], a[84:87], v[92:95], v[220:223]
s_waitcnt lgkmcnt(4)
v_mfma_f32_16x16x32_bf16 v[208:211], a[32:35], v[128:131], v[208:211]
ds_read_b128 v[160:163], v30 offset:6144
v_mfma_f32_16x16x32_bf16 v[212:215], a[32:35], v[132:135], v[212:215]
ds_read_b128 v[164:167], v30 offset:15360
v_mfma_f32_16x16x32_bf16 v[216:219], a[88:91], v[96:99], v[216:219]
v_mfma_f32_16x16x32_bf16 v[208:211], a[36:39], v[136:139], v[208:211]
ds_read_b128 v[168:171], v30 offset:24576
v_mfma_f32_16x16x32_bf16 v[212:215], a[36:39], v[140:143], v[212:215]
ds_read_b128 v[172:175], v30 offset:33792
v_mfma_f32_16x16x32_bf16 v[220:223], a[88:91], v[100:103], v[220:223]
s_waitcnt lgkmcnt(4)
v_mfma_f32_16x16x32_bf16 v[208:211], a[40:43], v[144:147], v[208:211]
ds_read_b128 v[176:179], v30 offset:7168
v_mfma_f32_16x16x32_bf16 v[212:215], a[40:43], v[148:151], v[212:215]
ds_read_b128 v[180:183], v30 offset:16384
s_waitcnt vmcnt(3)
ds_write_b32 v18, v24
v_mfma_f32_16x16x32_bf16 v[216:219], a[92:95], v[104:107], v[216:219]
v_mfma_f32_16x16x32_bf16 v[208:211], a[44:47], v[152:155], v[208:211]
ds_read_b128 v[184:187], v30 offset:25600
v_mfma_f32_16x16x32_bf16 v[212:215], a[44:47], v[156:159], v[212:215]
ds_read_b128 v[188:191], v30 offset:34816
s_waitcnt lgkmcnt(2)
s_barrier
v_mfma_f32_16x16x32_bf16 v[220:223], a[92:95], v[108:111], v[220:223]
ds_read_b32 v33, v32
v_mfma_f32_16x16x32_bf16 v[208:211], a[48:51], v[160:163], v[208:211]
ds_read_b128 v[192:195], v30 offset:8192
v_mfma_f32_16x16x32_bf16 v[212:215], a[48:51], v[164:167], v[212:215]
ds_read_b128 v[196:199], v30 offset:17408
v_mfma_f32_16x16x32_bf16 v[216:219], a[96:99], v[112:115], v[216:219]
s_waitcnt lgkmcnt(2)
v_cmp_gt_u32 vcc, s52, v33
v_mfma_f32_16x16x32_bf16 v[208:211], a[52:55], v[168:171], v[208:211]
ds_read_b128 v[200:203], v30 offset:26624
v_cmp_gt_u32 s[58:59], s54, v33
v_mfma_f32_16x16x32_bf16 v[212:215], a[52:55], v[172:175], v[212:215]
ds_read_b128 v[204:207], v30 offset:35840
s_and_b32 vcc_lo, vcc_lo, s56
s_cselect_b32 s70, 0, 1
v_mfma_f32_16x16x32_bf16 v[220:223], a[96:99], v[116:119], v[220:223]
v_mfma_f32_16x16x32_bf16 v[208:211], a[56:59], v[176:179], v[208:211]
s_and_b32 s59, s59, s56
s_cselect_b32 s71, 0, s89
v_mfma_f32_16x16x32_bf16 v[212:215], a[56:59], v[180:183], v[212:215]
s_or_b32 s94, s70, s71
s_cselect_b32 s10, 268435456, 0
v_mfma_f32_16x16x32_bf16 v[216:219], a[100:103], v[120:123], v[216:219]
s_cmp_lg_u32 s70, 0
s_cselect_b64 s[90:91], s[52:53], s[54:55]
s_cselect_b64 s[58:59], s[44:45], s[46:47]
v_mfma_f32_16x16x32_bf16 v[208:211], a[60:63], v[184:187], v[208:211]
s_mul_i32 s92, s90, s20
s_add_u32 s92, s92, s58
v_mfma_f32_16x16x32_bf16 v[212:215], a[60:63], v[188:191], v[212:215]
s_add_u32 m0, s51, 0
s_mul_i32 s93, s90, s21
s_add_u32 s93, s93, s59
v_mfma_f32_16x16x32_bf16 v[220:223], a[100:103], v[124:127], v[220:223]
buffer_load_dwordx4 v8, s[8:11], s92 offen offset:0 sc1 lds
s_waitcnt lgkmcnt(0)
v_mfma_f32_16x16x32_bf16 v[208:211], a[64:67], v[192:195], v[208:211]
s_andn2_b32 s71, s71, s70
s_add_u32 s52, s52, s70
s_add_u32 s54, s54, s71
v_mfma_f32_16x16x32_bf16 v[212:215], a[64:67], v[196:199], v[212:215]
s_mov_b32 s95, s94
v_mfma_f32_16x16x32_bf16 v[216:219], a[104:107], v[128:131], v[216:219]
buffer_load_dwordx4 v9, s[8:11], s92 offen offset:1024 sc1 lds
v_mfma_f32_16x16x32_bf16 v[208:211], a[68:71], v[200:203], v[208:211]
v_mfma_f32_16x16x32_bf16 v[212:215], a[68:71], v[204:207], v[212:215]
v_mfma_f32_16x16x32_bf16 v[220:223], a[104:107], v[132:135], v[220:223]
buffer_load_dwordx4 v10, s[8:11], s92 offen offset:2048 sc1 lds
v_mfma_f32_16x16x32_bf16 v[216:219], a[108:111], v[136:139], v[216:219]
v_mfma_f32_16x16x32_bf16 v[220:223], a[108:111], v[140:143], v[220:223]
v_mfma_f32_16x16x32_bf16 v[216:219], a[112:115], v[144:147], v[216:219]
buffer_load_dwordx4 v11, s[8:11], s92 offen offset:3072 sc1 lds
v_mfma_f32_16x16x32_bf16 v[220:223], a[112:115], v[148:151], v[220:223]
v_mfma_f32_16x16x32_bf16 v[216:219], a[116:119], v[152:155], v[216:219]
s_add_u32 m0, s51, 4096
v_cvt_pk_bf16_f32 v48, v208, v209
v_mfma_f32_16x16x32_bf16 v[220:223], a[116:119], v[156:159], v[220:223]
buffer_load_dwordx4 v12, s[8:11], s92 offen offset:0 sc1 lds
v_mfma_f32_16x16x32_bf16 v[216:219], a[120:123], v[160:163], v[216:219]
v_cvt_pk_bf16_f32 v49, v210, v211
v_cvt_pk_bf16_f32 v50, v212, v213
v_mfma_f32_16x16x32_bf16 v[220:223], a[120:123], v[164:167], v[220:223]
v_cvt_pk_bf16_f32 v51, v214, v215
v_mfma_f32_16x16x32_bf16 v[216:219], a[124:127], v[168:171], v[216:219]
buffer_load_dwordx4 v13, s[8:11], s92 offen offset:1024 sc1 lds
v_mfma_f32_16x16x32_bf16 v[220:223], a[124:127], v[172:175], v[220:223]
v_permlane16_swap_b32 v48, v50
v_mfma_f32_16x16x32_bf16 v[216:219], a[128:131], v[176:179], v[216:219]
v_permlane16_swap_b32 v49, v51
v_mfma_f32_16x16x32_bf16 v[220:223], a[128:131], v[180:183], v[220:223]
buffer_load_dwordx4 v14, s[8:11], s92 offen offset:2048 sc1 lds
v_mfma_f32_16x16x32_bf16 v[216:219], a[132:135], v[184:187], v[216:219]
buffer_store_dwordx4 v[48:51], v19, s[4:7], s87 offen sc1
v_mfma_f32_16x16x32_bf16 v[220:223], a[132:135], v[188:191], v[220:223]
v_mfma_f32_16x16x32_bf16 v[216:219], a[136:139], v[192:195], v[216:219]
buffer_load_dwordx4 v15, s[8:11], s92 offen offset:3072 sc1 lds
v_mfma_f32_16x16x32_bf16 v[220:223], a[136:139], v[196:199], v[220:223]
v_mfma_f32_16x16x32_bf16 v[216:219], a[140:143], v[200:203], v[216:219]
s_add_u32 m0, s51, 8192
v_mfma_f32_16x16x32_bf16 v[220:223], a[140:143], v[204:207], v[220:223]
buffer_load_dwordx4 v16, s[8:11], s92 offen offset:0 sc1 lds
v_mfma_f32_16x16x32_bf16 v[224:227], v[64:67], a[144:147], 0
v_mfma_f32_16x16x32_bf16 v[228:231], v[68:71], a[144:147], 0
v_mfma_f32_16x16x32_bf16 v[224:227], v[72:75], a[148:151], v[224:227]
v_mfma_f32_16x16x32_bf16 v[228:231], v[76:79], a[148:151], v[228:231]
v_mfma_f32_16x16x32_bf16 v[224:227], v[80:83], a[152:155], v[224:227]
v_mfma_f32_16x16x32_bf16 v[228:231], v[84:87], a[152:155], v[228:231]
v_cvt_pk_bf16_f32 v52, v216, v217
v_cvt_pk_bf16_f32 v53, v218, v219
v_mfma_f32_16x16x32_bf16 v[224:227], v[88:91], a[156:159], v[224:227]
v_cvt_pk_bf16_f32 v54, v220, v221
v_cvt_pk_bf16_f32 v55, v222, v223
v_mfma_f32_16x16x32_bf16 v[228:231], v[92:95], a[156:159], v[228:231]
v_permlane16_swap_b32 v52, v54
v_mfma_f32_16x16x32_bf16 v[224:227], v[96:99], a[160:163], v[224:227]
v_permlane16_swap_b32 v53, v55
v_mfma_f32_16x16x32_bf16 v[228:231], v[100:103], a[160:163], v[228:231]
buffer_store_dwordx4 v[52:55], v20, s[4:7], s87 offen sc1
v_mfma_f32_16x16x32_bf16 v[224:227], v[104:107], a[164:167], v[224:227]
v_mfma_f32_16x16x32_bf16 v[228:231], v[108:111], a[164:167], v[228:231]
v_mfma_f32_16x16x32_bf16 v[224:227], v[112:115], a[168:171], v[224:227]
v_mfma_f32_16x16x32_bf16 v[228:231], v[116:119], a[168:171], v[228:231]
v_mfma_f32_16x16x32_bf16 v[224:227], v[120:123], a[172:175], v[224:227]
v_mfma_f32_16x16x32_bf16 v[228:231], v[124:127], a[172:175], v[228:231]
v_mfma_f32_16x16x32_bf16 v[224:227], v[128:131], a[176:179], v[224:227]
v_mfma_f32_16x16x32_bf16 v[228:231], v[132:135], a[176:179], v[228:231]
v_mfma_f32_16x16x32_bf16 v[224:227], v[136:139], a[180:183], v[224:227]
v_mfma_f32_16x16x32_bf16 v[228:231], v[140:143], a[180:183], v[228:231]
v_mfma_f32_16x16x32_bf16 v[224:227], v[144:147], a[184:187], v[224:227]
v_mfma_f32_16x16x32_bf16 v[228:231], v[148:151], a[184:187], v[228:231]
v_mfma_f32_16x16x32_bf16 v[224:227], v[152:155], a[188:191], v[224:227]
buffer_load_dword v24, v22, s[4:7], 0 offen sc1
v_mfma_f32_16x16x32_bf16 v[228:231], v[156:159], a[188:191], v[228:231]
v_mfma_f32_16x16x32_bf16 v[224:227], v[160:163], a[192:195], v[224:227]
s_waitcnt vmcnt(10)
s_barrier
v_mfma_f32_16x16x32_bf16 v[228:231], v[164:167], a[192:195], v[228:231]
buffer_store_dword v27, v45, s[4:7], s79 offen
v_mfma_f32_16x16x32_bf16 v[224:227], v[168:171], a[196:199], v[224:227]
buffer_store_dword v27, v44, s[4:7], s79 offen sc1
s_cmp_eq_u32 s94, 0
s_cbranch_scc1 g_slow_62
v_mfma_f32_16x16x32_bf16 v[228:231], v[172:175], a[196:199], v[228:231]
ds_read_b128 v[64:67], v31 offset:0
v_mfma_f32_16x16x32_bf16 v[224:227], v[176:179], a[200:203], v[224:227]
ds_read_b128 v[68:71], v31 offset:9216
v_mfma_f32_16x16x32_bf16 v[228:231], v[180:183], a[200:203], v[228:231]
ds_read_b128 v[72:75], v31 offset:18432
v_mfma_f32_16x16x32_bf16 v[224:227], v[184:187], a[204:207], v[224:227]
ds_read_b128 v[76:79], v31 offset:27648
v_mfma_f32_16x16x32_bf16 v[228:231], v[188:191], a[204:207], v[228:231]
ds_read_b128 v[80:83], v31 offset:1024
v_mfma_f32_16x16x32_bf16 v[224:227], v[192:195], a[208:211], v[224:227]
ds_read_b128 v[84:87], v31 offset:10240
v_mfma_f32_16x16x32_bf16 v[228:231], v[196:199], a[208:211], v[228:231]
ds_read_b128 v[88:91], v31 offset:19456
v_mfma_f32_16x16x32_bf16 v[224:227], v[200:203], a[212:215], v[224:227]
ds_read_b128 v[92:95], v31 offset:28672
v_mfma_f32_16x16x32_bf16 v[228:231], v[204:207], a[212:215], v[228:231]
s_waitcnt vmcnt(9)
s_barrier
g_body_51:
s_waitcnt lgkmcnt(4)
v_mfma_f32_16x16x32_bf16 v[208:211], a[0:3], v[64:67], 0
ds_read_b128 v[96:99], v31 offset:2048
v_mfma_f32_16x16x32_bf16 v[212:215], a[0:3], v[68:71], 0
ds_read_b128 v[100:103], v31 offset:11264
v_mfma_f32_16x16x32_bf16 v[216:219], a[72:75], v[64:67], 0
v_mfma_f32_16x16x32_bf16 v[208:211], a[4:7], v[72:75], v[208:211]
ds_read_b128 v[104:107], v31 offset:20480
v_cvt_pk_bf16_f32 v56, v224, v225
v_mfma_f32_16x16x32_bf16 v[212:215], a[4:7], v[76:79], v[212:215]
ds_read_b128 v[108:111], v31 offset:29696
v_cvt_pk_bf16_f32 v57, v226, v227
v_mfma_f32_16x16x32_bf16 v[220:223], a[72:75], v[68:71], 0
v_cvt_pk_bf16_f32 v58, v228, v229
s_waitcnt lgkmcnt(4)
v_mfma_f32_16x16x32_bf16 v[208:211], a[8:11], v[80:83], v[208:211]
ds_read_b128 v[112:115], v31 offset:3072
v_cvt_pk_bf16_f32 v59, v230, v231
v_mfma_f32_16x16x32_bf16 v[212:215], a[8:11], v[84:87], v[212:215]
ds_read_b128 v[116:119], v31 offset:12288
v_mfma_f32_16x16x32_bf16 v[216:219], a[76:79], v[72:75], v[216:219]
buffer_store_dwordx4 v[56:59], v21, s[4:7], s87 offen sc1
v_mfma_f32_16x16x32_bf16 v[208:211], a[12:15], v[88:91], v[208:211]
ds_read_b128 v[120:123], v31 offset:21504
v_mfma_f32_16x16x32_bf16 v[212:215], a[12:15], v[92:95], v[212:215]
ds_read_b128 v[124:127], v31 offset:30720
v_mfma_f32_16x16x32_bf16 v[220:223], a[76:79], v[76:79], v[220:223]
s_waitcnt lgkmcnt(4)
v_mfma_f32_16x16x32_bf16 v[208:211], a[16:19], v[96:99], v[208:211]
ds_read_b128 v[128:131], v31 offset:4096
v_mfma_f32_16x16x32_bf16 v[212:215], a[16:19], v[100:103], v[212:215]
ds_read_b128 v[132:135], v31 offset:13312
v_mfma_f32_16x16x32_bf16 v[216:219], a[80:83], v[80:83], v[216:219]
v_mfma_f32_16x16x32_bf16 v[208:211], a[20:23], v[104:107], v[208:211]
ds_read_b128 v[136:139], v31 offset:22528
v_mfma_f32_16x16x32_bf16 v[212:215], a[20:23], v[108:111], v[212:215]
ds_read_b128 v[140:143], v31 offset:31744
v_mfma_f32_16x16x32_bf16 v[220:223], a[80:83], v[84:87], v[220:223]
s_waitcnt vmcnt(5)
s_barrier
s_waitcnt lgkmcnt(4)
v_mfma_f32_16x16x32_bf16 v[208:211], a[24:27], v[112:115], v[208:211]
ds_read_b128 v[144:147], v31 offset:5120
v_mov_b32 v27, s84
v_mfma_f32_16x16x32_bf16 v[212:215], a[24:27], v[116:119], v[212:215]
ds_read_b128 v[148:151], v31 offset:14336
v_mfma_f32_16x16x32_bf16 v[216:219], a[84:87], v[88:91], v[216:219]
v_mfma_f32_16x16x32_bf16 v[208:211], a[28:31], v[120:123], v[208:211]
ds_read_b128 v[152:155], v31 offset:23552
v_mfma_f32_16x16x32_bf16 v[212:215], a[28:31], v[124:127], v[212:215]
ds_read_b128 v[156:159], v31 offset:32768
v_mfma_f32_16x16x32_bf16 v[220:223], a[84:87], v[92:95], v[220:223]
s_waitcnt lgkmcnt(4)
v_mfma_f32_16x16x32_bf16 v[208:211], a[32:35], v[128:131], v[208:211]
ds_read_b128 v[160:163], v31 offset:6144
v_mfma_f32_16x16x32_bf16 v[212:215], a[32:35], v[132:135], v[212:215]
ds_read_b128 v[164:167], v31 offset:15360
v_mfma_f32_16x16x32_bf16 v[216:219], a[88:91], v[96:99], v[216:219]
v_mfma_f32_16x16x32_bf16 v[208:211], a[36:39], v[136:139], v[208:211]
ds_read_b128 v[168:171], v31 offset:24576
v_mfma_f32_16x16x32_bf16 v[212:215], a[36:39], v[140:143], v[212:215]
ds_read_b128 v[172:175], v31 offset:33792
v_mfma_f32_16x16x32_bf16 v[220:223], a[88:91], v[100:103], v[220:223]
s_waitcnt lgkmcnt(4)
v_mfma_f32_16x16x32_bf16 v[208:211], a[40:43], v[144:147], v[208:211]
ds_read_b128 v[176:179], v31 offset:7168
v_mfma_f32_16x16x32_bf16 v[212:215], a[40:43], v[148:151], v[212:215]
ds_read_b128 v[180:183], v31 offset:16384
s_waitcnt vmcnt(3)
ds_write_b32 v18, v24
v_mfma_f32_16x16x32_bf16 v[216:219], a[92:95], v[104:107], v[216:219]
v_mfma_f32_16x16x32_bf16 v[208:211], a[44:47], v[152:155], v[208:211]
ds_read_b128 v[184:187], v31 offset:25600
v_mfma_f32_16x16x32_bf16 v[212:215], a[44:47], v[156:159], v[212:215]
ds_read_b128 v[188:191], v31 offset:34816
s_waitcnt lgkmcnt(2)
s_barrier
v_mfma_f32_16x16x32_bf16 v[220:223], a[92:95], v[108:111], v[220:223]
ds_read_b32 v33, v32
v_mfma_f32_16x16x32_bf16 v[208:211], a[48:51], v[160:163], v[208:211]
ds_read_b128 v[192:195], v31 offset:8192
v_mfma_f32_16x16x32_bf16 v[212:215], a[48:51], v[164:167], v[212:215]
ds_read_b128 v[196:199], v31 offset:17408
v_mfma_f32_16x16x32_bf16 v[216:219], a[96:99], v[112:115], v[216:219]
s_waitcnt lgkmcnt(2)
v_cmp_gt_u32 vcc, s52, v33
v_mfma_f32_16x16x32_bf16 v[208:211], a[52:55], v[168:171], v[208:211]
ds_read_b128 v[200:203], v31 offset:26624
v_cmp_gt_u32 s[58:59], s54, v33
v_mfma_f32_16x16x32_bf16 v[212:215], a[52:55], v[172:175], v[212:215]
ds_read_b128 v[204:207], v31 offset:35840
s_and_b32 vcc_lo, vcc_lo, s56
s_cselect_b32 s70, 0, 1
v_mfma_f32_16x16x32_bf16 v[220:223], a[96:99], v[116:119], v[220:223]
v_mfma_f32_16x16x32_bf16 v[208:211], a[56:59], v[176:179], v[208:211]
s_and_b32 s59, s59, s56
s_cselect_b32 s71, 0, s95
v_mfma_f32_16x16x32_bf16 v[212:215], a[56:59], v[180:183], v[212:215]
s_or_b32 s76, s70, s71
s_cselect_b32 s10, 268435456, 0
v_mfma_f32_16x16x32_bf16 v[216:219], a[100:103], v[120:123], v[216:219]
s_cmp_lg_u32 s70, 0
s_cselect_b64 s[72:73], s[52:53], s[54:55]
s_cselect_b64 s[58:59], s[44:45], s[46:47]
v_mfma_f32_16x16x32_bf16 v[208:211], a[60:63], v[184:187], v[208:211]
s_mul_i32 s74, s72, s20
s_add_u32 s74, s74, s58
v_mfma_f32_16x16x32_bf16 v[212:215], a[60:63], v[188:191], v[212:215]
s_add_u32 m0, s48, 0
s_mul_i32 s75, s72, s21
s_add_u32 s75, s75, s59
v_mfma_f32_16x16x32_bf16 v[220:223], a[100:103], v[124:127], v[220:223]
buffer_load_dwordx4 v8, s[8:11], s74 offen offset:0 sc1 lds
s_waitcnt lgkmcnt(0)
v_mfma_f32_16x16x32_bf16 v[208:211], a[64:67], v[192:195], v[208:211]
s_andn2_b32 s71, s71, s70
s_add_u32 s52, s52, s70
s_add_u32 s54, s54, s71
v_mfma_f32_16x16x32_bf16 v[212:215], a[64:67], v[196:199], v[212:215]
s_mov_b32 s77, s76
v_mfma_f32_16x16x32_bf16 v[216:219], a[104:107], v[128:131], v[216:219]
buffer_load_dwordx4 v9, s[8:11], s74 offen offset:1024 sc1 lds
v_mfma_f32_16x16x32_bf16 v[208:211], a[68:71], v[200:203], v[208:211]
v_mfma_f32_16x16x32_bf16 v[212:215], a[68:71], v[204:207], v[212:215]
v_mfma_f32_16x16x32_bf16 v[220:223], a[104:107], v[132:135], v[220:223]
buffer_load_dwordx4 v10, s[8:11], s74 offen offset:2048 sc1 lds
v_mfma_f32_16x16x32_bf16 v[216:219], a[108:111], v[136:139], v[216:219]
v_mfma_f32_16x16x32_bf16 v[220:223], a[108:111], v[140:143], v[220:223]
v_mfma_f32_16x16x32_bf16 v[216:219], a[112:115], v[144:147], v[216:219]
buffer_load_dwordx4 v11, s[8:11], s74 offen offset:3072 sc1 lds
v_mfma_f32_16x16x32_bf16 v[220:223], a[112:115], v[148:151], v[220:223]
v_mfma_f32_16x16x32_bf16 v[216:219], a[116:119], v[152:155], v[216:219]
s_add_u32 m0, s48, 4096
v_cvt_pk_bf16_f32 v48, v208, v209
v_mfma_f32_16x16x32_bf16 v[220:223], a[116:119], v[156:159], v[220:223]
buffer_load_dwordx4 v12, s[8:11], s74 offen offset:0 sc1 lds
v_mfma_f32_16x16x32_bf16 v[216:219], a[120:123], v[160:163], v[216:219]
v_cvt_pk_bf16_f32 v49, v210, v211
v_cvt_pk_bf16_f32 v50, v212, v213
v_mfma_f32_16x16x32_bf16 v[220:223], a[120:123], v[164:167], v[220:223]
v_cvt_pk_bf16_f32 v51, v214, v215
v_mfma_f32_16x16x32_bf16 v[216:219], a[124:127], v[168:171], v[216:219]
buffer_load_dwordx4 v13, s[8:11], s74 offen offset:1024 sc1 lds
v_mfma_f32_16x16x32_bf16 v[220:223], a[124:127], v[172:175], v[220:223]
v_permlane16_swap_b32 v48, v50
v_mfma_f32_16x16x32_bf16 v[216:219], a[128:131], v[176:179], v[216:219]
v_permlane16_swap_b32 v49, v51
v_mfma_f32_16x16x32_bf16 v[220:223], a[128:131], v[180:183], v[220:223]
buffer_load_dwordx4 v14, s[8:11], s74 offen offset:2048 sc1 lds
v_mfma_f32_16x16x32_bf16 v[216:219], a[132:135], v[184:187], v[216:219]
buffer_store_dwordx4 v[48:51], v19, s[4:7], s93 offen sc1
v_mfma_f32_16x16x32_bf16 v[220:223], a[132:135], v[188:191], v[220:223]
v_mfma_f32_16x16x32_bf16 v[216:219], a[136:139], v[192:195], v[216:219]
buffer_load_dwordx4 v15, s[8:11], s74 offen offset:3072 sc1 lds
v_mfma_f32_16x16x32_bf16 v[220:223], a[136:139], v[196:199], v[220:223]
v_mfma_f32_16x16x32_bf16 v[216:219], a[140:143], v[200:203], v[216:219]
s_add_u32 m0, s48, 8192
v_mfma_f32_16x16x32_bf16 v[220:223], a[140:143], v[204:207], v[220:223]
buffer_load_dwordx4 v16, s[8:11], s74 offen offset:0 sc1 lds
v_mfma_f32_16x16x32_bf16 v[224:227], v[64:67], a[144:147], 0
v_mfma_f32_16x16x32_bf16 v[228:231], v[68:71], a[144:147], 0
v_mfma_f32_16x16x32_bf16 v[224:227], v[72:75], a[148:151], v[224:227]
v_mfma_f32_16x16x32_bf16 v[228:231], v[76:79], a[148:151], v[228:231]
v_mfma_f32_16x16x32_bf16 v[224:227], v[80:83], a[152:155], v[224:227]
v_mfma_f32_16x16x32_bf16 v[228:231], v[84:87], a[152:155], v[228:231]
v_cvt_pk_bf16_f32 v52, v216, v217
v_cvt_pk_bf16_f32 v53, v218, v219
v_mfma_f32_16x16x32_bf16 v[224:227], v[88:91], a[156:159], v[224:227]
v_cvt_pk_bf16_f32 v54, v220, v221
v_cvt_pk_bf16_f32 v55, v222, v223
v_mfma_f32_16x16x32_bf16 v[228:231], v[92:95], a[156:159], v[228:231]
v_permlane16_swap_b32 v52, v54
v_mfma_f32_16x16x32_bf16 v[224:227], v[96:99], a[160:163], v[224:227]
v_permlane16_swap_b32 v53, v55
v_mfma_f32_16x16x32_bf16 v[228:231], v[100:103], a[160:163], v[228:231]
buffer_store_dwordx4 v[52:55], v20, s[4:7], s93 offen sc1
v_mfma_f32_16x16x32_bf16 v[224:227], v[104:107], a[164:167], v[224:227]
v_mfma_f32_16x16x32_bf16 v[228:231], v[108:111], a[164:167], v[228:231]
v_mfma_f32_16x16x32_bf16 v[224:227], v[112:115], a[168:171], v[224:227]
v_mfma_f32_16x16x32_bf16 v[228:231], v[116:119], a[168:171], v[228:231]
v_mfma_f32_16x16x32_bf16 v[224:227], v[120:123], a[172:175], v[224:227]
v_mfma_f32_16x16x32_bf16 v[228:231], v[124:127], a[172:175], v[228:231]
v_mfma_f32_16x16x32_bf16 v[224:227], v[128:131], a[176:179], v[224:227]
v_mfma_f32_16x16x32_bf16 v[228:231], v[132:135], a[176:179], v[228:231]
v_mfma_f32_16x16x32_bf16 v[224:227], v[136:139], a[180:183], v[224:227]
v_mfma_f32_16x16x32_bf16 v[228:231], v[140:143], a[180:183], v[228:231]
v_mfma_f32_16x16x32_bf16 v[224:227], v[144:147], a[184:187], v[224:227]
v_mfma_f32_16x16x32_bf16 v[228:231], v[148:151], a[184:187], v[228:231]
v_mfma_f32_16x16x32_bf16 v[224:227], v[152:155], a[188:191], v[224:227]
buffer_load_dword v24, v22, s[4:7], 0 offen sc1
v_mfma_f32_16x16x32_bf16 v[228:231], v[156:159], a[188:191], v[228:231]
v_mfma_f32_16x16x32_bf16 v[224:227], v[160:163], a[192:195], v[224:227]
s_waitcnt vmcnt(10)
s_barrier
v_mfma_f32_16x16x32_bf16 v[228:231], v[164:167], a[192:195], v[228:231]
buffer_store_dword v27, v45, s[4:7], s85 offen
v_mfma_f32_16x16x32_bf16 v[224:227], v[168:171], a[196:199], v[224:227]
buffer_store_dword v27, v44, s[4:7], s85 offen sc1
s_cmp_eq_u32 s76, 0
s_cbranch_scc1 g_slow_63
v_mfma_f32_16x16x32_bf16 v[228:231], v[172:175], a[196:199], v[228:231]
ds_read_b128 v[64:67], v28 offset:0
v_mfma_f32_16x16x32_bf16 v[224:227], v[176:179], a[200:203], v[224:227]
ds_read_b128 v[68:71], v28 offset:9216
v_mfma_f32_16x16x32_bf16 v[228:231], v[180:183], a[200:203], v[228:231]
ds_read_b128 v[72:75], v28 offset:18432
v_mfma_f32_16x16x32_bf16 v[224:227], v[184:187], a[204:207], v[224:227]
ds_read_b128 v[76:79], v28 offset:27648
v_mfma_f32_16x16x32_bf16 v[228:231], v[188:191], a[204:207], v[228:231]
ds_read_b128 v[80:83], v28 offset:1024
v_mfma_f32_16x16x32_bf16 v[224:227], v[192:195], a[208:211], v[224:227]
ds_read_b128 v[84:87], v28 offset:10240
v_mfma_f32_16x16x32_bf16 v[228:231], v[196:199], a[208:211], v[228:231]
ds_read_b128 v[88:91], v28 offset:19456
v_mfma_f32_16x16x32_bf16 v[224:227], v[200:203], a[212:215], v[224:227]
ds_read_b128 v[92:95], v28 offset:28672
v_mfma_f32_16x16x32_bf16 v[228:231], v[204:207], a[212:215], v[228:231]
s_waitcnt vmcnt(9)
s_barrier
s_branch g_body_48
g_slow_60:
v_mfma_f32_16x16x32_bf16 v[228:231], v[172:175], a[196:199], v[228:231]
v_mfma_f32_16x16x32_bf16 v[224:227], v[176:179], a[200:203], v[224:227]
v_mfma_f32_16x16x32_bf16 v[228:231], v[180:183], a[200:203], v[228:231]
v_mfma_f32_16x16x32_bf16 v[224:227], v[184:187], a[204:207], v[224:227]
v_mfma_f32_16x16x32_bf16 v[228:231], v[188:191], a[204:207], v[228:231]
v_mfma_f32_16x16x32_bf16 v[224:227], v[192:195], a[208:211], v[224:227]
v_mfma_f32_16x16x32_bf16 v[228:231], v[196:199], a[208:211], v[228:231]
v_mfma_f32_16x16x32_bf16 v[224:227], v[200:203], a[212:215], v[224:227]
v_mfma_f32_16x16x32_bf16 v[228:231], v[204:207], a[212:215], v[228:231]
s_nop 6
v_cvt_pk_bf16_f32 v56, v224, v225
v_cvt_pk_bf16_f32 v57, v226, v227
v_cvt_pk_bf16_f32 v58, v228, v229
v_cvt_pk_bf16_f32 v59, v230, v231
buffer_store_dwordx4 v[56:59], v21, s[4:7], s75 offen sc1
s_mov_b32 s75, 1879048192
s_waitcnt vmcnt(3)
ds_write_b32 v18, v24
s_waitcnt lgkmcnt(0)
s_barrier
ds_read_b32 v33, v32
s_waitcnt lgkmcnt(0)
v_cmp_gt_u32 vcc, s52, v33
v_cmp_gt_u32 s[58:59], s54, v33
s_and_b32 vcc_lo, vcc_lo, s56
s_cselect_b32 s70, 0, 1
s_and_b32 s59, s59, s56
s_cselect_b32 s71, 0, s77
s_or_b32 s82, s70, s71
s_cselect_b32 s10, 268435456, 0
s_cmp_lg_u32 s70, 0
s_cselect_b64 s[78:79], s[52:53], s[54:55]
s_cselect_b64 s[58:59], s[44:45], s[46:47]
s_mul_i32 s80, s78, s20
s_add_u32 s80, s80, s58
s_mul_i32 s81, s78, s21
s_add_u32 s81, s81, s59
s_andn2_b32 s71, s71, s70
s_add_u32 s52, s52, s70
s_add_u32 s54, s54, s71
s_mov_b32 s83, s82
s_cmp_lg_u32 s82, 0
s_cbranch_scc1 g_go_64
v_mov_b32 v27, s72
s_waitcnt vmcnt(0)
s_barrier
s_add_u32 s70, s52, s54
s_cmp_eq_u32 s70, 130
s_cbranch_scc1 g_fin_52
s_cmp_lg_u32 s3, 0
s_cbranch_scc1 sp_ok_66_j
s_mov_b32 s23, 0
buffer_load_dword v33, v22, s[4:7], 0 offen sc1
buffer_store_dword v27, v45, s[4:7], s73 offen
buffer_store_dword v27, v44, s[4:7], s73 offen sc1
s_waitcnt vmcnt(2)
s_branch sp_loop_65_e
sp_loop_65:
buffer_load_dword v33, v22, s[4:7], 0 offen sc1
s_add_u32 s23, s23, 1
s_cmp_gt_u32 s23, 150000
s_cbranch_scc1 sp_bad_67
s_waitcnt vmcnt(0)
sp_loop_65_e:
v_cmp_gt_u32 vcc, s52, v33
v_cmp_gt_u32 s[58:59], s54, v33
s_and_b32 vcc_lo, vcc_lo, s56
s_cbranch_scc0 sp_ok_66
s_cmp_gt_u32 s23, 4
s_cselect_b32 s70, 0, s56
s_cmp_lg_u32 s77, 0
s_cselect_b32 s70, 0, s70
s_or_b32 s59, s59, s70
s_and_b32 s59, s59, s56
s_cbranch_scc0 sp_ok_66
s_sleep 1
s_branch sp_loop_65
sp_bad_67:
s_mov_b32 s98, 1026
s_branch L_fail
sp_ok_66:
ds_write_b32 v18, v33
s_waitcnt lgkmcnt(0)
sp_ok_66_j:
s_barrier
ds_read_b32 v33, v32
s_waitcnt lgkmcnt(0)
s_mov_b32 s73, 1879048192
v_cmp_gt_u32 vcc, s52, v33
v_cmp_gt_u32 s[58:59], s54, v33
s_and_b32 vcc_lo, vcc_lo, s56
s_cselect_b32 s70, 0, 1
s_and_b32 s59, s59, s56
s_cselect_b32 s71, 0, 1
s_or_b32 s82, s70, s71
s_cselect_b32 s10, 268435456, 0
s_cmp_lg_u32 s70, 0
s_cselect_b64 s[78:79], s[52:53], s[54:55]
s_cselect_b64 s[58:59], s[44:45], s[46:47]
s_mul_i32 s80, s78, s20
s_add_u32 s80, s80, s58
s_mul_i32 s81, s78, s21
s_add_u32 s81, s81, s59
s_andn2_b32 s71, s71, s70
s_add_u32 s52, s52, s70
s_add_u32 s54, s54, s71
s_mov_b32 s83, s82
g_go_64:
s_add_u32 m0, s49, 0
s_nop 0
buffer_load_dwordx4 v8, s[4:7], s80 offen offset:0 sc1 lds
buffer_load_dwordx4 v9, s[4:7], s80 offen offset:1024 sc1 lds
buffer_load_dwordx4 v10, s[4:7], s80 offen offset:2048 sc1 lds
buffer_load_dwordx4 v11, s[4:7], s80 offen offset:3072 sc1 lds
s_add_u32 m0, s49, 4096
s_nop 0
buffer_load_dwordx4 v12, s[4:7], s80 offen offset:0 sc1 lds
buffer_load_dwordx4 v13, s[4:7], s80 offen offset:1024 sc1 lds
buffer_load_dwordx4 v14, s[4:7], s80 offen offset:2048 sc1 lds
buffer_load_dwordx4 v15, s[4:7], s80 offen offset:3072 sc1 lds
s_add_u32 m0, s49, 8192
s_nop 0
buffer_load_dwordx4 v16, s[4:7], s80 offen offset:0 sc1 lds
buffer_store_dword v27, v34, s[4:7], 0 offen
buffer_load_dword v24, v22, s[4:7], 0 offen sc1
v_mov_b32 v27, s72
s_waitcnt vmcnt(9)
s_barrier
buffer_store_dword v27, v45, s[4:7], s73 offen
buffer_store_dword v27, v44, s[4:7], s73 offen sc1
s_mov_b32 s73, 1879048192
ds_read_b128 v[64:67], v29 offset:0
ds_read_b128 v[68:71], v29 offset:9216
ds_read_b128 v[72:75], v29 offset:18432
ds_read_b128 v[76:79], v29 offset:27648
ds_read_b128 v[80:83], v29 offset:1024
ds_read_b128 v[84:87], v29 offset:10240
ds_read_b128 v[88:91], v29 offset:19456
ds_read_b128 v[92:95], v29 offset:28672
s_waitcnt vmcnt(8)
s_barrier
s_branch g_body_49
g_slow_61:
v_mfma_f32_16x16x32_bf16 v[228:231], v[172:175], a[196:199], v[228:231]
v_mfma_f32_16x16x32_bf16 v[224:227], v[176:179], a[200:203], v[224:227]
v_mfma_f32_16x16x32_bf16 v[228:231], v[180:183], a[200:203], v[228:231]
v_mfma_f32_16x16x32_bf16 v[224:227], v[184:187], a[204:207], v[224:227]
v_mfma_f32_16x16x32_bf16 v[228:231], v[188:191], a[204:207], v[228:231]
v_mfma_f32_16x16x32_bf16 v[224:227], v[192:195], a[208:211], v[224:227]
v_mfma_f32_16x16x32_bf16 v[228:231], v[196:199], a[208:211], v[228:231]
v_mfma_f32_16x16x32_bf16 v[224:227], v[200:203], a[212:215], v[224:227]
v_mfma_f32_16x16x32_bf16 v[228:231], v[204:207], a[212:215], v[228:231]
s_nop 6
v_cvt_pk_bf16_f32 v56, v224, v225
v_cvt_pk_bf16_f32 v57, v226, v227
v_cvt_pk_bf16_f32 v58, v228, v229
v_cvt_pk_bf16_f32 v59, v230, v231
buffer_store_dwordx4 v[56:59], v21, s[4:7], s81 offen sc1
s_mov_b32 s81, 1879048192
s_waitcnt vmcnt(3)
ds_write_b32 v18, v24
s_waitcnt lgkmcnt(0)
s_barrier
ds_read_b32 v33, v32
s_waitcnt lgkmcnt(0)
v_cmp_gt_u32 vcc, s52, v33
v_cmp_gt_u32 s[58:59], s54, v33
s_and_b32 vcc_lo, vcc_lo, s56
s_cselect_b32 s70, 0, 1
s_and_b32 s59, s59, s56
s_cselect_b32 s71, 0, s83
s_or_b32 s88, s70, s71
s_cselect_b32 s10, 268435456, 0
s_cmp_lg_u32 s70, 0
s_cselect_b64 s[84:85], s[52:53], s[54:55]
s_cselect_b64 s[58:59], s[44:45], s[46:47]
s_mul_i32 s86, s84, s20
s_add_u32 s86, s86, s58
s_mul_i32 s87, s84, s21
s_add_u32 s87, s87, s59
s_andn2_b32 s71, s71, s70
s_add_u32 s52, s52, s70
s_add_u32 s54, s54, s71
s_mov_b32 s89, s88
s_cmp_lg_u32 s88, 0
s_cbranch_scc1 g_go_68
v_mov_b32 v27, s78
s_waitcnt vmcnt(0)
s_barrier
s_add_u32 s70, s52, s54
s_cmp_eq_u32 s70, 130
s_cbranch_scc1 g_fin_52
s_cmp_lg_u32 s3, 0
s_cbranch_scc1 sp_ok_70_j
s_mov_b32 s23, 0
buffer_load_dword v33, v22, s[4:7], 0 offen sc1
buffer_store_dword v27, v45, s[4:7], s79 offen
buffer_store_dword v27, v44, s[4:7], s79 offen sc1
s_waitcnt vmcnt(2)
s_branch sp_loop_69_e
sp_loop_69:
buffer_load_dword v33, v22, s[4:7], 0 offen sc1
s_add_u32 s23, s23, 1
s_cmp_gt_u32 s23, 150000
s_cbranch_scc1 sp_bad_71
s_waitcnt vmcnt(0)
sp_loop_69_e:
v_cmp_gt_u32 vcc, s52, v33
v_cmp_gt_u32 s[58:59], s54, v33
s_and_b32 vcc_lo, vcc_lo, s56
s_cbranch_scc0 sp_ok_70
s_cmp_gt_u32 s23, 4
s_cselect_b32 s70, 0, s56
s_cmp_lg_u32 s83, 0
s_cselect_b32 s70, 0, s70
s_or_b32 s59, s59, s70
s_and_b32 s59, s59, s56
s_cbranch_scc0 sp_ok_70
s_sleep 1
s_branch sp_loop_69
sp_bad_71:
s_mov_b32 s98, 1026
s_branch L_fail
sp_ok_70:
ds_write_b32 v18, v33
s_waitcnt lgkmcnt(0)
sp_ok_70_j:
s_barrier
ds_read_b32 v33, v32
s_waitcnt lgkmcnt(0)
s_mov_b32 s79, 1879048192
v_cmp_gt_u32 vcc, s52, v33
v_cmp_gt_u32 s[58:59], s54, v33
s_and_b32 vcc_lo, vcc_lo, s56
s_cselect_b32 s70, 0, 1
s_and_b32 s59, s59, s56
s_cselect_b32 s71, 0, 1
s_or_b32 s88, s70, s71
s_cselect_b32 s10, 268435456, 0
s_cmp_lg_u32 s70, 0
s_cselect_b64 s[84:85], s[52:53], s[54:55]
s_cselect_b64 s[58:59], s[44:45], s[46:47]
s_mul_i32 s86, s84, s20
s_add_u32 s86, s86, s58
s_mul_i32 s87, s84, s21
s_add_u32 s87, s87, s59
s_andn2_b32 s71, s71, s70
s_add_u32 s52, s52, s70
s_add_u32 s54, s54, s71
s_mov_b32 s89, s88
g_go_68:
s_add_u32 m0, s50, 0
s_nop 0
buffer_load_dwordx4 v8, s[4:7], s86 offen offset:0 sc1 lds
buffer_load_dwordx4 v9, s[4:7], s86 offen offset:1024 sc1 lds
buffer_load_dwordx4 v10, s[4:7], s86 offen offset:2048 sc1 lds
buffer_load_dwordx4 v11, s[4:7], s86 offen offset:3072 sc1 lds
s_add_u32 m0, s50, 4096
s_nop 0
buffer_load_dwordx4 v12, s[4:7], s86 offen offset:0 sc1 lds
buffer_load_dwordx4 v13, s[4:7], s86 offen offset:1024 sc1 lds
buffer_load_dwordx4 v14, s[4:7], s86 offen offset:2048 sc1 lds
buffer_load_dwordx4 v15, s[4:7], s86 offen offset:3072 sc1 lds
s_add_u32 m0, s50, 8192
s_nop 0
buffer_load_dwordx4 v16, s[4:7], s86 offen offset:0 sc1 lds
buffer_store_dword v27, v34, s[4:7], 0 offen
buffer_load_dword v24, v22, s[4:7], 0 offen sc1
v_mov_b32 v27, s78
s_waitcnt vmcnt(9)
s_barrier
buffer_store_dword v27, v45, s[4:7], s79 offen
buffer_store_dword v27, v44, s[4:7], s79 offen sc1
s_mov_b32 s79, 1879048192
ds_read_b128 v[64:67], v30 offset:0
ds_read_b128 v[68:71], v30 offset:9216
ds_read_b128 v[72:75], v30 offset:18432
ds_read_b128 v[76:79], v30 offset:27648
ds_read_b128 v[80:83], v30 offset:1024
ds_read_b128 v[84:87], v30 offset:10240
ds_read_b128 v[88:91], v30 offset:19456
ds_read_b128 v[92:95], v30 offset:28672
s_waitcnt vmcnt(8)
s_barrier
s_branch g_body_50
g_slow_62:
v_mfma_f32_16x16x32_bf16 v[228:231], v[172:175], a[196:199], v[228:231]
v_mfma_f32_16x16x32_bf16 v[224:227], v[176:179], a[200:203], v[224:227]
v_mfma_f32_16x16x32_bf16 v[228:231], v[180:183], a[200:203], v[228:231]
v_mfma_f32_16x16x32_bf16 v[224:227], v[184:187], a[204:207], v[224:227]
v_mfma_f32_16x16x32_bf16 v[228:231], v[188:191], a[204:207], v[228:231]
v_mfma_f32_16x16x32_bf16 v[224:227], v[192:195], a[208:211], v[224:227]
v_mfma_f32_16x16x32_bf16 v[228:231], v[196:199], a[208:211], v[228:231]
v_mfma_f32_16x16x32_bf16 v[224:227], v[200:203], a[212:215], v[224:227]
v_mfma_f32_16x16x32_bf16 v[228:231], v[204:207], a[212:215], v[228:231]
s_nop 6
v_cvt_pk_bf16_f32 v56, v224, v225
v_cvt_pk_bf16_f32 v57, v226, v227
v_cvt_pk_bf16_f32 v58, v228, v229
v_cvt_pk_bf16_f32 v59, v230, v231
buffer_store_dwordx4 v[56:59], v21, s[4:7], s87 offen sc1
s_mov_b32 s87, 1879048192
s_waitcnt vmcnt(3)
ds_write_b32 v18, v24
s_waitcnt lgkmcnt(0)
s_barrier
ds_read_b32 v33, v32
s_waitcnt lgkmcnt(0)
v_cmp_gt_u32 vcc, s52, v33
v_cmp_gt_u32 s[58:59], s54, v33
s_and_b32 vcc_lo, vcc_lo, s56
s_cselect_b32 s70, 0, 1
s_and_b32 s59, s59, s56
s_cselect_b32 s71, 0, s89
s_or_b32 s94, s70, s71
s_cselect_b32 s10, 268435456, 0
s_cmp_lg_u32 s70, 0
s_cselect_b64 s[90:91], s[52:53], s[54:55]
s_cselect_b64 s[58:59], s[44:45], s[46:47]
s_mul_i32 s92, s90, s20
s_add_u32 s92, s92, s58
s_mul_i32 s93, s90, s21
s_add_u32 s93, s93, s59
s_andn2_b32 s71, s71, s70
s_add_u32 s52, s52, s70
s_add_u32 s54, s54, s71
s_mov_b32 s95, s94
s_cmp_lg_u32 s94, 0
s_cbranch_scc1 g_go_72
v_mov_b32 v27, s84
s_waitcnt vmcnt(0)
s_barrier
s_add_u32 s70, s52, s54
s_cmp_eq_u32 s70, 130
s_cbranch_scc1 g_fin_52
s_cmp_lg_u32 s3, 0
s_cbranch_scc1 sp_ok_74_j
s_mov_b32 s23, 0
buffer_load_dword v33, v22, s[4:7], 0 offen sc1
buffer_store_dword v27, v45, s[4:7], s85 offen
buffer_store_dword v27, v44, s[4:7], s85 offen sc1
s_waitcnt vmcnt(2)
s_branch sp_loop_73_e
sp_loop_73:
buffer_load_dword v33, v22, s[4:7], 0 offen sc1
s_add_u32 s23, s23, 1
s_cmp_gt_u32 s23, 150000
s_cbranch_scc1 sp_bad_75
s_waitcnt vmcnt(0)
sp_loop_73_e:
v_cmp_gt_u32 vcc, s52, v33
v_cmp_gt_u32 s[58:59], s54, v33
s_and_b32 vcc_lo, vcc_lo, s56
s_cbranch_scc0 sp_ok_74
s_cmp_gt_u32 s23, 4
s_cselect_b32 s70, 0, s56
s_cmp_lg_u32 s89, 0
s_cselect_b32 s70, 0, s70
s_or_b32 s59, s59, s70
s_and_b32 s59, s59, s56
s_cbranch_scc0 sp_ok_74
s_sleep 1
s_branch sp_loop_73
sp_bad_75:
s_mov_b32 s98, 1026
s_branch L_fail
sp_ok_74:
ds_write_b32 v18, v33
s_waitcnt lgkmcnt(0)
sp_ok_74_j:
s_barrier
ds_read_b32 v33, v32
s_waitcnt lgkmcnt(0)
s_mov_b32 s85, 1879048192
v_cmp_gt_u32 vcc, s52, v33
v_cmp_gt_u32 s[58:59], s54, v33
s_and_b32 vcc_lo, vcc_lo, s56
s_cselect_b32 s70, 0, 1
s_and_b32 s59, s59, s56
s_cselect_b32 s71, 0, 1
s_or_b32 s94, s70, s71
s_cselect_b32 s10, 268435456, 0
s_cmp_lg_u32 s70, 0
s_cselect_b64 s[90:91], s[52:53], s[54:55]
s_cselect_b64 s[58:59], s[44:45], s[46:47]
s_mul_i32 s92, s90, s20
s_add_u32 s92, s92, s58
s_mul_i32 s93, s90, s21
s_add_u32 s93, s93, s59
s_andn2_b32 s71, s71, s70
s_add_u32 s52, s52, s70
s_add_u32 s54, s54, s71
s_mov_b32 s95, s94
g_go_72:
s_add_u32 m0, s51, 0
s_nop 0
buffer_load_dwordx4 v8, s[4:7], s92 offen offset:0 sc1 lds
buffer_load_dwordx4 v9, s[4:7], s92 offen offset:1024 sc1 lds
buffer_load_dwordx4 v10, s[4:7], s92 offen offset:2048 sc1 lds
buffer_load_dwordx4 v11, s[4:7], s92 offen offset:3072 sc1 lds
s_add_u32 m0, s51, 4096
s_nop 0
buffer_load_dwordx4 v12, s[4:7], s92 offen offset:0 sc1 lds
buffer_load_dwordx4 v13, s[4:7], s92 offen offset:1024 sc1 lds
buffer_load_dwordx4 v14, s[4:7], s92 offen offset:2048 sc1 lds
buffer_load_dwordx4 v15, s[4:7], s92 offen offset:3072 sc1 lds
s_add_u32 m0, s51, 8192
s_nop 0
buffer_load_dwordx4 v16, s[4:7], s92 offen offset:0 sc1 lds
buffer_store_dword v27, v34, s[4:7], 0 offen
buffer_load_dword v24, v22, s[4:7], 0 offen sc1
v_mov_b32 v27, s84
s_waitcnt vmcnt(9)
s_barrier
buffer_store_dword v27, v45, s[4:7], s85 offen
buffer_store_dword v27, v44, s[4:7], s85 offen sc1
s_mov_b32 s85, 1879048192
ds_read_b128 v[64:67], v31 offset:0
ds_read_b128 v[68:71], v31 offset:9216
ds_read_b128 v[72:75], v31 offset:18432
ds_read_b128 v[76:79], v31 offset:27648
ds_read_b128 v[80:83], v31 offset:1024
ds_read_b128 v[84:87], v31 offset:10240
ds_read_b128 v[88:91], v31 offset:19456
ds_read_b128 v[92:95], v31 offset:28672
s_waitcnt vmcnt(8)
s_barrier
s_branch g_body_51
g_slow_63:
v_mfma_f32_16x16x32_bf16 v[228:231], v[172:175], a[196:199], v[228:231]
v_mfma_f32_16x16x32_bf16 v[224:227], v[176:179], a[200:203], v[224:227]
v_mfma_f32_16x16x32_bf16 v[228:231], v[180:183], a[200:203], v[228:231]
v_mfma_f32_16x16x32_bf16 v[224:227], v[184:187], a[204:207], v[224:227]
v_mfma_f32_16x16x32_bf16 v[228:231], v[188:191], a[204:207], v[228:231]
v_mfma_f32_16x16x32_bf16 v[224:227], v[192:195], a[208:211], v[224:227]
v_mfma_f32_16x16x32_bf16 v[228:231], v[196:199], a[208:211], v[228:231]
v_mfma_f32_16x16x32_bf16 v[224:227], v[200:203], a[212:215], v[224:227]
v_mfma_f32_16x16x32_bf16 v[228:231], v[204:207], a[212:215], v[228:231]
s_nop 6
v_cvt_pk_bf16_f32 v56, v224, v225
v_cvt_pk_bf16_f32 v57, v226, v227
v_cvt_pk_bf16_f32 v58, v228, v229
v_cvt_pk_bf16_f32 v59, v230, v231
buffer_store_dwordx4 v[56:59], v21, s[4:7], s93 offen sc1
s_mov_b32 s93, 1879048192
s_waitcnt vmcnt(3)
ds_write_b32 v18, v24
s_waitcnt lgkmcnt(0)
s_barrier
ds_read_b32 v33, v32
s_waitcnt lgkmcnt(0)
v_cmp_gt_u32 vcc, s52, v33
v_cmp_gt_u32 s[58:59], s54, v33
s_and_b32 vcc_lo, vcc_lo, s56
s_cselect_b32 s70, 0, 1
s_and_b32 s59, s59, s56
s_cselect_b32 s71, 0, s95
s_or_b32 s76, s70, s71
s_cselect_b32 s10, 268435456, 0
s_cmp_lg_u32 s70, 0
s_cselect_b64 s[72:73], s[52:53], s[54:55]
s_cselect_b64 s[58:59], s[44:45], s[46:47]
s_mul_i32 s74, s72, s20
s_add_u32 s74, s74, s58
s_mul_i32 s75, s72, s21
s_add_u32 s75, s75, s59
s_andn2_b32 s71, s71, s70
s_add_u32 s52, s52, s70
s_add_u32 s54, s54, s71
s_mov_b32 s77, s76
s_cmp_lg_u32 s76, 0
s_cbranch_scc1 g_go_76
v_mov_b32 v27, s90
s_waitcnt vmcnt(0)
s_barrier
s_add_u32 s70, s52, s54
s_cmp_eq_u32 s70, 130
s_cbranch_scc1 g_fin_52
s_cmp_lg_u32 s3, 0
s_cbranch_scc1 sp_ok_78_j
s_mov_b32 s23, 0
buffer_load_dword v33, v22, s[4:7], 0 offen sc1
buffer_store_dword v27, v45, s[4:7], s91 offen
buffer_store_dword v27, v44, s[4:7], s91 offen sc1
s_waitcnt vmcnt(2)
s_branch sp_loop_77_e
sp_loop_77:
buffer_load_dword v33, v22, s[4:7], 0 offen sc1
s_add_u32 s23, s23, 1
s_cmp_gt_u32 s23, 150000
s_cbranch_scc1 sp_bad_79
s_waitcnt vmcnt(0)
sp_loop_77_e:
v_cmp_gt_u32 vcc, s52, v33
v_cmp_gt_u32 s[58:59], s54, v33
s_and_b32 vcc_lo, vcc_lo, s56
s_cbranch_scc0 sp_ok_78
s_cmp_gt_u32 s23, 4
s_cselect_b32 s70, 0, s56
s_cmp_lg_u32 s95, 0
s_cselect_b32 s70, 0, s70
s_or_b32 s59, s59, s70
s_and_b32 s59, s59, s56
s_cbranch_scc0 sp_ok_78
s_sleep 1
s_branch sp_loop_77
sp_bad_79:
s_mov_b32 s98, 1026
s_branch L_fail
sp_ok_78:
ds_write_b32 v18, v33
s_waitcnt lgkmcnt(0)
sp_ok_78_j:
s_barrier
ds_read_b32 v33, v32
s_waitcnt lgkmcnt(0)
s_mov_b32 s91, 1879048192
v_cmp_gt_u32 vcc, s52, v33
v_cmp_gt_u32 s[58:59], s54, v33
s_and_b32 vcc_lo, vcc_lo, s56
s_cselect_b32 s70, 0, 1
s_and_b32 s59, s59, s56
s_cselect_b32 s71, 0, 1
s_or_b32 s76, s70, s71
s_cselect_b32 s10, 268435456, 0
s_cmp_lg_u32 s70, 0
s_cselect_b64 s[72:73], s[52:53], s[54:55]
s_cselect_b64 s[58:59], s[44:45], s[46:47]
s_mul_i32 s74, s72, s20
s_add_u32 s74, s74, s58
s_mul_i32 s75, s72, s21
s_add_u32 s75, s75, s59
s_andn2_b32 s71, s71, s70
s_add_u32 s52, s52, s70
s_add_u32 s54, s54, s71
s_mov_b32 s77, s76
g_go_76:
s_add_u32 m0, s48, 0
s_nop 0
buffer_load_dwordx4 v8, s[4:7], s74 offen offset:0 sc1 lds
buffer_load_dwordx4 v9, s[4:7], s74 offen offset:1024 sc1 lds
buffer_load_dwordx4 v10, s[4:7], s74 offen offset:2048 sc1 lds
buffer_load_dwordx4 v11, s[4:7], s74 offen offset:3072 sc1 lds
s_add_u32 m0, s48, 4096
s_nop 0
buffer_load_dwordx4 v12, s[4:7], s74 offen offset:0 sc1 lds
buffer_load_dwordx4 v13, s[4:7], s74 offen offset:1024 sc1 lds
buffer_load_dwordx4 v14, s[4:7], s74 offen offset:2048 sc1 lds
buffer_load_dwordx4 v15, s[4:7], s74 offen offset:3072 sc1 lds
s_add_u32 m0, s48, 8192
s_nop 0
buffer_load_dwordx4 v16, s[4:7], s74 offen offset:0 sc1 lds
buffer_store_dword v27, v34, s[4:7], 0 offen
buffer_load_dword v24, v22, s[4:7], 0 offen sc1
v_mov_b32 v27, s90
s_waitcnt vmcnt(9)
s_barrier
buffer_store_dword v27, v45, s[4:7], s91 offen
buffer_store_dword v27, v44, s[4:7], s91 offen sc1
s_mov_b32 s91, 1879048192
ds_read_b128 v[64:67], v28 offset:0
ds_read_b128 v[68:71], v28 offset:9216
ds_read_b128 v[72:75], v28 offset:18432
ds_read_b128 v[76:79], v28 offset:27648
ds_read_b128 v[80:83], v28 offset:1024
ds_read_b128 v[84:87], v28 offset:10240
ds_read_b128 v[88:91], v28 offset:19456
ds_read_b128 v[92:95], v28 offset:28672
s_waitcnt vmcnt(8)
s_barrier
s_branch g_body_48
g_fin_52:
buffer_store_dword v27, v45, s[4:7], s91 offen
buffer_store_dword v27, v44, s[4:7], s91 offen sc1
s_endpgm
G_sss18:
s_mov_b32 s8, s42
s_and_b32 s9, s43, 0xffff
s_mov_b32 s10, 0
s_mov_b32 s11, 0x20000
s_mov_b32 s22, 0
s_mul_i32 s48, s3, 9216
s_add_u32 s49, s48, 36864
s_add_u32 s50, s48, 73728
s_add_u32 s51, s48, 110592
s_mov_b32 s57, 0xbfb8aa3b
v_add_u32 v28, 0, v17
v_add_u32 v29, 36864, v17
v_add_u32 v30, 73728, v17
v_add_u32 v31, 110592, v17
v_lshlrev_b32 v1, 2, v0
v_add_u32 v32, 147456, v1
s_lshl_b32 s70, s3, 8
v_add_u32 v18, s70, v32
v_mov_b64 v[224:225], 0
v_mov_b64 v[236:237], 0
v_mov_b64 v[226:227], 0
v_mov_b64 v[238:239], 0
v_mov_b64 v[228:229], 0
v_mov_b64 v[240:241], 0
v_mov_b64 v[230:231], 0
v_mov_b64 v[242:243], 0
s_mov_b32 s12, s40
s_and_b32 s13, s41, 0xffff
s_mov_b32 s14, 256
s_mov_b32 s15, 0x20000
v_lshlrev_b32 v26, 2, v0
v_add_u32 v27, 128, v26
v_cmp_le_u32 vcc, 2, v0
s_nop 1
v_cndmask_b32 v26, v26, v27, vcc
v_mov_b32 v27, 192
v_cmp_eq_u32 vcc, 8, v0
s_nop 1
v_cndmask_b32 v26, v26, v27, vcc
v_mov_b32 v27, 2147483632
v_cmp_lt_u32 vcc, 8, v0
s_nop 1
v_cndmask_b32 v26, v26, v27, vcc
s_mov_b32 s98, 0
wi_loop_85:
buffer_load_dword v27, v26, s[12:15], 0 offen sc1
s_add_u32 s98, s98, 1
s_cmp_gt_u32 s98, 150000
s_cbranch_scc1 wi_bad_87
s_waitcnt vmcnt(0)
v_cmp_eq_u32 vcc, 32, v27
s_nop 0
s_and_b32 s97, vcc_lo, 0x1ff
s_cmp_eq_u32 s97, 0x1ff
s_cbranch_scc1 wi_ok_86
v_cmp_lt_u32 vcc, 32, v27
s_nop 0
s_and_b32 s96, vcc_lo, 0xff
s_cselect_b32 s96, 0x100, 0
s_and_b32 s96, s96, s97
s_cbranch_scc1 wi_over_88
s_sleep 8
s_branch wi_loop_85
wi_bad_87:
s_mov_b32 s98, 512
s_branch L_fail
wi_over_88:
s_mov_b32 s100, 255
wi_ok_86:
v_add_u32 v26, 65536, v22
v_cmp_eq_u32 vcc, s100, v23
s_nop 1
v_cndmask_b32 v22, v22, v26, vcc
s_mov_b32 s90, 0
s_mov_b32 s91, 1879048192
s_mov_b32 s93, 1879048192
v_mov_b32 v34, 2147483632
s_barrier
s_mov_b32 s95, 1
s_cmp_lg_u32 s3, 0
s_cbranch_scc1 sp_ok_90_j
s_mov_b32 s23, 0
sp_loop_89:
buffer_load_dword v33, v22, s[4:7], 0 offen sc1
s_add_u32 s23, s23, 1
s_cmp_gt_u32 s23, 150000
s_cbranch_scc1 sp_bad_91
s_waitcnt vmcnt(0)
sp_loop_89_e:
v_cmp_gt_u32 vcc, s52, v33
v_cmp_gt_u32 s[58:59], s54, v33
s_and_b32 vcc_lo, vcc_lo, s56
s_cbranch_scc0 sp_ok_90
s_cmp_gt_u32 s23, 4
s_cselect_b32 s70, 0, s56
s_cmp_lg_u32 s95, 0
s_cselect_b32 s70, 0, s70
s_or_b32 s59, s59, s70
s_and_b32 s59, s59, s56
s_cbranch_scc0 sp_ok_90
s_sleep 1
s_branch sp_loop_89
sp_bad_91:
s_mov_b32 s98, 1027
s_branch L_fail
sp_ok_90:
ds_write_b32 v18, v33
s_waitcnt lgkmcnt(0)
sp_ok_90_j:
s_barrier
ds_read_b32 v33, v32
s_waitcnt lgkmcnt(0)
v_cmp_gt_u32 vcc, s52, v33
v_cmp_gt_u32 s[58:59], s54, v33
s_and_b32 vcc_lo, vcc_lo, s56
s_cselect_b32 s70, 0, 1
s_and_b32 s59, s59, s56
s_cselect_b32 s71, 0, 1
s_or_b32 s76, s70, s71
s_cselect_b32 s10, 268435456, 0
s_cmp_lg_u32 s70, 0
s_cselect_b64 s[72:73], s[52:53], s[54:55]
s_cselect_b64 s[58:59], s[44:45], s[46:47]
s_mul_i32 s74, s72, s20
s_add_u32 s74, s74, s58
s_mul_i32 s75, s72, s21
s_add_u32 s75, s75, s59
s_andn2_b32 s71, s71, s70
s_add_u32 s52, s52, s70
s_add_u32 s54, s54, s71
s_mov_b32 s77, s76
s_add_u32 m0, s48, 0
s_nop 0
buffer_load_dwordx4 v8, s[4:7], s74 offen offset:0 sc1 lds
buffer_load_dwordx4 v9, s[4:7], s74 offen offset:1024 sc1 lds
buffer_load_dwordx4 v10, s[4:7], s74 offen offset:2048 sc1 lds
buffer_load_dwordx4 v11, s[4:7], s74 offen offset:3072 sc1 lds
s_add_u32 m0, s48, 4096
s_nop 0
buffer_load_dwordx4 v12, s[4:7], s74 offen offset:0 sc1 lds
buffer_load_dwordx4 v13, s[4:7], s74 offen offset:1024 sc1 lds
buffer_load_dwordx4 v14, s[4:7], s74 offen offset:2048 sc1 lds
buffer_load_dwordx4 v15, s[4:7], s74 offen offset:3072 sc1 lds
s_add_u32 m0, s48, 8192
s_nop 0
buffer_load_dwordx4 v16, s[4:7], s74 offen offset:0 sc1 lds
buffer_store_dword v27, v34, s[4:7], 0 offen
buffer_load_dword v24, v22, s[4:7], 0 offen sc1
v_mov_b32 v27, s90
s_waitcnt vmcnt(9)
s_barrier
buffer_store_dword v27, v45, s[4:7], s91 offen
buffer_store_dword v27, v44, s[4:7], s91 offen sc1
s_mov_b32 s91, 1879048192
ds_read_b128 v[64:67], v28 offset:0
ds_read_b128 v[68:71], v28 offset:9216
ds_read_b128 v[72:75], v28 offset:18432
ds_read_b128 v[76:79], v28 offset:27648
ds_read_b128 v[80:83], v28 offset:1024
ds_read_b128 v[84:87], v28 offset:10240
ds_read_b128 v[88:91], v28 offset:19456
ds_read_b128 v[92:95], v28 offset:28672
s_waitcnt vmcnt(8)
s_barrier
s_branch g_body_80
g_body_80:
s_waitcnt lgkmcnt(4)
v_mfma_f32_16x16x32_bf16 v[208:211], a[0:3], v[64:67], 0
ds_read_b128 v[96:99], v28 offset:2048
v_mfma_f32_16x16x32_bf16 v[212:215], a[0:3], v[68:71], 0
ds_read_b128 v[100:103], v28 offset:11264
v_mfma_f32_16x16x32_bf16 v[216:219], a[72:75], v[64:67], 0
v_mfma_f32_16x16x32_bf16 v[208:211], a[4:7], v[72:75], v[208:211]
ds_read_b128 v[104:107], v28 offset:20480
v_cvt_pk_bf16_f32 v56, v224, v225
v_mfma_f32_16x16x32_bf16 v[212:215], a[4:7], v[76:79], v[212:215]
ds_read_b128 v[108:111], v28 offset:29696
v_cvt_pk_bf16_f32 v57, v226, v227
v_mfma_f32_16x16x32_bf16 v[220:223], a[72:75], v[68:71], 0
v_cvt_pk_bf16_f32 v58, v228, v229
s_waitcnt lgkmcnt(4)
v_mfma_f32_16x16x32_bf16 v[208:211], a[8:11], v[80:83], v[208:211]
ds_read_b128 v[112:115], v28 offset:3072
v_cvt_pk_bf16_f32 v59, v230, v231
v_mfma_f32_16x16x32_bf16 v[212:215], a[8:11], v[84:87], v[212:215]
ds_read_b128 v[116:119], v28 offset:12288
v_permlane16_swap_b32 v56, v58
v_mfma_f32_16x16x32_bf16 v[216:219], a[76:79], v[72:75], v[216:219]
v_permlane16_swap_b32 v57, v59
v_mfma_f32_16x16x32_bf16 v[208:211], a[12:15], v[88:91], v[208:211]
ds_read_b128 v[120:123], v28 offset:21504
v_mfma_f32_16x16x32_bf16 v[212:215], a[12:15], v[92:95], v[212:215]
ds_read_b128 v[124:127], v28 offset:30720
v_mfma_f32_16x16x32_bf16 v[220:223], a[76:79], v[76:79], v[220:223]
s_waitcnt lgkmcnt(4)
v_mfma_f32_16x16x32_bf16 v[208:211], a[16:19], v[96:99], v[208:211]
ds_read_b128 v[128:131], v28 offset:4096
v_mfma_f32_16x16x32_bf16 v[212:215], a[16:19], v[100:103], v[212:215]
ds_read_b128 v[132:135], v28 offset:13312
v_mfma_f32_16x16x32_bf16 v[216:219], a[80:83], v[80:83], v[216:219]
buffer_store_dwordx4 v[56:59], v21, s[4:7], s93 offen sc1
v_mfma_f32_16x16x32_bf16 v[208:211], a[20:23], v[104:107], v[208:211]
ds_read_b128 v[136:139], v28 offset:22528
v_mfma_f32_16x16x32_bf16 v[212:215], a[20:23], v[108:111], v[212:215]
ds_read_b128 v[140:143], v28 offset:31744
v_mfma_f32_16x16x32_bf16 v[220:223], a[80:83], v[84:87], v[220:223]
s_waitcnt vmcnt(5)
s_barrier
s_waitcnt lgkmcnt(4)
v_mfma_f32_16x16x32_bf16 v[208:211], a[24:27], v[112:115], v[208:211]
ds_read_b128 v[144:147], v28 offset:5120
v_mov_b32 v27, s90
v_mfma_f32_16x16x32_bf16 v[212:215], a[24:27], v[116:119], v[212:215]
ds_read_b128 v[148:151], v28 offset:14336
v_mfma_f32_16x16x32_bf16 v[216:219], a[84:87], v[88:91], v[216:219]
v_mfma_f32_16x16x32_bf16 v[208:211], a[28:31], v[120:123], v[208:211]
ds_read_b128 v[152:155], v28 offset:23552
v_mfma_f32_16x16x32_bf16 v[212:215], a[28:31], v[124:127], v[212:215]
ds_read_b128 v[156:159], v28 offset:32768
v_mfma_f32_16x16x32_bf16 v[220:223], a[84:87], v[92:95], v[220:223]
s_waitcnt lgkmcnt(4)
v_mfma_f32_16x16x32_bf16 v[208:211], a[32:35], v[128:131], v[208:211]
ds_read_b128 v[160:163], v28 offset:6144
v_mfma_f32_16x16x32_bf16 v[212:215], a[32:35], v[132:135], v[212:215]
ds_read_b128 v[164:167], v28 offset:15360
v_mfma_f32_16x16x32_bf16 v[216:219], a[88:91], v[96:99], v[216:219]
v_mfma_f32_16x16x32_bf16 v[208:211], a[36:39], v[136:139], v[208:211]
ds_read_b128 v[168:171], v28 offset:24576
v_mfma_f32_16x16x32_bf16 v[212:215], a[36:39], v[140:143], v[212:215]
ds_read_b128 v[172:175], v28 offset:33792
v_mfma_f32_16x16x32_bf16 v[220:223], a[88:91], v[100:103], v[220:223]
s_waitcnt lgkmcnt(4)
v_mfma_f32_16x16x32_bf16 v[208:211], a[40:43], v[144:147], v[208:211]
ds_read_b128 v[176:179], v28 offset:7168
v_mfma_f32_16x16x32_bf16 v[212:215], a[40:43], v[148:151], v[212:215]
ds_read_b128 v[180:183], v28 offset:16384
s_waitcnt vmcnt(3)
ds_write_b32 v18, v24
v_mfma_f32_16x16x32_bf16 v[216:219], a[92:95], v[104:107], v[216:219]
v_mfma_f32_16x16x32_bf16 v[208:211], a[44:47], v[152:155], v[208:211]
ds_read_b128 v[184:187], v28 offset:25600
v_mfma_f32_16x16x32_bf16 v[212:215], a[44:47], v[156:159], v[212:215]
ds_read_b128 v[188:191], v28 offset:34816
s_waitcnt lgkmcnt(2)
s_barrier
v_mfma_f32_16x16x32_bf16 v[220:223], a[92:95], v[108:111], v[220:223]
ds_read_b32 v33, v32
v_mfma_f32_16x16x32_bf16 v[208:211], a[48:51], v[160:163], v[208:211]
ds_read_b128 v[192:195], v28 offset:8192
v_mfma_f32_16x16x32_bf16 v[212:215], a[48:51], v[164:167], v[212:215]
ds_read_b128 v[196:199], v28 offset:17408
v_mfma_f32_16x16x32_bf16 v[216:219], a[96:99], v[112:115], v[216:219]
s_waitcnt lgkmcnt(2)
v_cmp_gt_u32 vcc, s52, v33
v_mfma_f32_16x16x32_bf16 v[208:211], a[52:55], v[168:171], v[208:211]
ds_read_b128 v[200:203], v28 offset:26624
v_cmp_gt_u32 s[58:59], s54, v33
v_mfma_f32_16x16x32_bf16 v[212:215], a[52:55], v[172:175], v[212:215]
ds_read_b128 v[204:207], v28 offset:35840
s_and_b32 vcc_lo, vcc_lo, s56
s_cselect_b32 s70, 0, 1
v_mfma_f32_16x16x32_bf16 v[220:223], a[96:99], v[116:119], v[220:223]
v_mfma_f32_16x16x32_bf16 v[208:211], a[56:59], v[176:179], v[208:211]
s_and_b32 s59, s59, s56
s_cselect_b32 s71, 0, s77
v_mfma_f32_16x16x32_bf16 v[212:215], a[56:59], v[180:183], v[212:215]
s_or_b32 s82, s70, s71
s_cselect_b32 s10, 268435456, 0
v_mfma_f32_16x16x32_bf16 v[216:219], a[100:103], v[120:123], v[216:219]
s_cmp_lg_u32 s70, 0
s_cselect_b64 s[78:79], s[52:53], s[54:55]
s_cselect_b64 s[58:59], s[44:45], s[46:47]
v_mfma_f32_16x16x32_bf16 v[208:211], a[60:63], v[184:187], v[208:211]
s_mul_i32 s80, s78, s20
s_add_u32 s80, s80, s58
v_mfma_f32_16x16x32_bf16 v[212:215], a[60:63], v[188:191], v[212:215]
s_add_u32 m0, s49, 0
s_mul_i32 s81, s78, s21
s_add_u32 s81, s81, s59
v_mfma_f32_16x16x32_bf16 v[220:223], a[100:103], v[124:127], v[220:223]
buffer_load_dwordx4 v8, s[8:11], s80 offen offset:0 sc1 lds
s_waitcnt lgkmcnt(0)
v_mfma_f32_16x16x32_bf16 v[208:211], a[64:67], v[192:195], v[208:211]
s_andn2_b32 s71, s71, s70
s_add_u32 s52, s52, s70
s_add_u32 s54, s54, s71
v_mfma_f32_16x16x32_bf16 v[212:215], a[64:67], v[196:199], v[212:215]
s_mov_b32 s83, s82
v_mfma_f32_16x16x32_bf16 v[216:219], a[104:107], v[128:131], v[216:219]
buffer_load_dwordx4 v9, s[8:11], s80 offen offset:1024 sc1 lds
v_mfma_f32_16x16x32_bf16 v[208:211], a[68:71], v[200:203], v[208:211]
v_mfma_f32_16x16x32_bf16 v[212:215], a[68:71], v[204:207], v[212:215]
v_mfma_f32_16x16x32_bf16 v[220:223], a[104:107], v[132:135], v[220:223]
buffer_load_dwordx4 v10, s[8:11], s80 offen offset:2048 sc1 lds
v_mfma_f32_16x16x32_bf16 v[216:219], a[108:111], v[136:139], v[216:219]
v_mfma_f32_16x16x32_bf16 v[220:223], a[108:111], v[140:143], v[220:223]
v_mfma_f32_16x16x32_bf16 v[216:219], a[112:115], v[144:147], v[216:219]
buffer_load_dwordx4 v11, s[8:11], s80 offen offset:3072 sc1 lds
v_mfma_f32_16x16x32_bf16 v[220:223], a[112:115], v[148:151], v[220:223]
v_mfma_f32_16x16x32_bf16 v[216:219], a[116:119], v[152:155], v[216:219]
s_add_u32 m0, s49, 4096
v_cvt_pk_bf16_f32 v48, v208, v209
v_mfma_f32_16x16x32_bf16 v[220:223], a[116:119], v[156:159], v[220:223]
buffer_load_dwordx4 v12, s[8:11], s80 offen offset:0 sc1 lds
v_mfma_f32_16x16x32_bf16 v[216:219], a[120:123], v[160:163], v[216:219]
v_cvt_pk_bf16_f32 v49, v210, v211
v_cvt_pk_bf16_f32 v50, v212, v213
v_mfma_f32_16x16x32_bf16 v[220:223], a[120:123], v[164:167], v[220:223]
v_cvt_pk_bf16_f32 v51, v214, v215
v_mfma_f32_16x16x32_bf16 v[216:219], a[124:127], v[168:171], v[216:219]
buffer_load_dwordx4 v13, s[8:11], s80 offen offset:1024 sc1 lds
v_mfma_f32_16x16x32_bf16 v[220:223], a[124:127], v[172:175], v[220:223]
v_permlane16_swap_b32 v48, v50
v_mfma_f32_16x16x32_bf16 v[216:219], a[128:131], v[176:179], v[216:219]
v_permlane16_swap_b32 v49, v51
v_mfma_f32_16x16x32_bf16 v[220:223], a[128:131], v[180:183], v[220:223]
buffer_load_dwordx4 v14, s[8:11], s80 offen offset:2048 sc1 lds
v_mfma_f32_16x16x32_bf16 v[216:219], a[132:135], v[184:187], v[216:219]
buffer_store_dwordx4 v[48:51], v19, s[4:7], s75 offen sc1
v_mfma_f32_16x16x32_bf16 v[220:223], a[132:135], v[188:191], v[220:223]
v_mfma_f32_16x16x32_bf16 v[216:219], a[136:139], v[192:195], v[216:219]
buffer_load_dwordx4 v15, s[8:11], s80 offen offset:3072 sc1 lds
v_mfma_f32_16x16x32_bf16 v[220:223], a[136:139], v[196:199], v[220:223]
v_mfma_f32_16x16x32_bf16 v[216:219], a[140:143], v[200:203], v[216:219]
s_add_u32 m0, s49, 8192
v_mfma_f32_16x16x32_bf16 v[220:223], a[140:143], v[204:207], v[220:223]
buffer_load_dwordx4 v16, s[8:11], s80 offen offset:0 sc1 lds
v_mfma_f32_16x16x32_bf16 v[224:227], a[144:147], v[64:67], 0
v_mfma_f32_16x16x32_bf16 v[228:231], a[144:147], v[68:71], 0
v_mfma_f32_16x16x32_bf16 v[224:227], a[148:151], v[72:75], v[224:227]
v_mfma_f32_16x16x32_bf16 v[228:231], a[148:151], v[76:79], v[228:231]
v_mfma_f32_16x16x32_bf16 v[224:227], a[152:155], v[80:83], v[224:227]
v_mfma_f32_16x16x32_bf16 v[228:231], a[152:155], v[84:87], v[228:231]
v_cvt_pk_bf16_f32 v52, v216, v217
v_cvt_pk_bf16_f32 v53, v218, v219
v_mfma_f32_16x16x32_bf16 v[224:227], a[156:159], v[88:91], v[224:227]
v_cvt_pk_bf16_f32 v54, v220, v221
v_cvt_pk_bf16_f32 v55, v222, v223
v_mfma_f32_16x16x32_bf16 v[228:231], a[156:159], v[92:95], v[228:231]
v_permlane16_swap_b32 v52, v54
v_mfma_f32_16x16x32_bf16 v[224:227], a[160:163], v[96:99], v[224:227]
v_permlane16_swap_b32 v53, v55
v_mfma_f32_16x16x32_bf16 v[228:231], a[160:163], v[100:103], v[228:231]
buffer_store_dwordx4 v[52:55], v20, s[4:7], s75 offen sc1
v_mfma_f32_16x16x32_bf16 v[224:227], a[164:167], v[104:107], v[224:227]
v_mfma_f32_16x16x32_bf16 v[228:231], a[164:167], v[108:111], v[228:231]
v_mfma_f32_16x16x32_bf16 v[224:227], a[168:171], v[112:115], v[224:227]
v_mfma_f32_16x16x32_bf16 v[228:231], a[168:171], v[116:119], v[228:231]
v_mfma_f32_16x16x32_bf16 v[224:227], a[172:175], v[120:123], v[224:227]
v_mfma_f32_16x16x32_bf16 v[228:231], a[172:175], v[124:127], v[228:231]
v_mfma_f32_16x16x32_bf16 v[224:227], a[176:179], v[128:131], v[224:227]
v_mfma_f32_16x16x32_bf16 v[228:231], a[176:179], v[132:135], v[228:231]
v_mfma_f32_16x16x32_bf16 v[224:227], a[180:183], v[136:139], v[224:227]
v_mfma_f32_16x16x32_bf16 v[228:231], a[180:183], v[140:143], v[228:231]
v_mfma_f32_16x16x32_bf16 v[224:227], a[184:187], v[144:147], v[224:227]
v_mfma_f32_16x16x32_bf16 v[228:231], a[184:187], v[148:151], v[228:231]
v_mfma_f32_16x16x32_bf16 v[224:227], a[188:191], v[152:155], v[224:227]
buffer_load_dword v24, v22, s[4:7], 0 offen sc1
v_mfma_f32_16x16x32_bf16 v[228:231], a[188:191], v[156:159], v[228:231]
v_mfma_f32_16x16x32_bf16 v[224:227], a[192:195], v[160:163], v[224:227]
s_waitcnt vmcnt(10)
s_barrier
v_mfma_f32_16x16x32_bf16 v[228:231], a[192:195], v[164:167], v[228:231]
buffer_store_dword v27, v45, s[4:7], s91 offen
v_mfma_f32_16x16x32_bf16 v[224:227], a[196:199], v[168:171], v[224:227]
buffer_store_dword v27, v44, s[4:7], s91 offen sc1
s_cmp_eq_u32 s82, 0
s_cbranch_scc1 g_slow_92
v_mfma_f32_16x16x32_bf16 v[228:231], a[196:199], v[172:175], v[228:231]
ds_read_b128 v[64:67], v29 offset:0
v_mfma_f32_16x16x32_bf16 v[224:227], a[200:203], v[176:179], v[224:227]
ds_read_b128 v[68:71], v29 offset:9216
v_mfma_f32_16x16x32_bf16 v[228:231], a[200:203], v[180:183], v[228:231]
ds_read_b128 v[72:75], v29 offset:18432
v_mfma_f32_16x16x32_bf16 v[224:227], a[204:207], v[184:187], v[224:227]
ds_read_b128 v[76:79], v29 offset:27648
v_mfma_f32_16x16x32_bf16 v[228:231], a[204:207], v[188:191], v[228:231]
ds_read_b128 v[80:83], v29 offset:1024
v_mfma_f32_16x16x32_bf16 v[224:227], a[208:211], v[192:195], v[224:227]
ds_read_b128 v[84:87], v29 offset:10240
v_mfma_f32_16x16x32_bf16 v[228:231], a[208:211], v[196:199], v[228:231]
ds_read_b128 v[88:91], v29 offset:19456
v_mfma_f32_16x16x32_bf16 v[224:227], a[212:215], v[200:203], v[224:227]
ds_read_b128 v[92:95], v29 offset:28672
v_mfma_f32_16x16x32_bf16 v[228:231], a[212:215], v[204:207], v[228:231]
s_waitcnt vmcnt(9)
s_barrier
g_body_81:
s_waitcnt lgkmcnt(4)
v_mfma_f32_16x16x32_bf16 v[208:211], a[0:3], v[64:67], 0
ds_read_b128 v[96:99], v29 offset:2048
v_mfma_f32_16x16x32_bf16 v[212:215], a[0:3], v[68:71], 0
ds_read_b128 v[100:103], v29 offset:11264
v_mfma_f32_16x16x32_bf16 v[216:219], a[72:75], v[64:67], 0
v_mfma_f32_16x16x32_bf16 v[208:211], a[4:7], v[72:75], v[208:211]
ds_read_b128 v[104:107], v29 offset:20480
v_cvt_pk_bf16_f32 v56, v224, v225
v_mfma_f32_16x16x32_bf16 v[212:215], a[4:7], v[76:79], v[212:215]
ds_read_b128 v[108:111], v29 offset:29696
v_cvt_pk_bf16_f32 v57, v226, v227
v_mfma_f32_16x16x32_bf16 v[220:223], a[72:75], v[68:71], 0
v_cvt_pk_bf16_f32 v58, v228, v229
s_waitcnt lgkmcnt(4)
v_mfma_f32_16x16x32_bf16 v[208:211], a[8:11], v[80:83], v[208:211]
ds_read_b128 v[112:115], v29 offset:3072
v_cvt_pk_bf16_f32 v59, v230, v231
v_mfma_f32_16x16x32_bf16 v[212:215], a[8:11], v[84:87], v[212:215]
ds_read_b128 v[116:119], v29 offset:12288
v_permlane16_swap_b32 v56, v58
v_mfma_f32_16x16x32_bf16 v[216:219], a[76:79], v[72:75], v[216:219]
v_permlane16_swap_b32 v57, v59
v_mfma_f32_16x16x32_bf16 v[208:211], a[12:15], v[88:91], v[208:211]
ds_read_b128 v[120:123], v29 offset:21504
v_mfma_f32_16x16x32_bf16 v[212:215], a[12:15], v[92:95], v[212:215]
ds_read_b128 v[124:127], v29 offset:30720
v_mfma_f32_16x16x32_bf16 v[220:223], a[76:79], v[76:79], v[220:223]
s_waitcnt lgkmcnt(4)
v_mfma_f32_16x16x32_bf16 v[208:211], a[16:19], v[96:99], v[208:211]
ds_read_b128 v[128:131], v29 offset:4096
v_mfma_f32_16x16x32_bf16 v[212:215], a[16:19], v[100:103], v[212:215]
ds_read_b128 v[132:135], v29 offset:13312
v_mfma_f32_16x16x32_bf16 v[216:219], a[80:83], v[80:83], v[216:219]
buffer_store_dwordx4 v[56:59], v21, s[4:7], s75 offen sc1
v_mfma_f32_16x16x32_bf16 v[208:211], a[20:23], v[104:107], v[208:211]
ds_read_b128 v[136:139], v29 offset:22528
v_mfma_f32_16x16x32_bf16 v[212:215], a[20:23], v[108:111], v[212:215]
ds_read_b128 v[140:143], v29 offset:31744
v_mfma_f32_16x16x32_bf16 v[220:223], a[80:83], v[84:87], v[220:223]
s_waitcnt vmcnt(5)
s_barrier
s_waitcnt lgkmcnt(4)
v_mfma_f32_16x16x32_bf16 v[208:211], a[24:27], v[112:115], v[208:211]
ds_read_b128 v[144:147], v29 offset:5120
v_mov_b32 v27, s72
v_mfma_f32_16x16x32_bf16 v[212:215], a[24:27], v[116:119], v[212:215]
ds_read_b128 v[148:151], v29 offset:14336
v_mfma_f32_16x16x32_bf16 v[216:219], a[84:87], v[88:91], v[216:219]
v_mfma_f32_16x16x32_bf16 v[208:211], a[28:31], v[120:123], v[208:211]
ds_read_b128 v[152:155], v29 offset:23552
v_mfma_f32_16x16x32_bf16 v[212:215], a[28:31], v[124:127], v[212:215]
ds_read_b128 v[156:159], v29 offset:32768
v_mfma_f32_16x16x32_bf16 v[220:223], a[84:87], v[92:95], v[220:223]
s_waitcnt lgkmcnt(4)
v_mfma_f32_16x16x32_bf16 v[208:211], a[32:35], v[128:131], v[208:211]
ds_read_b128 v[160:163], v29 offset:6144
v_mfma_f32_16x16x32_bf16 v[212:215], a[32:35], v[132:135], v[212:215]
ds_read_b128 v[164:167], v29 offset:15360
v_mfma_f32_16x16x32_bf16 v[216:219], a[88:91], v[96:99], v[216:219]
v_mfma_f32_16x16x32_bf16 v[208:211], a[36:39], v[136:139], v[208:211]
ds_read_b128 v[168:171], v29 offset:24576
v_mfma_f32_16x16x32_bf16 v[212:215], a[36:39], v[140:143], v[212:215]
ds_read_b128 v[172:175], v29 offset:33792
v_mfma_f32_16x16x32_bf16 v[220:223], a[88:91], v[100:103], v[220:223]
s_waitcnt lgkmcnt(4)
v_mfma_f32_16x16x32_bf16 v[208:211], a[40:43], v[144:147], v[208:211]
ds_read_b128 v[176:179], v29 offset:7168
v_mfma_f32_16x16x32_bf16 v[212:215], a[40:43], v[148:151], v[212:215]
ds_read_b128 v[180:183], v29 offset:16384
s_waitcnt vmcnt(3)
ds_write_b32 v18, v24
v_mfma_f32_16x16x32_bf16 v[216:219], a[92:95], v[104:107], v[216:219]
v_mfma_f32_16x16x32_bf16 v[208:211], a[44:47], v[152:155], v[208:211]
ds_read_b128 v[184:187], v29 offset:25600
v_mfma_f32_16x16x32_bf16 v[212:215], a[44:47], v[156:159], v[212:215]
ds_read_b128 v[188:191], v29 offset:34816
s_waitcnt lgkmcnt(2)
s_barrier
v_mfma_f32_16x16x32_bf16 v[220:223], a[92:95], v[108:111], v[220:223]
ds_read_b32 v33, v32
v_mfma_f32_16x16x32_bf16 v[208:211], a[48:51], v[160:163], v[208:211]
ds_read_b128 v[192:195], v29 offset:8192
v_mfma_f32_16x16x32_bf16 v[212:215], a[48:51], v[164:167], v[212:215]
ds_read_b128 v[196:199], v29 offset:17408
v_mfma_f32_16x16x32_bf16 v[216:219], a[96:99], v[112:115], v[216:219]
s_waitcnt lgkmcnt(2)
v_cmp_gt_u32 vcc, s52, v33
v_mfma_f32_16x16x32_bf16 v[208:211], a[52:55], v[168:171], v[208:211]
ds_read_b128 v[200:203], v29 offset:26624
v_cmp_gt_u32 s[58:59], s54, v33
v_mfma_f32_16x16x32_bf16 v[212:215], a[52:55], v[172:175], v[212:215]
ds_read_b128 v[204:207], v29 offset:35840
s_and_b32 vcc_lo, vcc_lo, s56
s_cselect_b32 s70, 0, 1
v_mfma_f32_16x16x32_bf16 v[220:223], a[96:99], v[116:119], v[220:223]
v_mfma_f32_16x16x32_bf16 v[208:211], a[56:59], v[176:179], v[208:211]
s_and_b32 s59, s59, s56
s_cselect_b32 s71, 0, s83
v_mfma_f32_16x16x32_bf16 v[212:215], a[56:59], v[180:183], v[212:215]
s_or_b32 s88, s70, s71
s_cselect_b32 s10, 268435456, 0
v_mfma_f32_16x16x32_bf16 v[216:219], a[100:103], v[120:123], v[216:219]
s_cmp_lg_u32 s70, 0
s_cselect_b64 s[84:85], s[52:53], s[54:55]
s_cselect_b64 s[58:59], s[44:45], s[46:47]
v_mfma_f32_16x16x32_bf16 v[208:211], a[60:63], v[184:187], v[208:211]
s_mul_i32 s86, s84, s20
s_add_u32 s86, s86, s58
v_mfma_f32_16x16x32_bf16 v[212:215], a[60:63], v[188:191], v[212:215]
s_add_u32 m0, s50, 0
s_mul_i32 s87, s84, s21
s_add_u32 s87, s87, s59
v_mfma_f32_16x16x32_bf16 v[220:223], a[100:103], v[124:127], v[220:223]
buffer_load_dwordx4 v8, s[8:11], s86 offen offset:0 sc1 lds
s_waitcnt lgkmcnt(0)
v_mfma_f32_16x16x32_bf16 v[208:211], a[64:67], v[192:195], v[208:211]
s_andn2_b32 s71, s71, s70
s_add_u32 s52, s52, s70
s_add_u32 s54, s54, s71
v_mfma_f32_16x16x32_bf16 v[212:215], a[64:67], v[196:199], v[212:215]
s_mov_b32 s89, s88
v_mfma_f32_16x16x32_bf16 v[216:219], a[104:107], v[128:131], v[216:219]
buffer_load_dwordx4 v9, s[8:11], s86 offen offset:1024 sc1 lds
v_mfma_f32_16x16x32_bf16 v[208:211], a[68:71], v[200:203], v[208:211]
v_mfma_f32_16x16x32_bf16 v[212:215], a[68:71], v[204:207], v[212:215]
v_mfma_f32_16x16x32_bf16 v[220:223], a[104:107], v[132:135], v[220:223]
buffer_load_dwordx4 v10, s[8:11], s86 offen offset:2048 sc1 lds
v_mfma_f32_16x16x32_bf16 v[216:219], a[108:111], v[136:139], v[216:219]
v_mfma_f32_16x16x32_bf16 v[220:223], a[108:111], v[140:143], v[220:223]
v_mfma_f32_16x16x32_bf16 v[216:219], a[112:115], v[144:147], v[216:219]
buffer_load_dwordx4 v11, s[8:11], s86 offen offset:3072 sc1 lds
v_mfma_f32_16x16x32_bf16 v[220:223], a[112:115], v[148:151], v[220:223]
v_mfma_f32_16x16x32_bf16 v[216:219], a[116:119], v[152:155], v[216:219]
s_add_u32 m0, s50, 4096
v_cvt_pk_bf16_f32 v48, v208, v209
v_mfma_f32_16x16x32_bf16 v[220:223], a[116:119], v[156:159], v[220:223]
buffer_load_dwordx4 v12, s[8:11], s86 offen offset:0 sc1 lds
v_mfma_f32_16x16x32_bf16 v[216:219], a[120:123], v[160:163], v[216:219]
v_cvt_pk_bf16_f32 v49, v210, v211
v_cvt_pk_bf16_f32 v50, v212, v213
v_mfma_f32_16x16x32_bf16 v[220:223], a[120:123], v[164:167], v[220:223]
v_cvt_pk_bf16_f32 v51, v214, v215
v_mfma_f32_16x16x32_bf16 v[216:219], a[124:127], v[168:171], v[216:219]
buffer_load_dwordx4 v13, s[8:11], s86 offen offset:1024 sc1 lds
v_mfma_f32_16x16x32_bf16 v[220:223], a[124:127], v[172:175], v[220:223]
v_permlane16_swap_b32 v48, v50
v_mfma_f32_16x16x32_bf16 v[216:219], a[128:131], v[176:179], v[216:219]
v_permlane16_swap_b32 v49, v51
v_mfma_f32_16x16x32_bf16 v[220:223], a[128:131], v[180:183], v[220:223]
buffer_load_dwordx4 v14, s[8:11], s86 offen offset:2048 sc1 lds
v_mfma_f32_16x16x32_bf16 v[216:219], a[132:135], v[184:187], v[216:219]
buffer_store_dwordx4 v[48:51], v19, s[4:7], s81 offen sc1
v_mfma_f32_16x16x32_bf16 v[220:223], a[132:135], v[188:191], v[220:223]
v_mfma_f32_16x16x32_bf16 v[216:219], a[136:139], v[192:195], v[216:219]
buffer_load_dwordx4 v15, s[8:11], s86 offen offset:3072 sc1 lds
v_mfma_f32_16x16x32_bf16 v[220:223], a[136:139], v[196:199], v[220:223]
v_mfma_f32_16x16x32_bf16 v[216:219], a[140:143], v[200:203], v[216:219]
s_add_u32 m0, s50, 8192
v_mfma_f32_16x16x32_bf16 v[220:223], a[140:143], v[204:207], v[220:223]
buffer_load_dwordx4 v16, s[8:11], s86 offen offset:0 sc1 lds
v_mfma_f32_16x16x32_bf16 v[224:227], a[144:147], v[64:67], 0
v_mfma_f32_16x16x32_bf16 v[228:231], a[144:147], v[68:71], 0
v_mfma_f32_16x16x32_bf16 v[224:227], a[148:151], v[72:75], v[224:227]
v_mfma_f32_16x16x32_bf16 v[228:231], a[148:151], v[76:79], v[228:231]
v_mfma_f32_16x16x32_bf16 v[224:227], a[152:155], v[80:83], v[224:227]
v_mfma_f32_16x16x32_bf16 v[228:231], a[152:155], v[84:87], v[228:231]
v_cvt_pk_bf16_f32 v52, v216, v217
v_cvt_pk_bf16_f32 v53, v218, v219
v_mfma_f32_16x16x32_bf16 v[224:227], a[156:159], v[88:91], v[224:227]
v_cvt_pk_bf16_f32 v54, v220, v221
v_cvt_pk_bf16_f32 v55, v222, v223
v_mfma_f32_16x16x32_bf16 v[228:231], a[156:159], v[92:95], v[228:231]
v_permlane16_swap_b32 v52, v54
v_mfma_f32_16x16x32_bf16 v[224:227], a[160:163], v[96:99], v[224:227]
v_permlane16_swap_b32 v53, v55
v_mfma_f32_16x16x32_bf16 v[228:231], a[160:163], v[100:103], v[228:231]
buffer_store_dwordx4 v[52:55], v20, s[4:7], s81 offen sc1
v_mfma_f32_16x16x32_bf16 v[224:227], a[164:167], v[104:107], v[224:227]
v_mfma_f32_16x16x32_bf16 v[228:231], a[164:167], v[108:111], v[228:231]
v_mfma_f32_16x16x32_bf16 v[224:227], a[168:171], v[112:115], v[224:227]
v_mfma_f32_16x16x32_bf16 v[228:231], a[168:171], v[116:119], v[228:231]
v_mfma_f32_16x16x32_bf16 v[224:227], a[172:175], v[120:123], v[224:227]
v_mfma_f32_16x16x32_bf16 v[228:231], a[172:175], v[124:127], v[228:231]
v_mfma_f32_16x16x32_bf16 v[224:227], a[176:179], v[128:131], v[224:227]
v_mfma_f32_16x16x32_bf16 v[228:231], a[176:179], v[132:135], v[228:231]
v_mfma_f32_16x16x32_bf16 v[224:227], a[180:183], v[136:139], v[224:227]
v_mfma_f32_16x16x32_bf16 v[228:231], a[180:183], v[140:143], v[228:231]
v_mfma_f32_16x16x32_bf16 v[224:227], a[184:187], v[144:147], v[224:227]
v_mfma_f32_16x16x32_bf16 v[228:231], a[184:187], v[148:151], v[228:231]
v_mfma_f32_16x16x32_bf16 v[224:227], a[188:191], v[152:155], v[224:227]
buffer_load_dword v24, v22, s[4:7], 0 offen sc1
v_mfma_f32_16x16x32_bf16 v[228:231], a[188:191], v[156:159], v[228:231]
v_mfma_f32_16x16x32_bf16 v[224:227], a[192:195], v[160:163], v[224:227]
s_waitcnt vmcnt(10)
s_barrier
v_mfma_f32_16x16x32_bf16 v[228:231], a[192:195], v[164:167], v[228:231]
buffer_store_dword v27, v45, s[4:7], s73 offen
v_mfma_f32_16x16x32_bf16 v[224:227], a[196:199], v[168:171], v[224:227]
buffer_store_dword v27, v44, s[4:7], s73 offen sc1
s_cmp_eq_u32 s88, 0
s_cbranch_scc1 g_slow_93
v_mfma_f32_16x16x32_bf16 v[228:231], a[196:199], v[172:175], v[228:231]
ds_read_b128 v[64:67], v30 offset:0
v_mfma_f32_16x16x32_bf16 v[224:227], a[200:203], v[176:179], v[224:227]
ds_read_b128 v[68:71], v30 offset:9216
v_mfma_f32_16x16x32_bf16 v[228:231], a[200:203], v[180:183], v[228:231]
ds_read_b128 v[72:75], v30 offset:18432
v_mfma_f32_16x16x32_bf16 v[224:227], a[204:207], v[184:187], v[224:227]
ds_read_b128 v[76:79], v30 offset:27648
v_mfma_f32_16x16x32_bf16 v[228:231], a[204:207], v[188:191], v[228:231]
ds_read_b128 v[80:83], v30 offset:1024
v_mfma_f32_16x16x32_bf16 v[224:227], a[208:211], v[192:195], v[224:227]
ds_read_b128 v[84:87], v30 offset:10240
v_mfma_f32_16x16x32_bf16 v[228:231], a[208:211], v[196:199], v[228:231]
ds_read_b128 v[88:91], v30 offset:19456
v_mfma_f32_16x16x32_bf16 v[224:227], a[212:215], v[200:203], v[224:227]
ds_read_b128 v[92:95], v30 offset:28672
v_mfma_f32_16x16x32_bf16 v[228:231], a[212:215], v[204:207], v[228:231]
s_waitcnt vmcnt(9)
s_barrier
g_body_82:
s_waitcnt lgkmcnt(4)
v_mfma_f32_16x16x32_bf16 v[208:211], a[0:3], v[64:67], 0
ds_read_b128 v[96:99], v30 offset:2048
v_mfma_f32_16x16x32_bf16 v[212:215], a[0:3], v[68:71], 0
ds_read_b128 v[100:103], v30 offset:11264
v_mfma_f32_16x16x32_bf16 v[216:219], a[72:75], v[64:67], 0
v_mfma_f32_16x16x32_bf16 v[208:211], a[4:7], v[72:75], v[208:211]
ds_read_b128 v[104:107], v30 offset:20480
v_cvt_pk_bf16_f32 v56, v224, v225
v_mfma_f32_16x16x32_bf16 v[212:215], a[4:7], v[76:79], v[212:215]
ds_read_b128 v[108:111], v30 offset:29696
v_cvt_pk_bf16_f32 v57, v226, v227
v_mfma_f32_16x16x32_bf16 v[220:223], a[72:75], v[68:71], 0
v_cvt_pk_bf16_f32 v58, v228, v229
s_waitcnt lgkmcnt(4)
v_mfma_f32_16x16x32_bf16 v[208:211], a[8:11], v[80:83], v[208:211]
ds_read_b128 v[112:115], v30 offset:3072
v_cvt_pk_bf16_f32 v59, v230, v231
v_mfma_f32_16x16x32_bf16 v[212:215], a[8:11], v[84:87], v[212:215]
ds_read_b128 v[116:119], v30 offset:12288
v_permlane16_swap_b32 v56, v58
v_mfma_f32_16x16x32_bf16 v[216:219], a[76:79], v[72:75], v[216:219]
v_permlane16_swap_b32 v57, v59
v_mfma_f32_16x16x32_bf16 v[208:211], a[12:15], v[88:91], v[208:211]
ds_read_b128 v[120:123], v30 offset:21504
v_mfma_f32_16x16x32_bf16 v[212:215], a[12:15], v[92:95], v[212:215]
ds_read_b128 v[124:127], v30 offset:30720
v_mfma_f32_16x16x32_bf16 v[220:223], a[76:79], v[76:79], v[220:223]
s_waitcnt lgkmcnt(4)
v_mfma_f32_16x16x32_bf16 v[208:211], a[16:19], v[96:99], v[208:211]
ds_read_b128 v[128:131], v30 offset:4096
v_mfma_f32_16x16x32_bf16 v[212:215], a[16:19], v[100:103], v[212:215]
ds_read_b128 v[132:135], v30 offset:13312
v_mfma_f32_16x16x32_bf16 v[216:219], a[80:83], v[80:83], v[216:219]
buffer_store_dwordx4 v[56:59], v21, s[4:7], s81 offen sc1
v_mfma_f32_16x16x32_bf16 v[208:211], a[20:23], v[104:107], v[208:211]
ds_read_b128 v[136:139], v30 offset:22528
v_mfma_f32_16x16x32_bf16 v[212:215], a[20:23], v[108:111], v[212:215]
ds_read_b128 v[140:143], v30 offset:31744
v_mfma_f32_16x16x32_bf16 v[220:223], a[80:83], v[84:87], v[220:223]
s_waitcnt vmcnt(5)
s_barrier
s_waitcnt lgkmcnt(4)
v_mfma_f32_16x16x32_bf16 v[208:211], a[24:27], v[112:115], v[208:211]
ds_read_b128 v[144:147], v30 offset:5120
v_mov_b32 v27, s78
v_mfma_f32_16x16x32_bf16 v[212:215], a[24:27], v[116:119], v[212:215]
ds_read_b128 v[148:151], v30 offset:14336
v_mfma_f32_16x16x32_bf16 v[216:219], a[84:87], v[88:91], v[216:219]
v_mfma_f32_16x16x32_bf16 v[208:211], a[28:31], v[120:123], v[208:211]
ds_read_b128 v[152:155], v30 offset:23552
v_mfma_f32_16x16x32_bf16 v[212:215], a[28:31], v[124:127], v[212:215]
ds_read_b128 v[156:159], v30 offset:32768
v_mfma_f32_16x16x32_bf16 v[220:223], a[84:87], v[92:95], v[220:223]
s_waitcnt lgkmcnt(4)
v_mfma_f32_16x16x32_bf16 v[208:211], a[32:35], v[128:131], v[208:211]
ds_read_b128 v[160:163], v30 offset:6144
v_mfma_f32_16x16x32_bf16 v[212:215], a[32:35], v[132:135], v[212:215]
ds_read_b128 v[164:167], v30 offset:15360
v_mfma_f32_16x16x32_bf16 v[216:219], a[88:91], v[96:99], v[216:219]
v_mfma_f32_16x16x32_bf16 v[208:211], a[36:39], v[136:139], v[208:211]
ds_read_b128 v[168:171], v30 offset:24576
v_mfma_f32_16x16x32_bf16 v[212:215], a[36:39], v[140:143], v[212:215]
ds_read_b128 v[172:175], v30 offset:33792
v_mfma_f32_16x16x32_bf16 v[220:223], a[88:91], v[100:103], v[220:223]
s_waitcnt lgkmcnt(4)
v_mfma_f32_16x16x32_bf16 v[208:211], a[40:43], v[144:147], v[208:211]
ds_read_b128 v[176:179], v30 offset:7168
v_mfma_f32_16x16x32_bf16 v[212:215], a[40:43], v[148:151], v[212:215]
ds_read_b128 v[180:183], v30 offset:16384
s_waitcnt vmcnt(3)
ds_write_b32 v18, v24
v_mfma_f32_16x16x32_bf16 v[216:219], a[92:95], v[104:107], v[216:219]
v_mfma_f32_16x16x32_bf16 v[208:211], a[44:47], v[152:155], v[208:211]
ds_read_b128 v[184:187], v30 offset:25600
v_mfma_f32_16x16x32_bf16 v[212:215], a[44:47], v[156:159], v[212:215]
ds_read_b128 v[188:191], v30 offset:34816
s_waitcnt lgkmcnt(2)
s_barrier
v_mfma_f32_16x16x32_bf16 v[220:223], a[92:95], v[108:111], v[220:223]
ds_read_b32 v33, v32
v_mfma_f32_16x16x32_bf16 v[208:211], a[48:51], v[160:163], v[208:211]
ds_read_b128 v[192:195], v30 offset:8192
v_mfma_f32_16x16x32_bf16 v[212:215], a[48:51], v[164:167], v[212:215]
ds_read_b128 v[196:199], v30 offset:17408
v_mfma_f32_16x16x32_bf16 v[216:219], a[96:99], v[112:115], v[216:219]
s_waitcnt lgkmcnt(2)
v_cmp_gt_u32 vcc, s52, v33
v_mfma_f32_16x16x32_bf16 v[208:211], a[52:55], v[168:171], v[208:211]
ds_read_b128 v[200:203], v30 offset:26624
v_cmp_gt_u32 s[58:59], s54, v33
v_mfma_f32_16x16x32_bf16 v[212:215], a[52:55], v[172:175], v[212:215]
ds_read_b128 v[204:207], v30 offset:35840
s_and_b32 vcc_lo, vcc_lo, s56
s_cselect_b32 s70, 0, 1
v_mfma_f32_16x16x32_bf16 v[220:223], a[96:99], v[116:119], v[220:223]
v_mfma_f32_16x16x32_bf16 v[208:211], a[56:59], v[176:179], v[208:211]
s_and_b32 s59, s59, s56
s_cselect_b32 s71, 0, s89
v_mfma_f32_16x16x32_bf16 v[212:215], a[56:59], v[180:183], v[212:215]
s_or_b32 s94, s70, s71
s_cselect_b32 s10, 268435456, 0
v_mfma_f32_16x16x32_bf16 v[216:219], a[100:103], v[120:123], v[216:219]
s_cmp_lg_u32 s70, 0
s_cselect_b64 s[90:91], s[52:53], s[54:55]
s_cselect_b64 s[58:59], s[44:45], s[46:47]
v_mfma_f32_16x16x32_bf16 v[208:211], a[60:63], v[184:187], v[208:211]
s_mul_i32 s92, s90, s20
s_add_u32 s92, s92, s58
v_mfma_f32_16x16x32_bf16 v[212:215], a[60:63], v[188:191], v[212:215]
s_add_u32 m0, s51, 0
s_mul_i32 s93, s90, s21
s_add_u32 s93, s93, s59
v_mfma_f32_16x16x32_bf16 v[220:223], a[100:103], v[124:127], v[220:223]
buffer_load_dwordx4 v8, s[8:11], s92 offen offset:0 sc1 lds
s_waitcnt lgkmcnt(0)
v_mfma_f32_16x16x32_bf16 v[208:211], a[64:67], v[192:195], v[208:211]
s_andn2_b32 s71, s71, s70
s_add_u32 s52, s52, s70
s_add_u32 s54, s54, s71
v_mfma_f32_16x16x32_bf16 v[212:215], a[64:67], v[196:199], v[212:215]
s_mov_b32 s95, s94
v_mfma_f32_16x16x32_bf16 v[216:219], a[104:107], v[128:131], v[216:219]
buffer_load_dwordx4 v9, s[8:11], s92 offen offset:1024 sc1 lds
v_mfma_f32_16x16x32_bf16 v[208:211], a[68:71], v[200:203], v[208:211]
v_mfma_f32_16x16x32_bf16 v[212:215], a[68:71], v[204:207], v[212:215]
v_mfma_f32_16x16x32_bf16 v[220:223], a[104:107], v[132:135], v[220:223]
buffer_load_dwordx4 v10, s[8:11], s92 offen offset:2048 sc1 lds
v_mfma_f32_16x16x32_bf16 v[216:219], a[108:111], v[136:139], v[216:219]
v_mfma_f32_16x16x32_bf16 v[220:223], a[108:111], v[140:143], v[220:223]
v_mfma_f32_16x16x32_bf16 v[216:219], a[112:115], v[144:147], v[216:219]
buffer_load_dwordx4 v11, s[8:11], s92 offen offset:3072 sc1 lds
v_mfma_f32_16x16x32_bf16 v[220:223], a[112:115], v[148:151], v[220:223]
v_mfma_f32_16x16x32_bf16 v[216:219], a[116:119], v[152:155], v[216:219]
s_add_u32 m0, s51, 4096
v_cvt_pk_bf16_f32 v48, v208, v209
v_mfma_f32_16x16x32_bf16 v[220:223], a[116:119], v[156:159], v[220:223]
buffer_load_dwordx4 v12, s[8:11], s92 offen offset:0 sc1 lds
v_mfma_f32_16x16x32_bf16 v[216:219], a[120:123], v[160:163], v[216:219]
v_cvt_pk_bf16_f32 v49, v210, v211
v_cvt_pk_bf16_f32 v50, v212, v213
v_mfma_f32_16x16x32_bf16 v[220:223], a[120:123], v[164:167], v[220:223]
v_cvt_pk_bf16_f32 v51, v214, v215
v_mfma_f32_16x16x32_bf16 v[216:219], a[124:127], v[168:171], v[216:219]
buffer_load_dwordx4 v13, s[8:11], s92 offen offset:1024 sc1 lds
v_mfma_f32_16x16x32_bf16 v[220:223], a[124:127], v[172:175], v[220:223]
v_permlane16_swap_b32 v48, v50
v_mfma_f32_16x16x32_bf16 v[216:219], a[128:131], v[176:179], v[216:219]
v_permlane16_swap_b32 v49, v51
v_mfma_f32_16x16x32_bf16 v[220:223], a[128:131], v[180:183], v[220:223]
buffer_load_dwordx4 v14, s[8:11], s92 offen offset:2048 sc1 lds
v_mfma_f32_16x16x32_bf16 v[216:219], a[132:135], v[184:187], v[216:219]
buffer_store_dwordx4 v[48:51], v19, s[4:7], s87 offen sc1
v_mfma_f32_16x16x32_bf16 v[220:223], a[132:135], v[188:191], v[220:223]
v_mfma_f32_16x16x32_bf16 v[216:219], a[136:139], v[192:195], v[216:219]
buffer_load_dwordx4 v15, s[8:11], s92 offen offset:3072 sc1 lds
v_mfma_f32_16x16x32_bf16 v[220:223], a[136:139], v[196:199], v[220:223]
v_mfma_f32_16x16x32_bf16 v[216:219], a[140:143], v[200:203], v[216:219]
s_add_u32 m0, s51, 8192
v_mfma_f32_16x16x32_bf16 v[220:223], a[140:143], v[204:207], v[220:223]
buffer_load_dwordx4 v16, s[8:11], s92 offen offset:0 sc1 lds
v_mfma_f32_16x16x32_bf16 v[224:227], a[144:147], v[64:67], 0
v_mfma_f32_16x16x32_bf16 v[228:231], a[144:147], v[68:71], 0
v_mfma_f32_16x16x32_bf16 v[224:227], a[148:151], v[72:75], v[224:227]
v_mfma_f32_16x16x32_bf16 v[228:231], a[148:151], v[76:79], v[228:231]
v_mfma_f32_16x16x32_bf16 v[224:227], a[152:155], v[80:83], v[224:227]
v_mfma_f32_16x16x32_bf16 v[228:231], a[152:155], v[84:87], v[228:231]
v_cvt_pk_bf16_f32 v52, v216, v217
v_cvt_pk_bf16_f32 v53, v218, v219
v_mfma_f32_16x16x32_bf16 v[224:227], a[156:159], v[88:91], v[224:227]
v_cvt_pk_bf16_f32 v54, v220, v221
v_cvt_pk_bf16_f32 v55, v222, v223
v_mfma_f32_16x16x32_bf16 v[228:231], a[156:159], v[92:95], v[228:231]
v_permlane16_swap_b32 v52, v54
v_mfma_f32_16x16x32_bf16 v[224:227], a[160:163], v[96:99], v[224:227]
v_permlane16_swap_b32 v53, v55
v_mfma_f32_16x16x32_bf16 v[228:231], a[160:163], v[100:103], v[228:231]
buffer_store_dwordx4 v[52:55], v20, s[4:7], s87 offen sc1
v_mfma_f32_16x16x32_bf16 v[224:227], a[164:167], v[104:107], v[224:227]
v_mfma_f32_16x16x32_bf16 v[228:231], a[164:167], v[108:111], v[228:231]
v_mfma_f32_16x16x32_bf16 v[224:227], a[168:171], v[112:115], v[224:227]
v_mfma_f32_16x16x32_bf16 v[228:231], a[168:171], v[116:119], v[228:231]
v_mfma_f32_16x16x32_bf16 v[224:227], a[172:175], v[120:123], v[224:227]
v_mfma_f32_16x16x32_bf16 v[228:231], a[172:175], v[124:127], v[228:231]
v_mfma_f32_16x16x32_bf16 v[224:227], a[176:179], v[128:131], v[224:227]
v_mfma_f32_16x16x32_bf16 v[228:231], a[176:179], v[132:135], v[228:231]
v_mfma_f32_16x16x32_bf16 v[224:227], a[180:183], v[136:139], v[224:227]
v_mfma_f32_16x16x32_bf16 v[228:231], a[180:183], v[140:143], v[228:231]
v_mfma_f32_16x16x32_bf16 v[224:227], a[184:187], v[144:147], v[224:227]
v_mfma_f32_16x16x32_bf16 v[228:231], a[184:187], v[148:151], v[228:231]
v_mfma_f32_16x16x32_bf16 v[224:227], a[188:191], v[152:155], v[224:227]
buffer_load_dword v24, v22, s[4:7], 0 offen sc1
v_mfma_f32_16x16x32_bf16 v[228:231], a[188:191], v[156:159], v[228:231]
v_mfma_f32_16x16x32_bf16 v[224:227], a[192:195], v[160:163], v[224:227]
s_waitcnt vmcnt(10)
s_barrier
v_mfma_f32_16x16x32_bf16 v[228:231], a[192:195], v[164:167], v[228:231]
buffer_store_dword v27, v45, s[4:7], s79 offen
v_mfma_f32_16x16x32_bf16 v[224:227], a[196:199], v[168:171], v[224:227]
buffer_store_dword v27, v44, s[4:7], s79 offen sc1
s_cmp_eq_u32 s94, 0
s_cbranch_scc1 g_slow_94
v_mfma_f32_16x16x32_bf16 v[228:231], a[196:199], v[172:175], v[228:231]
ds_read_b128 v[64:67], v31 offset:0
v_mfma_f32_16x16x32_bf16 v[224:227], a[200:203], v[176:179], v[224:227]
ds_read_b128 v[68:71], v31 offset:9216
v_mfma_f32_16x16x32_bf16 v[228:231], a[200:203], v[180:183], v[228:231]
ds_read_b128 v[72:75], v31 offset:18432
v_mfma_f32_16x16x32_bf16 v[224:227], a[204:207], v[184:187], v[224:227]
ds_read_b128 v[76:79], v31 offset:27648
v_mfma_f32_16x16x32_bf16 v[228:231], a[204:207], v[188:191], v[228:231]
ds_read_b128 v[80:83], v31 offset:1024
v_mfma_f32_16x16x32_bf16 v[224:227], a[208:211], v[192:195], v[224:227]
ds_read_b128 v[84:87], v31 offset:10240
v_mfma_f32_16x16x32_bf16 v[228:231], a[208:211], v[196:199], v[228:231]
ds_read_b128 v[88:91], v31 offset:19456
v_mfma_f32_16x16x32_bf16 v[224:227], a[212:215], v[200:203], v[224:227]
ds_read_b128 v[92:95], v31 offset:28672
v_mfma_f32_16x16x32_bf16 v[228:231], a[212:215], v[204:207], v[228:231]
s_waitcnt vmcnt(9)
s_barrier
g_body_83:
s_waitcnt lgkmcnt(4)
v_mfma_f32_16x16x32_bf16 v[208:211], a[0:3], v[64:67], 0
ds_read_b128 v[96:99], v31 offset:2048
v_mfma_f32_16x16x32_bf16 v[212:215], a[0:3], v[68:71], 0
ds_read_b128 v[100:103], v31 offset:11264
v_mfma_f32_16x16x32_bf16 v[216:219], a[72:75], v[64:67], 0
v_mfma_f32_16x16x32_bf16 v[208:211], a[4:7], v[72:75], v[208:211]
ds_read_b128 v[104:107], v31 offset:20480
v_cvt_pk_bf16_f32 v56, v224, v225
v_mfma_f32_16x16x32_bf16 v[212:215], a[4:7], v[76:79], v[212:215]
ds_read_b128 v[108:111], v31 offset:29696
v_cvt_pk_bf16_f32 v57, v226, v227
v_mfma_f32_16x16x32_bf16 v[220:223], a[72:75], v[68:71], 0
v_cvt_pk_bf16_f32 v58, v228, v229
s_waitcnt lgkmcnt(4)
v_mfma_f32_16x16x32_bf16 v[208:211], a[8:11], v[80:83], v[208:211]
ds_read_b128 v[112:115], v31 offset:3072
v_cvt_pk_bf16_f32 v59, v230, v231
v_mfma_f32_16x16x32_bf16 v[212:215], a[8:11], v[84:87], v[212:215]
ds_read_b128 v[116:119], v31 offset:12288
v_permlane16_swap_b32 v56, v58
v_mfma_f32_16x16x32_bf16 v[216:219], a[76:79], v[72:75], v[216:219]
v_permlane16_swap_b32 v57, v59
v_mfma_f32_16x16x32_bf16 v[208:211], a[12:15], v[88:91], v[208:211]
ds_read_b128 v[120:123], v31 offset:21504
v_mfma_f32_16x16x32_bf16 v[212:215], a[12:15], v[92:95], v[212:215]
ds_read_b128 v[124:127], v31 offset:30720
v_mfma_f32_16x16x32_bf16 v[220:223], a[76:79], v[76:79], v[220:223]
s_waitcnt lgkmcnt(4)
v_mfma_f32_16x16x32_bf16 v[208:211], a[16:19], v[96:99], v[208:211]
ds_read_b128 v[128:131], v31 offset:4096
v_mfma_f32_16x16x32_bf16 v[212:215], a[16:19], v[100:103], v[212:215]
ds_read_b128 v[132:135], v31 offset:13312
v_mfma_f32_16x16x32_bf16 v[216:219], a[80:83], v[80:83], v[216:219]
buffer_store_dwordx4 v[56:59], v21, s[4:7], s87 offen sc1
v_mfma_f32_16x16x32_bf16 v[208:211], a[20:23], v[104:107], v[208:211]
ds_read_b128 v[136:139], v31 offset:22528
v_mfma_f32_16x16x32_bf16 v[212:215], a[20:23], v[108:111], v[212:215]
ds_read_b128 v[140:143], v31 offset:31744
v_mfma_f32_16x16x32_bf16 v[220:223], a[80:83], v[84:87], v[220:223]
s_waitcnt vmcnt(5)
s_barrier
s_waitcnt lgkmcnt(4)
v_mfma_f32_16x16x32_bf16 v[208:211], a[24:27], v[112:115], v[208:211]
ds_read_b128 v[144:147], v31 offset:5120
v_mov_b32 v27, s84
v_mfma_f32_16x16x32_bf16 v[212:215], a[24:27], v[116:119], v[212:215]
ds_read_b128 v[148:151], v31 offset:14336
v_mfma_f32_16x16x32_bf16 v[216:219], a[84:87], v[88:91], v[216:219]
v_mfma_f32_16x16x32_bf16 v[208:211], a[28:31], v[120:123], v[208:211]
ds_read_b128 v[152:155], v31 offset:23552
v_mfma_f32_16x16x32_bf16 v[212:215], a[28:31], v[124:127], v[212:215]
ds_read_b128 v[156:159], v31 offset:32768
v_mfma_f32_16x16x32_bf16 v[220:223], a[84:87], v[92:95], v[220:223]
s_waitcnt lgkmcnt(4)
v_mfma_f32_16x16x32_bf16 v[208:211], a[32:35], v[128:131], v[208:211]
ds_read_b128 v[160:163], v31 offset:6144
v_mfma_f32_16x16x32_bf16 v[212:215], a[32:35], v[132:135], v[212:215]
ds_read_b128 v[164:167], v31 offset:15360
v_mfma_f32_16x16x32_bf16 v[216:219], a[88:91], v[96:99], v[216:219]
v_mfma_f32_16x16x32_bf16 v[208:211], a[36:39], v[136:139], v[208:211]
ds_read_b128 v[168:171], v31 offset:24576
v_mfma_f32_16x16x32_bf16 v[212:215], a[36:39], v[140:143], v[212:215]
ds_read_b128 v[172:175], v31 offset:33792
v_mfma_f32_16x16x32_bf16 v[220:223], a[88:91], v[100:103], v[220:223]
s_waitcnt lgkmcnt(4)
v_mfma_f32_16x16x32_bf16 v[208:211], a[40:43], v[144:147], v[208:211]
ds_read_b128 v[176:179], v31 offset:7168
v_mfma_f32_16x16x32_bf16 v[212:215], a[40:43], v[148:151], v[212:215]
ds_read_b128 v[180:183], v31 offset:16384
s_waitcnt vmcnt(3)
ds_write_b32 v18, v24
v_mfma_f32_16x16x32_bf16 v[216:219], a[92:95], v[104:107], v[216:219]
v_mfma_f32_16x16x32_bf16 v[208:211], a[44:47], v[152:155], v[208:211]
ds_read_b128 v[184:187], v31 offset:25600
v_mfma_f32_16x16x32_bf16 v[212:215], a[44:47], v[156:159], v[212:215]
ds_read_b128 v[188:191], v31 offset:34816
s_waitcnt lgkmcnt(2)
s_barrier
v_mfma_f32_16x16x32_bf16 v[220:223], a[92:95], v[108:111], v[220:223]
ds_read_b32 v33, v32
v_mfma_f32_16x16x32_bf16 v[208:211], a[48:51], v[160:163], v[208:211]
ds_read_b128 v[192:195], v31 offset:8192
v_mfma_f32_16x16x32_bf16 v[212:215], a[48:51], v[164:167], v[212:215]
ds_read_b128 v[196:199], v31 offset:17408
v_mfma_f32_16x16x32_bf16 v[216:219], a[96:99], v[112:115], v[216:219]
s_waitcnt lgkmcnt(2)
v_cmp_gt_u32 vcc, s52, v33
v_mfma_f32_16x16x32_bf16 v[208:211], a[52:55], v[168:171], v[208:211]
ds_read_b128 v[200:203], v31 offset:26624
v_cmp_gt_u32 s[58:59], s54, v33
v_mfma_f32_16x16x32_bf16 v[212:215], a[52:55], v[172:175], v[212:215]
ds_read_b128 v[204:207], v31 offset:35840
s_and_b32 vcc_lo, vcc_lo, s56
s_cselect_b32 s70, 0, 1
v_mfma_f32_16x16x32_bf16 v[220:223], a[96:99], v[116:119], v[220:223]
v_mfma_f32_16x16x32_bf16 v[208:211], a[56:59], v[176:179], v[208:211]
s_and_b32 s59, s59, s56
s_cselect_b32 s71, 0, s95
v_mfma_f32_16x16x32_bf16 v[212:215], a[56:59], v[180:183], v[212:215]
s_or_b32 s76, s70, s71
s_cselect_b32 s10, 268435456, 0
v_mfma_f32_16x16x32_bf16 v[216:219], a[100:103], v[120:123], v[216:219]
s_cmp_lg_u32 s70, 0
s_cselect_b64 s[72:73], s[52:53], s[54:55]
s_cselect_b64 s[58:59], s[44:45], s[46:47]
v_mfma_f32_16x16x32_bf16 v[208:211], a[60:63], v[184:187], v[208:211]
s_mul_i32 s74, s72, s20
s_add_u32 s74, s74, s58
v_mfma_f32_16x16x32_bf16 v[212:215], a[60:63], v[188:191], v[212:215]
s_add_u32 m0, s48, 0
s_mul_i32 s75, s72, s21
s_add_u32 s75, s75, s59
v_mfma_f32_16x16x32_bf16 v[220:223], a[100:103], v[124:127], v[220:223]
buffer_load_dwordx4 v8, s[8:11], s74 offen offset:0 sc1 lds
s_waitcnt lgkmcnt(0)
v_mfma_f32_16x16x32_bf16 v[208:211], a[64:67], v[192:195], v[208:211]
s_andn2_b32 s71, s71, s70
s_add_u32 s52, s52, s70
s_add_u32 s54, s54, s71
v_mfma_f32_16x16x32_bf16 v[212:215], a[64:67], v[196:199], v[212:215]
s_mov_b32 s77, s76
v_mfma_f32_16x16x32_bf16 v[216:219], a[104:107], v[128:131], v[216:219]
buffer_load_dwordx4 v9, s[8:11], s74 offen offset:1024 sc1 lds
v_mfma_f32_16x16x32_bf16 v[208:211], a[68:71], v[200:203], v[208:211]
v_mfma_f32_16x16x32_bf16 v[212:215], a[68:71], v[204:207], v[212:215]
v_mfma_f32_16x16x32_bf16 v[220:223], a[104:107], v[132:135], v[220:223]
buffer_load_dwordx4 v10, s[8:11], s74 offen offset:2048 sc1 lds
v_mfma_f32_16x16x32_bf16 v[216:219], a[108:111], v[136:139], v[216:219]
v_mfma_f32_16x16x32_bf16 v[220:223], a[108:111], v[140:143], v[220:223]
v_mfma_f32_16x16x32_bf16 v[216:219], a[112:115], v[144:147], v[216:219]
buffer_load_dwordx4 v11, s[8:11], s74 offen offset:3072 sc1 lds
v_mfma_f32_16x16x32_bf16 v[220:223], a[112:115], v[148:151], v[220:223]
v_mfma_f32_16x16x32_bf16 v[216:219], a[116:119], v[152:155], v[216:219]
s_add_u32 m0, s48, 4096
v_cvt_pk_bf16_f32 v48, v208, v209
v_mfma_f32_16x16x32_bf16 v[220:223], a[116:119], v[156:159], v[220:223]
buffer_load_dwordx4 v12, s[8:11], s74 offen offset:0 sc1 lds
v_mfma_f32_16x16x32_bf16 v[216:219], a[120:123], v[160:163], v[216:219]
v_cvt_pk_bf16_f32 v49, v210, v211
v_cvt_pk_bf16_f32 v50, v212, v213
v_mfma_f32_16x16x32_bf16 v[220:223], a[120:123], v[164:167], v[220:223]
v_cvt_pk_bf16_f32 v51, v214, v215
v_mfma_f32_16x16x32_bf16 v[216:219], a[124:127], v[168:171], v[216:219]
buffer_load_dwordx4 v13, s[8:11], s74 offen offset:1024 sc1 lds
v_mfma_f32_16x16x32_bf16 v[220:223], a[124:127], v[172:175], v[220:223]
v_permlane16_swap_b32 v48, v50
v_mfma_f32_16x16x32_bf16 v[216:219], a[128:131], v[176:179], v[216:219]
v_permlane16_swap_b32 v49, v51
v_mfma_f32_16x16x32_bf16 v[220:223], a[128:131], v[180:183], v[220:223]
buffer_load_dwordx4 v14, s[8:11], s74 offen offset:2048 sc1 lds
v_mfma_f32_16x16x32_bf16 v[216:219], a[132:135], v[184:187], v[216:219]
buffer_store_dwordx4 v[48:51], v19, s[4:7], s93 offen sc1
v_mfma_f32_16x16x32_bf16 v[220:223], a[132:135], v[188:191], v[220:223]
v_mfma_f32_16x16x32_bf16 v[216:219], a[136:139], v[192:195], v[216:219]
buffer_load_dwordx4 v15, s[8:11], s74 offen offset:3072 sc1 lds
v_mfma_f32_16x16x32_bf16 v[220:223], a[136:139], v[196:199], v[220:223]
v_mfma_f32_16x16x32_bf16 v[216:219], a[140:143], v[200:203], v[216:219]
s_add_u32 m0, s48, 8192
v_mfma_f32_16x16x32_bf16 v[220:223], a[140:143], v[204:207], v[220:223]
buffer_load_dwordx4 v16, s[8:11], s74 offen offset:0 sc1 lds
v_mfma_f32_16x16x32_bf16 v[224:227], a[144:147], v[64:67], 0
v_mfma_f32_16x16x32_bf16 v[228:231], a[144:147], v[68:71], 0
v_mfma_f32_16x16x32_bf16 v[224:227], a[148:151], v[72:75], v[224:227]
v_mfma_f32_16x16x32_bf16 v[228:231], a[148:151], v[76:79], v[228:231]
v_mfma_f32_16x16x32_bf16 v[224:227], a[152:155], v[80:83], v[224:227]
v_mfma_f32_16x16x32_bf16 v[228:231], a[152:155], v[84:87], v[228:231]
v_cvt_pk_bf16_f32 v52, v216, v217
v_cvt_pk_bf16_f32 v53, v218, v219
v_mfma_f32_16x16x32_bf16 v[224:227], a[156:159], v[88:91], v[224:227]
v_cvt_pk_bf16_f32 v54, v220, v221
v_cvt_pk_bf16_f32 v55, v222, v223
v_mfma_f32_16x16x32_bf16 v[228:231], a[156:159], v[92:95], v[228:231]
v_permlane16_swap_b32 v52, v54
v_mfma_f32_16x16x32_bf16 v[224:227], a[160:163], v[96:99], v[224:227]
v_permlane16_swap_b32 v53, v55
v_mfma_f32_16x16x32_bf16 v[228:231], a[160:163], v[100:103], v[228:231]
buffer_store_dwordx4 v[52:55], v20, s[4:7], s93 offen sc1
v_mfma_f32_16x16x32_bf16 v[224:227], a[164:167], v[104:107], v[224:227]
v_mfma_f32_16x16x32_bf16 v[228:231], a[164:167], v[108:111], v[228:231]
v_mfma_f32_16x16x32_bf16 v[224:227], a[168:171], v[112:115], v[224:227]
v_mfma_f32_16x16x32_bf16 v[228:231], a[168:171], v[116:119], v[228:231]
v_mfma_f32_16x16x32_bf16 v[224:227], a[172:175], v[120:123], v[224:227]
v_mfma_f32_16x16x32_bf16 v[228:231], a[172:175], v[124:127], v[228:231]
v_mfma_f32_16x16x32_bf16 v[224:227], a[176:179], v[128:131], v[224:227]
v_mfma_f32_16x16x32_bf16 v[228:231], a[176:179], v[132:135], v[228:231]
v_mfma_f32_16x16x32_bf16 v[224:227], a[180:183], v[136:139], v[224:227]
v_mfma_f32_16x16x32_bf16 v[228:231], a[180:183], v[140:143], v[228:231]
v_mfma_f32_16x16x32_bf16 v[224:227], a[184:187], v[144:147], v[224:227]
v_mfma_f32_16x16x32_bf16 v[228:231], a[184:187], v[148:151], v[228:231]
v_mfma_f32_16x16x32_bf16 v[224:227], a[188:191], v[152:155], v[224:227]
buffer_load_dword v24, v22, s[4:7], 0 offen sc1
v_mfma_f32_16x16x32_bf16 v[228:231], a[188:191], v[156:159], v[228:231]
v_mfma_f32_16x16x32_bf16 v[224:227], a[192:195], v[160:163], v[224:227]
s_waitcnt vmcnt(10)
s_barrier
v_mfma_f32_16x16x32_bf16 v[228:231], a[192:195], v[164:167], v[228:231]
buffer_store_dword v27, v45, s[4:7], s85 offen
v_mfma_f32_16x16x32_bf16 v[224:227], a[196:199], v[168:171], v[224:227]
buffer_store_dword v27, v44, s[4:7], s85 offen sc1
s_cmp_eq_u32 s76, 0
s_cbranch_scc1 g_slow_95
v_mfma_f32_16x16x32_bf16 v[228:231], a[196:199], v[172:175], v[228:231]
ds_read_b128 v[64:67], v28 offset:0
v_mfma_f32_16x16x32_bf16 v[224:227], a[200:203], v[176:179], v[224:227]
ds_read_b128 v[68:71], v28 offset:9216
v_mfma_f32_16x16x32_bf16 v[228:231], a[200:203], v[180:183], v[228:231]
ds_read_b128 v[72:75], v28 offset:18432
v_mfma_f32_16x16x32_bf16 v[224:227], a[204:207], v[184:187], v[224:227]
ds_read_b128 v[76:79], v28 offset:27648
v_mfma_f32_16x16x32_bf16 v[228:231], a[204:207], v[188:191], v[228:231]
ds_read_b128 v[80:83], v28 offset:1024
v_mfma_f32_16x16x32_bf16 v[224:227], a[208:211], v[192:195], v[224:227]
ds_read_b128 v[84:87], v28 offset:10240
v_mfma_f32_16x16x32_bf16 v[228:231], a[208:211], v[196:199], v[228:231]
ds_read_b128 v[88:91], v28 offset:19456
v_mfma_f32_16x16x32_bf16 v[224:227], a[212:215], v[200:203], v[224:227]
ds_read_b128 v[92:95], v28 offset:28672
v_mfma_f32_16x16x32_bf16 v[228:231], a[212:215], v[204:207], v[228:231]
s_waitcnt vmcnt(9)
s_barrier
s_branch g_body_80
g_slow_92:
v_mfma_f32_16x16x32_bf16 v[228:231], a[196:199], v[172:175], v[228:231]
v_mfma_f32_16x16x32_bf16 v[224:227], a[200:203], v[176:179], v[224:227]
v_mfma_f32_16x16x32_bf16 v[228:231], a[200:203], v[180:183], v[228:231]
v_mfma_f32_16x16x32_bf16 v[224:227], a[204:207], v[184:187], v[224:227]
v_mfma_f32_16x16x32_bf16 v[228:231], a[204:207], v[188:191], v[228:231]
v_mfma_f32_16x16x32_bf16 v[224:227], a[208:211], v[192:195], v[224:227]
v_mfma_f32_16x16x32_bf16 v[228:231], a[208:211], v[196:199], v[228:231]
v_mfma_f32_16x16x32_bf16 v[224:227], a[212:215], v[200:203], v[224:227]
v_mfma_f32_16x16x32_bf16 v[228:231], a[212:215], v[204:207], v[228:231]
s_nop 6
v_cvt_pk_bf16_f32 v56, v224, v225
v_cvt_pk_bf16_f32 v57, v226, v227
v_cvt_pk_bf16_f32 v58, v228, v229
v_cvt_pk_bf16_f32 v59, v230, v231
s_nop 0
v_permlane16_swap_b32 v56, v58
v_permlane16_swap_b32 v57, v59
buffer_store_dwordx4 v[56:59], v21, s[4:7], s75 offen sc1
s_mov_b32 s75, 1879048192
s_waitcnt vmcnt(3)
ds_write_b32 v18, v24
s_waitcnt lgkmcnt(0)
s_barrier
ds_read_b32 v33, v32
s_waitcnt lgkmcnt(0)
v_cmp_gt_u32 vcc, s52, v33
v_cmp_gt_u32 s[58:59], s54, v33
s_and_b32 vcc_lo, vcc_lo, s56
s_cselect_b32 s70, 0, 1
s_and_b32 s59, s59, s56
s_cselect_b32 s71, 0, s77
s_or_b32 s82, s70, s71
s_cselect_b32 s10, 268435456, 0
s_cmp_lg_u32 s70, 0
s_cselect_b64 s[78:79], s[52:53], s[54:55]
s_cselect_b64 s[58:59], s[44:45], s[46:47]
s_mul_i32 s80, s78, s20
s_add_u32 s80, s80, s58
s_mul_i32 s81, s78, s21
s_add_u32 s81, s81, s59
s_andn2_b32 s71, s71, s70
s_add_u32 s52, s52, s70
s_add_u32 s54, s54, s71
s_mov_b32 s83, s82
s_cmp_lg_u32 s82, 0
s_cbranch_scc1 g_go_96
v_mov_b32 v27, s72
s_waitcnt vmcnt(0)
s_barrier
s_add_u32 s70, s52, s54
s_cmp_eq_u32 s70, 130
s_cbranch_scc1 g_fin_84
s_cmp_lg_u32 s3, 0
s_cbranch_scc1 sp_ok_98_j
s_mov_b32 s23, 0
buffer_load_dword v33, v22, s[4:7], 0 offen sc1
buffer_store_dword v27, v45, s[4:7], s73 offen
buffer_store_dword v27, v44, s[4:7], s73 offen sc1
s_waitcnt vmcnt(2)
s_branch sp_loop_97_e
sp_loop_97:
buffer_load_dword v33, v22, s[4:7], 0 offen sc1
s_add_u32 s23, s23, 1
s_cmp_gt_u32 s23, 150000
s_cbranch_scc1 sp_bad_99
s_waitcnt vmcnt(0)
sp_loop_97_e:
v_cmp_gt_u32 vcc, s52, v33
v_cmp_gt_u32 s[58:59], s54, v33
s_and_b32 vcc_lo, vcc_lo, s56
s_cbranch_scc0 sp_ok_98
s_cmp_gt_u32 s23, 4
s_cselect_b32 s70, 0, s56
s_cmp_lg_u32 s77, 0
s_cselect_b32 s70, 0, s70
s_or_b32 s59, s59, s70
s_and_b32 s59, s59, s56
s_cbranch_scc0 sp_ok_98
s_sleep 1
s_branch sp_loop_97
sp_bad_99:
s_mov_b32 s98, 1027
s_branch L_fail
sp_ok_98:
ds_write_b32 v18, v33
s_waitcnt lgkmcnt(0)
sp_ok_98_j:
s_barrier
ds_read_b32 v33, v32
s_waitcnt lgkmcnt(0)
s_mov_b32 s73, 1879048192
v_cmp_gt_u32 vcc, s52, v33
v_cmp_gt_u32 s[58:59], s54, v33
s_and_b32 vcc_lo, vcc_lo, s56
s_cselect_b32 s70, 0, 1
s_and_b32 s59, s59, s56
s_cselect_b32 s71, 0, 1
s_or_b32 s82, s70, s71
s_cselect_b32 s10, 268435456, 0
s_cmp_lg_u32 s70, 0
s_cselect_b64 s[78:79], s[52:53], s[54:55]
s_cselect_b64 s[58:59], s[44:45], s[46:47]
s_mul_i32 s80, s78, s20
s_add_u32 s80, s80, s58
s_mul_i32 s81, s78, s21
s_add_u32 s81, s81, s59
s_andn2_b32 s71, s71, s70
s_add_u32 s52, s52, s70
s_add_u32 s54, s54, s71
s_mov_b32 s83, s82
g_go_96:
s_add_u32 m0, s49, 0
s_nop 0
buffer_load_dwordx4 v8, s[4:7], s80 offen offset:0 sc1 lds
buffer_load_dwordx4 v9, s[4:7], s80 offen offset:1024 sc1 lds
buffer_load_dwordx4 v10, s[4:7], s80 offen offset:2048 sc1 lds
buffer_load_dwordx4 v11, s[4:7], s80 offen offset:3072 sc1 lds
s_add_u32 m0, s49, 4096
s_nop 0
buffer_load_dwordx4 v12, s[4:7], s80 offen offset:0 sc1 lds
buffer_load_dwordx4 v13, s[4:7], s80 offen offset:1024 sc1 lds
buffer_load_dwordx4 v14, s[4:7], s80 offen offset:2048 sc1 lds
buffer_load_dwordx4 v15, s[4:7], s80 offen offset:3072 sc1 lds
s_add_u32 m0, s49, 8192
s_nop 0
buffer_load_dwordx4 v16, s[4:7], s80 offen offset:0 sc1 lds
buffer_store_dword v27, v34, s[4:7], 0 offen
buffer_load_dword v24, v22, s[4:7], 0 offen sc1
v_mov_b32 v27, s72
s_waitcnt vmcnt(9)
s_barrier
buffer_store_dword v27, v45, s[4:7], s73 offen
buffer_store_dword v27, v44, s[4:7], s73 offen sc1
s_mov_b32 s73, 1879048192
ds_read_b128 v[64:67], v29 offset:0
ds_read_b128 v[68:71], v29 offset:9216
ds_read_b128 v[72:75], v29 offset:18432
ds_read_b128 v[76:79], v29 offset:27648
ds_read_b128 v[80:83], v29 offset:1024
ds_read_b128 v[84:87], v29 offset:10240
ds_read_b128 v[88:91], v29 offset:19456
ds_read_b128 v[92:95], v29 offset:28672
s_waitcnt vmcnt(8)
s_barrier
s_branch g_body_81
g_slow_93:
v_mfma_f32_16x16x32_bf16 v[228:231], a[196:199], v[172:175], v[228:231]
v_mfma_f32_16x16x32_bf16 v[224:227], a[200:203], v[176:179], v[224:227]
v_mfma_f32_16x16x32_bf16 v[228:231], a[200:203], v[180:183], v[228:231]
v_mfma_f32_16x16x32_bf16 v[224:227], a[204:207], v[184:187], v[224:227]
v_mfma_f32_16x16x32_bf16 v[228:231], a[204:207], v[188:191], v[228:231]
v_mfma_f32_16x16x32_bf16 v[224:227], a[208:211], v[192:195], v[224:227]
v_mfma_f32_16x16x32_bf16 v[228:231], a[208:211], v[196:199], v[228:231]
v_mfma_f32_16x16x32_bf16 v[224:227], a[212:215], v[200:203], v[224:227]
v_mfma_f32_16x16x32_bf16 v[228:231], a[212:215], v[204:207], v[228:231]
s_nop 6
v_cvt_pk_bf16_f32 v56, v224, v225
v_cvt_pk_bf16_f32 v57, v226, v227
v_cvt_pk_bf16_f32 v58, v228, v229
v_cvt_pk_bf16_f32 v59, v230, v231
s_nop 0
v_permlane16_swap_b32 v56, v58
v_permlane16_swap_b32 v57, v59
buffer_store_dwordx4 v[56:59], v21, s[4:7], s81 offen sc1
s_mov_b32 s81, 1879048192
s_waitcnt vmcnt(3)
ds_write_b32 v18, v24
s_waitcnt lgkmcnt(0)
s_barrier
ds_read_b32 v33, v32
s_waitcnt lgkmcnt(0)
v_cmp_gt_u32 vcc, s52, v33
v_cmp_gt_u32 s[58:59], s54, v33
s_and_b32 vcc_lo, vcc_lo, s56
s_cselect_b32 s70, 0, 1
s_and_b32 s59, s59, s56
s_cselect_b32 s71, 0, s83
s_or_b32 s88, s70, s71
s_cselect_b32 s10, 268435456, 0
s_cmp_lg_u32 s70, 0
s_cselect_b64 s[84:85], s[52:53], s[54:55]
s_cselect_b64 s[58:59], s[44:45], s[46:47]
s_mul_i32 s86, s84, s20
s_add_u32 s86, s86, s58
s_mul_i32 s87, s84, s21
s_add_u32 s87, s87, s59
s_andn2_b32 s71, s71, s70
s_add_u32 s52, s52, s70
s_add_u32 s54, s54, s71
s_mov_b32 s89, s88
s_cmp_lg_u32 s88, 0
s_cbranch_scc1 g_go_100
v_mov_b32 v27, s78
s_waitcnt vmcnt(0)
s_barrier
s_add_u32 s70, s52, s54
s_cmp_eq_u32 s70, 130
s_cbranch_scc1 g_fin_84
s_cmp_lg_u32 s3, 0
s_cbranch_scc1 sp_ok_102_j
s_mov_b32 s23, 0
buffer_load_dword v33, v22, s[4:7], 0 offen sc1
buffer_store_dword v27, v45, s[4:7], s79 offen
buffer_store_dword v27, v44, s[4:7], s79 offen sc1
s_waitcnt vmcnt(2)
s_branch sp_loop_101_e
sp_loop_101:
buffer_load_dword v33, v22, s[4:7], 0 offen sc1
s_add_u32 s23, s23, 1
s_cmp_gt_u32 s23, 150000
s_cbranch_scc1 sp_bad_103
s_waitcnt vmcnt(0)
sp_loop_101_e:
v_cmp_gt_u32 vcc, s52, v33
v_cmp_gt_u32 s[58:59], s54, v33
s_and_b32 vcc_lo, vcc_lo, s56
s_cbranch_scc0 sp_ok_102
s_cmp_gt_u32 s23, 4
s_cselect_b32 s70, 0, s56
s_cmp_lg_u32 s83, 0
s_cselect_b32 s70, 0, s70
s_or_b32 s59, s59, s70
s_and_b32 s59, s59, s56
s_cbranch_scc0 sp_ok_102
s_sleep 1
s_branch sp_loop_101
sp_bad_103:
s_mov_b32 s98, 1027
s_branch L_fail
sp_ok_102:
ds_write_b32 v18, v33
s_waitcnt lgkmcnt(0)
sp_ok_102_j:
s_barrier
ds_read_b32 v33, v32
s_waitcnt lgkmcnt(0)
s_mov_b32 s79, 1879048192
v_cmp_gt_u32 vcc, s52, v33
v_cmp_gt_u32 s[58:59], s54, v33
s_and_b32 vcc_lo, vcc_lo, s56
s_cselect_b32 s70, 0, 1
s_and_b32 s59, s59, s56
s_cselect_b32 s71, 0, 1
s_or_b32 s88, s70, s71
s_cselect_b32 s10, 268435456, 0
s_cmp_lg_u32 s70, 0
s_cselect_b64 s[84:85], s[52:53], s[54:55]
s_cselect_b64 s[58:59], s[44:45], s[46:47]
s_mul_i32 s86, s84, s20
s_add_u32 s86, s86, s58
s_mul_i32 s87, s84, s21
s_add_u32 s87, s87, s59
s_andn2_b32 s71, s71, s70
s_add_u32 s52, s52, s70
s_add_u32 s54, s54, s71
s_mov_b32 s89, s88
g_go_100:
s_add_u32 m0, s50, 0
s_nop 0
buffer_load_dwordx4 v8, s[4:7], s86 offen offset:0 sc1 lds
buffer_load_dwordx4 v9, s[4:7], s86 offen offset:1024 sc1 lds
buffer_load_dwordx4 v10, s[4:7], s86 offen offset:2048 sc1 lds
buffer_load_dwordx4 v11, s[4:7], s86 offen offset:3072 sc1 lds
s_add_u32 m0, s50, 4096
s_nop 0
buffer_load_dwordx4 v12, s[4:7], s86 offen offset:0 sc1 lds
buffer_load_dwordx4 v13, s[4:7], s86 offen offset:1024 sc1 lds
buffer_load_dwordx4 v14, s[4:7], s86 offen offset:2048 sc1 lds
buffer_load_dwordx4 v15, s[4:7], s86 offen offset:3072 sc1 lds
s_add_u32 m0, s50, 8192
s_nop 0
buffer_load_dwordx4 v16, s[4:7], s86 offen offset:0 sc1 lds
buffer_store_dword v27, v34, s[4:7], 0 offen
buffer_load_dword v24, v22, s[4:7], 0 offen sc1
v_mov_b32 v27, s78
s_waitcnt vmcnt(9)
s_barrier
buffer_store_dword v27, v45, s[4:7], s79 offen
buffer_store_dword v27, v44, s[4:7], s79 offen sc1
s_mov_b32 s79, 1879048192
ds_read_b128 v[64:67], v30 offset:0
ds_read_b128 v[68:71], v30 offset:9216
ds_read_b128 v[72:75], v30 offset:18432
ds_read_b128 v[76:79], v30 offset:27648
ds_read_b128 v[80:83], v30 offset:1024
ds_read_b128 v[84:87], v30 offset:10240
ds_read_b128 v[88:91], v30 offset:19456
ds_read_b128 v[92:95], v30 offset:28672
s_waitcnt vmcnt(8)
s_barrier
s_branch g_body_82
g_slow_94:
v_mfma_f32_16x16x32_bf16 v[228:231], a[196:199], v[172:175], v[228:231]
v_mfma_f32_16x16x32_bf16 v[224:227], a[200:203], v[176:179], v[224:227]
v_mfma_f32_16x16x32_bf16 v[228:231], a[200:203], v[180:183], v[228:231]
v_mfma_f32_16x16x32_bf16 v[224:227], a[204:207], v[184:187], v[224:227]
v_mfma_f32_16x16x32_bf16 v[228:231], a[204:207], v[188:191], v[228:231]
v_mfma_f32_16x16x32_bf16 v[224:227], a[208:211], v[192:195], v[224:227]
v_mfma_f32_16x16x32_bf16 v[228:231], a[208:211], v[196:199], v[228:231]
v_mfma_f32_16x16x32_bf16 v[224:227], a[212:215], v[200:203], v[224:227]
v_mfma_f32_16x16x32_bf16 v[228:231], a[212:215], v[204:207], v[228:231]
s_nop 6
v_cvt_pk_bf16_f32 v56, v224, v225
v_cvt_pk_bf16_f32 v57, v226, v227
v_cvt_pk_bf16_f32 v58, v228, v229
v_cvt_pk_bf16_f32 v59, v230, v231
s_nop 0
v_permlane16_swap_b32 v56, v58
v_permlane16_swap_b32 v57, v59
buffer_store_dwordx4 v[56:59], v21, s[4:7], s87 offen sc1
s_mov_b32 s87, 1879048192
s_waitcnt vmcnt(3)
ds_write_b32 v18, v24
s_waitcnt lgkmcnt(0)
s_barrier
ds_read_b32 v33, v32
s_waitcnt lgkmcnt(0)
v_cmp_gt_u32 vcc, s52, v33
v_cmp_gt_u32 s[58:59], s54, v33
s_and_b32 vcc_lo, vcc_lo, s56
s_cselect_b32 s70, 0, 1
s_and_b32 s59, s59, s56
s_cselect_b32 s71, 0, s89
s_or_b32 s94, s70, s71
s_cselect_b32 s10, 268435456, 0
s_cmp_lg_u32 s70, 0
s_cselect_b64 s[90:91], s[52:53], s[54:55]
s_cselect_b64 s[58:59], s[44:45], s[46:47]
s_mul_i32 s92, s90, s20
s_add_u32 s92, s92, s58
s_mul_i32 s93, s90, s21
s_add_u32 s93, s93, s59
s_andn2_b32 s71, s71, s70
s_add_u32 s52, s52, s70
s_add_u32 s54, s54, s71
s_mov_b32 s95, s94
s_cmp_lg_u32 s94, 0
s_cbranch_scc1 g_go_104
v_mov_b32 v27, s84
s_waitcnt vmcnt(0)
s_barrier
s_add_u32 s70, s52, s54
s_cmp_eq_u32 s70, 130
s_cbranch_scc1 g_fin_84
s_cmp_lg_u32 s3, 0
s_cbranch_scc1 sp_ok_106_j
s_mov_b32 s23, 0
buffer_load_dword v33, v22, s[4:7], 0 offen sc1
buffer_store_dword v27, v45, s[4:7], s85 offen
buffer_store_dword v27, v44, s[4:7], s85 offen sc1
s_waitcnt vmcnt(2)
s_branch sp_loop_105_e
sp_loop_105:
buffer_load_dword v33, v22, s[4:7], 0 offen sc1
s_add_u32 s23, s23, 1
s_cmp_gt_u32 s23, 150000
s_cbranch_scc1 sp_bad_107
s_waitcnt vmcnt(0)
sp_loop_105_e:
v_cmp_gt_u32 vcc, s52, v33
v_cmp_gt_u32 s[58:59], s54, v33
s_and_b32 vcc_lo, vcc_lo, s56
s_cbranch_scc0 sp_ok_106
s_cmp_gt_u32 s23, 4
s_cselect_b32 s70, 0, s56
s_cmp_lg_u32 s89, 0
s_cselect_b32 s70, 0, s70
s_or_b32 s59, s59, s70
s_and_b32 s59, s59, s56
s_cbranch_scc0 sp_ok_106
s_sleep 1
s_branch sp_loop_105
sp_bad_107:
s_mov_b32 s98, 1027
s_branch L_fail
sp_ok_106:
ds_write_b32 v18, v33
s_waitcnt lgkmcnt(0)
sp_ok_106_j:
s_barrier
ds_read_b32 v33, v32
s_waitcnt lgkmcnt(0)
s_mov_b32 s85, 1879048192
v_cmp_gt_u32 vcc, s52, v33
v_cmp_gt_u32 s[58:59], s54, v33
s_and_b32 vcc_lo, vcc_lo, s56
s_cselect_b32 s70, 0, 1
s_and_b32 s59, s59, s56
s_cselect_b32 s71, 0, 1
s_or_b32 s94, s70, s71
s_cselect_b32 s10, 268435456, 0
s_cmp_lg_u32 s70, 0
s_cselect_b64 s[90:91], s[52:53], s[54:55]
s_cselect_b64 s[58:59], s[44:45], s[46:47]
s_mul_i32 s92, s90, s20
s_add_u32 s92, s92, s58
s_mul_i32 s93, s90, s21
s_add_u32 s93, s93, s59
s_andn2_b32 s71, s71, s70
s_add_u32 s52, s52, s70
s_add_u32 s54, s54, s71
s_mov_b32 s95, s94
g_go_104:
s_add_u32 m0, s51, 0
s_nop 0
buffer_load_dwordx4 v8, s[4:7], s92 offen offset:0 sc1 lds
buffer_load_dwordx4 v9, s[4:7], s92 offen offset:1024 sc1 lds
buffer_load_dwordx4 v10, s[4:7], s92 offen offset:2048 sc1 lds
buffer_load_dwordx4 v11, s[4:7], s92 offen offset:3072 sc1 lds
s_add_u32 m0, s51, 4096
s_nop 0
buffer_load_dwordx4 v12, s[4:7], s92 offen offset:0 sc1 lds
buffer_load_dwordx4 v13, s[4:7], s92 offen offset:1024 sc1 lds
buffer_load_dwordx4 v14, s[4:7], s92 offen offset:2048 sc1 lds
buffer_load_dwordx4 v15, s[4:7], s92 offen offset:3072 sc1 lds
s_add_u32 m0, s51, 8192
s_nop 0
buffer_load_dwordx4 v16, s[4:7], s92 offen offset:0 sc1 lds
buffer_store_dword v27, v34, s[4:7], 0 offen
buffer_load_dword v24, v22, s[4:7], 0 offen sc1
v_mov_b32 v27, s84
s_waitcnt vmcnt(9)
s_barrier
buffer_store_dword v27, v45, s[4:7], s85 offen
buffer_store_dword v27, v44, s[4:7], s85 offen sc1
s_mov_b32 s85, 1879048192
ds_read_b128 v[64:67], v31 offset:0
ds_read_b128 v[68:71], v31 offset:9216
ds_read_b128 v[72:75], v31 offset:18432
ds_read_b128 v[76:79], v31 offset:27648
ds_read_b128 v[80:83], v31 offset:1024
ds_read_b128 v[84:87], v31 offset:10240
ds_read_b128 v[88:91], v31 offset:19456
ds_read_b128 v[92:95], v31 offset:28672
s_waitcnt vmcnt(8)
s_barrier
s_branch g_body_83
g_slow_95:
v_mfma_f32_16x16x32_bf16 v[228:231], a[196:199], v[172:175], v[228:231]
v_mfma_f32_16x16x32_bf16 v[224:227], a[200:203], v[176:179], v[224:227]
v_mfma_f32_16x16x32_bf16 v[228:231], a[200:203], v[180:183], v[228:231]
v_mfma_f32_16x16x32_bf16 v[224:227], a[204:207], v[184:187], v[224:227]
v_mfma_f32_16x16x32_bf16 v[228:231], a[204:207], v[188:191], v[228:231]
v_mfma_f32_16x16x32_bf16 v[224:227], a[208:211], v[192:195], v[224:227]
v_mfma_f32_16x16x32_bf16 v[228:231], a[208:211], v[196:199], v[228:231]
v_mfma_f32_16x16x32_bf16 v[224:227], a[212:215], v[200:203], v[224:227]
v_mfma_f32_16x16x32_bf16 v[228:231], a[212:215], v[204:207], v[228:231]
s_nop 6
v_cvt_pk_bf16_f32 v56, v224, v225
v_cvt_pk_bf16_f32 v57, v226, v227
v_cvt_pk_bf16_f32 v58, v228, v229
v_cvt_pk_bf16_f32 v59, v230, v231
s_nop 0
v_permlane16_swap_b32 v56, v58
v_permlane16_swap_b32 v57, v59
buffer_store_dwordx4 v[56:59], v21, s[4:7], s93 offen sc1
s_mov_b32 s93, 1879048192
s_waitcnt vmcnt(3)
ds_write_b32 v18, v24
s_waitcnt lgkmcnt(0)
s_barrier
ds_read_b32 v33, v32
s_waitcnt lgkmcnt(0)
v_cmp_gt_u32 vcc, s52, v33
v_cmp_gt_u32 s[58:59], s54, v33
s_and_b32 vcc_lo, vcc_lo, s56
s_cselect_b32 s70, 0, 1
s_and_b32 s59, s59, s56
s_cselect_b32 s71, 0, s95
s_or_b32 s76, s70, s71
s_cselect_b32 s10, 268435456, 0
s_cmp_lg_u32 s70, 0
s_cselect_b64 s[72:73], s[52:53], s[54:55]
s_cselect_b64 s[58:59], s[44:45], s[46:47]
s_mul_i32 s74, s72, s20
s_add_u32 s74, s74, s58
s_mul_i32 s75, s72, s21
s_add_u32 s75, s75, s59
s_andn2_b32 s71, s71, s70
s_add_u32 s52, s52, s70
s_add_u32 s54, s54, s71
s_mov_b32 s77, s76
s_cmp_lg_u32 s76, 0
s_cbranch_scc1 g_go_108
v_mov_b32 v27, s90
s_waitcnt vmcnt(0)
s_barrier
s_add_u32 s70, s52, s54
s_cmp_eq_u32 s70, 130
s_cbranch_scc1 g_fin_84
s_cmp_lg_u32 s3, 0
s_cbranch_scc1 sp_ok_110_j
s_mov_b32 s23, 0
buffer_load_dword v33, v22, s[4:7], 0 offen sc1
buffer_store_dword v27, v45, s[4:7], s91 offen
buffer_store_dword v27, v44, s[4:7], s91 offen sc1
s_waitcnt vmcnt(2)
s_branch sp_loop_109_e
sp_loop_109:
buffer_load_dword v33, v22, s[4:7], 0 offen sc1
s_add_u32 s23, s23, 1
s_cmp_gt_u32 s23, 150000
s_cbranch_scc1 sp_bad_111
s_waitcnt vmcnt(0)
sp_loop_109_e:
v_cmp_gt_u32 vcc, s52, v33
v_cmp_gt_u32 s[58:59], s54, v33
s_and_b32 vcc_lo, vcc_lo, s56
s_cbranch_scc0 sp_ok_110
s_cmp_gt_u32 s23, 4
s_cselect_b32 s70, 0, s56
s_cmp_lg_u32 s95, 0
s_cselect_b32 s70, 0, s70
s_or_b32 s59, s59, s70
s_and_b32 s59, s59, s56
s_cbranch_scc0 sp_ok_110
s_sleep 1
s_branch sp_loop_109
sp_bad_111:
s_mov_b32 s98, 1027
s_branch L_fail
sp_ok_110:
ds_write_b32 v18, v33
s_waitcnt lgkmcnt(0)
sp_ok_110_j:
s_barrier
ds_read_b32 v33, v32
s_waitcnt lgkmcnt(0)
s_mov_b32 s91, 1879048192
v_cmp_gt_u32 vcc, s52, v33
v_cmp_gt_u32 s[58:59], s54, v33
s_and_b32 vcc_lo, vcc_lo, s56
s_cselect_b32 s70, 0, 1
s_and_b32 s59, s59, s56
s_cselect_b32 s71, 0, 1
s_or_b32 s76, s70, s71
s_cselect_b32 s10, 268435456, 0
s_cmp_lg_u32 s70, 0
s_cselect_b64 s[72:73], s[52:53], s[54:55]
s_cselect_b64 s[58:59], s[44:45], s[46:47]
s_mul_i32 s74, s72, s20
s_add_u32 s74, s74, s58
s_mul_i32 s75, s72, s21
s_add_u32 s75, s75, s59
s_andn2_b32 s71, s71, s70
s_add_u32 s52, s52, s70
s_add_u32 s54, s54, s71
s_mov_b32 s77, s76
g_go_108:
s_add_u32 m0, s48, 0
s_nop 0
buffer_load_dwordx4 v8, s[4:7], s74 offen offset:0 sc1 lds
buffer_load_dwordx4 v9, s[4:7], s74 offen offset:1024 sc1 lds
buffer_load_dwordx4 v10, s[4:7], s74 offen offset:2048 sc1 lds
buffer_load_dwordx4 v11, s[4:7], s74 offen offset:3072 sc1 lds
s_add_u32 m0, s48, 4096
s_nop 0
buffer_load_dwordx4 v12, s[4:7], s74 offen offset:0 sc1 lds
buffer_load_dwordx4 v13, s[4:7], s74 offen offset:1024 sc1 lds
buffer_load_dwordx4 v14, s[4:7], s74 offen offset:2048 sc1 lds
buffer_load_dwordx4 v15, s[4:7], s74 offen offset:3072 sc1 lds
s_add_u32 m0, s48, 8192
s_nop 0
buffer_load_dwordx4 v16, s[4:7], s74 offen offset:0 sc1 lds
buffer_store_dword v27, v34, s[4:7], 0 offen
buffer_load_dword v24, v22, s[4:7], 0 offen sc1
v_mov_b32 v27, s90
s_waitcnt vmcnt(9)
s_barrier
buffer_store_dword v27, v45, s[4:7], s91 offen
buffer_store_dword v27, v44, s[4:7], s91 offen sc1
s_mov_b32 s91, 1879048192
ds_read_b128 v[64:67], v28 offset:0
ds_read_b128 v[68:71], v28 offset:9216
ds_read_b128 v[72:75], v28 offset:18432
ds_read_b128 v[76:79], v28 offset:27648
ds_read_b128 v[80:83], v28 offset:1024
ds_read_b128 v[84:87], v28 offset:10240
ds_read_b128 v[88:91], v28 offset:19456
ds_read_b128 v[92:95], v28 offset:28672
s_waitcnt vmcnt(8)
s_barrier
s_branch g_body_80
g_fin_84:
buffer_store_dword v27, v45, s[4:7], s91 offen
buffer_store_dword v27, v44, s[4:7], s91 offen sc1
s_endpgm
H_dn:
s_mul_i32 s75, s74, 43
s_lshr_b32 s75, s75, 7
s_mul_i32 s76, s75, 3
s_sub_u32 s76, s74, s76
s_mov_b32 s8, s36
s_and_b32 s9, s37, 0xffff
s_mov_b32 s10, 5308416
s_mov_b32 s11, 0x20000
s_mul_i32 s77, s76, 12
s_mul_i32 s78, s3, 3
s_add_u32 s77, s77, s78
s_mul_i32 s78, s75, 663552
v_bfe_u32 v1, v0, 4, 1
v_bfe_u32 v2, v0, 1, 3
v_lshl_add_u32 v1, v1, 3, v2
v_mul_u32_u24 v1, 2304, v1
v_lshrrev_b32 v2, 5, v0
v_lshl_add_u32 v1, v2, 5, v1
v_and_b32 v2, 1, v0
v_lshl_add_u32 v5, v2, 4, v1
s_mul_i32 s79, s75, 36864
s_add_u32 s80, s77, 0
s_lshl_b32 s81, s80, 5
s_add_u32 s48, s81, s78
s_lshl_b32 s81, s80, 6
s_add_u32 s81, s81, s79
v_add_u32 v19, s81, v5
s_add_u32 s80, s77, 1
s_lshl_b32 s81, s80, 5
s_add_u32 s49, s81, s78
s_lshl_b32 s81, s80, 6
s_add_u32 s81, s81, s79
v_add_u32 v20, s81, v5
s_add_u32 s80, s77, 2
s_lshl_b32 s81, s80, 5
s_add_u32 s50, s81, s78
s_lshl_b32 s81, s80, 6
s_add_u32 s81, s81, s79
v_add_u32 v21, s81, v5
v_lshrrev_b32 v1, 5, v0
v_bfe_u32 v2, v0, 3, 1
v_lshl_add_u32 v1, v1, 1, v2
v_bfe_u32 v2, v0, 4, 1
v_bfe_u32 v3, v0, 1, 2
v_lshlrev_b32 v1, 3, v1
v_lshl_add_u32 v1, v2, 2, v1
v_add_u32 v1, v1, v3
v_mul_u32_u24 v1, 1152, v1
v_and_b32 v2, 1, v0
v_lshl_add_u32 v63, v2, 4, v1
s_mul_i32 s70, s3, 40960
v_lshrrev_b32 v1, 5, v0
v_lshlrev_b32 v1, 9, v1
v_bfe_u32 v2, v0, 4, 1
v_lshl_add_u32 v1, v2, 7, v1
v_add_u32 v1, s70, v1
v_and_b32 v2, 15, v0
v_lshl_add_u32 v2, v2, 3, v1
v_add_u32 v60, 0, v2
v_add_u32 v61, 1024, v2
v_add_u32 v62, 2048, v2
s_add_u32 m0, s70, 0
s_add_u32 s71, s48, 0
buffer_load_dwordx4 v63, s[8:11], s71 offen lds
s_add_u32 m0, s70, 1024
s_add_u32 s71, s49, 0
buffer_load_dwordx4 v63, s[8:11], s71 offen lds
s_add_u32 m0, s70, 2048
s_add_u32 s71, s50, 0
buffer_load_dwordx4 v63, s[8:11], s71 offen lds
s_add_u32 m0, s70, 3072
s_add_u32 s71, s48, 36864
buffer_load_dwordx4 v63, s[8:11], s71 offen lds
s_add_u32 m0, s70, 4096
s_add_u32 s71, s49, 36864
buffer_load_dwordx4 v63, s[8:11], s71 offen lds
s_add_u32 m0, s70, 5120
s_add_u32 s71, s50, 36864
buffer_load_dwordx4 v63, s[8:11], s71 offen lds
s_add_u32 m0, s70, 6144
s_add_u32 s71, s48, 73728
buffer_load_dwordx4 v63, s[8:11], s71 offen lds
s_add_u32 m0, s70, 7168
s_add_u32 s71, s49, 73728
buffer_load_dwordx4 v63, s[8:11], s71 offen lds
s_add_u32 m0, s70, 8192
s_add_u32 s71, s50, 73728
buffer_load_dwordx4 v63, s[8:11], s71 offen lds
s_add_u32 m0, s70, 9216
s_add_u32 s71, s48, 110592
buffer_load_dwordx4 v63, s[8:11], s71 offen lds
s_add_u32 m0, s70, 10240
s_add_u32 s71, s49, 110592
buffer_load_dwordx4 v63, s[8:11], s71 offen lds
s_add_u32 m0, s70, 11264
s_add_u32 s71, s50, 110592
buffer_load_dwordx4 v63, s[8:11], s71 offen lds
s_add_u32 m0, s70, 12288
s_add_u32 s71, s48, 147456
buffer_load_dwordx4 v63, s[8:11], s71 offen lds
s_add_u32 m0, s70, 13312
s_add_u32 s71, s49, 147456
buffer_load_dwordx4 v63, s[8:11], s71 offen lds
s_add_u32 m0, s70, 14336
s_add_u32 s71, s50, 147456
buffer_load_dwordx4 v63, s[8:11], s71 offen lds
s_add_u32 m0, s70, 15360
s_add_u32 s71, s48, 184320
buffer_load_dwordx4 v63, s[8:11], s71 offen lds
s_add_u32 m0, s70, 16384
s_add_u32 s71, s49, 184320
buffer_load_dwordx4 v63, s[8:11], s71 offen lds
s_add_u32 m0, s70, 17408
s_add_u32 s71, s50, 184320
buffer_load_dwordx4 v63, s[8:11], s71 offen lds
s_add_u32 m0, s70, 18432
s_add_u32 s71, s48, 221184
buffer_load_dwordx4 v63, s[8:11], s71 offen lds
s_add_u32 m0, s70, 19456
s_add_u32 s71, s49, 221184
buffer_load_dwordx4 v63, s[8:11], s71 offen lds
s_add_u32 m0, s70, 20480
s_add_u32 s71, s50, 221184
buffer_load_dwordx4 v63, s[8:11], s71 offen lds
s_add_u32 m0, s70, 21504
s_add_u32 s71, s48, 258048
buffer_load_dwordx4 v63, s[8:11], s71 offen lds
s_add_u32 m0, s70, 22528
s_add_u32 s71, s49, 258048
buffer_load_dwordx4 v63, s[8:11], s71 offen lds
s_add_u32 m0, s70, 23552
s_add_u32 s71, s50, 258048
buffer_load_dwordx4 v63, s[8:11], s71 offen lds
s_add_u32 m0, s70, 24576
s_add_u32 s71, s48, 294912
buffer_load_dwordx4 v63, s[8:11], s71 offen lds
s_add_u32 m0, s70, 25600
s_add_u32 s71, s49, 294912
buffer_load_dwordx4 v63, s[8:11], s71 offen lds
s_add_u32 m0, s70, 26624
s_add_u32 s71, s50, 294912
buffer_load_dwordx4 v63, s[8:11], s71 offen lds
s_add_u32 m0, s70, 27648
s_add_u32 s71, s48, 331776
buffer_load_dwordx4 v63, s[8:11], s71 offen lds
s_add_u32 m0, s70, 28672
s_add_u32 s71, s49, 331776
buffer_load_dwordx4 v63, s[8:11], s71 offen lds
s_add_u32 m0, s70, 29696
s_add_u32 s71, s50, 331776
buffer_load_dwordx4 v63, s[8:11], s71 offen lds
s_add_u32 m0, s70, 30720
s_add_u32 s71, s48, 368640
buffer_load_dwordx4 v63, s[8:11], s71 offen lds
s_add_u32 m0, s70, 31744
s_add_u32 s71, s49, 368640
buffer_load_dwordx4 v63, s[8:11], s71 offen lds
s_add_u32 m0, s70, 32768
s_add_u32 s71, s50, 368640
buffer_load_dwordx4 v63, s[8:11], s71 offen lds
s_add_u32 m0, s70, 33792
s_add_u32 s71, s48, 405504
buffer_load_dwordx4 v63, s[8:11], s71 offen lds
s_add_u32 m0, s70, 34816
s_add_u32 s71, s49, 405504
buffer_load_dwordx4 v63, s[8:11], s71 offen lds
s_add_u32 m0, s70, 35840
s_add_u32 s71, s50, 405504
buffer_load_dwordx4 v63, s[8:11], s71 offen lds
s_add_u32 m0, s70, 36864
s_add_u32 s71, s48, 442368
buffer_load_dwordx4 v63, s[8:11], s71 offen lds
s_add_u32 m0, s70, 37888
s_add_u32 s71, s49, 442368
buffer_load_dwordx4 v63, s[8:11], s71 offen lds
s_add_u32 m0, s70, 38912
s_add_u32 s71, s50, 442368
buffer_load_dwordx4 v63, s[8:11], s71 offen lds
s_waitcnt vmcnt(36)
ds_read_b64_tr_b16 a[0:1], v60 offset:0
ds_read_b64_tr_b16 a[2:3], v60 offset:256
ds_read_b64_tr_b16 a[72:73], v61 offset:0
ds_read_b64_tr_b16 a[74:75], v61 offset:256
ds_read_b64_tr_b16 a[144:145], v62 offset:0
ds_read_b64_tr_b16 a[146:147], v62 offset:256
s_waitcnt lgkmcnt(0)
s_add_u32 m0, s70, 0
s_add_u32 s71, s48, 479232
buffer_load_dwordx4 v63, s[8:11], s71 offen lds
s_add_u32 m0, s70, 1024
s_add_u32 s71, s49, 479232
buffer_load_dwordx4 v63, s[8:11], s71 offen lds
s_add_u32 m0, s70, 2048
s_add_u32 s71, s50, 479232
buffer_load_dwordx4 v63, s[8:11], s71 offen lds
s_waitcnt vmcnt(36)
ds_read_b64_tr_b16 a[4:5], v60 offset:3072
ds_read_b64_tr_b16 a[6:7], v60 offset:3328
ds_read_b64_tr_b16 a[76:77], v61 offset:3072
ds_read_b64_tr_b16 a[78:79], v61 offset:3328
ds_read_b64_tr_b16 a[148:149], v62 offset:3072
ds_read_b64_tr_b16 a[150:151], v62 offset:3328
s_waitcnt lgkmcnt(0)
s_add_u32 m0, s70, 3072
s_add_u32 s71, s48, 516096
buffer_load_dwordx4 v63, s[8:11], s71 offen lds
s_add_u32 m0, s70, 4096
s_add_u32 s71, s49, 516096
buffer_load_dwordx4 v63, s[8:11], s71 offen lds
s_add_u32 m0, s70, 5120
s_add_u32 s71, s50, 516096
buffer_load_dwordx4 v63, s[8:11], s71 offen lds
s_waitcnt vmcnt(36)
ds_read_b64_tr_b16 a[8:9], v60 offset:6144
ds_read_b64_tr_b16 a[10:11], v60 offset:6400
ds_read_b64_tr_b16 a[80:81], v61 offset:6144
ds_read_b64_tr_b16 a[82:83], v61 offset:6400
ds_read_b64_tr_b16 a[152:153], v62 offset:6144
ds_read_b64_tr_b16 a[154:155], v62 offset:6400
s_waitcnt lgkmcnt(0)
s_add_u32 m0, s70, 6144
s_add_u32 s71, s48, 552960
buffer_load_dwordx4 v63, s[8:11], s71 offen lds
s_add_u32 m0, s70, 7168
s_add_u32 s71, s49, 552960
buffer_load_dwordx4 v63, s[8:11], s71 offen lds
s_add_u32 m0, s70, 8192
s_add_u32 s71, s50, 552960
buffer_load_dwordx4 v63, s[8:11], s71 offen lds
s_waitcnt vmcnt(36)
ds_read_b64_tr_b16 a[12:13], v60 offset:9216
ds_read_b64_tr_b16 a[14:15], v60 offset:9472
ds_read_b64_tr_b16 a[84:85], v61 offset:9216
ds_read_b64_tr_b16 a[86:87], v61 offset:9472
ds_read_b64_tr_b16 a[156:157], v62 offset:9216
ds_read_b64_tr_b16 a[158:159], v62 offset:9472
s_waitcnt lgkmcnt(0)
s_add_u32 m0, s70, 9216
s_add_u32 s71, s48, 589824
buffer_load_dwordx4 v63, s[8:11], s71 offen lds
s_add_u32 m0, s70, 10240
s_add_u32 s71, s49, 589824
buffer_load_dwordx4 v63, s[8:11], s71 offen lds
s_add_u32 m0, s70, 11264
s_add_u32 s71, s50, 589824
buffer_load_dwordx4 v63, s[8:11], s71 offen lds
s_waitcnt vmcnt(36)
ds_read_b64_tr_b16 a[16:17], v60 offset:12288
ds_read_b64_tr_b16 a[18:19], v60 offset:12544
ds_read_b64_tr_b16 a[88:89], v61 offset:12288
ds_read_b64_tr_b16 a[90:91], v61 offset:12544
ds_read_b64_tr_b16 a[160:161], v62 offset:12288
ds_read_b64_tr_b16 a[162:163], v62 offset:12544
s_waitcnt lgkmcnt(0)
s_add_u32 m0, s70, 12288
s_add_u32 s71, s48, 626688
buffer_load_dwordx4 v63, s[8:11], s71 offen lds
s_add_u32 m0, s70, 13312
s_add_u32 s71, s49, 626688
buffer_load_dwordx4 v63, s[8:11], s71 offen lds
s_add_u32 m0, s70, 14336
s_add_u32 s71, s50, 626688
buffer_load_dwordx4 v63, s[8:11], s71 offen lds
s_waitcnt vmcnt(36)
ds_read_b64_tr_b16 a[20:21], v60 offset:15360
ds_read_b64_tr_b16 a[22:23], v60 offset:15616
ds_read_b64_tr_b16 a[92:93], v61 offset:15360
ds_read_b64_tr_b16 a[94:95], v61 offset:15616
ds_read_b64_tr_b16 a[164:165], v62 offset:15360
ds_read_b64_tr_b16 a[166:167], v62 offset:15616
s_waitcnt vmcnt(33)
ds_read_b64_tr_b16 a[24:25], v60 offset:18432
ds_read_b64_tr_b16 a[26:27], v60 offset:18688
ds_read_b64_tr_b16 a[96:97], v61 offset:18432
ds_read_b64_tr_b16 a[98:99], v61 offset:18688
ds_read_b64_tr_b16 a[168:169], v62 offset:18432
ds_read_b64_tr_b16 a[170:171], v62 offset:18688
s_waitcnt vmcnt(30)
ds_read_b64_tr_b16 a[28:29], v60 offset:21504
ds_read_b64_tr_b16 a[30:31], v60 offset:21760
ds_read_b64_tr_b16 a[100:101], v61 offset:21504
ds_read_b64_tr_b16 a[102:103], v61 offset:21760
ds_read_b64_tr_b16 a[172:173], v62 offset:21504
ds_read_b64_tr_b16 a[174:175], v62 offset:21760
s_waitcnt vmcnt(27)
ds_read_b64_tr_b16 a[32:33], v60 offset:24576
ds_read_b64_tr_b16 a[34:35], v60 offset:24832
ds_read_b64_tr_b16 a[104:105], v61 offset:24576
ds_read_b64_tr_b16 a[106:107], v61 offset:24832
ds_read_b64_tr_b16 a[176:177], v62 offset:24576
ds_read_b64_tr_b16 a[178:179], v62 offset:24832
s_waitcnt vmcnt(24)
ds_read_b64_tr_b16 a[36:37], v60 offset:27648
ds_read_b64_tr_b16 a[38:39], v60 offset:27904
ds_read_b64_tr_b16 a[108:109], v61 offset:27648
ds_read_b64_tr_b16 a[110:111], v61 offset:27904
ds_read_b64_tr_b16 a[180:181], v62 offset:27648
ds_read_b64_tr_b16 a[182:183], v62 offset:27904
s_waitcnt vmcnt(21)
ds_read_b64_tr_b16 a[40:41], v60 offset:30720
ds_read_b64_tr_b16 a[42:43], v60 offset:30976
ds_read_b64_tr_b16 a[112:113], v61 offset:30720
ds_read_b64_tr_b16 a[114:115], v61 offset:30976
ds_read_b64_tr_b16 a[184:185], v62 offset:30720
ds_read_b64_tr_b16 a[186:187], v62 offset:30976
s_waitcnt vmcnt(18)
ds_read_b64_tr_b16 a[44:45], v60 offset:33792
ds_read_b64_tr_b16 a[46:47], v60 offset:34048
ds_read_b64_tr_b16 a[116:117], v61 offset:33792
ds_read_b64_tr_b16 a[118:119], v61 offset:34048
ds_read_b64_tr_b16 a[188:189], v62 offset:33792
ds_read_b64_tr_b16 a[190:191], v62 offset:34048
s_waitcnt vmcnt(15)
ds_read_b64_tr_b16 a[48:49], v60 offset:36864
ds_read_b64_tr_b16 a[50:51], v60 offset:37120
ds_read_b64_tr_b16 a[120:121], v61 offset:36864
ds_read_b64_tr_b16 a[122:123], v61 offset:37120
ds_read_b64_tr_b16 a[192:193], v62 offset:36864
ds_read_b64_tr_b16 a[194:195], v62 offset:37120
s_waitcnt vmcnt(12)
ds_read_b64_tr_b16 a[52:53], v60 offset:0
ds_read_b64_tr_b16 a[54:55], v60 offset:256
ds_read_b64_tr_b16 a[124:125], v61 offset:0
ds_read_b64_tr_b16 a[126:127], v61 offset:256
ds_read_b64_tr_b16 a[196:197], v62 offset:0
ds_read_b64_tr_b16 a[198:199], v62 offset:256
s_waitcnt vmcnt(9)
ds_read_b64_tr_b16 a[56:57], v60 offset:3072
ds_read_b64_tr_b16 a[58:59], v60 offset:3328
ds_read_b64_tr_b16 a[128:129], v61 offset:3072
ds_read_b64_tr_b16 a[130:131], v61 offset:3328
ds_read_b64_tr_b16 a[200:201], v62 offset:3072
ds_read_b64_tr_b16 a[202:203], v62 offset:3328
s_waitcnt vmcnt(6)
ds_read_b64_tr_b16 a[60:61], v60 offset:6144
ds_read_b64_tr_b16 a[62:63], v60 offset:6400
ds_read_b64_tr_b16 a[132:133], v61 offset:6144
ds_read_b64_tr_b16 a[134:135], v61 offset:6400
ds_read_b64_tr_b16 a[204:205], v62 offset:6144
ds_read_b64_tr_b16 a[206:207], v62 offset:6400
s_waitcnt vmcnt(3)
ds_read_b64_tr_b16 a[64:65], v60 offset:9216
ds_read_b64_tr_b16 a[66:67], v60 offset:9472
ds_read_b64_tr_b16 a[136:137], v61 offset:9216
ds_read_b64_tr_b16 a[138:139], v61 offset:9472
ds_read_b64_tr_b16 a[208:209], v62 offset:9216
ds_read_b64_tr_b16 a[210:211], v62 offset:9472
s_waitcnt vmcnt(0)
ds_read_b64_tr_b16 a[68:69], v60 offset:12288
ds_read_b64_tr_b16 a[70:71], v60 offset:12544
ds_read_b64_tr_b16 a[140:141], v61 offset:12288
ds_read_b64_tr_b16 a[142:143], v61 offset:12544
ds_read_b64_tr_b16 a[212:213], v62 offset:12288
ds_read_b64_tr_b16 a[214:215], v62 offset:12544
s_waitcnt lgkmcnt(0)
v_lshlrev_b32 v17, 4, v0
s_lshl_b32 s70, s3, 10
v_add_u32 v1, s70, v17
v_add_u32 v8, 4096, v1
v_add_u32 v9, 7168, v1
v_add_u32 v10, 10240, v1
v_add_u32 v11, 13312, v1
v_add_u32 v12, 20480, v1
v_add_u32 v13, 23552, v1
v_add_u32 v14, 26624, v1
v_add_u32 v15, 29696, v1
v_add_u32 v16, 36864, v1
s_mul_i32 s77, s75, 6
v_and_b32 v2, 31, v0
v_add_u32 v1, s77, v2
v_mul_u32_u24 v1, 128, v1
v_lshrrev_b32 v3, 5, v0
v_mul_u32_u24 v3, 32768, v3
v_add_u32 v1, 23552, v1
v_add_u32 v1, v1, v3
v_mov_b32 v3, 2147483632
s_cmp_eq_u32 s3, 0
s_cselect_b32 s71, 6, 0
v_cmp_gt_u32 vcc, s71, v2
s_nop 1
v_cndmask_b32 v22, v3, v1, vcc
s_mov_b32 s56, 0x3f
s_mul_i32 s70, s74, 128
s_add_u32 s70, s70, 29696
v_mov_b32 v1, s70
s_min_u32 s71, s71, 1
v_cmp_gt_u32 vcc, s71, v0
s_nop 1
v_cndmask_b32 v44, v3, v1, vcc
v_add_u32 v45, 65536, v44
s_getpc_b64 s[96:97]
pc_112:
s_add_u32 s96, s96, L_writers-pc_112
s_addc_u32 s97, s97, 0
v_subrev_u32 v23, 0, v22
v_lshrrev_b32 v23, 7, v23
v_cmp_gt_u32 vcc, 0x200, v23
s_nop 1
v_cndmask_b32 v23, 0, v23, vcc
global_load_ubyte v23, v23, s[96:97]
s_mul_i32 s77, s75, 36864
s_add_u32 s44, s77, 161517568
s_mov_b32 s45, 218144768
s_mov_b32 s52, 1
s_mov_b32 s53, 0
s_add_u32 s46, s77, 180391936
s_mov_b32 s47, 218144768
s_mov_b32 s54, 1
s_mov_b32 s55, 32768
s_mov_b32 s25, 200
s_mov_b32 s20, 294912
s_mov_b32 s21, 294912
s_branch G_sss18
H_wo:
s_mul_i32 s75, s74, 43
s_lshr_b32 s75, s75, 7
s_mul_i32 s76, s75, 3
s_sub_u32 s76, s74, s76
s_mov_b32 s8, s30
s_and_b32 s9, s31, 0xffff
s_mov_b32 s10, 4718592
s_mov_b32 s11, 0x20000
s_mul_i32 s77, s76, 12
s_mul_i32 s78, s3, 3
s_add_u32 s77, s77, s78
s_mul_i32 s78, s75, 589824
v_bfe_u32 v1, v0, 4, 1
v_bfe_u32 v2, v0, 1, 3
v_lshl_add_u32 v1, v1, 3, v2
v_mul_u32_u24 v1, 2304, v1
v_lshrrev_b32 v2, 5, v0
v_lshl_add_u32 v1, v2, 5, v1
v_and_b32 v2, 1, v0
v_lshl_add_u32 v5, v2, 4, v1
s_mul_i32 s79, s75, 36864
s_add_u32 s80, s77, 0
s_lshl_b32 s81, s80, 5
s_add_u32 s48, s81, s78
s_lshl_b32 s81, s80, 6
s_add_u32 s81, s81, s79
v_add_u32 v19, s81, v5
s_add_u32 s80, s77, 1
s_lshl_b32 s81, s80, 5
s_add_u32 s49, s81, s78
s_lshl_b32 s81, s80, 6
s_add_u32 s81, s81, s79
v_add_u32 v20, s81, v5
s_add_u32 s80, s77, 2
s_lshl_b32 s81, s80, 5
s_add_u32 s50, s81, s78
s_lshl_b32 s81, s80, 6
s_add_u32 s81, s81, s79
v_add_u32 v21, s81, v5
v_lshrrev_b32 v1, 5, v0
v_bfe_u32 v2, v0, 3, 1
v_lshl_add_u32 v1, v1, 1, v2
v_bfe_u32 v2, v0, 4, 1
v_bfe_u32 v3, v0, 1, 2
v_lshlrev_b32 v1, 2, v1
v_lshl_add_u32 v1, v2, 4, v1
v_add_u32 v1, v1, v3
v_mul_u32_u24 v1, 1152, v1
v_and_b32 v2, 1, v0
v_lshl_add_u32 v63, v2, 4, v1
s_mul_i32 s70, s3, 40960
v_lshrrev_b32 v1, 5, v0
v_lshlrev_b32 v1, 9, v1
v_bfe_u32 v2, v0, 4, 1
v_lshl_add_u32 v1, v2, 7, v1
v_add_u32 v1, s70, v1
v_and_b32 v2, 15, v0
v_lshl_add_u32 v2, v2, 3, v1
v_add_u32 v60, 0, v2
v_add_u32 v61, 1024, v2
v_add_u32 v62, 2048, v2
s_add_u32 m0, s70, 0
s_add_u32 s71, s48, 0
buffer_load_dwordx4 v63, s[8:11], s71 offen lds
s_add_u32 m0, s70, 1024
s_add_u32 s71, s49, 0
buffer_load_dwordx4 v63, s[8:11], s71 offen lds
s_add_u32 m0, s70, 2048
s_add_u32 s71, s50, 0
buffer_load_dwordx4 v63, s[8:11], s71 offen lds
s_add_u32 m0, s70, 3072
s_add_u32 s71, s48, 36864
buffer_load_dwordx4 v63, s[8:11], s71 offen lds
s_add_u32 m0, s70, 4096
s_add_u32 s71, s49, 36864
buffer_load_dwordx4 v63, s[8:11], s71 offen lds
s_add_u32 m0, s70, 5120
s_add_u32 s71, s50, 36864
buffer_load_dwordx4 v63, s[8:11], s71 offen lds
s_add_u32 m0, s70, 6144
s_add_u32 s71, s48, 73728
buffer_load_dwordx4 v63, s[8:11], s71 offen lds
s_add_u32 m0, s70, 7168
s_add_u32 s71, s49, 73728
buffer_load_dwordx4 v63, s[8:11], s71 offen lds
s_add_u32 m0, s70, 8192
s_add_u32 s71, s50, 73728
buffer_load_dwordx4 v63, s[8:11], s71 offen lds
s_add_u32 m0, s70, 9216
s_add_u32 s71, s48, 110592
buffer_load_dwordx4 v63, s[8:11], s71 offen lds
s_add_u32 m0, s70, 10240
s_add_u32 s71, s49, 110592
buffer_load_dwordx4 v63, s[8:11], s71 offen lds
s_add_u32 m0, s70, 11264
s_add_u32 s71, s50, 110592
buffer_load_dwordx4 v63, s[8:11], s71 offen lds
s_add_u32 m0, s70, 12288
s_add_u32 s71, s48, 147456
buffer_load_dwordx4 v63, s[8:11], s71 offen lds
s_add_u32 m0, s70, 13312
s_add_u32 s71, s49, 147456
buffer_load_dwordx4 v63, s[8:11], s71 offen lds
s_add_u32 m0, s70, 14336
s_add_u32 s71, s50, 147456
buffer_load_dwordx4 v63, s[8:11], s71 offen lds
s_add_u32 m0, s70, 15360
s_add_u32 s71, s48, 184320
buffer_load_dwordx4 v63, s[8:11], s71 offen lds
s_add_u32 m0, s70, 16384
s_add_u32 s71, s49, 184320
buffer_load_dwordx4 v63, s[8:11], s71 offen lds
s_add_u32 m0, s70, 17408
s_add_u32 s71, s50, 184320
buffer_load_dwordx4 v63, s[8:11], s71 offen lds
s_add_u32 m0, s70, 18432
s_add_u32 s71, s48, 221184
buffer_load_dwordx4 v63, s[8:11], s71 offen lds
s_add_u32 m0, s70, 19456
s_add_u32 s71, s49, 221184
buffer_load_dwordx4 v63, s[8:11], s71 offen lds
s_add_u32 m0, s70, 20480
s_add_u32 s71, s50, 221184
buffer_load_dwordx4 v63, s[8:11], s71 offen lds
s_add_u32 m0, s70, 21504
s_add_u32 s71, s48, 258048
buffer_load_dwordx4 v63, s[8:11], s71 offen lds
s_add_u32 m0, s70, 22528
s_add_u32 s71, s49, 258048
buffer_load_dwordx4 v63, s[8:11], s71 offen lds
s_add_u32 m0, s70, 23552
s_add_u32 s71, s50, 258048
buffer_load_dwordx4 v63, s[8:11], s71 offen lds
s_add_u32 m0, s70, 24576
s_add_u32 s71, s48, 294912
buffer_load_dwordx4 v63, s[8:11], s71 offen lds
s_add_u32 m0, s70, 25600
s_add_u32 s71, s49, 294912
buffer_load_dwordx4 v63, s[8:11], s71 offen lds
s_add_u32 m0, s70, 26624
s_add_u32 s71, s50, 294912
buffer_load_dwordx4 v63, s[8:11], s71 offen lds
s_add_u32 m0, s70, 27648
s_add_u32 s71, s48, 331776
buffer_load_dwordx4 v63, s[8:11], s71 offen lds
s_add_u32 m0, s70, 28672
s_add_u32 s71, s49, 331776
buffer_load_dwordx4 v63, s[8:11], s71 offen lds
s_add_u32 m0, s70, 29696
s_add_u32 s71, s50, 331776
buffer_load_dwordx4 v63, s[8:11], s71 offen lds
s_add_u32 m0, s70, 30720
s_add_u32 s71, s48, 368640
buffer_load_dwordx4 v63, s[8:11], s71 offen lds
s_add_u32 m0, s70, 31744
s_add_u32 s71, s49, 368640
buffer_load_dwordx4 v63, s[8:11], s71 offen lds
s_add_u32 m0, s70, 32768
s_add_u32 s71, s50, 368640
buffer_load_dwordx4 v63, s[8:11], s71 offen lds
s_add_u32 m0, s70, 33792
s_add_u32 s71, s48, 405504
buffer_load_dwordx4 v63, s[8:11], s71 offen lds
s_add_u32 m0, s70, 34816
s_add_u32 s71, s49, 405504
buffer_load_dwordx4 v63, s[8:11], s71 offen lds
s_add_u32 m0, s70, 35840
s_add_u32 s71, s50, 405504
buffer_load_dwordx4 v63, s[8:11], s71 offen lds
s_add_u32 m0, s70, 36864
s_add_u32 s71, s48, 442368
buffer_load_dwordx4 v63, s[8:11], s71 offen lds
s_add_u32 m0, s70, 37888
s_add_u32 s71, s49, 442368
buffer_load_dwordx4 v63, s[8:11], s71 offen lds
s_add_u32 m0, s70, 38912
s_add_u32 s71, s50, 442368
buffer_load_dwordx4 v63, s[8:11], s71 offen lds
s_waitcnt vmcnt(36)
ds_read_b64_tr_b16 a[0:1], v60 offset:0
ds_read_b64_tr_b16 a[2:3], v60 offset:256
ds_read_b64_tr_b16 a[72:73], v61 offset:0
ds_read_b64_tr_b16 a[74:75], v61 offset:256
ds_read_b64_tr_b16 a[144:145], v62 offset:0
ds_read_b64_tr_b16 a[146:147], v62 offset:256
s_waitcnt lgkmcnt(0)
s_add_u32 m0, s70, 0
s_add_u32 s71, s48, 479232
buffer_load_dwordx4 v63, s[8:11], s71 offen lds
s_add_u32 m0, s70, 1024
s_add_u32 s71, s49, 479232
buffer_load_dwordx4 v63, s[8:11], s71 offen lds
s_add_u32 m0, s70, 2048
s_add_u32 s71, s50, 479232
buffer_load_dwordx4 v63, s[8:11], s71 offen lds
s_waitcnt vmcnt(36)
ds_read_b64_tr_b16 a[4:5], v60 offset:3072
ds_read_b64_tr_b16 a[6:7], v60 offset:3328
ds_read_b64_tr_b16 a[76:77], v61 offset:3072
ds_read_b64_tr_b16 a[78:79], v61 offset:3328
ds_read_b64_tr_b16 a[148:149], v62 offset:3072
ds_read_b64_tr_b16 a[150:151], v62 offset:3328
s_waitcnt lgkmcnt(0)
s_add_u32 m0, s70, 3072
s_add_u32 s71, s48, 516096
buffer_load_dwordx4 v63, s[8:11], s71 offen lds
s_add_u32 m0, s70, 4096
s_add_u32 s71, s49, 516096
buffer_load_dwordx4 v63, s[8:11], s71 offen lds
s_add_u32 m0, s70, 5120
s_add_u32 s71, s50, 516096
buffer_load_dwordx4 v63, s[8:11], s71 offen lds
s_waitcnt vmcnt(36)
ds_read_b64_tr_b16 a[8:9], v60 offset:6144
ds_read_b64_tr_b16 a[10:11], v60 offset:6400
ds_read_b64_tr_b16 a[80:81], v61 offset:6144
ds_read_b64_tr_b16 a[82:83], v61 offset:6400
ds_read_b64_tr_b16 a[152:153], v62 offset:6144
ds_read_b64_tr_b16 a[154:155], v62 offset:6400
s_waitcnt lgkmcnt(0)
s_add_u32 m0, s70, 6144
s_add_u32 s71, s48, 552960
buffer_load_dwordx4 v63, s[8:11], s71 offen lds
s_add_u32 m0, s70, 7168
s_add_u32 s71, s49, 552960
buffer_load_dwordx4 v63, s[8:11], s71 offen lds
s_add_u32 m0, s70, 8192
s_add_u32 s71, s50, 552960
buffer_load_dwordx4 v63, s[8:11], s71 offen lds
s_waitcnt vmcnt(36)
ds_read_b64_tr_b16 a[12:13], v60 offset:9216
ds_read_b64_tr_b16 a[14:15], v60 offset:9472
ds_read_b64_tr_b16 a[84:85], v61 offset:9216
ds_read_b64_tr_b16 a[86:87], v61 offset:9472
ds_read_b64_tr_b16 a[156:157], v62 offset:9216
ds_read_b64_tr_b16 a[158:159], v62 offset:9472
s_waitcnt vmcnt(33)
ds_read_b64_tr_b16 a[16:17], v60 offset:12288
ds_read_b64_tr_b16 a[18:19], v60 offset:12544
ds_read_b64_tr_b16 a[88:89], v61 offset:12288
ds_read_b64_tr_b16 a[90:91], v61 offset:12544
ds_read_b64_tr_b16 a[160:161], v62 offset:12288
ds_read_b64_tr_b16 a[162:163], v62 offset:12544
s_waitcnt vmcnt(30)
ds_read_b64_tr_b16 a[20:21], v60 offset:15360
ds_read_b64_tr_b16 a[22:23], v60 offset:15616
ds_read_b64_tr_b16 a[92:93], v61 offset:15360
ds_read_b64_tr_b16 a[94:95], v61 offset:15616
ds_read_b64_tr_b16 a[164:165], v62 offset:15360
ds_read_b64_tr_b16 a[166:167], v62 offset:15616
s_waitcnt vmcnt(27)
ds_read_b64_tr_b16 a[24:25], v60 offset:18432
ds_read_b64_tr_b16 a[26:27], v60 offset:18688
ds_read_b64_tr_b16 a[96:97], v61 offset:18432
ds_read_b64_tr_b16 a[98:99], v61 offset:18688
ds_read_b64_tr_b16 a[168:169], v62 offset:18432
ds_read_b64_tr_b16 a[170:171], v62 offset:18688
s_waitcnt vmcnt(24)
ds_read_b64_tr_b16 a[28:29], v60 offset:21504
ds_read_b64_tr_b16 a[30:31], v60 offset:21760
ds_read_b64_tr_b16 a[100:101], v61 offset:21504
ds_read_b64_tr_b16 a[102:103], v61 offset:21760
ds_read_b64_tr_b16 a[172:173], v62 offset:21504
ds_read_b64_tr_b16 a[174:175], v62 offset:21760
s_waitcnt vmcnt(21)
ds_read_b64_tr_b16 a[32:33], v60 offset:24576
ds_read_b64_tr_b16 a[34:35], v60 offset:24832
ds_read_b64_tr_b16 a[104:105], v61 offset:24576
ds_read_b64_tr_b16 a[106:107], v61 offset:24832
ds_read_b64_tr_b16 a[176:177], v62 offset:24576
ds_read_b64_tr_b16 a[178:179], v62 offset:24832
s_waitcnt vmcnt(18)
ds_read_b64_tr_b16 a[36:37], v60 offset:27648
ds_read_b64_tr_b16 a[38:39], v60 offset:27904
ds_read_b64_tr_b16 a[108:109], v61 offset:27648
ds_read_b64_tr_b16 a[110:111], v61 offset:27904
ds_read_b64_tr_b16 a[180:181], v62 offset:27648
ds_read_b64_tr_b16 a[182:183], v62 offset:27904
s_waitcnt vmcnt(15)
ds_read_b64_tr_b16 a[40:41], v60 offset:30720
ds_read_b64_tr_b16 a[42:43], v60 offset:30976
ds_read_b64_tr_b16 a[112:113], v61 offset:30720
ds_read_b64_tr_b16 a[114:115], v61 offset:30976
ds_read_b64_tr_b16 a[184:185], v62 offset:30720
ds_read_b64_tr_b16 a[186:187], v62 offset:30976
s_waitcnt vmcnt(12)
ds_read_b64_tr_b16 a[44:45], v60 offset:33792
ds_read_b64_tr_b16 a[46:47], v60 offset:34048
ds_read_b64_tr_b16 a[116:117], v61 offset:33792
ds_read_b64_tr_b16 a[118:119], v61 offset:34048
ds_read_b64_tr_b16 a[188:189], v62 offset:33792
ds_read_b64_tr_b16 a[190:191], v62 offset:34048
s_waitcnt vmcnt(9)
ds_read_b64_tr_b16 a[48:49], v60 offset:36864
ds_read_b64_tr_b16 a[50:51], v60 offset:37120
ds_read_b64_tr_b16 a[120:121], v61 offset:36864
ds_read_b64_tr_b16 a[122:123], v61 offset:37120
ds_read_b64_tr_b16 a[192:193], v62 offset:36864
ds_read_b64_tr_b16 a[194:195], v62 offset:37120
s_waitcnt vmcnt(6)
ds_read_b64_tr_b16 a[52:53], v60 offset:0
ds_read_b64_tr_b16 a[54:55], v60 offset:256
ds_read_b64_tr_b16 a[124:125], v61 offset:0
ds_read_b64_tr_b16 a[126:127], v61 offset:256
ds_read_b64_tr_b16 a[196:197], v62 offset:0
ds_read_b64_tr_b16 a[198:199], v62 offset:256
s_waitcnt vmcnt(3)
ds_read_b64_tr_b16 a[56:57], v60 offset:3072
ds_read_b64_tr_b16 a[58:59], v60 offset:3328
ds_read_b64_tr_b16 a[128:129], v61 offset:3072
ds_read_b64_tr_b16 a[130:131], v61 offset:3328
ds_read_b64_tr_b16 a[200:201], v62 offset:3072
ds_read_b64_tr_b16 a[202:203], v62 offset:3328
s_waitcnt vmcnt(0)
ds_read_b64_tr_b16 a[60:61], v60 offset:6144
ds_read_b64_tr_b16 a[62:63], v60 offset:6400
ds_read_b64_tr_b16 a[132:133], v61 offset:6144
ds_read_b64_tr_b16 a[134:135], v61 offset:6400
ds_read_b64_tr_b16 a[204:205], v62 offset:6144
ds_read_b64_tr_b16 a[206:207], v62 offset:6400
s_waitcnt lgkmcnt(0)
v_lshlrev_b32 v17, 4, v0
s_lshl_b32 s70, s3, 10
v_add_u32 v1, s70, v17
v_add_u32 v8, 4096, v1
v_add_u32 v9, 7168, v1
v_add_u32 v10, 10240, v1
v_add_u32 v11, 13312, v1
v_add_u32 v12, 20480, v1
v_add_u32 v13, 23552, v1
v_add_u32 v14, 26624, v1
v_add_u32 v15, 29696, v1
s_mul_i32 s77, s75, 4
v_and_b32 v2, 31, v0
v_add_u32 v1, s77, v2
v_mul_u32_u24 v1, 128, v1
v_lshrrev_b32 v3, 5, v0
v_mul_u32_u24 v3, 32768, v3
v_add_u32 v1, 14336, v1
v_add_u32 v1, v1, v3
v_mov_b32 v3, 2147483632
s_cmp_eq_u32 s3, 0
s_cselect_b32 s71, 4, 0
v_cmp_gt_u32 vcc, s71, v2
s_nop 1
v_cndmask_b32 v22, v3, v1, vcc
s_mov_b32 s56, 0xf
s_mul_i32 s70, s74, 128
s_add_u32 s70, s70, 18432
v_mov_b32 v1, s70
s_min_u32 s71, s71, 1
v_cmp_gt_u32 vcc, s71, v0
s_nop 1
v_cndmask_b32 v44, v3, v1, vcc
v_add_u32 v45, 65536, v44
s_getpc_b64 s[96:97]
pc_113:
s_add_u32 s96, s96, L_writers-pc_113
s_addc_u32 s97, s97, 0
v_subrev_u32 v23, 0, v22
v_lshrrev_b32 v23, 7, v23
v_cmp_gt_u32 vcc, 0x200, v23
s_nop 1
v_cndmask_b32 v23, 0, v23, vcc
global_load_ubyte v23, v23, s[96:97]
s_mul_i32 s77, s75, 32768
s_add_u32 s44, s77, 127995904
s_mov_b32 s45, 199270400
s_mov_b32 s52, 1
s_mov_b32 s53, 0
s_add_u32 s46, s77, 144773120
s_mov_b32 s47, 199270400
s_mov_b32 s54, 1
s_mov_b32 s55, 32768
s_mov_b32 s25, 200
s_mov_b32 s20, 262144
s_mov_b32 s21, 294912
s_mov_b32 s8, s42
s_and_b32 s9, s43, 0xffff
s_mov_b32 s10, 0
s_mov_b32 s11, 0x20000
s_mov_b32 s22, 0
s_mul_i32 s48, s3, 8192
s_add_u32 s49, s48, 36864
s_add_u32 s50, s48, 73728
s_add_u32 s51, s48, 110592
s_mov_b32 s57, 0xbfb8aa3b
v_add_u32 v28, 0, v17
v_add_u32 v29, 36864, v17
v_add_u32 v30, 73728, v17
v_add_u32 v31, 110592, v17
v_lshlrev_b32 v1, 2, v0
v_add_u32 v32, 147456, v1
s_lshl_b32 s70, s3, 8
v_add_u32 v18, s70, v32
v_mov_b64 v[224:225], 0
v_mov_b64 v[236:237], 0
v_mov_b64 v[226:227], 0
v_mov_b64 v[238:239], 0
v_mov_b64 v[228:229], 0
v_mov_b64 v[240:241], 0
v_mov_b64 v[230:231], 0
v_mov_b64 v[242:243], 0
s_mov_b32 s12, s40
s_and_b32 s13, s41, 0xffff
s_mov_b32 s14, 256
s_mov_b32 s15, 0x20000
v_lshlrev_b32 v26, 2, v0
v_add_u32 v27, 128, v26
v_cmp_le_u32 vcc, 2, v0
s_nop 1
v_cndmask_b32 v26, v26, v27, vcc
v_mov_b32 v27, 192
v_cmp_eq_u32 vcc, 8, v0
s_nop 1
v_cndmask_b32 v26, v26, v27, vcc
v_mov_b32 v27, 2147483632
v_cmp_lt_u32 vcc, 8, v0
s_nop 1
v_cndmask_b32 v26, v26, v27, vcc
s_mov_b32 s98, 0
wi_loop_119:
buffer_load_dword v27, v26, s[12:15], 0 offen sc1
s_add_u32 s98, s98, 1
s_cmp_gt_u32 s98, 150000
s_cbranch_scc1 wi_bad_121
s_waitcnt vmcnt(0)
v_cmp_eq_u32 vcc, 32, v27
s_nop 0
s_and_b32 s97, vcc_lo, 0x1ff
s_cmp_eq_u32 s97, 0x1ff
s_cbranch_scc1 wi_ok_120
v_cmp_lt_u32 vcc, 32, v27
s_nop 0
s_and_b32 s96, vcc_lo, 0xff
s_cselect_b32 s96, 0x100, 0
s_and_b32 s96, s96, s97
s_cbranch_scc1 wi_over_122
s_sleep 8
s_branch wi_loop_119
wi_bad_121:
s_mov_b32 s98, 512
s_branch L_fail
wi_over_122:
s_mov_b32 s100, 255
wi_ok_120:
v_add_u32 v26, 65536, v22
v_cmp_eq_u32 vcc, s100, v23
s_nop 1
v_cndmask_b32 v22, v22, v26, vcc
s_mov_b32 s90, 0
s_mov_b32 s91, 1879048192
s_mov_b32 s93, 1879048192
v_mov_b32 v34, 2147483632
s_barrier
s_mov_b32 s95, 1
s_cmp_lg_u32 s3, 0
s_cbranch_scc1 sp_ok_124_j
s_mov_b32 s23, 0
sp_loop_123:
buffer_load_dword v33, v22, s[4:7], 0 offen sc1
s_add_u32 s23, s23, 1
s_cmp_gt_u32 s23, 150000
s_cbranch_scc1 sp_bad_125
s_waitcnt vmcnt(0)
sp_loop_123_e:
v_cmp_gt_u32 vcc, s52, v33
v_cmp_gt_u32 s[58:59], s54, v33
s_and_b32 vcc_lo, vcc_lo, s56
s_cbranch_scc0 sp_ok_124
s_cmp_gt_u32 s23, 4
s_cselect_b32 s70, 0, s56
s_cmp_lg_u32 s95, 0
s_cselect_b32 s70, 0, s70
s_or_b32 s59, s59, s70
s_and_b32 s59, s59, s56
s_cbranch_scc0 sp_ok_124
s_sleep 1
s_branch sp_loop_123
sp_bad_125:
s_mov_b32 s98, 1029
s_branch L_fail
sp_ok_124:
ds_write_b32 v18, v33
s_waitcnt lgkmcnt(0)
sp_ok_124_j:
s_barrier
ds_read_b32 v33, v32
s_waitcnt lgkmcnt(0)
v_cmp_gt_u32 vcc, s52, v33
v_cmp_gt_u32 s[58:59], s54, v33
s_and_b32 vcc_lo, vcc_lo, s56
s_cselect_b32 s70, 0, 1
s_and_b32 s59, s59, s56
s_cselect_b32 s71, 0, 1
s_or_b32 s76, s70, s71
s_cselect_b32 s10, 268435456, 0
s_cmp_lg_u32 s70, 0
s_cselect_b64 s[72:73], s[52:53], s[54:55]
s_cselect_b64 s[58:59], s[44:45], s[46:47]
s_mul_i32 s74, s72, s20
s_add_u32 s74, s74, s58
s_mul_i32 s75, s72, s21
s_add_u32 s75, s75, s59
s_andn2_b32 s71, s71, s70
s_add_u32 s52, s52, s70
s_add_u32 s54, s54, s71
s_mov_b32 s77, s76
s_add_u32 m0, s48, 0
s_nop 0
buffer_load_dwordx4 v8, s[4:7], s74 offen offset:0 sc1 lds
buffer_load_dwordx4 v9, s[4:7], s74 offen offset:1024 sc1 lds
buffer_load_dwordx4 v10, s[4:7], s74 offen offset:2048 sc1 lds
buffer_load_dwordx4 v11, s[4:7], s74 offen offset:3072 sc1 lds
s_add_u32 m0, s48, 4096
s_nop 0
buffer_load_dwordx4 v12, s[4:7], s74 offen offset:0 sc1 lds
buffer_load_dwordx4 v13, s[4:7], s74 offen offset:1024 sc1 lds
buffer_load_dwordx4 v14, s[4:7], s74 offen offset:2048 sc1 lds
buffer_load_dwordx4 v15, s[4:7], s74 offen offset:3072 sc1 lds
buffer_store_dword v27, v34, s[4:7], 0 offen
buffer_load_dword v24, v22, s[4:7], 0 offen sc1
v_mov_b32 v27, s90
s_waitcnt vmcnt(8)
s_barrier
buffer_store_dword v27, v45, s[4:7], s91 offen
buffer_store_dword v27, v44, s[4:7], s91 offen sc1
s_mov_b32 s91, 1879048192
ds_read_b128 v[64:67], v28 offset:0
ds_read_b128 v[68:71], v28 offset:8192
ds_read_b128 v[72:75], v28 offset:16384
ds_read_b128 v[76:79], v28 offset:24576
ds_read_b128 v[80:83], v28 offset:1024
ds_read_b128 v[84:87], v28 offset:9216
ds_read_b128 v[88:91], v28 offset:17408
ds_read_b128 v[92:95], v28 offset:25600
s_waitcnt vmcnt(7)
s_barrier
s_branch g_body_114
g_body_114:
s_waitcnt lgkmcnt(4)
v_mfma_f32_16x16x32_bf16 v[208:211], a[0:3], v[64:67], 0
ds_read_b128 v[96:99], v28 offset:2048
v_mfma_f32_16x16x32_bf16 v[212:215], a[0:3], v[68:71], 0
ds_read_b128 v[100:103], v28 offset:10240
v_mfma_f32_16x16x32_bf16 v[216:219], a[72:75], v[64:67], 0
v_mfma_f32_16x16x32_bf16 v[208:211], a[4:7], v[72:75], v[208:211]
ds_read_b128 v[104:107], v28 offset:18432
v_cvt_pk_bf16_f32 v56, v224, v225
v_mfma_f32_16x16x32_bf16 v[212:215], a[4:7], v[76:79], v[212:215]
ds_read_b128 v[108:111], v28 offset:26624
v_cvt_pk_bf16_f32 v57, v226, v227
v_mfma_f32_16x16x32_bf16 v[220:223], a[72:75], v[68:71], 0
v_cvt_pk_bf16_f32 v58, v228, v229
s_waitcnt lgkmcnt(4)
v_mfma_f32_16x16x32_bf16 v[208:211], a[8:11], v[80:83], v[208:211]
ds_read_b128 v[112:115], v28 offset:3072
v_cvt_pk_bf16_f32 v59, v230, v231
v_mfma_f32_16x16x32_bf16 v[212:215], a[8:11], v[84:87], v[212:215]
ds_read_b128 v[116:119], v28 offset:11264
v_permlane16_swap_b32 v56, v58
v_mfma_f32_16x16x32_bf16 v[216:219], a[76:79], v[72:75], v[216:219]
v_permlane16_swap_b32 v57, v59
v_mfma_f32_16x16x32_bf16 v[208:211], a[12:15], v[88:91], v[208:211]
ds_read_b128 v[120:123], v28 offset:19456
v_mfma_f32_16x16x32_bf16 v[212:215], a[12:15], v[92:95], v[212:215]
ds_read_b128 v[124:127], v28 offset:27648
v_mfma_f32_16x16x32_bf16 v[220:223], a[76:79], v[76:79], v[220:223]
s_waitcnt lgkmcnt(4)
v_mfma_f32_16x16x32_bf16 v[208:211], a[16:19], v[96:99], v[208:211]
ds_read_b128 v[128:131], v28 offset:4096
v_mfma_f32_16x16x32_bf16 v[212:215], a[16:19], v[100:103], v[212:215]
ds_read_b128 v[132:135], v28 offset:12288
v_mfma_f32_16x16x32_bf16 v[216:219], a[80:83], v[80:83], v[216:219]
buffer_store_dwordx4 v[56:59], v21, s[4:7], s93 offen sc1
v_mfma_f32_16x16x32_bf16 v[208:211], a[20:23], v[104:107], v[208:211]
ds_read_b128 v[136:139], v28 offset:20480
v_mfma_f32_16x16x32_bf16 v[212:215], a[20:23], v[108:111], v[212:215]
ds_read_b128 v[140:143], v28 offset:28672
v_mfma_f32_16x16x32_bf16 v[220:223], a[80:83], v[84:87], v[220:223]
s_waitcnt vmcnt(5)
s_barrier
s_waitcnt lgkmcnt(4)
v_mfma_f32_16x16x32_bf16 v[208:211], a[24:27], v[112:115], v[208:211]
ds_read_b128 v[144:147], v28 offset:5120
v_mov_b32 v27, s90
v_mfma_f32_16x16x32_bf16 v[212:215], a[24:27], v[116:119], v[212:215]
ds_read_b128 v[148:151], v28 offset:13312
v_mfma_f32_16x16x32_bf16 v[216:219], a[84:87], v[88:91], v[216:219]
v_mfma_f32_16x16x32_bf16 v[208:211], a[28:31], v[120:123], v[208:211]
ds_read_b128 v[152:155], v28 offset:21504
v_mfma_f32_16x16x32_bf16 v[212:215], a[28:31], v[124:127], v[212:215]
ds_read_b128 v[156:159], v28 offset:29696
v_mfma_f32_16x16x32_bf16 v[220:223], a[84:87], v[92:95], v[220:223]
s_waitcnt lgkmcnt(4)
v_mfma_f32_16x16x32_bf16 v[208:211], a[32:35], v[128:131], v[208:211]
ds_read_b128 v[160:163], v28 offset:6144
v_mfma_f32_16x16x32_bf16 v[212:215], a[32:35], v[132:135], v[212:215]
ds_read_b128 v[164:167], v28 offset:14336
v_mfma_f32_16x16x32_bf16 v[216:219], a[88:91], v[96:99], v[216:219]
v_mfma_f32_16x16x32_bf16 v[208:211], a[36:39], v[136:139], v[208:211]
ds_read_b128 v[168:171], v28 offset:22528
s_waitcnt vmcnt(3)
ds_write_b32 v18, v24
v_mfma_f32_16x16x32_bf16 v[212:215], a[36:39], v[140:143], v[212:215]
ds_read_b128 v[172:175], v28 offset:30720
v_mfma_f32_16x16x32_bf16 v[220:223], a[88:91], v[100:103], v[220:223]
s_waitcnt lgkmcnt(5)
v_mfma_f32_16x16x32_bf16 v[208:211], a[40:43], v[144:147], v[208:211]
ds_read_b128 v[176:179], v28 offset:7168
s_waitcnt lgkmcnt(2)
s_barrier
v_mfma_f32_16x16x32_bf16 v[212:215], a[40:43], v[148:151], v[212:215]
ds_read_b128 v[180:183], v28 offset:15360
ds_read_b32 v33, v32
v_mfma_f32_16x16x32_bf16 v[216:219], a[92:95], v[104:107], v[216:219]
v_mfma_f32_16x16x32_bf16 v[208:211], a[44:47], v[152:155], v[208:211]
ds_read_b128 v[184:187], v28 offset:23552
v_mfma_f32_16x16x32_bf16 v[212:215], a[44:47], v[156:159], v[212:215]
ds_read_b128 v[188:191], v28 offset:31744
s_waitcnt lgkmcnt(2)
v_cmp_gt_u32 vcc, s52, v33
v_mfma_f32_16x16x32_bf16 v[220:223], a[92:95], v[108:111], v[220:223]
v_cmp_gt_u32 s[58:59], s54, v33
v_mfma_f32_16x16x32_bf16 v[208:211], a[48:51], v[160:163], v[208:211]
s_and_b32 vcc_lo, vcc_lo, s56
s_cselect_b32 s70, 0, 1
v_mfma_f32_16x16x32_bf16 v[212:215], a[48:51], v[164:167], v[212:215]
s_and_b32 s59, s59, s56
s_cselect_b32 s71, 0, s77
v_mfma_f32_16x16x32_bf16 v[216:219], a[96:99], v[112:115], v[216:219]
s_or_b32 s82, s70, s71
s_cselect_b32 s10, 268435456, 0
v_mfma_f32_16x16x32_bf16 v[208:211], a[52:55], v[168:171], v[208:211]
s_cmp_lg_u32 s70, 0
s_cselect_b64 s[78:79], s[52:53], s[54:55]
s_cselect_b64 s[58:59], s[44:45], s[46:47]
v_mfma_f32_16x16x32_bf16 v[212:215], a[52:55], v[172:175], v[212:215]
s_mul_i32 s80, s78, s20
s_add_u32 s80, s80, s58
v_mfma_f32_16x16x32_bf16 v[220:223], a[96:99], v[116:119], v[220:223]
s_add_u32 m0, s49, 0
s_waitcnt lgkmcnt(0)
v_mfma_f32_16x16x32_bf16 v[208:211], a[56:59], v[176:179], v[208:211]
buffer_load_dwordx4 v8, s[8:11], s80 offen offset:0 sc1 lds
v_mfma_f32_16x16x32_bf16 v[212:215], a[56:59], v[180:183], v[212:215]
s_mul_i32 s81, s78, s21
s_add_u32 s81, s81, s59
s_andn2_b32 s71, s71, s70
v_mfma_f32_16x16x32_bf16 v[216:219], a[100:103], v[120:123], v[216:219]
s_add_u32 s52, s52, s70
s_add_u32 s54, s54, s71
s_mov_b32 s83, s82
v_mfma_f32_16x16x32_bf16 v[208:211], a[60:63], v[184:187], v[208:211]
buffer_load_dwordx4 v9, s[8:11], s80 offen offset:1024 sc1 lds
v_mfma_f32_16x16x32_bf16 v[212:215], a[60:63], v[188:191], v[212:215]
v_mfma_f32_16x16x32_bf16 v[220:223], a[100:103], v[124:127], v[220:223]
v_mfma_f32_16x16x32_bf16 v[216:219], a[104:107], v[128:131], v[216:219]
buffer_load_dwordx4 v10, s[8:11], s80 offen offset:2048 sc1 lds
v_mfma_f32_16x16x32_bf16 v[220:223], a[104:107], v[132:135], v[220:223]
v_mfma_f32_16x16x32_bf16 v[216:219], a[108:111], v[136:139], v[216:219]
v_mfma_f32_16x16x32_bf16 v[220:223], a[108:111], v[140:143], v[220:223]
buffer_load_dwordx4 v11, s[8:11], s80 offen offset:3072 sc1 lds
v_mfma_f32_16x16x32_bf16 v[216:219], a[112:115], v[144:147], v[216:219]
v_cvt_pk_bf16_f32 v48, v208, v209
v_cvt_pk_bf16_f32 v49, v210, v211
v_mfma_f32_16x16x32_bf16 v[220:223], a[112:115], v[148:151], v[220:223]
s_add_u32 m0, s49, 4096
v_cvt_pk_bf16_f32 v50, v212, v213
v_mfma_f32_16x16x32_bf16 v[216:219], a[116:119], v[152:155], v[216:219]
buffer_load_dwordx4 v12, s[8:11], s80 offen offset:0 sc1 lds
v_mfma_f32_16x16x32_bf16 v[220:223], a[116:119], v[156:159], v[220:223]
v_cvt_pk_bf16_f32 v51, v214, v215
v_mfma_f32_16x16x32_bf16 v[216:219], a[120:123], v[160:163], v[216:219]
v_permlane16_swap_b32 v48, v50
v_mfma_f32_16x16x32_bf16 v[220:223], a[120:123], v[164:167], v[220:223]
buffer_load_dwordx4 v13, s[8:11], s80 offen offset:1024 sc1 lds
v_mfma_f32_16x16x32_bf16 v[216:219], a[124:127], v[168:171], v[216:219]
v_permlane16_swap_b32 v49, v51
v_mfma_f32_16x16x32_bf16 v[220:223], a[124:127], v[172:175], v[220:223]
buffer_store_dwordx4 v[48:51], v19, s[4:7], s75 offen sc1
v_mfma_f32_16x16x32_bf16 v[216:219], a[128:131], v[176:179], v[216:219]
buffer_load_dwordx4 v14, s[8:11], s80 offen offset:2048 sc1 lds
v_mfma_f32_16x16x32_bf16 v[220:223], a[128:131], v[180:183], v[220:223]
v_mfma_f32_16x16x32_bf16 v[216:219], a[132:135], v[184:187], v[216:219]
v_mfma_f32_16x16x32_bf16 v[220:223], a[132:135], v[188:191], v[220:223]
buffer_load_dwordx4 v15, s[8:11], s80 offen offset:3072 sc1 lds
v_mfma_f32_16x16x32_bf16 v[224:227], a[144:147], v[64:67], 0
v_mfma_f32_16x16x32_bf16 v[228:231], a[144:147], v[68:71], 0
v_mfma_f32_16x16x32_bf16 v[224:227], a[148:151], v[72:75], v[224:227]
v_mfma_f32_16x16x32_bf16 v[228:231], a[148:151], v[76:79], v[228:231]
v_mfma_f32_16x16x32_bf16 v[224:227], a[152:155], v[80:83], v[224:227]
v_mfma_f32_16x16x32_bf16 v[228:231], a[152:155], v[84:87], v[228:231]
v_cvt_pk_bf16_f32 v52, v216, v217
v_cvt_pk_bf16_f32 v53, v218, v219
v_mfma_f32_16x16x32_bf16 v[224:227], a[156:159], v[88:91], v[224:227]
v_cvt_pk_bf16_f32 v54, v220, v221
v_cvt_pk_bf16_f32 v55, v222, v223
v_mfma_f32_16x16x32_bf16 v[228:231], a[156:159], v[92:95], v[228:231]
v_permlane16_swap_b32 v52, v54
v_mfma_f32_16x16x32_bf16 v[224:227], a[160:163], v[96:99], v[224:227]
v_permlane16_swap_b32 v53, v55
v_mfma_f32_16x16x32_bf16 v[228:231], a[160:163], v[100:103], v[228:231]
buffer_store_dwordx4 v[52:55], v20, s[4:7], s75 offen sc1
v_mfma_f32_16x16x32_bf16 v[224:227], a[164:167], v[104:107], v[224:227]
v_mfma_f32_16x16x32_bf16 v[228:231], a[164:167], v[108:111], v[228:231]
v_mfma_f32_16x16x32_bf16 v[224:227], a[168:171], v[112:115], v[224:227]
v_mfma_f32_16x16x32_bf16 v[228:231], a[168:171], v[116:119], v[228:231]
v_mfma_f32_16x16x32_bf16 v[224:227], a[172:175], v[120:123], v[224:227]
v_mfma_f32_16x16x32_bf16 v[228:231], a[172:175], v[124:127], v[228:231]
v_mfma_f32_16x16x32_bf16 v[224:227], a[176:179], v[128:131], v[224:227]
v_mfma_f32_16x16x32_bf16 v[228:231], a[176:179], v[132:135], v[228:231]
v_mfma_f32_16x16x32_bf16 v[224:227], a[180:183], v[136:139], v[224:227]
buffer_load_dword v24, v22, s[4:7], 0 offen sc1
v_mfma_f32_16x16x32_bf16 v[228:231], a[180:183], v[140:143], v[228:231]
v_mfma_f32_16x16x32_bf16 v[224:227], a[184:187], v[144:147], v[224:227]
s_waitcnt vmcnt(9)
s_barrier
v_mfma_f32_16x16x32_bf16 v[228:231], a[184:187], v[148:151], v[228:231]
buffer_store_dword v27, v45, s[4:7], s91 offen
v_mfma_f32_16x16x32_bf16 v[224:227], a[188:191], v[152:155], v[224:227]
buffer_store_dword v27, v44, s[4:7], s91 offen sc1
s_cmp_eq_u32 s82, 0
s_cbranch_scc1 g_slow_126
v_mfma_f32_16x16x32_bf16 v[228:231], a[188:191], v[156:159], v[228:231]
ds_read_b128 v[64:67], v29 offset:0
v_mfma_f32_16x16x32_bf16 v[224:227], a[192:195], v[160:163], v[224:227]
ds_read_b128 v[68:71], v29 offset:8192
v_mfma_f32_16x16x32_bf16 v[228:231], a[192:195], v[164:167], v[228:231]
ds_read_b128 v[72:75], v29 offset:16384
v_mfma_f32_16x16x32_bf16 v[224:227], a[196:199], v[168:171], v[224:227]
ds_read_b128 v[76:79], v29 offset:24576
v_mfma_f32_16x16x32_bf16 v[228:231], a[196:199], v[172:175], v[228:231]
ds_read_b128 v[80:83], v29 offset:1024
v_mfma_f32_16x16x32_bf16 v[224:227], a[200:203], v[176:179], v[224:227]
ds_read_b128 v[84:87], v29 offset:9216
v_mfma_f32_16x16x32_bf16 v[228:231], a[200:203], v[180:183], v[228:231]
ds_read_b128 v[88:91], v29 offset:17408
v_mfma_f32_16x16x32_bf16 v[224:227], a[204:207], v[184:187], v[224:227]
ds_read_b128 v[92:95], v29 offset:25600
v_mfma_f32_16x16x32_bf16 v[228:231], a[204:207], v[188:191], v[228:231]
s_waitcnt vmcnt(8)
s_barrier
g_body_115:
s_waitcnt lgkmcnt(4)
v_mfma_f32_16x16x32_bf16 v[208:211], a[0:3], v[64:67], 0
ds_read_b128 v[96:99], v29 offset:2048
v_mfma_f32_16x16x32_bf16 v[212:215], a[0:3], v[68:71], 0
ds_read_b128 v[100:103], v29 offset:10240
v_mfma_f32_16x16x32_bf16 v[216:219], a[72:75], v[64:67], 0
v_mfma_f32_16x16x32_bf16 v[208:211], a[4:7], v[72:75], v[208:211]
ds_read_b128 v[104:107], v29 offset:18432
v_cvt_pk_bf16_f32 v56, v224, v225
v_mfma_f32_16x16x32_bf16 v[212:215], a[4:7], v[76:79], v[212:215]
ds_read_b128 v[108:111], v29 offset:26624
v_cvt_pk_bf16_f32 v57, v226, v227
v_mfma_f32_16x16x32_bf16 v[220:223], a[72:75], v[68:71], 0
v_cvt_pk_bf16_f32 v58, v228, v229
s_waitcnt lgkmcnt(4)
v_mfma_f32_16x16x32_bf16 v[208:211], a[8:11], v[80:83], v[208:211]
ds_read_b128 v[112:115], v29 offset:3072
v_cvt_pk_bf16_f32 v59, v230, v231
v_mfma_f32_16x16x32_bf16 v[212:215], a[8:11], v[84:87], v[212:215]
ds_read_b128 v[116:119], v29 offset:11264
v_permlane16_swap_b32 v56, v58
v_mfma_f32_16x16x32_bf16 v[216:219], a[76:79], v[72:75], v[216:219]
v_permlane16_swap_b32 v57, v59
v_mfma_f32_16x16x32_bf16 v[208:211], a[12:15], v[88:91], v[208:211]
ds_read_b128 v[120:123], v29 offset:19456
v_mfma_f32_16x16x32_bf16 v[212:215], a[12:15], v[92:95], v[212:215]
ds_read_b128 v[124:127], v29 offset:27648
v_mfma_f32_16x16x32_bf16 v[220:223], a[76:79], v[76:79], v[220:223]
s_waitcnt lgkmcnt(4)
v_mfma_f32_16x16x32_bf16 v[208:211], a[16:19], v[96:99], v[208:211]
ds_read_b128 v[128:131], v29 offset:4096
v_mfma_f32_16x16x32_bf16 v[212:215], a[16:19], v[100:103], v[212:215]
ds_read_b128 v[132:135], v29 offset:12288
v_mfma_f32_16x16x32_bf16 v[216:219], a[80:83], v[80:83], v[216:219]
buffer_store_dwordx4 v[56:59], v21, s[4:7], s75 offen sc1
v_mfma_f32_16x16x32_bf16 v[208:211], a[20:23], v[104:107], v[208:211]
ds_read_b128 v[136:139], v29 offset:20480
v_mfma_f32_16x16x32_bf16 v[212:215], a[20:23], v[108:111], v[212:215]
ds_read_b128 v[140:143], v29 offset:28672
v_mfma_f32_16x16x32_bf16 v[220:223], a[80:83], v[84:87], v[220:223]
s_waitcnt vmcnt(5)
s_barrier
s_waitcnt lgkmcnt(4)
v_mfma_f32_16x16x32_bf16 v[208:211], a[24:27], v[112:115], v[208:211]
ds_read_b128 v[144:147], v29 offset:5120
v_mov_b32 v27, s72
v_mfma_f32_16x16x32_bf16 v[212:215], a[24:27], v[116:119], v[212:215]
ds_read_b128 v[148:151], v29 offset:13312
v_mfma_f32_16x16x32_bf16 v[216:219], a[84:87], v[88:91], v[216:219]
v_mfma_f32_16x16x32_bf16 v[208:211], a[28:31], v[120:123], v[208:211]
ds_read_b128 v[152:155], v29 offset:21504
v_mfma_f32_16x16x32_bf16 v[212:215], a[28:31], v[124:127], v[212:215]
ds_read_b128 v[156:159], v29 offset:29696
v_mfma_f32_16x16x32_bf16 v[220:223], a[84:87], v[92:95], v[220:223]
s_waitcnt lgkmcnt(4)
v_mfma_f32_16x16x32_bf16 v[208:211], a[32:35], v[128:131], v[208:211]
ds_read_b128 v[160:163], v29 offset:6144
v_mfma_f32_16x16x32_bf16 v[212:215], a[32:35], v[132:135], v[212:215]
ds_read_b128 v[164:167], v29 offset:14336
v_mfma_f32_16x16x32_bf16 v[216:219], a[88:91], v[96:99], v[216:219]
v_mfma_f32_16x16x32_bf16 v[208:211], a[36:39], v[136:139], v[208:211]
ds_read_b128 v[168:171], v29 offset:22528
s_waitcnt vmcnt(3)
ds_write_b32 v18, v24
v_mfma_f32_16x16x32_bf16 v[212:215], a[36:39], v[140:143], v[212:215]
ds_read_b128 v[172:175], v29 offset:30720
v_mfma_f32_16x16x32_bf16 v[220:223], a[88:91], v[100:103], v[220:223]
s_waitcnt lgkmcnt(5)
v_mfma_f32_16x16x32_bf16 v[208:211], a[40:43], v[144:147], v[208:211]
ds_read_b128 v[176:179], v29 offset:7168
s_waitcnt lgkmcnt(2)
s_barrier
v_mfma_f32_16x16x32_bf16 v[212:215], a[40:43], v[148:151], v[212:215]
ds_read_b128 v[180:183], v29 offset:15360
ds_read_b32 v33, v32
v_mfma_f32_16x16x32_bf16 v[216:219], a[92:95], v[104:107], v[216:219]
v_mfma_f32_16x16x32_bf16 v[208:211], a[44:47], v[152:155], v[208:211]
ds_read_b128 v[184:187], v29 offset:23552
v_mfma_f32_16x16x32_bf16 v[212:215], a[44:47], v[156:159], v[212:215]
ds_read_b128 v[188:191], v29 offset:31744
s_waitcnt lgkmcnt(2)
v_cmp_gt_u32 vcc, s52, v33
v_mfma_f32_16x16x32_bf16 v[220:223], a[92:95], v[108:111], v[220:223]
v_cmp_gt_u32 s[58:59], s54, v33
v_mfma_f32_16x16x32_bf16 v[208:211], a[48:51], v[160:163], v[208:211]
s_and_b32 vcc_lo, vcc_lo, s56
s_cselect_b32 s70, 0, 1
v_mfma_f32_16x16x32_bf16 v[212:215], a[48:51], v[164:167], v[212:215]
s_and_b32 s59, s59, s56
s_cselect_b32 s71, 0, s83
v_mfma_f32_16x16x32_bf16 v[216:219], a[96:99], v[112:115], v[216:219]
s_or_b32 s88, s70, s71
s_cselect_b32 s10, 268435456, 0
v_mfma_f32_16x16x32_bf16 v[208:211], a[52:55], v[168:171], v[208:211]
s_cmp_lg_u32 s70, 0
s_cselect_b64 s[84:85], s[52:53], s[54:55]
s_cselect_b64 s[58:59], s[44:45], s[46:47]
v_mfma_f32_16x16x32_bf16 v[212:215], a[52:55], v[172:175], v[212:215]
s_mul_i32 s86, s84, s20
s_add_u32 s86, s86, s58
v_mfma_f32_16x16x32_bf16 v[220:223], a[96:99], v[116:119], v[220:223]
s_add_u32 m0, s50, 0
s_waitcnt lgkmcnt(0)
v_mfma_f32_16x16x32_bf16 v[208:211], a[56:59], v[176:179], v[208:211]
buffer_load_dwordx4 v8, s[8:11], s86 offen offset:0 sc1 lds
v_mfma_f32_16x16x32_bf16 v[212:215], a[56:59], v[180:183], v[212:215]
s_mul_i32 s87, s84, s21
s_add_u32 s87, s87, s59
s_andn2_b32 s71, s71, s70
v_mfma_f32_16x16x32_bf16 v[216:219], a[100:103], v[120:123], v[216:219]
s_add_u32 s52, s52, s70
s_add_u32 s54, s54, s71
s_mov_b32 s89, s88
v_mfma_f32_16x16x32_bf16 v[208:211], a[60:63], v[184:187], v[208:211]
buffer_load_dwordx4 v9, s[8:11], s86 offen offset:1024 sc1 lds
v_mfma_f32_16x16x32_bf16 v[212:215], a[60:63], v[188:191], v[212:215]
v_mfma_f32_16x16x32_bf16 v[220:223], a[100:103], v[124:127], v[220:223]
v_mfma_f32_16x16x32_bf16 v[216:219], a[104:107], v[128:131], v[216:219]
buffer_load_dwordx4 v10, s[8:11], s86 offen offset:2048 sc1 lds
v_mfma_f32_16x16x32_bf16 v[220:223], a[104:107], v[132:135], v[220:223]
v_mfma_f32_16x16x32_bf16 v[216:219], a[108:111], v[136:139], v[216:219]
v_mfma_f32_16x16x32_bf16 v[220:223], a[108:111], v[140:143], v[220:223]
buffer_load_dwordx4 v11, s[8:11], s86 offen offset:3072 sc1 lds
v_mfma_f32_16x16x32_bf16 v[216:219], a[112:115], v[144:147], v[216:219]
v_cvt_pk_bf16_f32 v48, v208, v209
v_cvt_pk_bf16_f32 v49, v210, v211
v_mfma_f32_16x16x32_bf16 v[220:223], a[112:115], v[148:151], v[220:223]
s_add_u32 m0, s50, 4096
v_cvt_pk_bf16_f32 v50, v212, v213
v_mfma_f32_16x16x32_bf16 v[216:219], a[116:119], v[152:155], v[216:219]
buffer_load_dwordx4 v12, s[8:11], s86 offen offset:0 sc1 lds
v_mfma_f32_16x16x32_bf16 v[220:223], a[116:119], v[156:159], v[220:223]
v_cvt_pk_bf16_f32 v51, v214, v215
v_mfma_f32_16x16x32_bf16 v[216:219], a[120:123], v[160:163], v[216:219]
v_permlane16_swap_b32 v48, v50
v_mfma_f32_16x16x32_bf16 v[220:223], a[120:123], v[164:167], v[220:223]
buffer_load_dwordx4 v13, s[8:11], s86 offen offset:1024 sc1 lds
v_mfma_f32_16x16x32_bf16 v[216:219], a[124:127], v[168:171], v[216:219]
v_permlane16_swap_b32 v49, v51
v_mfma_f32_16x16x32_bf16 v[220:223], a[124:127], v[172:175], v[220:223]
buffer_store_dwordx4 v[48:51], v19, s[4:7], s81 offen sc1
v_mfma_f32_16x16x32_bf16 v[216:219], a[128:131], v[176:179], v[216:219]
buffer_load_dwordx4 v14, s[8:11], s86 offen offset:2048 sc1 lds
v_mfma_f32_16x16x32_bf16 v[220:223], a[128:131], v[180:183], v[220:223]
v_mfma_f32_16x16x32_bf16 v[216:219], a[132:135], v[184:187], v[216:219]
v_mfma_f32_16x16x32_bf16 v[220:223], a[132:135], v[188:191], v[220:223]
buffer_load_dwordx4 v15, s[8:11], s86 offen offset:3072 sc1 lds
v_mfma_f32_16x16x32_bf16 v[224:227], a[144:147], v[64:67], 0
v_mfma_f32_16x16x32_bf16 v[228:231], a[144:147], v[68:71], 0
v_mfma_f32_16x16x32_bf16 v[224:227], a[148:151], v[72:75], v[224:227]
v_mfma_f32_16x16x32_bf16 v[228:231], a[148:151], v[76:79], v[228:231]
v_mfma_f32_16x16x32_bf16 v[224:227], a[152:155], v[80:83], v[224:227]
v_mfma_f32_16x16x32_bf16 v[228:231], a[152:155], v[84:87], v[228:231]
v_cvt_pk_bf16_f32 v52, v216, v217
v_cvt_pk_bf16_f32 v53, v218, v219
v_mfma_f32_16x16x32_bf16 v[224:227], a[156:159], v[88:91], v[224:227]
v_cvt_pk_bf16_f32 v54, v220, v221
v_cvt_pk_bf16_f32 v55, v222, v223
v_mfma_f32_16x16x32_bf16 v[228:231], a[156:159], v[92:95], v[228:231]
v_permlane16_swap_b32 v52, v54
v_mfma_f32_16x16x32_bf16 v[224:227], a[160:163], v[96:99], v[224:227]
v_permlane16_swap_b32 v53, v55
v_mfma_f32_16x16x32_bf16 v[228:231], a[160:163], v[100:103], v[228:231]
buffer_store_dwordx4 v[52:55], v20, s[4:7], s81 offen sc1
v_mfma_f32_16x16x32_bf16 v[224:227], a[164:167], v[104:107], v[224:227]
v_mfma_f32_16x16x32_bf16 v[228:231], a[164:167], v[108:111], v[228:231]
v_mfma_f32_16x16x32_bf16 v[224:227], a[168:171], v[112:115], v[224:227]
v_mfma_f32_16x16x32_bf16 v[228:231], a[168:171], v[116:119], v[228:231]
v_mfma_f32_16x16x32_bf16 v[224:227], a[172:175], v[120:123], v[224:227]
v_mfma_f32_16x16x32_bf16 v[228:231], a[172:175], v[124:127], v[228:231]
v_mfma_f32_16x16x32_bf16 v[224:227], a[176:179], v[128:131], v[224:227]
v_mfma_f32_16x16x32_bf16 v[228:231], a[176:179], v[132:135], v[228:231]
v_mfma_f32_16x16x32_bf16 v[224:227], a[180:183], v[136:139], v[224:227]
buffer_load_dword v24, v22, s[4:7], 0 offen sc1
v_mfma_f32_16x16x32_bf16 v[228:231], a[180:183], v[140:143], v[228:231]
v_mfma_f32_16x16x32_bf16 v[224:227], a[184:187], v[144:147], v[224:227]
s_waitcnt vmcnt(9)
s_barrier
v_mfma_f32_16x16x32_bf16 v[228:231], a[184:187], v[148:151], v[228:231]
buffer_store_dword v27, v45, s[4:7], s73 offen
v_mfma_f32_16x16x32_bf16 v[224:227], a[188:191], v[152:155], v[224:227]
buffer_store_dword v27, v44, s[4:7], s73 offen sc1
s_cmp_eq_u32 s88, 0
s_cbranch_scc1 g_slow_127
v_mfma_f32_16x16x32_bf16 v[228:231], a[188:191], v[156:159], v[228:231]
ds_read_b128 v[64:67], v30 offset:0
v_mfma_f32_16x16x32_bf16 v[224:227], a[192:195], v[160:163], v[224:227]
ds_read_b128 v[68:71], v30 offset:8192
v_mfma_f32_16x16x32_bf16 v[228:231], a[192:195], v[164:167], v[228:231]
ds_read_b128 v[72:75], v30 offset:16384
v_mfma_f32_16x16x32_bf16 v[224:227], a[196:199], v[168:171], v[224:227]
ds_read_b128 v[76:79], v30 offset:24576
v_mfma_f32_16x16x32_bf16 v[228:231], a[196:199], v[172:175], v[228:231]
ds_read_b128 v[80:83], v30 offset:1024
v_mfma_f32_16x16x32_bf16 v[224:227], a[200:203], v[176:179], v[224:227]
ds_read_b128 v[84:87], v30 offset:9216
v_mfma_f32_16x16x32_bf16 v[228:231], a[200:203], v[180:183], v[228:231]
ds_read_b128 v[88:91], v30 offset:17408
v_mfma_f32_16x16x32_bf16 v[224:227], a[204:207], v[184:187], v[224:227]
ds_read_b128 v[92:95], v30 offset:25600
v_mfma_f32_16x16x32_bf16 v[228:231], a[204:207], v[188:191], v[228:231]
s_waitcnt vmcnt(8)
s_barrier
g_body_116:
s_waitcnt lgkmcnt(4)
v_mfma_f32_16x16x32_bf16 v[208:211], a[0:3], v[64:67], 0
ds_read_b128 v[96:99], v30 offset:2048
v_mfma_f32_16x16x32_bf16 v[212:215], a[0:3], v[68:71], 0
ds_read_b128 v[100:103], v30 offset:10240
v_mfma_f32_16x16x32_bf16 v[216:219], a[72:75], v[64:67], 0
v_mfma_f32_16x16x32_bf16 v[208:211], a[4:7], v[72:75], v[208:211]
ds_read_b128 v[104:107], v30 offset:18432
v_cvt_pk_bf16_f32 v56, v224, v225
v_mfma_f32_16x16x32_bf16 v[212:215], a[4:7], v[76:79], v[212:215]
ds_read_b128 v[108:111], v30 offset:26624
v_cvt_pk_bf16_f32 v57, v226, v227
v_mfma_f32_16x16x32_bf16 v[220:223], a[72:75], v[68:71], 0
v_cvt_pk_bf16_f32 v58, v228, v229
s_waitcnt lgkmcnt(4)
v_mfma_f32_16x16x32_bf16 v[208:211], a[8:11], v[80:83], v[208:211]
ds_read_b128 v[112:115], v30 offset:3072
v_cvt_pk_bf16_f32 v59, v230, v231
v_mfma_f32_16x16x32_bf16 v[212:215], a[8:11], v[84:87], v[212:215]
ds_read_b128 v[116:119], v30 offset:11264
v_permlane16_swap_b32 v56, v58
v_mfma_f32_16x16x32_bf16 v[216:219], a[76:79], v[72:75], v[216:219]
v_permlane16_swap_b32 v57, v59
v_mfma_f32_16x16x32_bf16 v[208:211], a[12:15], v[88:91], v[208:211]
ds_read_b128 v[120:123], v30 offset:19456
v_mfma_f32_16x16x32_bf16 v[212:215], a[12:15], v[92:95], v[212:215]
ds_read_b128 v[124:127], v30 offset:27648
v_mfma_f32_16x16x32_bf16 v[220:223], a[76:79], v[76:79], v[220:223]
s_waitcnt lgkmcnt(4)
v_mfma_f32_16x16x32_bf16 v[208:211], a[16:19], v[96:99], v[208:211]
ds_read_b128 v[128:131], v30 offset:4096
v_mfma_f32_16x16x32_bf16 v[212:215], a[16:19], v[100:103], v[212:215]
ds_read_b128 v[132:135], v30 offset:12288
v_mfma_f32_16x16x32_bf16 v[216:219], a[80:83], v[80:83], v[216:219]
buffer_store_dwordx4 v[56:59], v21, s[4:7], s81 offen sc1
v_mfma_f32_16x16x32_bf16 v[208:211], a[20:23], v[104:107], v[208:211]
ds_read_b128 v[136:139], v30 offset:20480
v_mfma_f32_16x16x32_bf16 v[212:215], a[20:23], v[108:111], v[212:215]
ds_read_b128 v[140:143], v30 offset:28672
v_mfma_f32_16x16x32_bf16 v[220:223], a[80:83], v[84:87], v[220:223]
s_waitcnt vmcnt(5)
s_barrier
s_waitcnt lgkmcnt(4)
v_mfma_f32_16x16x32_bf16 v[208:211], a[24:27], v[112:115], v[208:211]
ds_read_b128 v[144:147], v30 offset:5120
v_mov_b32 v27, s78
v_mfma_f32_16x16x32_bf16 v[212:215], a[24:27], v[116:119], v[212:215]
ds_read_b128 v[148:151], v30 offset:13312
v_mfma_f32_16x16x32_bf16 v[216:219], a[84:87], v[88:91], v[216:219]
v_mfma_f32_16x16x32_bf16 v[208:211], a[28:31], v[120:123], v[208:211]
ds_read_b128 v[152:155], v30 offset:21504
v_mfma_f32_16x16x32_bf16 v[212:215], a[28:31], v[124:127], v[212:215]
ds_read_b128 v[156:159], v30 offset:29696
v_mfma_f32_16x16x32_bf16 v[220:223], a[84:87], v[92:95], v[220:223]
s_waitcnt lgkmcnt(4)
v_mfma_f32_16x16x32_bf16 v[208:211], a[32:35], v[128:131], v[208:211]
ds_read_b128 v[160:163], v30 offset:6144
v_mfma_f32_16x16x32_bf16 v[212:215], a[32:35], v[132:135], v[212:215]
ds_read_b128 v[164:167], v30 offset:14336
v_mfma_f32_16x16x32_bf16 v[216:219], a[88:91], v[96:99], v[216:219]
v_mfma_f32_16x16x32_bf16 v[208:211], a[36:39], v[136:139], v[208:211]
ds_read_b128 v[168:171], v30 offset:22528
s_waitcnt vmcnt(3)
ds_write_b32 v18, v24
v_mfma_f32_16x16x32_bf16 v[212:215], a[36:39], v[140:143], v[212:215]
ds_read_b128 v[172:175], v30 offset:30720
v_mfma_f32_16x16x32_bf16 v[220:223], a[88:91], v[100:103], v[220:223]
s_waitcnt lgkmcnt(5)
v_mfma_f32_16x16x32_bf16 v[208:211], a[40:43], v[144:147], v[208:211]
ds_read_b128 v[176:179], v30 offset:7168
s_waitcnt lgkmcnt(2)
s_barrier
v_mfma_f32_16x16x32_bf16 v[212:215], a[40:43], v[148:151], v[212:215]
ds_read_b128 v[180:183], v30 offset:15360
ds_read_b32 v33, v32
v_mfma_f32_16x16x32_bf16 v[216:219], a[92:95], v[104:107], v[216:219]
v_mfma_f32_16x16x32_bf16 v[208:211], a[44:47], v[152:155], v[208:211]
ds_read_b128 v[184:187], v30 offset:23552
v_mfma_f32_16x16x32_bf16 v[212:215], a[44:47], v[156:159], v[212:215]
ds_read_b128 v[188:191], v30 offset:31744
s_waitcnt lgkmcnt(2)
v_cmp_gt_u32 vcc, s52, v33
v_mfma_f32_16x16x32_bf16 v[220:223], a[92:95], v[108:111], v[220:223]
v_cmp_gt_u32 s[58:59], s54, v33
v_mfma_f32_16x16x32_bf16 v[208:211], a[48:51], v[160:163], v[208:211]
s_and_b32 vcc_lo, vcc_lo, s56
s_cselect_b32 s70, 0, 1
v_mfma_f32_16x16x32_bf16 v[212:215], a[48:51], v[164:167], v[212:215]
s_and_b32 s59, s59, s56
s_cselect_b32 s71, 0, s89
v_mfma_f32_16x16x32_bf16 v[216:219], a[96:99], v[112:115], v[216:219]
s_or_b32 s94, s70, s71
s_cselect_b32 s10, 268435456, 0
v_mfma_f32_16x16x32_bf16 v[208:211], a[52:55], v[168:171], v[208:211]
s_cmp_lg_u32 s70, 0
s_cselect_b64 s[90:91], s[52:53], s[54:55]
s_cselect_b64 s[58:59], s[44:45], s[46:47]
v_mfma_f32_16x16x32_bf16 v[212:215], a[52:55], v[172:175], v[212:215]
s_mul_i32 s92, s90, s20
s_add_u32 s92, s92, s58
v_mfma_f32_16x16x32_bf16 v[220:223], a[96:99], v[116:119], v[220:223]
s_add_u32 m0, s51, 0
s_waitcnt lgkmcnt(0)
v_mfma_f32_16x16x32_bf16 v[208:211], a[56:59], v[176:179], v[208:211]
buffer_load_dwordx4 v8, s[8:11], s92 offen offset:0 sc1 lds
v_mfma_f32_16x16x32_bf16 v[212:215], a[56:59], v[180:183], v[212:215]
s_mul_i32 s93, s90, s21
s_add_u32 s93, s93, s59
s_andn2_b32 s71, s71, s70
v_mfma_f32_16x16x32_bf16 v[216:219], a[100:103], v[120:123], v[216:219]
s_add_u32 s52, s52, s70
s_add_u32 s54, s54, s71
s_mov_b32 s95, s94
v_mfma_f32_16x16x32_bf16 v[208:211], a[60:63], v[184:187], v[208:211]
buffer_load_dwordx4 v9, s[8:11], s92 offen offset:1024 sc1 lds
v_mfma_f32_16x16x32_bf16 v[212:215], a[60:63], v[188:191], v[212:215]
v_mfma_f32_16x16x32_bf16 v[220:223], a[100:103], v[124:127], v[220:223]
v_mfma_f32_16x16x32_bf16 v[216:219], a[104:107], v[128:131], v[216:219]
buffer_load_dwordx4 v10, s[8:11], s92 offen offset:2048 sc1 lds
v_mfma_f32_16x16x32_bf16 v[220:223], a[104:107], v[132:135], v[220:223]
v_mfma_f32_16x16x32_bf16 v[216:219], a[108:111], v[136:139], v[216:219]
v_mfma_f32_16x16x32_bf16 v[220:223], a[108:111], v[140:143], v[220:223]
buffer_load_dwordx4 v11, s[8:11], s92 offen offset:3072 sc1 lds
v_mfma_f32_16x16x32_bf16 v[216:219], a[112:115], v[144:147], v[216:219]
v_cvt_pk_bf16_f32 v48, v208, v209
v_cvt_pk_bf16_f32 v49, v210, v211
v_mfma_f32_16x16x32_bf16 v[220:223], a[112:115], v[148:151], v[220:223]
s_add_u32 m0, s51, 4096
v_cvt_pk_bf16_f32 v50, v212, v213
v_mfma_f32_16x16x32_bf16 v[216:219], a[116:119], v[152:155], v[216:219]
buffer_load_dwordx4 v12, s[8:11], s92 offen offset:0 sc1 lds
v_mfma_f32_16x16x32_bf16 v[220:223], a[116:119], v[156:159], v[220:223]
v_cvt_pk_bf16_f32 v51, v214, v215
v_mfma_f32_16x16x32_bf16 v[216:219], a[120:123], v[160:163], v[216:219]
v_permlane16_swap_b32 v48, v50
v_mfma_f32_16x16x32_bf16 v[220:223], a[120:123], v[164:167], v[220:223]
buffer_load_dwordx4 v13, s[8:11], s92 offen offset:1024 sc1 lds
v_mfma_f32_16x16x32_bf16 v[216:219], a[124:127], v[168:171], v[216:219]
v_permlane16_swap_b32 v49, v51
v_mfma_f32_16x16x32_bf16 v[220:223], a[124:127], v[172:175], v[220:223]
buffer_store_dwordx4 v[48:51], v19, s[4:7], s87 offen sc1
v_mfma_f32_16x16x32_bf16 v[216:219], a[128:131], v[176:179], v[216:219]
buffer_load_dwordx4 v14, s[8:11], s92 offen offset:2048 sc1 lds
v_mfma_f32_16x16x32_bf16 v[220:223], a[128:131], v[180:183], v[220:223]
v_mfma_f32_16x16x32_bf16 v[216:219], a[132:135], v[184:187], v[216:219]
v_mfma_f32_16x16x32_bf16 v[220:223], a[132:135], v[188:191], v[220:223]
buffer_load_dwordx4 v15, s[8:11], s92 offen offset:3072 sc1 lds
v_mfma_f32_16x16x32_bf16 v[224:227], a[144:147], v[64:67], 0
v_mfma_f32_16x16x32_bf16 v[228:231], a[144:147], v[68:71], 0
v_mfma_f32_16x16x32_bf16 v[224:227], a[148:151], v[72:75], v[224:227]
v_mfma_f32_16x16x32_bf16 v[228:231], a[148:151], v[76:79], v[228:231]
v_mfma_f32_16x16x32_bf16 v[224:227], a[152:155], v[80:83], v[224:227]
v_mfma_f32_16x16x32_bf16 v[228:231], a[152:155], v[84:87], v[228:231]
v_cvt_pk_bf16_f32 v52, v216, v217
v_cvt_pk_bf16_f32 v53, v218, v219
v_mfma_f32_16x16x32_bf16 v[224:227], a[156:159], v[88:91], v[224:227]
v_cvt_pk_bf16_f32 v54, v220, v221
v_cvt_pk_bf16_f32 v55, v222, v223
v_mfma_f32_16x16x32_bf16 v[228:231], a[156:159], v[92:95], v[228:231]
v_permlane16_swap_b32 v52, v54
v_mfma_f32_16x16x32_bf16 v[224:227], a[160:163], v[96:99], v[224:227]
v_permlane16_swap_b32 v53, v55
v_mfma_f32_16x16x32_bf16 v[228:231], a[160:163], v[100:103], v[228:231]
buffer_store_dwordx4 v[52:55], v20, s[4:7], s87 offen sc1
v_mfma_f32_16x16x32_bf16 v[224:227], a[164:167], v[104:107], v[224:227]
v_mfma_f32_16x16x32_bf16 v[228:231], a[164:167], v[108:111], v[228:231]
v_mfma_f32_16x16x32_bf16 v[224:227], a[168:171], v[112:115], v[224:227]
v_mfma_f32_16x16x32_bf16 v[228:231], a[168:171], v[116:119], v[228:231]
v_mfma_f32_16x16x32_bf16 v[224:227], a[172:175], v[120:123], v[224:227]
v_mfma_f32_16x16x32_bf16 v[228:231], a[172:175], v[124:127], v[228:231]
v_mfma_f32_16x16x32_bf16 v[224:227], a[176:179], v[128:131], v[224:227]
v_mfma_f32_16x16x32_bf16 v[228:231], a[176:179], v[132:135], v[228:231]
v_mfma_f32_16x16x32_bf16 v[224:227], a[180:183], v[136:139], v[224:227]
buffer_load_dword v24, v22, s[4:7], 0 offen sc1
v_mfma_f32_16x16x32_bf16 v[228:231], a[180:183], v[140:143], v[228:231]
v_mfma_f32_16x16x32_bf16 v[224:227], a[184:187], v[144:147], v[224:227]
s_waitcnt vmcnt(9)
s_barrier
v_mfma_f32_16x16x32_bf16 v[228:231], a[184:187], v[148:151], v[228:231]
buffer_store_dword v27, v45, s[4:7], s79 offen
v_mfma_f32_16x16x32_bf16 v[224:227], a[188:191], v[152:155], v[224:227]
buffer_store_dword v27, v44, s[4:7], s79 offen sc1
s_cmp_eq_u32 s94, 0
s_cbranch_scc1 g_slow_128
v_mfma_f32_16x16x32_bf16 v[228:231], a[188:191], v[156:159], v[228:231]
ds_read_b128 v[64:67], v31 offset:0
v_mfma_f32_16x16x32_bf16 v[224:227], a[192:195], v[160:163], v[224:227]
ds_read_b128 v[68:71], v31 offset:8192
v_mfma_f32_16x16x32_bf16 v[228:231], a[192:195], v[164:167], v[228:231]
ds_read_b128 v[72:75], v31 offset:16384
v_mfma_f32_16x16x32_bf16 v[224:227], a[196:199], v[168:171], v[224:227]
ds_read_b128 v[76:79], v31 offset:24576
v_mfma_f32_16x16x32_bf16 v[228:231], a[196:199], v[172:175], v[228:231]
ds_read_b128 v[80:83], v31 offset:1024
v_mfma_f32_16x16x32_bf16 v[224:227], a[200:203], v[176:179], v[224:227]
ds_read_b128 v[84:87], v31 offset:9216
v_mfma_f32_16x16x32_bf16 v[228:231], a[200:203], v[180:183], v[228:231]
ds_read_b128 v[88:91], v31 offset:17408
v_mfma_f32_16x16x32_bf16 v[224:227], a[204:207], v[184:187], v[224:227]
ds_read_b128 v[92:95], v31 offset:25600
v_mfma_f32_16x16x32_bf16 v[228:231], a[204:207], v[188:191], v[228:231]
s_waitcnt vmcnt(8)
s_barrier
g_body_117:
s_waitcnt lgkmcnt(4)
v_mfma_f32_16x16x32_bf16 v[208:211], a[0:3], v[64:67], 0
ds_read_b128 v[96:99], v31 offset:2048
v_mfma_f32_16x16x32_bf16 v[212:215], a[0:3], v[68:71], 0
ds_read_b128 v[100:103], v31 offset:10240
v_mfma_f32_16x16x32_bf16 v[216:219], a[72:75], v[64:67], 0
v_mfma_f32_16x16x32_bf16 v[208:211], a[4:7], v[72:75], v[208:211]
ds_read_b128 v[104:107], v31 offset:18432
v_cvt_pk_bf16_f32 v56, v224, v225
v_mfma_f32_16x16x32_bf16 v[212:215], a[4:7], v[76:79], v[212:215]
ds_read_b128 v[108:111], v31 offset:26624
v_cvt_pk_bf16_f32 v57, v226, v227
v_mfma_f32_16x16x32_bf16 v[220:223], a[72:75], v[68:71], 0
v_cvt_pk_bf16_f32 v58, v228, v229
s_waitcnt lgkmcnt(4)
v_mfma_f32_16x16x32_bf16 v[208:211], a[8:11], v[80:83], v[208:211]
ds_read_b128 v[112:115], v31 offset:3072
v_cvt_pk_bf16_f32 v59, v230, v231
v_mfma_f32_16x16x32_bf16 v[212:215], a[8:11], v[84:87], v[212:215]
ds_read_b128 v[116:119], v31 offset:11264
v_permlane16_swap_b32 v56, v58
v_mfma_f32_16x16x32_bf16 v[216:219], a[76:79], v[72:75], v[216:219]
v_permlane16_swap_b32 v57, v59
v_mfma_f32_16x16x32_bf16 v[208:211], a[12:15], v[88:91], v[208:211]
ds_read_b128 v[120:123], v31 offset:19456
v_mfma_f32_16x16x32_bf16 v[212:215], a[12:15], v[92:95], v[212:215]
ds_read_b128 v[124:127], v31 offset:27648
v_mfma_f32_16x16x32_bf16 v[220:223], a[76:79], v[76:79], v[220:223]
s_waitcnt lgkmcnt(4)
v_mfma_f32_16x16x32_bf16 v[208:211], a[16:19], v[96:99], v[208:211]
ds_read_b128 v[128:131], v31 offset:4096
v_mfma_f32_16x16x32_bf16 v[212:215], a[16:19], v[100:103], v[212:215]
ds_read_b128 v[132:135], v31 offset:12288
v_mfma_f32_16x16x32_bf16 v[216:219], a[80:83], v[80:83], v[216:219]
buffer_store_dwordx4 v[56:59], v21, s[4:7], s87 offen sc1
v_mfma_f32_16x16x32_bf16 v[208:211], a[20:23], v[104:107], v[208:211]
ds_read_b128 v[136:139], v31 offset:20480
v_mfma_f32_16x16x32_bf16 v[212:215], a[20:23], v[108:111], v[212:215]
ds_read_b128 v[140:143], v31 offset:28672
v_mfma_f32_16x16x32_bf16 v[220:223], a[80:83], v[84:87], v[220:223]
s_waitcnt vmcnt(5)
s_barrier
s_waitcnt lgkmcnt(4)
v_mfma_f32_16x16x32_bf16 v[208:211], a[24:27], v[112:115], v[208:211]
ds_read_b128 v[144:147], v31 offset:5120
v_mov_b32 v27, s84
v_mfma_f32_16x16x32_bf16 v[212:215], a[24:27], v[116:119], v[212:215]
ds_read_b128 v[148:151], v31 offset:13312
v_mfma_f32_16x16x32_bf16 v[216:219], a[84:87], v[88:91], v[216:219]
v_mfma_f32_16x16x32_bf16 v[208:211], a[28:31], v[120:123], v[208:211]
ds_read_b128 v[152:155], v31 offset:21504
v_mfma_f32_16x16x32_bf16 v[212:215], a[28:31], v[124:127], v[212:215]
ds_read_b128 v[156:159], v31 offset:29696
v_mfma_f32_16x16x32_bf16 v[220:223], a[84:87], v[92:95], v[220:223]
s_waitcnt lgkmcnt(4)
v_mfma_f32_16x16x32_bf16 v[208:211], a[32:35], v[128:131], v[208:211]
ds_read_b128 v[160:163], v31 offset:6144
v_mfma_f32_16x16x32_bf16 v[212:215], a[32:35], v[132:135], v[212:215]
ds_read_b128 v[164:167], v31 offset:14336
v_mfma_f32_16x16x32_bf16 v[216:219], a[88:91], v[96:99], v[216:219]
v_mfma_f32_16x16x32_bf16 v[208:211], a[36:39], v[136:139], v[208:211]
ds_read_b128 v[168:171], v31 offset:22528
s_waitcnt vmcnt(3)
ds_write_b32 v18, v24
v_mfma_f32_16x16x32_bf16 v[212:215], a[36:39], v[140:143], v[212:215]
ds_read_b128 v[172:175], v31 offset:30720
v_mfma_f32_16x16x32_bf16 v[220:223], a[88:91], v[100:103], v[220:223]
s_waitcnt lgkmcnt(5)
v_mfma_f32_16x16x32_bf16 v[208:211], a[40:43], v[144:147], v[208:211]
ds_read_b128 v[176:179], v31 offset:7168
s_waitcnt lgkmcnt(2)
s_barrier
v_mfma_f32_16x16x32_bf16 v[212:215], a[40:43], v[148:151], v[212:215]
ds_read_b128 v[180:183], v31 offset:15360
ds_read_b32 v33, v32
v_mfma_f32_16x16x32_bf16 v[216:219], a[92:95], v[104:107], v[216:219]
v_mfma_f32_16x16x32_bf16 v[208:211], a[44:47], v[152:155], v[208:211]
ds_read_b128 v[184:187], v31 offset:23552
v_mfma_f32_16x16x32_bf16 v[212:215], a[44:47], v[156:159], v[212:215]
ds_read_b128 v[188:191], v31 offset:31744
s_waitcnt lgkmcnt(2)
v_cmp_gt_u32 vcc, s52, v33
v_mfma_f32_16x16x32_bf16 v[220:223], a[92:95], v[108:111], v[220:223]
v_cmp_gt_u32 s[58:59], s54, v33
v_mfma_f32_16x16x32_bf16 v[208:211], a[48:51], v[160:163], v[208:211]
s_and_b32 vcc_lo, vcc_lo, s56
s_cselect_b32 s70, 0, 1
v_mfma_f32_16x16x32_bf16 v[212:215], a[48:51], v[164:167], v[212:215]
s_and_b32 s59, s59, s56
s_cselect_b32 s71, 0, s95
v_mfma_f32_16x16x32_bf16 v[216:219], a[96:99], v[112:115], v[216:219]
s_or_b32 s76, s70, s71
s_cselect_b32 s10, 268435456, 0
v_mfma_f32_16x16x32_bf16 v[208:211], a[52:55], v[168:171], v[208:211]
s_cmp_lg_u32 s70, 0
s_cselect_b64 s[72:73], s[52:53], s[54:55]
s_cselect_b64 s[58:59], s[44:45], s[46:47]
v_mfma_f32_16x16x32_bf16 v[212:215], a[52:55], v[172:175], v[212:215]
s_mul_i32 s74, s72, s20
s_add_u32 s74, s74, s58
v_mfma_f32_16x16x32_bf16 v[220:223], a[96:99], v[116:119], v[220:223]
s_add_u32 m0, s48, 0
s_waitcnt lgkmcnt(0)
v_mfma_f32_16x16x32_bf16 v[208:211], a[56:59], v[176:179], v[208:211]
buffer_load_dwordx4 v8, s[8:11], s74 offen offset:0 sc1 lds
v_mfma_f32_16x16x32_bf16 v[212:215], a[56:59], v[180:183], v[212:215]
s_mul_i32 s75, s72, s21
s_add_u32 s75, s75, s59
s_andn2_b32 s71, s71, s70
v_mfma_f32_16x16x32_bf16 v[216:219], a[100:103], v[120:123], v[216:219]
s_add_u32 s52, s52, s70
s_add_u32 s54, s54, s71
s_mov_b32 s77, s76
v_mfma_f32_16x16x32_bf16 v[208:211], a[60:63], v[184:187], v[208:211]
buffer_load_dwordx4 v9, s[8:11], s74 offen offset:1024 sc1 lds
v_mfma_f32_16x16x32_bf16 v[212:215], a[60:63], v[188:191], v[212:215]
v_mfma_f32_16x16x32_bf16 v[220:223], a[100:103], v[124:127], v[220:223]
v_mfma_f32_16x16x32_bf16 v[216:219], a[104:107], v[128:131], v[216:219]
buffer_load_dwordx4 v10, s[8:11], s74 offen offset:2048 sc1 lds
v_mfma_f32_16x16x32_bf16 v[220:223], a[104:107], v[132:135], v[220:223]
v_mfma_f32_16x16x32_bf16 v[216:219], a[108:111], v[136:139], v[216:219]
v_mfma_f32_16x16x32_bf16 v[220:223], a[108:111], v[140:143], v[220:223]
buffer_load_dwordx4 v11, s[8:11], s74 offen offset:3072 sc1 lds
v_mfma_f32_16x16x32_bf16 v[216:219], a[112:115], v[144:147], v[216:219]
v_cvt_pk_bf16_f32 v48, v208, v209
v_cvt_pk_bf16_f32 v49, v210, v211
v_mfma_f32_16x16x32_bf16 v[220:223], a[112:115], v[148:151], v[220:223]
s_add_u32 m0, s48, 4096
v_cvt_pk_bf16_f32 v50, v212, v213
v_mfma_f32_16x16x32_bf16 v[216:219], a[116:119], v[152:155], v[216:219]
buffer_load_dwordx4 v12, s[8:11], s74 offen offset:0 sc1 lds
v_mfma_f32_16x16x32_bf16 v[220:223], a[116:119], v[156:159], v[220:223]
v_cvt_pk_bf16_f32 v51, v214, v215
v_mfma_f32_16x16x32_bf16 v[216:219], a[120:123], v[160:163], v[216:219]
v_permlane16_swap_b32 v48, v50
v_mfma_f32_16x16x32_bf16 v[220:223], a[120:123], v[164:167], v[220:223]
buffer_load_dwordx4 v13, s[8:11], s74 offen offset:1024 sc1 lds
v_mfma_f32_16x16x32_bf16 v[216:219], a[124:127], v[168:171], v[216:219]
v_permlane16_swap_b32 v49, v51
v_mfma_f32_16x16x32_bf16 v[220:223], a[124:127], v[172:175], v[220:223]
buffer_store_dwordx4 v[48:51], v19, s[4:7], s93 offen sc1
v_mfma_f32_16x16x32_bf16 v[216:219], a[128:131], v[176:179], v[216:219]
buffer_load_dwordx4 v14, s[8:11], s74 offen offset:2048 sc1 lds
v_mfma_f32_16x16x32_bf16 v[220:223], a[128:131], v[180:183], v[220:223]
v_mfma_f32_16x16x32_bf16 v[216:219], a[132:135], v[184:187], v[216:219]
v_mfma_f32_16x16x32_bf16 v[220:223], a[132:135], v[188:191], v[220:223]
buffer_load_dwordx4 v15, s[8:11], s74 offen offset:3072 sc1 lds
v_mfma_f32_16x16x32_bf16 v[224:227], a[144:147], v[64:67], 0
v_mfma_f32_16x16x32_bf16 v[228:231], a[144:147], v[68:71], 0
v_mfma_f32_16x16x32_bf16 v[224:227], a[148:151], v[72:75], v[224:227]
v_mfma_f32_16x16x32_bf16 v[228:231], a[148:151], v[76:79], v[228:231]
v_mfma_f32_16x16x32_bf16 v[224:227], a[152:155], v[80:83], v[224:227]
v_mfma_f32_16x16x32_bf16 v[228:231], a[152:155], v[84:87], v[228:231]
v_cvt_pk_bf16_f32 v52, v216, v217
v_cvt_pk_bf16_f32 v53, v218, v219
v_mfma_f32_16x16x32_bf16 v[224:227], a[156:159], v[88:91], v[224:227]
v_cvt_pk_bf16_f32 v54, v220, v221
v_cvt_pk_bf16_f32 v55, v222, v223
v_mfma_f32_16x16x32_bf16 v[228:231], a[156:159], v[92:95], v[228:231]
v_permlane16_swap_b32 v52, v54
v_mfma_f32_16x16x32_bf16 v[224:227], a[160:163], v[96:99], v[224:227]
v_permlane16_swap_b32 v53, v55
v_mfma_f32_16x16x32_bf16 v[228:231], a[160:163], v[100:103], v[228:231]
buffer_store_dwordx4 v[52:55], v20, s[4:7], s93 offen sc1
v_mfma_f32_16x16x32_bf16 v[224:227], a[164:167], v[104:107], v[224:227]
v_mfma_f32_16x16x32_bf16 v[228:231], a[164:167], v[108:111], v[228:231]
v_mfma_f32_16x16x32_bf16 v[224:227], a[168:171], v[112:115], v[224:227]
v_mfma_f32_16x16x32_bf16 v[228:231], a[168:171], v[116:119], v[228:231]
v_mfma_f32_16x16x32_bf16 v[224:227], a[172:175], v[120:123], v[224:227]
v_mfma_f32_16x16x32_bf16 v[228:231], a[172:175], v[124:127], v[228:231]
v_mfma_f32_16x16x32_bf16 v[224:227], a[176:179], v[128:131], v[224:227]
v_mfma_f32_16x16x32_bf16 v[228:231], a[176:179], v[132:135], v[228:231]
v_mfma_f32_16x16x32_bf16 v[224:227], a[180:183], v[136:139], v[224:227]
buffer_load_dword v24, v22, s[4:7], 0 offen sc1
v_mfma_f32_16x16x32_bf16 v[228:231], a[180:183], v[140:143], v[228:231]
v_mfma_f32_16x16x32_bf16 v[224:227], a[184:187], v[144:147], v[224:227]
s_waitcnt vmcnt(9)
s_barrier
v_mfma_f32_16x16x32_bf16 v[228:231], a[184:187], v[148:151], v[228:231]
buffer_store_dword v27, v45, s[4:7], s85 offen
v_mfma_f32_16x16x32_bf16 v[224:227], a[188:191], v[152:155], v[224:227]
buffer_store_dword v27, v44, s[4:7], s85 offen sc1
s_cmp_eq_u32 s76, 0
s_cbranch_scc1 g_slow_129
v_mfma_f32_16x16x32_bf16 v[228:231], a[188:191], v[156:159], v[228:231]
ds_read_b128 v[64:67], v28 offset:0
v_mfma_f32_16x16x32_bf16 v[224:227], a[192:195], v[160:163], v[224:227]
ds_read_b128 v[68:71], v28 offset:8192
v_mfma_f32_16x16x32_bf16 v[228:231], a[192:195], v[164:167], v[228:231]
ds_read_b128 v[72:75], v28 offset:16384
v_mfma_f32_16x16x32_bf16 v[224:227], a[196:199], v[168:171], v[224:227]
ds_read_b128 v[76:79], v28 offset:24576
v_mfma_f32_16x16x32_bf16 v[228:231], a[196:199], v[172:175], v[228:231]
ds_read_b128 v[80:83], v28 offset:1024
v_mfma_f32_16x16x32_bf16 v[224:227], a[200:203], v[176:179], v[224:227]
ds_read_b128 v[84:87], v28 offset:9216
v_mfma_f32_16x16x32_bf16 v[228:231], a[200:203], v[180:183], v[228:231]
ds_read_b128 v[88:91], v28 offset:17408
v_mfma_f32_16x16x32_bf16 v[224:227], a[204:207], v[184:187], v[224:227]
ds_read_b128 v[92:95], v28 offset:25600
v_mfma_f32_16x16x32_bf16 v[228:231], a[204:207], v[188:191], v[228:231]
s_waitcnt vmcnt(8)
s_barrier
s_branch g_body_114
g_slow_126:
v_mfma_f32_16x16x32_bf16 v[228:231], a[188:191], v[156:159], v[228:231]
v_mfma_f32_16x16x32_bf16 v[224:227], a[192:195], v[160:163], v[224:227]
v_mfma_f32_16x16x32_bf16 v[228:231], a[192:195], v[164:167], v[228:231]
v_mfma_f32_16x16x32_bf16 v[224:227], a[196:199], v[168:171], v[224:227]
v_mfma_f32_16x16x32_bf16 v[228:231], a[196:199], v[172:175], v[228:231]
v_mfma_f32_16x16x32_bf16 v[224:227], a[200:203], v[176:179], v[224:227]
v_mfma_f32_16x16x32_bf16 v[228:231], a[200:203], v[180:183], v[228:231]
v_mfma_f32_16x16x32_bf16 v[224:227], a[204:207], v[184:187], v[224:227]
v_mfma_f32_16x16x32_bf16 v[228:231], a[204:207], v[188:191], v[228:231]
s_nop 6
v_cvt_pk_bf16_f32 v56, v224, v225
v_cvt_pk_bf16_f32 v57, v226, v227
v_cvt_pk_bf16_f32 v58, v228, v229
v_cvt_pk_bf16_f32 v59, v230, v231
s_nop 0
v_permlane16_swap_b32 v56, v58
v_permlane16_swap_b32 v57, v59
buffer_store_dwordx4 v[56:59], v21, s[4:7], s75 offen sc1
s_mov_b32 s75, 1879048192
s_waitcnt vmcnt(3)
ds_write_b32 v18, v24
s_waitcnt lgkmcnt(0)
s_barrier
ds_read_b32 v33, v32
s_waitcnt lgkmcnt(0)
v_cmp_gt_u32 vcc, s52, v33
v_cmp_gt_u32 s[58:59], s54, v33
s_and_b32 vcc_lo, vcc_lo, s56
s_cselect_b32 s70, 0, 1
s_and_b32 s59, s59, s56
s_cselect_b32 s71, 0, s77
s_or_b32 s82, s70, s71
s_cselect_b32 s10, 268435456, 0
s_cmp_lg_u32 s70, 0
s_cselect_b64 s[78:79], s[52:53], s[54:55]
s_cselect_b64 s[58:59], s[44:45], s[46:47]
s_mul_i32 s80, s78, s20
s_add_u32 s80, s80, s58
s_mul_i32 s81, s78, s21
s_add_u32 s81, s81, s59
s_andn2_b32 s71, s71, s70
s_add_u32 s52, s52, s70
s_add_u32 s54, s54, s71
s_mov_b32 s83, s82
s_cmp_lg_u32 s82, 0
s_cbranch_scc1 g_go_130
v_mov_b32 v27, s72
s_waitcnt vmcnt(0)
s_barrier
s_add_u32 s70, s52, s54
s_cmp_eq_u32 s70, 130
s_cbranch_scc1 g_fin_118
s_cmp_lg_u32 s3, 0
s_cbranch_scc1 sp_ok_132_j
s_mov_b32 s23, 0
buffer_load_dword v33, v22, s[4:7], 0 offen sc1
buffer_store_dword v27, v45, s[4:7], s73 offen
buffer_store_dword v27, v44, s[4:7], s73 offen sc1
s_waitcnt vmcnt(2)
s_branch sp_loop_131_e
sp_loop_131:
buffer_load_dword v33, v22, s[4:7], 0 offen sc1
s_add_u32 s23, s23, 1
s_cmp_gt_u32 s23, 150000
s_cbranch_scc1 sp_bad_133
s_waitcnt vmcnt(0)
sp_loop_131_e:
v_cmp_gt_u32 vcc, s52, v33
v_cmp_gt_u32 s[58:59], s54, v33
s_and_b32 vcc_lo, vcc_lo, s56
s_cbranch_scc0 sp_ok_132
s_cmp_gt_u32 s23, 4
s_cselect_b32 s70, 0, s56
s_cmp_lg_u32 s77, 0
s_cselect_b32 s70, 0, s70
s_or_b32 s59, s59, s70
s_and_b32 s59, s59, s56
s_cbranch_scc0 sp_ok_132
s_sleep 1
s_branch sp_loop_131
sp_bad_133:
s_mov_b32 s98, 1029
s_branch L_fail
sp_ok_132:
ds_write_b32 v18, v33
s_waitcnt lgkmcnt(0)
sp_ok_132_j:
s_barrier
ds_read_b32 v33, v32
s_waitcnt lgkmcnt(0)
s_mov_b32 s73, 1879048192
v_cmp_gt_u32 vcc, s52, v33
v_cmp_gt_u32 s[58:59], s54, v33
s_and_b32 vcc_lo, vcc_lo, s56
s_cselect_b32 s70, 0, 1
s_and_b32 s59, s59, s56
s_cselect_b32 s71, 0, 1
s_or_b32 s82, s70, s71
s_cselect_b32 s10, 268435456, 0
s_cmp_lg_u32 s70, 0
s_cselect_b64 s[78:79], s[52:53], s[54:55]
s_cselect_b64 s[58:59], s[44:45], s[46:47]
s_mul_i32 s80, s78, s20
s_add_u32 s80, s80, s58
s_mul_i32 s81, s78, s21
s_add_u32 s81, s81, s59
s_andn2_b32 s71, s71, s70
s_add_u32 s52, s52, s70
s_add_u32 s54, s54, s71
s_mov_b32 s83, s82
g_go_130:
s_add_u32 m0, s49, 0
s_nop 0
buffer_load_dwordx4 v8, s[4:7], s80 offen offset:0 sc1 lds
buffer_load_dwordx4 v9, s[4:7], s80 offen offset:1024 sc1 lds
buffer_load_dwordx4 v10, s[4:7], s80 offen offset:2048 sc1 lds
buffer_load_dwordx4 v11, s[4:7], s80 offen offset:3072 sc1 lds
s_add_u32 m0, s49, 4096
s_nop 0
buffer_load_dwordx4 v12, s[4:7], s80 offen offset:0 sc1 lds
buffer_load_dwordx4 v13, s[4:7], s80 offen offset:1024 sc1 lds
buffer_load_dwordx4 v14, s[4:7], s80 offen offset:2048 sc1 lds
buffer_load_dwordx4 v15, s[4:7], s80 offen offset:3072 sc1 lds
buffer_store_dword v27, v34, s[4:7], 0 offen
buffer_load_dword v24, v22, s[4:7], 0 offen sc1
v_mov_b32 v27, s72
s_waitcnt vmcnt(8)
s_barrier
buffer_store_dword v27, v45, s[4:7], s73 offen
buffer_store_dword v27, v44, s[4:7], s73 offen sc1
s_mov_b32 s73, 1879048192
ds_read_b128 v[64:67], v29 offset:0
ds_read_b128 v[68:71], v29 offset:8192
ds_read_b128 v[72:75], v29 offset:16384
ds_read_b128 v[76:79], v29 offset:24576
ds_read_b128 v[80:83], v29 offset:1024
ds_read_b128 v[84:87], v29 offset:9216
ds_read_b128 v[88:91], v29 offset:17408
ds_read_b128 v[92:95], v29 offset:25600
s_waitcnt vmcnt(7)
s_barrier
s_branch g_body_115
g_slow_127:
v_mfma_f32_16x16x32_bf16 v[228:231], a[188:191], v[156:159], v[228:231]
v_mfma_f32_16x16x32_bf16 v[224:227], a[192:195], v[160:163], v[224:227]
v_mfma_f32_16x16x32_bf16 v[228:231], a[192:195], v[164:167], v[228:231]
v_mfma_f32_16x16x32_bf16 v[224:227], a[196:199], v[168:171], v[224:227]
v_mfma_f32_16x16x32_bf16 v[228:231], a[196:199], v[172:175], v[228:231]
v_mfma_f32_16x16x32_bf16 v[224:227], a[200:203], v[176:179], v[224:227]
v_mfma_f32_16x16x32_bf16 v[228:231], a[200:203], v[180:183], v[228:231]
v_mfma_f32_16x16x32_bf16 v[224:227], a[204:207], v[184:187], v[224:227]
v_mfma_f32_16x16x32_bf16 v[228:231], a[204:207], v[188:191], v[228:231]
s_nop 6
v_cvt_pk_bf16_f32 v56, v224, v225
v_cvt_pk_bf16_f32 v57, v226, v227
v_cvt_pk_bf16_f32 v58, v228, v229
v_cvt_pk_bf16_f32 v59, v230, v231
s_nop 0
v_permlane16_swap_b32 v56, v58
v_permlane16_swap_b32 v57, v59
buffer_store_dwordx4 v[56:59], v21, s[4:7], s81 offen sc1
s_mov_b32 s81, 1879048192
s_waitcnt vmcnt(3)
ds_write_b32 v18, v24
s_waitcnt lgkmcnt(0)
s_barrier
ds_read_b32 v33, v32
s_waitcnt lgkmcnt(0)
v_cmp_gt_u32 vcc, s52, v33
v_cmp_gt_u32 s[58:59], s54, v33
s_and_b32 vcc_lo, vcc_lo, s56
s_cselect_b32 s70, 0, 1
s_and_b32 s59, s59, s56
s_cselect_b32 s71, 0, s83
s_or_b32 s88, s70, s71
s_cselect_b32 s10, 268435456, 0
s_cmp_lg_u32 s70, 0
s_cselect_b64 s[84:85], s[52:53], s[54:55]
s_cselect_b64 s[58:59], s[44:45], s[46:47]
s_mul_i32 s86, s84, s20
s_add_u32 s86, s86, s58
s_mul_i32 s87, s84, s21
s_add_u32 s87, s87, s59
s_andn2_b32 s71, s71, s70
s_add_u32 s52, s52, s70
s_add_u32 s54, s54, s71
s_mov_b32 s89, s88
s_cmp_lg_u32 s88, 0
s_cbranch_scc1 g_go_134
v_mov_b32 v27, s78
s_waitcnt vmcnt(0)
s_barrier
s_add_u32 s70, s52, s54
s_cmp_eq_u32 s70, 130
s_cbranch_scc1 g_fin_118
s_cmp_lg_u32 s3, 0
s_cbranch_scc1 sp_ok_136_j
s_mov_b32 s23, 0
buffer_load_dword v33, v22, s[4:7], 0 offen sc1
buffer_store_dword v27, v45, s[4:7], s79 offen
buffer_store_dword v27, v44, s[4:7], s79 offen sc1
s_waitcnt vmcnt(2)
s_branch sp_loop_135_e
sp_loop_135:
buffer_load_dword v33, v22, s[4:7], 0 offen sc1
s_add_u32 s23, s23, 1
s_cmp_gt_u32 s23, 150000
s_cbranch_scc1 sp_bad_137
s_waitcnt vmcnt(0)
sp_loop_135_e:
v_cmp_gt_u32 vcc, s52, v33
v_cmp_gt_u32 s[58:59], s54, v33
s_and_b32 vcc_lo, vcc_lo, s56
s_cbranch_scc0 sp_ok_136
s_cmp_gt_u32 s23, 4
s_cselect_b32 s70, 0, s56
s_cmp_lg_u32 s83, 0
s_cselect_b32 s70, 0, s70
s_or_b32 s59, s59, s70
s_and_b32 s59, s59, s56
s_cbranch_scc0 sp_ok_136
s_sleep 1
s_branch sp_loop_135
sp_bad_137:
s_mov_b32 s98, 1029
s_branch L_fail
sp_ok_136:
ds_write_b32 v18, v33
s_waitcnt lgkmcnt(0)
sp_ok_136_j:
s_barrier
ds_read_b32 v33, v32
s_waitcnt lgkmcnt(0)
s_mov_b32 s79, 1879048192
v_cmp_gt_u32 vcc, s52, v33
v_cmp_gt_u32 s[58:59], s54, v33
s_and_b32 vcc_lo, vcc_lo, s56
s_cselect_b32 s70, 0, 1
s_and_b32 s59, s59, s56
s_cselect_b32 s71, 0, 1
s_or_b32 s88, s70, s71
s_cselect_b32 s10, 268435456, 0
s_cmp_lg_u32 s70, 0
s_cselect_b64 s[84:85], s[52:53], s[54:55]
s_cselect_b64 s[58:59], s[44:45], s[46:47]
s_mul_i32 s86, s84, s20
s_add_u32 s86, s86, s58
s_mul_i32 s87, s84, s21
s_add_u32 s87, s87, s59
s_andn2_b32 s71, s71, s70
s_add_u32 s52, s52, s70
s_add_u32 s54, s54, s71
s_mov_b32 s89, s88
g_go_134:
s_add_u32 m0, s50, 0
s_nop 0
buffer_load_dwordx4 v8, s[4:7], s86 offen offset:0 sc1 lds
buffer_load_dwordx4 v9, s[4:7], s86 offen offset:1024 sc1 lds
buffer_load_dwordx4 v10, s[4:7], s86 offen offset:2048 sc1 lds
buffer_load_dwordx4 v11, s[4:7], s86 offen offset:3072 sc1 lds
s_add_u32 m0, s50, 4096
s_nop 0
buffer_load_dwordx4 v12, s[4:7], s86 offen offset:0 sc1 lds
buffer_load_dwordx4 v13, s[4:7], s86 offen offset:1024 sc1 lds
buffer_load_dwordx4 v14, s[4:7], s86 offen offset:2048 sc1 lds
buffer_load_dwordx4 v15, s[4:7], s86 offen offset:3072 sc1 lds
buffer_store_dword v27, v34, s[4:7], 0 offen
buffer_load_dword v24, v22, s[4:7], 0 offen sc1
v_mov_b32 v27, s78
s_waitcnt vmcnt(8)
s_barrier
buffer_store_dword v27, v45, s[4:7], s79 offen
buffer_store_dword v27, v44, s[4:7], s79 offen sc1
s_mov_b32 s79, 1879048192
ds_read_b128 v[64:67], v30 offset:0
ds_read_b128 v[68:71], v30 offset:8192
ds_read_b128 v[72:75], v30 offset:16384
ds_read_b128 v[76:79], v30 offset:24576
ds_read_b128 v[80:83], v30 offset:1024
ds_read_b128 v[84:87], v30 offset:9216
ds_read_b128 v[88:91], v30 offset:17408
ds_read_b128 v[92:95], v30 offset:25600
s_waitcnt vmcnt(7)
s_barrier
s_branch g_body_116
g_slow_128:
v_mfma_f32_16x16x32_bf16 v[228:231], a[188:191], v[156:159], v[228:231]
v_mfma_f32_16x16x32_bf16 v[224:227], a[192:195], v[160:163], v[224:227]
v_mfma_f32_16x16x32_bf16 v[228:231], a[192:195], v[164:167], v[228:231]
v_mfma_f32_16x16x32_bf16 v[224:227], a[196:199], v[168:171], v[224:227]
v_mfma_f32_16x16x32_bf16 v[228:231], a[196:199], v[172:175], v[228:231]
v_mfma_f32_16x16x32_bf16 v[224:227], a[200:203], v[176:179], v[224:227]
v_mfma_f32_16x16x32_bf16 v[228:231], a[200:203], v[180:183], v[228:231]
v_mfma_f32_16x16x32_bf16 v[224:227], a[204:207], v[184:187], v[224:227]
v_mfma_f32_16x16x32_bf16 v[228:231], a[204:207], v[188:191], v[228:231]
s_nop 6
v_cvt_pk_bf16_f32 v56, v224, v225
v_cvt_pk_bf16_f32 v57, v226, v227
v_cvt_pk_bf16_f32 v58, v228, v229
v_cvt_pk_bf16_f32 v59, v230, v231
s_nop 0
v_permlane16_swap_b32 v56, v58
v_permlane16_swap_b32 v57, v59
buffer_store_dwordx4 v[56:59], v21, s[4:7], s87 offen sc1
s_mov_b32 s87, 1879048192
s_waitcnt vmcnt(3)
ds_write_b32 v18, v24
s_waitcnt lgkmcnt(0)
s_barrier
ds_read_b32 v33, v32
s_waitcnt lgkmcnt(0)
v_cmp_gt_u32 vcc, s52, v33
v_cmp_gt_u32 s[58:59], s54, v33
s_and_b32 vcc_lo, vcc_lo, s56
s_cselect_b32 s70, 0, 1
s_and_b32 s59, s59, s56
s_cselect_b32 s71, 0, s89
s_or_b32 s94, s70, s71
s_cselect_b32 s10, 268435456, 0
s_cmp_lg_u32 s70, 0
s_cselect_b64 s[90:91], s[52:53], s[54:55]
s_cselect_b64 s[58:59], s[44:45], s[46:47]
s_mul_i32 s92, s90, s20
s_add_u32 s92, s92, s58
s_mul_i32 s93, s90, s21
s_add_u32 s93, s93, s59
s_andn2_b32 s71, s71, s70
s_add_u32 s52, s52, s70
s_add_u32 s54, s54, s71
s_mov_b32 s95, s94
s_cmp_lg_u32 s94, 0
s_cbranch_scc1 g_go_138
v_mov_b32 v27, s84
s_waitcnt vmcnt(0)
s_barrier
s_add_u32 s70, s52, s54
s_cmp_eq_u32 s70, 130
s_cbranch_scc1 g_fin_118
s_cmp_lg_u32 s3, 0
s_cbranch_scc1 sp_ok_140_j
s_mov_b32 s23, 0
buffer_load_dword v33, v22, s[4:7], 0 offen sc1
buffer_store_dword v27, v45, s[4:7], s85 offen
buffer_store_dword v27, v44, s[4:7], s85 offen sc1
s_waitcnt vmcnt(2)
s_branch sp_loop_139_e
sp_loop_139:
buffer_load_dword v33, v22, s[4:7], 0 offen sc1
s_add_u32 s23, s23, 1
s_cmp_gt_u32 s23, 150000
s_cbranch_scc1 sp_bad_141
s_waitcnt vmcnt(0)
sp_loop_139_e:
v_cmp_gt_u32 vcc, s52, v33
v_cmp_gt_u32 s[58:59], s54, v33
s_and_b32 vcc_lo, vcc_lo, s56
s_cbranch_scc0 sp_ok_140
s_cmp_gt_u32 s23, 4
s_cselect_b32 s70, 0, s56
s_cmp_lg_u32 s89, 0
s_cselect_b32 s70, 0, s70
s_or_b32 s59, s59, s70
s_and_b32 s59, s59, s56
s_cbranch_scc0 sp_ok_140
s_sleep 1
s_branch sp_loop_139
sp_bad_141:
s_mov_b32 s98, 1029
s_branch L_fail
sp_ok_140:
ds_write_b32 v18, v33
s_waitcnt lgkmcnt(0)
sp_ok_140_j:
s_barrier
ds_read_b32 v33, v32
s_waitcnt lgkmcnt(0)
s_mov_b32 s85, 1879048192
v_cmp_gt_u32 vcc, s52, v33
v_cmp_gt_u32 s[58:59], s54, v33
s_and_b32 vcc_lo, vcc_lo, s56
s_cselect_b32 s70, 0, 1
s_and_b32 s59, s59, s56
s_cselect_b32 s71, 0, 1
s_or_b32 s94, s70, s71
s_cselect_b32 s10, 268435456, 0
s_cmp_lg_u32 s70, 0
s_cselect_b64 s[90:91], s[52:53], s[54:55]
s_cselect_b64 s[58:59], s[44:45], s[46:47]
s_mul_i32 s92, s90, s20
s_add_u32 s92, s92, s58
s_mul_i32 s93, s90, s21
s_add_u32 s93, s93, s59
s_andn2_b32 s71, s71, s70
s_add_u32 s52, s52, s70
s_add_u32 s54, s54, s71
s_mov_b32 s95, s94
g_go_138:
s_add_u32 m0, s51, 0
s_nop 0
buffer_load_dwordx4 v8, s[4:7], s92 offen offset:0 sc1 lds
buffer_load_dwordx4 v9, s[4:7], s92 offen offset:1024 sc1 lds
buffer_load_dwordx4 v10, s[4:7], s92 offen offset:2048 sc1 lds
buffer_load_dwordx4 v11, s[4:7], s92 offen offset:3072 sc1 lds
s_add_u32 m0, s51, 4096
s_nop 0
buffer_load_dwordx4 v12, s[4:7], s92 offen offset:0 sc1 lds
buffer_load_dwordx4 v13, s[4:7], s92 offen offset:1024 sc1 lds
buffer_load_dwordx4 v14, s[4:7], s92 offen offset:2048 sc1 lds
buffer_load_dwordx4 v15, s[4:7], s92 offen offset:3072 sc1 lds
buffer_store_dword v27, v34, s[4:7], 0 offen
buffer_load_dword v24, v22, s[4:7], 0 offen sc1
v_mov_b32 v27, s84
s_waitcnt vmcnt(8)
s_barrier
buffer_store_dword v27, v45, s[4:7], s85 offen
buffer_store_dword v27, v44, s[4:7], s85 offen sc1
s_mov_b32 s85, 1879048192
ds_read_b128 v[64:67], v31 offset:0
ds_read_b128 v[68:71], v31 offset:8192
ds_read_b128 v[72:75], v31 offset:16384
ds_read_b128 v[76:79], v31 offset:24576
ds_read_b128 v[80:83], v31 offset:1024
ds_read_b128 v[84:87], v31 offset:9216
ds_read_b128 v[88:91], v31 offset:17408
ds_read_b128 v[92:95], v31 offset:25600
s_waitcnt vmcnt(7)
s_barrier
s_branch g_body_117
g_slow_129:
v_mfma_f32_16x16x32_bf16 v[228:231], a[188:191], v[156:159], v[228:231]
v_mfma_f32_16x16x32_bf16 v[224:227], a[192:195], v[160:163], v[224:227]
v_mfma_f32_16x16x32_bf16 v[228:231], a[192:195], v[164:167], v[228:231]
v_mfma_f32_16x16x32_bf16 v[224:227], a[196:199], v[168:171], v[224:227]
v_mfma_f32_16x16x32_bf16 v[228:231], a[196:199], v[172:175], v[228:231]
v_mfma_f32_16x16x32_bf16 v[224:227], a[200:203], v[176:179], v[224:227]
v_mfma_f32_16x16x32_bf16 v[228:231], a[200:203], v[180:183], v[228:231]
v_mfma_f32_16x16x32_bf16 v[224:227], a[204:207], v[184:187], v[224:227]
v_mfma_f32_16x16x32_bf16 v[228:231], a[204:207], v[188:191], v[228:231]
s_nop 6
v_cvt_pk_bf16_f32 v56, v224, v225
v_cvt_pk_bf16_f32 v57, v226, v227
v_cvt_pk_bf16_f32 v58, v228, v229
v_cvt_pk_bf16_f32 v59, v230, v231
s_nop 0
v_permlane16_swap_b32 v56, v58
v_permlane16_swap_b32 v57, v59
buffer_store_dwordx4 v[56:59], v21, s[4:7], s93 offen sc1
s_mov_b32 s93, 1879048192
s_waitcnt vmcnt(3)
ds_write_b32 v18, v24
s_waitcnt lgkmcnt(0)
s_barrier
ds_read_b32 v33, v32
s_waitcnt lgkmcnt(0)
v_cmp_gt_u32 vcc, s52, v33
v_cmp_gt_u32 s[58:59], s54, v33
s_and_b32 vcc_lo, vcc_lo, s56
s_cselect_b32 s70, 0, 1
s_and_b32 s59, s59, s56
s_cselect_b32 s71, 0, s95
s_or_b32 s76, s70, s71
s_cselect_b32 s10, 268435456, 0
s_cmp_lg_u32 s70, 0
s_cselect_b64 s[72:73], s[52:53], s[54:55]
s_cselect_b64 s[58:59], s[44:45], s[46:47]
s_mul_i32 s74, s72, s20
s_add_u32 s74, s74, s58
s_mul_i32 s75, s72, s21
s_add_u32 s75, s75, s59
s_andn2_b32 s71, s71, s70
s_add_u32 s52, s52, s70
s_add_u32 s54, s54, s71
s_mov_b32 s77, s76
s_cmp_lg_u32 s76, 0
s_cbranch_scc1 g_go_142
v_mov_b32 v27, s90
s_waitcnt vmcnt(0)
s_barrier
s_add_u32 s70, s52, s54
s_cmp_eq_u32 s70, 130
s_cbranch_scc1 g_fin_118
s_cmp_lg_u32 s3, 0
s_cbranch_scc1 sp_ok_144_j
s_mov_b32 s23, 0
buffer_load_dword v33, v22, s[4:7], 0 offen sc1
buffer_store_dword v27, v45, s[4:7], s91 offen
buffer_store_dword v27, v44, s[4:7], s91 offen sc1
s_waitcnt vmcnt(2)
s_branch sp_loop_143_e
sp_loop_143:
buffer_load_dword v33, v22, s[4:7], 0 offen sc1
s_add_u32 s23, s23, 1
s_cmp_gt_u32 s23, 150000
s_cbranch_scc1 sp_bad_145
s_waitcnt vmcnt(0)
sp_loop_143_e:
v_cmp_gt_u32 vcc, s52, v33
v_cmp_gt_u32 s[58:59], s54, v33
s_and_b32 vcc_lo, vcc_lo, s56
s_cbranch_scc0 sp_ok_144
s_cmp_gt_u32 s23, 4
s_cselect_b32 s70, 0, s56
s_cmp_lg_u32 s95, 0
s_cselect_b32 s70, 0, s70
s_or_b32 s59, s59, s70
s_and_b32 s59, s59, s56
s_cbranch_scc0 sp_ok_144
s_sleep 1
s_branch sp_loop_143
sp_bad_145:
s_mov_b32 s98, 1029
s_branch L_fail
sp_ok_144:
ds_write_b32 v18, v33
s_waitcnt lgkmcnt(0)
sp_ok_144_j:
s_barrier
ds_read_b32 v33, v32
s_waitcnt lgkmcnt(0)
s_mov_b32 s91, 1879048192
v_cmp_gt_u32 vcc, s52, v33
v_cmp_gt_u32 s[58:59], s54, v33
s_and_b32 vcc_lo, vcc_lo, s56
s_cselect_b32 s70, 0, 1
s_and_b32 s59, s59, s56
s_cselect_b32 s71, 0, 1
s_or_b32 s76, s70, s71
s_cselect_b32 s10, 268435456, 0
s_cmp_lg_u32 s70, 0
s_cselect_b64 s[72:73], s[52:53], s[54:55]
s_cselect_b64 s[58:59], s[44:45], s[46:47]
s_mul_i32 s74, s72, s20
s_add_u32 s74, s74, s58
s_mul_i32 s75, s72, s21
s_add_u32 s75, s75, s59
s_andn2_b32 s71, s71, s70
s_add_u32 s52, s52, s70
s_add_u32 s54, s54, s71
s_mov_b32 s77, s76
g_go_142:
s_add_u32 m0, s48, 0
s_nop 0
buffer_load_dwordx4 v8, s[4:7], s74 offen offset:0 sc1 lds
buffer_load_dwordx4 v9, s[4:7], s74 offen offset:1024 sc1 lds
buffer_load_dwordx4 v10, s[4:7], s74 offen offset:2048 sc1 lds
buffer_load_dwordx4 v11, s[4:7], s74 offen offset:3072 sc1 lds
s_add_u32 m0, s48, 4096
s_nop 0
buffer_load_dwordx4 v12, s[4:7], s74 offen offset:0 sc1 lds
buffer_load_dwordx4 v13, s[4:7], s74 offen offset:1024 sc1 lds
buffer_load_dwordx4 v14, s[4:7], s74 offen offset:2048 sc1 lds
buffer_load_dwordx4 v15, s[4:7], s74 offen offset:3072 sc1 lds
buffer_store_dword v27, v34, s[4:7], 0 offen
buffer_load_dword v24, v22, s[4:7], 0 offen sc1
v_mov_b32 v27, s90
s_waitcnt vmcnt(8)
s_barrier
buffer_store_dword v27, v45, s[4:7], s91 offen
buffer_store_dword v27, v44, s[4:7], s91 offen sc1
s_mov_b32 s91, 1879048192
ds_read_b128 v[64:67], v28 offset:0
ds_read_b128 v[68:71], v28 offset:8192
ds_read_b128 v[72:75], v28 offset:16384
ds_read_b128 v[76:79], v28 offset:24576
ds_read_b128 v[80:83], v28 offset:1024
ds_read_b128 v[84:87], v28 offset:9216
ds_read_b128 v[88:91], v28 offset:17408
ds_read_b128 v[92:95], v28 offset:25600
s_waitcnt vmcnt(7)
s_barrier
s_branch g_body_114
g_fin_118:
buffer_store_dword v27, v45, s[4:7], s91 offen
buffer_store_dword v27, v44, s[4:7], s91 offen sc1
s_endpgm
H_up:
s_mov_b32 s8, s32
s_and_b32 s9, s33, 0xffff
s_mov_b32 s10, 5308416
s_mov_b32 s11, 0x20000
s_mov_b32 s12, s34
s_and_b32 s13, s35, 0xffff
s_mov_b32 s14, 5308416
s_mov_b32 s15, 0x20000
s_mul_i32 s75, s74, 192
s_lshl_b32 s76, s3, 5
s_add_u32 s48, s75, s76
s_mov_b32 s49, s48
s_lshr_b32 s77, s3, 1
s_lshl_b32 s76, s77, 5
s_add_u32 s76, s76, s75
s_add_u32 s50, s76, 128
s_mov_b32 s51, s50
s_mul_i32 s75, s74, 6144
v_lshrrev_b32 v1, 5, v0
v_lshlrev_b32 v1, 10, v1
v_and_b32 v2, 15, v0
v_lshl_add_u32 v1, v2, 4, v1
v_bfe_u32 v2, v0, 4, 1
v_lshl_add_u32 v1, v2, 3, v1
s_lshl_b32 s76, s3, 8
s_add_u32 s76, s76, s75
s_add_u32 s76, s76, 4096
v_add_u32 v19, s76, v1
v_bfe_u32 v1, v0, 4, 1
v_lshlrev_b32 v1, 10, v1
v_lshrrev_b32 v2, 5, v0
v_lshl_add_u32 v1, v2, 8, v1
v_and_b32 v2, 15, v0
v_lshl_add_u32 v5, v2, 4, v1
s_lshl_b32 s76, s77, 11
s_add_u32 s76, s76, s75
s_and_b32 s77, s3, 1
s_lshl_b32 s77, s77, 9
s_add_u32 s76, s76, s77
v_add_u32 v20, s76, v5
v_lshrrev_b32 v1, 5, v0
v_bfe_u32 v2, v0, 3, 1
v_lshl_add_u32 v1, v1, 1, v2
v_bfe_u32 v2, v0, 4, 1
v_bfe_u32 v3, v0, 1, 2
v_lshlrev_b32 v1, 3, v1
v_lshl_add_u32 v1, v2, 2, v1
v_add_u32 v1, v1, v3
v_mul_u32_u24 v1, 9216, v1
v_and_b32 v2, 1, v0
v_lshl_add_u32 v63, v2, 4, v1
s_mul_i32 s70, s3, 40960
v_lshrrev_b32 v1, 5, v0
v_lshlrev_b32 v1, 9, v1
v_bfe_u32 v2, v0, 4, 1
v_lshl_add_u32 v1, v2, 7, v1
v_add_u32 v1, s70, v1
v_and_b32 v2, 15, v0
v_lshl_add_u32 v2, v2, 3, v1
v_mov_b32 v61, v2
v_add_u32 v62, 1024, v2
v_bfe_u32 v2, v0, 2, 2
v_lshl_add_u32 v1, v2, 5, v1
v_bfe_u32 v2, v0, 1, 1
v_lshl_add_u32 v1, v2, 10, v1
v_and_b32 v2, 1, v0
v_lshl_add_u32 v1, v2, 3, v1
s_and_b32 s71, s3, 1
s_lshl_b32 s71, s71, 4
s_add_u32 s71, s71, 2048
v_add_u32 v60, s71, v1
s_add_u32 m0, s70, 0
s_add_u32 s71, s48, 0
buffer_load_dwordx4 v63, s[8:11], s71 offen lds
s_add_u32 m0, s70, 1024
s_add_u32 s71, s49, 0
buffer_load_dwordx4 v63, s[12:15], s71 offen lds
s_add_u32 m0, s70, 2048
s_add_u32 s71, s50, 0
buffer_load_dwordx4 v63, s[8:11], s71 offen lds
s_add_u32 m0, s70, 3072
s_add_u32 s71, s51, 0
buffer_load_dwordx4 v63, s[12:15], s71 offen lds
s_add_u32 m0, s70, 4096
s_add_u32 s71, s48, 294912
buffer_load_dwordx4 v63, s[8:11], s71 offen lds
s_add_u32 m0, s70, 5120
s_add_u32 s71, s49, 294912
buffer_load_dwordx4 v63, s[12:15], s71 offen lds
s_add_u32 m0, s70, 6144
s_add_u32 s71, s50, 294912
buffer_load_dwordx4 v63, s[8:11], s71 offen lds
s_add_u32 m0, s70, 7168
s_add_u32 s71, s51, 294912
buffer_load_dwordx4 v63, s[12:15], s71 offen lds
s_add_u32 m0, s70, 8192
s_add_u32 s71, s48, 589824
buffer_load_dwordx4 v63, s[8:11], s71 offen lds
s_add_u32 m0, s70, 9216
s_add_u32 s71, s49, 589824
buffer_load_dwordx4 v63, s[12:15], s71 offen lds
s_add_u32 m0, s70, 10240
s_add_u32 s71, s50, 589824
buffer_load_dwordx4 v63, s[8:11], s71 offen lds
s_add_u32 m0, s70, 11264
s_add_u32 s71, s51, 589824
buffer_load_dwordx4 v63, s[12:15], s71 offen lds
s_add_u32 m0, s70, 12288
s_add_u32 s71, s48, 884736
buffer_load_dwordx4 v63, s[8:11], s71 offen lds
s_add_u32 m0, s70, 13312
s_add_u32 s71, s49, 884736
buffer_load_dwordx4 v63, s[12:15], s71 offen lds
s_add_u32 m0, s70, 14336
s_add_u32 s71, s50, 884736
buffer_load_dwordx4 v63, s[8:11], s71 offen lds
s_add_u32 m0, s70, 15360
s_add_u32 s71, s51, 884736
buffer_load_dwordx4 v63, s[12:15], s71 offen lds
s_add_u32 m0, s70, 16384
s_add_u32 s71, s48, 1179648
buffer_load_dwordx4 v63, s[8:11], s71 offen lds
s_add_u32 m0, s70, 17408
s_add_u32 s71, s49, 1179648
buffer_load_dwordx4 v63, s[12:15], s71 offen lds
s_add_u32 m0, s70, 18432
s_add_u32 s71, s50, 1179648
buffer_load_dwordx4 v63, s[8:11], s71 offen lds
s_add_u32 m0, s70, 19456
s_add_u32 s71, s51, 1179648
buffer_load_dwordx4 v63, s[12:15], s71 offen lds
s_add_u32 m0, s70, 20480
s_add_u32 s71, s48, 1474560
buffer_load_dwordx4 v63, s[8:11], s71 offen lds
s_add_u32 m0, s70, 21504
s_add_u32 s71, s49, 1474560
buffer_load_dwordx4 v63, s[12:15], s71 offen lds
s_add_u32 m0, s70, 22528
s_add_u32 s71, s50, 1474560
buffer_load_dwordx4 v63, s[8:11], s71 offen lds
s_add_u32 m0, s70, 23552
s_add_u32 s71, s51, 1474560
buffer_load_dwordx4 v63, s[12:15], s71 offen lds
s_add_u32 m0, s70, 24576
s_add_u32 s71, s48, 1769472
buffer_load_dwordx4 v63, s[8:11], s71 offen lds
s_add_u32 m0, s70, 25600
s_add_u32 s71, s49, 1769472
buffer_load_dwordx4 v63, s[12:15], s71 offen lds
s_add_u32 m0, s70, 26624
s_add_u32 s71, s50, 1769472
buffer_load_dwordx4 v63, s[8:11], s71 offen lds
s_add_u32 m0, s70, 27648
s_add_u32 s71, s51, 1769472
buffer_load_dwordx4 v63, s[12:15], s71 offen lds
s_add_u32 m0, s70, 28672
s_add_u32 s71, s48, 2064384
buffer_load_dwordx4 v63, s[8:11], s71 offen lds
s_add_u32 m0, s70, 29696
s_add_u32 s71, s49, 2064384
buffer_load_dwordx4 v63, s[12:15], s71 offen lds
s_add_u32 m0, s70, 30720
s_add_u32 s71, s50, 2064384
buffer_load_dwordx4 v63, s[8:11], s71 offen lds
s_add_u32 m0, s70, 31744
s_add_u32 s71, s51, 2064384
buffer_load_dwordx4 v63, s[12:15], s71 offen lds
s_add_u32 m0, s70, 32768
s_add_u32 s71, s48, 2359296
buffer_load_dwordx4 v63, s[8:11], s71 offen lds
s_add_u32 m0, s70, 33792
s_add_u32 s71, s49, 2359296
buffer_load_dwordx4 v63, s[12:15], s71 offen lds
s_add_u32 m0, s70, 34816
s_add_u32 s71, s50, 2359296
buffer_load_dwordx4 v63, s[8:11], s71 offen lds
s_add_u32 m0, s70, 35840
s_add_u32 s71, s51, 2359296
buffer_load_dwordx4 v63, s[12:15], s71 offen lds
s_add_u32 m0, s70, 36864
s_add_u32 s71, s48, 2654208
buffer_load_dwordx4 v63, s[8:11], s71 offen lds
s_add_u32 m0, s70, 37888
s_add_u32 s71, s49, 2654208
buffer_load_dwordx4 v63, s[12:15], s71 offen lds
s_add_u32 m0, s70, 38912
s_add_u32 s71, s50, 2654208
buffer_load_dwordx4 v63, s[8:11], s71 offen lds
s_add_u32 m0, s70, 39936
s_add_u32 s71, s51, 2654208
buffer_load_dwordx4 v63, s[12:15], s71 offen lds
s_waitcnt vmcnt(36)
ds_read_b64_tr_b16 a[0:1], v60 offset:0
ds_read_b64_tr_b16 a[2:3], v60 offset:256
ds_read_b64_tr_b16 a[72:73], v61 offset:0
ds_read_b64_tr_b16 a[74:75], v61 offset:256
ds_read_b64_tr_b16 a[144:145], v62 offset:0
ds_read_b64_tr_b16 a[146:147], v62 offset:256
s_waitcnt lgkmcnt(0)
s_add_u32 m0, s70, 0
s_add_u32 s71, s48, 2949120
buffer_load_dwordx4 v63, s[8:11], s71 offen lds
s_add_u32 m0, s70, 1024
s_add_u32 s71, s49, 2949120
buffer_load_dwordx4 v63, s[12:15], s71 offen lds
s_add_u32 m0, s70, 2048
s_add_u32 s71, s50, 2949120
buffer_load_dwordx4 v63, s[8:11], s71 offen lds
s_add_u32 m0, s70, 3072
s_add_u32 s71, s51, 2949120
buffer_load_dwordx4 v63, s[12:15], s71 offen lds
s_waitcnt vmcnt(36)
ds_read_b64_tr_b16 a[4:5], v60 offset:4096
ds_read_b64_tr_b16 a[6:7], v60 offset:4352
ds_read_b64_tr_b16 a[76:77], v61 offset:4096
ds_read_b64_tr_b16 a[78:79], v61 offset:4352
ds_read_b64_tr_b16 a[148:149], v62 offset:4096
ds_read_b64_tr_b16 a[150:151], v62 offset:4352
s_waitcnt lgkmcnt(0)
s_add_u32 m0, s70, 4096
s_add_u32 s71, s48, 3244032
buffer_load_dwordx4 v63, s[8:11], s71 offen lds
s_add_u32 m0, s70, 5120
s_add_u32 s71, s49, 3244032
buffer_load_dwordx4 v63, s[12:15], s71 offen lds
s_add_u32 m0, s70, 6144
s_add_u32 s71, s50, 3244032
buffer_load_dwordx4 v63, s[8:11], s71 offen lds
s_add_u32 m0, s70, 7168
s_add_u32 s71, s51, 3244032
buffer_load_dwordx4 v63, s[12:15], s71 offen lds
s_waitcnt vmcnt(36)
ds_read_b64_tr_b16 a[8:9], v60 offset:8192
ds_read_b64_tr_b16 a[10:11], v60 offset:8448
ds_read_b64_tr_b16 a[80:81], v61 offset:8192
ds_read_b64_tr_b16 a[82:83], v61 offset:8448
ds_read_b64_tr_b16 a[152:153], v62 offset:8192
ds_read_b64_tr_b16 a[154:155], v62 offset:8448
s_waitcnt lgkmcnt(0)
s_add_u32 m0, s70, 8192
s_add_u32 s71, s48, 3538944
buffer_load_dwordx4 v63, s[8:11], s71 offen lds
s_add_u32 m0, s70, 9216
s_add_u32 s71, s49, 3538944
buffer_load_dwordx4 v63, s[12:15], s71 offen lds
s_add_u32 m0, s70, 10240
s_add_u32 s71, s50, 3538944
buffer_load_dwordx4 v63, s[8:11], s71 offen lds
s_add_u32 m0, s70, 11264
s_add_u32 s71, s51, 3538944
buffer_load_dwordx4 v63, s[12:15], s71 offen lds
s_waitcnt vmcnt(36)
ds_read_b64_tr_b16 a[12:13], v60 offset:12288
ds_read_b64_tr_b16 a[14:15], v60 offset:12544
ds_read_b64_tr_b16 a[84:85], v61 offset:12288
ds_read_b64_tr_b16 a[86:87], v61 offset:12544
ds_read_b64_tr_b16 a[156:157], v62 offset:12288
ds_read_b64_tr_b16 a[158:159], v62 offset:12544
s_waitcnt lgkmcnt(0)
s_add_u32 m0, s70, 12288
s_add_u32 s71, s48, 3833856
buffer_load_dwordx4 v63, s[8:11], s71 offen lds
s_add_u32 m0, s70, 13312
s_add_u32 s71, s49, 3833856
buffer_load_dwordx4 v63, s[12:15], s71 offen lds
s_add_u32 m0, s70, 14336
s_add_u32 s71, s50, 3833856
buffer_load_dwordx4 v63, s[8:11], s71 offen lds
s_add_u32 m0, s70, 15360
s_add_u32 s71, s51, 3833856
buffer_load_dwordx4 v63, s[12:15], s71 offen lds
s_waitcnt vmcnt(36)
ds_read_b64_tr_b16 a[16:17], v60 offset:16384
ds_read_b64_tr_b16 a[18:19], v60 offset:16640
ds_read_b64_tr_b16 a[88:89], v61 offset:16384
ds_read_b64_tr_b16 a[90:91], v61 offset:16640
ds_read_b64_tr_b16 a[160:161], v62 offset:16384
ds_read_b64_tr_b16 a[162:163], v62 offset:16640
s_waitcnt lgkmcnt(0)
s_add_u32 m0, s70, 16384
s_add_u32 s71, s48, 4128768
buffer_load_dwordx4 v63, s[8:11], s71 offen lds
s_add_u32 m0, s70, 17408
s_add_u32 s71, s49, 4128768
buffer_load_dwordx4 v63, s[12:15], s71 offen lds
s_add_u32 m0, s70, 18432
s_add_u32 s71, s50, 4128768
buffer_load_dwordx4 v63, s[8:11], s71 offen lds
s_add_u32 m0, s70, 19456
s_add_u32 s71, s51, 4128768
buffer_load_dwordx4 v63, s[12:15], s71 offen lds
s_waitcnt vmcnt(36)
ds_read_b64_tr_b16 a[20:21], v60 offset:20480
ds_read_b64_tr_b16 a[22:23], v60 offset:20736
ds_read_b64_tr_b16 a[92:93], v61 offset:20480
ds_read_b64_tr_b16 a[94:95], v61 offset:20736
ds_read_b64_tr_b16 a[164:165], v62 offset:20480
ds_read_b64_tr_b16 a[166:167], v62 offset:20736
s_waitcnt lgkmcnt(0)
s_add_u32 m0, s70, 20480
s_add_u32 s71, s48, 4423680
buffer_load_dwordx4 v63, s[8:11], s71 offen lds
s_add_u32 m0, s70, 21504
s_add_u32 s71, s49, 4423680
buffer_load_dwordx4 v63, s[12:15], s71 offen lds
s_add_u32 m0, s70, 22528
s_add_u32 s71, s50, 4423680
buffer_load_dwordx4 v63, s[8:11], s71 offen lds
s_add_u32 m0, s70, 23552
s_add_u32 s71, s51, 4423680
buffer_load_dwordx4 v63, s[12:15], s71 offen lds
s_waitcnt vmcnt(36)
ds_read_b64_tr_b16 a[24:25], v60 offset:24576
ds_read_b64_tr_b16 a[26:27], v60 offset:24832
ds_read_b64_tr_b16 a[96:97], v61 offset:24576
ds_read_b64_tr_b16 a[98:99], v61 offset:24832
ds_read_b64_tr_b16 a[168:169], v62 offset:24576
ds_read_b64_tr_b16 a[170:171], v62 offset:24832
s_waitcnt lgkmcnt(0)
s_add_u32 m0, s70, 24576
s_add_u32 s71, s48, 4718592
buffer_load_dwordx4 v63, s[8:11], s71 offen lds
s_add_u32 m0, s70, 25600
s_add_u32 s71, s49, 4718592
buffer_load_dwordx4 v63, s[12:15], s71 offen lds
s_add_u32 m0, s70, 26624
s_add_u32 s71, s50, 4718592
buffer_load_dwordx4 v63, s[8:11], s71 offen lds
s_add_u32 m0, s70, 27648
s_add_u32 s71, s51, 4718592
buffer_load_dwordx4 v63, s[12:15], s71 offen lds
s_waitcnt vmcnt(36)
ds_read_b64_tr_b16 a[28:29], v60 offset:28672
ds_read_b64_tr_b16 a[30:31], v60 offset:28928
ds_read_b64_tr_b16 a[100:101], v61 offset:28672
ds_read_b64_tr_b16 a[102:103], v61 offset:28928
ds_read_b64_tr_b16 a[172:173], v62 offset:28672
ds_read_b64_tr_b16 a[174:175], v62 offset:28928
s_waitcnt lgkmcnt(0)
s_add_u32 m0, s70, 28672
s_add_u32 s71, s48, 5013504
buffer_load_dwordx4 v63, s[8:11], s71 offen lds
s_add_u32 m0, s70, 29696
s_add_u32 s71, s49, 5013504
buffer_load_dwordx4 v63, s[12:15], s71 offen lds
s_add_u32 m0, s70, 30720
s_add_u32 s71, s50, 5013504
buffer_load_dwordx4 v63, s[8:11], s71 offen lds
s_add_u32 m0, s70, 31744
s_add_u32 s71, s51, 5013504
buffer_load_dwordx4 v63, s[12:15], s71 offen lds
s_waitcnt vmcnt(36)
ds_read_b64_tr_b16 a[32:33], v60 offset:32768
ds_read_b64_tr_b16 a[34:35], v60 offset:33024
ds_read_b64_tr_b16 a[104:105], v61 offset:32768
ds_read_b64_tr_b16 a[106:107], v61 offset:33024
ds_read_b64_tr_b16 a[176:177], v62 offset:32768
ds_read_b64_tr_b16 a[178:179], v62 offset:33024
s_waitcnt vmcnt(32)
ds_read_b64_tr_b16 a[36:37], v60 offset:36864
ds_read_b64_tr_b16 a[38:39], v60 offset:37120
ds_read_b64_tr_b16 a[108:109], v61 offset:36864
ds_read_b64_tr_b16 a[110:111], v61 offset:37120
ds_read_b64_tr_b16 a[180:181], v62 offset:36864
ds_read_b64_tr_b16 a[182:183], v62 offset:37120
s_waitcnt vmcnt(28)
ds_read_b64_tr_b16 a[40:41], v60 offset:0
ds_read_b64_tr_b16 a[42:43], v60 offset:256
ds_read_b64_tr_b16 a[112:113], v61 offset:0
ds_read_b64_tr_b16 a[114:115], v61 offset:256
ds_read_b64_tr_b16 a[184:185], v62 offset:0
ds_read_b64_tr_b16 a[186:187], v62 offset:256
s_waitcnt vmcnt(24)
ds_read_b64_tr_b16 a[44:45], v60 offset:4096
ds_read_b64_tr_b16 a[46:47], v60 offset:4352
ds_read_b64_tr_b16 a[116:117], v61 offset:4096
ds_read_b64_tr_b16 a[118:119], v61 offset:4352
ds_read_b64_tr_b16 a[188:189], v62 offset:4096
ds_read_b64_tr_b16 a[190:191], v62 offset:4352
s_waitcnt vmcnt(20)
ds_read_b64_tr_b16 a[48:49], v60 offset:8192
ds_read_b64_tr_b16 a[50:51], v60 offset:8448
ds_read_b64_tr_b16 a[120:121], v61 offset:8192
ds_read_b64_tr_b16 a[122:123], v61 offset:8448
ds_read_b64_tr_b16 a[192:193], v62 offset:8192
ds_read_b64_tr_b16 a[194:195], v62 offset:8448
s_waitcnt vmcnt(16)
ds_read_b64_tr_b16 a[52:53], v60 offset:12288
ds_read_b64_tr_b16 a[54:55], v60 offset:12544
ds_read_b64_tr_b16 a[124:125], v61 offset:12288
ds_read_b64_tr_b16 a[126:127], v61 offset:12544
ds_read_b64_tr_b16 a[196:197], v62 offset:12288
ds_read_b64_tr_b16 a[198:199], v62 offset:12544
s_waitcnt vmcnt(12)
ds_read_b64_tr_b16 a[56:57], v60 offset:16384
ds_read_b64_tr_b16 a[58:59], v60 offset:16640
ds_read_b64_tr_b16 a[128:129], v61 offset:16384
ds_read_b64_tr_b16 a[130:131], v61 offset:16640
ds_read_b64_tr_b16 a[200:201], v62 offset:16384
ds_read_b64_tr_b16 a[202:203], v62 offset:16640
s_waitcnt vmcnt(8)
ds_read_b64_tr_b16 a[60:61], v60 offset:20480
ds_read_b64_tr_b16 a[62:63], v60 offset:20736
ds_read_b64_tr_b16 a[132:133], v61 offset:20480
ds_read_b64_tr_b16 a[134:135], v61 offset:20736
ds_read_b64_tr_b16 a[204:205], v62 offset:20480
ds_read_b64_tr_b16 a[206:207], v62 offset:20736
s_waitcnt vmcnt(4)
ds_read_b64_tr_b16 a[64:65], v60 offset:24576
ds_read_b64_tr_b16 a[66:67], v60 offset:24832
ds_read_b64_tr_b16 a[136:137], v61 offset:24576
ds_read_b64_tr_b16 a[138:139], v61 offset:24832
ds_read_b64_tr_b16 a[208:209], v62 offset:24576
ds_read_b64_tr_b16 a[210:211], v62 offset:24832
s_waitcnt vmcnt(0)
ds_read_b64_tr_b16 a[68:69], v60 offset:28672
ds_read_b64_tr_b16 a[70:71], v60 offset:28928
ds_read_b64_tr_b16 a[140:141], v61 offset:28672
ds_read_b64_tr_b16 a[142:143], v61 offset:28928
ds_read_b64_tr_b16 a[212:213], v62 offset:28672
ds_read_b64_tr_b16 a[214:215], v62 offset:28928
s_waitcnt lgkmcnt(0)
v_lshrrev_b32 v1, 3, v0
v_bfe_u32 v2, v0, 1, 2
v_lshrrev_b32 v3, 5, v0
v_lshlrev_b32 v3, 1, v3
v_xor_b32 v2, v2, v3
v_mul_u32_u24 v1, 2304, v1
v_lshl_add_u32 v1, v2, 5, v1
v_and_b32 v2, 1, v0
v_lshl_add_u32 v1, v2, 4, v1
s_and_b32 s70, s3, 1
s_mul_i32 s70, s70, 18432
s_lshr_b32 s71, s3, 1
s_lshl_b32 s71, s71, 7
s_add_u32 s70, s70, s71
v_add_u32 v1, s70, v1
v_add_u32 v8, 4096, v1
v_add_u32 v9, 3328, v1
v_add_u32 v10, 2560, v1
v_add_u32 v11, 1792, v1
v_add_u32 v12, 5120, v1
v_add_u32 v13, 4352, v1
v_add_u32 v14, 3584, v1
v_add_u32 v15, 2816, v1
v_add_u32 v16, 6144, v1
v_bfe_u32 v1, v0, 1, 3
v_lshlrev_b32 v1, 7, v1
v_lshrrev_b32 v2, 4, v0
v_bfe_u32 v3, v0, 3, 1
v_lshlrev_b32 v3, 1, v3
v_xor_b32 v2, v2, v3
v_lshl_add_u32 v1, v2, 5, v1
v_and_b32 v2, 1, v0
v_lshl_add_u32 v17, v2, 4, v1
v_and_b32 v2, 31, v0
v_add_u32 v1, 0, v2
v_mul_u32_u24 v1, 128, v1
v_lshrrev_b32 v3, 5, v0
v_mul_u32_u24 v3, 32768, v3
v_add_u32 v1, 21504, v1
v_add_u32 v1, v1, v3
v_mov_b32 v3, 2147483632
s_cmp_eq_u32 s3, 0
s_cselect_b32 s71, 16, 0
v_cmp_gt_u32 vcc, s71, v2
s_nop 1
v_cndmask_b32 v22, v3, v1, vcc
s_mov_b32 s56, 0xffff
s_mul_i32 s70, s74, 128
s_add_u32 s70, s70, 23552
v_mov_b32 v1, s70
s_min_u32 s71, s71, 1
v_cmp_gt_u32 vcc, s71, v0
s_nop 1
v_cndmask_b32 v44, v3, v1, vcc
v_add_u32 v45, 65536, v44
s_getpc_b64 s[96:97]
pc_146:
s_add_u32 s96, s96, L_writers-pc_146
s_addc_u32 s97, s97, 0
v_subrev_u32 v23, 0, v22
v_lshrrev_b32 v23, 7, v23
v_cmp_gt_u32 vcc, 0x200, v23
s_nop 1
v_cndmask_b32 v23, 0, v23, vcc
global_load_ubyte v23, v23, s[96:97]
s_mov_b32 s44, 6062080
s_mov_b32 s45, 161521664
s_mov_b32 s52, 1
s_mov_b32 s53, 0
s_mov_b32 s46, 8421376
s_mov_b32 s47, 180396032
s_mov_b32 s54, 1
s_mov_b32 s55, 32768
s_mov_b32 s25, 200
s_mov_b32 s20, 36864
s_mov_b32 s21, 294912
s_mov_b32 s8, s42
s_and_b32 s9, s43, 0xffff
s_mov_b32 s10, 0
s_mov_b32 s11, 0x20000
s_mov_b32 s22, 0
s_mul_i32 s48, s3, 9216
s_add_u32 s49, s48, 36864
s_add_u32 s50, s48, 73728
s_add_u32 s51, s48, 110592
s_mov_b32 s57, 0xbfb8aa3b
v_add_u32 v28, 0, v17
v_add_u32 v29, 36864, v17
v_add_u32 v30, 73728, v17
v_add_u32 v31, 110592, v17
v_lshlrev_b32 v1, 2, v0
v_add_u32 v32, 147456, v1
s_lshl_b32 s70, s3, 8
v_add_u32 v18, s70, v32
v_mov_b64 v[224:225], 0
v_mov_b64 v[236:237], 0
v_mov_b64 v[226:227], 0
v_mov_b64 v[238:239], 0
v_mov_b64 v[228:229], 0
v_mov_b64 v[240:241], 0
v_mov_b64 v[230:231], 0
v_mov_b64 v[242:243], 0
s_mov_b32 s12, s40
s_and_b32 s13, s41, 0xffff
s_mov_b32 s14, 256
s_mov_b32 s15, 0x20000
v_lshlrev_b32 v26, 2, v0
v_add_u32 v27, 128, v26
v_cmp_le_u32 vcc, 2, v0
s_nop 1
v_cndmask_b32 v26, v26, v27, vcc
v_mov_b32 v27, 192
v_cmp_eq_u32 vcc, 8, v0
s_nop 1
v_cndmask_b32 v26, v26, v27, vcc
v_mov_b32 v27, 2147483632
v_cmp_lt_u32 vcc, 8, v0
s_nop 1
v_cndmask_b32 v26, v26, v27, vcc
s_mov_b32 s98, 0
wi_loop_152:
buffer_load_dword v27, v26, s[12:15], 0 offen sc1
s_add_u32 s98, s98, 1
s_cmp_gt_u32 s98, 150000
s_cbranch_scc1 wi_bad_154
s_waitcnt vmcnt(0)
v_cmp_eq_u32 vcc, 32, v27
s_nop 0
s_and_b32 s97, vcc_lo, 0x1ff
s_cmp_eq_u32 s97, 0x1ff
s_cbranch_scc1 wi_ok_153
v_cmp_lt_u32 vcc, 32, v27
s_nop 0
s_and_b32 s96, vcc_lo, 0xff
s_cselect_b32 s96, 0x100, 0
s_and_b32 s96, s96, s97
s_cbranch_scc1 wi_over_155
s_sleep 8
s_branch wi_loop_152
wi_bad_154:
s_mov_b32 s98, 512
s_branch L_fail
wi_over_155:
s_mov_b32 s100, 255
wi_ok_153:
v_add_u32 v26, 65536, v22
v_cmp_eq_u32 vcc, s100, v23
s_nop 1
v_cndmask_b32 v22, v22, v26, vcc
v_mov_b32 v26, 2147483632
s_cmp_lg_u32 s100, 255
s_cselect_b64 vcc, -1, 0
v_cndmask_b32 v44, v44, v26, vcc
s_cselect_b32 s38, 1, 0
s_mov_b32 s90, 0
s_mov_b32 s91, 1879048192
s_mov_b32 s93, 1879048192
v_mov_b32 v34, 2147483632
s_barrier
s_mov_b32 s95, 1
s_cmp_lg_u32 s3, 0
s_cbranch_scc1 sp_ok_157_j
s_mov_b32 s23, 0
sp_loop_156:
buffer_load_dword v33, v22, s[4:7], 0 offen sc1
s_add_u32 s23, s23, 1
s_cmp_gt_u32 s23, 150000
s_cbranch_scc1 sp_bad_158
s_waitcnt vmcnt(0)
sp_loop_156_e:
v_cmp_gt_u32 vcc, s52, v33
v_cmp_gt_u32 s[58:59], s54, v33
s_and_b32 vcc_lo, vcc_lo, s56
s_cbranch_scc0 sp_ok_157
s_cmp_gt_u32 s23, 4
s_cselect_b32 s70, 0, s56
s_cmp_lg_u32 s95, 0
s_cselect_b32 s70, 0, s70
s_or_b32 s59, s59, s70
s_and_b32 s59, s59, s56
s_cbranch_scc0 sp_ok_157
s_sleep 1
s_branch sp_loop_156
sp_bad_158:
s_mov_b32 s98, 1028
s_branch L_fail
sp_ok_157:
ds_write_b32 v18, v33
s_waitcnt lgkmcnt(0)
sp_ok_157_j:
s_barrier
ds_read_b32 v33, v32
s_waitcnt lgkmcnt(0)
v_cmp_gt_u32 vcc, s52, v33
v_cmp_gt_u32 s[58:59], s54, v33
s_and_b32 vcc_lo, vcc_lo, s56
s_cselect_b32 s70, 0, 1
s_and_b32 s59, s59, s56
s_cselect_b32 s71, 0, 1
s_or_b32 s76, s70, s71
s_cselect_b32 s10, 268435456, 0
s_cmp_lg_u32 s70, 0
s_cselect_b64 s[72:73], s[52:53], s[54:55]
s_cselect_b64 s[58:59], s[44:45], s[46:47]
s_mul_i32 s74, s72, s20
s_add_u32 s74, s74, s58
s_mul_i32 s75, s72, s21
s_add_u32 s75, s75, s59
s_andn2_b32 s71, s71, s70
s_add_u32 s52, s52, s70
s_add_u32 s54, s54, s71
s_mov_b32 s77, s76
s_add_u32 m0, s48, 0
s_nop 0
buffer_load_dwordx4 v8, s[4:7], s74 offen offset:0 sc1 lds
buffer_load_dwordx4 v9, s[4:7], s74 offen offset:1024 sc1 lds
buffer_load_dwordx4 v10, s[4:7], s74 offen offset:2048 sc1 lds
buffer_load_dwordx4 v11, s[4:7], s74 offen offset:3072 sc1 lds
s_add_u32 m0, s48, 4096
s_nop 0
buffer_load_dwordx4 v12, s[4:7], s74 offen offset:0 sc1 lds
buffer_load_dwordx4 v13, s[4:7], s74 offen offset:1024 sc1 lds
buffer_load_dwordx4 v14, s[4:7], s74 offen offset:2048 sc1 lds
buffer_load_dwordx4 v15, s[4:7], s74 offen offset:3072 sc1 lds
s_add_u32 m0, s48, 8192
s_nop 0
buffer_load_dwordx4 v16, s[4:7], s74 offen offset:0 sc1 lds
buffer_store_dword v27, v34, s[4:7], 0 offen
buffer_load_dword v24, v22, s[4:7], 0 offen sc1
v_mov_b32 v27, s90
s_waitcnt vmcnt(9)
s_barrier
buffer_store_dword v27, v45, s[4:7], s91 offen
buffer_store_dword v27, v44, s[4:7], s91 offen sc1
s_mov_b32 s91, 1879048192
ds_read_b128 v[64:67], v28 offset:0
ds_read_b128 v[68:71], v28 offset:9216
ds_read_b128 v[72:75], v28 offset:18432
ds_read_b128 v[76:79], v28 offset:27648
ds_read_b128 v[80:83], v28 offset:1024
ds_read_b128 v[84:87], v28 offset:10240
ds_read_b128 v[88:91], v28 offset:19456
ds_read_b128 v[92:95], v28 offset:28672
s_waitcnt vmcnt(8)
s_barrier
s_branch g_body_147
g_body_147:
s_waitcnt lgkmcnt(4)
v_mfma_f32_16x16x32_bf16 v[208:211], a[0:3], v[64:67], 0
ds_read_b128 v[96:99], v28 offset:2048
v_mfma_f32_16x16x32_bf16 v[212:215], a[0:3], v[68:71], 0
ds_read_b128 v[100:103], v28 offset:11264
v_mfma_f32_16x16x32_bf16 v[208:211], a[4:7], v[72:75], v[208:211]
ds_read_b128 v[104:107], v28 offset:20480
v_mfma_f32_16x16x32_bf16 v[212:215], a[4:7], v[76:79], v[212:215]
ds_read_b128 v[108:111], v28 offset:29696
v_mul_f32 v224, v224, v236
v_mul_f32 v225, v225, v237
v_mul_f32 v226, v226, v238
v_mul_f32 v227, v227, v239
v_mul_f32 v228, v228, v240
v_mfma_f32_16x16x32_bf16 v[216:219], a[72:75], v[64:67], 0
v_mul_f32 v229, v229, v241
s_waitcnt lgkmcnt(4)
v_mfma_f32_16x16x32_bf16 v[208:211], a[8:11], v[80:83], v[208:211]
ds_read_b128 v[112:115], v28 offset:3072
v_mul_f32 v230, v230, v242
v_mfma_f32_16x16x32_bf16 v[212:215], a[8:11], v[84:87], v[212:215]
ds_read_b128 v[116:119], v28 offset:12288
v_mul_f32 v231, v231, v243
v_mfma_f32_16x16x32_bf16 v[208:211], a[12:15], v[88:91], v[208:211]
ds_read_b128 v[120:123], v28 offset:21504
v_cvt_pk_bf16_f32 v52, v224, v225
v_mfma_f32_16x16x32_bf16 v[212:215], a[12:15], v[92:95], v[212:215]
ds_read_b128 v[124:127], v28 offset:30720
v_cvt_pk_bf16_f32 v53, v226, v227
v_mfma_f32_16x16x32_bf16 v[220:223], a[72:75], v[68:71], 0
v_cvt_pk_bf16_f32 v54, v228, v229
s_waitcnt lgkmcnt(4)
v_mfma_f32_16x16x32_bf16 v[208:211], a[16:19], v[96:99], v[208:211]
ds_read_b128 v[128:131], v28 offset:4096
v_cvt_pk_bf16_f32 v55, v230, v231
v_mfma_f32_16x16x32_bf16 v[212:215], a[16:19], v[100:103], v[212:215]
ds_read_b128 v[132:135], v28 offset:13312
v_permlane16_swap_b32 v52, v54
v_mfma_f32_16x16x32_bf16 v[208:211], a[20:23], v[104:107], v[208:211]
ds_read_b128 v[136:139], v28 offset:22528
v_permlane16_swap_b32 v53, v55
v_mfma_f32_16x16x32_bf16 v[212:215], a[20:23], v[108:111], v[212:215]
ds_read_b128 v[140:143], v28 offset:31744
buffer_store_dwordx4 v[52:55], v20, s[4:7], s93 offen sc1
v_mfma_f32_16x16x32_bf16 v[216:219], a[76:79], v[72:75], v[216:219]
s_waitcnt vmcnt(5)
s_barrier
s_waitcnt lgkmcnt(4)
v_mfma_f32_16x16x32_bf16 v[208:211], a[24:27], v[112:115], v[208:211]
ds_read_b128 v[144:147], v28 offset:5120
v_mov_b32 v27, s90
v_mfma_f32_16x16x32_bf16 v[212:215], a[24:27], v[116:119], v[212:215]
ds_read_b128 v[148:151], v28 offset:14336
v_mfma_f32_16x16x32_bf16 v[208:211], a[28:31], v[120:123], v[208:211]
ds_read_b128 v[152:155], v28 offset:23552
v_mfma_f32_16x16x32_bf16 v[212:215], a[28:31], v[124:127], v[212:215]
ds_read_b128 v[156:159], v28 offset:32768
v_mfma_f32_16x16x32_bf16 v[220:223], a[76:79], v[76:79], v[220:223]
s_waitcnt lgkmcnt(4)
v_mfma_f32_16x16x32_bf16 v[208:211], a[32:35], v[128:131], v[208:211]
ds_read_b128 v[160:163], v28 offset:6144
v_mfma_f32_16x16x32_bf16 v[212:215], a[32:35], v[132:135], v[212:215]
ds_read_b128 v[164:167], v28 offset:15360
v_mfma_f32_16x16x32_bf16 v[208:211], a[36:39], v[136:139], v[208:211]
ds_read_b128 v[168:171], v28 offset:24576
v_mfma_f32_16x16x32_bf16 v[212:215], a[36:39], v[140:143], v[212:215]
ds_read_b128 v[172:175], v28 offset:33792
v_mfma_f32_16x16x32_bf16 v[216:219], a[80:83], v[80:83], v[216:219]
s_waitcnt lgkmcnt(4)
v_mfma_f32_16x16x32_bf16 v[208:211], a[40:43], v[144:147], v[208:211]
ds_read_b128 v[176:179], v28 offset:7168
v_mfma_f32_16x16x32_bf16 v[212:215], a[40:43], v[148:151], v[212:215]
ds_read_b128 v[180:183], v28 offset:16384
v_mfma_f32_16x16x32_bf16 v[208:211], a[44:47], v[152:155], v[208:211]
ds_read_b128 v[184:187], v28 offset:25600
v_mfma_f32_16x16x32_bf16 v[212:215], a[44:47], v[156:159], v[212:215]
ds_read_b128 v[188:191], v28 offset:34816
v_mfma_f32_16x16x32_bf16 v[220:223], a[80:83], v[84:87], v[220:223]
s_waitcnt lgkmcnt(4)
v_mfma_f32_16x16x32_bf16 v[208:211], a[48:51], v[160:163], v[208:211]
ds_read_b128 v[192:195], v28 offset:8192
v_mfma_f32_16x16x32_bf16 v[212:215], a[48:51], v[164:167], v[212:215]
ds_read_b128 v[196:199], v28 offset:17408
s_waitcnt vmcnt(3)
ds_write_b32 v18, v24
v_mfma_f32_16x16x32_bf16 v[208:211], a[52:55], v[168:171], v[208:211]
ds_read_b128 v[200:203], v28 offset:26624
v_mfma_f32_16x16x32_bf16 v[212:215], a[52:55], v[172:175], v[212:215]
ds_read_b128 v[204:207], v28 offset:35840
v_mfma_f32_16x16x32_bf16 v[216:219], a[84:87], v[88:91], v[216:219]
s_waitcnt lgkmcnt(2)
s_barrier
v_mfma_f32_16x16x32_bf16 v[208:211], a[56:59], v[176:179], v[208:211]
ds_read_b32 v33, v32
v_mfma_f32_16x16x32_bf16 v[212:215], a[56:59], v[180:183], v[212:215]
v_mfma_f32_16x16x32_bf16 v[208:211], a[60:63], v[184:187], v[208:211]
v_mfma_f32_16x16x32_bf16 v[212:215], a[60:63], v[188:191], v[212:215]
s_waitcnt lgkmcnt(0)
v_cmp_gt_u32 vcc, s52, v33
v_mfma_f32_16x16x32_bf16 v[220:223], a[84:87], v[92:95], v[220:223]
v_cmp_gt_u32 s[58:59], s54, v33
v_mfma_f32_16x16x32_bf16 v[208:211], a[64:67], v[192:195], v[208:211]
s_and_b32 vcc_lo, vcc_lo, s56
s_cselect_b32 s70, 0, 1
v_mfma_f32_16x16x32_bf16 v[212:215], a[64:67], v[196:199], v[212:215]
s_and_b32 s59, s59, s56
s_cselect_b32 s71, 0, s77
v_mfma_f32_16x16x32_bf16 v[208:211], a[68:71], v[200:203], v[208:211]
s_or_b32 s82, s70, s71
s_cselect_b32 s10, 268435456, 0
v_mfma_f32_16x16x32_bf16 v[212:215], a[68:71], v[204:207], v[212:215]
s_cmp_lg_u32 s70, 0
s_cselect_b64 s[78:79], s[52:53], s[54:55]
s_cselect_b64 s[58:59], s[44:45], s[46:47]
v_mfma_f32_16x16x32_bf16 v[216:219], a[88:91], v[96:99], v[216:219]
s_mul_i32 s80, s78, s20
s_add_u32 s80, s80, s58
v_mfma_f32_16x16x32_bf16 v[220:223], a[88:91], v[100:103], v[220:223]
s_add_u32 m0, s49, 0
s_mul_i32 s81, s78, s21
s_add_u32 s81, s81, s59
v_mfma_f32_16x16x32_bf16 v[216:219], a[92:95], v[104:107], v[216:219]
buffer_load_dwordx4 v8, s[8:11], s80 offen offset:0 sc1 lds
v_mfma_f32_16x16x32_bf16 v[220:223], a[92:95], v[108:111], v[220:223]
s_andn2_b32 s71, s71, s70
s_add_u32 s52, s52, s70
s_add_u32 s54, s54, s71
v_mfma_f32_16x16x32_bf16 v[216:219], a[96:99], v[112:115], v[216:219]
s_mov_b32 s83, s82
v_mfma_f32_16x16x32_bf16 v[220:223], a[96:99], v[116:119], v[220:223]
buffer_load_dwordx4 v9, s[8:11], s80 offen offset:1024 sc1 lds
v_mfma_f32_16x16x32_bf16 v[216:219], a[100:103], v[120:123], v[216:219]
v_permlane32_swap_b32 v208, v212
v_mfma_f32_16x16x32_bf16 v[220:223], a[100:103], v[124:127], v[220:223]
v_permlane32_swap_b32 v209, v213
v_mfma_f32_16x16x32_bf16 v[216:219], a[104:107], v[128:131], v[216:219]
buffer_load_dwordx4 v10, s[8:11], s80 offen offset:2048 sc1 lds
v_mfma_f32_16x16x32_bf16 v[220:223], a[104:107], v[132:135], v[220:223]
v_permlane32_swap_b32 v210, v214
v_mfma_f32_16x16x32_bf16 v[216:219], a[108:111], v[136:139], v[216:219]
v_permlane32_swap_b32 v211, v215
v_mfma_f32_16x16x32_bf16 v[220:223], a[108:111], v[140:143], v[220:223]
buffer_load_dwordx4 v11, s[8:11], s80 offen offset:3072 sc1 lds
v_mfma_f32_16x16x32_bf16 v[216:219], a[112:115], v[144:147], v[216:219]
v_mul_f32 v232, s57, v208
v_mul_f32 v233, s57, v209
v_mfma_f32_16x16x32_bf16 v[220:223], a[112:115], v[148:151], v[220:223]
s_add_u32 m0, s49, 4096
v_mul_f32 v234, s57, v210
v_mfma_f32_16x16x32_bf16 v[216:219], a[116:119], v[152:155], v[216:219]
buffer_load_dwordx4 v12, s[8:11], s80 offen offset:0 sc1 lds
v_mfma_f32_16x16x32_bf16 v[220:223], a[116:119], v[156:159], v[220:223]
v_mul_f32 v235, s57, v211
v_mfma_f32_16x16x32_bf16 v[216:219], a[120:123], v[160:163], v[216:219]
v_exp_f32 v232, v232
v_mfma_f32_16x16x32_bf16 v[220:223], a[120:123], v[164:167], v[220:223]
buffer_load_dwordx4 v13, s[8:11], s80 offen offset:1024 sc1 lds
v_mfma_f32_16x16x32_bf16 v[216:219], a[124:127], v[168:171], v[216:219]
v_exp_f32 v233, v233
v_mfma_f32_16x16x32_bf16 v[220:223], a[124:127], v[172:175], v[220:223]
v_exp_f32 v234, v234
v_mfma_f32_16x16x32_bf16 v[216:219], a[128:131], v[176:179], v[216:219]
buffer_load_dwordx4 v14, s[8:11], s80 offen offset:2048 sc1 lds
v_mfma_f32_16x16x32_bf16 v[220:223], a[128:131], v[180:183], v[220:223]
v_exp_f32 v235, v235
v_mfma_f32_16x16x32_bf16 v[216:219], a[132:135], v[184:187], v[216:219]
v_add_f32 v232, 1.0, v232
v_add_f32 v233, 1.0, v233
v_mfma_f32_16x16x32_bf16 v[220:223], a[132:135], v[188:191], v[220:223]
buffer_load_dwordx4 v15, s[8:11], s80 offen offset:3072 sc1 lds
v_mfma_f32_16x16x32_bf16 v[216:219], a[136:139], v[192:195], v[216:219]
v_add_f32 v234, 1.0, v234
v_add_f32 v235, 1.0, v235
v_mfma_f32_16x16x32_bf16 v[220:223], a[136:139], v[196:199], v[220:223]
s_add_u32 m0, s49, 8192
v_mfma_f32_16x16x32_bf16 v[216:219], a[140:143], v[200:203], v[216:219]
buffer_load_dwordx4 v16, s[8:11], s80 offen offset:0 sc1 lds
v_mfma_f32_16x16x32_bf16 v[220:223], a[140:143], v[204:207], v[220:223]
v_rcp_f32 v232, v232
v_mfma_f32_16x16x32_bf16 v[224:227], a[144:147], v[64:67], 0
v_rcp_f32 v233, v233
v_mfma_f32_16x16x32_bf16 v[228:231], a[144:147], v[68:71], 0
v_rcp_f32 v234, v234
v_mfma_f32_16x16x32_bf16 v[224:227], a[148:151], v[72:75], v[224:227]
v_rcp_f32 v235, v235
v_mfma_f32_16x16x32_bf16 v[228:231], a[148:151], v[76:79], v[228:231]
v_mul_f32 v212, v208, v212
v_mul_f32 v213, v209, v213
v_mfma_f32_16x16x32_bf16 v[224:227], a[152:155], v[80:83], v[224:227]
v_mul_f32 v214, v210, v214
v_mul_f32 v215, v211, v215
v_mfma_f32_16x16x32_bf16 v[228:231], a[152:155], v[84:87], v[228:231]
v_mul_f32 v212, v212, v232
v_mul_f32 v213, v213, v233
v_mul_f32 v236, s57, v216
v_mul_f32 v237, s57, v217
v_mul_f32 v238, s57, v218
v_mul_f32 v239, s57, v219
v_exp_f32 v236, v236
v_exp_f32 v237, v237
v_exp_f32 v238, v238
v_exp_f32 v239, v239
v_add_f32 v236, 1.0, v236
v_add_f32 v237, 1.0, v237
v_add_f32 v238, 1.0, v238
v_add_f32 v239, 1.0, v239
v_mfma_f32_16x16x32_bf16 v[224:227], a[156:159], v[88:91], v[224:227]
v_mul_f32 v214, v214, v234
v_mul_f32 v215, v215, v235
v_mfma_f32_16x16x32_bf16 v[228:231], a[156:159], v[92:95], v[228:231]
v_cvt_pk_bf16_f32 v48, v212, v213
v_cvt_pk_bf16_f32 v49, v214, v215
v_mfma_f32_16x16x32_bf16 v[224:227], a[160:163], v[96:99], v[224:227]
buffer_store_dwordx2 v[48:49], v19, s[4:7], s75 offen sc1
v_mfma_f32_16x16x32_bf16 v[228:231], a[160:163], v[100:103], v[228:231]
v_rcp_f32 v236, v236
v_mfma_f32_16x16x32_bf16 v[224:227], a[164:167], v[104:107], v[224:227]
v_rcp_f32 v237, v237
v_mfma_f32_16x16x32_bf16 v[228:231], a[164:167], v[108:111], v[228:231]
v_rcp_f32 v238, v238
v_mfma_f32_16x16x32_bf16 v[224:227], a[168:171], v[112:115], v[224:227]
v_rcp_f32 v239, v239
v_mfma_f32_16x16x32_bf16 v[228:231], a[168:171], v[116:119], v[228:231]
v_mul_f32 v240, s57, v220
v_mul_f32 v241, s57, v221
v_mfma_f32_16x16x32_bf16 v[224:227], a[172:175], v[120:123], v[224:227]
v_mul_f32 v242, s57, v222
v_mul_f32 v243, s57, v223
v_mfma_f32_16x16x32_bf16 v[228:231], a[172:175], v[124:127], v[228:231]
v_mul_f32 v236, v216, v236
v_mul_f32 v237, v217, v237
v_mfma_f32_16x16x32_bf16 v[224:227], a[176:179], v[128:131], v[224:227]
v_mul_f32 v238, v218, v238
v_mul_f32 v239, v219, v239
v_mfma_f32_16x16x32_bf16 v[228:231], a[176:179], v[132:135], v[228:231]
v_exp_f32 v240, v240
v_mfma_f32_16x16x32_bf16 v[224:227], a[180:183], v[136:139], v[224:227]
v_exp_f32 v241, v241
v_mfma_f32_16x16x32_bf16 v[228:231], a[180:183], v[140:143], v[228:231]
v_exp_f32 v242, v242
v_mfma_f32_16x16x32_bf16 v[224:227], a[184:187], v[144:147], v[224:227]
v_exp_f32 v243, v243
v_mfma_f32_16x16x32_bf16 v[228:231], a[184:187], v[148:151], v[228:231]
v_add_f32 v240, 1.0, v240
v_add_f32 v241, 1.0, v241
v_mfma_f32_16x16x32_bf16 v[224:227], a[188:191], v[152:155], v[224:227]
buffer_load_dword v24, v22, s[4:7], 0 offen sc1
v_mfma_f32_16x16x32_bf16 v[228:231], a[188:191], v[156:159], v[228:231]
v_add_f32 v242, 1.0, v242
v_add_f32 v243, 1.0, v243
v_mfma_f32_16x16x32_bf16 v[224:227], a[192:195], v[160:163], v[224:227]
s_waitcnt vmcnt(9)
s_barrier
v_mfma_f32_16x16x32_bf16 v[228:231], a[192:195], v[164:167], v[228:231]
buffer_store_dword v27, v45, s[4:7], s91 offen
v_mfma_f32_16x16x32_bf16 v[224:227], a[196:199], v[168:171], v[224:227]
buffer_store_dword v27, v44, s[4:7], s91 offen sc1
s_cmp_eq_u32 s82, 0
s_cbranch_scc1 g_slow_159
v_mfma_f32_16x16x32_bf16 v[228:231], a[196:199], v[172:175], v[228:231]
v_rcp_f32 v240, v240
ds_read_b128 v[64:67], v29 offset:0
v_mfma_f32_16x16x32_bf16 v[224:227], a[200:203], v[176:179], v[224:227]
v_rcp_f32 v241, v241
ds_read_b128 v[68:71], v29 offset:9216
v_mfma_f32_16x16x32_bf16 v[228:231], a[200:203], v[180:183], v[228:231]
v_rcp_f32 v242, v242
ds_read_b128 v[72:75], v29 offset:18432
v_mfma_f32_16x16x32_bf16 v[224:227], a[204:207], v[184:187], v[224:227]
v_rcp_f32 v243, v243
ds_read_b128 v[76:79], v29 offset:27648
v_mfma_f32_16x16x32_bf16 v[228:231], a[204:207], v[188:191], v[228:231]
v_mul_f32 v240, v220, v240
ds_read_b128 v[80:83], v29 offset:1024
v_mfma_f32_16x16x32_bf16 v[224:227], a[208:211], v[192:195], v[224:227]
v_mul_f32 v241, v221, v241
ds_read_b128 v[84:87], v29 offset:10240
v_mfma_f32_16x16x32_bf16 v[228:231], a[208:211], v[196:199], v[228:231]
v_mul_f32 v242, v222, v242
ds_read_b128 v[88:91], v29 offset:19456
v_mfma_f32_16x16x32_bf16 v[224:227], a[212:215], v[200:203], v[224:227]
v_mul_f32 v243, v223, v243
ds_read_b128 v[92:95], v29 offset:28672
v_mfma_f32_16x16x32_bf16 v[228:231], a[212:215], v[204:207], v[228:231]
s_waitcnt vmcnt(8)
s_barrier
g_body_148:
s_waitcnt lgkmcnt(4)
v_mfma_f32_16x16x32_bf16 v[208:211], a[0:3], v[64:67], 0
ds_read_b128 v[96:99], v29 offset:2048
v_mfma_f32_16x16x32_bf16 v[212:215], a[0:3], v[68:71], 0
ds_read_b128 v[100:103], v29 offset:11264
v_mfma_f32_16x16x32_bf16 v[208:211], a[4:7], v[72:75], v[208:211]
ds_read_b128 v[104:107], v29 offset:20480
v_mfma_f32_16x16x32_bf16 v[212:215], a[4:7], v[76:79], v[212:215]
ds_read_b128 v[108:111], v29 offset:29696
v_mul_f32 v224, v224, v236
v_mul_f32 v225, v225, v237
v_mul_f32 v226, v226, v238
v_mul_f32 v227, v227, v239
v_mul_f32 v228, v228, v240
v_mfma_f32_16x16x32_bf16 v[216:219], a[72:75], v[64:67], 0
v_mul_f32 v229, v229, v241
s_waitcnt lgkmcnt(4)
v_mfma_f32_16x16x32_bf16 v[208:211], a[8:11], v[80:83], v[208:211]
ds_read_b128 v[112:115], v29 offset:3072
v_mul_f32 v230, v230, v242
v_mfma_f32_16x16x32_bf16 v[212:215], a[8:11], v[84:87], v[212:215]
ds_read_b128 v[116:119], v29 offset:12288
v_mul_f32 v231, v231, v243
v_mfma_f32_16x16x32_bf16 v[208:211], a[12:15], v[88:91], v[208:211]
ds_read_b128 v[120:123], v29 offset:21504
v_cvt_pk_bf16_f32 v52, v224, v225
v_mfma_f32_16x16x32_bf16 v[212:215], a[12:15], v[92:95], v[212:215]
ds_read_b128 v[124:127], v29 offset:30720
v_cvt_pk_bf16_f32 v53, v226, v227
v_mfma_f32_16x16x32_bf16 v[220:223], a[72:75], v[68:71], 0
v_cvt_pk_bf16_f32 v54, v228, v229
s_waitcnt lgkmcnt(4)
v_mfma_f32_16x16x32_bf16 v[208:211], a[16:19], v[96:99], v[208:211]
ds_read_b128 v[128:131], v29 offset:4096
v_cvt_pk_bf16_f32 v55, v230, v231
v_mfma_f32_16x16x32_bf16 v[212:215], a[16:19], v[100:103], v[212:215]
ds_read_b128 v[132:135], v29 offset:13312
v_permlane16_swap_b32 v52, v54
v_mfma_f32_16x16x32_bf16 v[208:211], a[20:23], v[104:107], v[208:211]
ds_read_b128 v[136:139], v29 offset:22528
v_permlane16_swap_b32 v53, v55
v_mfma_f32_16x16x32_bf16 v[212:215], a[20:23], v[108:111], v[212:215]
ds_read_b128 v[140:143], v29 offset:31744
buffer_store_dwordx4 v[52:55], v20, s[4:7], s75 offen sc1
v_mfma_f32_16x16x32_bf16 v[216:219], a[76:79], v[72:75], v[216:219]
s_waitcnt vmcnt(5)
s_barrier
s_waitcnt lgkmcnt(4)
v_mfma_f32_16x16x32_bf16 v[208:211], a[24:27], v[112:115], v[208:211]
ds_read_b128 v[144:147], v29 offset:5120
v_mov_b32 v27, s72
v_mfma_f32_16x16x32_bf16 v[212:215], a[24:27], v[116:119], v[212:215]
ds_read_b128 v[148:151], v29 offset:14336
v_mfma_f32_16x16x32_bf16 v[208:211], a[28:31], v[120:123], v[208:211]
ds_read_b128 v[152:155], v29 offset:23552
v_mfma_f32_16x16x32_bf16 v[212:215], a[28:31], v[124:127], v[212:215]
ds_read_b128 v[156:159], v29 offset:32768
v_mfma_f32_16x16x32_bf16 v[220:223], a[76:79], v[76:79], v[220:223]
s_waitcnt lgkmcnt(4)
v_mfma_f32_16x16x32_bf16 v[208:211], a[32:35], v[128:131], v[208:211]
ds_read_b128 v[160:163], v29 offset:6144
v_mfma_f32_16x16x32_bf16 v[212:215], a[32:35], v[132:135], v[212:215]
ds_read_b128 v[164:167], v29 offset:15360
v_mfma_f32_16x16x32_bf16 v[208:211], a[36:39], v[136:139], v[208:211]
ds_read_b128 v[168:171], v29 offset:24576
v_mfma_f32_16x16x32_bf16 v[212:215], a[36:39], v[140:143], v[212:215]
ds_read_b128 v[172:175], v29 offset:33792
v_mfma_f32_16x16x32_bf16 v[216:219], a[80:83], v[80:83], v[216:219]
s_waitcnt lgkmcnt(4)
v_mfma_f32_16x16x32_bf16 v[208:211], a[40:43], v[144:147], v[208:211]
ds_read_b128 v[176:179], v29 offset:7168
v_mfma_f32_16x16x32_bf16 v[212:215], a[40:43], v[148:151], v[212:215]
ds_read_b128 v[180:183], v29 offset:16384
v_mfma_f32_16x16x32_bf16 v[208:211], a[44:47], v[152:155], v[208:211]
ds_read_b128 v[184:187], v29 offset:25600
v_mfma_f32_16x16x32_bf16 v[212:215], a[44:47], v[156:159], v[212:215]
ds_read_b128 v[188:191], v29 offset:34816
v_mfma_f32_16x16x32_bf16 v[220:223], a[80:83], v[84:87], v[220:223]
s_waitcnt lgkmcnt(4)
v_mfma_f32_16x16x32_bf16 v[208:211], a[48:51], v[160:163], v[208:211]
ds_read_b128 v[192:195], v29 offset:8192
v_mfma_f32_16x16x32_bf16 v[212:215], a[48:51], v[164:167], v[212:215]
ds_read_b128 v[196:199], v29 offset:17408
s_waitcnt vmcnt(3)
ds_write_b32 v18, v24
v_mfma_f32_16x16x32_bf16 v[208:211], a[52:55], v[168:171], v[208:211]
ds_read_b128 v[200:203], v29 offset:26624
v_mfma_f32_16x16x32_bf16 v[212:215], a[52:55], v[172:175], v[212:215]
ds_read_b128 v[204:207], v29 offset:35840
v_mfma_f32_16x16x32_bf16 v[216:219], a[84:87], v[88:91], v[216:219]
s_waitcnt lgkmcnt(2)
s_barrier
v_mfma_f32_16x16x32_bf16 v[208:211], a[56:59], v[176:179], v[208:211]
ds_read_b32 v33, v32
v_mfma_f32_16x16x32_bf16 v[212:215], a[56:59], v[180:183], v[212:215]
v_mfma_f32_16x16x32_bf16 v[208:211], a[60:63], v[184:187], v[208:211]
v_mfma_f32_16x16x32_bf16 v[212:215], a[60:63], v[188:191], v[212:215]
s_waitcnt lgkmcnt(0)
v_cmp_gt_u32 vcc, s52, v33
v_mfma_f32_16x16x32_bf16 v[220:223], a[84:87], v[92:95], v[220:223]
v_cmp_gt_u32 s[58:59], s54, v33
v_mfma_f32_16x16x32_bf16 v[208:211], a[64:67], v[192:195], v[208:211]
s_and_b32 vcc_lo, vcc_lo, s56
s_cselect_b32 s70, 0, 1
v_mfma_f32_16x16x32_bf16 v[212:215], a[64:67], v[196:199], v[212:215]
s_and_b32 s59, s59, s56
s_cselect_b32 s71, 0, s83
v_mfma_f32_16x16x32_bf16 v[208:211], a[68:71], v[200:203], v[208:211]
s_or_b32 s88, s70, s71
s_cselect_b32 s10, 268435456, 0
v_mfma_f32_16x16x32_bf16 v[212:215], a[68:71], v[204:207], v[212:215]
s_cmp_lg_u32 s70, 0
s_cselect_b64 s[84:85], s[52:53], s[54:55]
s_cselect_b64 s[58:59], s[44:45], s[46:47]
v_mfma_f32_16x16x32_bf16 v[216:219], a[88:91], v[96:99], v[216:219]
s_mul_i32 s86, s84, s20
s_add_u32 s86, s86, s58
v_mfma_f32_16x16x32_bf16 v[220:223], a[88:91], v[100:103], v[220:223]
s_add_u32 m0, s50, 0
s_mul_i32 s87, s84, s21
s_add_u32 s87, s87, s59
v_mfma_f32_16x16x32_bf16 v[216:219], a[92:95], v[104:107], v[216:219]
buffer_load_dwordx4 v8, s[8:11], s86 offen offset:0 sc1 lds
v_mfma_f32_16x16x32_bf16 v[220:223], a[92:95], v[108:111], v[220:223]
s_andn2_b32 s71, s71, s70
s_add_u32 s52, s52, s70
s_add_u32 s54, s54, s71
v_mfma_f32_16x16x32_bf16 v[216:219], a[96:99], v[112:115], v[216:219]
s_mov_b32 s89, s88
v_mfma_f32_16x16x32_bf16 v[220:223], a[96:99], v[116:119], v[220:223]
buffer_load_dwordx4 v9, s[8:11], s86 offen offset:1024 sc1 lds
v_mfma_f32_16x16x32_bf16 v[216:219], a[100:103], v[120:123], v[216:219]
v_permlane32_swap_b32 v208, v212
v_mfma_f32_16x16x32_bf16 v[220:223], a[100:103], v[124:127], v[220:223]
v_permlane32_swap_b32 v209, v213
v_mfma_f32_16x16x32_bf16 v[216:219], a[104:107], v[128:131], v[216:219]
buffer_load_dwordx4 v10, s[8:11], s86 offen offset:2048 sc1 lds
v_mfma_f32_16x16x32_bf16 v[220:223], a[104:107], v[132:135], v[220:223]
v_permlane32_swap_b32 v210, v214
v_mfma_f32_16x16x32_bf16 v[216:219], a[108:111], v[136:139], v[216:219]
v_permlane32_swap_b32 v211, v215
v_mfma_f32_16x16x32_bf16 v[220:223], a[108:111], v[140:143], v[220:223]
buffer_load_dwordx4 v11, s[8:11], s86 offen offset:3072 sc1 lds
v_mfma_f32_16x16x32_bf16 v[216:219], a[112:115], v[144:147], v[216:219]
v_mul_f32 v232, s57, v208
v_mul_f32 v233, s57, v209
v_mfma_f32_16x16x32_bf16 v[220:223], a[112:115], v[148:151], v[220:223]
s_add_u32 m0, s50, 4096
v_mul_f32 v234, s57, v210
v_mfma_f32_16x16x32_bf16 v[216:219], a[116:119], v[152:155], v[216:219]
buffer_load_dwordx4 v12, s[8:11], s86 offen offset:0 sc1 lds
v_mfma_f32_16x16x32_bf16 v[220:223], a[116:119], v[156:159], v[220:223]
v_mul_f32 v235, s57, v211
v_mfma_f32_16x16x32_bf16 v[216:219], a[120:123], v[160:163], v[216:219]
v_exp_f32 v232, v232
v_mfma_f32_16x16x32_bf16 v[220:223], a[120:123], v[164:167], v[220:223]
buffer_load_dwordx4 v13, s[8:11], s86 offen offset:1024 sc1 lds
v_mfma_f32_16x16x32_bf16 v[216:219], a[124:127], v[168:171], v[216:219]
v_exp_f32 v233, v233
v_mfma_f32_16x16x32_bf16 v[220:223], a[124:127], v[172:175], v[220:223]
v_exp_f32 v234, v234
v_mfma_f32_16x16x32_bf16 v[216:219], a[128:131], v[176:179], v[216:219]
buffer_load_dwordx4 v14, s[8:11], s86 offen offset:2048 sc1 lds
v_mfma_f32_16x16x32_bf16 v[220:223], a[128:131], v[180:183], v[220:223]
v_exp_f32 v235, v235
v_mfma_f32_16x16x32_bf16 v[216:219], a[132:135], v[184:187], v[216:219]
v_add_f32 v232, 1.0, v232
v_add_f32 v233, 1.0, v233
v_mfma_f32_16x16x32_bf16 v[220:223], a[132:135], v[188:191], v[220:223]
buffer_load_dwordx4 v15, s[8:11], s86 offen offset:3072 sc1 lds
v_mfma_f32_16x16x32_bf16 v[216:219], a[136:139], v[192:195], v[216:219]
v_add_f32 v234, 1.0, v234
v_add_f32 v235, 1.0, v235
v_mfma_f32_16x16x32_bf16 v[220:223], a[136:139], v[196:199], v[220:223]
s_add_u32 m0, s50, 8192
v_mfma_f32_16x16x32_bf16 v[216:219], a[140:143], v[200:203], v[216:219]
buffer_load_dwordx4 v16, s[8:11], s86 offen offset:0 sc1 lds
v_mfma_f32_16x16x32_bf16 v[220:223], a[140:143], v[204:207], v[220:223]
v_rcp_f32 v232, v232
v_mfma_f32_16x16x32_bf16 v[224:227], a[144:147], v[64:67], 0
v_rcp_f32 v233, v233
v_mfma_f32_16x16x32_bf16 v[228:231], a[144:147], v[68:71], 0
v_rcp_f32 v234, v234
v_mfma_f32_16x16x32_bf16 v[224:227], a[148:151], v[72:75], v[224:227]
v_rcp_f32 v235, v235
v_mfma_f32_16x16x32_bf16 v[228:231], a[148:151], v[76:79], v[228:231]
v_mul_f32 v212, v208, v212
v_mul_f32 v213, v209, v213
v_mfma_f32_16x16x32_bf16 v[224:227], a[152:155], v[80:83], v[224:227]
v_mul_f32 v214, v210, v214
v_mul_f32 v215, v211, v215
v_mfma_f32_16x16x32_bf16 v[228:231], a[152:155], v[84:87], v[228:231]
v_mul_f32 v212, v212, v232
v_mul_f32 v213, v213, v233
v_mul_f32 v236, s57, v216
v_mul_f32 v237, s57, v217
v_mul_f32 v238, s57, v218
v_mul_f32 v239, s57, v219
v_exp_f32 v236, v236
v_exp_f32 v237, v237
v_exp_f32 v238, v238
v_exp_f32 v239, v239
v_add_f32 v236, 1.0, v236
v_add_f32 v237, 1.0, v237
v_add_f32 v238, 1.0, v238
v_add_f32 v239, 1.0, v239
v_mfma_f32_16x16x32_bf16 v[224:227], a[156:159], v[88:91], v[224:227]
v_mul_f32 v214, v214, v234
v_mul_f32 v215, v215, v235
v_mfma_f32_16x16x32_bf16 v[228:231], a[156:159], v[92:95], v[228:231]
v_cvt_pk_bf16_f32 v48, v212, v213
v_cvt_pk_bf16_f32 v49, v214, v215
v_mfma_f32_16x16x32_bf16 v[224:227], a[160:163], v[96:99], v[224:227]
buffer_store_dwordx2 v[48:49], v19, s[4:7], s81 offen sc1
v_mfma_f32_16x16x32_bf16 v[228:231], a[160:163], v[100:103], v[228:231]
v_rcp_f32 v236, v236
v_mfma_f32_16x16x32_bf16 v[224:227], a[164:167], v[104:107], v[224:227]
v_rcp_f32 v237, v237
v_mfma_f32_16x16x32_bf16 v[228:231], a[164:167], v[108:111], v[228:231]
v_rcp_f32 v238, v238
v_mfma_f32_16x16x32_bf16 v[224:227], a[168:171], v[112:115], v[224:227]
v_rcp_f32 v239, v239
v_mfma_f32_16x16x32_bf16 v[228:231], a[168:171], v[116:119], v[228:231]
v_mul_f32 v240, s57, v220
v_mul_f32 v241, s57, v221
v_mfma_f32_16x16x32_bf16 v[224:227], a[172:175], v[120:123], v[224:227]
v_mul_f32 v242, s57, v222
v_mul_f32 v243, s57, v223
v_mfma_f32_16x16x32_bf16 v[228:231], a[172:175], v[124:127], v[228:231]
v_mul_f32 v236, v216, v236
v_mul_f32 v237, v217, v237
v_mfma_f32_16x16x32_bf16 v[224:227], a[176:179], v[128:131], v[224:227]
v_mul_f32 v238, v218, v238
v_mul_f32 v239, v219, v239
v_mfma_f32_16x16x32_bf16 v[228:231], a[176:179], v[132:135], v[228:231]
v_exp_f32 v240, v240
v_mfma_f32_16x16x32_bf16 v[224:227], a[180:183], v[136:139], v[224:227]
v_exp_f32 v241, v241
v_mfma_f32_16x16x32_bf16 v[228:231], a[180:183], v[140:143], v[228:231]
v_exp_f32 v242, v242
v_mfma_f32_16x16x32_bf16 v[224:227], a[184:187], v[144:147], v[224:227]
v_exp_f32 v243, v243
v_mfma_f32_16x16x32_bf16 v[228:231], a[184:187], v[148:151], v[228:231]
v_add_f32 v240, 1.0, v240
v_add_f32 v241, 1.0, v241
v_mfma_f32_16x16x32_bf16 v[224:227], a[188:191], v[152:155], v[224:227]
buffer_load_dword v24, v22, s[4:7], 0 offen sc1
v_mfma_f32_16x16x32_bf16 v[228:231], a[188:191], v[156:159], v[228:231]
v_add_f32 v242, 1.0, v242
v_add_f32 v243, 1.0, v243
v_mfma_f32_16x16x32_bf16 v[224:227], a[192:195], v[160:163], v[224:227]
s_waitcnt vmcnt(9)
s_barrier
v_mfma_f32_16x16x32_bf16 v[228:231], a[192:195], v[164:167], v[228:231]
buffer_store_dword v27, v45, s[4:7], s73 offen
v_mfma_f32_16x16x32_bf16 v[224:227], a[196:199], v[168:171], v[224:227]
buffer_store_dword v27, v44, s[4:7], s73 offen sc1
s_cmp_eq_u32 s88, 0
s_cbranch_scc1 g_slow_160
v_mfma_f32_16x16x32_bf16 v[228:231], a[196:199], v[172:175], v[228:231]
v_rcp_f32 v240, v240
ds_read_b128 v[64:67], v30 offset:0
v_mfma_f32_16x16x32_bf16 v[224:227], a[200:203], v[176:179], v[224:227]
v_rcp_f32 v241, v241
ds_read_b128 v[68:71], v30 offset:9216
v_mfma_f32_16x16x32_bf16 v[228:231], a[200:203], v[180:183], v[228:231]
v_rcp_f32 v242, v242
ds_read_b128 v[72:75], v30 offset:18432
v_mfma_f32_16x16x32_bf16 v[224:227], a[204:207], v[184:187], v[224:227]
v_rcp_f32 v243, v243
ds_read_b128 v[76:79], v30 offset:27648
v_mfma_f32_16x16x32_bf16 v[228:231], a[204:207], v[188:191], v[228:231]
v_mul_f32 v240, v220, v240
ds_read_b128 v[80:83], v30 offset:1024
v_mfma_f32_16x16x32_bf16 v[224:227], a[208:211], v[192:195], v[224:227]
v_mul_f32 v241, v221, v241
ds_read_b128 v[84:87], v30 offset:10240
v_mfma_f32_16x16x32_bf16 v[228:231], a[208:211], v[196:199], v[228:231]
v_mul_f32 v242, v222, v242
ds_read_b128 v[88:91], v30 offset:19456
v_mfma_f32_16x16x32_bf16 v[224:227], a[212:215], v[200:203], v[224:227]
v_mul_f32 v243, v223, v243
ds_read_b128 v[92:95], v30 offset:28672
v_mfma_f32_16x16x32_bf16 v[228:231], a[212:215], v[204:207], v[228:231]
s_waitcnt vmcnt(8)
s_barrier
g_body_149:
s_waitcnt lgkmcnt(4)
v_mfma_f32_16x16x32_bf16 v[208:211], a[0:3], v[64:67], 0
ds_read_b128 v[96:99], v30 offset:2048
v_mfma_f32_16x16x32_bf16 v[212:215], a[0:3], v[68:71], 0
ds_read_b128 v[100:103], v30 offset:11264
v_mfma_f32_16x16x32_bf16 v[208:211], a[4:7], v[72:75], v[208:211]
ds_read_b128 v[104:107], v30 offset:20480
v_mfma_f32_16x16x32_bf16 v[212:215], a[4:7], v[76:79], v[212:215]
ds_read_b128 v[108:111], v30 offset:29696
v_mul_f32 v224, v224, v236
v_mul_f32 v225, v225, v237
v_mul_f32 v226, v226, v238
v_mul_f32 v227, v227, v239
v_mul_f32 v228, v228, v240
v_mfma_f32_16x16x32_bf16 v[216:219], a[72:75], v[64:67], 0
v_mul_f32 v229, v229, v241
s_waitcnt lgkmcnt(4)
v_mfma_f32_16x16x32_bf16 v[208:211], a[8:11], v[80:83], v[208:211]
ds_read_b128 v[112:115], v30 offset:3072
v_mul_f32 v230, v230, v242
v_mfma_f32_16x16x32_bf16 v[212:215], a[8:11], v[84:87], v[212:215]
ds_read_b128 v[116:119], v30 offset:12288
v_mul_f32 v231, v231, v243
v_mfma_f32_16x16x32_bf16 v[208:211], a[12:15], v[88:91], v[208:211]
ds_read_b128 v[120:123], v30 offset:21504
v_cvt_pk_bf16_f32 v52, v224, v225
v_mfma_f32_16x16x32_bf16 v[212:215], a[12:15], v[92:95], v[212:215]
ds_read_b128 v[124:127], v30 offset:30720
v_cvt_pk_bf16_f32 v53, v226, v227
v_mfma_f32_16x16x32_bf16 v[220:223], a[72:75], v[68:71], 0
v_cvt_pk_bf16_f32 v54, v228, v229
s_waitcnt lgkmcnt(4)
v_mfma_f32_16x16x32_bf16 v[208:211], a[16:19], v[96:99], v[208:211]
ds_read_b128 v[128:131], v30 offset:4096
v_cvt_pk_bf16_f32 v55, v230, v231
v_mfma_f32_16x16x32_bf16 v[212:215], a[16:19], v[100:103], v[212:215]
ds_read_b128 v[132:135], v30 offset:13312
v_permlane16_swap_b32 v52, v54
v_mfma_f32_16x16x32_bf16 v[208:211], a[20:23], v[104:107], v[208:211]
ds_read_b128 v[136:139], v30 offset:22528
v_permlane16_swap_b32 v53, v55
v_mfma_f32_16x16x32_bf16 v[212:215], a[20:23], v[108:111], v[212:215]
ds_read_b128 v[140:143], v30 offset:31744
buffer_store_dwordx4 v[52:55], v20, s[4:7], s81 offen sc1
v_mfma_f32_16x16x32_bf16 v[216:219], a[76:79], v[72:75], v[216:219]
s_waitcnt vmcnt(5)
s_barrier
s_waitcnt lgkmcnt(4)
v_mfma_f32_16x16x32_bf16 v[208:211], a[24:27], v[112:115], v[208:211]
ds_read_b128 v[144:147], v30 offset:5120
v_mov_b32 v27, s78
v_mfma_f32_16x16x32_bf16 v[212:215], a[24:27], v[116:119], v[212:215]
ds_read_b128 v[148:151], v30 offset:14336
v_mfma_f32_16x16x32_bf16 v[208:211], a[28:31], v[120:123], v[208:211]
ds_read_b128 v[152:155], v30 offset:23552
v_mfma_f32_16x16x32_bf16 v[212:215], a[28:31], v[124:127], v[212:215]
ds_read_b128 v[156:159], v30 offset:32768
v_mfma_f32_16x16x32_bf16 v[220:223], a[76:79], v[76:79], v[220:223]
s_waitcnt lgkmcnt(4)
v_mfma_f32_16x16x32_bf16 v[208:211], a[32:35], v[128:131], v[208:211]
ds_read_b128 v[160:163], v30 offset:6144
v_mfma_f32_16x16x32_bf16 v[212:215], a[32:35], v[132:135], v[212:215]
ds_read_b128 v[164:167], v30 offset:15360
v_mfma_f32_16x16x32_bf16 v[208:211], a[36:39], v[136:139], v[208:211]
ds_read_b128 v[168:171], v30 offset:24576
v_mfma_f32_16x16x32_bf16 v[212:215], a[36:39], v[140:143], v[212:215]
ds_read_b128 v[172:175], v30 offset:33792
v_mfma_f32_16x16x32_bf16 v[216:219], a[80:83], v[80:83], v[216:219]
s_waitcnt lgkmcnt(4)
v_mfma_f32_16x16x32_bf16 v[208:211], a[40:43], v[144:147], v[208:211]
ds_read_b128 v[176:179], v30 offset:7168
v_mfma_f32_16x16x32_bf16 v[212:215], a[40:43], v[148:151], v[212:215]
ds_read_b128 v[180:183], v30 offset:16384
v_mfma_f32_16x16x32_bf16 v[208:211], a[44:47], v[152:155], v[208:211]
ds_read_b128 v[184:187], v30 offset:25600
v_mfma_f32_16x16x32_bf16 v[212:215], a[44:47], v[156:159], v[212:215]
ds_read_b128 v[188:191], v30 offset:34816
v_mfma_f32_16x16x32_bf16 v[220:223], a[80:83], v[84:87], v[220:223]
s_waitcnt lgkmcnt(4)
v_mfma_f32_16x16x32_bf16 v[208:211], a[48:51], v[160:163], v[208:211]
ds_read_b128 v[192:195], v30 offset:8192
v_mfma_f32_16x16x32_bf16 v[212:215], a[48:51], v[164:167], v[212:215]
ds_read_b128 v[196:199], v30 offset:17408
s_waitcnt vmcnt(3)
ds_write_b32 v18, v24
v_mfma_f32_16x16x32_bf16 v[208:211], a[52:55], v[168:171], v[208:211]
ds_read_b128 v[200:203], v30 offset:26624
v_mfma_f32_16x16x32_bf16 v[212:215], a[52:55], v[172:175], v[212:215]
ds_read_b128 v[204:207], v30 offset:35840
v_mfma_f32_16x16x32_bf16 v[216:219], a[84:87], v[88:91], v[216:219]
s_waitcnt lgkmcnt(2)
s_barrier
v_mfma_f32_16x16x32_bf16 v[208:211], a[56:59], v[176:179], v[208:211]
ds_read_b32 v33, v32
v_mfma_f32_16x16x32_bf16 v[212:215], a[56:59], v[180:183], v[212:215]
v_mfma_f32_16x16x32_bf16 v[208:211], a[60:63], v[184:187], v[208:211]
v_mfma_f32_16x16x32_bf16 v[212:215], a[60:63], v[188:191], v[212:215]
s_waitcnt lgkmcnt(0)
v_cmp_gt_u32 vcc, s52, v33
v_mfma_f32_16x16x32_bf16 v[220:223], a[84:87], v[92:95], v[220:223]
v_cmp_gt_u32 s[58:59], s54, v33
v_mfma_f32_16x16x32_bf16 v[208:211], a[64:67], v[192:195], v[208:211]
s_and_b32 vcc_lo, vcc_lo, s56
s_cselect_b32 s70, 0, 1
v_mfma_f32_16x16x32_bf16 v[212:215], a[64:67], v[196:199], v[212:215]
s_and_b32 s59, s59, s56
s_cselect_b32 s71, 0, s89
v_mfma_f32_16x16x32_bf16 v[208:211], a[68:71], v[200:203], v[208:211]
s_or_b32 s94, s70, s71
s_cselect_b32 s10, 268435456, 0
v_mfma_f32_16x16x32_bf16 v[212:215], a[68:71], v[204:207], v[212:215]
s_cmp_lg_u32 s70, 0
s_cselect_b64 s[90:91], s[52:53], s[54:55]
s_cselect_b64 s[58:59], s[44:45], s[46:47]
v_mfma_f32_16x16x32_bf16 v[216:219], a[88:91], v[96:99], v[216:219]
s_mul_i32 s92, s90, s20
s_add_u32 s92, s92, s58
v_mfma_f32_16x16x32_bf16 v[220:223], a[88:91], v[100:103], v[220:223]
s_add_u32 m0, s51, 0
s_mul_i32 s93, s90, s21
s_add_u32 s93, s93, s59
v_mfma_f32_16x16x32_bf16 v[216:219], a[92:95], v[104:107], v[216:219]
buffer_load_dwordx4 v8, s[8:11], s92 offen offset:0 sc1 lds
v_mfma_f32_16x16x32_bf16 v[220:223], a[92:95], v[108:111], v[220:223]
s_andn2_b32 s71, s71, s70
s_add_u32 s52, s52, s70
s_add_u32 s54, s54, s71
v_mfma_f32_16x16x32_bf16 v[216:219], a[96:99], v[112:115], v[216:219]
s_mov_b32 s95, s94
v_mfma_f32_16x16x32_bf16 v[220:223], a[96:99], v[116:119], v[220:223]
buffer_load_dwordx4 v9, s[8:11], s92 offen offset:1024 sc1 lds
v_mfma_f32_16x16x32_bf16 v[216:219], a[100:103], v[120:123], v[216:219]
v_permlane32_swap_b32 v208, v212
v_mfma_f32_16x16x32_bf16 v[220:223], a[100:103], v[124:127], v[220:223]
v_permlane32_swap_b32 v209, v213
v_mfma_f32_16x16x32_bf16 v[216:219], a[104:107], v[128:131], v[216:219]
buffer_load_dwordx4 v10, s[8:11], s92 offen offset:2048 sc1 lds
v_mfma_f32_16x16x32_bf16 v[220:223], a[104:107], v[132:135], v[220:223]
v_permlane32_swap_b32 v210, v214
v_mfma_f32_16x16x32_bf16 v[216:219], a[108:111], v[136:139], v[216:219]
v_permlane32_swap_b32 v211, v215
v_mfma_f32_16x16x32_bf16 v[220:223], a[108:111], v[140:143], v[220:223]
buffer_load_dwordx4 v11, s[8:11], s92 offen offset:3072 sc1 lds
v_mfma_f32_16x16x32_bf16 v[216:219], a[112:115], v[144:147], v[216:219]
v_mul_f32 v232, s57, v208
v_mul_f32 v233, s57, v209
v_mfma_f32_16x16x32_bf16 v[220:223], a[112:115], v[148:151], v[220:223]
s_add_u32 m0, s51, 4096
v_mul_f32 v234, s57, v210
v_mfma_f32_16x16x32_bf16 v[216:219], a[116:119], v[152:155], v[216:219]
buffer_load_dwordx4 v12, s[8:11], s92 offen offset:0 sc1 lds
v_mfma_f32_16x16x32_bf16 v[220:223], a[116:119], v[156:159], v[220:223]
v_mul_f32 v235, s57, v211
v_mfma_f32_16x16x32_bf16 v[216:219], a[120:123], v[160:163], v[216:219]
v_exp_f32 v232, v232
v_mfma_f32_16x16x32_bf16 v[220:223], a[120:123], v[164:167], v[220:223]
buffer_load_dwordx4 v13, s[8:11], s92 offen offset:1024 sc1 lds
v_mfma_f32_16x16x32_bf16 v[216:219], a[124:127], v[168:171], v[216:219]
v_exp_f32 v233, v233
v_mfma_f32_16x16x32_bf16 v[220:223], a[124:127], v[172:175], v[220:223]
v_exp_f32 v234, v234
v_mfma_f32_16x16x32_bf16 v[216:219], a[128:131], v[176:179], v[216:219]
buffer_load_dwordx4 v14, s[8:11], s92 offen offset:2048 sc1 lds
v_mfma_f32_16x16x32_bf16 v[220:223], a[128:131], v[180:183], v[220:223]
v_exp_f32 v235, v235
v_mfma_f32_16x16x32_bf16 v[216:219], a[132:135], v[184:187], v[216:219]
v_add_f32 v232, 1.0, v232
v_add_f32 v233, 1.0, v233
v_mfma_f32_16x16x32_bf16 v[220:223], a[132:135], v[188:191], v[220:223]
buffer_load_dwordx4 v15, s[8:11], s92 offen offset:3072 sc1 lds
v_mfma_f32_16x16x32_bf16 v[216:219], a[136:139], v[192:195], v[216:219]
v_add_f32 v234, 1.0, v234
v_add_f32 v235, 1.0, v235
v_mfma_f32_16x16x32_bf16 v[220:223], a[136:139], v[196:199], v[220:223]
s_add_u32 m0, s51, 8192
v_mfma_f32_16x16x32_bf16 v[216:219], a[140:143], v[200:203], v[216:219]
buffer_load_dwordx4 v16, s[8:11], s92 offen offset:0 sc1 lds
v_mfma_f32_16x16x32_bf16 v[220:223], a[140:143], v[204:207], v[220:223]
v_rcp_f32 v232, v232
v_mfma_f32_16x16x32_bf16 v[224:227], a[144:147], v[64:67], 0
v_rcp_f32 v233, v233
v_mfma_f32_16x16x32_bf16 v[228:231], a[144:147], v[68:71], 0
v_rcp_f32 v234, v234
v_mfma_f32_16x16x32_bf16 v[224:227], a[148:151], v[72:75], v[224:227]
v_rcp_f32 v235, v235
v_mfma_f32_16x16x32_bf16 v[228:231], a[148:151], v[76:79], v[228:231]
v_mul_f32 v212, v208, v212
v_mul_f32 v213, v209, v213
v_mfma_f32_16x16x32_bf16 v[224:227], a[152:155], v[80:83], v[224:227]
v_mul_f32 v214, v210, v214
v_mul_f32 v215, v211, v215
v_mfma_f32_16x16x32_bf16 v[228:231], a[152:155], v[84:87], v[228:231]
v_mul_f32 v212, v212, v232
v_mul_f32 v213, v213, v233
v_mul_f32 v236, s57, v216
v_mul_f32 v237, s57, v217
v_mul_f32 v238, s57, v218
v_mul_f32 v239, s57, v219
v_exp_f32 v236, v236
v_exp_f32 v237, v237
v_exp_f32 v238, v238
v_exp_f32 v239, v239
v_add_f32 v236, 1.0, v236
v_add_f32 v237, 1.0, v237
v_add_f32 v238, 1.0, v238
v_add_f32 v239, 1.0, v239
v_mfma_f32_16x16x32_bf16 v[224:227], a[156:159], v[88:91], v[224:227]
v_mul_f32 v214, v214, v234
v_mul_f32 v215, v215, v235
v_mfma_f32_16x16x32_bf16 v[228:231], a[156:159], v[92:95], v[228:231]
v_cvt_pk_bf16_f32 v48, v212, v213
v_cvt_pk_bf16_f32 v49, v214, v215
v_mfma_f32_16x16x32_bf16 v[224:227], a[160:163], v[96:99], v[224:227]
buffer_store_dwordx2 v[48:49], v19, s[4:7], s87 offen sc1
v_mfma_f32_16x16x32_bf16 v[228:231], a[160:163], v[100:103], v[228:231]
v_rcp_f32 v236, v236
v_mfma_f32_16x16x32_bf16 v[224:227], a[164:167], v[104:107], v[224:227]
v_rcp_f32 v237, v237
v_mfma_f32_16x16x32_bf16 v[228:231], a[164:167], v[108:111], v[228:231]
v_rcp_f32 v238, v238
v_mfma_f32_16x16x32_bf16 v[224:227], a[168:171], v[112:115], v[224:227]
v_rcp_f32 v239, v239
v_mfma_f32_16x16x32_bf16 v[228:231], a[168:171], v[116:119], v[228:231]
v_mul_f32 v240, s57, v220
v_mul_f32 v241, s57, v221
v_mfma_f32_16x16x32_bf16 v[224:227], a[172:175], v[120:123], v[224:227]
v_mul_f32 v242, s57, v222
v_mul_f32 v243, s57, v223
v_mfma_f32_16x16x32_bf16 v[228:231], a[172:175], v[124:127], v[228:231]
v_mul_f32 v236, v216, v236
v_mul_f32 v237, v217, v237
v_mfma_f32_16x16x32_bf16 v[224:227], a[176:179], v[128:131], v[224:227]
v_mul_f32 v238, v218, v238
v_mul_f32 v239, v219, v239
v_mfma_f32_16x16x32_bf16 v[228:231], a[176:179], v[132:135], v[228:231]
v_exp_f32 v240, v240
v_mfma_f32_16x16x32_bf16 v[224:227], a[180:183], v[136:139], v[224:227]
v_exp_f32 v241, v241
v_mfma_f32_16x16x32_bf16 v[228:231], a[180:183], v[140:143], v[228:231]
v_exp_f32 v242, v242
v_mfma_f32_16x16x32_bf16 v[224:227], a[184:187], v[144:147], v[224:227]
v_exp_f32 v243, v243
v_mfma_f32_16x16x32_bf16 v[228:231], a[184:187], v[148:151], v[228:231]
v_add_f32 v240, 1.0, v240
v_add_f32 v241, 1.0, v241
v_mfma_f32_16x16x32_bf16 v[224:227], a[188:191], v[152:155], v[224:227]
buffer_load_dword v24, v22, s[4:7], 0 offen sc1
v_mfma_f32_16x16x32_bf16 v[228:231], a[188:191], v[156:159], v[228:231]
v_add_f32 v242, 1.0, v242
v_add_f32 v243, 1.0, v243
v_mfma_f32_16x16x32_bf16 v[224:227], a[192:195], v[160:163], v[224:227]
s_waitcnt vmcnt(9)
s_barrier
v_mfma_f32_16x16x32_bf16 v[228:231], a[192:195], v[164:167], v[228:231]
buffer_store_dword v27, v45, s[4:7], s79 offen
v_mfma_f32_16x16x32_bf16 v[224:227], a[196:199], v[168:171], v[224:227]
buffer_store_dword v27, v44, s[4:7], s79 offen sc1
s_cmp_eq_u32 s94, 0
s_cbranch_scc1 g_slow_161
v_mfma_f32_16x16x32_bf16 v[228:231], a[196:199], v[172:175], v[228:231]
v_rcp_f32 v240, v240
ds_read_b128 v[64:67], v31 offset:0
v_mfma_f32_16x16x32_bf16 v[224:227], a[200:203], v[176:179], v[224:227]
v_rcp_f32 v241, v241
ds_read_b128 v[68:71], v31 offset:9216
v_mfma_f32_16x16x32_bf16 v[228:231], a[200:203], v[180:183], v[228:231]
v_rcp_f32 v242, v242
ds_read_b128 v[72:75], v31 offset:18432
v_mfma_f32_16x16x32_bf16 v[224:227], a[204:207], v[184:187], v[224:227]
v_rcp_f32 v243, v243
ds_read_b128 v[76:79], v31 offset:27648
v_mfma_f32_16x16x32_bf16 v[228:231], a[204:207], v[188:191], v[228:231]
v_mul_f32 v240, v220, v240
ds_read_b128 v[80:83], v31 offset:1024
v_mfma_f32_16x16x32_bf16 v[224:227], a[208:211], v[192:195], v[224:227]
v_mul_f32 v241, v221, v241
ds_read_b128 v[84:87], v31 offset:10240
v_mfma_f32_16x16x32_bf16 v[228:231], a[208:211], v[196:199], v[228:231]
v_mul_f32 v242, v222, v242
ds_read_b128 v[88:91], v31 offset:19456
v_mfma_f32_16x16x32_bf16 v[224:227], a[212:215], v[200:203], v[224:227]
v_mul_f32 v243, v223, v243
ds_read_b128 v[92:95], v31 offset:28672
v_mfma_f32_16x16x32_bf16 v[228:231], a[212:215], v[204:207], v[228:231]
s_waitcnt vmcnt(8)
s_barrier
g_body_150:
s_waitcnt lgkmcnt(4)
v_mfma_f32_16x16x32_bf16 v[208:211], a[0:3], v[64:67], 0
ds_read_b128 v[96:99], v31 offset:2048
v_mfma_f32_16x16x32_bf16 v[212:215], a[0:3], v[68:71], 0
ds_read_b128 v[100:103], v31 offset:11264
v_mfma_f32_16x16x32_bf16 v[208:211], a[4:7], v[72:75], v[208:211]
ds_read_b128 v[104:107], v31 offset:20480
v_mfma_f32_16x16x32_bf16 v[212:215], a[4:7], v[76:79], v[212:215]
ds_read_b128 v[108:111], v31 offset:29696
v_mul_f32 v224, v224, v236
v_mul_f32 v225, v225, v237
v_mul_f32 v226, v226, v238
v_mul_f32 v227, v227, v239
v_mul_f32 v228, v228, v240
v_mfma_f32_16x16x32_bf16 v[216:219], a[72:75], v[64:67], 0
v_mul_f32 v229, v229, v241
s_waitcnt lgkmcnt(4)
v_mfma_f32_16x16x32_bf16 v[208:211], a[8:11], v[80:83], v[208:211]
ds_read_b128 v[112:115], v31 offset:3072
v_mul_f32 v230, v230, v242
v_mfma_f32_16x16x32_bf16 v[212:215], a[8:11], v[84:87], v[212:215]
ds_read_b128 v[116:119], v31 offset:12288
v_mul_f32 v231, v231, v243
v_mfma_f32_16x16x32_bf16 v[208:211], a[12:15], v[88:91], v[208:211]
ds_read_b128 v[120:123], v31 offset:21504
v_cvt_pk_bf16_f32 v52, v224, v225
v_mfma_f32_16x16x32_bf16 v[212:215], a[12:15], v[92:95], v[212:215]
ds_read_b128 v[124:127], v31 offset:30720
v_cvt_pk_bf16_f32 v53, v226, v227
v_mfma_f32_16x16x32_bf16 v[220:223], a[72:75], v[68:71], 0
v_cvt_pk_bf16_f32 v54, v228, v229
s_waitcnt lgkmcnt(4)
v_mfma_f32_16x16x32_bf16 v[208:211], a[16:19], v[96:99], v[208:211]
ds_read_b128 v[128:131], v31 offset:4096
v_cvt_pk_bf16_f32 v55, v230, v231
v_mfma_f32_16x16x32_bf16 v[212:215], a[16:19], v[100:103], v[212:215]
ds_read_b128 v[132:135], v31 offset:13312
v_permlane16_swap_b32 v52, v54
v_mfma_f32_16x16x32_bf16 v[208:211], a[20:23], v[104:107], v[208:211]
ds_read_b128 v[136:139], v31 offset:22528
v_permlane16_swap_b32 v53, v55
v_mfma_f32_16x16x32_bf16 v[212:215], a[20:23], v[108:111], v[212:215]
ds_read_b128 v[140:143], v31 offset:31744
buffer_store_dwordx4 v[52:55], v20, s[4:7], s87 offen sc1
v_mfma_f32_16x16x32_bf16 v[216:219], a[76:79], v[72:75], v[216:219]
s_waitcnt vmcnt(5)
s_barrier
s_waitcnt lgkmcnt(4)
v_mfma_f32_16x16x32_bf16 v[208:211], a[24:27], v[112:115], v[208:211]
ds_read_b128 v[144:147], v31 offset:5120
v_mov_b32 v27, s84
v_mfma_f32_16x16x32_bf16 v[212:215], a[24:27], v[116:119], v[212:215]
ds_read_b128 v[148:151], v31 offset:14336
v_mfma_f32_16x16x32_bf16 v[208:211], a[28:31], v[120:123], v[208:211]
ds_read_b128 v[152:155], v31 offset:23552
v_mfma_f32_16x16x32_bf16 v[212:215], a[28:31], v[124:127], v[212:215]
ds_read_b128 v[156:159], v31 offset:32768
v_mfma_f32_16x16x32_bf16 v[220:223], a[76:79], v[76:79], v[220:223]
s_waitcnt lgkmcnt(4)
v_mfma_f32_16x16x32_bf16 v[208:211], a[32:35], v[128:131], v[208:211]
ds_read_b128 v[160:163], v31 offset:6144
v_mfma_f32_16x16x32_bf16 v[212:215], a[32:35], v[132:135], v[212:215]
ds_read_b128 v[164:167], v31 offset:15360
v_mfma_f32_16x16x32_bf16 v[208:211], a[36:39], v[136:139], v[208:211]
ds_read_b128 v[168:171], v31 offset:24576
v_mfma_f32_16x16x32_bf16 v[212:215], a[36:39], v[140:143], v[212:215]
ds_read_b128 v[172:175], v31 offset:33792
v_mfma_f32_16x16x32_bf16 v[216:219], a[80:83], v[80:83], v[216:219]
s_waitcnt lgkmcnt(4)
v_mfma_f32_16x16x32_bf16 v[208:211], a[40:43], v[144:147], v[208:211]
ds_read_b128 v[176:179], v31 offset:7168
v_mfma_f32_16x16x32_bf16 v[212:215], a[40:43], v[148:151], v[212:215]
ds_read_b128 v[180:183], v31 offset:16384
v_mfma_f32_16x16x32_bf16 v[208:211], a[44:47], v[152:155], v[208:211]
ds_read_b128 v[184:187], v31 offset:25600
v_mfma_f32_16x16x32_bf16 v[212:215], a[44:47], v[156:159], v[212:215]
ds_read_b128 v[188:191], v31 offset:34816
v_mfma_f32_16x16x32_bf16 v[220:223], a[80:83], v[84:87], v[220:223]
s_waitcnt lgkmcnt(4)
v_mfma_f32_16x16x32_bf16 v[208:211], a[48:51], v[160:163], v[208:211]
ds_read_b128 v[192:195], v31 offset:8192
v_mfma_f32_16x16x32_bf16 v[212:215], a[48:51], v[164:167], v[212:215]
ds_read_b128 v[196:199], v31 offset:17408
s_waitcnt vmcnt(3)
ds_write_b32 v18, v24
v_mfma_f32_16x16x32_bf16 v[208:211], a[52:55], v[168:171], v[208:211]
ds_read_b128 v[200:203], v31 offset:26624
v_mfma_f32_16x16x32_bf16 v[212:215], a[52:55], v[172:175], v[212:215]
ds_read_b128 v[204:207], v31 offset:35840
v_mfma_f32_16x16x32_bf16 v[216:219], a[84:87], v[88:91], v[216:219]
s_waitcnt lgkmcnt(2)
s_barrier
v_mfma_f32_16x16x32_bf16 v[208:211], a[56:59], v[176:179], v[208:211]
ds_read_b32 v33, v32
v_mfma_f32_16x16x32_bf16 v[212:215], a[56:59], v[180:183], v[212:215]
v_mfma_f32_16x16x32_bf16 v[208:211], a[60:63], v[184:187], v[208:211]
v_mfma_f32_16x16x32_bf16 v[212:215], a[60:63], v[188:191], v[212:215]
s_waitcnt lgkmcnt(0)
v_cmp_gt_u32 vcc, s52, v33
v_mfma_f32_16x16x32_bf16 v[220:223], a[84:87], v[92:95], v[220:223]
v_cmp_gt_u32 s[58:59], s54, v33
v_mfma_f32_16x16x32_bf16 v[208:211], a[64:67], v[192:195], v[208:211]
s_and_b32 vcc_lo, vcc_lo, s56
s_cselect_b32 s70, 0, 1
v_mfma_f32_16x16x32_bf16 v[212:215], a[64:67], v[196:199], v[212:215]
s_and_b32 s59, s59, s56
s_cselect_b32 s71, 0, s95
v_mfma_f32_16x16x32_bf16 v[208:211], a[68:71], v[200:203], v[208:211]
s_or_b32 s76, s70, s71
s_cselect_b32 s10, 268435456, 0
v_mfma_f32_16x16x32_bf16 v[212:215], a[68:71], v[204:207], v[212:215]
s_cmp_lg_u32 s70, 0
s_cselect_b64 s[72:73], s[52:53], s[54:55]
s_cselect_b64 s[58:59], s[44:45], s[46:47]
v_mfma_f32_16x16x32_bf16 v[216:219], a[88:91], v[96:99], v[216:219]
s_mul_i32 s74, s72, s20
s_add_u32 s74, s74, s58
v_mfma_f32_16x16x32_bf16 v[220:223], a[88:91], v[100:103], v[220:223]
s_add_u32 m0, s48, 0
s_mul_i32 s75, s72, s21
s_add_u32 s75, s75, s59
v_mfma_f32_16x16x32_bf16 v[216:219], a[92:95], v[104:107], v[216:219]
buffer_load_dwordx4 v8, s[8:11], s74 offen offset:0 sc1 lds
v_mfma_f32_16x16x32_bf16 v[220:223], a[92:95], v[108:111], v[220:223]
s_andn2_b32 s71, s71, s70
s_add_u32 s52, s52, s70
s_add_u32 s54, s54, s71
v_mfma_f32_16x16x32_bf16 v[216:219], a[96:99], v[112:115], v[216:219]
s_mov_b32 s77, s76
v_mfma_f32_16x16x32_bf16 v[220:223], a[96:99], v[116:119], v[220:223]
buffer_load_dwordx4 v9, s[8:11], s74 offen offset:1024 sc1 lds
v_mfma_f32_16x16x32_bf16 v[216:219], a[100:103], v[120:123], v[216:219]
v_permlane32_swap_b32 v208, v212
v_mfma_f32_16x16x32_bf16 v[220:223], a[100:103], v[124:127], v[220:223]
v_permlane32_swap_b32 v209, v213
v_mfma_f32_16x16x32_bf16 v[216:219], a[104:107], v[128:131], v[216:219]
buffer_load_dwordx4 v10, s[8:11], s74 offen offset:2048 sc1 lds
v_mfma_f32_16x16x32_bf16 v[220:223], a[104:107], v[132:135], v[220:223]
v_permlane32_swap_b32 v210, v214
v_mfma_f32_16x16x32_bf16 v[216:219], a[108:111], v[136:139], v[216:219]
v_permlane32_swap_b32 v211, v215
v_mfma_f32_16x16x32_bf16 v[220:223], a[108:111], v[140:143], v[220:223]
buffer_load_dwordx4 v11, s[8:11], s74 offen offset:3072 sc1 lds
v_mfma_f32_16x16x32_bf16 v[216:219], a[112:115], v[144:147], v[216:219]
v_mul_f32 v232, s57, v208
v_mul_f32 v233, s57, v209
v_mfma_f32_16x16x32_bf16 v[220:223], a[112:115], v[148:151], v[220:223]
s_add_u32 m0, s48, 4096
v_mul_f32 v234, s57, v210
v_mfma_f32_16x16x32_bf16 v[216:219], a[116:119], v[152:155], v[216:219]
buffer_load_dwordx4 v12, s[8:11], s74 offen offset:0 sc1 lds
v_mfma_f32_16x16x32_bf16 v[220:223], a[116:119], v[156:159], v[220:223]
v_mul_f32 v235, s57, v211
v_mfma_f32_16x16x32_bf16 v[216:219], a[120:123], v[160:163], v[216:219]
v_exp_f32 v232, v232
v_mfma_f32_16x16x32_bf16 v[220:223], a[120:123], v[164:167], v[220:223]
buffer_load_dwordx4 v13, s[8:11], s74 offen offset:1024 sc1 lds
v_mfma_f32_16x16x32_bf16 v[216:219], a[124:127], v[168:171], v[216:219]
v_exp_f32 v233, v233
v_mfma_f32_16x16x32_bf16 v[220:223], a[124:127], v[172:175], v[220:223]
v_exp_f32 v234, v234
v_mfma_f32_16x16x32_bf16 v[216:219], a[128:131], v[176:179], v[216:219]
buffer_load_dwordx4 v14, s[8:11], s74 offen offset:2048 sc1 lds
v_mfma_f32_16x16x32_bf16 v[220:223], a[128:131], v[180:183], v[220:223]
v_exp_f32 v235, v235
v_mfma_f32_16x16x32_bf16 v[216:219], a[132:135], v[184:187], v[216:219]
v_add_f32 v232, 1.0, v232
v_add_f32 v233, 1.0, v233
v_mfma_f32_16x16x32_bf16 v[220:223], a[132:135], v[188:191], v[220:223]
buffer_load_dwordx4 v15, s[8:11], s74 offen offset:3072 sc1 lds
v_mfma_f32_16x16x32_bf16 v[216:219], a[136:139], v[192:195], v[216:219]
v_add_f32 v234, 1.0, v234
v_add_f32 v235, 1.0, v235
v_mfma_f32_16x16x32_bf16 v[220:223], a[136:139], v[196:199], v[220:223]
s_add_u32 m0, s48, 8192
v_mfma_f32_16x16x32_bf16 v[216:219], a[140:143], v[200:203], v[216:219]
buffer_load_dwordx4 v16, s[8:11], s74 offen offset:0 sc1 lds
v_mfma_f32_16x16x32_bf16 v[220:223], a[140:143], v[204:207], v[220:223]
v_rcp_f32 v232, v232
v_mfma_f32_16x16x32_bf16 v[224:227], a[144:147], v[64:67], 0
v_rcp_f32 v233, v233
v_mfma_f32_16x16x32_bf16 v[228:231], a[144:147], v[68:71], 0
v_rcp_f32 v234, v234
v_mfma_f32_16x16x32_bf16 v[224:227], a[148:151], v[72:75], v[224:227]
v_rcp_f32 v235, v235
v_mfma_f32_16x16x32_bf16 v[228:231], a[148:151], v[76:79], v[228:231]
v_mul_f32 v212, v208, v212
v_mul_f32 v213, v209, v213
v_mfma_f32_16x16x32_bf16 v[224:227], a[152:155], v[80:83], v[224:227]
v_mul_f32 v214, v210, v214
v_mul_f32 v215, v211, v215
v_mfma_f32_16x16x32_bf16 v[228:231], a[152:155], v[84:87], v[228:231]
v_mul_f32 v212, v212, v232
v_mul_f32 v213, v213, v233
v_mul_f32 v236, s57, v216
v_mul_f32 v237, s57, v217
v_mul_f32 v238, s57, v218
v_mul_f32 v239, s57, v219
v_exp_f32 v236, v236
v_exp_f32 v237, v237
v_exp_f32 v238, v238
v_exp_f32 v239, v239
v_add_f32 v236, 1.0, v236
v_add_f32 v237, 1.0, v237
v_add_f32 v238, 1.0, v238
v_add_f32 v239, 1.0, v239
v_mfma_f32_16x16x32_bf16 v[224:227], a[156:159], v[88:91], v[224:227]
v_mul_f32 v214, v214, v234
v_mul_f32 v215, v215, v235
v_mfma_f32_16x16x32_bf16 v[228:231], a[156:159], v[92:95], v[228:231]
v_cvt_pk_bf16_f32 v48, v212, v213
v_cvt_pk_bf16_f32 v49, v214, v215
v_mfma_f32_16x16x32_bf16 v[224:227], a[160:163], v[96:99], v[224:227]
buffer_store_dwordx2 v[48:49], v19, s[4:7], s93 offen sc1
v_mfma_f32_16x16x32_bf16 v[228:231], a[160:163], v[100:103], v[228:231]
v_rcp_f32 v236, v236
v_mfma_f32_16x16x32_bf16 v[224:227], a[164:167], v[104:107], v[224:227]
v_rcp_f32 v237, v237
v_mfma_f32_16x16x32_bf16 v[228:231], a[164:167], v[108:111], v[228:231]
v_rcp_f32 v238, v238
v_mfma_f32_16x16x32_bf16 v[224:227], a[168:171], v[112:115], v[224:227]
v_rcp_f32 v239, v239
v_mfma_f32_16x16x32_bf16 v[228:231], a[168:171], v[116:119], v[228:231]
v_mul_f32 v240, s57, v220
v_mul_f32 v241, s57, v221
v_mfma_f32_16x16x32_bf16 v[224:227], a[172:175], v[120:123], v[224:227]
v_mul_f32 v242, s57, v222
v_mul_f32 v243, s57, v223
v_mfma_f32_16x16x32_bf16 v[228:231], a[172:175], v[124:127], v[228:231]
v_mul_f32 v236, v216, v236
v_mul_f32 v237, v217, v237
v_mfma_f32_16x16x32_bf16 v[224:227], a[176:179], v[128:131], v[224:227]
v_mul_f32 v238, v218, v238
v_mul_f32 v239, v219, v239
v_mfma_f32_16x16x32_bf16 v[228:231], a[176:179], v[132:135], v[228:231]
v_exp_f32 v240, v240
v_mfma_f32_16x16x32_bf16 v[224:227], a[180:183], v[136:139], v[224:227]
v_exp_f32 v241, v241
v_mfma_f32_16x16x32_bf16 v[228:231], a[180:183], v[140:143], v[228:231]
v_exp_f32 v242, v242
v_mfma_f32_16x16x32_bf16 v[224:227], a[184:187], v[144:147], v[224:227]
v_exp_f32 v243, v243
v_mfma_f32_16x16x32_bf16 v[228:231], a[184:187], v[148:151], v[228:231]
v_add_f32 v240, 1.0, v240
v_add_f32 v241, 1.0, v241
v_mfma_f32_16x16x32_bf16 v[224:227], a[188:191], v[152:155], v[224:227]
buffer_load_dword v24, v22, s[4:7], 0 offen sc1
v_mfma_f32_16x16x32_bf16 v[228:231], a[188:191], v[156:159], v[228:231]
v_add_f32 v242, 1.0, v242
v_add_f32 v243, 1.0, v243
v_mfma_f32_16x16x32_bf16 v[224:227], a[192:195], v[160:163], v[224:227]
s_waitcnt vmcnt(9)
s_barrier
v_mfma_f32_16x16x32_bf16 v[228:231], a[192:195], v[164:167], v[228:231]
buffer_store_dword v27, v45, s[4:7], s85 offen
v_mfma_f32_16x16x32_bf16 v[224:227], a[196:199], v[168:171], v[224:227]
buffer_store_dword v27, v44, s[4:7], s85 offen sc1
s_cmp_eq_u32 s76, 0
s_cbranch_scc1 g_slow_162
v_mfma_f32_16x16x32_bf16 v[228:231], a[196:199], v[172:175], v[228:231]
v_rcp_f32 v240, v240
ds_read_b128 v[64:67], v28 offset:0
v_mfma_f32_16x16x32_bf16 v[224:227], a[200:203], v[176:179], v[224:227]
v_rcp_f32 v241, v241
ds_read_b128 v[68:71], v28 offset:9216
v_mfma_f32_16x16x32_bf16 v[228:231], a[200:203], v[180:183], v[228:231]
v_rcp_f32 v242, v242
ds_read_b128 v[72:75], v28 offset:18432
v_mfma_f32_16x16x32_bf16 v[224:227], a[204:207], v[184:187], v[224:227]
v_rcp_f32 v243, v243
ds_read_b128 v[76:79], v28 offset:27648
v_mfma_f32_16x16x32_bf16 v[228:231], a[204:207], v[188:191], v[228:231]
v_mul_f32 v240, v220, v240
ds_read_b128 v[80:83], v28 offset:1024
v_mfma_f32_16x16x32_bf16 v[224:227], a[208:211], v[192:195], v[224:227]
v_mul_f32 v241, v221, v241
ds_read_b128 v[84:87], v28 offset:10240
v_mfma_f32_16x16x32_bf16 v[228:231], a[208:211], v[196:199], v[228:231]
v_mul_f32 v242, v222, v242
ds_read_b128 v[88:91], v28 offset:19456
v_mfma_f32_16x16x32_bf16 v[224:227], a[212:215], v[200:203], v[224:227]
v_mul_f32 v243, v223, v243
ds_read_b128 v[92:95], v28 offset:28672
v_mfma_f32_16x16x32_bf16 v[228:231], a[212:215], v[204:207], v[228:231]
s_waitcnt vmcnt(8)
s_barrier
s_branch g_body_147
g_slow_159:
v_mfma_f32_16x16x32_bf16 v[228:231], a[196:199], v[172:175], v[228:231]
v_rcp_f32 v240, v240
v_mfma_f32_16x16x32_bf16 v[224:227], a[200:203], v[176:179], v[224:227]
v_rcp_f32 v241, v241
v_mfma_f32_16x16x32_bf16 v[228:231], a[200:203], v[180:183], v[228:231]
v_rcp_f32 v242, v242
v_mfma_f32_16x16x32_bf16 v[224:227], a[204:207], v[184:187], v[224:227]
v_rcp_f32 v243, v243
v_mfma_f32_16x16x32_bf16 v[228:231], a[204:207], v[188:191], v[228:231]
v_mul_f32 v240, v220, v240
v_mfma_f32_16x16x32_bf16 v[224:227], a[208:211], v[192:195], v[224:227]
v_mul_f32 v241, v221, v241
v_mfma_f32_16x16x32_bf16 v[228:231], a[208:211], v[196:199], v[228:231]
v_mul_f32 v242, v222, v242
v_mfma_f32_16x16x32_bf16 v[224:227], a[212:215], v[200:203], v[224:227]
v_mul_f32 v243, v223, v243
v_mfma_f32_16x16x32_bf16 v[228:231], a[212:215], v[204:207], v[228:231]
s_nop 5
v_mul_f32 v224, v224, v236
v_mul_f32 v225, v225, v237
v_mul_f32 v226, v226, v238
v_mul_f32 v227, v227, v239
v_mul_f32 v228, v228, v240
v_mul_f32 v229, v229, v241
v_mul_f32 v230, v230, v242
v_mul_f32 v231, v231, v243
v_cvt_pk_bf16_f32 v52, v224, v225
v_cvt_pk_bf16_f32 v53, v226, v227
v_cvt_pk_bf16_f32 v54, v228, v229
v_cvt_pk_bf16_f32 v55, v230, v231
s_nop 0
v_permlane16_swap_b32 v52, v54
v_permlane16_swap_b32 v53, v55
buffer_store_dwordx4 v[52:55], v20, s[4:7], s75 offen sc1
s_mov_b32 s75, 1879048192
s_waitcnt vmcnt(3)
ds_write_b32 v18, v24
s_waitcnt lgkmcnt(0)
s_barrier
ds_read_b32 v33, v32
s_waitcnt lgkmcnt(0)
v_cmp_gt_u32 vcc, s52, v33
v_cmp_gt_u32 s[58:59], s54, v33
s_and_b32 vcc_lo, vcc_lo, s56
s_cselect_b32 s70, 0, 1
s_and_b32 s59, s59, s56
s_cselect_b32 s71, 0, s77
s_or_b32 s82, s70, s71
s_cselect_b32 s10, 268435456, 0
s_cmp_lg_u32 s70, 0
s_cselect_b64 s[78:79], s[52:53], s[54:55]
s_cselect_b64 s[58:59], s[44:45], s[46:47]
s_mul_i32 s80, s78, s20
s_add_u32 s80, s80, s58
s_mul_i32 s81, s78, s21
s_add_u32 s81, s81, s59
s_andn2_b32 s71, s71, s70
s_add_u32 s52, s52, s70
s_add_u32 s54, s54, s71
s_mov_b32 s83, s82
s_cmp_lg_u32 s82, 0
s_cbranch_scc1 g_go_163
v_mov_b32 v27, s72
s_waitcnt vmcnt(0)
s_barrier
s_add_u32 s70, s52, s54
s_cmp_eq_u32 s70, 130
s_cbranch_scc1 g_fin_151
s_cmp_lg_u32 s3, 0
s_cbranch_scc1 sp_ok_165_j
s_mov_b32 s23, 0
buffer_load_dword v33, v22, s[4:7], 0 offen sc1
buffer_store_dword v27, v45, s[4:7], s73 offen
buffer_store_dword v27, v44, s[4:7], s73 offen sc1
s_waitcnt vmcnt(2)
s_branch sp_loop_164_e
sp_loop_164:
buffer_load_dword v33, v22, s[4:7], 0 offen sc1
s_add_u32 s23, s23, 1
s_cmp_gt_u32 s23, 150000
s_cbranch_scc1 sp_bad_166
s_waitcnt vmcnt(0)
sp_loop_164_e:
v_cmp_gt_u32 vcc, s52, v33
v_cmp_gt_u32 s[58:59], s54, v33
s_and_b32 vcc_lo, vcc_lo, s56
s_cbranch_scc0 sp_ok_165
s_cmp_gt_u32 s23, 4
s_cselect_b32 s70, 0, s56
s_cmp_lg_u32 s77, 0
s_cselect_b32 s70, 0, s70
s_or_b32 s59, s59, s70
s_and_b32 s59, s59, s56
s_cbranch_scc0 sp_ok_165
s_sleep 1
s_branch sp_loop_164
sp_bad_166:
s_mov_b32 s98, 1028
s_branch L_fail
sp_ok_165:
ds_write_b32 v18, v33
s_waitcnt lgkmcnt(0)
sp_ok_165_j:
s_barrier
ds_read_b32 v33, v32
s_waitcnt lgkmcnt(0)
s_mov_b32 s73, 1879048192
v_cmp_gt_u32 vcc, s52, v33
v_cmp_gt_u32 s[58:59], s54, v33
s_and_b32 vcc_lo, vcc_lo, s56
s_cselect_b32 s70, 0, 1
s_and_b32 s59, s59, s56
s_cselect_b32 s71, 0, 1
s_or_b32 s82, s70, s71
s_cselect_b32 s10, 268435456, 0
s_cmp_lg_u32 s70, 0
s_cselect_b64 s[78:79], s[52:53], s[54:55]
s_cselect_b64 s[58:59], s[44:45], s[46:47]
s_mul_i32 s80, s78, s20
s_add_u32 s80, s80, s58
s_mul_i32 s81, s78, s21
s_add_u32 s81, s81, s59
s_andn2_b32 s71, s71, s70
s_add_u32 s52, s52, s70
s_add_u32 s54, s54, s71
s_mov_b32 s83, s82
g_go_163:
s_add_u32 m0, s49, 0
s_nop 0
buffer_load_dwordx4 v8, s[4:7], s80 offen offset:0 sc1 lds
buffer_load_dwordx4 v9, s[4:7], s80 offen offset:1024 sc1 lds
buffer_load_dwordx4 v10, s[4:7], s80 offen offset:2048 sc1 lds
buffer_load_dwordx4 v11, s[4:7], s80 offen offset:3072 sc1 lds
s_add_u32 m0, s49, 4096
s_nop 0
buffer_load_dwordx4 v12, s[4:7], s80 offen offset:0 sc1 lds
buffer_load_dwordx4 v13, s[4:7], s80 offen offset:1024 sc1 lds
buffer_load_dwordx4 v14, s[4:7], s80 offen offset:2048 sc1 lds
buffer_load_dwordx4 v15, s[4:7], s80 offen offset:3072 sc1 lds
s_add_u32 m0, s49, 8192
s_nop 0
buffer_load_dwordx4 v16, s[4:7], s80 offen offset:0 sc1 lds
buffer_store_dword v27, v34, s[4:7], 0 offen
buffer_load_dword v24, v22, s[4:7], 0 offen sc1
v_mov_b32 v27, s72
s_waitcnt vmcnt(9)
s_barrier
buffer_store_dword v27, v45, s[4:7], s73 offen
buffer_store_dword v27, v44, s[4:7], s73 offen sc1
s_mov_b32 s73, 1879048192
ds_read_b128 v[64:67], v29 offset:0
ds_read_b128 v[68:71], v29 offset:9216
ds_read_b128 v[72:75], v29 offset:18432
ds_read_b128 v[76:79], v29 offset:27648
ds_read_b128 v[80:83], v29 offset:1024
ds_read_b128 v[84:87], v29 offset:10240
ds_read_b128 v[88:91], v29 offset:19456
ds_read_b128 v[92:95], v29 offset:28672
s_waitcnt vmcnt(8)
s_barrier
s_branch g_body_148
g_slow_160:
v_mfma_f32_16x16x32_bf16 v[228:231], a[196:199], v[172:175], v[228:231]
v_rcp_f32 v240, v240
v_mfma_f32_16x16x32_bf16 v[224:227], a[200:203], v[176:179], v[224:227]
v_rcp_f32 v241, v241
v_mfma_f32_16x16x32_bf16 v[228:231], a[200:203], v[180:183], v[228:231]
v_rcp_f32 v242, v242
v_mfma_f32_16x16x32_bf16 v[224:227], a[204:207], v[184:187], v[224:227]
v_rcp_f32 v243, v243
v_mfma_f32_16x16x32_bf16 v[228:231], a[204:207], v[188:191], v[228:231]
v_mul_f32 v240, v220, v240
v_mfma_f32_16x16x32_bf16 v[224:227], a[208:211], v[192:195], v[224:227]
v_mul_f32 v241, v221, v241
v_mfma_f32_16x16x32_bf16 v[228:231], a[208:211], v[196:199], v[228:231]
v_mul_f32 v242, v222, v242
v_mfma_f32_16x16x32_bf16 v[224:227], a[212:215], v[200:203], v[224:227]
v_mul_f32 v243, v223, v243
v_mfma_f32_16x16x32_bf16 v[228:231], a[212:215], v[204:207], v[228:231]
s_nop 5
v_mul_f32 v224, v224, v236
v_mul_f32 v225, v225, v237
v_mul_f32 v226, v226, v238
v_mul_f32 v227, v227, v239
v_mul_f32 v228, v228, v240
v_mul_f32 v229, v229, v241
v_mul_f32 v230, v230, v242
v_mul_f32 v231, v231, v243
v_cvt_pk_bf16_f32 v52, v224, v225
v_cvt_pk_bf16_f32 v53, v226, v227
v_cvt_pk_bf16_f32 v54, v228, v229
v_cvt_pk_bf16_f32 v55, v230, v231
s_nop 0
v_permlane16_swap_b32 v52, v54
v_permlane16_swap_b32 v53, v55
buffer_store_dwordx4 v[52:55], v20, s[4:7], s81 offen sc1
s_mov_b32 s81, 1879048192
s_waitcnt vmcnt(3)
ds_write_b32 v18, v24
s_waitcnt lgkmcnt(0)
s_barrier
ds_read_b32 v33, v32
s_waitcnt lgkmcnt(0)
v_cmp_gt_u32 vcc, s52, v33
v_cmp_gt_u32 s[58:59], s54, v33
s_and_b32 vcc_lo, vcc_lo, s56
s_cselect_b32 s70, 0, 1
s_and_b32 s59, s59, s56
s_cselect_b32 s71, 0, s83
s_or_b32 s88, s70, s71
s_cselect_b32 s10, 268435456, 0
s_cmp_lg_u32 s70, 0
s_cselect_b64 s[84:85], s[52:53], s[54:55]
s_cselect_b64 s[58:59], s[44:45], s[46:47]
s_mul_i32 s86, s84, s20
s_add_u32 s86, s86, s58
s_mul_i32 s87, s84, s21
s_add_u32 s87, s87, s59
s_andn2_b32 s71, s71, s70
s_add_u32 s52, s52, s70
s_add_u32 s54, s54, s71
s_mov_b32 s89, s88
s_cmp_lg_u32 s88, 0
s_cbranch_scc1 g_go_167
v_mov_b32 v27, s78
s_waitcnt vmcnt(0)
s_barrier
s_add_u32 s70, s52, s54
s_cmp_eq_u32 s70, 130
s_cbranch_scc1 g_fin_151
s_cmp_lg_u32 s3, 0
s_cbranch_scc1 sp_ok_169_j
s_mov_b32 s23, 0
buffer_load_dword v33, v22, s[4:7], 0 offen sc1
buffer_store_dword v27, v45, s[4:7], s79 offen
buffer_store_dword v27, v44, s[4:7], s79 offen sc1
s_waitcnt vmcnt(2)
s_branch sp_loop_168_e
sp_loop_168:
buffer_load_dword v33, v22, s[4:7], 0 offen sc1
s_add_u32 s23, s23, 1
s_cmp_gt_u32 s23, 150000
s_cbranch_scc1 sp_bad_170
s_waitcnt vmcnt(0)
sp_loop_168_e:
v_cmp_gt_u32 vcc, s52, v33
v_cmp_gt_u32 s[58:59], s54, v33
s_and_b32 vcc_lo, vcc_lo, s56
s_cbranch_scc0 sp_ok_169
s_cmp_gt_u32 s23, 4
s_cselect_b32 s70, 0, s56
s_cmp_lg_u32 s83, 0
s_cselect_b32 s70, 0, s70
s_or_b32 s59, s59, s70
s_and_b32 s59, s59, s56
s_cbranch_scc0 sp_ok_169
s_sleep 1
s_branch sp_loop_168
sp_bad_170:
s_mov_b32 s98, 1028
s_branch L_fail
sp_ok_169:
ds_write_b32 v18, v33
s_waitcnt lgkmcnt(0)
sp_ok_169_j:
s_barrier
ds_read_b32 v33, v32
s_waitcnt lgkmcnt(0)
s_mov_b32 s79, 1879048192
v_cmp_gt_u32 vcc, s52, v33
v_cmp_gt_u32 s[58:59], s54, v33
s_and_b32 vcc_lo, vcc_lo, s56
s_cselect_b32 s70, 0, 1
s_and_b32 s59, s59, s56
s_cselect_b32 s71, 0, 1
s_or_b32 s88, s70, s71
s_cselect_b32 s10, 268435456, 0
s_cmp_lg_u32 s70, 0
s_cselect_b64 s[84:85], s[52:53], s[54:55]
s_cselect_b64 s[58:59], s[44:45], s[46:47]
s_mul_i32 s86, s84, s20
s_add_u32 s86, s86, s58
s_mul_i32 s87, s84, s21
s_add_u32 s87, s87, s59
s_andn2_b32 s71, s71, s70
s_add_u32 s52, s52, s70
s_add_u32 s54, s54, s71
s_mov_b32 s89, s88
g_go_167:
s_add_u32 m0, s50, 0
s_nop 0
buffer_load_dwordx4 v8, s[4:7], s86 offen offset:0 sc1 lds
buffer_load_dwordx4 v9, s[4:7], s86 offen offset:1024 sc1 lds
buffer_load_dwordx4 v10, s[4:7], s86 offen offset:2048 sc1 lds
buffer_load_dwordx4 v11, s[4:7], s86 offen offset:3072 sc1 lds
s_add_u32 m0, s50, 4096
s_nop 0
buffer_load_dwordx4 v12, s[4:7], s86 offen offset:0 sc1 lds
buffer_load_dwordx4 v13, s[4:7], s86 offen offset:1024 sc1 lds
buffer_load_dwordx4 v14, s[4:7], s86 offen offset:2048 sc1 lds
buffer_load_dwordx4 v15, s[4:7], s86 offen offset:3072 sc1 lds
s_add_u32 m0, s50, 8192
s_nop 0
buffer_load_dwordx4 v16, s[4:7], s86 offen offset:0 sc1 lds
buffer_store_dword v27, v34, s[4:7], 0 offen
buffer_load_dword v24, v22, s[4:7], 0 offen sc1
v_mov_b32 v27, s78
s_waitcnt vmcnt(9)
s_barrier
buffer_store_dword v27, v45, s[4:7], s79 offen
buffer_store_dword v27, v44, s[4:7], s79 offen sc1
s_mov_b32 s79, 1879048192
ds_read_b128 v[64:67], v30 offset:0
ds_read_b128 v[68:71], v30 offset:9216
ds_read_b128 v[72:75], v30 offset:18432
ds_read_b128 v[76:79], v30 offset:27648
ds_read_b128 v[80:83], v30 offset:1024
ds_read_b128 v[84:87], v30 offset:10240
ds_read_b128 v[88:91], v30 offset:19456
ds_read_b128 v[92:95], v30 offset:28672
s_waitcnt vmcnt(8)
s_barrier
s_branch g_body_149
g_slow_161:
v_mfma_f32_16x16x32_bf16 v[228:231], a[196:199], v[172:175], v[228:231]
v_rcp_f32 v240, v240
v_mfma_f32_16x16x32_bf16 v[224:227], a[200:203], v[176:179], v[224:227]
v_rcp_f32 v241, v241
v_mfma_f32_16x16x32_bf16 v[228:231], a[200:203], v[180:183], v[228:231]
v_rcp_f32 v242, v242
v_mfma_f32_16x16x32_bf16 v[224:227], a[204:207], v[184:187], v[224:227]
v_rcp_f32 v243, v243
v_mfma_f32_16x16x32_bf16 v[228:231], a[204:207], v[188:191], v[228:231]
v_mul_f32 v240, v220, v240
v_mfma_f32_16x16x32_bf16 v[224:227], a[208:211], v[192:195], v[224:227]
v_mul_f32 v241, v221, v241
v_mfma_f32_16x16x32_bf16 v[228:231], a[208:211], v[196:199], v[228:231]
v_mul_f32 v242, v222, v242
v_mfma_f32_16x16x32_bf16 v[224:227], a[212:215], v[200:203], v[224:227]
v_mul_f32 v243, v223, v243
v_mfma_f32_16x16x32_bf16 v[228:231], a[212:215], v[204:207], v[228:231]
s_nop 5
v_mul_f32 v224, v224, v236
v_mul_f32 v225, v225, v237
v_mul_f32 v226, v226, v238
v_mul_f32 v227, v227, v239
v_mul_f32 v228, v228, v240
v_mul_f32 v229, v229, v241
v_mul_f32 v230, v230, v242
v_mul_f32 v231, v231, v243
v_cvt_pk_bf16_f32 v52, v224, v225
v_cvt_pk_bf16_f32 v53, v226, v227
v_cvt_pk_bf16_f32 v54, v228, v229
v_cvt_pk_bf16_f32 v55, v230, v231
s_nop 0
v_permlane16_swap_b32 v52, v54
v_permlane16_swap_b32 v53, v55
buffer_store_dwordx4 v[52:55], v20, s[4:7], s87 offen sc1
s_mov_b32 s87, 1879048192
s_waitcnt vmcnt(3)
ds_write_b32 v18, v24
s_waitcnt lgkmcnt(0)
s_barrier
ds_read_b32 v33, v32
s_waitcnt lgkmcnt(0)
v_cmp_gt_u32 vcc, s52, v33
v_cmp_gt_u32 s[58:59], s54, v33
s_and_b32 vcc_lo, vcc_lo, s56
s_cselect_b32 s70, 0, 1
s_and_b32 s59, s59, s56
s_cselect_b32 s71, 0, s89
s_or_b32 s94, s70, s71
s_cselect_b32 s10, 268435456, 0
s_cmp_lg_u32 s70, 0
s_cselect_b64 s[90:91], s[52:53], s[54:55]
s_cselect_b64 s[58:59], s[44:45], s[46:47]
s_mul_i32 s92, s90, s20
s_add_u32 s92, s92, s58
s_mul_i32 s93, s90, s21
s_add_u32 s93, s93, s59
s_andn2_b32 s71, s71, s70
s_add_u32 s52, s52, s70
s_add_u32 s54, s54, s71
s_mov_b32 s95, s94
s_cmp_lg_u32 s94, 0
s_cbranch_scc1 g_go_171
v_mov_b32 v27, s84
s_waitcnt vmcnt(0)
s_barrier
s_add_u32 s70, s52, s54
s_cmp_eq_u32 s70, 130
s_cbranch_scc1 g_fin_151
s_cmp_lg_u32 s3, 0
s_cbranch_scc1 sp_ok_173_j
s_mov_b32 s23, 0
buffer_load_dword v33, v22, s[4:7], 0 offen sc1
buffer_store_dword v27, v45, s[4:7], s85 offen
buffer_store_dword v27, v44, s[4:7], s85 offen sc1
s_waitcnt vmcnt(2)
s_branch sp_loop_172_e
sp_loop_172:
buffer_load_dword v33, v22, s[4:7], 0 offen sc1
s_add_u32 s23, s23, 1
s_cmp_gt_u32 s23, 150000
s_cbranch_scc1 sp_bad_174
s_waitcnt vmcnt(0)
sp_loop_172_e:
v_cmp_gt_u32 vcc, s52, v33
v_cmp_gt_u32 s[58:59], s54, v33
s_and_b32 vcc_lo, vcc_lo, s56
s_cbranch_scc0 sp_ok_173
s_cmp_gt_u32 s23, 4
s_cselect_b32 s70, 0, s56
s_cmp_lg_u32 s89, 0
s_cselect_b32 s70, 0, s70
s_or_b32 s59, s59, s70
s_and_b32 s59, s59, s56
s_cbranch_scc0 sp_ok_173
s_sleep 1
s_branch sp_loop_172
sp_bad_174:
s_mov_b32 s98, 1028
s_branch L_fail
sp_ok_173:
ds_write_b32 v18, v33
s_waitcnt lgkmcnt(0)
sp_ok_173_j:
s_barrier
ds_read_b32 v33, v32
s_waitcnt lgkmcnt(0)
s_mov_b32 s85, 1879048192
v_cmp_gt_u32 vcc, s52, v33
v_cmp_gt_u32 s[58:59], s54, v33
s_and_b32 vcc_lo, vcc_lo, s56
s_cselect_b32 s70, 0, 1
s_and_b32 s59, s59, s56
s_cselect_b32 s71, 0, 1
s_or_b32 s94, s70, s71
s_cselect_b32 s10, 268435456, 0
s_cmp_lg_u32 s70, 0
s_cselect_b64 s[90:91], s[52:53], s[54:55]
s_cselect_b64 s[58:59], s[44:45], s[46:47]
s_mul_i32 s92, s90, s20
s_add_u32 s92, s92, s58
s_mul_i32 s93, s90, s21
s_add_u32 s93, s93, s59
s_andn2_b32 s71, s71, s70
s_add_u32 s52, s52, s70
s_add_u32 s54, s54, s71
s_mov_b32 s95, s94
g_go_171:
s_add_u32 m0, s51, 0
s_nop 0
buffer_load_dwordx4 v8, s[4:7], s92 offen offset:0 sc1 lds
buffer_load_dwordx4 v9, s[4:7], s92 offen offset:1024 sc1 lds
buffer_load_dwordx4 v10, s[4:7], s92 offen offset:2048 sc1 lds
buffer_load_dwordx4 v11, s[4:7], s92 offen offset:3072 sc1 lds
s_add_u32 m0, s51, 4096
s_nop 0
buffer_load_dwordx4 v12, s[4:7], s92 offen offset:0 sc1 lds
buffer_load_dwordx4 v13, s[4:7], s92 offen offset:1024 sc1 lds
buffer_load_dwordx4 v14, s[4:7], s92 offen offset:2048 sc1 lds
buffer_load_dwordx4 v15, s[4:7], s92 offen offset:3072 sc1 lds
s_add_u32 m0, s51, 8192
s_nop 0
buffer_load_dwordx4 v16, s[4:7], s92 offen offset:0 sc1 lds
buffer_store_dword v27, v34, s[4:7], 0 offen
buffer_load_dword v24, v22, s[4:7], 0 offen sc1
v_mov_b32 v27, s84
s_waitcnt vmcnt(9)
s_barrier
buffer_store_dword v27, v45, s[4:7], s85 offen
buffer_store_dword v27, v44, s[4:7], s85 offen sc1
s_mov_b32 s85, 1879048192
ds_read_b128 v[64:67], v31 offset:0
ds_read_b128 v[68:71], v31 offset:9216
ds_read_b128 v[72:75], v31 offset:18432
ds_read_b128 v[76:79], v31 offset:27648
ds_read_b128 v[80:83], v31 offset:1024
ds_read_b128 v[84:87], v31 offset:10240
ds_read_b128 v[88:91], v31 offset:19456
ds_read_b128 v[92:95], v31 offset:28672
s_waitcnt vmcnt(8)
s_barrier
s_branch g_body_150
g_slow_162:
v_mfma_f32_16x16x32_bf16 v[228:231], a[196:199], v[172:175], v[228:231]
v_rcp_f32 v240, v240
v_mfma_f32_16x16x32_bf16 v[224:227], a[200:203], v[176:179], v[224:227]
v_rcp_f32 v241, v241
v_mfma_f32_16x16x32_bf16 v[228:231], a[200:203], v[180:183], v[228:231]
v_rcp_f32 v242, v242
v_mfma_f32_16x16x32_bf16 v[224:227], a[204:207], v[184:187], v[224:227]
v_rcp_f32 v243, v243
v_mfma_f32_16x16x32_bf16 v[228:231], a[204:207], v[188:191], v[228:231]
v_mul_f32 v240, v220, v240
v_mfma_f32_16x16x32_bf16 v[224:227], a[208:211], v[192:195], v[224:227]
v_mul_f32 v241, v221, v241
v_mfma_f32_16x16x32_bf16 v[228:231], a[208:211], v[196:199], v[228:231]
v_mul_f32 v242, v222, v242
v_mfma_f32_16x16x32_bf16 v[224:227], a[212:215], v[200:203], v[224:227]
v_mul_f32 v243, v223, v243
v_mfma_f32_16x16x32_bf16 v[228:231], a[212:215], v[204:207], v[228:231]
s_nop 5
v_mul_f32 v224, v224, v236
v_mul_f32 v225, v225, v237
v_mul_f32 v226, v226, v238
v_mul_f32 v227, v227, v239
v_mul_f32 v228, v228, v240
v_mul_f32 v229, v229, v241
v_mul_f32 v230, v230, v242
v_mul_f32 v231, v231, v243
v_cvt_pk_bf16_f32 v52, v224, v225
v_cvt_pk_bf16_f32 v53, v226, v227
v_cvt_pk_bf16_f32 v54, v228, v229
v_cvt_pk_bf16_f32 v55, v230, v231
s_nop 0
v_permlane16_swap_b32 v52, v54
v_permlane16_swap_b32 v53, v55
buffer_store_dwordx4 v[52:55], v20, s[4:7], s93 offen sc1
s_mov_b32 s93, 1879048192
s_waitcnt vmcnt(3)
ds_write_b32 v18, v24
s_waitcnt lgkmcnt(0)
s_barrier
ds_read_b32 v33, v32
s_waitcnt lgkmcnt(0)
v_cmp_gt_u32 vcc, s52, v33
v_cmp_gt_u32 s[58:59], s54, v33
s_and_b32 vcc_lo, vcc_lo, s56
s_cselect_b32 s70, 0, 1
s_and_b32 s59, s59, s56
s_cselect_b32 s71, 0, s95
s_or_b32 s76, s70, s71
s_cselect_b32 s10, 268435456, 0
s_cmp_lg_u32 s70, 0
s_cselect_b64 s[72:73], s[52:53], s[54:55]
s_cselect_b64 s[58:59], s[44:45], s[46:47]
s_mul_i32 s74, s72, s20
s_add_u32 s74, s74, s58
s_mul_i32 s75, s72, s21
s_add_u32 s75, s75, s59
s_andn2_b32 s71, s71, s70
s_add_u32 s52, s52, s70
s_add_u32 s54, s54, s71
s_mov_b32 s77, s76
s_cmp_lg_u32 s76, 0
s_cbranch_scc1 g_go_175
v_mov_b32 v27, s90
s_waitcnt vmcnt(0)
s_barrier
s_add_u32 s70, s52, s54
s_cmp_eq_u32 s70, 130
s_cbranch_scc1 g_fin_151
s_cmp_lg_u32 s3, 0
s_cbranch_scc1 sp_ok_177_j
s_mov_b32 s23, 0
buffer_load_dword v33, v22, s[4:7], 0 offen sc1
buffer_store_dword v27, v45, s[4:7], s91 offen
buffer_store_dword v27, v44, s[4:7], s91 offen sc1
s_waitcnt vmcnt(2)
s_branch sp_loop_176_e
sp_loop_176:
buffer_load_dword v33, v22, s[4:7], 0 offen sc1
s_add_u32 s23, s23, 1
s_cmp_gt_u32 s23, 150000
s_cbranch_scc1 sp_bad_178
s_waitcnt vmcnt(0)
sp_loop_176_e:
v_cmp_gt_u32 vcc, s52, v33
v_cmp_gt_u32 s[58:59], s54, v33
s_and_b32 vcc_lo, vcc_lo, s56
s_cbranch_scc0 sp_ok_177
s_cmp_gt_u32 s23, 4
s_cselect_b32 s70, 0, s56
s_cmp_lg_u32 s95, 0
s_cselect_b32 s70, 0, s70
s_or_b32 s59, s59, s70
s_and_b32 s59, s59, s56
s_cbranch_scc0 sp_ok_177
s_sleep 1
s_branch sp_loop_176
sp_bad_178:
s_mov_b32 s98, 1028
s_branch L_fail
sp_ok_177:
ds_write_b32 v18, v33
s_waitcnt lgkmcnt(0)
sp_ok_177_j:
s_barrier
ds_read_b32 v33, v32
s_waitcnt lgkmcnt(0)
s_mov_b32 s91, 1879048192
v_cmp_gt_u32 vcc, s52, v33
v_cmp_gt_u32 s[58:59], s54, v33
s_and_b32 vcc_lo, vcc_lo, s56
s_cselect_b32 s70, 0, 1
s_and_b32 s59, s59, s56
s_cselect_b32 s71, 0, 1
s_or_b32 s76, s70, s71
s_cselect_b32 s10, 268435456, 0
s_cmp_lg_u32 s70, 0
s_cselect_b64 s[72:73], s[52:53], s[54:55]
s_cselect_b64 s[58:59], s[44:45], s[46:47]
s_mul_i32 s74, s72, s20
s_add_u32 s74, s74, s58
s_mul_i32 s75, s72, s21
s_add_u32 s75, s75, s59
s_andn2_b32 s71, s71, s70
s_add_u32 s52, s52, s70
s_add_u32 s54, s54, s71
s_mov_b32 s77, s76
g_go_175:
s_add_u32 m0, s48, 0
s_nop 0
buffer_load_dwordx4 v8, s[4:7], s74 offen offset:0 sc1 lds
buffer_load_dwordx4 v9, s[4:7], s74 offen offset:1024 sc1 lds
buffer_load_dwordx4 v10, s[4:7], s74 offen offset:2048 sc1 lds
buffer_load_dwordx4 v11, s[4:7], s74 offen offset:3072 sc1 lds
s_add_u32 m0, s48, 4096
s_nop 0
buffer_load_dwordx4 v12, s[4:7], s74 offen offset:0 sc1 lds
buffer_load_dwordx4 v13, s[4:7], s74 offen offset:1024 sc1 lds
buffer_load_dwordx4 v14, s[4:7], s74 offen offset:2048 sc1 lds
buffer_load_dwordx4 v15, s[4:7], s74 offen offset:3072 sc1 lds
s_add_u32 m0, s48, 8192
s_nop 0
buffer_load_dwordx4 v16, s[4:7], s74 offen offset:0 sc1 lds
buffer_store_dword v27, v34, s[4:7], 0 offen
buffer_load_dword v24, v22, s[4:7], 0 offen sc1
v_mov_b32 v27, s90
s_waitcnt vmcnt(9)
s_barrier
buffer_store_dword v27, v45, s[4:7], s91 offen
buffer_store_dword v27, v44, s[4:7], s91 offen sc1
s_mov_b32 s91, 1879048192
ds_read_b128 v[64:67], v28 offset:0
ds_read_b128 v[68:71], v28 offset:9216
ds_read_b128 v[72:75], v28 offset:18432
ds_read_b128 v[76:79], v28 offset:27648
ds_read_b128 v[80:83], v28 offset:1024
ds_read_b128 v[84:87], v28 offset:10240
ds_read_b128 v[88:91], v28 offset:19456
ds_read_b128 v[92:95], v28 offset:28672
s_waitcnt vmcnt(8)
s_barrier
s_branch g_body_147
g_fin_151:
buffer_store_dword v27, v45, s[4:7], s91 offen
buffer_store_dword v27, v44, s[4:7], s91 offen sc1
s_endpgm
H_att:
s_lshr_b32 s75, s74, 1
s_and_b32 s76, s74, 1
s_lshl_b32 s44, s75, 2
s_add_u32 s44, s44, s3
s_mul_i32 s52, s76, 32768
s_mul_i32 s46, s76, 50331648
s_add_u32 s46, s46, 10821632
s_mul_i32 s49, s44, 24576
s_add_u32 s46, s46, s49
s_mul_i32 s47, s76, 8388608
s_add_u32 s47, s47, 111484928
s_mul_i32 s49, s44, 4096
s_add_u32 s47, s47, s49
s_mul_i32 s48, s76, 16777216
s_add_u32 s48, s48, 128262144
s_mul_i32 s49, s44, 8192
s_add_u32 s48, s48, s49
s_mov_b32 s50, 0x3e0293ee
v_lshlrev_b32 v8, 4, v0
v_lshlrev_b32 v10, 3, v0
v_add_u32 v10, 2048, v10
v_bfe_u32 v1, v0, 2, 2
v_and_b32 v2, 1, v0
v_lshl_add_u32 v1, v1, 1, v2
v_lshlrev_b32 v1, 4, v1
v_lshrrev_b32 v2, 4, v0
v_lshl_add_u32 v9, v2, 7, v1
v_and_b32 v1, 15, v0
v_lshlrev_b32 v2, 2, v2
v_sub_u32 v1, v1, v2
v_cmp_le_i32 s[56:57], 0, v1
v_cmp_le_i32 s[58:59], 1, v1
v_cmp_le_i32 s[60:61], 2, v1
v_cmp_le_i32 s[62:63], 3, v1
v_mov_b32 v16, 0xff800000
v_mov_b64 v[50:51], 0
v_mov_b32 v57, 0
v_mov_b32 v58, 0
v_mov_b32 v61, 0
v_mov_b32 v62, 0
v_min_u32 v1, 5, v0
v_lshrrev_b32 v2, 1, v1
v_lshlrev_b32 v2, 8, v2
v_and_b32 v1, 1, v1
v_mul_u32_u24 v1, 7, v1
v_add_u32 v1, v1, v2
s_lshl_b32 s49, s44, 3
v_add_u32 v1, s49, v1
v_mul_u32_u24 v1, 43691, v1
v_lshrrev_b32 v1, 19, v1
v_mul_u32_u24 v1, 128, v1
v_add_u32 v1, 2048, v1
s_mul_i32 s49, s44, 128
s_add_u32 s49, s49, 10240
v_mov_b32 v2, s49
v_cmp_eq_u32 vcc, 6, v0
s_nop 1
v_cndmask_b32 v1, v1, v2, vcc
v_cndmask_b32 v20, 1, 0, vcc
v_mov_b32 v7, 2147483632
v_cmp_gt_u32 vcc, 7, v0
s_nop 1
v_cndmask_b32 v11, v7, v1, vcc
s_mul_i32 s49, s44, 128
s_add_u32 s49, s49, 14336
v_mov_b32 v1, s49
v_mov_b32 v2, 2147483632
v_cmp_eq_u32 vcc, 0, v0
s_nop 1
v_cndmask_b32 v22, v2, v1, vcc
v_add_u32 v23, 65536, v22
s_mov_b32 s45, 0
s_getpc_b64 s[96:97]
pc_179:
s_add_u32 s96, s96, L_writers-pc_179
s_addc_u32 s97, s97, 0
v_subrev_u32 v2, 0, v11
v_lshrrev_b32 v2, 7, v2
v_cmp_gt_u32 vcc, 0x200, v2
s_nop 1
v_cndmask_b32 v2, 0, v2, vcc
global_load_ubyte v2, v2, s[96:97]
s_mov_b32 s12, s40
s_and_b32 s13, s41, 0xffff
s_mov_b32 s14, 256
s_mov_b32 s15, 0x20000
v_lshlrev_b32 v14, 2, v0
v_add_u32 v15, 128, v14
v_cmp_le_u32 vcc, 2, v0
s_nop 1
v_cndmask_b32 v14, v14, v15, vcc
v_mov_b32 v15, 192
v_cmp_eq_u32 vcc, 8, v0
s_nop 1
v_cndmask_b32 v14, v14, v15, vcc
v_mov_b32 v15, 2147483632
v_cmp_lt_u32 vcc, 8, v0
s_nop 1
v_cndmask_b32 v14, v14, v15, vcc
s_mov_b32 s98, 0
wi_loop_180:
buffer_load_dword v15, v14, s[12:15], 0 offen sc1
s_add_u32 s98, s98, 1
s_cmp_gt_u32 s98, 150000
s_cbranch_scc1 wi_bad_182
s_waitcnt vmcnt(0)
v_cmp_eq_u32 vcc, 32, v15
s_nop 0
s_and_b32 s97, vcc_lo, 0x1ff
s_cmp_eq_u32 s97, 0x1ff
s_cbranch_scc1 wi_ok_181
v_cmp_lt_u32 vcc, 32, v15
s_nop 0
s_and_b32 s96, vcc_lo, 0xff
s_cselect_b32 s96, 0x100, 0
s_and_b32 s96, s96, s97
s_cbranch_scc1 wi_over_183
s_sleep 8
s_branch wi_loop_180
wi_bad_182:
s_mov_b32 s98, 512
s_branch L_fail
wi_over_183:
s_mov_b32 s100, 255
wi_ok_181:
v_add_u32 v3, 65536, v11
v_cmp_eq_u32 vcc, s100, v2
s_nop 1
v_cndmask_b32 v11, v11, v3, vcc
v_mov_b32 v3, 2147483632
s_cmp_lg_u32 s100, 255
s_cselect_b64 vcc, -1, 0
v_cndmask_b32 v22, v22, v3, vcc
s_mov_b32 s8, s42
s_and_b32 s9, s43, 0xffff
s_mov_b32 s10, 0
s_mov_b32 s11, 0x20000
s_mov_b32 s98, 0
sp_loop_186:
buffer_load_dword v24, v11, s[4:7], s52 offen sc1
s_add_u32 s98, s98, 1
s_cmp_gt_u32 s98, 150000
s_cbranch_scc1 sp_bad_188
s_waitcnt vmcnt(0)
v_cmp_gt_u32 vcc, 1, v24
s_nop 0
s_and_b32 vcc_lo, vcc_lo, 0x3f
s_cbranch_scc0 sp_ok_187
s_sleep 2
s_branch sp_loop_186
sp_bad_188:
s_mov_b32 s98, 1536
s_branch L_fail
sp_ok_187:
s_add_u32 s54, s46, 0
buffer_load_dwordx4 a[0:3], v8, s[4:7], s54 offen offset:0 sc1
buffer_load_dwordx4 a[4:7], v8, s[4:7], s54 offen offset:1024 sc1
buffer_load_dwordx4 a[8:11], v8, s[4:7], s54 offen offset:2048 sc1
buffer_load_dwordx4 a[12:15], v8, s[4:7], s54 offen offset:3072 sc1
s_add_u32 s54, s46, 4096
buffer_load_dwordx4 a[16:19], v8, s[4:7], s54 offen offset:0 sc1
buffer_load_dwordx4 a[20:23], v8, s[4:7], s54 offen offset:1024 sc1
buffer_load_dwordx4 a[24:27], v8, s[4:7], s54 offen offset:2048 sc1
buffer_load_dwordx4 a[28:31], v8, s[4:7], s54 offen offset:3072 sc1
s_add_u32 s54, s46, 8192
buffer_load_dwordx4 a[32:35], v8, s[4:7], s54 offen offset:0 sc1
buffer_load_dwordx4 a[36:39], v8, s[4:7], s54 offen offset:1024 sc1
buffer_load_dwordx4 a[40:43], v8, s[4:7], s54 offen offset:2048 sc1
buffer_load_dwordx4 a[44:47], v8, s[4:7], s54 offen offset:3072 sc1
s_add_u32 s54, s46, 12288
buffer_load_dwordx4 a[48:51], v8, s[4:7], s54 offen offset:0 sc1
buffer_load_dwordx4 a[52:55], v8, s[4:7], s54 offen offset:1024 sc1
buffer_load_dwordx4 a[56:59], v8, s[4:7], s54 offen offset:2048 sc1
buffer_load_dwordx4 a[60:63], v8, s[4:7], s54 offen offset:3072 sc1
s_add_u32 s54, s46, 16384
buffer_load_dwordx4 a[64:67], v8, s[4:7], s54 offen offset:0 sc1
buffer_load_dwordx4 a[68:71], v8, s[4:7], s54 offen offset:1024 sc1
buffer_load_dwordx4 a[72:75], v8, s[4:7], s54 offen offset:2048 sc1
buffer_load_dwordx4 a[76:79], v8, s[4:7], s54 offen offset:3072 sc1
s_add_u32 s54, s46, 20480
buffer_load_dwordx4 a[80:83], v8, s[4:7], s54 offen offset:0 sc1
buffer_load_dwordx4 a[84:87], v8, s[4:7], s54 offen offset:1024 sc1
buffer_load_dwordx4 a[88:91], v8, s[4:7], s54 offen offset:2048 sc1
buffer_load_dwordx4 a[92:95], v8, s[4:7], s54 offen offset:3072 sc1
s_waitcnt vmcnt(0)
s_mov_b32 s55, 0
v_mfma_f32_16x16x32_bf16 v[28:31], a[32:35], a[0:3], 0
v_mfma_f32_16x16x32_bf16 v[32:35], a[32:35], a[4:7], 0
v_mfma_f32_16x16x32_bf16 v[36:39], a[36:39], a[4:7], 0
v_mfma_f32_16x16x32_bf16 v[28:31], a[40:43], a[8:11], v[28:31]
v_mfma_f32_16x16x32_bf16 v[32:35], a[40:43], a[12:15], v[32:35]
v_mfma_f32_16x16x32_bf16 v[36:39], a[44:47], a[12:15], v[36:39]
v_mfma_f32_16x16x32_bf16 v[28:31], a[48:51], a[16:19], v[28:31]
v_mfma_f32_16x16x32_bf16 v[32:35], a[48:51], a[20:23], v[32:35]
v_mfma_f32_16x16x32_bf16 v[36:39], a[52:55], a[20:23], v[36:39]
v_mfma_f32_16x16x32_bf16 v[28:31], a[56:59], a[24:27], v[28:31]
v_mfma_f32_16x16x32_bf16 v[32:35], a[56:59], a[28:31], v[32:35]
v_mfma_f32_16x16x32_bf16 v[36:39], a[60:63], a[28:31], v[36:39]
s_add_u32 s53, s45, 1
v_add_u32 v13, s53, v20
s_nop 3
v_cndmask_b32 v28, v16, v28, s[56:57]
v_cndmask_b32 v29, v16, v29, s[58:59]
v_cndmask_b32 v30, v16, v30, s[60:61]
v_cndmask_b32 v31, v16, v31, s[62:63]
v_cndmask_b32 v36, v16, v36, s[56:57]
v_cndmask_b32 v37, v16, v37, s[58:59]
v_cndmask_b32 v38, v16, v38, s[60:61]
v_cndmask_b32 v39, v16, v39, s[62:63]
v_max3_f32 v18, v32, v33, v34
v_max3_f32 v17, v28, v29, v30
v_max3_f32 v18, v18, v35, v36
v_max_f32 v17, v17, v31
v_max3_f32 v18, v18, v37, v38
v_max_f32 v18, v18, v39
att_loop_184:
v_cmp_gt_u32 vcc, v13, v24
s_nop 0
s_and_b32 vcc_lo, vcc_lo, 0x7f
s_cmp_lg_u32 s55, 0
s_cbranch_scc1 att_have_192
s_mov_b32 s98, 0
att_sp_189:
buffer_load_dword v24, v11, s[4:7], s52 offen sc1
s_add_u32 s98, s98, 1
s_cmp_gt_u32 s98, 150000
s_cbranch_scc1 att_bad_191
s_waitcnt vmcnt(0)
v_cmp_gt_u32 vcc, v13, v24
s_nop 0
s_and_b32 vcc_lo, vcc_lo, 0x7f
s_and_b32 s49, vcc_lo, 0x40
s_cbranch_scc0 att_ok_190
s_sleep 2
s_branch att_sp_189
att_bad_191:
s_mov_b32 s98, 1537
s_branch L_fail
att_ok_190:
buffer_load_dwordx4 v[64:67], v9, s[4:7], s47 offen offset:0 sc1
buffer_load_dwordx4 v[68:71], v9, s[4:7], s47 offen offset:512 sc1
buffer_load_dwordx4 v[72:75], v9, s[4:7], s47 offen offset:1024 sc1
buffer_load_dwordx4 v[76:79], v9, s[4:7], s47 offen offset:1536 sc1
buffer_load_dwordx2 v[80:81], v10, s[4:7], s47 offen offset:0 sc1
buffer_load_dwordx2 v[82:83], v10, s[4:7], s47 offen offset:512 sc1
buffer_load_dwordx2 v[84:85], v10, s[4:7], s47 offen offset:1024 sc1
buffer_load_dwordx2 v[86:87], v10, s[4:7], s47 offen offset:1536 sc1
att_have_192:
s_cmp_eq_u32 vcc_lo, 0
s_cselect_b32 s51, 1, 0
s_cselect_b32 s10, 268435456, 0
s_add_u32 s46, s46, 786432
s_add_u32 s47, s47, 131072
s_add_u32 s54, s46, 0
buffer_load_dwordx4 a[96:99], v8, s[8:11], s54 offen offset:0 sc1
buffer_load_dwordx4 a[100:103], v8, s[8:11], s54 offen offset:1024 sc1
buffer_load_dwordx4 a[104:107], v8, s[8:11], s54 offen offset:2048 sc1
buffer_load_dwordx4 a[108:111], v8, s[8:11], s54 offen offset:3072 sc1
s_add_u32 s54, s46, 4096
buffer_load_dwordx4 a[112:115], v8, s[8:11], s54 offen offset:0 sc1
buffer_load_dwordx4 a[116:119], v8, s[8:11], s54 offen offset:1024 sc1
buffer_load_dwordx4 a[120:123], v8, s[8:11], s54 offen offset:2048 sc1
buffer_load_dwordx4 a[124:127], v8, s[8:11], s54 offen offset:3072 sc1
s_waitcnt vmcnt(15)
v_mfma_f32_16x16x32_bf16 v[40:43], v[64:67], a[0:3], 0
v_mfma_f32_16x16x32_bf16 v[44:47], v[64:67], a[4:7], 0
s_waitcnt vmcnt(14)
v_mfma_f32_16x16x32_bf16 v[40:43], v[68:71], a[8:11], v[40:43]
v_mfma_f32_16x16x32_bf16 v[44:47], v[68:71], a[12:15], v[44:47]
s_waitcnt vmcnt(13)
v_mfma_f32_16x16x32_bf16 v[40:43], v[72:75], a[16:19], v[40:43]
v_mfma_f32_16x16x32_bf16 v[44:47], v[72:75], a[20:23], v[44:47]
s_waitcnt vmcnt(12)
v_mfma_f32_16x16x32_bf16 v[40:43], v[76:79], a[24:27], v[40:43]
v_mfma_f32_16x16x32_bf16 v[44:47], v[76:79], a[28:31], v[44:47]
s_add_u32 s54, s46, 8192
buffer_load_dwordx4 a[128:131], v8, s[8:11], s54 offen offset:0 sc1
buffer_load_dwordx4 a[132:135], v8, s[8:11], s54 offen offset:1024 sc1
s_nop 3
v_max3_f32 v17, v17, v40, v41
v_max3_f32 v18, v18, v44, v45
s_nop 1
v_permlane32_swap_b32 v17, v18
v_max_f32 v17, v17, v18
v_mov_b32 v19, v17
s_nop 1
v_permlane16_swap_b32 v17, v19
v_max_f32 v17, v17, v19
v_mul_f32 v17, s50, v17
v_mov_b32 v18, v17
buffer_load_dwordx4 a[136:139], v8, s[8:11], s54 offen offset:2048 sc1
s_nop 0
v_permlane32_swap_b32 v17, v18
v_fma_f32 v28, v28, s50, -v17
v_fma_f32 v29, v29, s50, -v17
v_fma_f32 v30, v30, s50, -v17
v_fma_f32 v31, v31, s50, -v17
v_fma_f32 v40, v40, s50, -v17
v_fma_f32 v41, v41, s50, -v17
v_fma_f32 v32, v32, s50, -v18
v_fma_f32 v33, v33, s50, -v18
v_fma_f32 v34, v34, s50, -v18
v_fma_f32 v35, v35, s50, -v18
v_fma_f32 v36, v36, s50, -v18
v_fma_f32 v37, v37, s50, -v18
v_fma_f32 v38, v38, s50, -v18
v_fma_f32 v39, v39, s50, -v18
v_fma_f32 v44, v44, s50, -v18
v_fma_f32 v45, v45, s50, -v18
buffer_load_dwordx4 a[140:143], v8, s[8:11], s54 offen offset:3072 sc1
v_exp_f32 v28, v28
v_exp_f32 v29, v29
v_exp_f32 v30, v30
v_exp_f32 v31, v31
v_exp_f32 v40, v40
v_exp_f32 v41, v41
s_add_u32 s54, s46, 12288
buffer_load_dwordx4 a[144:147], v8, s[8:11], s54 offen offset:0 sc1
v_exp_f32 v32, v32
v_exp_f32 v33, v33
v_exp_f32 v34, v34
v_exp_f32 v35, v35
v_exp_f32 v36, v36
v_exp_f32 v37, v37
v_exp_f32 v38, v38
v_exp_f32 v39, v39
v_exp_f32 v44, v44
v_exp_f32 v45, v45
buffer_load_dwordx4 a[148:151], v8, s[8:11], s54 offen offset:1024 sc1
v_add_f32 v17, v28, v29
v_add_f32 v18, v32, v33
v_add_f32 v17, v17, v30
v_add_f32 v18, v18, v34
v_add_f32 v17, v17, v31
v_add_f32 v18, v18, v35
v_add_f32 v17, v17, v40
v_add_f32 v18, v18, v36
v_add_f32 v17, v17, v41
v_add_f32 v18, v18, v37
v_add_f32 v18, v18, v38
v_add_f32 v18, v18, v39
v_add_f32 v18, v18, v44
v_add_f32 v18, v18, v45
buffer_load_dwordx4 a[152:155], v8, s[8:11], s54 offen offset:2048 sc1
s_nop 0
v_permlane32_swap_b32 v17, v18
v_add_f32 v17, v17, v18
v_mov_b32 v19, v17
s_nop 1
v_permlane16_swap_b32 v17, v19
v_add_f32 v17, v17, v19
v_rcp_f32 v17, v17
buffer_load_dwordx4 a[156:159], v8, s[8:11], s54 offen offset:3072 sc1
v_mov_b32 v18, v17
s_add_u32 s54, s46, 16384
buffer_load_dwordx4 a[160:163], v8, s[8:11], s54 offen offset:0 sc1
v_permlane32_swap_b32 v17, v18
v_mul_f32 v28, v28, v17
v_mul_f32 v29, v29, v17
v_mul_f32 v30, v30, v17
v_mul_f32 v31, v31, v17
v_mul_f32 v40, v40, v17
v_mul_f32 v41, v41, v17
v_cvt_pk_bf16_f32 v48, v28, v29
v_cvt_pk_bf16_f32 v49, v30, v31
v_cvt_pk_bf16_f32 v56, v40, v41
v_cvt_pk_bf16_f32 v59, v40, v41
buffer_load_dwordx4 a[164:167], v8, s[8:11], s54 offen offset:1024 sc1
v_mul_f32 v32, v32, v18
v_mul_f32 v33, v33, v18
v_mul_f32 v34, v34, v18
v_mul_f32 v35, v35, v18
v_mul_f32 v36, v36, v18
v_mul_f32 v37, v37, v18
v_mul_f32 v38, v38, v18
v_mul_f32 v39, v39, v18
v_mul_f32 v44, v44, v18
v_mul_f32 v45, v45, v18
v_cvt_pk_bf16_f32 v52, v32, v33
v_cvt_pk_bf16_f32 v53, v34, v35
v_cvt_pk_bf16_f32 v54, v36, v37
v_cvt_pk_bf16_f32 v55, v38, v39
v_cvt_pk_bf16_f32 v60, v44, v45
v_cvt_pk_bf16_f32 v63, v44, v45
buffer_load_dwordx4 a[168:171], v8, s[8:11], s54 offen offset:2048 sc1
s_add_u32 s49, s48, 4096
s_waitcnt vmcnt(19)
buffer_load_dword v24, v11, s[4:7], s52 offen sc1
v_mfma_f32_16x16x32_bf16 v[128:131], a[64:67], v[48:51], 0
v_mfma_f32_16x16x32_bf16 v[132:135], a[68:71], v[48:51], 0
v_mfma_f32_16x16x16_bf16 v[128:131], v[80:81], v[56:57], v[128:131]
v_mfma_f32_16x16x16_bf16 v[132:135], v[80:81], v[58:59], v[132:135]
v_mfma_f32_16x16x32_bf16 v[136:139], a[72:75], v[48:51], 0
v_mfma_f32_16x16x32_bf16 v[140:143], a[76:79], v[48:51], 0
v_mfma_f32_16x16x16_bf16 v[136:139], v[82:83], v[56:57], v[136:139]
v_mfma_f32_16x16x16_bf16 v[140:143], v[82:83], v[58:59], v[140:143]
v_mfma_f32_16x16x32_bf16 v[144:147], a[80:83], v[48:51], 0
s_nop 1
v_cvt_pk_bf16_f32 v88, v128, v129
v_mfma_f32_16x16x32_bf16 v[148:151], a[84:87], v[48:51], 0
v_cvt_pk_bf16_f32 v89, v130, v131
v_mfma_f32_16x16x16_bf16 v[144:147], v[84:85], v[56:57], v[144:147]
v_cvt_pk_bf16_f32 v90, v132, v133
v_mfma_f32_16x16x16_bf16 v[148:151], v[84:85], v[58:59], v[148:151]
v_cvt_pk_bf16_f32 v91, v134, v135
buffer_store_dwordx4 v[88:91], v8, s[4:7], s48 offen offset:0 sc1
v_mfma_f32_16x16x32_bf16 v[152:155], a[88:91], v[48:51], 0
v_cvt_pk_bf16_f32 v92, v136, v137
v_mfma_f32_16x16x32_bf16 v[156:159], a[92:95], v[48:51], 0
v_cvt_pk_bf16_f32 v93, v138, v139
v_mfma_f32_16x16x16_bf16 v[152:155], v[86:87], v[56:57], v[152:155]
v_cvt_pk_bf16_f32 v94, v140, v141
v_mfma_f32_16x16x16_bf16 v[156:159], v[86:87], v[58:59], v[156:159]
v_cvt_pk_bf16_f32 v95, v142, v143
buffer_store_dwordx4 v[92:95], v8, s[4:7], s48 offen offset:2048 sc1
v_mfma_f32_16x16x32_bf16 v[160:163], a[64:67], v[52:55], 0
v_cvt_pk_bf16_f32 v96, v144, v145
v_mfma_f32_16x16x32_bf16 v[164:167], a[68:71], v[52:55], 0
v_cvt_pk_bf16_f32 v97, v146, v147
v_mfma_f32_16x16x16_bf16 v[160:163], v[80:81], v[60:61], v[160:163]
v_cvt_pk_bf16_f32 v98, v148, v149
v_mfma_f32_16x16x16_bf16 v[164:167], v[80:81], v[62:63], v[164:167]
v_cvt_pk_bf16_f32 v99, v150, v151
buffer_store_dwordx4 v[96:99], v8, s[4:7], s49 offen offset:0 sc1
v_mfma_f32_16x16x32_bf16 v[168:171], a[72:75], v[52:55], 0
v_cvt_pk_bf16_f32 v100, v152, v153
v_mfma_f32_16x16x32_bf16 v[172:175], a[76:79], v[52:55], 0
v_cvt_pk_bf16_f32 v101, v154, v155
v_mfma_f32_16x16x16_bf16 v[168:171], v[82:83], v[60:61], v[168:171]
v_cvt_pk_bf16_f32 v102, v156, v157
v_mfma_f32_16x16x16_bf16 v[172:175], v[82:83], v[62:63], v[172:175]
v_cvt_pk_bf16_f32 v103, v158, v159
buffer_store_dwordx4 v[100:103], v8, s[4:7], s49 offen offset:2048 sc1
v_mfma_f32_16x16x32_bf16 v[176:179], a[80:83], v[52:55], 0
v_cvt_pk_bf16_f32 v104, v160, v161
v_mfma_f32_16x16x32_bf16 v[180:183], a[84:87], v[52:55], 0
v_cvt_pk_bf16_f32 v105, v162, v163
v_mfma_f32_16x16x16_bf16 v[176:179], v[84:85], v[60:61], v[176:179]
v_cvt_pk_bf16_f32 v106, v164, v165
v_mfma_f32_16x16x16_bf16 v[180:183], v[84:85], v[62:63], v[180:183]
v_cvt_pk_bf16_f32 v107, v166, v167
buffer_store_dwordx4 v[104:107], v8, s[4:7], s48 offen offset:1024 sc1
v_mfma_f32_16x16x32_bf16 v[184:187], a[88:91], v[52:55], 0
v_cvt_pk_bf16_f32 v108, v168, v169
v_mfma_f32_16x16x32_bf16 v[188:191], a[92:95], v[52:55], 0
v_cvt_pk_bf16_f32 v109, v170, v171
v_mfma_f32_16x16x16_bf16 v[184:187], v[86:87], v[60:61], v[184:187]
v_cvt_pk_bf16_f32 v110, v172, v173
v_mfma_f32_16x16x16_bf16 v[188:191], v[86:87], v[62:63], v[188:191]
v_cvt_pk_bf16_f32 v111, v174, v175
buffer_store_dwordx4 v[108:111], v8, s[4:7], s48 offen offset:3072 sc1
v_cvt_pk_bf16_f32 v112, v176, v177
v_cvt_pk_bf16_f32 v113, v178, v179
v_cvt_pk_bf16_f32 v114, v180, v181
v_cvt_pk_bf16_f32 v115, v182, v183
buffer_store_dwordx4 v[112:115], v8, s[4:7], s49 offen offset:1024 sc1
v_cvt_pk_bf16_f32 v116, v184, v185
v_cvt_pk_bf16_f32 v117, v186, v187
v_cvt_pk_bf16_f32 v118, v188, v189
v_cvt_pk_bf16_f32 v119, v190, v191
buffer_store_dwordx4 v[116:119], v8, s[4:7], s49 offen offset:3072 sc1
buffer_load_dwordx4 a[172:175], v8, s[8:11], s54 offen offset:3072 sc1
s_add_u32 s54, s46, 20480
buffer_load_dwordx4 a[176:179], v8, s[8:11], s54 offen offset:0 sc1
buffer_load_dwordx4 a[180:183], v8, s[8:11], s54 offen offset:1024 sc1
buffer_load_dwordx4 a[184:187], v8, s[8:11], s54 offen offset:2048 sc1
buffer_load_dwordx4 a[188:191], v8, s[8:11], s54 offen offset:3072 sc1
s_add_u32 s48, s48, 262144
v_mov_b32 v15, s53
s_mov_b32 s45, s53
s_cmp_eq_u32 s51, 0
s_cbranch_scc1 att_nopre_193
s_waitcnt vmcnt(13)
v_add_u32 v13, 1, v13
v_cmp_gt_u32 vcc, v13, v24
s_nop 0
s_and_b32 vcc_lo, vcc_lo, 0x40
s_cselect_b32 s55, 0, 1
s_cbranch_scc1 att_nokm_195
buffer_load_dwordx4 v[64:67], v9, s[4:7], s47 offen offset:0 sc1
buffer_load_dwordx4 v[68:71], v9, s[4:7], s47 offen offset:512 sc1
buffer_load_dwordx4 v[72:75], v9, s[4:7], s47 offen offset:1024 sc1
buffer_load_dwordx4 v[76:79], v9, s[4:7], s47 offen offset:1536 sc1
buffer_load_dwordx2 v[80:81], v10, s[4:7], s47 offen offset:0 sc1
buffer_load_dwordx2 v[82:83], v10, s[4:7], s47 offen offset:512 sc1
buffer_load_dwordx2 v[84:85], v10, s[4:7], s47 offen offset:1024 sc1
buffer_load_dwordx2 v[86:87], v10, s[4:7], s47 offen offset:1536 sc1
s_waitcnt vmcnt(13)
buffer_store_dword v15, v23, s[4:7], s52 offen
buffer_store_dword v15, v22, s[4:7], s52 offen sc1
s_waitcnt vmcnt(10)
s_branch att_nokm_195_j
att_nokm_195:
s_waitcnt vmcnt(5)
buffer_store_dword v15, v23, s[4:7], s52 offen
buffer_store_dword v15, v22, s[4:7], s52 offen sc1
s_waitcnt vmcnt(2)
att_nokm_195_j:
v_mfma_f32_16x16x32_bf16 v[28:31], a[128:131], a[96:99], 0
v_mfma_f32_16x16x32_bf16 v[32:35], a[128:131], a[100:103], 0
v_mfma_f32_16x16x32_bf16 v[36:39], a[132:135], a[100:103], 0
v_mfma_f32_16x16x32_bf16 v[28:31], a[136:139], a[104:107], v[28:31]
v_mfma_f32_16x16x32_bf16 v[32:35], a[136:139], a[108:111], v[32:35]
v_mfma_f32_16x16x32_bf16 v[36:39], a[140:143], a[108:111], v[36:39]
v_mfma_f32_16x16x32_bf16 v[28:31], a[144:147], a[112:115], v[28:31]
v_mfma_f32_16x16x32_bf16 v[32:35], a[144:147], a[116:119], v[32:35]
v_mfma_f32_16x16x32_bf16 v[36:39], a[148:151], a[116:119], v[36:39]
v_mfma_f32_16x16x32_bf16 v[28:31], a[152:155], a[120:123], v[28:31]
v_mfma_f32_16x16x32_bf16 v[32:35], a[152:155], a[124:127], v[32:35]
v_mfma_f32_16x16x32_bf16 v[36:39], a[156:159], a[124:127], v[36:39]
s_add_u32 s53, s45, 1
v_add_u32 v13, s53, v20
s_nop 3
v_cndmask_b32 v28, v16, v28, s[56:57]
v_cndmask_b32 v29, v16, v29, s[58:59]
v_cndmask_b32 v30, v16, v30, s[60:61]
v_cndmask_b32 v31, v16, v31, s[62:63]
v_cndmask_b32 v36, v16, v36, s[56:57]
v_cndmask_b32 v37, v16, v37, s[58:59]
v_cndmask_b32 v38, v16, v38, s[60:61]
v_cndmask_b32 v39, v16, v39, s[62:63]
v_max3_f32 v18, v32, v33, v34
v_max3_f32 v17, v28, v29, v30
v_max3_f32 v18, v18, v35, v36
v_max_f32 v17, v17, v31
v_max3_f32 v18, v18, v37, v38
v_max_f32 v18, v18, v39
att_j2_194:
v_cmp_gt_u32 vcc, v13, v24
s_nop 0
s_and_b32 vcc_lo, vcc_lo, 0x7f
s_cmp_lg_u32 s55, 0
s_cbranch_scc1 att_have_199
s_mov_b32 s98, 0
att_sp_196:
buffer_load_dword v24, v11, s[4:7], s52 offen sc1
s_add_u32 s98, s98, 1
s_cmp_gt_u32 s98, 150000
s_cbranch_scc1 att_bad_198
s_waitcnt vmcnt(0)
v_cmp_gt_u32 vcc, v13, v24
s_nop 0
s_and_b32 vcc_lo, vcc_lo, 0x7f
s_and_b32 s49, vcc_lo, 0x40
s_cbranch_scc0 att_ok_197
s_sleep 2
s_branch att_sp_196
att_bad_198:
s_mov_b32 s98, 1537
s_branch L_fail
att_ok_197:
buffer_load_dwordx4 v[64:67], v9, s[4:7], s47 offen offset:0 sc1
buffer_load_dwordx4 v[68:71], v9, s[4:7], s47 offen offset:512 sc1
buffer_load_dwordx4 v[72:75], v9, s[4:7], s47 offen offset:1024 sc1
buffer_load_dwordx4 v[76:79], v9, s[4:7], s47 offen offset:1536 sc1
buffer_load_dwordx2 v[80:81], v10, s[4:7], s47 offen offset:0 sc1
buffer_load_dwordx2 v[82:83], v10, s[4:7], s47 offen offset:512 sc1
buffer_load_dwordx2 v[84:85], v10, s[4:7], s47 offen offset:1024 sc1
buffer_load_dwordx2 v[86:87], v10, s[4:7], s47 offen offset:1536 sc1
att_have_199:
s_cmp_eq_u32 vcc_lo, 0
s_cselect_b32 s51, 1, 0
s_cselect_b32 s10, 268435456, 0
s_add_u32 s46, s46, 786432
s_add_u32 s47, s47, 131072
s_add_u32 s54, s46, 0
buffer_load_dwordx4 a[0:3], v8, s[8:11], s54 offen offset:0 sc1
buffer_load_dwordx4 a[4:7], v8, s[8:11], s54 offen offset:1024 sc1
buffer_load_dwordx4 a[8:11], v8, s[8:11], s54 offen offset:2048 sc1
buffer_load_dwordx4 a[12:15], v8, s[8:11], s54 offen offset:3072 sc1
s_add_u32 s54, s46, 4096
buffer_load_dwordx4 a[16:19], v8, s[8:11], s54 offen offset:0 sc1
buffer_load_dwordx4 a[20:23], v8, s[8:11], s54 offen offset:1024 sc1
buffer_load_dwordx4 a[24:27], v8, s[8:11], s54 offen offset:2048 sc1
buffer_load_dwordx4 a[28:31], v8, s[8:11], s54 offen offset:3072 sc1
s_waitcnt vmcnt(15)
v_mfma_f32_16x16x32_bf16 v[40:43], v[64:67], a[96:99], 0
v_mfma_f32_16x16x32_bf16 v[44:47], v[64:67], a[100:103], 0
s_waitcnt vmcnt(14)
v_mfma_f32_16x16x32_bf16 v[40:43], v[68:71], a[104:107], v[40:43]
v_mfma_f32_16x16x32_bf16 v[44:47], v[68:71], a[108:111], v[44:47]
s_waitcnt vmcnt(13)
v_mfma_f32_16x16x32_bf16 v[40:43], v[72:75], a[112:115], v[40:43]
v_mfma_f32_16x16x32_bf16 v[44:47], v[72:75], a[116:119], v[44:47]
s_waitcnt vmcnt(12)
v_mfma_f32_16x16x32_bf16 v[40:43], v[76:79], a[120:123], v[40:43]
v_mfma_f32_16x16x32_bf16 v[44:47], v[76:79], a[124:127], v[44:47]
s_add_u32 s54, s46, 8192
buffer_load_dwordx4 a[32:35], v8, s[8:11], s54 offen offset:0 sc1
buffer_load_dwordx4 a[36:39], v8, s[8:11], s54 offen offset:1024 sc1
s_nop 3
v_max3_f32 v17, v17, v40, v41
v_max3_f32 v18, v18, v44, v45
s_nop 1
v_permlane32_swap_b32 v17, v18
v_max_f32 v17, v17, v18
v_mov_b32 v19, v17
s_nop 1
v_permlane16_swap_b32 v17, v19
v_max_f32 v17, v17, v19
v_mul_f32 v17, s50, v17
v_mov_b32 v18, v17
buffer_load_dwordx4 a[40:43], v8, s[8:11], s54 offen offset:2048 sc1
s_nop 0
v_permlane32_swap_b32 v17, v18
v_fma_f32 v28, v28, s50, -v17
v_fma_f32 v29, v29, s50, -v17
v_fma_f32 v30, v30, s50, -v17
v_fma_f32 v31, v31, s50, -v17
v_fma_f32 v40, v40, s50, -v17
v_fma_f32 v41, v41, s50, -v17
v_fma_f32 v32, v32, s50, -v18
v_fma_f32 v33, v33, s50, -v18
v_fma_f32 v34, v34, s50, -v18
v_fma_f32 v35, v35, s50, -v18
v_fma_f32 v36, v36, s50, -v18
v_fma_f32 v37, v37, s50, -v18
v_fma_f32 v38, v38, s50, -v18
v_fma_f32 v39, v39, s50, -v18
v_fma_f32 v44, v44, s50, -v18
v_fma_f32 v45, v45, s50, -v18
buffer_load_dwordx4 a[44:47], v8, s[8:11], s54 offen offset:3072 sc1
v_exp_f32 v28, v28
v_exp_f32 v29, v29
v_exp_f32 v30, v30
v_exp_f32 v31, v31
v_exp_f32 v40, v40
v_exp_f32 v41, v41
s_add_u32 s54, s46, 12288
buffer_load_dwordx4 a[48:51], v8, s[8:11], s54 offen offset:0 sc1
v_exp_f32 v32, v32
v_exp_f32 v33, v33
v_exp_f32 v34, v34
v_exp_f32 v35, v35
v_exp_f32 v36, v36
v_exp_f32 v37, v37
v_exp_f32 v38, v38
v_exp_f32 v39, v39
v_exp_f32 v44, v44
v_exp_f32 v45, v45
buffer_load_dwordx4 a[52:55], v8, s[8:11], s54 offen offset:1024 sc1
v_add_f32 v17, v28, v29
v_add_f32 v18, v32, v33
v_add_f32 v17, v17, v30
v_add_f32 v18, v18, v34
v_add_f32 v17, v17, v31
v_add_f32 v18, v18, v35
v_add_f32 v17, v17, v40
v_add_f32 v18, v18, v36
v_add_f32 v17, v17, v41
v_add_f32 v18, v18, v37
v_add_f32 v18, v18, v38
v_add_f32 v18, v18, v39
v_add_f32 v18, v18, v44
v_add_f32 v18, v18, v45
buffer_load_dwordx4 a[56:59], v8, s[8:11], s54 offen offset:2048 sc1
s_nop 0
v_permlane32_swap_b32 v17, v18
v_add_f32 v17, v17, v18
v_mov_b32 v19, v17
s_nop 1
v_permlane16_swap_b32 v17, v19
v_add_f32 v17, v17, v19
v_rcp_f32 v17, v17
buffer_load_dwordx4 a[60:63], v8, s[8:11], s54 offen offset:3072 sc1
v_mov_b32 v18, v17
s_add_u32 s54, s46, 16384
buffer_load_dwordx4 a[64:67], v8, s[8:11], s54 offen offset:0 sc1
v_permlane32_swap_b32 v17, v18
v_mul_f32 v28, v28, v17
v_mul_f32 v29, v29, v17
v_mul_f32 v30, v30, v17
v_mul_f32 v31, v31, v17
v_mul_f32 v40, v40, v17
v_mul_f32 v41, v41, v17
v_cvt_pk_bf16_f32 v48, v28, v29
v_cvt_pk_bf16_f32 v49, v30, v31
v_cvt_pk_bf16_f32 v56, v40, v41
v_cvt_pk_bf16_f32 v59, v40, v41
buffer_load_dwordx4 a[68:71], v8, s[8:11], s54 offen offset:1024 sc1
v_mul_f32 v32, v32, v18
v_mul_f32 v33, v33, v18
v_mul_f32 v34, v34, v18
v_mul_f32 v35, v35, v18
v_mul_f32 v36, v36, v18
v_mul_f32 v37, v37, v18
v_mul_f32 v38, v38, v18
v_mul_f32 v39, v39, v18
v_mul_f32 v44, v44, v18
v_mul_f32 v45, v45, v18
v_cvt_pk_bf16_f32 v52, v32, v33
v_cvt_pk_bf16_f32 v53, v34, v35
v_cvt_pk_bf16_f32 v54, v36, v37
v_cvt_pk_bf16_f32 v55, v38, v39
v_cvt_pk_bf16_f32 v60, v44, v45
v_cvt_pk_bf16_f32 v63, v44, v45
buffer_load_dwordx4 a[72:75], v8, s[8:11], s54 offen offset:2048 sc1
s_add_u32 s49, s48, 4096
s_waitcnt vmcnt(19)
buffer_load_dword v24, v11, s[4:7], s52 offen sc1
v_mfma_f32_16x16x32_bf16 v[128:131], a[160:163], v[48:51], 0
v_mfma_f32_16x16x32_bf16 v[132:135], a[164:167], v[48:51], 0
v_mfma_f32_16x16x16_bf16 v[128:131], v[80:81], v[56:57], v[128:131]
v_mfma_f32_16x16x16_bf16 v[132:135], v[80:81], v[58:59], v[132:135]
v_mfma_f32_16x16x32_bf16 v[136:139], a[168:171], v[48:51], 0
v_mfma_f32_16x16x32_bf16 v[140:143], a[172:175], v[48:51], 0
v_mfma_f32_16x16x16_bf16 v[136:139], v[82:83], v[56:57], v[136:139]
v_mfma_f32_16x16x16_bf16 v[140:143], v[82:83], v[58:59], v[140:143]
v_mfma_f32_16x16x32_bf16 v[144:147], a[176:179], v[48:51], 0
s_nop 1
v_cvt_pk_bf16_f32 v88, v128, v129
v_mfma_f32_16x16x32_bf16 v[148:151], a[180:183], v[48:51], 0
v_cvt_pk_bf16_f32 v89, v130, v131
v_mfma_f32_16x16x16_bf16 v[144:147], v[84:85], v[56:57], v[144:147]
v_cvt_pk_bf16_f32 v90, v132, v133
v_mfma_f32_16x16x16_bf16 v[148:151], v[84:85], v[58:59], v[148:151]
v_cvt_pk_bf16_f32 v91, v134, v135
buffer_store_dwordx4 v[88:91], v8, s[4:7], s48 offen offset:0 sc1
v_mfma_f32_16x16x32_bf16 v[152:155], a[184:187], v[48:51], 0
v_cvt_pk_bf16_f32 v92, v136, v137
v_mfma_f32_16x16x32_bf16 v[156:159], a[188:191], v[48:51], 0
v_cvt_pk_bf16_f32 v93, v138, v139
v_mfma_f32_16x16x16_bf16 v[152:155], v[86:87], v[56:57], v[152:155]
v_cvt_pk_bf16_f32 v94, v140, v141
v_mfma_f32_16x16x16_bf16 v[156:159], v[86:87], v[58:59], v[156:159]
v_cvt_pk_bf16_f32 v95, v142, v143
buffer_store_dwordx4 v[92:95], v8, s[4:7], s48 offen offset:2048 sc1
v_mfma_f32_16x16x32_bf16 v[160:163], a[160:163], v[52:55], 0
v_cvt_pk_bf16_f32 v96, v144, v145
v_mfma_f32_16x16x32_bf16 v[164:167], a[164:167], v[52:55], 0
v_cvt_pk_bf16_f32 v97, v146, v147
v_mfma_f32_16x16x16_bf16 v[160:163], v[80:81], v[60:61], v[160:163]
v_cvt_pk_bf16_f32 v98, v148, v149
v_mfma_f32_16x16x16_bf16 v[164:167], v[80:81], v[62:63], v[164:167]
v_cvt_pk_bf16_f32 v99, v150, v151
buffer_store_dwordx4 v[96:99], v8, s[4:7], s49 offen offset:0 sc1
v_mfma_f32_16x16x32_bf16 v[168:171], a[168:171], v[52:55], 0
v_cvt_pk_bf16_f32 v100, v152, v153
v_mfma_f32_16x16x32_bf16 v[172:175], a[172:175], v[52:55], 0
v_cvt_pk_bf16_f32 v101, v154, v155
v_mfma_f32_16x16x16_bf16 v[168:171], v[82:83], v[60:61], v[168:171]
v_cvt_pk_bf16_f32 v102, v156, v157
v_mfma_f32_16x16x16_bf16 v[172:175], v[82:83], v[62:63], v[172:175]
v_cvt_pk_bf16_f32 v103, v158, v159
buffer_store_dwordx4 v[100:103], v8, s[4:7], s49 offen offset:2048 sc1
v_mfma_f32_16x16x32_bf16 v[176:179], a[176:179], v[52:55], 0
v_cvt_pk_bf16_f32 v104, v160, v161
v_mfma_f32_16x16x32_bf16 v[180:183], a[180:183], v[52:55], 0
v_cvt_pk_bf16_f32 v105, v162, v163
v_mfma_f32_16x16x16_bf16 v[176:179], v[84:85], v[60:61], v[176:179]
v_cvt_pk_bf16_f32 v106, v164, v165
v_mfma_f32_16x16x16_bf16 v[180:183], v[84:85], v[62:63], v[180:183]
v_cvt_pk_bf16_f32 v107, v166, v167
buffer_store_dwordx4 v[104:107], v8, s[4:7], s48 offen offset:1024 sc1
v_mfma_f32_16x16x32_bf16 v[184:187], a[184:187], v[52:55], 0
v_cvt_pk_bf16_f32 v108, v168, v169
v_mfma_f32_16x16x32_bf16 v[188:191], a[188:191], v[52:55], 0
v_cvt_pk_bf16_f32 v109, v170, v171
v_mfma_f32_16x16x16_bf16 v[184:187], v[86:87], v[60:61], v[184:187]
v_cvt_pk_bf16_f32 v110, v172, v173
v_mfma_f32_16x16x16_bf16 v[188:191], v[86:87], v[62:63], v[188:191]
v_cvt_pk_bf16_f32 v111, v174, v175
buffer_store_dwordx4 v[108:111], v8, s[4:7], s48 offen offset:3072 sc1
v_cvt_pk_bf16_f32 v112, v176, v177
v_cvt_pk_bf16_f32 v113, v178, v179
v_cvt_pk_bf16_f32 v114, v180, v181
v_cvt_pk_bf16_f32 v115, v182, v183
buffer_store_dwordx4 v[112:115], v8, s[4:7], s49 offen offset:1024 sc1
v_cvt_pk_bf16_f32 v116, v184, v185
v_cvt_pk_bf16_f32 v117, v186, v187
v_cvt_pk_bf16_f32 v118, v188, v189
v_cvt_pk_bf16_f32 v119, v190, v191
buffer_store_dwordx4 v[116:119], v8, s[4:7], s49 offen offset:3072 sc1
buffer_load_dwordx4 a[76:79], v8, s[8:11], s54 offen offset:3072 sc1
s_add_u32 s54, s46, 20480
buffer_load_dwordx4 a[80:83], v8, s[8:11], s54 offen offset:0 sc1
buffer_load_dwordx4 a[84:87], v8, s[8:11], s54 offen offset:1024 sc1
buffer_load_dwordx4 a[88:91], v8, s[8:11], s54 offen offset:2048 sc1
buffer_load_dwordx4 a[92:95], v8, s[8:11], s54 offen offset:3072 sc1
s_add_u32 s48, s48, 262144
v_mov_b32 v15, s53
s_mov_b32 s45, s53
s_cmp_eq_u32 s51, 0
s_cbranch_scc1 att_nopre_200
s_waitcnt vmcnt(13)
v_add_u32 v13, 1, v13
v_cmp_gt_u32 vcc, v13, v24
s_nop 0
s_and_b32 vcc_lo, vcc_lo, 0x40
s_cselect_b32 s55, 0, 1
s_cbranch_scc1 att_nokm_202
buffer_load_dwordx4 v[64:67], v9, s[4:7], s47 offen offset:0 sc1
buffer_load_dwordx4 v[68:71], v9, s[4:7], s47 offen offset:512 sc1
buffer_load_dwordx4 v[72:75], v9, s[4:7], s47 offen offset:1024 sc1
buffer_load_dwordx4 v[76:79], v9, s[4:7], s47 offen offset:1536 sc1
buffer_load_dwordx2 v[80:81], v10, s[4:7], s47 offen offset:0 sc1
buffer_load_dwordx2 v[82:83], v10, s[4:7], s47 offen offset:512 sc1
buffer_load_dwordx2 v[84:85], v10, s[4:7], s47 offen offset:1024 sc1
buffer_load_dwordx2 v[86:87], v10, s[4:7], s47 offen offset:1536 sc1
s_waitcnt vmcnt(13)
buffer_store_dword v15, v23, s[4:7], s52 offen
buffer_store_dword v15, v22, s[4:7], s52 offen sc1
s_waitcnt vmcnt(10)
s_branch att_nokm_202_j
att_nokm_202:
s_waitcnt vmcnt(5)
buffer_store_dword v15, v23, s[4:7], s52 offen
buffer_store_dword v15, v22, s[4:7], s52 offen sc1
s_waitcnt vmcnt(2)
att_nokm_202_j:
v_mfma_f32_16x16x32_bf16 v[28:31], a[32:35], a[0:3], 0
v_mfma_f32_16x16x32_bf16 v[32:35], a[32:35], a[4:7], 0
v_mfma_f32_16x16x32_bf16 v[36:39], a[36:39], a[4:7], 0
v_mfma_f32_16x16x32_bf16 v[28:31], a[40:43], a[8:11], v[28:31]
v_mfma_f32_16x16x32_bf16 v[32:35], a[40:43], a[12:15], v[32:35]
v_mfma_f32_16x16x32_bf16 v[36:39], a[44:47], a[12:15], v[36:39]
v_mfma_f32_16x16x32_bf16 v[28:31], a[48:51], a[16:19], v[28:31]
v_mfma_f32_16x16x32_bf16 v[32:35], a[48:51], a[20:23], v[32:35]
v_mfma_f32_16x16x32_bf16 v[36:39], a[52:55], a[20:23], v[36:39]
v_mfma_f32_16x16x32_bf16 v[28:31], a[56:59], a[24:27], v[28:31]
v_mfma_f32_16x16x32_bf16 v[32:35], a[56:59], a[28:31], v[32:35]
v_mfma_f32_16x16x32_bf16 v[36:39], a[60:63], a[28:31], v[36:39]
s_add_u32 s53, s45, 1
v_add_u32 v13, s53, v20
s_nop 3
v_cndmask_b32 v28, v16, v28, s[56:57]
v_cndmask_b32 v29, v16, v29, s[58:59]
v_cndmask_b32 v30, v16, v30, s[60:61]
v_cndmask_b32 v31, v16, v31, s[62:63]
v_cndmask_b32 v36, v16, v36, s[56:57]
v_cndmask_b32 v37, v16, v37, s[58:59]
v_cndmask_b32 v38, v16, v38, s[60:61]
v_cndmask_b32 v39, v16, v39, s[62:63]
v_max3_f32 v18, v32, v33, v34
v_max3_f32 v17, v28, v29, v30
v_max3_f32 v18, v18, v35, v36
v_max_f32 v17, v17, v31
v_max3_f32 v18, v18, v37, v38
v_max_f32 v18, v18, v39
att_j2_201:
s_branch att_loop_184
att_nopre_193:
s_waitcnt vmcnt(0)
buffer_store_dword v15, v23, s[4:7], s52 offen
buffer_store_dword v15, v22, s[4:7], s52 offen sc1
s_cmp_ge_u32 s45, 64
s_cbranch_scc1 att_done_185
s_add_u32 s49, s45, 1
s_mov_b32 s98, 0
sp_loop_203:
buffer_load_dword v24, v11, s[4:7], s52 offen sc1
s_add_u32 s98, s98, 1
s_cmp_gt_u32 s98, 150000
s_cbranch_scc1 sp_bad_205
s_waitcnt vmcnt(0)
v_cmp_gt_u32 vcc, s49, v24
s_nop 0
s_and_b32 vcc_lo, vcc_lo, 0x3f
s_cbranch_scc0 sp_ok_204
s_sleep 2
s_branch sp_loop_203
sp_bad_205:
s_mov_b32 s98, 1536
s_branch L_fail
sp_ok_204:
s_add_u32 s54, s46, 0
buffer_load_dwordx4 a[96:99], v8, s[4:7], s54 offen offset:0 sc1
buffer_load_dwordx4 a[100:103], v8, s[4:7], s54 offen offset:1024 sc1
buffer_load_dwordx4 a[104:107], v8, s[4:7], s54 offen offset:2048 sc1
buffer_load_dwordx4 a[108:111], v8, s[4:7], s54 offen offset:3072 sc1
s_add_u32 s54, s46, 4096
buffer_load_dwordx4 a[112:115], v8, s[4:7], s54 offen offset:0 sc1
buffer_load_dwordx4 a[116:119], v8, s[4:7], s54 offen offset:1024 sc1
buffer_load_dwordx4 a[120:123], v8, s[4:7], s54 offen offset:2048 sc1
buffer_load_dwordx4 a[124:127], v8, s[4:7], s54 offen offset:3072 sc1
s_add_u32 s54, s46, 8192
buffer_load_dwordx4 a[128:131], v8, s[4:7], s54 offen offset:0 sc1
buffer_load_dwordx4 a[132:135], v8, s[4:7], s54 offen offset:1024 sc1
buffer_load_dwordx4 a[136:139], v8, s[4:7], s54 offen offset:2048 sc1
buffer_load_dwordx4 a[140:143], v8, s[4:7], s54 offen offset:3072 sc1
s_add_u32 s54, s46, 12288
buffer_load_dwordx4 a[144:147], v8, s[4:7], s54 offen offset:0 sc1
buffer_load_dwordx4 a[148:151], v8, s[4:7], s54 offen offset:1024 sc1
buffer_load_dwordx4 a[152:155], v8, s[4:7], s54 offen offset:2048 sc1
buffer_load_dwordx4 a[156:159], v8, s[4:7], s54 offen offset:3072 sc1
s_add_u32 s54, s46, 16384
buffer_load_dwordx4 a[160:163], v8, s[4:7], s54 offen offset:0 sc1
buffer_load_dwordx4 a[164:167], v8, s[4:7], s54 offen offset:1024 sc1
buffer_load_dwordx4 a[168:171], v8, s[4:7], s54 offen offset:2048 sc1
buffer_load_dwordx4 a[172:175], v8, s[4:7], s54 offen offset:3072 sc1
s_add_u32 s54, s46, 20480
buffer_load_dwordx4 a[176:179], v8, s[4:7], s54 offen offset:0 sc1
buffer_load_dwordx4 a[180:183], v8, s[4:7], s54 offen offset:1024 sc1
buffer_load_dwordx4 a[184:187], v8, s[4:7], s54 offen offset:2048 sc1
buffer_load_dwordx4 a[188:191], v8, s[4:7], s54 offen offset:3072 sc1
s_waitcnt vmcnt(0)
s_mov_b32 s55, 0
v_mfma_f32_16x16x32_bf16 v[28:31], a[128:131], a[96:99], 0
v_mfma_f32_16x16x32_bf16 v[32:35], a[128:131], a[100:103], 0
v_mfma_f32_16x16x32_bf16 v[36:39], a[132:135], a[100:103], 0
v_mfma_f32_16x16x32_bf16 v[28:31], a[136:139], a[104:107], v[28:31]
v_mfma_f32_16x16x32_bf16 v[32:35], a[136:139], a[108:111], v[32:35]
v_mfma_f32_16x16x32_bf16 v[36:39], a[140:143], a[108:111], v[36:39]
v_mfma_f32_16x16x32_bf16 v[28:31], a[144:147], a[112:115], v[28:31]
v_mfma_f32_16x16x32_bf16 v[32:35], a[144:147], a[116:119], v[32:35]
v_mfma_f32_16x16x32_bf16 v[36:39], a[148:151], a[116:119], v[36:39]
v_mfma_f32_16x16x32_bf16 v[28:31], a[152:155], a[120:123], v[28:31]
v_mfma_f32_16x16x32_bf16 v[32:35], a[152:155], a[124:127], v[32:35]
v_mfma_f32_16x16x32_bf16 v[36:39], a[156:159], a[124:127], v[36:39]
s_add_u32 s53, s45, 1
v_add_u32 v13, s53, v20
s_nop 3
v_cndmask_b32 v28, v16, v28, s[56:57]
v_cndmask_b32 v29, v16, v29, s[58:59]
v_cndmask_b32 v30, v16, v30, s[60:61]
v_cndmask_b32 v31, v16, v31, s[62:63]
v_cndmask_b32 v36, v16, v36, s[56:57]
v_cndmask_b32 v37, v16, v37, s[58:59]
v_cndmask_b32 v38, v16, v38, s[60:61]
v_cndmask_b32 v39, v16, v39, s[62:63]
v_max3_f32 v18, v32, v33, v34
v_max3_f32 v17, v28, v29, v30
v_max3_f32 v18, v18, v35, v36
v_max_f32 v17, v17, v31
v_max3_f32 v18, v18, v37, v38
v_max_f32 v18, v18, v39
s_branch att_j2_194
att_nopre_200:
s_waitcnt vmcnt(0)
buffer_store_dword v15, v23, s[4:7], s52 offen
buffer_store_dword v15, v22, s[4:7], s52 offen sc1
s_cmp_ge_u32 s45, 64
s_cbranch_scc1 att_done_185
s_add_u32 s49, s45, 1
s_mov_b32 s98, 0
sp_loop_206:
buffer_load_dword v24, v11, s[4:7], s52 offen sc1
s_add_u32 s98, s98, 1
s_cmp_gt_u32 s98, 150000
s_cbranch_scc1 sp_bad_208
s_waitcnt vmcnt(0)
v_cmp_gt_u32 vcc, s49, v24
s_nop 0
s_and_b32 vcc_lo, vcc_lo, 0x3f
s_cbranch_scc0 sp_ok_207
s_sleep 2
s_branch sp_loop_206
sp_bad_208:
s_mov_b32 s98, 1536
s_branch L_fail
sp_ok_207:
s_add_u32 s54, s46, 0
buffer_load_dwordx4 a[0:3], v8, s[4:7], s54 offen offset:0 sc1
buffer_load_dwordx4 a[4:7], v8, s[4:7], s54 offen offset:1024 sc1
buffer_load_dwordx4 a[8:11], v8, s[4:7], s54 offen offset:2048 sc1
buffer_load_dwordx4 a[12:15], v8, s[4:7], s54 offen offset:3072 sc1
s_add_u32 s54, s46, 4096
buffer_load_dwordx4 a[16:19], v8, s[4:7], s54 offen offset:0 sc1
buffer_load_dwordx4 a[20:23], v8, s[4:7], s54 offen offset:1024 sc1
buffer_load_dwordx4 a[24:27], v8, s[4:7], s54 offen offset:2048 sc1
buffer_load_dwordx4 a[28:31], v8, s[4:7], s54 offen offset:3072 sc1
s_add_u32 s54, s46, 8192
buffer_load_dwordx4 a[32:35], v8, s[4:7], s54 offen offset:0 sc1
buffer_load_dwordx4 a[36:39], v8, s[4:7], s54 offen offset:1024 sc1
buffer_load_dwordx4 a[40:43], v8, s[4:7], s54 offen offset:2048 sc1
buffer_load_dwordx4 a[44:47], v8, s[4:7], s54 offen offset:3072 sc1
s_add_u32 s54, s46, 12288
buffer_load_dwordx4 a[48:51], v8, s[4:7], s54 offen offset:0 sc1
buffer_load_dwordx4 a[52:55], v8, s[4:7], s54 offen offset:1024 sc1
buffer_load_dwordx4 a[56:59], v8, s[4:7], s54 offen offset:2048 sc1
buffer_load_dwordx4 a[60:63], v8, s[4:7], s54 offen offset:3072 sc1
s_add_u32 s54, s46, 16384
buffer_load_dwordx4 a[64:67], v8, s[4:7], s54 offen offset:0 sc1
buffer_load_dwordx4 a[68:71], v8, s[4:7], s54 offen offset:1024 sc1
buffer_load_dwordx4 a[72:75], v8, s[4:7], s54 offen offset:2048 sc1
buffer_load_dwordx4 a[76:79], v8, s[4:7], s54 offen offset:3072 sc1
s_add_u32 s54, s46, 20480
buffer_load_dwordx4 a[80:83], v8, s[4:7], s54 offen offset:0 sc1
buffer_load_dwordx4 a[84:87], v8, s[4:7], s54 offen offset:1024 sc1
buffer_load_dwordx4 a[88:91], v8, s[4:7], s54 offen offset:2048 sc1
buffer_load_dwordx4 a[92:95], v8, s[4:7], s54 offen offset:3072 sc1
s_waitcnt vmcnt(0)
s_mov_b32 s55, 0
v_mfma_f32_16x16x32_bf16 v[28:31], a[32:35], a[0:3], 0
v_mfma_f32_16x16x32_bf16 v[32:35], a[32:35], a[4:7], 0
v_mfma_f32_16x16x32_bf16 v[36:39], a[36:39], a[4:7], 0
v_mfma_f32_16x16x32_bf16 v[28:31], a[40:43], a[8:11], v[28:31]
v_mfma_f32_16x16x32_bf16 v[32:35], a[40:43], a[12:15], v[32:35]
v_mfma_f32_16x16x32_bf16 v[36:39], a[44:47], a[12:15], v[36:39]
v_mfma_f32_16x16x32_bf16 v[28:31], a[48:51], a[16:19], v[28:31]
v_mfma_f32_16x16x32_bf16 v[32:35], a[48:51], a[20:23], v[32:35]
v_mfma_f32_16x16x32_bf16 v[36:39], a[52:55], a[20:23], v[36:39]
v_mfma_f32_16x16x32_bf16 v[28:31], a[56:59], a[24:27], v[28:31]
v_mfma_f32_16x16x32_bf16 v[32:35], a[56:59], a[28:31], v[32:35]
v_mfma_f32_16x16x32_bf16 v[36:39], a[60:63], a[28:31], v[36:39]
s_add_u32 s53, s45, 1
v_add_u32 v13, s53, v20
s_nop 3
v_cndmask_b32 v28, v16, v28, s[56:57]
v_cndmask_b32 v29, v16, v29, s[58:59]
v_cndmask_b32 v30, v16, v30, s[60:61]
v_cndmask_b32 v31, v16, v31, s[62:63]
v_cndmask_b32 v36, v16, v36, s[56:57]
v_cndmask_b32 v37, v16, v37, s[58:59]
v_cndmask_b32 v38, v16, v38, s[60:61]
v_cndmask_b32 v39, v16, v39, s[62:63]
v_max3_f32 v18, v32, v33, v34
v_max3_f32 v17, v28, v29, v30
v_max3_f32 v18, v18, v35, v36
v_max_f32 v17, v17, v31
v_max3_f32 v18, v18, v37, v38
v_max_f32 v18, v18, v39
s_branch att_j2_201
att_done_185:
s_endpgm
H_red:
s_mov_b32 s44, s74
s_cmp_lg_u32 s44, 0
s_cbranch_scc1 nozero_209
s_lshl_b32 s46, s3, 15
s_add_u32 s46, s46, 0
v_lshlrev_b32 v2, 4, v0
v_mov_b64 v[4:5], 0
v_mov_b64 v[6:7], 0
buffer_store_dwordx4 v[4:7], v2, s[4:7], s46 offen offset:0 sc1
buffer_store_dwordx4 v[4:7], v2, s[4:7], s46 offen offset:1024 sc1
buffer_store_dwordx4 v[4:7], v2, s[4:7], s46 offen offset:2048 sc1
buffer_store_dwordx4 v[4:7], v2, s[4:7], s46 offen offset:3072 sc1
s_add_u32 s46, s46, 4096
buffer_store_dwordx4 v[4:7], v2, s[4:7], s46 offen offset:0 sc1
buffer_store_dwordx4 v[4:7], v2, s[4:7], s46 offen offset:1024 sc1
buffer_store_dwordx4 v[4:7], v2, s[4:7], s46 offen offset:2048 sc1
buffer_store_dwordx4 v[4:7], v2, s[4:7], s46 offen offset:3072 sc1
s_add_u32 s46, s46, 4096
buffer_store_dwordx4 v[4:7], v2, s[4:7], s46 offen offset:0 sc1
buffer_store_dwordx4 v[4:7], v2, s[4:7], s46 offen offset:1024 sc1
buffer_store_dwordx4 v[4:7], v2, s[4:7], s46 offen offset:2048 sc1
buffer_store_dwordx4 v[4:7], v2, s[4:7], s46 offen offset:3072 sc1
s_add_u32 s46, s46, 4096
buffer_store_dwordx4 v[4:7], v2, s[4:7], s46 offen offset:0 sc1
buffer_store_dwordx4 v[4:7], v2, s[4:7], s46 offen offset:1024 sc1
buffer_store_dwordx4 v[4:7], v2, s[4:7], s46 offen offset:2048 sc1
buffer_store_dwordx4 v[4:7], v2, s[4:7], s46 offen offset:3072 sc1
s_add_u32 s46, s46, 4096
buffer_store_dwordx4 v[4:7], v2, s[4:7], s46 offen offset:0 sc1
buffer_store_dwordx4 v[4:7], v2, s[4:7], s46 offen offset:1024 sc1
buffer_store_dwordx4 v[4:7], v2, s[4:7], s46 offen offset:2048 sc1
buffer_store_dwordx4 v[4:7], v2, s[4:7], s46 offen offset:3072 sc1
s_add_u32 s46, s46, 4096
buffer_store_dwordx4 v[4:7], v2, s[4:7], s46 offen offset:0 sc1
buffer_store_dwordx4 v[4:7], v2, s[4:7], s46 offen offset:1024 sc1
buffer_store_dwordx4 v[4:7], v2, s[4:7], s46 offen offset:2048 sc1
buffer_store_dwordx4 v[4:7], v2, s[4:7], s46 offen offset:3072 sc1
s_add_u32 s46, s46, 4096
buffer_store_dwordx4 v[4:7], v2, s[4:7], s46 offen offset:0 sc1
buffer_store_dwordx4 v[4:7], v2, s[4:7], s46 offen offset:1024 sc1
buffer_store_dwordx4 v[4:7], v2, s[4:7], s46 offen offset:2048 sc1
buffer_store_dwordx4 v[4:7], v2, s[4:7], s46 offen offset:3072 sc1
s_add_u32 s46, s46, 4096
buffer_store_dwordx4 v[4:7], v2, s[4:7], s46 offen offset:0 sc1
buffer_store_dwordx4 v[4:7], v2, s[4:7], s46 offen offset:1024 sc1
buffer_store_dwordx4 v[4:7], v2, s[4:7], s46 offen offset:2048 sc1
buffer_store_dwordx4 v[4:7], v2, s[4:7], s46 offen offset:3072 sc1
s_add_u32 s46, s46, 4096
s_waitcnt vmcnt(0)
s_barrier
s_cmp_lg_u32 s3, 0
s_cbranch_scc1 nozero_209
s_mov_b32 s12, s40
s_and_b32 s13, s41, 0xffff
s_mov_b32 s14, 256
s_mov_b32 s15, 0x20000
v_mov_b32 v2, 32
v_mov_b32 v3, 192
s_mov_b64 exec, 1
buffer_store_dword v2, v3, s[12:15], 0 offen sc1
s_mov_b64 exec, -1
nozero_209:
v_and_b32 v1, 15, v0
v_lshrrev_b32 v2, 4, v0
v_and_b32 v3, 1, v0
v_bfe_u32 v4, v0, 1, 3
v_bfe_u32 v5, v0, 4, 1
v_lshrrev_b32 v6, 5, v0
s_mul_i32 s46, s44, 2304
v_mul_u32_u24 v7, 36864, v2
v_lshl_add_u32 v7, v1, 4, v7
v_add_u32 v8, s46, v7
v_lshlrev_b32 v7, 9, v5
v_lshl_add_u32 v7, v6, 8, v7
v_lshl_add_u32 v7, v1, 4, v7
v_add_u32 v10, s46, v7
v_lshlrev_b32 v7, 4, v1
v_lshl_add_u32 v7, v5, 3, v7
v_add_u32 v11, s46, v7
v_mul_u32_u24 v7, 1152, v3
v_lshl_add_u32 v7, v4, 4, v7
v_add_u32 v7, s46, v7
v_lshl_add_u32 v13, v5, 3, v7
v_lshl_add_u32 v9, v6, 7, v13
v_lshl_add_u32 v7, v6, 7, v7
v_lshl_add_u32 v12, v5, 8, v7
v_lshlrev_b32 v7, 4, v3
v_mov_b32 v22, 0x3f80
v_lshlrev_b32 v7, v7, v22
v_cmp_eq_u32 vcc, 0, v4
s_nop 1
v_cndmask_b32 v28, 0, v7, vcc
v_cmp_eq_u32 vcc, 1, v4
s_nop 1
v_cndmask_b32 v29, 0, v7, vcc
v_cmp_eq_u32 vcc, 2, v4
s_nop 1
v_cndmask_b32 v30, 0, v7, vcc
v_cmp_eq_u32 vcc, 3, v4
s_nop 1
v_cndmask_b32 v31, 0, v7, vcc
v_cmp_eq_u32 vcc, 4, v4
s_nop 1
v_cndmask_b32 v32, 0, v7, vcc
v_cmp_eq_u32 vcc, 5, v4
s_nop 1
v_cndmask_b32 v33, 0, v7, vcc
v_cmp_eq_u32 vcc, 6, v4
s_nop 1
v_cndmask_b32 v34, 0, v7, vcc
v_cmp_eq_u32 vcc, 7, v4
s_nop 1
v_cndmask_b32 v35, 0, v7, vcc
s_mul_i32 s46, s44, 128
v_mov_b32 v1, s46
v_mov_b32 v22, 2147483632
v_cmp_eq_u32 vcc, 0, v0
s_nop 1
v_cndmask_b32 v36, v22, v1, vcc
v_add_u32 v37, 65536, v36
v_lshlrev_b32 v1, 2, v0
v_add_u32 v1, 147456, v1
v_mov_b32 v2, 0
ds_write_b32 v1, v2
v_mov_b32 v14, 147460
s_mov_b32 s8, s20
s_and_b32 s9, s21, 0xffff
s_mov_b32 s10, 2359296
s_mov_b32 s11, 0x20000
s_mov_b32 s16, s38
s_and_b32 s17, s39, 0xffff
s_mov_b32 s18, 2359296
s_mov_b32 s19, 0x20000
s_mov_b32 s45, s3
s_mov_b32 s52, 1384448
s_mov_b32 s50, 0
s_mul_i32 s47, s45, 36864
buffer_load_dwordx2 v[60:61], v9, s[8:11], s47 offen offset:0
buffer_load_dwordx2 v[62:63], v9, s[8:11], s47 offen offset:256
buffer_load_dwordx2 v[64:65], v9, s[8:11], s47 offen offset:512
buffer_load_dwordx2 v[66:67], v9, s[8:11], s47 offen offset:768
v_mov_b64 v[68:69], 0
s_mov_b64 exec, 0xffffffff
buffer_load_dwordx2 v[68:69], v9, s[8:11], s47 offen offset:1024
s_mov_b64 exec, -1
s_waitcnt lgkmcnt(0)
s_barrier
s_mov_b32 s12, s40
s_and_b32 s13, s41, 0xffff
s_mov_b32 s14, 256
s_mov_b32 s15, 0x20000
v_lshlrev_b32 v17, 2, v0
v_add_u32 v18, 128, v17
v_cmp_le_u32 vcc, 2, v0
s_nop 1
v_cndmask_b32 v17, v17, v18, vcc
v_mov_b32 v18, 192
v_cmp_eq_u32 vcc, 8, v0
s_nop 1
v_cndmask_b32 v17, v17, v18, vcc
v_mov_b32 v18, 2147483632
v_cmp_lt_u32 vcc, 8, v0
s_nop 1
v_cndmask_b32 v17, v17, v18, vcc
s_mov_b32 s98, 0
wi_loop_210:
buffer_load_dword v18, v17, s[12:15], 0 offen sc1
s_add_u32 s98, s98, 1
s_cmp_gt_u32 s98, 150000
s_cbranch_scc1 wi_bad_212
s_waitcnt vmcnt(0)
v_cmp_eq_u32 vcc, 32, v18
s_nop 0
s_and_b32 s97, vcc_lo, 0x1ff
s_cmp_eq_u32 s97, 0x1ff
s_cbranch_scc1 wi_ok_211
v_cmp_lt_u32 vcc, 32, v18
s_nop 0
s_and_b32 s96, vcc_lo, 0xff
s_cselect_b32 s96, 0x100, 0
s_and_b32 s96, s96, s97
s_cbranch_scc1 wi_over_213
s_sleep 8
s_branch wi_loop_210
wi_bad_212:
s_mov_b32 s98, 512
s_branch L_fail
wi_over_213:
s_mov_b32 s100, 255
wi_ok_211:
ln0_214:
v_lshlrev_b32 v40, 16, v60
v_and_b32 v41, 0xffff0000, v60
v_lshlrev_b32 v42, 16, v61
v_and_b32 v43, 0xffff0000, v61
v_lshlrev_b32 v44, 16, v62
v_and_b32 v45, 0xffff0000, v62
v_lshlrev_b32 v46, 16, v63
v_and_b32 v47, 0xffff0000, v63
v_lshlrev_b32 v48, 16, v64
v_and_b32 v49, 0xffff0000, v64
v_lshlrev_b32 v50, 16, v65
v_and_b32 v51, 0xffff0000, v65
v_lshlrev_b32 v52, 16, v66
v_and_b32 v53, 0xffff0000, v66
v_lshlrev_b32 v54, 16, v67
v_and_b32 v55, 0xffff0000, v67
v_lshlrev_b32 v56, 16, v68
v_and_b32 v57, 0xffff0000, v68
v_lshlrev_b32 v58, 16, v69
v_and_b32 v59, 0xffff0000, v69
v_mul_f32 v20, v40, v40
v_add_f32 v19, v40, v41
v_fmac_f32 v20, v41, v41
v_add_f32 v19, v19, v42
v_fmac_f32 v20, v42, v42
v_add_f32 v19, v19, v43
v_fmac_f32 v20, v43, v43
v_add_f32 v19, v19, v44
v_fmac_f32 v20, v44, v44
v_add_f32 v19, v19, v45
v_fmac_f32 v20, v45, v45
v_add_f32 v19, v19, v46
v_fmac_f32 v20, v46, v46
v_add_f32 v19, v19, v47
v_fmac_f32 v20, v47, v47
v_add_f32 v19, v19, v48
v_fmac_f32 v20, v48, v48
v_add_f32 v19, v19, v49
v_fmac_f32 v20, v49, v49
v_add_f32 v19, v19, v50
v_fmac_f32 v20, v50, v50
v_add_f32 v19, v19, v51
v_fmac_f32 v20, v51, v51
v_add_f32 v19, v19, v52
v_fmac_f32 v20, v52, v52
v_add_f32 v19, v19, v53
v_fmac_f32 v20, v53, v53
v_add_f32 v19, v19, v54
v_fmac_f32 v20, v54, v54
v_add_f32 v19, v19, v55
v_fmac_f32 v20, v55, v55
v_add_f32 v19, v19, v56
v_fmac_f32 v20, v56, v56
v_add_f32 v19, v19, v57
v_fmac_f32 v20, v57, v57
v_add_f32 v19, v19, v58
v_fmac_f32 v20, v58, v58
v_add_f32 v19, v19, v59
v_fmac_f32 v20, v59, v59
s_mul_i32 s47, s45, 36864
s_add_u32 s47, s47, s52
v_permlane32_swap_b32 v19, v20
v_add_f32 v19, v19, v20
v_mov_b32 v21, v19
s_nop 1
v_permlane16_swap_b32 v19, v21
v_add_f32 v19, v19, v21
s_nop 1
v_add_f32_dpp v19, v19, v19 quad_perm:[2,3,0,1] row_mask:0xf bank_mask:0xf
s_nop 1
v_add_f32_dpp v19, v19, v19 row_ror:4 row_mask:0xf bank_mask:0xf
s_nop 1
v_add_f32_dpp v19, v19, v19 row_ror:8 row_mask:0xf bank_mask:0xf
v_mul_f32 v19, 0x3ae38e39, v19
v_mov_b32 v20, v19
s_nop 1
v_permlane32_swap_b32 v19, v20
v_fma_f32 v20, -v19, v19, v20
v_max_f32 v20, 0, v20
v_add_f32 v20, 0x3727c5ac, v20
v_rsq_f32 v20, v20
s_nop 0
v_mul_f32 v19, v19, v20
v_fma_f32 v40, v40, v20, -v19
v_fma_f32 v41, v41, v20, -v19
v_fma_f32 v42, v42, v20, -v19
v_fma_f32 v43, v43, v20, -v19
v_fma_f32 v44, v44, v20, -v19
v_fma_f32 v45, v45, v20, -v19
v_fma_f32 v46, v46, v20, -v19
v_fma_f32 v47, v47, v20, -v19
v_fma_f32 v48, v48, v20, -v19
v_fma_f32 v49, v49, v20, -v19
v_fma_f32 v50, v50, v20, -v19
v_fma_f32 v51, v51, v20, -v19
v_fma_f32 v52, v52, v20, -v19
v_fma_f32 v53, v53, v20, -v19
v_fma_f32 v54, v54, v20, -v19
v_fma_f32 v55, v55, v20, -v19
v_fma_f32 v56, v56, v20, -v19
v_fma_f32 v57, v57, v20, -v19
v_fma_f32 v58, v58, v20, -v19
v_fma_f32 v59, v59, v20, -v19
v_cvt_pk_bf16_f32 v72, v40, v41
v_cvt_pk_bf16_f32 v74, v44, v45
v_cvt_pk_bf16_f32 v73, v42, v43
v_cvt_pk_bf16_f32 v75, v46, v47
v_permlane16_swap_b32 v72, v74
s_nop 0
v_permlane16_swap_b32 v73, v75
buffer_store_dwordx4 v[72:75], v10, s[4:7], s47 offen offset:0 sc1
v_cvt_pk_bf16_f32 v76, v48, v49
v_cvt_pk_bf16_f32 v78, v52, v53
v_cvt_pk_bf16_f32 v77, v50, v51
v_cvt_pk_bf16_f32 v79, v54, v55
v_permlane16_swap_b32 v76, v78
s_nop 0
v_permlane16_swap_b32 v77, v79
buffer_store_dwordx4 v[76:79], v10, s[4:7], s47 offen offset:1024 sc1
v_cvt_pk_bf16_f32 v80, v56, v57
v_cvt_pk_bf16_f32 v81, v58, v59
s_mov_b64 exec, 0xffffffff
buffer_store_dwordx2 v[80:81], v11, s[4:7], s47 offen offset:2048 sc1
s_mov_b64 exec, -1
s_add_u32 s45, s45, 4
s_cmp_ge_u32 s45, 64
s_cbranch_scc1 ln0_done_215
s_mul_i32 s47, s45, 36864
buffer_load_dwordx2 v[60:61], v9, s[8:11], s47 offen offset:0
buffer_load_dwordx2 v[62:63], v9, s[8:11], s47 offen offset:256
buffer_load_dwordx2 v[64:65], v9, s[8:11], s47 offen offset:512
buffer_load_dwordx2 v[66:67], v9, s[8:11], s47 offen offset:768
v_mov_b64 v[68:69], 0
s_mov_b64 exec, 0xffffffff
buffer_load_dwordx2 v[68:69], v9, s[8:11], s47 offen offset:1024
s_mov_b64 exec, -1
s_waitcnt vmcnt(0)
v_mov_b32 v17, 1
s_mov_b64 exec, 1
ds_add_rtn_u32 v17, v14, v17
s_mov_b64 exec, -1
s_andn2_b32 s48, s45, 3
s_waitcnt lgkmcnt(0)
v_readfirstlane_b32 s47, v17
v_mov_b32 v18, s48
s_and_b32 s47, s47, 3
s_cmp_lg_u32 s47, 3
s_cbranch_scc1 nolast_216
buffer_store_dword v18, v36, s[4:7], s50 offen sc1
buffer_store_dword v18, v37, s[4:7], s50 offen
nolast_216:
v_add_u32 v14, 4, v14
s_branch ln0_214
ln0_done_215:
s_waitcnt vmcnt(0)
v_mov_b32 v17, 1
s_mov_b64 exec, 1
ds_add_rtn_u32 v17, v14, v17
s_mov_b64 exec, -1
s_andn2_b32 s48, s45, 3
s_waitcnt lgkmcnt(0)
v_readfirstlane_b32 s47, v17
v_mov_b32 v18, s48
s_and_b32 s47, s47, 3
s_cmp_lg_u32 s47, 3
s_cbranch_scc1 nolast_217
buffer_store_dword v18, v36, s[4:7], s50 offen sc1
buffer_store_dword v18, v37, s[4:7], s50 offen
nolast_217:
v_add_u32 v14, 4, v14
s_mov_b32 s99, 100
s_and_b32 s47, s3, 1
s_mul_i32 s51, s47, 18874368
s_add_u32 s51, s51, 199565312
s_mul_i32 s47, s47, 11264
s_add_u32 s47, s47, 18432
v_mul_u32_u24 v1, 128, v0
v_add_u32 v1, s47, v1
v_mov_b32 v7, 2147483632
v_cmp_gt_u32 vcc, 24, v0
s_nop 1
v_cndmask_b32 v15, v7, v1, vcc
s_getpc_b64 s[96:97]
pc_218:
s_add_u32 s96, s96, L_writers-pc_218
s_addc_u32 s97, s97, 0
v_subrev_u32 v2, 0, v15
v_lshrrev_b32 v2, 7, v2
v_cmp_gt_u32 vcc, 0x200, v2
s_nop 1
v_cndmask_b32 v2, 0, v2, vcc
global_load_ubyte v2, v2, s[96:97]
s_waitcnt vmcnt(0)
v_add_u32 v3, 65536, v15
v_cmp_eq_u32 vcc, s100, v2
s_nop 1
v_cndmask_b32 v15, v15, v3, vcc
s_lshr_b32 s47, s3, 1
s_mul_i32 s49, s47, 32768
s_mov_b32 s52, 6103040
s_mov_b32 s50, 21504
s_cmp_eq_u32 s3, 1
s_cselect_b32 s52, 3743744, s52
s_cselect_b32 s50, 32768, s50
s_cmp_eq_u32 s3, 2
s_cselect_b32 s52, 8462336, s52
s_cselect_b32 s50, 54272, s50
s_mov_b32 s45, 0
v_mov_b32 v16, 2147483632
s_cmp_eq_u32 s3, 3
s_cbranch_scc1 red_fin_220
s_cmp_lg_u32 s3, 0
s_cbranch_scc1 red_mid_219
red_loop_221:
s_add_u32 s48, s45, 1
s_mov_b32 s98, 0
grd_224:
v_mov_b32 v1, 147456
ds_read_b32 v2, v1
s_waitcnt lgkmcnt(0)
v_readfirstlane_b32 s47, v2
s_nop 0
s_add_u32 s47, s47, 32
s_cmp_gt_u32 s47, s45
s_cbranch_scc1 grd_ok_225
s_add_u32 s98, s98, 1
s_cmp_gt_u32 s98, 600000
s_cbranch_scc1 grd_bad_226
s_sleep 2
s_branch grd_224
grd_bad_226:
s_mov_b32 s98, 1280
s_branch L_fail
grd_ok_225:
s_mov_b32 s98, 0
sp_loop_227:
buffer_load_dword v24, v15, s[4:7], s49 offen sc1
s_add_u32 s98, s98, 1
s_cmp_gt_u32 s98, 150000
s_cbranch_scc1 sp_bad_229
s_waitcnt vmcnt(0)
v_cmp_gt_u32 vcc, s48, v24
s_nop 0
s_and_b32 vcc_lo, vcc_lo, 0xffffff
s_cbranch_scc0 sp_ok_228
s_sleep 2
s_branch sp_loop_227
sp_bad_229:
s_mov_b32 s98, 1281
s_branch L_fail
sp_ok_228:
s_mul_i32 s47, s45, 36864
buffer_load_dwordx2 v[60:61], v9, s[8:11], s47 offen offset:0
buffer_load_dwordx2 v[62:63], v9, s[8:11], s47 offen offset:256
buffer_load_dwordx2 v[64:65], v9, s[8:11], s47 offen offset:512
buffer_load_dwordx2 v[66:67], v9, s[8:11], s47 offen offset:768
v_mov_b64 v[68:69], 0
s_mov_b64 exec, 0xffffffff
buffer_load_dwordx2 v[68:69], v9, s[8:11], s47 offen offset:1024
s_mov_b64 exec, -1
s_mul_i32 s47, s45, 294912
s_add_u32 s47, s47, s51
s_add_u32 s46, s47, 147456
buffer_load_dwordx4 v[96:99], v8, s[4:7], s47 offen offset:0 sc1
buffer_load_dwordx4 v[100:103], v8, s[4:7], s46 offen offset:0 sc1
buffer_load_dwordx4 v[104:107], v8, s[4:7], s47 offen offset:256 sc1
buffer_load_dwordx4 v[108:111], v8, s[4:7], s46 offen offset:256 sc1
buffer_load_dwordx4 v[112:115], v8, s[4:7], s47 offen offset:512 sc1
buffer_load_dwordx4 v[116:119], v8, s[4:7], s46 offen offset:512 sc1
buffer_load_dwordx4 v[120:123], v8, s[4:7], s47 offen offset:768 sc1
buffer_load_dwordx4 v[124:127], v8, s[4:7], s46 offen offset:768 sc1
buffer_load_dwordx4 v[128:131], v8, s[4:7], s47 offen offset:1024 sc1
buffer_load_dwordx4 v[132:135], v8, s[4:7], s46 offen offset:1024 sc1
buffer_load_dwordx4 v[136:139], v8, s[4:7], s47 offen offset:1280 sc1
buffer_load_dwordx4 v[140:143], v8, s[4:7], s46 offen offset:1280 sc1
buffer_load_dwordx4 v[144:147], v8, s[4:7], s47 offen offset:1536 sc1
buffer_load_dwordx4 v[148:151], v8, s[4:7], s46 offen offset:1536 sc1
buffer_load_dwordx4 v[152:155], v8, s[4:7], s47 offen offset:1792 sc1
buffer_load_dwordx4 v[156:159], v8, s[4:7], s46 offen offset:1792 sc1
buffer_load_dwordx4 v[160:163], v8, s[4:7], s47 offen offset:2048 sc1
buffer_load_dwordx4 v[164:167], v8, s[4:7], s46 offen offset:2048 sc1
buffer_store_dword v18, v16, s[4:7], 0 offen
buffer_store_dword v18, v16, s[4:7], 0 offen
red_have_222:
buffer_load_dword v24, v15, s[4:7], s49 offen sc1
s_and_b32 s47, s45, 31
s_mul_i32 s47, s47, 4608
v_lshlrev_b32 v14, 4, v0
v_add_u32 v14, s47, v14
s_waitcnt vmcnt(21)
v_lshlrev_b32 v40, 16, v60
v_and_b32 v41, 0xffff0000, v60
v_lshlrev_b32 v42, 16, v61
v_and_b32 v43, 0xffff0000, v61
v_lshlrev_b32 v44, 16, v62
v_and_b32 v45, 0xffff0000, v62
v_lshlrev_b32 v46, 16, v63
v_and_b32 v47, 0xffff0000, v63
v_lshlrev_b32 v48, 16, v64
v_and_b32 v49, 0xffff0000, v64
v_lshlrev_b32 v50, 16, v65
v_and_b32 v51, 0xffff0000, v65
v_lshlrev_b32 v52, 16, v66
v_and_b32 v53, 0xffff0000, v66
v_lshlrev_b32 v54, 16, v67
v_and_b32 v55, 0xffff0000, v67
v_lshlrev_b32 v56, 16, v68
v_and_b32 v57, 0xffff0000, v68
v_lshlrev_b32 v58, 16, v69
v_and_b32 v59, 0xffff0000, v69
s_waitcnt vmcnt(20)
v_mfma_f32_16x16x32_bf16 v[40:43], v[28:31], v[96:99], v[40:43]
s_waitcnt vmcnt(19)
v_mfma_f32_16x16x32_bf16 v[40:43], v[28:31], v[100:103], v[40:43]
s_waitcnt vmcnt(18)
v_mfma_f32_16x16x32_bf16 v[40:43], v[32:35], v[104:107], v[40:43]
s_waitcnt vmcnt(17)
v_mfma_f32_16x16x32_bf16 v[40:43], v[32:35], v[108:111], v[40:43]
s_waitcnt vmcnt(16)
v_mfma_f32_16x16x32_bf16 v[44:47], v[28:31], v[112:115], v[44:47]
s_waitcnt vmcnt(15)
v_mfma_f32_16x16x32_bf16 v[44:47], v[28:31], v[116:119], v[44:47]
s_nop 3
ds_write_b128 v14, v[40:43] offset:0
v_mul_f32 v20, v40, v40
v_add_f32 v19, v40, v41
v_fmac_f32 v20, v41, v41
v_add_f32 v19, v19, v42
v_fmac_f32 v20, v42, v42
v_add_f32 v19, v19, v43
v_fmac_f32 v20, v43, v43
s_waitcnt vmcnt(14)
v_mfma_f32_16x16x32_bf16 v[44:47], v[32:35], v[120:123], v[44:47]
s_waitcnt vmcnt(13)
v_mfma_f32_16x16x32_bf16 v[44:47], v[32:35], v[124:127], v[44:47]
s_waitcnt vmcnt(12)
v_mfma_f32_16x16x32_bf16 v[48:51], v[28:31], v[128:131], v[48:51]
s_waitcnt vmcnt(11)
v_mfma_f32_16x16x32_bf16 v[48:51], v[28:31], v[132:135], v[48:51]
s_nop 3
ds_write_b128 v14, v[44:47] offset:1024
v_add_f32 v19, v19, v44
v_fmac_f32 v20, v44, v44
v_add_f32 v19, v19, v45
v_fmac_f32 v20, v45, v45
v_add_f32 v19, v19, v46
v_fmac_f32 v20, v46, v46
v_add_f32 v19, v19, v47
v_fmac_f32 v20, v47, v47
s_waitcnt vmcnt(10)
v_mfma_f32_16x16x32_bf16 v[48:51], v[32:35], v[136:139], v[48:51]
s_waitcnt vmcnt(9)
v_mfma_f32_16x16x32_bf16 v[48:51], v[32:35], v[140:143], v[48:51]
s_waitcnt vmcnt(8)
v_mfma_f32_16x16x32_bf16 v[52:55], v[28:31], v[144:147], v[52:55]
s_waitcnt vmcnt(7)
v_mfma_f32_16x16x32_bf16 v[52:55], v[28:31], v[148:151], v[52:55]
s_nop 3
ds_write_b128 v14, v[48:51] offset:2048
v_add_f32 v19, v19, v48
v_fmac_f32 v20, v48, v48
v_add_f32 v19, v19, v49
v_fmac_f32 v20, v49, v49
v_add_f32 v19, v19, v50
v_fmac_f32 v20, v50, v50
v_add_f32 v19, v19, v51
v_fmac_f32 v20, v51, v51
s_waitcnt vmcnt(6)
v_mfma_f32_16x16x32_bf16 v[52:55], v[32:35], v[152:155], v[52:55]
s_waitcnt vmcnt(5)
v_mfma_f32_16x16x32_bf16 v[52:55], v[32:35], v[156:159], v[52:55]
s_waitcnt vmcnt(4)
v_mfma_f32_16x16x32_bf16 v[56:59], v[28:31], v[160:163], v[56:59]
s_waitcnt vmcnt(3)
v_mfma_f32_16x16x32_bf16 v[56:59], v[28:31], v[164:167], v[56:59]
s_nop 3
ds_write_b128 v14, v[52:55] offset:3072
v_add_f32 v19, v19, v52
v_fmac_f32 v20, v52, v52
v_add_f32 v19, v19, v53
v_fmac_f32 v20, v53, v53
v_add_f32 v19, v19, v54
v_fmac_f32 v20, v54, v54
v_add_f32 v19, v19, v55
v_fmac_f32 v20, v55, v55
s_mov_b64 exec, 0xffffffff
ds_write_b128 v14, v[56:59] offset:4096
s_mov_b64 exec, -1
v_add_f32 v19, v19, v56
v_fmac_f32 v20, v56, v56
v_add_f32 v19, v19, v57
v_fmac_f32 v20, v57, v57
v_add_f32 v19, v19, v58
v_fmac_f32 v20, v58, v58
v_add_f32 v19, v19, v59
v_fmac_f32 v20, v59, v59
s_mul_i32 s47, s45, 36864
s_add_u32 s47, s47, s52
v_permlane32_swap_b32 v19, v20
v_add_f32 v19, v19, v20
v_mov_b32 v21, v19
s_nop 1
v_permlane16_swap_b32 v19, v21
v_add_f32 v19, v19, v21
s_nop 1
v_add_f32_dpp v19, v19, v19 quad_perm:[2,3,0,1] row_mask:0xf bank_mask:0xf
s_nop 1
v_add_f32_dpp v19, v19, v19 row_ror:4 row_mask:0xf bank_mask:0xf
s_nop 1
v_add_f32_dpp v19, v19, v19 row_ror:8 row_mask:0xf bank_mask:0xf
v_mul_f32 v19, 0x3ae38e39, v19
v_mov_b32 v20, v19
s_nop 1
v_permlane32_swap_b32 v19, v20
v_fma_f32 v20, -v19, v19, v20
v_max_f32 v20, 0, v20
v_add_f32 v20, 0x3727c5ac, v20
v_rsq_f32 v20, v20
s_nop 0
v_mul_f32 v19, v19, v20
v_fma_f32 v40, v40, v20, -v19
v_fma_f32 v41, v41, v20, -v19
v_fma_f32 v42, v42, v20, -v19
v_fma_f32 v43, v43, v20, -v19
v_fma_f32 v44, v44, v20, -v19
v_fma_f32 v45, v45, v20, -v19
v_fma_f32 v46, v46, v20, -v19
v_fma_f32 v47, v47, v20, -v19
v_fma_f32 v48, v48, v20, -v19
v_fma_f32 v49, v49, v20, -v19
v_fma_f32 v50, v50, v20, -v19
v_fma_f32 v51, v51, v20, -v19
v_fma_f32 v52, v52, v20, -v19
v_fma_f32 v53, v53, v20, -v19
v_fma_f32 v54, v54, v20, -v19
v_fma_f32 v55, v55, v20, -v19
v_fma_f32 v56, v56, v20, -v19
v_fma_f32 v57, v57, v20, -v19
v_fma_f32 v58, v58, v20, -v19
v_fma_f32 v59, v59, v20, -v19
v_cvt_pk_bf16_f32 v72, v40, v41
v_cvt_pk_bf16_f32 v74, v44, v45
v_cvt_pk_bf16_f32 v73, v42, v43
v_cvt_pk_bf16_f32 v75, v46, v47
v_permlane16_swap_b32 v72, v74
s_nop 0
v_permlane16_swap_b32 v73, v75
buffer_store_dwordx4 v[72:75], v10, s[4:7], s47 offen offset:0 sc1
v_cvt_pk_bf16_f32 v76, v48, v49
v_cvt_pk_bf16_f32 v78, v52, v53
v_cvt_pk_bf16_f32 v77, v50, v51
v_cvt_pk_bf16_f32 v79, v54, v55
v_permlane16_swap_b32 v76, v78
s_nop 0
v_permlane16_swap_b32 v77, v79
buffer_store_dwordx4 v[76:79], v10, s[4:7], s47 offen offset:1024 sc1
v_cvt_pk_bf16_f32 v80, v56, v57
v_cvt_pk_bf16_f32 v81, v58, v59
s_mov_b64 exec, 0xffffffff
buffer_store_dwordx2 v[80:81], v11, s[4:7], s47 offen offset:2048 sc1
s_mov_b64 exec, -1
v_mov_b32 v18, s48
s_mov_b32 s45, s48
s_add_u32 s48, s48, 1
s_waitcnt vmcnt(3)
v_cmp_gt_u32 vcc, s48, v24
s_nop 0
s_and_b32 vcc_lo, vcc_lo, 0xffffff
s_cbranch_scc1 red_late_223
v_mov_b32 v1, 147456
ds_read_b32 v2, v1
s_waitcnt lgkmcnt(0)
v_readfirstlane_b32 s47, v2
s_nop 0
s_add_u32 s47, s47, 32
s_cmp_gt_u32 s47, s45
s_cbranch_scc0 red_late_223
s_mul_i32 s47, s45, 36864
buffer_load_dwordx2 v[60:61], v9, s[8:11], s47 offen offset:0
buffer_load_dwordx2 v[62:63], v9, s[8:11], s47 offen offset:256
buffer_load_dwordx2 v[64:65], v9, s[8:11], s47 offen offset:512
buffer_load_dwordx2 v[66:67], v9, s[8:11], s47 offen offset:768
v_mov_b64 v[68:69], 0
s_mov_b64 exec, 0xffffffff
buffer_load_dwordx2 v[68:69], v9, s[8:11], s47 offen offset:1024
s_mov_b64 exec, -1
s_mul_i32 s47, s45, 294912
s_add_u32 s47, s47, s51
s_add_u32 s46, s47, 147456
buffer_load_dwordx4 v[96:99], v8, s[4:7], s47 offen offset:0 sc1
buffer_load_dwordx4 v[100:103], v8, s[4:7], s46 offen offset:0 sc1
buffer_load_dwordx4 v[104:107], v8, s[4:7], s47 offen offset:256 sc1
buffer_load_dwordx4 v[108:111], v8, s[4:7], s46 offen offset:256 sc1
buffer_load_dwordx4 v[112:115], v8, s[4:7], s47 offen offset:512 sc1
buffer_load_dwordx4 v[116:119], v8, s[4:7], s46 offen offset:512 sc1
buffer_load_dwordx4 v[120:123], v8, s[4:7], s47 offen offset:768 sc1
buffer_load_dwordx4 v[124:127], v8, s[4:7], s46 offen offset:768 sc1
buffer_load_dwordx4 v[128:131], v8, s[4:7], s47 offen offset:1024 sc1
buffer_load_dwordx4 v[132:135], v8, s[4:7], s46 offen offset:1024 sc1
buffer_load_dwordx4 v[136:139], v8, s[4:7], s47 offen offset:1280 sc1
buffer_load_dwordx4 v[140:143], v8, s[4:7], s46 offen offset:1280 sc1
buffer_load_dwordx4 v[144:147], v8, s[4:7], s47 offen offset:1536 sc1
buffer_load_dwordx4 v[148:151], v8, s[4:7], s46 offen offset:1536 sc1
buffer_load_dwordx4 v[152:155], v8, s[4:7], s47 offen offset:1792 sc1
buffer_load_dwordx4 v[156:159], v8, s[4:7], s46 offen offset:1792 sc1
buffer_load_dwordx4 v[160:163], v8, s[4:7], s47 offen offset:2048 sc1
buffer_load_dwordx4 v[164:167], v8, s[4:7], s46 offen offset:2048 sc1
s_waitcnt vmcnt(23) lgkmcnt(0)
buffer_store_dword v18, v36, s[4:7], s50 offen sc1
buffer_store_dword v18, v37, s[4:7], s50 offen
s_branch red_have_222
red_late_223:
s_waitcnt vmcnt(0) lgkmcnt(0)
buffer_store_dword v18, v36, s[4:7], s50 offen sc1
buffer_store_dword v18, v37, s[4:7], s50 offen
s_cmp_lt_u32 s45, 64
s_cbranch_scc1 red_loop_221
s_endpgm
red_mid_219:
red_loop_230:
s_add_u32 s48, s45, 1
s_mov_b32 s98, 0
sp_loop_233:
buffer_load_dword v24, v15, s[4:7], s49 offen sc1
s_add_u32 s98, s98, 1
s_cmp_gt_u32 s98, 150000
s_cbranch_scc1 sp_bad_235
s_waitcnt vmcnt(0)
v_cmp_gt_u32 vcc, s48, v24
s_nop 0
s_and_b32 vcc_lo, vcc_lo, 0xffffff
s_cbranch_scc0 sp_ok_234
s_sleep 2
s_branch sp_loop_233
sp_bad_235:
s_mov_b32 s98, 1281
s_branch L_fail
sp_ok_234:
s_mul_i32 s47, s45, 294912
s_add_u32 s47, s47, s51
s_add_u32 s46, s47, 147456
buffer_load_dwordx4 v[96:99], v8, s[4:7], s47 offen offset:0 sc1
buffer_load_dwordx4 v[100:103], v8, s[4:7], s46 offen offset:0 sc1
buffer_load_dwordx4 v[104:107], v8, s[4:7], s47 offen offset:256 sc1
buffer_load_dwordx4 v[108:111], v8, s[4:7], s46 offen offset:256 sc1
buffer_load_dwordx4 v[112:115], v8, s[4:7], s47 offen offset:512 sc1
buffer_load_dwordx4 v[116:119], v8, s[4:7], s46 offen offset:512 sc1
buffer_load_dwordx4 v[120:123], v8, s[4:7], s47 offen offset:768 sc1
buffer_load_dwordx4 v[124:127], v8, s[4:7], s46 offen offset:768 sc1
buffer_load_dwordx4 v[128:131], v8, s[4:7], s47 offen offset:1024 sc1
buffer_load_dwordx4 v[132:135], v8, s[4:7], s46 offen offset:1024 sc1
buffer_load_dwordx4 v[136:139], v8, s[4:7], s47 offen offset:1280 sc1
buffer_load_dwordx4 v[140:143], v8, s[4:7], s46 offen offset:1280 sc1
buffer_load_dwordx4 v[144:147], v8, s[4:7], s47 offen offset:1536 sc1
buffer_load_dwordx4 v[148:151], v8, s[4:7], s46 offen offset:1536 sc1
buffer_load_dwordx4 v[152:155], v8, s[4:7], s47 offen offset:1792 sc1
buffer_load_dwordx4 v[156:159], v8, s[4:7], s46 offen offset:1792 sc1
buffer_load_dwordx4 v[160:163], v8, s[4:7], s47 offen offset:2048 sc1
buffer_load_dwordx4 v[164:167], v8, s[4:7], s46 offen offset:2048 sc1
buffer_store_dword v18, v16, s[4:7], 0 offen
buffer_store_dword v18, v16, s[4:7], 0 offen
red_have_231:
buffer_load_dword v24, v15, s[4:7], s49 offen sc1
s_and_b32 s47, s45, 31
s_mul_i32 s47, s47, 4608
v_lshlrev_b32 v14, 4, v0
v_add_u32 v14, s47, v14
ds_read_b128 v[40:43], v14 offset:0
ds_read_b128 v[44:47], v14 offset:1024
ds_read_b128 v[48:51], v14 offset:2048
ds_read_b128 v[52:55], v14 offset:3072
v_mov_b64 v[56:57], 0
v_mov_b64 v[58:59], 0
s_mov_b64 exec, 0xffffffff
ds_read_b128 v[56:59], v14 offset:4096
s_mov_b64 exec, -1
s_waitcnt lgkmcnt(0)
s_waitcnt vmcnt(20)
v_mfma_f32_16x16x32_bf16 v[40:43], v[28:31], v[96:99], v[40:43]
s_waitcnt vmcnt(19)
v_mfma_f32_16x16x32_bf16 v[40:43], v[28:31], v[100:103], v[40:43]
s_waitcnt vmcnt(18)
v_mfma_f32_16x16x32_bf16 v[40:43], v[32:35], v[104:107], v[40:43]
s_waitcnt vmcnt(17)
v_mfma_f32_16x16x32_bf16 v[40:43], v[32:35], v[108:111], v[40:43]
s_waitcnt vmcnt(16)
v_mfma_f32_16x16x32_bf16 v[44:47], v[28:31], v[112:115], v[44:47]
s_waitcnt vmcnt(15)
v_mfma_f32_16x16x32_bf16 v[44:47], v[28:31], v[116:119], v[44:47]
s_nop 3
ds_write_b128 v14, v[40:43] offset:0
v_mul_f32 v20, v40, v40
v_add_f32 v19, v40, v41
v_fmac_f32 v20, v41, v41
v_add_f32 v19, v19, v42
v_fmac_f32 v20, v42, v42
v_add_f32 v19, v19, v43
v_fmac_f32 v20, v43, v43
s_waitcnt vmcnt(14)
v_mfma_f32_16x16x32_bf16 v[44:47], v[32:35], v[120:123], v[44:47]
s_waitcnt vmcnt(13)
v_mfma_f32_16x16x32_bf16 v[44:47], v[32:35], v[124:127], v[44:47]
s_waitcnt vmcnt(12)
v_mfma_f32_16x16x32_bf16 v[48:51], v[28:31], v[128:131], v[48:51]
s_waitcnt vmcnt(11)
v_mfma_f32_16x16x32_bf16 v[48:51], v[28:31], v[132:135], v[48:51]
s_nop 3
ds_write_b128 v14, v[44:47] offset:1024
v_add_f32 v19, v19, v44
v_fmac_f32 v20, v44, v44
v_add_f32 v19, v19, v45
v_fmac_f32 v20, v45, v45
v_add_f32 v19, v19, v46
v_fmac_f32 v20, v46, v46
v_add_f32 v19, v19, v47
v_fmac_f32 v20, v47, v47
s_waitcnt vmcnt(10)
v_mfma_f32_16x16x32_bf16 v[48:51], v[32:35], v[136:139], v[48:51]
s_waitcnt vmcnt(9)
v_mfma_f32_16x16x32_bf16 v[48:51], v[32:35], v[140:143], v[48:51]
s_waitcnt vmcnt(8)
v_mfma_f32_16x16x32_bf16 v[52:55], v[28:31], v[144:147], v[52:55]
s_waitcnt vmcnt(7)
v_mfma_f32_16x16x32_bf16 v[52:55], v[28:31], v[148:151], v[52:55]
s_nop 3
ds_write_b128 v14, v[48:51] offset:2048
v_add_f32 v19, v19, v48
v_fmac_f32 v20, v48, v48
v_add_f32 v19, v19, v49
v_fmac_f32 v20, v49, v49
v_add_f32 v19, v19, v50
v_fmac_f32 v20, v50, v50
v_add_f32 v19, v19, v51
v_fmac_f32 v20, v51, v51
s_waitcnt vmcnt(6)
v_mfma_f32_16x16x32_bf16 v[52:55], v[32:35], v[152:155], v[52:55]
s_waitcnt vmcnt(5)
v_mfma_f32_16x16x32_bf16 v[52:55], v[32:35], v[156:159], v[52:55]
s_waitcnt vmcnt(4)
v_mfma_f32_16x16x32_bf16 v[56:59], v[28:31], v[160:163], v[56:59]
s_waitcnt vmcnt(3)
v_mfma_f32_16x16x32_bf16 v[56:59], v[28:31], v[164:167], v[56:59]
s_nop 3
ds_write_b128 v14, v[52:55] offset:3072
v_add_f32 v19, v19, v52
v_fmac_f32 v20, v52, v52
v_add_f32 v19, v19, v53
v_fmac_f32 v20, v53, v53
v_add_f32 v19, v19, v54
v_fmac_f32 v20, v54, v54
v_add_f32 v19, v19, v55
v_fmac_f32 v20, v55, v55
s_mov_b64 exec, 0xffffffff
ds_write_b128 v14, v[56:59] offset:4096
s_mov_b64 exec, -1
v_add_f32 v19, v19, v56
v_fmac_f32 v20, v56, v56
v_add_f32 v19, v19, v57
v_fmac_f32 v20, v57, v57
v_add_f32 v19, v19, v58
v_fmac_f32 v20, v58, v58
v_add_f32 v19, v19, v59
v_fmac_f32 v20, v59, v59
s_mul_i32 s47, s45, 36864
s_add_u32 s47, s47, s52
v_permlane32_swap_b32 v19, v20
v_add_f32 v19, v19, v20
v_mov_b32 v21, v19
s_nop 1
v_permlane16_swap_b32 v19, v21
v_add_f32 v19, v19, v21
s_nop 1
v_add_f32_dpp v19, v19, v19 quad_perm:[2,3,0,1] row_mask:0xf bank_mask:0xf
s_nop 1
v_add_f32_dpp v19, v19, v19 row_ror:4 row_mask:0xf bank_mask:0xf
s_nop 1
v_add_f32_dpp v19, v19, v19 row_ror:8 row_mask:0xf bank_mask:0xf
v_mul_f32 v19, 0x3ae38e39, v19
v_mov_b32 v20, v19
s_nop 1
v_permlane32_swap_b32 v19, v20
v_fma_f32 v20, -v19, v19, v20
v_max_f32 v20, 0, v20
v_add_f32 v20, 0x3727c5ac, v20
v_rsq_f32 v20, v20
s_nop 0
v_mul_f32 v19, v19, v20
v_fma_f32 v40, v40, v20, -v19
v_fma_f32 v41, v41, v20, -v19
v_fma_f32 v42, v42, v20, -v19
v_fma_f32 v43, v43, v20, -v19
v_fma_f32 v44, v44, v20, -v19
v_fma_f32 v45, v45, v20, -v19
v_fma_f32 v46, v46, v20, -v19
v_fma_f32 v47, v47, v20, -v19
v_fma_f32 v48, v48, v20, -v19
v_fma_f32 v49, v49, v20, -v19
v_fma_f32 v50, v50, v20, -v19
v_fma_f32 v51, v51, v20, -v19
v_fma_f32 v52, v52, v20, -v19
v_fma_f32 v53, v53, v20, -v19
v_fma_f32 v54, v54, v20, -v19
v_fma_f32 v55, v55, v20, -v19
v_fma_f32 v56, v56, v20, -v19
v_fma_f32 v57, v57, v20, -v19
v_fma_f32 v58, v58, v20, -v19
v_fma_f32 v59, v59, v20, -v19
v_cvt_pk_bf16_f32 v72, v40, v41
v_cvt_pk_bf16_f32 v74, v44, v45
v_cvt_pk_bf16_f32 v73, v42, v43
v_cvt_pk_bf16_f32 v75, v46, v47
v_permlane16_swap_b32 v72, v74
s_nop 0
v_permlane16_swap_b32 v73, v75
buffer_store_dwordx4 v[72:75], v10, s[4:7], s47 offen offset:0 sc1
v_cvt_pk_bf16_f32 v76, v48, v49
v_cvt_pk_bf16_f32 v78, v52, v53
v_cvt_pk_bf16_f32 v77, v50, v51
v_cvt_pk_bf16_f32 v79, v54, v55
v_permlane16_swap_b32 v76, v78
s_nop 0
v_permlane16_swap_b32 v77, v79
buffer_store_dwordx4 v[76:79], v10, s[4:7], s47 offen offset:1024 sc1
v_cvt_pk_bf16_f32 v80, v56, v57
v_cvt_pk_bf16_f32 v81, v58, v59
s_mov_b64 exec, 0xffffffff
buffer_store_dwordx2 v[80:81], v11, s[4:7], s47 offen offset:2048 sc1
s_mov_b64 exec, -1
v_mov_b32 v18, s48
s_mov_b32 s45, s48
s_add_u32 s48, s48, 1
s_waitcnt vmcnt(3)
v_cmp_gt_u32 vcc, s48, v24
s_nop 0
s_and_b32 vcc_lo, vcc_lo, 0xffffff
s_cbranch_scc1 red_late_232
s_mul_i32 s47, s45, 294912
s_add_u32 s47, s47, s51
s_add_u32 s46, s47, 147456
buffer_load_dwordx4 v[96:99], v8, s[4:7], s47 offen offset:0 sc1
buffer_load_dwordx4 v[100:103], v8, s[4:7], s46 offen offset:0 sc1
buffer_load_dwordx4 v[104:107], v8, s[4:7], s47 offen offset:256 sc1
buffer_load_dwordx4 v[108:111], v8, s[4:7], s46 offen offset:256 sc1
buffer_load_dwordx4 v[112:115], v8, s[4:7], s47 offen offset:512 sc1
buffer_load_dwordx4 v[116:119], v8, s[4:7], s46 offen offset:512 sc1
buffer_load_dwordx4 v[120:123], v8, s[4:7], s47 offen offset:768 sc1
buffer_load_dwordx4 v[124:127], v8, s[4:7], s46 offen offset:768 sc1
buffer_load_dwordx4 v[128:131], v8, s[4:7], s47 offen offset:1024 sc1
buffer_load_dwordx4 v[132:135], v8, s[4:7], s46 offen offset:1024 sc1
buffer_load_dwordx4 v[136:139], v8, s[4:7], s47 offen offset:1280 sc1
buffer_load_dwordx4 v[140:143], v8, s[4:7], s46 offen offset:1280 sc1
buffer_load_dwordx4 v[144:147], v8, s[4:7], s47 offen offset:1536 sc1
buffer_load_dwordx4 v[148:151], v8, s[4:7], s46 offen offset:1536 sc1
buffer_load_dwordx4 v[152:155], v8, s[4:7], s47 offen offset:1792 sc1
buffer_load_dwordx4 v[156:159], v8, s[4:7], s46 offen offset:1792 sc1
buffer_load_dwordx4 v[160:163], v8, s[4:7], s47 offen offset:2048 sc1
buffer_load_dwordx4 v[164:167], v8, s[4:7], s46 offen offset:2048 sc1
s_waitcnt vmcnt(18) lgkmcnt(0)
buffer_store_dword v18, v36, s[4:7], s50 offen sc1
buffer_store_dword v18, v37, s[4:7], s50 offen
s_branch red_have_231
red_late_232:
s_waitcnt vmcnt(0) lgkmcnt(0)
buffer_store_dword v18, v36, s[4:7], s50 offen sc1
buffer_store_dword v18, v37, s[4:7], s50 offen
s_cmp_lt_u32 s45, 64
s_cbranch_scc1 red_loop_230
s_endpgm
red_fin_220:
red_loop_236:
s_add_u32 s48, s45, 1
s_mov_b32 s98, 0
sp_loop_239:
buffer_load_dword v24, v15, s[4:7], s49 offen sc1
s_add_u32 s98, s98, 1
s_cmp_gt_u32 s98, 150000
s_cbranch_scc1 sp_bad_241
s_waitcnt vmcnt(0)
v_cmp_gt_u32 vcc, s48, v24
s_nop 0
s_and_b32 vcc_lo, vcc_lo, 0xffffff
s_cbranch_scc0 sp_ok_240
s_sleep 2
s_branch sp_loop_239
sp_bad_241:
s_mov_b32 s98, 1281
s_branch L_fail
sp_ok_240:
s_mul_i32 s47, s45, 294912
s_add_u32 s47, s47, s51
s_add_u32 s46, s47, 147456
buffer_load_dwordx4 v[96:99], v8, s[4:7], s47 offen offset:0 sc1
buffer_load_dwordx4 v[100:103], v8, s[4:7], s46 offen offset:0 sc1
buffer_load_dwordx4 v[104:107], v8, s[4:7], s47 offen offset:256 sc1
buffer_load_dwordx4 v[108:111], v8, s[4:7], s46 offen offset:256 sc1
buffer_load_dwordx4 v[112:115], v8, s[4:7], s47 offen offset:512 sc1
buffer_load_dwordx4 v[116:119], v8, s[4:7], s46 offen offset:512 sc1
buffer_load_dwordx4 v[120:123], v8, s[4:7], s47 offen offset:768 sc1
buffer_load_dwordx4 v[124:127], v8, s[4:7], s46 offen offset:768 sc1
buffer_load_dwordx4 v[128:131], v8, s[4:7], s47 offen offset:1024 sc1
buffer_load_dwordx4 v[132:135], v8, s[4:7], s46 offen offset:1024 sc1
buffer_load_dwordx4 v[136:139], v8, s[4:7], s47 offen offset:1280 sc1
buffer_load_dwordx4 v[140:143], v8, s[4:7], s46 offen offset:1280 sc1
buffer_load_dwordx4 v[144:147], v8, s[4:7], s47 offen offset:1536 sc1
buffer_load_dwordx4 v[148:151], v8, s[4:7], s46 offen offset:1536 sc1
buffer_load_dwordx4 v[152:155], v8, s[4:7], s47 offen offset:1792 sc1
buffer_load_dwordx4 v[156:159], v8, s[4:7], s46 offen offset:1792 sc1
buffer_load_dwordx4 v[160:163], v8, s[4:7], s47 offen offset:2048 sc1
buffer_load_dwordx4 v[164:167], v8, s[4:7], s46 offen offset:2048 sc1
red_have_237:
buffer_load_dword v24, v15, s[4:7], s49 offen sc1
s_and_b32 s47, s45, 31
s_mul_i32 s47, s47, 4608
v_lshlrev_b32 v14, 4, v0
v_add_u32 v14, s47, v14
ds_read_b128 v[40:43], v14 offset:0
ds_read_b128 v[44:47], v14 offset:1024
ds_read_b128 v[48:51], v14 offset:2048
ds_read_b128 v[52:55], v14 offset:3072
v_mov_b64 v[56:57], 0
v_mov_b64 v[58:59], 0
s_mov_b64 exec, 0xffffffff
ds_read_b128 v[56:59], v14 offset:4096
s_mov_b64 exec, -1
s_waitcnt lgkmcnt(0)
v_mov_b32 v1, 147456
v_mov_b32 v2, s48
ds_write_b32 v1, v2
s_waitcnt vmcnt(18)
v_mfma_f32_16x16x32_bf16 v[40:43], v[28:31], v[96:99], v[40:43]
s_waitcnt vmcnt(17)
v_mfma_f32_16x16x32_bf16 v[40:43], v[28:31], v[100:103], v[40:43]
s_waitcnt vmcnt(16)
v_mfma_f32_16x16x32_bf16 v[40:43], v[32:35], v[104:107], v[40:43]
s_waitcnt vmcnt(15)
v_mfma_f32_16x16x32_bf16 v[40:43], v[32:35], v[108:111], v[40:43]
s_waitcnt vmcnt(14)
v_mfma_f32_16x16x32_bf16 v[44:47], v[28:31], v[112:115], v[44:47]
s_waitcnt vmcnt(13)
v_mfma_f32_16x16x32_bf16 v[44:47], v[28:31], v[116:119], v[44:47]
s_waitcnt vmcnt(12)
v_mfma_f32_16x16x32_bf16 v[44:47], v[32:35], v[120:123], v[44:47]
s_waitcnt vmcnt(11)
v_mfma_f32_16x16x32_bf16 v[44:47], v[32:35], v[124:127], v[44:47]
s_waitcnt vmcnt(10)
v_mfma_f32_16x16x32_bf16 v[48:51], v[28:31], v[128:131], v[48:51]
s_waitcnt vmcnt(9)
v_mfma_f32_16x16x32_bf16 v[48:51], v[28:31], v[132:135], v[48:51]
s_waitcnt vmcnt(8)
v_mfma_f32_16x16x32_bf16 v[48:51], v[32:35], v[136:139], v[48:51]
s_waitcnt vmcnt(7)
v_mfma_f32_16x16x32_bf16 v[48:51], v[32:35], v[140:143], v[48:51]
s_waitcnt vmcnt(6)
v_mfma_f32_16x16x32_bf16 v[52:55], v[28:31], v[144:147], v[52:55]
s_waitcnt vmcnt(5)
v_mfma_f32_16x16x32_bf16 v[52:55], v[28:31], v[148:151], v[52:55]
s_waitcnt vmcnt(4)
v_mfma_f32_16x16x32_bf16 v[52:55], v[32:35], v[152:155], v[52:55]
s_waitcnt vmcnt(3)
v_mfma_f32_16x16x32_bf16 v[52:55], v[32:35], v[156:159], v[52:55]
s_waitcnt vmcnt(2)
v_mfma_f32_16x16x32_bf16 v[56:59], v[28:31], v[160:163], v[56:59]
s_waitcnt vmcnt(1)
v_mfma_f32_16x16x32_bf16 v[56:59], v[28:31], v[164:167], v[56:59]
s_mul_i32 s47, s45, 36864
v_cvt_pk_bf16_f32 v72, v40, v41
v_cvt_pk_bf16_f32 v74, v44, v45
v_cvt_pk_bf16_f32 v73, v42, v43
v_cvt_pk_bf16_f32 v75, v46, v47
v_permlane16_swap_b32 v72, v74
s_nop 0
v_permlane16_swap_b32 v73, v75
buffer_store_dwordx4 v[72:75], v12, s[16:19], s47 offen offset:0
v_cvt_pk_bf16_f32 v76, v48, v49
v_cvt_pk_bf16_f32 v78, v52, v53
v_cvt_pk_bf16_f32 v77, v50, v51
v_cvt_pk_bf16_f32 v79, v54, v55
v_permlane16_swap_b32 v76, v78
s_nop 0
v_permlane16_swap_b32 v77, v79
buffer_store_dwordx4 v[76:79], v12, s[16:19], s47 offen offset:512
v_cvt_pk_bf16_f32 v80, v56, v57
v_cvt_pk_bf16_f32 v81, v58, v59
s_mov_b64 exec, 0xffffffff
buffer_store_dwordx2 v[80:81], v13, s[16:19], s47 offen offset:1024
s_mov_b64 exec, -1
v_mov_b32 v18, s48
s_mov_b32 s45, s48
s_add_u32 s48, s48, 1
s_waitcnt vmcnt(3)
v_cmp_gt_u32 vcc, s48, v24
s_nop 0
s_and_b32 vcc_lo, vcc_lo, 0xffffff
s_cbranch_scc1 red_late_238
s_mul_i32 s47, s45, 294912
s_add_u32 s47, s47, s51
s_add_u32 s46, s47, 147456
buffer_load_dwordx4 v[96:99], v8, s[4:7], s47 offen offset:0 sc1
buffer_load_dwordx4 v[100:103], v8, s[4:7], s46 offen offset:0 sc1
buffer_load_dwordx4 v[104:107], v8, s[4:7], s47 offen offset:256 sc1
buffer_load_dwordx4 v[108:111], v8, s[4:7], s46 offen offset:256 sc1
buffer_load_dwordx4 v[112:115], v8, s[4:7], s47 offen offset:512 sc1
buffer_load_dwordx4 v[116:119], v8, s[4:7], s46 offen offset:512 sc1
buffer_load_dwordx4 v[120:123], v8, s[4:7], s47 offen offset:768 sc1
buffer_load_dwordx4 v[124:127], v8, s[4:7], s46 offen offset:768 sc1
buffer_load_dwordx4 v[128:131], v8, s[4:7], s47 offen offset:1024 sc1
buffer_load_dwordx4 v[132:135], v8, s[4:7], s46 offen offset:1024 sc1
buffer_load_dwordx4 v[136:139], v8, s[4:7], s47 offen offset:1280 sc1
buffer_load_dwordx4 v[140:143], v8, s[4:7], s46 offen offset:1280 sc1
buffer_load_dwordx4 v[144:147], v8, s[4:7], s47 offen offset:1536 sc1
buffer_load_dwordx4 v[148:151], v8, s[4:7], s46 offen offset:1536 sc1
buffer_load_dwordx4 v[152:155], v8, s[4:7], s47 offen offset:1792 sc1
buffer_load_dwordx4 v[156:159], v8, s[4:7], s46 offen offset:1792 sc1
buffer_load_dwordx4 v[160:163], v8, s[4:7], s47 offen offset:2048 sc1
buffer_load_dwordx4 v[164:167], v8, s[4:7], s46 offen offset:2048 sc1
s_branch red_have_237
red_late_238:
s_cmp_lt_u32 s45, 64
s_cbranch_scc1 red_loop_236
s_endpgm
L_fail:
s_mov_b64 exec, -1
v_mov_b32 v2, s98
v_mov_b32 v3, 252
s_mov_b32 s12, s40
s_and_b32 s13, s41, 0xffff
s_mov_b32 s14, 256
s_mov_b32 s15, 0x20000
buffer_store_dword v2, v3, s[12:15], 0 offen
s_waitcnt vmcnt(0)
s_endpgm
L_chain:
s_mul_i32 s53, s50, 50331648
s_add_u32 s53, s53, 10821632
s_mul_i32 s54, s50, 8388608
s_add_u32 s54, s54, 111484928
s_mul_i32 s55, s50, 589824
s_add_u32 s55, s55, 131072
s_mul_i32 s56, s50, 36864
s_add_u32 s56, s56, 1310720
s_mul_i32 s57, s50, 4
s_add_u32 s57, s57, 48
s_mul_i32 s58, s50, 32768
s_add_u32 s58, s58, 0
v_lshlrev_b32 v1, 4, v0
v_lshlrev_b32 v15, 3, v0
v_add_u32 v2, 139264, v15
v_and_b32 v24, 1, v0
v_mov_b32 v25, 0x88888888
v_mov_b32 v26, 0xdddddddd
v_cmp_eq_u32 vcc, 1, v24
s_nop 1
v_cndmask_b32 v3, v25, v26, vcc
v_lshrrev_b32 v24, 5, v0
v_bfe_u32 v25, v0, 4, 1
v_and_b32 v26, 15, v0
v_lshrrev_b32 v27, 4, v0
s_lshl_b32 s60, s3, 5
v_bfe_u32 v28, v0, 2, 1
v_lshlrev_b32 v28, 3, v28
v_bfe_u32 v29, v0, 3, 1
v_lshl_add_u32 v28, v29, 2, v28
v_and_b32 v29, 3, v0
v_add3_u32 v28, v28, v29, s60
v_lshlrev_b32 v28, 5, v28
v_lshl_add_u32 v28, v27, 3, v28
v_add_u32 v4, 148480, v28
v_bfe_u32 v28, v0, 1, 3
v_lshlrev_b32 v28, 5, v28
v_and_b32 v29, 1, v0
v_lshl_add_u32 v28, v29, 9, v28
v_lshl_add_u32 v28, v27, 3, v28
s_mul_i32 s60, s3, 2304
s_add_u32 s60, s60, 139264
v_add_u32 v11, s60, v28
s_add_u32 s68, s60, 2048
s_lshl_b32 s78, s3, 9
s_sub_u32 s78, s78, 137216
v_lshrrev_b32 v28, 3, v0
v_lshlrev_b32 v28, 12, v28
v_and_b32 v29, 7, v0
v_lshl_add_u32 v9, v29, 4, v28
v_lshlrev_b32 v28, 9, v24
v_lshl_add_u32 v28, v25, 7, v28
v_lshl_add_u32 v28, v26, 3, v28
v_add_u32 v5, 148480, v28
v_bfe_u32 v28, v0, 2, 2
v_lshlrev_b32 v28, 1, v28
v_and_b32 v30, 1, v0
v_add_u32 v30, v28, v30
v_lshlrev_b32 v28, 8, v24
v_lshl_add_u32 v28, v25, 7, v28
v_lshl_add_u32 v12, v30, 4, v28
v_mov_b32 v31, v30
v_min_u32 v28, 3, v0
v_lshrrev_b32 v29, 1, v28
v_lshlrev_b32 v29, 8, v29
v_and_b32 v28, 1, v28
v_mul_u32_u24 v28, 7, v28
s_lshl_b32 s60, s51, 3
s_add_u32 s60, s60, 256
v_add3_u32 v28, v28, v29, s60
v_mul_u32_u24 v28, 43691, v28
v_lshrrev_b32 v28, 19, v28
v_mul_u32_u24 v28, 128, v28
v_add_u32 v28, 2048, v28
v_mov_b32 v29, 2147483632
s_cmp_eq_u32 s3, 3
s_cselect_b32 s61, 4, 0
v_cmp_gt_u32 vcc, s61, v0
s_nop 1
v_cndmask_b32 v7, v29, v28, vcc
s_mul_i32 s60, s51, 128
s_add_u32 s60, s60, 10240
v_mov_b32 v28, s60
v_mov_b32 v29, 2147483632
s_lshr_b32 s61, s61, 2
v_cmp_gt_u32 vcc, s61, v0
s_nop 1
v_cndmask_b32 v8, v29, v28, vcc
s_lshr_b32 s60, s3, 1
s_lshl_b32 s60, s60, 10
s_and_b32 s61, s3, 1
s_lshl_b32 s61, s61, 9
s_add_u32 s60, s60, s61
s_add_u32 s60, s60, 152576
v_lshrrev_b32 v28, 4, v0
v_lshlrev_b32 v28, 2, v28
v_lshl_add_u32 v28, v31, 5, v28
v_add_u32 v6, s60, v28
v_lshlrev_b32 v29, 6, v25
v_lshl_add_u32 v29, v24, 5, v29
v_lshl_add_u32 v10, v26, 2, v29
s_mov_b32 s66, 0x3e0293ee
s_mov_b32 s70, 0xfffffffe
s_mov_b32 s98, 0xff800000
s_mov_b32 s99, 0xff800000
s_mul_i32 s60, s3, 65536
s_lshl_b32 s61, s51, 7
s_add_u32 s74, s60, s61
s_add_u32 s74, s74, s55
s_lshl_b32 s69, s51, 1
s_add_u32 s69, s69, s3
s_add_u32 s60, s51, 64
s_cmp_lt_u32 s3, 2
s_cselect_b32 s69, s69, s60
s_cselect_b32 s48, 1, 0
s_cmp_eq_u32 s3, 2
s_cselect_b32 s60, 1, 0
s_cmp_lt_u32 s51, 8
s_cselect_b32 s60, s60, 0
s_or_b32 s48, s48, s60
s_lshl_b32 s60, s3, 13
s_lshl_b32 s49, s51, 7
s_add_u32 s49, s49, s60
s_add_u32 s49, s49, s55
s_add_u32 s49, s49, 262144
s_lshl_b32 s75, s69, 12
s_add_u32 s75, s75, s55
s_lshl_b32 s76, s69, 7
s_add_u32 s79, s56, 9216
s_add_u32 s71, s56, 18432
s_mov_b32 s73, s56
s_mov_b32 s72, 0x00ff00ff
s_cmp_eq_u32 s48, 0
s_cbranch_scc1 z2_244
v_mov_b64 v[24:25], 0
v_mov_b64 v[26:27], 0
buffer_store_dwordx4 v[24:27], v1, s[4:7], s75 offen offset:0 sc1
buffer_store_dwordx4 v[24:27], v1, s[4:7], s75 offen offset:1024 sc1
buffer_store_dwordx4 v[24:27], v1, s[4:7], s75 offen offset:2048 sc1
buffer_store_dwordx4 v[24:27], v1, s[4:7], s75 offen offset:3072 sc1
v_mov_b32 v28, -1
s_mov_b32 exec_lo, s72
s_mov_b32 exec_hi, s72
s_add_u32 s60, s76, s56
s_add_u32 s60, s60, 0
buffer_store_dword v28, v10, s[4:7], s60 offen sc1
s_add_u32 s60, s76, s56
s_add_u32 s60, s60, 9216
buffer_store_dword v28, v10, s[4:7], s60 offen sc1
s_add_u32 s60, s76, s56
s_add_u32 s60, s60, 18432
buffer_store_dword v28, v10, s[4:7], s60 offen sc1
s_mov_b64 exec, -1
z2_244:
s_mov_b32 s8, s22
s_and_b32 s9, s23, 0xffff
s_mov_b32 s10, 9216
s_mov_b32 s11, 0x20000
s_lshl_b32 s60, s3, 6
v_add_u32 v24, s60, v0
v_lshrrev_b32 v26, 3, v24
v_lshlrev_b32 v26, 2, v26
v_and_b32 v27, 7, v24
v_mul_u32_u24 v27, 1152, v27
v_add_u32 v26, v26, v27
buffer_load_dword v16, v26, s[8:11], 0 offen offset:0
buffer_load_dword v17, v26, s[8:11], 0 offen offset:128
buffer_load_dword v18, v26, s[8:11], 0 offen offset:256
buffer_load_dword v19, v26, s[8:11], 0 offen offset:384
buffer_load_dword v20, v26, s[8:11], 0 offen offset:512
buffer_load_dword v21, v26, s[8:11], 0 offen offset:640
buffer_load_dword v22, v26, s[8:11], 0 offen offset:768
buffer_load_dword v23, v26, s[8:11], 0 offen offset:896
buffer_load_dword v14, v26, s[8:11], 0 offen offset:1024
v_lshrrev_b32 v28, 4, v0
v_lshlrev_b32 v29, 1, v28
v_and_b32 v30, 15, v0
v_xor_b32 v30, v30, v29
v_lshlrev_b32 v30, 4, v30
v_lshlrev_b32 v28, 13, v28
v_add_u32 v30, v28, v30
v_xor_b32 v31, 128, v30
s_mov_b32 s8, s24
s_and_b32 s9, s25, 0xffff
s_mov_b32 s10, 4718592
s_mov_b32 s11, 0x20000
s_lshl_b32 s61, s51, 8
s_mul_i32 s60, s3, 393216
s_add_u32 s61, s61, s60
s_add_u32 s61, s61, 0
s_mul_i32 s60, s3, 12288
s_add_u32 m0, s60, 0
s_mul_i32 s62, s3, 48
s_bitcmp1_b32 s62, 5
s_cbranch_scc1 sq_245
buffer_load_dwordx4 v30, s[8:11], s61 offen lds
s_branch sq_246
sq_245:
buffer_load_dwordx4 v31, s[8:11], s61 offen lds
sq_246:
s_add_u32 s62, s62, 4
s_add_u32 s61, s61, 32768
s_add_u32 m0, m0, 1024
s_bitcmp1_b32 s62, 5
s_cbranch_scc1 sq_247
buffer_load_dwordx4 v30, s[8:11], s61 offen lds
s_branch sq_248
sq_247:
buffer_load_dwordx4 v31, s[8:11], s61 offen lds
sq_248:
s_add_u32 s62, s62, 4
s_add_u32 s61, s61, 32768
s_add_u32 m0, m0, 1024
s_bitcmp1_b32 s62, 5
s_cbranch_scc1 sq_249
buffer_load_dwordx4 v30, s[8:11], s61 offen lds
s_branch sq_250
sq_249:
buffer_load_dwordx4 v31, s[8:11], s61 offen lds
sq_250:
s_add_u32 s62, s62, 4
s_add_u32 s61, s61, 32768
s_add_u32 m0, m0, 1024
s_bitcmp1_b32 s62, 5
s_cbranch_scc1 sq_251
buffer_load_dwordx4 v30, s[8:11], s61 offen lds
s_branch sq_252
sq_251:
buffer_load_dwordx4 v31, s[8:11], s61 offen lds
sq_252:
s_add_u32 s62, s62, 4
s_add_u32 s61, s61, 32768
s_add_u32 m0, m0, 1024
s_bitcmp1_b32 s62, 5
s_cbranch_scc1 sq_253
buffer_load_dwordx4 v30, s[8:11], s61 offen lds
s_branch sq_254
sq_253:
buffer_load_dwordx4 v31, s[8:11], s61 offen lds
sq_254:
s_add_u32 s62, s62, 4
s_add_u32 s61, s61, 32768
s_add_u32 m0, m0, 1024
s_bitcmp1_b32 s62, 5
s_cbranch_scc1 sq_255
buffer_load_dwordx4 v30, s[8:11], s61 offen lds
s_branch sq_256
sq_255:
buffer_load_dwordx4 v31, s[8:11], s61 offen lds
sq_256:
s_add_u32 s62, s62, 4
s_add_u32 s61, s61, 32768
s_add_u32 m0, m0, 1024
s_bitcmp1_b32 s62, 5
s_cbranch_scc1 sq_257
buffer_load_dwordx4 v30, s[8:11], s61 offen lds
s_branch sq_258
sq_257:
buffer_load_dwordx4 v31, s[8:11], s61 offen lds
sq_258:
s_add_u32 s62, s62, 4
s_add_u32 s61, s61, 32768
s_add_u32 m0, m0, 1024
s_bitcmp1_b32 s62, 5
s_cbranch_scc1 sq_259
buffer_load_dwordx4 v30, s[8:11], s61 offen lds
s_branch sq_260
sq_259:
buffer_load_dwordx4 v31, s[8:11], s61 offen lds
sq_260:
s_add_u32 s62, s62, 4
s_add_u32 s61, s61, 32768
s_add_u32 m0, m0, 1024
s_bitcmp1_b32 s62, 5
s_cbranch_scc1 sq_261
buffer_load_dwordx4 v30, s[8:11], s61 offen lds
s_branch sq_262
sq_261:
buffer_load_dwordx4 v31, s[8:11], s61 offen lds
sq_262:
s_add_u32 s62, s62, 4
s_add_u32 s61, s61, 32768
s_add_u32 m0, m0, 1024
s_bitcmp1_b32 s62, 5
s_cbranch_scc1 sq_263
buffer_load_dwordx4 v30, s[8:11], s61 offen lds
s_branch sq_264
sq_263:
buffer_load_dwordx4 v31, s[8:11], s61 offen lds
sq_264:
s_add_u32 s62, s62, 4
s_add_u32 s61, s61, 32768
s_add_u32 m0, m0, 1024
s_bitcmp1_b32 s62, 5
s_cbranch_scc1 sq_265
buffer_load_dwordx4 v30, s[8:11], s61 offen lds
s_branch sq_266
sq_265:
buffer_load_dwordx4 v31, s[8:11], s61 offen lds
sq_266:
s_add_u32 s62, s62, 4
s_add_u32 s61, s61, 32768
s_add_u32 m0, m0, 1024
s_bitcmp1_b32 s62, 5
s_cbranch_scc1 sq_267
buffer_load_dwordx4 v30, s[8:11], s61 offen lds
s_branch sq_268
sq_267:
buffer_load_dwordx4 v31, s[8:11], s61 offen lds
sq_268:
s_add_u32 s62, s62, 4
s_add_u32 s61, s61, 32768
s_add_u32 m0, m0, 1024
s_mov_b32 s8, s24
s_and_b32 s9, s25, 0xffff
s_mov_b32 s10, 4718592
s_mov_b32 s11, 0x20000
s_lshl_b32 s61, s51, 8
s_mul_i32 s60, s3, 393216
s_add_u32 s61, s61, s60
s_add_u32 s61, s61, 1572864
s_mul_i32 s60, s3, 12288
s_add_u32 m0, s60, 49152
s_mul_i32 s62, s3, 48
s_bitcmp1_b32 s62, 5
s_cbranch_scc1 sq_269
buffer_load_dwordx4 v30, s[8:11], s61 offen lds
s_branch sq_270
sq_269:
buffer_load_dwordx4 v31, s[8:11], s61 offen lds
sq_270:
s_add_u32 s62, s62, 4
s_add_u32 s61, s61, 32768
s_add_u32 m0, m0, 1024
s_bitcmp1_b32 s62, 5
s_cbranch_scc1 sq_271
buffer_load_dwordx4 v30, s[8:11], s61 offen lds
s_branch sq_272
sq_271:
buffer_load_dwordx4 v31, s[8:11], s61 offen lds
sq_272:
s_add_u32 s62, s62, 4
s_add_u32 s61, s61, 32768
s_add_u32 m0, m0, 1024
s_bitcmp1_b32 s62, 5
s_cbranch_scc1 sq_273
buffer_load_dwordx4 v30, s[8:11], s61 offen lds
s_branch sq_274
sq_273:
buffer_load_dwordx4 v31, s[8:11], s61 offen lds
sq_274:
s_add_u32 s62, s62, 4
s_add_u32 s61, s61, 32768
s_add_u32 m0, m0, 1024
s_bitcmp1_b32 s62, 5
s_cbranch_scc1 sq_275
buffer_load_dwordx4 v30, s[8:11], s61 offen lds
s_branch sq_276
sq_275:
buffer_load_dwordx4 v31, s[8:11], s61 offen lds
sq_276:
s_add_u32 s62, s62, 4
s_add_u32 s61, s61, 32768
s_add_u32 m0, m0, 1024
s_bitcmp1_b32 s62, 5
s_cbranch_scc1 sq_277
buffer_load_dwordx4 v30, s[8:11], s61 offen lds
s_branch sq_278
sq_277:
buffer_load_dwordx4 v31, s[8:11], s61 offen lds
sq_278:
s_add_u32 s62, s62, 4
s_add_u32 s61, s61, 32768
s_add_u32 m0, m0, 1024
s_bitcmp1_b32 s62, 5
s_cbranch_scc1 sq_279
buffer_load_dwordx4 v30, s[8:11], s61 offen lds
s_branch sq_280
sq_279:
buffer_load_dwordx4 v31, s[8:11], s61 offen lds
sq_280:
s_add_u32 s62, s62, 4
s_add_u32 s61, s61, 32768
s_add_u32 m0, m0, 1024
s_bitcmp1_b32 s62, 5
s_cbranch_scc1 sq_281
buffer_load_dwordx4 v30, s[8:11], s61 offen lds
s_branch sq_282
sq_281:
buffer_load_dwordx4 v31, s[8:11], s61 offen lds
sq_282:
s_add_u32 s62, s62, 4
s_add_u32 s61, s61, 32768
s_add_u32 m0, m0, 1024
s_bitcmp1_b32 s62, 5
s_cbranch_scc1 sq_283
buffer_load_dwordx4 v30, s[8:11], s61 offen lds
s_branch sq_284
sq_283:
buffer_load_dwordx4 v31, s[8:11], s61 offen lds
sq_284:
s_add_u32 s62, s62, 4
s_add_u32 s61, s61, 32768
s_add_u32 m0, m0, 1024
s_bitcmp1_b32 s62, 5
s_cbranch_scc1 sq_285
buffer_load_dwordx4 v30, s[8:11], s61 offen lds
s_branch sq_286
sq_285:
buffer_load_dwordx4 v31, s[8:11], s61 offen lds
sq_286:
s_add_u32 s62, s62, 4
s_add_u32 s61, s61, 32768
s_add_u32 m0, m0, 1024
s_bitcmp1_b32 s62, 5
s_cbranch_scc1 sq_287
buffer_load_dwordx4 v30, s[8:11], s61 offen lds
s_branch sq_288
sq_287:
buffer_load_dwordx4 v31, s[8:11], s61 offen lds
sq_288:
s_add_u32 s62, s62, 4
s_add_u32 s61, s61, 32768
s_add_u32 m0, m0, 1024
s_bitcmp1_b32 s62, 5
s_cbranch_scc1 sq_289
buffer_load_dwordx4 v30, s[8:11], s61 offen lds
s_branch sq_290
sq_289:
buffer_load_dwordx4 v31, s[8:11], s61 offen lds
sq_290:
s_add_u32 s62, s62, 4
s_add_u32 s61, s61, 32768
s_add_u32 m0, m0, 1024
s_bitcmp1_b32 s62, 5
s_cbranch_scc1 sq_291
buffer_load_dwordx4 v30, s[8:11], s61 offen lds
s_branch sq_292
sq_291:
buffer_load_dwordx4 v31, s[8:11], s61 offen lds
sq_292:
s_add_u32 s62, s62, 4
s_add_u32 s61, s61, 32768
s_add_u32 m0, m0, 1024
s_mov_b32 s8, s24
s_and_b32 s9, s25, 0xffff
s_mov_b32 s10, 4718592
s_mov_b32 s11, 0x20000
s_lshl_b32 s61, s51, 8
s_mul_i32 s60, s3, 393216
s_add_u32 s61, s61, s60
s_add_u32 s61, s61, 3145728
s_mul_i32 s60, s3, 12288
s_add_u32 m0, s60, 98304
s_mul_i32 s62, s3, 48
s_bitcmp1_b32 s62, 5
s_cbranch_scc1 sq_293
buffer_load_dwordx4 v30, s[8:11], s61 offen lds
s_branch sq_294
sq_293:
buffer_load_dwordx4 v31, s[8:11], s61 offen lds
sq_294:
s_add_u32 s62, s62, 4
s_add_u32 s61, s61, 32768
s_add_u32 m0, m0, 1024
s_bitcmp1_b32 s62, 5
s_cbranch_scc1 sq_295
buffer_load_dwordx4 v30, s[8:11], s61 offen lds
s_branch sq_296
sq_295:
buffer_load_dwordx4 v31, s[8:11], s61 offen lds
sq_296:
s_add_u32 s62, s62, 4
s_add_u32 s61, s61, 32768
s_add_u32 m0, m0, 1024
s_bitcmp1_b32 s62, 5
s_cbranch_scc1 sq_297
buffer_load_dwordx4 v30, s[8:11], s61 offen lds
s_branch sq_298
sq_297:
buffer_load_dwordx4 v31, s[8:11], s61 offen lds
sq_298:
s_add_u32 s62, s62, 4
s_add_u32 s61, s61, 32768
s_add_u32 m0, m0, 1024
s_bitcmp1_b32 s62, 5
s_cbranch_scc1 sq_299
buffer_load_dwordx4 v30, s[8:11], s61 offen lds
s_branch sq_300
sq_299:
buffer_load_dwordx4 v31, s[8:11], s61 offen lds
sq_300:
s_add_u32 s62, s62, 4
s_add_u32 s61, s61, 32768
s_add_u32 m0, m0, 1024
s_bitcmp1_b32 s62, 5
s_cbranch_scc1 sq_301
buffer_load_dwordx4 v30, s[8:11], s61 offen lds
s_branch sq_302
sq_301:
buffer_load_dwordx4 v31, s[8:11], s61 offen lds
sq_302:
s_add_u32 s62, s62, 4
s_add_u32 s61, s61, 32768
s_add_u32 m0, m0, 1024
s_bitcmp1_b32 s62, 5
s_cbranch_scc1 sq_303
buffer_load_dwordx4 v30, s[8:11], s61 offen lds
s_branch sq_304
sq_303:
buffer_load_dwordx4 v31, s[8:11], s61 offen lds
sq_304:
s_add_u32 s62, s62, 4
s_add_u32 s61, s61, 32768
s_add_u32 m0, m0, 1024
s_bitcmp1_b32 s62, 5
s_cbranch_scc1 sq_305
buffer_load_dwordx4 v30, s[8:11], s61 offen lds
s_branch sq_306
sq_305:
buffer_load_dwordx4 v31, s[8:11], s61 offen lds
sq_306:
s_add_u32 s62, s62, 4
s_add_u32 s61, s61, 32768
s_add_u32 m0, m0, 1024
s_bitcmp1_b32 s62, 5
s_cbranch_scc1 sq_307
buffer_load_dwordx4 v30, s[8:11], s61 offen lds
s_branch sq_308
sq_307:
buffer_load_dwordx4 v31, s[8:11], s61 offen lds
sq_308:
s_add_u32 s62, s62, 4
s_add_u32 s61, s61, 32768
s_add_u32 m0, m0, 1024
s_bitcmp1_b32 s62, 5
s_cbranch_scc1 sq_309
buffer_load_dwordx4 v30, s[8:11], s61 offen lds
s_branch sq_310
sq_309:
buffer_load_dwordx4 v31, s[8:11], s61 offen lds
sq_310:
s_add_u32 s62, s62, 4
s_add_u32 s61, s61, 32768
s_add_u32 m0, m0, 1024
s_bitcmp1_b32 s62, 5
s_cbranch_scc1 sq_311
buffer_load_dwordx4 v30, s[8:11], s61 offen lds
s_branch sq_312
sq_311:
buffer_load_dwordx4 v31, s[8:11], s61 offen lds
sq_312:
s_add_u32 s62, s62, 4
s_add_u32 s61, s61, 32768
s_add_u32 m0, m0, 1024
s_bitcmp1_b32 s62, 5
s_cbranch_scc1 sq_313
buffer_load_dwordx4 v30, s[8:11], s61 offen lds
s_branch sq_314
sq_313:
buffer_load_dwordx4 v31, s[8:11], s61 offen lds
sq_314:
s_add_u32 s62, s62, 4
s_add_u32 s61, s61, 32768
s_add_u32 m0, m0, 1024
s_bitcmp1_b32 s62, 5
s_cbranch_scc1 sq_315
buffer_load_dwordx4 v30, s[8:11], s61 offen lds
s_branch sq_316
sq_315:
buffer_load_dwordx4 v31, s[8:11], s61 offen lds
sq_316:
s_add_u32 s62, s62, 4
s_add_u32 s61, s61, 32768
s_add_u32 m0, m0, 1024
s_waitcnt vmcnt(24)
s_barrier
s_cmp_lg_u32 s3, 0
s_cbranch_scc1 cb_317
v_mov_b32 v24, s52
v_mov_b32 v25, s57
s_mov_b64 exec, 1
buffer_atomic_add v24, v25, s[12:15], 0 offen
s_mov_b64 exec, -1
cb_317:
v_bfe_u32 v24, v0, 4, 1
v_lshrrev_b32 v25, 5, v0
v_bfe_u32 v26, v0, 2, 2
v_lshlrev_b32 v27, 5, v24
v_lshl_add_u32 v27, v25, 3, v27
v_add_u32 v27, v27, v26
v_lshlrev_b32 v27, 8, v27
v_lshl_add_u32 v26, v24, 2, v26
s_lshl_b32 s60, s3, 1
s_add_u32 s60, s60, 0
v_xor_b32 v26, s60, v26
v_lshl_add_u32 v27, v26, 5, v27
v_and_b32 v26, 3, v0
v_lshl_add_u32 v28, v26, 3, v27
v_bfe_u32 v24, v0, 4, 1
v_lshrrev_b32 v25, 5, v0
v_bfe_u32 v26, v0, 2, 2
v_lshlrev_b32 v27, 5, v24
v_lshl_add_u32 v27, v25, 3, v27
v_add_u32 v27, v27, v26
v_lshlrev_b32 v27, 8, v27
v_lshl_add_u32 v26, v24, 2, v26
s_lshl_b32 s60, s3, 1
s_add_u32 s60, s60, 1
v_xor_b32 v26, s60, v26
v_lshl_add_u32 v27, v26, 5, v27
v_and_b32 v26, 3, v0
v_lshl_add_u32 v29, v26, 3, v27
ds_read_b64_tr_b16 a[0:1], v28 offset:0
ds_read_b64_tr_b16 a[2:3], v28 offset:1024
ds_read_b64_tr_b16 a[4:5], v28 offset:4096
ds_read_b64_tr_b16 a[6:7], v28 offset:5120
ds_read_b64_tr_b16 a[72:73], v29 offset:0
ds_read_b64_tr_b16 a[74:75], v29 offset:1024
ds_read_b64_tr_b16 a[76:77], v29 offset:4096
ds_read_b64_tr_b16 a[78:79], v29 offset:5120
s_waitcnt lgkmcnt(0)
ds_read_b64_tr_b16 a[8:9], v28 offset:16384
ds_read_b64_tr_b16 a[10:11], v28 offset:17408
ds_read_b64_tr_b16 a[12:13], v28 offset:20480
ds_read_b64_tr_b16 a[14:15], v28 offset:21504
ds_read_b64_tr_b16 a[80:81], v29 offset:16384
ds_read_b64_tr_b16 a[82:83], v29 offset:17408
ds_read_b64_tr_b16 a[84:85], v29 offset:20480
ds_read_b64_tr_b16 a[86:87], v29 offset:21504
s_waitcnt lgkmcnt(0)
ds_read_b64_tr_b16 a[16:17], v28 offset:32768
ds_read_b64_tr_b16 a[18:19], v28 offset:33792
ds_read_b64_tr_b16 a[20:21], v28 offset:36864
ds_read_b64_tr_b16 a[22:23], v28 offset:37888
ds_read_b64_tr_b16 a[88:89], v29 offset:32768
ds_read_b64_tr_b16 a[90:91], v29 offset:33792
ds_read_b64_tr_b16 a[92:93], v29 offset:36864
ds_read_b64_tr_b16 a[94:95], v29 offset:37888
s_waitcnt lgkmcnt(0)
s_barrier
s_mov_b32 s8, s26
s_and_b32 s9, s27, 0xffff
s_mov_b32 s10, 4718592
s_mov_b32 s11, 0x20000
s_lshl_b32 s61, s51, 8
s_mul_i32 s60, s3, 393216
s_add_u32 s61, s61, s60
s_add_u32 s61, s61, 0
s_mul_i32 s60, s3, 12288
s_add_u32 m0, s60, 0
s_mul_i32 s62, s3, 48
s_bitcmp1_b32 s62, 5
s_cbranch_scc1 sq_318
buffer_load_dwordx4 v30, s[8:11], s61 offen lds
s_branch sq_319
sq_318:
buffer_load_dwordx4 v31, s[8:11], s61 offen lds
sq_319:
s_add_u32 s62, s62, 4
s_add_u32 s61, s61, 32768
s_add_u32 m0, m0, 1024
s_bitcmp1_b32 s62, 5
s_cbranch_scc1 sq_320
buffer_load_dwordx4 v30, s[8:11], s61 offen lds
s_branch sq_321
sq_320:
buffer_load_dwordx4 v31, s[8:11], s61 offen lds
sq_321:
s_add_u32 s62, s62, 4
s_add_u32 s61, s61, 32768
s_add_u32 m0, m0, 1024
s_bitcmp1_b32 s62, 5
s_cbranch_scc1 sq_322
buffer_load_dwordx4 v30, s[8:11], s61 offen lds
s_branch sq_323
sq_322:
buffer_load_dwordx4 v31, s[8:11], s61 offen lds
sq_323:
s_add_u32 s62, s62, 4
s_add_u32 s61, s61, 32768
s_add_u32 m0, m0, 1024
s_bitcmp1_b32 s62, 5
s_cbranch_scc1 sq_324
buffer_load_dwordx4 v30, s[8:11], s61 offen lds
s_branch sq_325
sq_324:
buffer_load_dwordx4 v31, s[8:11], s61 offen lds
sq_325:
s_add_u32 s62, s62, 4
s_add_u32 s61, s61, 32768
s_add_u32 m0, m0, 1024
s_bitcmp1_b32 s62, 5
s_cbranch_scc1 sq_326
buffer_load_dwordx4 v30, s[8:11], s61 offen lds
s_branch sq_327
sq_326:
buffer_load_dwordx4 v31, s[8:11], s61 offen lds
sq_327:
s_add_u32 s62, s62, 4
s_add_u32 s61, s61, 32768
s_add_u32 m0, m0, 1024
s_bitcmp1_b32 s62, 5
s_cbranch_scc1 sq_328
buffer_load_dwordx4 v30, s[8:11], s61 offen lds
s_branch sq_329
sq_328:
buffer_load_dwordx4 v31, s[8:11], s61 offen lds
sq_329:
s_add_u32 s62, s62, 4
s_add_u32 s61, s61, 32768
s_add_u32 m0, m0, 1024
s_bitcmp1_b32 s62, 5
s_cbranch_scc1 sq_330
buffer_load_dwordx4 v30, s[8:11], s61 offen lds
s_branch sq_331
sq_330:
buffer_load_dwordx4 v31, s[8:11], s61 offen lds
sq_331:
s_add_u32 s62, s62, 4
s_add_u32 s61, s61, 32768
s_add_u32 m0, m0, 1024
s_bitcmp1_b32 s62, 5
s_cbranch_scc1 sq_332
buffer_load_dwordx4 v30, s[8:11], s61 offen lds
s_branch sq_333
sq_332:
buffer_load_dwordx4 v31, s[8:11], s61 offen lds
sq_333:
s_add_u32 s62, s62, 4
s_add_u32 s61, s61, 32768
s_add_u32 m0, m0, 1024
s_bitcmp1_b32 s62, 5
s_cbranch_scc1 sq_334
buffer_load_dwordx4 v30, s[8:11], s61 offen lds
s_branch sq_335
sq_334:
buffer_load_dwordx4 v31, s[8:11], s61 offen lds
sq_335:
s_add_u32 s62, s62, 4
s_add_u32 s61, s61, 32768
s_add_u32 m0, m0, 1024
s_bitcmp1_b32 s62, 5
s_cbranch_scc1 sq_336
buffer_load_dwordx4 v30, s[8:11], s61 offen lds
s_branch sq_337
sq_336:
buffer_load_dwordx4 v31, s[8:11], s61 offen lds
sq_337:
s_add_u32 s62, s62, 4
s_add_u32 s61, s61, 32768
s_add_u32 m0, m0, 1024
s_bitcmp1_b32 s62, 5
s_cbranch_scc1 sq_338
buffer_load_dwordx4 v30, s[8:11], s61 offen lds
s_branch sq_339
sq_338:
buffer_load_dwordx4 v31, s[8:11], s61 offen lds
sq_339:
s_add_u32 s62, s62, 4
s_add_u32 s61, s61, 32768
s_add_u32 m0, m0, 1024
s_bitcmp1_b32 s62, 5
s_cbranch_scc1 sq_340
buffer_load_dwordx4 v30, s[8:11], s61 offen lds
s_branch sq_341
sq_340:
buffer_load_dwordx4 v31, s[8:11], s61 offen lds
sq_341:
s_add_u32 s62, s62, 4
s_add_u32 s61, s61, 32768
s_add_u32 m0, m0, 1024
s_waitcnt vmcnt(24)
s_barrier
v_bfe_u32 v24, v0, 4, 1
v_lshrrev_b32 v25, 5, v0
v_bfe_u32 v26, v0, 2, 2
v_lshlrev_b32 v27, 5, v24
v_lshl_add_u32 v27, v25, 3, v27
v_add_u32 v27, v27, v26
v_lshlrev_b32 v27, 8, v27
v_lshl_add_u32 v26, v24, 2, v26
s_lshl_b32 s60, s3, 1
s_add_u32 s60, s60, 0
v_xor_b32 v26, s60, v26
v_lshl_add_u32 v27, v26, 5, v27
v_and_b32 v26, 3, v0
v_lshl_add_u32 v28, v26, 3, v27
v_add_u32 v28, 49152, v28
v_bfe_u32 v24, v0, 4, 1
v_lshrrev_b32 v25, 5, v0
v_bfe_u32 v26, v0, 2, 2
v_lshlrev_b32 v27, 5, v24
v_lshl_add_u32 v27, v25, 3, v27
v_add_u32 v27, v27, v26
v_lshlrev_b32 v27, 8, v27
v_lshl_add_u32 v26, v24, 2, v26
s_lshl_b32 s60, s3, 1
s_add_u32 s60, s60, 1
v_xor_b32 v26, s60, v26
v_lshl_add_u32 v27, v26, 5, v27
v_and_b32 v26, 3, v0
v_lshl_add_u32 v29, v26, 3, v27
v_add_u32 v29, 49152, v29
ds_read_b64_tr_b16 a[24:25], v28 offset:0
ds_read_b64_tr_b16 a[26:27], v28 offset:1024
ds_read_b64_tr_b16 a[28:29], v28 offset:4096
ds_read_b64_tr_b16 a[30:31], v28 offset:5120
ds_read_b64_tr_b16 a[96:97], v29 offset:0
ds_read_b64_tr_b16 a[98:99], v29 offset:1024
ds_read_b64_tr_b16 a[100:101], v29 offset:4096
ds_read_b64_tr_b16 a[102:103], v29 offset:5120
s_waitcnt lgkmcnt(0)
ds_read_b64_tr_b16 a[32:33], v28 offset:16384
ds_read_b64_tr_b16 a[34:35], v28 offset:17408
ds_read_b64_tr_b16 a[36:37], v28 offset:20480
ds_read_b64_tr_b16 a[38:39], v28 offset:21504
ds_read_b64_tr_b16 a[104:105], v29 offset:16384
ds_read_b64_tr_b16 a[106:107], v29 offset:17408
ds_read_b64_tr_b16 a[108:109], v29 offset:20480
ds_read_b64_tr_b16 a[110:111], v29 offset:21504
s_waitcnt lgkmcnt(0)
ds_read_b64_tr_b16 a[40:41], v28 offset:32768
ds_read_b64_tr_b16 a[42:43], v28 offset:33792
ds_read_b64_tr_b16 a[44:45], v28 offset:36864
ds_read_b64_tr_b16 a[46:47], v28 offset:37888
ds_read_b64_tr_b16 a[112:113], v29 offset:32768
ds_read_b64_tr_b16 a[114:115], v29 offset:33792
ds_read_b64_tr_b16 a[116:117], v29 offset:36864
ds_read_b64_tr_b16 a[118:119], v29 offset:37888
s_waitcnt lgkmcnt(0)
s_barrier
s_mov_b32 s8, s26
s_and_b32 s9, s27, 0xffff
s_mov_b32 s10, 4718592
s_mov_b32 s11, 0x20000
s_lshl_b32 s61, s51, 8
s_mul_i32 s60, s3, 393216
s_add_u32 s61, s61, s60
s_add_u32 s61, s61, 1572864
s_mul_i32 s60, s3, 12288
s_add_u32 m0, s60, 49152
s_mul_i32 s62, s3, 48
s_bitcmp1_b32 s62, 5
s_cbranch_scc1 sq_342
buffer_load_dwordx4 v30, s[8:11], s61 offen lds
s_branch sq_343
sq_342:
buffer_load_dwordx4 v31, s[8:11], s61 offen lds
sq_343:
s_add_u32 s62, s62, 4
s_add_u32 s61, s61, 32768
s_add_u32 m0, m0, 1024
s_bitcmp1_b32 s62, 5
s_cbranch_scc1 sq_344
buffer_load_dwordx4 v30, s[8:11], s61 offen lds
s_branch sq_345
sq_344:
buffer_load_dwordx4 v31, s[8:11], s61 offen lds
sq_345:
s_add_u32 s62, s62, 4
s_add_u32 s61, s61, 32768
s_add_u32 m0, m0, 1024
s_bitcmp1_b32 s62, 5
s_cbranch_scc1 sq_346
buffer_load_dwordx4 v30, s[8:11], s61 offen lds
s_branch sq_347
sq_346:
buffer_load_dwordx4 v31, s[8:11], s61 offen lds
sq_347:
s_add_u32 s62, s62, 4
s_add_u32 s61, s61, 32768
s_add_u32 m0, m0, 1024
s_bitcmp1_b32 s62, 5
s_cbranch_scc1 sq_348
buffer_load_dwordx4 v30, s[8:11], s61 offen lds
s_branch sq_349
sq_348:
buffer_load_dwordx4 v31, s[8:11], s61 offen lds
sq_349:
s_add_u32 s62, s62, 4
s_add_u32 s61, s61, 32768
s_add_u32 m0, m0, 1024
s_bitcmp1_b32 s62, 5
s_cbranch_scc1 sq_350
buffer_load_dwordx4 v30, s[8:11], s61 offen lds
s_branch sq_351
sq_350:
buffer_load_dwordx4 v31, s[8:11], s61 offen lds
sq_351:
s_add_u32 s62, s62, 4
s_add_u32 s61, s61, 32768
s_add_u32 m0, m0, 1024
s_bitcmp1_b32 s62, 5
s_cbranch_scc1 sq_352
buffer_load_dwordx4 v30, s[8:11], s61 offen lds
s_branch sq_353
sq_352:
buffer_load_dwordx4 v31, s[8:11], s61 offen lds
sq_353:
s_add_u32 s62, s62, 4
s_add_u32 s61, s61, 32768
s_add_u32 m0, m0, 1024
s_bitcmp1_b32 s62, 5
s_cbranch_scc1 sq_354
buffer_load_dwordx4 v30, s[8:11], s61 offen lds
s_branch sq_355
sq_354:
buffer_load_dwordx4 v31, s[8:11], s61 offen lds
sq_355:
s_add_u32 s62, s62, 4
s_add_u32 s61, s61, 32768
s_add_u32 m0, m0, 1024
s_bitcmp1_b32 s62, 5
s_cbranch_scc1 sq_356
buffer_load_dwordx4 v30, s[8:11], s61 offen lds
s_branch sq_357
sq_356:
buffer_load_dwordx4 v31, s[8:11], s61 offen lds
sq_357:
s_add_u32 s62, s62, 4
s_add_u32 s61, s61, 32768
s_add_u32 m0, m0, 1024
s_bitcmp1_b32 s62, 5
s_cbranch_scc1 sq_358
buffer_load_dwordx4 v30, s[8:11], s61 offen lds
s_branch sq_359
sq_358:
buffer_load_dwordx4 v31, s[8:11], s61 offen lds
sq_359:
s_add_u32 s62, s62, 4
s_add_u32 s61, s61, 32768
s_add_u32 m0, m0, 1024
s_bitcmp1_b32 s62, 5
s_cbranch_scc1 sq_360
buffer_load_dwordx4 v30, s[8:11], s61 offen lds
s_branch sq_361
sq_360:
buffer_load_dwordx4 v31, s[8:11], s61 offen lds
sq_361:
s_add_u32 s62, s62, 4
s_add_u32 s61, s61, 32768
s_add_u32 m0, m0, 1024
s_bitcmp1_b32 s62, 5
s_cbranch_scc1 sq_362
buffer_load_dwordx4 v30, s[8:11], s61 offen lds
s_branch sq_363
sq_362:
buffer_load_dwordx4 v31, s[8:11], s61 offen lds
sq_363:
s_add_u32 s62, s62, 4
s_add_u32 s61, s61, 32768
s_add_u32 m0, m0, 1024
s_bitcmp1_b32 s62, 5
s_cbranch_scc1 sq_364
buffer_load_dwordx4 v30, s[8:11], s61 offen lds
s_branch sq_365
sq_364:
buffer_load_dwordx4 v31, s[8:11], s61 offen lds
sq_365:
s_add_u32 s62, s62, 4
s_add_u32 s61, s61, 32768
s_add_u32 m0, m0, 1024
s_waitcnt vmcnt(24)
s_barrier
v_bfe_u32 v24, v0, 4, 1
v_lshrrev_b32 v25, 5, v0
v_bfe_u32 v26, v0, 2, 2
v_lshlrev_b32 v27, 5, v24
v_lshl_add_u32 v27, v25, 3, v27
v_add_u32 v27, v27, v26
v_lshlrev_b32 v27, 8, v27
v_lshl_add_u32 v26, v24, 2, v26
s_lshl_b32 s60, s3, 1
s_add_u32 s60, s60, 0
v_xor_b32 v26, s60, v26
v_lshl_add_u32 v27, v26, 5, v27
v_and_b32 v26, 3, v0
v_lshl_add_u32 v28, v26, 3, v27
v_add_u32 v28, 98304, v28
v_bfe_u32 v24, v0, 4, 1
v_lshrrev_b32 v25, 5, v0
v_bfe_u32 v26, v0, 2, 2
v_lshlrev_b32 v27, 5, v24
v_lshl_add_u32 v27, v25, 3, v27
v_add_u32 v27, v27, v26
v_lshlrev_b32 v27, 8, v27
v_lshl_add_u32 v26, v24, 2, v26
s_lshl_b32 s60, s3, 1
s_add_u32 s60, s60, 1
v_xor_b32 v26, s60, v26
v_lshl_add_u32 v27, v26, 5, v27
v_and_b32 v26, 3, v0
v_lshl_add_u32 v29, v26, 3, v27
v_add_u32 v29, 98304, v29
ds_read_b64_tr_b16 a[48:49], v28 offset:0
ds_read_b64_tr_b16 a[50:51], v28 offset:1024
ds_read_b64_tr_b16 a[52:53], v28 offset:4096
ds_read_b64_tr_b16 a[54:55], v28 offset:5120
ds_read_b64_tr_b16 a[120:121], v29 offset:0
ds_read_b64_tr_b16 a[122:123], v29 offset:1024
ds_read_b64_tr_b16 a[124:125], v29 offset:4096
ds_read_b64_tr_b16 a[126:127], v29 offset:5120
s_waitcnt lgkmcnt(0)
ds_read_b64_tr_b16 a[56:57], v28 offset:16384
ds_read_b64_tr_b16 a[58:59], v28 offset:17408
ds_read_b64_tr_b16 a[60:61], v28 offset:20480
ds_read_b64_tr_b16 a[62:63], v28 offset:21504
ds_read_b64_tr_b16 a[128:129], v29 offset:16384
ds_read_b64_tr_b16 a[130:131], v29 offset:17408
ds_read_b64_tr_b16 a[132:133], v29 offset:20480
ds_read_b64_tr_b16 a[134:135], v29 offset:21504
s_waitcnt lgkmcnt(0)
ds_read_b64_tr_b16 a[64:65], v28 offset:32768
ds_read_b64_tr_b16 a[66:67], v28 offset:33792
ds_read_b64_tr_b16 a[68:69], v28 offset:36864
ds_read_b64_tr_b16 a[70:71], v28 offset:37888
ds_read_b64_tr_b16 a[136:137], v29 offset:32768
ds_read_b64_tr_b16 a[138:139], v29 offset:33792
ds_read_b64_tr_b16 a[140:141], v29 offset:36864
ds_read_b64_tr_b16 a[142:143], v29 offset:37888
s_waitcnt lgkmcnt(0)
s_barrier
s_mov_b32 s8, s26
s_and_b32 s9, s27, 0xffff
s_mov_b32 s10, 4718592
s_mov_b32 s11, 0x20000
s_lshl_b32 s61, s51, 8
s_mul_i32 s60, s3, 393216
s_add_u32 s61, s61, s60
s_add_u32 s61, s61, 3145728
s_mul_i32 s60, s3, 12288
s_add_u32 m0, s60, 98304
s_mul_i32 s62, s3, 48
s_bitcmp1_b32 s62, 5
s_cbranch_scc1 sq_366
buffer_load_dwordx4 v30, s[8:11], s61 offen lds
s_branch sq_367
sq_366:
buffer_load_dwordx4 v31, s[8:11], s61 offen lds
sq_367:
s_add_u32 s62, s62, 4
s_add_u32 s61, s61, 32768
s_add_u32 m0, m0, 1024
s_bitcmp1_b32 s62, 5
s_cbranch_scc1 sq_368
buffer_load_dwordx4 v30, s[8:11], s61 offen lds
s_branch sq_369
sq_368:
buffer_load_dwordx4 v31, s[8:11], s61 offen lds
sq_369:
s_add_u32 s62, s62, 4
s_add_u32 s61, s61, 32768
s_add_u32 m0, m0, 1024
s_bitcmp1_b32 s62, 5
s_cbranch_scc1 sq_370
buffer_load_dwordx4 v30, s[8:11], s61 offen lds
s_branch sq_371
sq_370:
buffer_load_dwordx4 v31, s[8:11], s61 offen lds
sq_371:
s_add_u32 s62, s62, 4
s_add_u32 s61, s61, 32768
s_add_u32 m0, m0, 1024
s_bitcmp1_b32 s62, 5
s_cbranch_scc1 sq_372
buffer_load_dwordx4 v30, s[8:11], s61 offen lds
s_branch sq_373
sq_372:
buffer_load_dwordx4 v31, s[8:11], s61 offen lds
sq_373:
s_add_u32 s62, s62, 4
s_add_u32 s61, s61, 32768
s_add_u32 m0, m0, 1024
s_bitcmp1_b32 s62, 5
s_cbranch_scc1 sq_374
buffer_load_dwordx4 v30, s[8:11], s61 offen lds
s_branch sq_375
sq_374:
buffer_load_dwordx4 v31, s[8:11], s61 offen lds
sq_375:
s_add_u32 s62, s62, 4
s_add_u32 s61, s61, 32768
s_add_u32 m0, m0, 1024
s_bitcmp1_b32 s62, 5
s_cbranch_scc1 sq_376
buffer_load_dwordx4 v30, s[8:11], s61 offen lds
s_branch sq_377
sq_376:
buffer_load_dwordx4 v31, s[8:11], s61 offen lds
sq_377:
s_add_u32 s62, s62, 4
s_add_u32 s61, s61, 32768
s_add_u32 m0, m0, 1024
s_bitcmp1_b32 s62, 5
s_cbranch_scc1 sq_378
buffer_load_dwordx4 v30, s[8:11], s61 offen lds
s_branch sq_379
sq_378:
buffer_load_dwordx4 v31, s[8:11], s61 offen lds
sq_379:
s_add_u32 s62, s62, 4
s_add_u32 s61, s61, 32768
s_add_u32 m0, m0, 1024
s_bitcmp1_b32 s62, 5
s_cbranch_scc1 sq_380
buffer_load_dwordx4 v30, s[8:11], s61 offen lds
s_branch sq_381
sq_380:
buffer_load_dwordx4 v31, s[8:11], s61 offen lds
sq_381:
s_add_u32 s62, s62, 4
s_add_u32 s61, s61, 32768
s_add_u32 m0, m0, 1024
s_bitcmp1_b32 s62, 5
s_cbranch_scc1 sq_382
buffer_load_dwordx4 v30, s[8:11], s61 offen lds
s_branch sq_383
sq_382:
buffer_load_dwordx4 v31, s[8:11], s61 offen lds
sq_383:
s_add_u32 s62, s62, 4
s_add_u32 s61, s61, 32768
s_add_u32 m0, m0, 1024
s_bitcmp1_b32 s62, 5
s_cbranch_scc1 sq_384
buffer_load_dwordx4 v30, s[8:11], s61 offen lds
s_branch sq_385
sq_384:
buffer_load_dwordx4 v31, s[8:11], s61 offen lds
sq_385:
s_add_u32 s62, s62, 4
s_add_u32 s61, s61, 32768
s_add_u32 m0, m0, 1024
s_bitcmp1_b32 s62, 5
s_cbranch_scc1 sq_386
buffer_load_dwordx4 v30, s[8:11], s61 offen lds
s_branch sq_387
sq_386:
buffer_load_dwordx4 v31, s[8:11], s61 offen lds
sq_387:
s_add_u32 s62, s62, 4
s_add_u32 s61, s61, 32768
s_add_u32 m0, m0, 1024
s_bitcmp1_b32 s62, 5
s_cbranch_scc1 sq_388
buffer_load_dwordx4 v30, s[8:11], s61 offen lds
s_branch sq_389
sq_388:
buffer_load_dwordx4 v31, s[8:11], s61 offen lds
sq_389:
s_add_u32 s62, s62, 4
s_add_u32 s61, s61, 32768
s_add_u32 m0, m0, 1024
s_waitcnt vmcnt(24)
s_barrier
v_bfe_u32 v24, v0, 4, 1
v_lshrrev_b32 v25, 5, v0
v_bfe_u32 v26, v0, 2, 2
v_lshlrev_b32 v27, 5, v24
v_lshl_add_u32 v27, v25, 3, v27
v_add_u32 v27, v27, v26
v_lshlrev_b32 v27, 8, v27
v_lshl_add_u32 v26, v24, 2, v26
s_lshl_b32 s60, s3, 1
s_add_u32 s60, s60, 0
v_xor_b32 v26, s60, v26
v_lshl_add_u32 v27, v26, 5, v27
v_and_b32 v26, 3, v0
v_lshl_add_u32 v28, v26, 3, v27
v_bfe_u32 v24, v0, 4, 1
v_lshrrev_b32 v25, 5, v0
v_bfe_u32 v26, v0, 2, 2
v_lshlrev_b32 v27, 5, v24
v_lshl_add_u32 v27, v25, 3, v27
v_add_u32 v27, v27, v26
v_lshlrev_b32 v27, 8, v27
v_lshl_add_u32 v26, v24, 2, v26
s_lshl_b32 s60, s3, 1
s_add_u32 s60, s60, 1
v_xor_b32 v26, s60, v26
v_lshl_add_u32 v27, v26, 5, v27
v_and_b32 v26, 3, v0
v_lshl_add_u32 v29, v26, 3, v27
ds_read_b64_tr_b16 a[144:145], v28 offset:0
ds_read_b64_tr_b16 a[146:147], v28 offset:1024
ds_read_b64_tr_b16 a[148:149], v28 offset:4096
ds_read_b64_tr_b16 a[150:151], v28 offset:5120
ds_read_b64_tr_b16 a[216:217], v29 offset:0
ds_read_b64_tr_b16 a[218:219], v29 offset:1024
ds_read_b64_tr_b16 a[220:221], v29 offset:4096
ds_read_b64_tr_b16 a[222:223], v29 offset:5120
s_waitcnt lgkmcnt(0)
ds_read_b64_tr_b16 a[152:153], v28 offset:16384
ds_read_b64_tr_b16 a[154:155], v28 offset:17408
ds_read_b64_tr_b16 a[156:157], v28 offset:20480
ds_read_b64_tr_b16 a[158:159], v28 offset:21504
ds_read_b64_tr_b16 a[224:225], v29 offset:16384
ds_read_b64_tr_b16 a[226:227], v29 offset:17408
ds_read_b64_tr_b16 a[228:229], v29 offset:20480
ds_read_b64_tr_b16 a[230:231], v29 offset:21504
s_waitcnt lgkmcnt(0)
ds_read_b64_tr_b16 a[160:161], v28 offset:32768
ds_read_b64_tr_b16 a[162:163], v28 offset:33792
ds_read_b64_tr_b16 a[164:165], v28 offset:36864
ds_read_b64_tr_b16 a[166:167], v28 offset:37888
ds_read_b64_tr_b16 a[232:233], v29 offset:32768
ds_read_b64_tr_b16 a[234:235], v29 offset:33792
ds_read_b64_tr_b16 a[236:237], v29 offset:36864
ds_read_b64_tr_b16 a[238:239], v29 offset:37888
s_waitcnt lgkmcnt(0)
s_barrier
s_mov_b32 s8, s30
s_and_b32 s9, s31, 0xffff
s_mov_b32 s10, 4718592
s_mov_b32 s11, 0x20000
s_mul_i32 s61, s51, 147456
s_mul_i32 s60, s3, 9216
s_add_u32 s61, s61, s60
s_add_u32 s61, s61, 0
s_add_u32 m0, s60, 0
s_nop 0
buffer_load_dwordx4 v1, s[8:11], s61 offen lds
s_add_u32 s61, s61, 1024
s_add_u32 m0, m0, 1024
s_nop 0
buffer_load_dwordx4 v1, s[8:11], s61 offen lds
s_add_u32 s61, s61, 1024
s_add_u32 m0, m0, 1024
s_nop 0
buffer_load_dwordx4 v1, s[8:11], s61 offen lds
s_add_u32 s61, s61, 1024
s_add_u32 m0, m0, 1024
s_nop 0
buffer_load_dwordx4 v1, s[8:11], s61 offen lds
s_add_u32 s61, s61, 1024
s_add_u32 m0, m0, 1024
s_nop 0
buffer_load_dwordx4 v1, s[8:11], s61 offen lds
s_add_u32 s61, s61, 1024
s_add_u32 m0, m0, 1024
s_nop 0
buffer_load_dwordx4 v1, s[8:11], s61 offen lds
s_add_u32 s61, s61, 1024
s_add_u32 m0, m0, 1024
s_nop 0
buffer_load_dwordx4 v1, s[8:11], s61 offen lds
s_add_u32 s61, s61, 1024
s_add_u32 m0, m0, 1024
s_nop 0
buffer_load_dwordx4 v1, s[8:11], s61 offen lds
s_add_u32 s61, s61, 1024
s_add_u32 m0, m0, 1024
s_nop 0
buffer_load_dwordx4 v1, s[8:11], s61 offen lds
s_add_u32 s61, s61, 1024
s_add_u32 m0, m0, 1024
s_waitcnt vmcnt(21)
s_barrier
v_bfe_u32 v24, v0, 4, 1
v_lshrrev_b32 v25, 5, v0
v_bfe_u32 v26, v0, 2, 2
v_lshlrev_b32 v27, 5, v24
v_lshl_add_u32 v27, v25, 3, v27
v_add_u32 v27, v27, v26
v_lshlrev_b32 v27, 8, v27
v_lshl_add_u32 v26, v24, 2, v26
s_lshl_b32 s60, s3, 1
s_add_u32 s60, s60, 0
v_xor_b32 v26, s60, v26
v_lshl_add_u32 v27, v26, 5, v27
v_and_b32 v26, 3, v0
v_lshl_add_u32 v28, v26, 3, v27
v_add_u32 v28, 49152, v28
v_bfe_u32 v24, v0, 4, 1
v_lshrrev_b32 v25, 5, v0
v_bfe_u32 v26, v0, 2, 2
v_lshlrev_b32 v27, 5, v24
v_lshl_add_u32 v27, v25, 3, v27
v_add_u32 v27, v27, v26
v_lshlrev_b32 v27, 8, v27
v_lshl_add_u32 v26, v24, 2, v26
s_lshl_b32 s60, s3, 1
s_add_u32 s60, s60, 1
v_xor_b32 v26, s60, v26
v_lshl_add_u32 v27, v26, 5, v27
v_and_b32 v26, 3, v0
v_lshl_add_u32 v29, v26, 3, v27
v_add_u32 v29, 49152, v29
ds_read_b64_tr_b16 a[168:169], v28 offset:0
ds_read_b64_tr_b16 a[170:171], v28 offset:1024
ds_read_b64_tr_b16 a[172:173], v28 offset:4096
ds_read_b64_tr_b16 a[174:175], v28 offset:5120
ds_read_b64_tr_b16 a[240:241], v29 offset:0
ds_read_b64_tr_b16 a[242:243], v29 offset:1024
ds_read_b64_tr_b16 a[244:245], v29 offset:4096
ds_read_b64_tr_b16 a[246:247], v29 offset:5120
s_waitcnt lgkmcnt(0)
ds_read_b64_tr_b16 a[176:177], v28 offset:16384
ds_read_b64_tr_b16 a[178:179], v28 offset:17408
ds_read_b64_tr_b16 a[180:181], v28 offset:20480
ds_read_b64_tr_b16 a[182:183], v28 offset:21504
ds_read_b64_tr_b16 a[248:249], v29 offset:16384
ds_read_b64_tr_b16 a[250:251], v29 offset:17408
ds_read_b64_tr_b16 a[252:253], v29 offset:20480
ds_read_b64_tr_b16 a[254:255], v29 offset:21504
s_waitcnt lgkmcnt(0)
ds_read_b64_tr_b16 a[184:185], v28 offset:32768
ds_read_b64_tr_b16 a[186:187], v28 offset:33792
ds_read_b64_tr_b16 a[188:189], v28 offset:36864
ds_read_b64_tr_b16 a[190:191], v28 offset:37888
ds_read_b64_tr_b16 v[72:73], v29 offset:32768
ds_read_b64_tr_b16 v[74:75], v29 offset:33792
ds_read_b64_tr_b16 v[76:77], v29 offset:36864
ds_read_b64_tr_b16 v[78:79], v29 offset:37888
s_waitcnt lgkmcnt(0)
s_barrier
s_mov_b32 s8, s30
s_and_b32 s9, s31, 0xffff
s_mov_b32 s10, 4718592
s_mov_b32 s11, 0x20000
s_mul_i32 s61, s51, 147456
s_mul_i32 s60, s3, 9216
s_add_u32 s61, s61, s60
s_add_u32 s61, s61, 36864
s_add_u32 m0, s60, 49152
s_nop 0
buffer_load_dwordx4 v1, s[8:11], s61 offen lds
s_add_u32 s61, s61, 1024
s_add_u32 m0, m0, 1024
s_nop 0
buffer_load_dwordx4 v1, s[8:11], s61 offen lds
s_add_u32 s61, s61, 1024
s_add_u32 m0, m0, 1024
s_nop 0
buffer_load_dwordx4 v1, s[8:11], s61 offen lds
s_add_u32 s61, s61, 1024
s_add_u32 m0, m0, 1024
s_nop 0
buffer_load_dwordx4 v1, s[8:11], s61 offen lds
s_add_u32 s61, s61, 1024
s_add_u32 m0, m0, 1024
s_nop 0
buffer_load_dwordx4 v1, s[8:11], s61 offen lds
s_add_u32 s61, s61, 1024
s_add_u32 m0, m0, 1024
s_nop 0
buffer_load_dwordx4 v1, s[8:11], s61 offen lds
s_add_u32 s61, s61, 1024
s_add_u32 m0, m0, 1024
s_nop 0
buffer_load_dwordx4 v1, s[8:11], s61 offen lds
s_add_u32 s61, s61, 1024
s_add_u32 m0, m0, 1024
s_nop 0
buffer_load_dwordx4 v1, s[8:11], s61 offen lds
s_add_u32 s61, s61, 1024
s_add_u32 m0, m0, 1024
s_nop 0
buffer_load_dwordx4 v1, s[8:11], s61 offen lds
s_add_u32 s61, s61, 1024
s_add_u32 m0, m0, 1024
s_waitcnt vmcnt(18)
s_barrier
v_bfe_u32 v24, v0, 4, 1
v_lshrrev_b32 v25, 5, v0
v_bfe_u32 v26, v0, 2, 2
v_lshlrev_b32 v27, 5, v24
v_lshl_add_u32 v27, v25, 3, v27
v_add_u32 v27, v27, v26
v_lshlrev_b32 v27, 8, v27
v_lshl_add_u32 v26, v24, 2, v26
s_lshl_b32 s60, s3, 1
s_add_u32 s60, s60, 0
v_xor_b32 v26, s60, v26
v_lshl_add_u32 v27, v26, 5, v27
v_and_b32 v26, 3, v0
v_lshl_add_u32 v28, v26, 3, v27
v_add_u32 v28, 98304, v28
v_bfe_u32 v24, v0, 4, 1
v_lshrrev_b32 v25, 5, v0
v_bfe_u32 v26, v0, 2, 2
v_lshlrev_b32 v27, 5, v24
v_lshl_add_u32 v27, v25, 3, v27
v_add_u32 v27, v27, v26
v_lshlrev_b32 v27, 8, v27
v_lshl_add_u32 v26, v24, 2, v26
s_lshl_b32 s60, s3, 1
s_add_u32 s60, s60, 1
v_xor_b32 v26, s60, v26
v_lshl_add_u32 v27, v26, 5, v27
v_and_b32 v26, 3, v0
v_lshl_add_u32 v29, v26, 3, v27
v_add_u32 v29, 98304, v29
ds_read_b64_tr_b16 a[192:193], v28 offset:0
ds_read_b64_tr_b16 a[194:195], v28 offset:1024
ds_read_b64_tr_b16 a[196:197], v28 offset:4096
ds_read_b64_tr_b16 a[198:199], v28 offset:5120
ds_read_b64_tr_b16 v[80:81], v29 offset:0
ds_read_b64_tr_b16 v[82:83], v29 offset:1024
ds_read_b64_tr_b16 v[84:85], v29 offset:4096
ds_read_b64_tr_b16 v[86:87], v29 offset:5120
s_waitcnt lgkmcnt(0)
ds_read_b64_tr_b16 a[200:201], v28 offset:16384
ds_read_b64_tr_b16 a[202:203], v28 offset:17408
ds_read_b64_tr_b16 a[204:205], v28 offset:20480
ds_read_b64_tr_b16 a[206:207], v28 offset:21504
ds_read_b64_tr_b16 v[88:89], v29 offset:16384
ds_read_b64_tr_b16 v[90:91], v29 offset:17408
ds_read_b64_tr_b16 v[92:93], v29 offset:20480
ds_read_b64_tr_b16 v[94:95], v29 offset:21504
s_waitcnt lgkmcnt(0)
ds_read_b64_tr_b16 a[208:209], v28 offset:32768
ds_read_b64_tr_b16 a[210:211], v28 offset:33792
ds_read_b64_tr_b16 a[212:213], v28 offset:36864
ds_read_b64_tr_b16 a[214:215], v28 offset:37888
ds_read_b64_tr_b16 v[96:97], v29 offset:32768
ds_read_b64_tr_b16 v[98:99], v29 offset:33792
ds_read_b64_tr_b16 v[100:101], v29 offset:36864
ds_read_b64_tr_b16 v[102:103], v29 offset:37888
s_waitcnt lgkmcnt(0)
s_barrier
s_mov_b32 s8, s30
s_and_b32 s9, s31, 0xffff
s_mov_b32 s10, 4718592
s_mov_b32 s11, 0x20000
s_mul_i32 s61, s51, 147456
s_mul_i32 s60, s3, 9216
s_add_u32 s61, s61, s60
s_add_u32 s61, s61, 73728
s_add_u32 m0, s60, 98304
s_nop 0
buffer_load_dwordx4 v1, s[8:11], s61 offen lds
s_add_u32 s61, s61, 1024
s_add_u32 m0, m0, 1024
s_nop 0
buffer_load_dwordx4 v1, s[8:11], s61 offen lds
s_add_u32 s61, s61, 1024
s_add_u32 m0, m0, 1024
s_nop 0
buffer_load_dwordx4 v1, s[8:11], s61 offen lds
s_add_u32 s61, s61, 1024
s_add_u32 m0, m0, 1024
s_nop 0
buffer_load_dwordx4 v1, s[8:11], s61 offen lds
s_add_u32 s61, s61, 1024
s_add_u32 m0, m0, 1024
s_nop 0
buffer_load_dwordx4 v1, s[8:11], s61 offen lds
s_add_u32 s61, s61, 1024
s_add_u32 m0, m0, 1024
s_nop 0
buffer_load_dwordx4 v1, s[8:11], s61 offen lds
s_add_u32 s61, s61, 1024
s_add_u32 m0, m0, 1024
s_nop 0
buffer_load_dwordx4 v1, s[8:11], s61 offen lds
s_add_u32 s61, s61, 1024
s_add_u32 m0, m0, 1024
s_nop 0
buffer_load_dwordx4 v1, s[8:11], s61 offen lds
s_add_u32 s61, s61, 1024
s_add_u32 m0, m0, 1024
s_nop 0
buffer_load_dwordx4 v1, s[8:11], s61 offen lds
s_add_u32 s61, s61, 1024
s_add_u32 m0, m0, 1024
s_waitcnt vmcnt(18)
s_barrier
v_lshrrev_b32 v24, 4, v0
v_lshlrev_b32 v24, 3, v24
v_bfe_u32 v25, v0, 2, 2
v_add_u32 v24, v24, v25
v_mul_u32_u24 v24, 1152, v24
v_and_b32 v25, 3, v0
v_lshl_add_u32 v24, v25, 3, v24
s_mul_i32 s60, s3, 288
s_add_u32 s60, s60, 0
v_add_u32 v28, s60, v24
ds_read_b64_tr_b16 v[104:105], v28 offset:0
ds_read_b64_tr_b16 v[106:107], v28 offset:4608
ds_read_b64_tr_b16 v[120:121], v28 offset:32
ds_read_b64_tr_b16 v[122:123], v28 offset:4640
ds_read_b64_tr_b16 v[136:137], v28 offset:64
ds_read_b64_tr_b16 v[138:139], v28 offset:4672
s_waitcnt lgkmcnt(0)
ds_read_b64_tr_b16 v[152:153], v28 offset:96
ds_read_b64_tr_b16 v[154:155], v28 offset:4704
ds_read_b64_tr_b16 v[168:169], v28 offset:128
ds_read_b64_tr_b16 v[170:171], v28 offset:4736
ds_read_b64_tr_b16 v[184:185], v28 offset:160
ds_read_b64_tr_b16 v[186:187], v28 offset:4768
s_waitcnt lgkmcnt(0)
ds_read_b64_tr_b16 v[200:201], v28 offset:192
ds_read_b64_tr_b16 v[202:203], v28 offset:4800
ds_read_b64_tr_b16 v[216:217], v28 offset:224
ds_read_b64_tr_b16 v[218:219], v28 offset:4832
ds_read_b64_tr_b16 v[232:233], v28 offset:256
ds_read_b64_tr_b16 v[234:235], v28 offset:4864
s_waitcnt lgkmcnt(0)
s_barrier
s_mov_b32 s8, s30
s_and_b32 s9, s31, 0xffff
s_mov_b32 s10, 4718592
s_mov_b32 s11, 0x20000
s_mul_i32 s61, s51, 147456
s_mul_i32 s60, s3, 9216
s_add_u32 s61, s61, s60
s_add_u32 s61, s61, 110592
s_add_u32 m0, s60, 0
s_nop 0
buffer_load_dwordx4 v1, s[8:11], s61 offen lds
s_add_u32 s61, s61, 1024
s_add_u32 m0, m0, 1024
s_nop 0
buffer_load_dwordx4 v1, s[8:11], s61 offen lds
s_add_u32 s61, s61, 1024
s_add_u32 m0, m0, 1024
s_nop 0
buffer_load_dwordx4 v1, s[8:11], s61 offen lds
s_add_u32 s61, s61, 1024
s_add_u32 m0, m0, 1024
s_nop 0
buffer_load_dwordx4 v1, s[8:11], s61 offen lds
s_add_u32 s61, s61, 1024
s_add_u32 m0, m0, 1024
s_nop 0
buffer_load_dwordx4 v1, s[8:11], s61 offen lds
s_add_u32 s61, s61, 1024
s_add_u32 m0, m0, 1024
s_nop 0
buffer_load_dwordx4 v1, s[8:11], s61 offen lds
s_add_u32 s61, s61, 1024
s_add_u32 m0, m0, 1024
s_nop 0
buffer_load_dwordx4 v1, s[8:11], s61 offen lds
s_add_u32 s61, s61, 1024
s_add_u32 m0, m0, 1024
s_nop 0
buffer_load_dwordx4 v1, s[8:11], s61 offen lds
s_add_u32 s61, s61, 1024
s_add_u32 m0, m0, 1024
s_nop 0
buffer_load_dwordx4 v1, s[8:11], s61 offen lds
s_add_u32 s61, s61, 1024
s_add_u32 m0, m0, 1024
s_waitcnt vmcnt(18)
s_barrier
v_lshrrev_b32 v24, 4, v0
v_lshlrev_b32 v24, 3, v24
v_bfe_u32 v25, v0, 2, 2
v_add_u32 v24, v24, v25
v_mul_u32_u24 v24, 1152, v24
v_and_b32 v25, 3, v0
v_lshl_add_u32 v24, v25, 3, v24
s_mul_i32 s60, s3, 288
s_add_u32 s60, s60, 49152
v_add_u32 v28, s60, v24
ds_read_b64_tr_b16 v[108:109], v28 offset:0
ds_read_b64_tr_b16 v[110:111], v28 offset:4608
ds_read_b64_tr_b16 v[124:125], v28 offset:32
ds_read_b64_tr_b16 v[126:127], v28 offset:4640
ds_read_b64_tr_b16 v[140:141], v28 offset:64
ds_read_b64_tr_b16 v[142:143], v28 offset:4672
s_waitcnt lgkmcnt(0)
ds_read_b64_tr_b16 v[156:157], v28 offset:96
ds_read_b64_tr_b16 v[158:159], v28 offset:4704
ds_read_b64_tr_b16 v[172:173], v28 offset:128
ds_read_b64_tr_b16 v[174:175], v28 offset:4736
ds_read_b64_tr_b16 v[188:189], v28 offset:160
ds_read_b64_tr_b16 v[190:191], v28 offset:4768
s_waitcnt lgkmcnt(0)
ds_read_b64_tr_b16 v[204:205], v28 offset:192
ds_read_b64_tr_b16 v[206:207], v28 offset:4800
ds_read_b64_tr_b16 v[220:221], v28 offset:224
ds_read_b64_tr_b16 v[222:223], v28 offset:4832
ds_read_b64_tr_b16 v[236:237], v28 offset:256
ds_read_b64_tr_b16 v[238:239], v28 offset:4864
s_waitcnt lgkmcnt(0)
s_barrier
s_mov_b32 s8, s28
s_and_b32 s9, s29, 0xffff
s_mov_b32 s10, 4718592
s_mov_b32 s11, 0x20000
s_lshl_b32 s61, s51, 8
s_mul_i32 s60, s3, 393216
s_add_u32 s61, s61, s60
s_add_u32 s61, s61, 1572864
s_mul_i32 s60, s3, 12288
s_add_u32 m0, s60, 49152
s_mul_i32 s62, s3, 48
s_bitcmp1_b32 s62, 5
s_cbranch_scc1 sq_390
buffer_load_dwordx4 v30, s[8:11], s61 offen lds
s_branch sq_391
sq_390:
buffer_load_dwordx4 v31, s[8:11], s61 offen lds
sq_391:
s_add_u32 s62, s62, 4
s_add_u32 s61, s61, 32768
s_add_u32 m0, m0, 1024
s_bitcmp1_b32 s62, 5
s_cbranch_scc1 sq_392
buffer_load_dwordx4 v30, s[8:11], s61 offen lds
s_branch sq_393
sq_392:
buffer_load_dwordx4 v31, s[8:11], s61 offen lds
sq_393:
s_add_u32 s62, s62, 4
s_add_u32 s61, s61, 32768
s_add_u32 m0, m0, 1024
s_bitcmp1_b32 s62, 5
s_cbranch_scc1 sq_394
buffer_load_dwordx4 v30, s[8:11], s61 offen lds
s_branch sq_395
sq_394:
buffer_load_dwordx4 v31, s[8:11], s61 offen lds
sq_395:
s_add_u32 s62, s62, 4
s_add_u32 s61, s61, 32768
s_add_u32 m0, m0, 1024
s_bitcmp1_b32 s62, 5
s_cbranch_scc1 sq_396
buffer_load_dwordx4 v30, s[8:11], s61 offen lds
s_branch sq_397
sq_396:
buffer_load_dwordx4 v31, s[8:11], s61 offen lds
sq_397:
s_add_u32 s62, s62, 4
s_add_u32 s61, s61, 32768
s_add_u32 m0, m0, 1024
s_bitcmp1_b32 s62, 5
s_cbranch_scc1 sq_398
buffer_load_dwordx4 v30, s[8:11], s61 offen lds
s_branch sq_399
sq_398:
buffer_load_dwordx4 v31, s[8:11], s61 offen lds
sq_399:
s_add_u32 s62, s62, 4
s_add_u32 s61, s61, 32768
s_add_u32 m0, m0, 1024
s_bitcmp1_b32 s62, 5
s_cbranch_scc1 sq_400
buffer_load_dwordx4 v30, s[8:11], s61 offen lds
s_branch sq_401
sq_400:
buffer_load_dwordx4 v31, s[8:11], s61 offen lds
sq_401:
s_add_u32 s62, s62, 4
s_add_u32 s61, s61, 32768
s_add_u32 m0, m0, 1024
s_bitcmp1_b32 s62, 5
s_cbranch_scc1 sq_402
buffer_load_dwordx4 v30, s[8:11], s61 offen lds
s_branch sq_403
sq_402:
buffer_load_dwordx4 v31, s[8:11], s61 offen lds
sq_403:
s_add_u32 s62, s62, 4
s_add_u32 s61, s61, 32768
s_add_u32 m0, m0, 1024
s_bitcmp1_b32 s62, 5
s_cbranch_scc1 sq_404
buffer_load_dwordx4 v30, s[8:11], s61 offen lds
s_branch sq_405
sq_404:
buffer_load_dwordx4 v31, s[8:11], s61 offen lds
sq_405:
s_add_u32 s62, s62, 4
s_add_u32 s61, s61, 32768
s_add_u32 m0, m0, 1024
s_bitcmp1_b32 s62, 5
s_cbranch_scc1 sq_406
buffer_load_dwordx4 v30, s[8:11], s61 offen lds
s_branch sq_407
sq_406:
buffer_load_dwordx4 v31, s[8:11], s61 offen lds
sq_407:
s_add_u32 s62, s62, 4
s_add_u32 s61, s61, 32768
s_add_u32 m0, m0, 1024
s_bitcmp1_b32 s62, 5
s_cbranch_scc1 sq_408
buffer_load_dwordx4 v30, s[8:11], s61 offen lds
s_branch sq_409
sq_408:
buffer_load_dwordx4 v31, s[8:11], s61 offen lds
sq_409:
s_add_u32 s62, s62, 4
s_add_u32 s61, s61, 32768
s_add_u32 m0, m0, 1024
s_bitcmp1_b32 s62, 5
s_cbranch_scc1 sq_410
buffer_load_dwordx4 v30, s[8:11], s61 offen lds
s_branch sq_411
sq_410:
buffer_load_dwordx4 v31, s[8:11], s61 offen lds
sq_411:
s_add_u32 s62, s62, 4
s_add_u32 s61, s61, 32768
s_add_u32 m0, m0, 1024
s_bitcmp1_b32 s62, 5
s_cbranch_scc1 sq_412
buffer_load_dwordx4 v30, s[8:11], s61 offen lds
s_branch sq_413
sq_412:
buffer_load_dwordx4 v31, s[8:11], s61 offen lds
sq_413:
s_add_u32 s62, s62, 4
s_add_u32 s61, s61, 32768
s_add_u32 m0, m0, 1024
s_waitcnt vmcnt(21)
s_barrier
v_lshrrev_b32 v24, 4, v0
v_lshlrev_b32 v24, 3, v24
v_bfe_u32 v25, v0, 2, 2
v_add_u32 v24, v24, v25
v_mul_u32_u24 v24, 1152, v24
v_and_b32 v25, 3, v0
v_lshl_add_u32 v24, v25, 3, v24
s_mul_i32 s60, s3, 288
s_add_u32 s60, s60, 98304
v_add_u32 v28, s60, v24
ds_read_b64_tr_b16 v[112:113], v28 offset:0
ds_read_b64_tr_b16 v[114:115], v28 offset:4608
ds_read_b64_tr_b16 v[128:129], v28 offset:32
ds_read_b64_tr_b16 v[130:131], v28 offset:4640
ds_read_b64_tr_b16 v[144:145], v28 offset:64
ds_read_b64_tr_b16 v[146:147], v28 offset:4672
s_waitcnt lgkmcnt(0)
ds_read_b64_tr_b16 v[160:161], v28 offset:96
ds_read_b64_tr_b16 v[162:163], v28 offset:4704
ds_read_b64_tr_b16 v[176:177], v28 offset:128
ds_read_b64_tr_b16 v[178:179], v28 offset:4736
ds_read_b64_tr_b16 v[192:193], v28 offset:160
ds_read_b64_tr_b16 v[194:195], v28 offset:4768
s_waitcnt lgkmcnt(0)
ds_read_b64_tr_b16 v[208:209], v28 offset:192
ds_read_b64_tr_b16 v[210:211], v28 offset:4800
ds_read_b64_tr_b16 v[224:225], v28 offset:224
ds_read_b64_tr_b16 v[226:227], v28 offset:4832
ds_read_b64_tr_b16 v[240:241], v28 offset:256
ds_read_b64_tr_b16 v[242:243], v28 offset:4864
s_waitcnt lgkmcnt(0)
s_barrier
s_mov_b32 s8, s28
s_and_b32 s9, s29, 0xffff
s_mov_b32 s10, 4718592
s_mov_b32 s11, 0x20000
s_lshl_b32 s61, s51, 8
s_mul_i32 s60, s3, 393216
s_add_u32 s61, s61, s60
s_add_u32 s61, s61, 3145728
s_mul_i32 s60, s3, 12288
s_add_u32 m0, s60, 98304
s_mul_i32 s62, s3, 48
s_bitcmp1_b32 s62, 5
s_cbranch_scc1 sq_414
buffer_load_dwordx4 v30, s[8:11], s61 offen lds
s_branch sq_415
sq_414:
buffer_load_dwordx4 v31, s[8:11], s61 offen lds
sq_415:
s_add_u32 s62, s62, 4
s_add_u32 s61, s61, 32768
s_add_u32 m0, m0, 1024
s_bitcmp1_b32 s62, 5
s_cbranch_scc1 sq_416
buffer_load_dwordx4 v30, s[8:11], s61 offen lds
s_branch sq_417
sq_416:
buffer_load_dwordx4 v31, s[8:11], s61 offen lds
sq_417:
s_add_u32 s62, s62, 4
s_add_u32 s61, s61, 32768
s_add_u32 m0, m0, 1024
s_bitcmp1_b32 s62, 5
s_cbranch_scc1 sq_418
buffer_load_dwordx4 v30, s[8:11], s61 offen lds
s_branch sq_419
sq_418:
buffer_load_dwordx4 v31, s[8:11], s61 offen lds
sq_419:
s_add_u32 s62, s62, 4
s_add_u32 s61, s61, 32768
s_add_u32 m0, m0, 1024
s_bitcmp1_b32 s62, 5
s_cbranch_scc1 sq_420
buffer_load_dwordx4 v30, s[8:11], s61 offen lds
s_branch sq_421
sq_420:
buffer_load_dwordx4 v31, s[8:11], s61 offen lds
sq_421:
s_add_u32 s62, s62, 4
s_add_u32 s61, s61, 32768
s_add_u32 m0, m0, 1024
s_bitcmp1_b32 s62, 5
s_cbranch_scc1 sq_422
buffer_load_dwordx4 v30, s[8:11], s61 offen lds
s_branch sq_423
sq_422:
buffer_load_dwordx4 v31, s[8:11], s61 offen lds
sq_423:
s_add_u32 s62, s62, 4
s_add_u32 s61, s61, 32768
s_add_u32 m0, m0, 1024
s_bitcmp1_b32 s62, 5
s_cbranch_scc1 sq_424
buffer_load_dwordx4 v30, s[8:11], s61 offen lds
s_branch sq_425
sq_424:
buffer_load_dwordx4 v31, s[8:11], s61 offen lds
sq_425:
s_add_u32 s62, s62, 4
s_add_u32 s61, s61, 32768
s_add_u32 m0, m0, 1024
s_bitcmp1_b32 s62, 5
s_cbranch_scc1 sq_426
buffer_load_dwordx4 v30, s[8:11], s61 offen lds
s_branch sq_427
sq_426:
buffer_load_dwordx4 v31, s[8:11], s61 offen lds
sq_427:
s_add_u32 s62, s62, 4
s_add_u32 s61, s61, 32768
s_add_u32 m0, m0, 1024
s_bitcmp1_b32 s62, 5
s_cbranch_scc1 sq_428
buffer_load_dwordx4 v30, s[8:11], s61 offen lds
s_branch sq_429
sq_428:
buffer_load_dwordx4 v31, s[8:11], s61 offen lds
sq_429:
s_add_u32 s62, s62, 4
s_add_u32 s61, s61, 32768
s_add_u32 m0, m0, 1024
s_bitcmp1_b32 s62, 5
s_cbranch_scc1 sq_430
buffer_load_dwordx4 v30, s[8:11], s61 offen lds
s_branch sq_431
sq_430:
buffer_load_dwordx4 v31, s[8:11], s61 offen lds
sq_431:
s_add_u32 s62, s62, 4
s_add_u32 s61, s61, 32768
s_add_u32 m0, m0, 1024
s_bitcmp1_b32 s62, 5
s_cbranch_scc1 sq_432
buffer_load_dwordx4 v30, s[8:11], s61 offen lds
s_branch sq_433
sq_432:
buffer_load_dwordx4 v31, s[8:11], s61 offen lds
sq_433:
s_add_u32 s62, s62, 4
s_add_u32 s61, s61, 32768
s_add_u32 m0, m0, 1024
s_bitcmp1_b32 s62, 5
s_cbranch_scc1 sq_434
buffer_load_dwordx4 v30, s[8:11], s61 offen lds
s_branch sq_435
sq_434:
buffer_load_dwordx4 v31, s[8:11], s61 offen lds
sq_435:
s_add_u32 s62, s62, 4
s_add_u32 s61, s61, 32768
s_add_u32 m0, m0, 1024
s_bitcmp1_b32 s62, 5
s_cbranch_scc1 sq_436
buffer_load_dwordx4 v30, s[8:11], s61 offen lds
s_branch sq_437
sq_436:
buffer_load_dwordx4 v31, s[8:11], s61 offen lds
sq_437:
s_add_u32 s62, s62, 4
s_add_u32 s61, s61, 32768
s_add_u32 m0, m0, 1024
s_waitcnt vmcnt(24)
s_barrier
v_lshrrev_b32 v24, 4, v0
v_lshlrev_b32 v24, 3, v24
v_bfe_u32 v25, v0, 2, 2
v_add_u32 v24, v24, v25
v_mul_u32_u24 v24, 1152, v24
v_and_b32 v25, 3, v0
v_lshl_add_u32 v24, v25, 3, v24
s_mul_i32 s60, s3, 288
s_add_u32 s60, s60, 0
v_add_u32 v28, s60, v24
ds_read_b64_tr_b16 v[116:117], v28 offset:0
ds_read_b64_tr_b16 v[118:119], v28 offset:4608
ds_read_b64_tr_b16 v[132:133], v28 offset:32
ds_read_b64_tr_b16 v[134:135], v28 offset:4640
ds_read_b64_tr_b16 v[148:149], v28 offset:64
ds_read_b64_tr_b16 v[150:151], v28 offset:4672
s_waitcnt lgkmcnt(0)
ds_read_b64_tr_b16 v[164:165], v28 offset:96
ds_read_b64_tr_b16 v[166:167], v28 offset:4704
ds_read_b64_tr_b16 v[180:181], v28 offset:128
ds_read_b64_tr_b16 v[182:183], v28 offset:4736
ds_read_b64_tr_b16 v[196:197], v28 offset:160
ds_read_b64_tr_b16 v[198:199], v28 offset:4768
s_waitcnt lgkmcnt(0)
ds_read_b64_tr_b16 v[212:213], v28 offset:192
ds_read_b64_tr_b16 v[214:215], v28 offset:4800
ds_read_b64_tr_b16 v[228:229], v28 offset:224
ds_read_b64_tr_b16 v[230:231], v28 offset:4832
ds_read_b64_tr_b16 v[244:245], v28 offset:256
ds_read_b64_tr_b16 v[246:247], v28 offset:4864
s_waitcnt lgkmcnt(0)
s_barrier
s_mov_b32 s8, s28
s_and_b32 s9, s29, 0xffff
s_mov_b32 s10, 4718592
s_mov_b32 s11, 0x20000
s_lshl_b32 s61, s51, 8
s_mul_i32 s60, s3, 393216
s_add_u32 s61, s61, s60
s_add_u32 s61, s61, 0
s_mul_i32 s60, s3, 12288
s_add_u32 m0, s60, 0
s_mul_i32 s62, s3, 48
s_bitcmp1_b32 s62, 5
s_cbranch_scc1 sq_438
buffer_load_dwordx4 v30, s[8:11], s61 offen lds
s_branch sq_439
sq_438:
buffer_load_dwordx4 v31, s[8:11], s61 offen lds
sq_439:
s_add_u32 s62, s62, 4
s_add_u32 s61, s61, 32768
s_add_u32 m0, m0, 1024
s_bitcmp1_b32 s62, 5
s_cbranch_scc1 sq_440
buffer_load_dwordx4 v30, s[8:11], s61 offen lds
s_branch sq_441
sq_440:
buffer_load_dwordx4 v31, s[8:11], s61 offen lds
sq_441:
s_add_u32 s62, s62, 4
s_add_u32 s61, s61, 32768
s_add_u32 m0, m0, 1024
s_bitcmp1_b32 s62, 5
s_cbranch_scc1 sq_442
buffer_load_dwordx4 v30, s[8:11], s61 offen lds
s_branch sq_443
sq_442:
buffer_load_dwordx4 v31, s[8:11], s61 offen lds
sq_443:
s_add_u32 s62, s62, 4
s_add_u32 s61, s61, 32768
s_add_u32 m0, m0, 1024
s_bitcmp1_b32 s62, 5
s_cbranch_scc1 sq_444
buffer_load_dwordx4 v30, s[8:11], s61 offen lds
s_branch sq_445
sq_444:
buffer_load_dwordx4 v31, s[8:11], s61 offen lds
sq_445:
s_add_u32 s62, s62, 4
s_add_u32 s61, s61, 32768
s_add_u32 m0, m0, 1024
s_bitcmp1_b32 s62, 5
s_cbranch_scc1 sq_446
buffer_load_dwordx4 v30, s[8:11], s61 offen lds
s_branch sq_447
sq_446:
buffer_load_dwordx4 v31, s[8:11], s61 offen lds
sq_447:
s_add_u32 s62, s62, 4
s_add_u32 s61, s61, 32768
s_add_u32 m0, m0, 1024
s_bitcmp1_b32 s62, 5
s_cbranch_scc1 sq_448
buffer_load_dwordx4 v30, s[8:11], s61 offen lds
s_branch sq_449
sq_448:
buffer_load_dwordx4 v31, s[8:11], s61 offen lds
sq_449:
s_add_u32 s62, s62, 4
s_add_u32 s61, s61, 32768
s_add_u32 m0, m0, 1024
s_bitcmp1_b32 s62, 5
s_cbranch_scc1 sq_450
buffer_load_dwordx4 v30, s[8:11], s61 offen lds
s_branch sq_451
sq_450:
buffer_load_dwordx4 v31, s[8:11], s61 offen lds
sq_451:
s_add_u32 s62, s62, 4
s_add_u32 s61, s61, 32768
s_add_u32 m0, m0, 1024
s_bitcmp1_b32 s62, 5
s_cbranch_scc1 sq_452
buffer_load_dwordx4 v30, s[8:11], s61 offen lds
s_branch sq_453
sq_452:
buffer_load_dwordx4 v31, s[8:11], s61 offen lds
sq_453:
s_add_u32 s62, s62, 4
s_add_u32 s61, s61, 32768
s_add_u32 m0, m0, 1024
s_bitcmp1_b32 s62, 5
s_cbranch_scc1 sq_454
buffer_load_dwordx4 v30, s[8:11], s61 offen lds
s_branch sq_455
sq_454:
buffer_load_dwordx4 v31, s[8:11], s61 offen lds
sq_455:
s_add_u32 s62, s62, 4
s_add_u32 s61, s61, 32768
s_add_u32 m0, m0, 1024
s_bitcmp1_b32 s62, 5
s_cbranch_scc1 sq_456
buffer_load_dwordx4 v30, s[8:11], s61 offen lds
s_branch sq_457
sq_456:
buffer_load_dwordx4 v31, s[8:11], s61 offen lds
sq_457:
s_add_u32 s62, s62, 4
s_add_u32 s61, s61, 32768
s_add_u32 m0, m0, 1024
s_bitcmp1_b32 s62, 5
s_cbranch_scc1 sq_458
buffer_load_dwordx4 v30, s[8:11], s61 offen lds
s_branch sq_459
sq_458:
buffer_load_dwordx4 v31, s[8:11], s61 offen lds
sq_459:
s_add_u32 s62, s62, 4
s_add_u32 s61, s61, 32768
s_add_u32 m0, m0, 1024
s_bitcmp1_b32 s62, 5
s_cbranch_scc1 sq_460
buffer_load_dwordx4 v30, s[8:11], s61 offen lds
s_branch sq_461
sq_460:
buffer_load_dwordx4 v31, s[8:11], s61 offen lds
sq_461:
s_add_u32 s62, s62, 4
s_add_u32 s61, s61, 32768
s_add_u32 m0, m0, 1024
s_waitcnt vmcnt(24)
s_barrier
v_bfe_u32 v24, v0, 4, 1
v_lshrrev_b32 v25, 5, v0
v_bfe_u32 v26, v0, 2, 2
v_lshlrev_b32 v27, 5, v24
v_lshl_add_u32 v27, v25, 3, v27
v_add_u32 v27, v27, v26
v_lshlrev_b32 v27, 8, v27
v_lshl_add_u32 v26, v24, 2, v26
s_lshl_b32 s60, s3, 1
s_add_u32 s60, s60, 0
v_xor_b32 v26, s60, v26
v_lshl_add_u32 v27, v26, 5, v27
v_and_b32 v26, 3, v0
v_lshl_add_u32 v28, v26, 3, v27
v_add_u32 v28, 49152, v28
v_bfe_u32 v24, v0, 4, 1
v_lshrrev_b32 v25, 5, v0
v_bfe_u32 v26, v0, 2, 2
v_lshlrev_b32 v27, 5, v24
v_lshl_add_u32 v27, v25, 3, v27
v_add_u32 v27, v27, v26
v_lshlrev_b32 v27, 8, v27
v_lshl_add_u32 v26, v24, 2, v26
s_lshl_b32 s60, s3, 1
s_add_u32 s60, s60, 1
v_xor_b32 v26, s60, v26
v_lshl_add_u32 v27, v26, 5, v27
v_and_b32 v26, 3, v0
v_lshl_add_u32 v29, v26, 3, v27
v_add_u32 v29, 49152, v29
ds_read_b64_tr_b16 v[32:33], v28 offset:0
ds_read_b64_tr_b16 v[34:35], v28 offset:1024
ds_read_b64_tr_b16 v[36:37], v28 offset:4096
ds_read_b64_tr_b16 v[38:39], v28 offset:5120
ds_read_b64_tr_b16 v[40:41], v29 offset:0
ds_read_b64_tr_b16 v[42:43], v29 offset:1024
ds_read_b64_tr_b16 v[44:45], v29 offset:4096
ds_read_b64_tr_b16 v[46:47], v29 offset:5120
s_waitcnt lgkmcnt(0)
ds_read_b64_tr_b16 v[48:49], v28 offset:16384
ds_read_b64_tr_b16 v[50:51], v28 offset:17408
ds_read_b64_tr_b16 v[52:53], v28 offset:20480
ds_read_b64_tr_b16 v[54:55], v28 offset:21504
ds_read_b64_tr_b16 v[56:57], v29 offset:16384
ds_read_b64_tr_b16 v[58:59], v29 offset:17408
ds_read_b64_tr_b16 v[60:61], v29 offset:20480
ds_read_b64_tr_b16 v[62:63], v29 offset:21504
s_waitcnt lgkmcnt(0)
ds_read_b64_tr_b16 v[64:65], v28 offset:32768
ds_read_b64_tr_b16 v[66:67], v28 offset:33792
ds_read_b64_tr_b16 v[68:69], v28 offset:36864
ds_read_b64_tr_b16 v[70:71], v28 offset:37888
ds_read_b64_tr_b16 v[248:249], v29 offset:32768
ds_read_b64_tr_b16 v[250:251], v29 offset:33792
ds_read_b64_tr_b16 v[252:253], v29 offset:36864
ds_read_b64_tr_b16 v[254:255], v29 offset:37888
s_waitcnt lgkmcnt(0)
s_barrier
s_lshl_b32 s60, s3, 12
s_add_u32 s60, s60, 49152
v_add_u32 v28, s60, v1
ds_write_b128 v28, v[32:35] offset:0
ds_write_b128 v28, v[36:39] offset:1024
ds_write_b128 v28, v[40:43] offset:2048
ds_write_b128 v28, v[44:47] offset:3072
ds_write_b128 v28, v[48:51] offset:16384
ds_write_b128 v28, v[52:55] offset:17408
ds_write_b128 v28, v[56:59] offset:18432
ds_write_b128 v28, v[60:63] offset:19456
ds_write_b128 v28, v[64:67] offset:32768
ds_write_b128 v28, v[68:71] offset:33792
ds_write_b128 v28, v[248:251] offset:34816
ds_write_b128 v28, v[252:255] offset:35840
s_waitcnt lgkmcnt(0)
s_barrier
s_waitcnt vmcnt(0)
s_barrier
v_bfe_u32 v24, v0, 4, 1
v_lshrrev_b32 v25, 5, v0
v_bfe_u32 v26, v0, 2, 2
v_lshlrev_b32 v27, 5, v24
v_lshl_add_u32 v27, v25, 3, v27
v_add_u32 v27, v27, v26
v_lshlrev_b32 v27, 8, v27
v_lshl_add_u32 v26, v24, 2, v26
s_lshl_b32 s60, s3, 1
s_add_u32 s60, s60, 0
v_xor_b32 v26, s60, v26
v_lshl_add_u32 v27, v26, 5, v27
v_and_b32 v26, 3, v0
v_lshl_add_u32 v28, v26, 3, v27
v_bfe_u32 v24, v0, 4, 1
v_lshrrev_b32 v25, 5, v0
v_bfe_u32 v26, v0, 2, 2
v_lshlrev_b32 v27, 5, v24
v_lshl_add_u32 v27, v25, 3, v27
v_add_u32 v27, v27, v26
v_lshlrev_b32 v27, 8, v27
v_lshl_add_u32 v26, v24, 2, v26
s_lshl_b32 s60, s3, 1
s_add_u32 s60, s60, 1
v_xor_b32 v26, s60, v26
v_lshl_add_u32 v27, v26, 5, v27
v_and_b32 v26, 3, v0
v_lshl_add_u32 v29, v26, 3, v27
ds_read_b64_tr_b16 v[32:33], v28 offset:0
ds_read_b64_tr_b16 v[34:35], v28 offset:1024
ds_read_b64_tr_b16 v[36:37], v28 offset:4096
ds_read_b64_tr_b16 v[38:39], v28 offset:5120
ds_read_b64_tr_b16 v[40:41], v29 offset:0
ds_read_b64_tr_b16 v[42:43], v29 offset:1024
ds_read_b64_tr_b16 v[44:45], v29 offset:4096
ds_read_b64_tr_b16 v[46:47], v29 offset:5120
s_waitcnt lgkmcnt(0)
ds_read_b64_tr_b16 v[48:49], v28 offset:16384
ds_read_b64_tr_b16 v[50:51], v28 offset:17408
ds_read_b64_tr_b16 v[52:53], v28 offset:20480
ds_read_b64_tr_b16 v[54:55], v28 offset:21504
ds_read_b64_tr_b16 v[56:57], v29 offset:16384
ds_read_b64_tr_b16 v[58:59], v29 offset:17408
ds_read_b64_tr_b16 v[60:61], v29 offset:20480
ds_read_b64_tr_b16 v[62:63], v29 offset:21504
s_waitcnt lgkmcnt(0)
ds_read_b64_tr_b16 v[64:65], v28 offset:32768
ds_read_b64_tr_b16 v[66:67], v28 offset:33792
ds_read_b64_tr_b16 v[68:69], v28 offset:36864
ds_read_b64_tr_b16 v[70:71], v28 offset:37888
ds_read_b64_tr_b16 v[248:249], v29 offset:32768
ds_read_b64_tr_b16 v[250:251], v29 offset:33792
ds_read_b64_tr_b16 v[252:253], v29 offset:36864
ds_read_b64_tr_b16 v[254:255], v29 offset:37888
s_waitcnt lgkmcnt(0)
s_barrier
s_lshl_b32 s60, s3, 12
s_add_u32 s60, s60, 0
v_add_u32 v28, s60, v1
ds_write_b128 v28, v[32:35] offset:0
ds_write_b128 v28, v[36:39] offset:1024
ds_write_b128 v28, v[40:43] offset:2048
ds_write_b128 v28, v[44:47] offset:3072
ds_write_b128 v28, v[48:51] offset:16384
ds_write_b128 v28, v[52:55] offset:17408
ds_write_b128 v28, v[56:59] offset:18432
ds_write_b128 v28, v[60:63] offset:19456
ds_write_b128 v28, v[64:67] offset:32768
ds_write_b128 v28, v[68:71] offset:33792
ds_write_b128 v28, v[248:251] offset:34816
ds_write_b128 v28, v[252:255] offset:35840
s_waitcnt lgkmcnt(0)
s_barrier
s_waitcnt vmcnt(12)
s_barrier
v_bfe_u32 v24, v0, 4, 1
v_lshrrev_b32 v25, 5, v0
v_bfe_u32 v26, v0, 2, 2
v_lshlrev_b32 v27, 5, v24
v_lshl_add_u32 v27, v25, 3, v27
v_add_u32 v27, v27, v26
v_lshlrev_b32 v27, 8, v27
v_lshl_add_u32 v26, v24, 2, v26
s_lshl_b32 s60, s3, 1
s_add_u32 s60, s60, 0
v_xor_b32 v26, s60, v26
v_lshl_add_u32 v27, v26, 5, v27
v_and_b32 v26, 3, v0
v_lshl_add_u32 v28, v26, 3, v27
v_add_u32 v28, 98304, v28
v_bfe_u32 v24, v0, 4, 1
v_lshrrev_b32 v25, 5, v0
v_bfe_u32 v26, v0, 2, 2
v_lshlrev_b32 v27, 5, v24
v_lshl_add_u32 v27, v25, 3, v27
v_add_u32 v27, v27, v26
v_lshlrev_b32 v27, 8, v27
v_lshl_add_u32 v26, v24, 2, v26
s_lshl_b32 s60, s3, 1
s_add_u32 s60, s60, 1
v_xor_b32 v26, s60, v26
v_lshl_add_u32 v27, v26, 5, v27
v_and_b32 v26, 3, v0
v_lshl_add_u32 v29, v26, 3, v27
v_add_u32 v29, 98304, v29
ds_read_b64_tr_b16 v[32:33], v28 offset:0
ds_read_b64_tr_b16 v[34:35], v28 offset:1024
ds_read_b64_tr_b16 v[36:37], v28 offset:4096
ds_read_b64_tr_b16 v[38:39], v28 offset:5120
ds_read_b64_tr_b16 v[40:41], v29 offset:0
ds_read_b64_tr_b16 v[42:43], v29 offset:1024
ds_read_b64_tr_b16 v[44:45], v29 offset:4096
ds_read_b64_tr_b16 v[46:47], v29 offset:5120
s_waitcnt lgkmcnt(0)
ds_read_b64_tr_b16 v[48:49], v28 offset:16384
ds_read_b64_tr_b16 v[50:51], v28 offset:17408
ds_read_b64_tr_b16 v[52:53], v28 offset:20480
ds_read_b64_tr_b16 v[54:55], v28 offset:21504
ds_read_b64_tr_b16 v[56:57], v29 offset:16384
ds_read_b64_tr_b16 v[58:59], v29 offset:17408
ds_read_b64_tr_b16 v[60:61], v29 offset:20480
ds_read_b64_tr_b16 v[62:63], v29 offset:21504
s_waitcnt lgkmcnt(0)
ds_read_b64_tr_b16 v[64:65], v28 offset:32768
ds_read_b64_tr_b16 v[66:67], v28 offset:33792
ds_read_b64_tr_b16 v[68:69], v28 offset:36864
ds_read_b64_tr_b16 v[70:71], v28 offset:37888
ds_read_b64_tr_b16 v[248:249], v29 offset:32768
ds_read_b64_tr_b16 v[250:251], v29 offset:33792
ds_read_b64_tr_b16 v[252:253], v29 offset:36864
ds_read_b64_tr_b16 v[254:255], v29 offset:37888
s_waitcnt lgkmcnt(0)
s_barrier
s_lshl_b32 s60, s3, 12
s_add_u32 s60, s60, 98304
v_add_u32 v28, s60, v1
ds_write_b128 v28, v[32:35] offset:0
ds_write_b128 v28, v[36:39] offset:1024
ds_write_b128 v28, v[40:43] offset:2048
ds_write_b128 v28, v[44:47] offset:3072
ds_write_b128 v28, v[48:51] offset:16384
ds_write_b128 v28, v[52:55] offset:17408
ds_write_b128 v28, v[56:59] offset:18432
ds_write_b128 v28, v[60:63] offset:19456
s_lshl_b32 s60, s3, 11
s_add_u32 s60, s60, 131072
v_add_u32 v29, s60, v1
ds_write_b128 v29, v[64:67] offset:0
ds_write_b128 v29, v[68:71] offset:1024
s_waitcnt lgkmcnt(0)
s_barrier
s_lshl_b32 s60, s3, 6
v_add_u32 v24, s60, v0
v_lshlrev_b32 v25, 2, v24
v_add_u32 v25, 139264, v25
ds_write_b32 v25, v16 offset:0
ds_write_b32 v25, v17 offset:1024
ds_write_b32 v25, v18 offset:2048
ds_write_b32 v25, v19 offset:3072
ds_write_b32 v25, v20 offset:4096
ds_write_b32 v25, v21 offset:5120
ds_write_b32 v25, v22 offset:6144
ds_write_b32 v25, v23 offset:7168
ds_write_b32 v25, v14 offset:8192
s_waitcnt lgkmcnt(0)
s_mov_b32 s67, 0
v_mov_b32 v25, s57
cbp_462:
buffer_load_dword v24, v25, s[12:15], 0 offen sc1
s_add_u32 s67, s67, 1
s_cmp_gt_u32 s67, 400000
s_cbranch_scc1 chain_fail_242
s_waitcnt vmcnt(0)
v_readfirstlane_b32 s61, v24
s_nop 0
s_and_b32 s60, s61, 0xffff
s_cmp_lt_u32 s60, 32
s_cbranch_scc1 cbp_462
s_lshr_b32 s47, s61, 16
s_mov_b32 s12, s40
s_and_b32 s13, s41, 0xffff
s_mov_b32 s14, 256
s_mov_b32 s15, 0x20000
v_lshlrev_b32 v24, 2, v0
v_add_u32 v25, 128, v24
v_cmp_le_u32 vcc, 2, v0
s_nop 1
v_cndmask_b32 v24, v24, v25, vcc
v_mov_b32 v25, 192
v_cmp_eq_u32 vcc, 8, v0
s_nop 1
v_cndmask_b32 v24, v24, v25, vcc
v_mov_b32 v25, 2147483632
v_cmp_lt_u32 vcc, 8, v0
s_nop 1
v_cndmask_b32 v24, v24, v25, vcc
s_mov_b32 s98, 0
wi_loop_463:
buffer_load_dword v25, v24, s[12:15], 0 offen sc1
s_add_u32 s98, s98, 1
s_cmp_gt_u32 s98, 150000
s_cbranch_scc1 wi_bad_465
s_waitcnt vmcnt(0)
v_cmp_eq_u32 vcc, 32, v25
s_nop 0
s_and_b32 s97, vcc_lo, 0x1ff
s_cmp_eq_u32 s97, 0x1ff
s_cbranch_scc1 wi_ok_464
v_cmp_lt_u32 vcc, 32, v25
s_nop 0
s_and_b32 s96, vcc_lo, 0xff
s_cselect_b32 s96, 0x100, 0
s_and_b32 s96, s96, s97
s_cbranch_scc1 wi_over_466
s_sleep 8
s_branch wi_loop_463
wi_bad_465:
s_mov_b32 s98, 512
s_branch L_fail
wi_over_466:
s_mov_b32 s100, 255
wi_ok_464:
s_mov_b32 s98, 0xff800000
s_mov_b32 s99, 0xff800000
s_cmp_lg_u32 s47, 0
s_cbranch_scc1 chain_foreign_467
s_mov_b32 s62, 0
s_lshl_b32 s65, s3, 11
s_add_u32 s65, s65, 16384
s_mul_i32 s63, s51, 24576
s_add_u32 s63, s63, s53
s_mul_i32 s77, s51, 4096
s_add_u32 s77, s77, s54
v_mov_b64 v[48:49], 0
v_mov_b64 v[50:51], 0
v_mov_b64 v[52:53], 0
v_mov_b64 v[54:55], 0
v_mov_b64 v[56:57], 0
v_mov_b64 v[58:59], 0
v_mov_b64 v[60:61], 0
v_mov_b64 v[62:63], 0
v_mov_b64 v[64:65], 0
v_mov_b64 v[66:67], 0
v_mov_b64 v[68:69], 0
v_mov_b64 v[70:71], 0
s_lshl_b32 s60, s3, 12
v_add_u32 v15, s60, v1
s_lshl_b32 s60, s3, 11
s_add_u32 s60, s60, 131072
v_add_u32 v14, s60, v1
s_cmp_lg_u32 s3, 3
s_cbranch_scc1 kx0_468
s_add_u32 s61, s62, 1
s_mov_b32 s67, 0
sp_loop_469:
buffer_load_dword v32, v7, s[4:7], s58 offen sc1
s_add_u32 s67, s67, 1
s_cmp_gt_u32 s67, 150000
s_cbranch_scc1 sp_bad_471
s_waitcnt vmcnt(0)
v_cmp_gt_u32 vcc, s61, v32
s_nop 0
s_and_b32 vcc_lo, vcc_lo, 15
s_cbranch_scc0 sp_ok_470
s_sleep 1
s_branch sp_loop_469
sp_bad_471:
s_mov_b32 s98, 1792
s_branch L_fail
sp_ok_470:
kx0_468:
s_barrier
chain_loop_472:
ds_read_b64_tr_b16 v[24:25], v2 offset:0
ds_read_b64_tr_b16 v[26:27], v2 offset:512
ds_read_b128 v[32:35], v15 offset:0
ds_read_b128 v[36:39], v15 offset:1024
ds_read_b64_tr_b16 v[28:29], v2 offset:1024
ds_read_b64_tr_b16 v[30:31], v2 offset:1536
s_sub_u32 s60, s65, 8192
s_add_u32 m0, s60, 146432
s_add_u32 s60, s60, s63
v_lshlrev_b32 v13, 5, v0
s_add_u32 s61, s63, s65
buffer_load_dwordx4 v1, s[4:7], s60 offen offset:0 sc1 lds
buffer_load_dwordx4 v1, s[4:7], s60 offen offset:1024 sc1 lds
buffer_load_dword v13, v13, s[4:7], s61 offen sc1
v_mov_b32 v42, s62
buffer_store_dword v42, v8, s[4:7], s58 offen sc1
s_waitcnt lgkmcnt(4)
v_smfmac_f32_16x16x64_bf16 v[48:51], v[24:27], a[0:7], v3
ds_read_b128 v[40:43], v15 offset:2048
v_smfmac_f32_16x16x64_bf16 v[52:55], v[24:27], a[72:79], v3
ds_read_b128 v[44:47], v15 offset:3072
v_smfmac_f32_16x16x64_bf16 v[56:59], v[24:27], a[144:151], v3
ds_read_b128 v[16:19], v15 offset:16384
v_smfmac_f32_16x16x64_bf16 v[60:63], v[24:27], a[216:223], v3
ds_read_b128 v[20:23], v15 offset:17408
s_waitcnt lgkmcnt(6)
v_smfmac_f32_16x16x64_bf16 v[64:67], v[24:27], v[32:39], v3
ds_read_b128 v[32:35], v15 offset:18432
s_waitcnt lgkmcnt(3)
v_smfmac_f32_16x16x64_bf16 v[68:71], v[24:27], v[40:47], v3
ds_read_b128 v[36:39], v15 offset:19456
v_smfmac_f32_16x16x64_bf16 v[48:51], v[28:31], a[8:15], v3
ds_read_b64_tr_b16 v[24:25], v2 offset:2048
v_smfmac_f32_16x16x64_bf16 v[52:55], v[28:31], a[80:87], v3
ds_read_b64_tr_b16 v[26:27], v2 offset:2560
v_smfmac_f32_16x16x64_bf16 v[56:59], v[28:31], a[152:159], v3
ds_read_b128 v[40:43], v15 offset:32768
v_smfmac_f32_16x16x64_bf16 v[60:63], v[28:31], a[224:231], v3
ds_read_b128 v[44:47], v15 offset:33792
s_waitcnt lgkmcnt(6)
v_smfmac_f32_16x16x64_bf16 v[64:67], v[28:31], v[16:23], v3
ds_read_b128 v[16:19], v15 offset:34816
s_waitcnt lgkmcnt(5)
v_smfmac_f32_16x16x64_bf16 v[68:71], v[28:31], v[32:39], v3
ds_read_b128 v[20:23], v15 offset:35840
s_waitcnt lgkmcnt(4)
v_smfmac_f32_16x16x64_bf16 v[48:51], v[24:27], a[16:23], v3
ds_read_b64_tr_b16 v[28:29], v2 offset:3072
v_smfmac_f32_16x16x64_bf16 v[52:55], v[24:27], a[88:95], v3
ds_read_b64_tr_b16 v[30:31], v2 offset:3584
v_smfmac_f32_16x16x64_bf16 v[56:59], v[24:27], a[160:167], v3
ds_read_b128 v[32:35], v15 offset:49152
v_smfmac_f32_16x16x64_bf16 v[60:63], v[24:27], a[232:239], v3
ds_read_b128 v[36:39], v15 offset:50176
s_waitcnt lgkmcnt(6)
v_smfmac_f32_16x16x64_bf16 v[64:67], v[24:27], v[40:47], v3
ds_read_b128 v[40:43], v15 offset:51200
s_waitcnt lgkmcnt(5)
v_smfmac_f32_16x16x64_bf16 v[68:71], v[24:27], v[16:23], v3
ds_read_b128 v[44:47], v15 offset:52224
s_waitcnt lgkmcnt(4)
v_smfmac_f32_16x16x64_bf16 v[48:51], v[28:31], a[24:31], v3
ds_read_b64_tr_b16 v[24:25], v2 offset:4096
v_smfmac_f32_16x16x64_bf16 v[52:55], v[28:31], a[96:103], v3
ds_read_b64_tr_b16 v[26:27], v2 offset:4608
v_smfmac_f32_16x16x64_bf16 v[56:59], v[28:31], a[168:175], v3
v_add_u32 v15, 65536, v15
ds_read_b128 v[16:19], v15 offset:0
v_smfmac_f32_16x16x64_bf16 v[60:63], v[28:31], a[240:247], v3
ds_read_b128 v[20:23], v15 offset:1024
s_waitcnt lgkmcnt(6)
v_smfmac_f32_16x16x64_bf16 v[64:67], v[28:31], v[32:39], v3
ds_read_b128 v[32:35], v15 offset:2048
s_waitcnt lgkmcnt(5)
v_smfmac_f32_16x16x64_bf16 v[68:71], v[28:31], v[40:47], v3
ds_read_b128 v[36:39], v15 offset:3072
s_waitcnt lgkmcnt(4)
v_smfmac_f32_16x16x64_bf16 v[48:51], v[24:27], a[32:39], v3
ds_read_b64_tr_b16 v[28:29], v2 offset:5120
v_smfmac_f32_16x16x64_bf16 v[52:55], v[24:27], a[104:111], v3
ds_read_b64_tr_b16 v[30:31], v2 offset:5632
v_smfmac_f32_16x16x64_bf16 v[56:59], v[24:27], a[176:183], v3
ds_read_b128 v[40:43], v15 offset:16384
v_smfmac_f32_16x16x64_bf16 v[60:63], v[24:27], a[248:255], v3
ds_read_b128 v[44:47], v15 offset:17408
s_waitcnt lgkmcnt(6)
v_smfmac_f32_16x16x64_bf16 v[64:67], v[24:27], v[16:23], v3
ds_read_b128 v[16:19], v15 offset:18432
s_waitcnt lgkmcnt(5)
v_smfmac_f32_16x16x64_bf16 v[68:71], v[24:27], v[32:39], v3
ds_read_b128 v[20:23], v15 offset:19456
s_waitcnt lgkmcnt(4)
v_smfmac_f32_16x16x64_bf16 v[48:51], v[28:31], a[40:47], v3
ds_read_b64_tr_b16 v[24:25], v2 offset:6144
v_smfmac_f32_16x16x64_bf16 v[52:55], v[28:31], a[112:119], v3
ds_read_b64_tr_b16 v[26:27], v2 offset:6656
v_smfmac_f32_16x16x64_bf16 v[56:59], v[28:31], a[184:191], v3
ds_read_b128 v[32:35], v15 offset:32768
v_smfmac_f32_16x16x64_bf16 v[60:63], v[28:31], v[72:79], v3
ds_read_b128 v[36:39], v15 offset:33792
s_waitcnt lgkmcnt(6)
v_smfmac_f32_16x16x64_bf16 v[64:67], v[28:31], v[40:47], v3
ds_read_b128 v[40:43], v15 offset:34816
s_waitcnt lgkmcnt(5)
v_smfmac_f32_16x16x64_bf16 v[68:71], v[28:31], v[16:23], v3
ds_read_b128 v[44:47], v15 offset:35840
s_waitcnt lgkmcnt(4)
v_smfmac_f32_16x16x64_bf16 v[48:51], v[24:27], a[48:55], v3
ds_read_b64_tr_b16 v[28:29], v2 offset:7168
v_smfmac_f32_16x16x64_bf16 v[52:55], v[24:27], a[120:127], v3
ds_read_b64_tr_b16 v[30:31], v2 offset:7680
v_smfmac_f32_16x16x64_bf16 v[56:59], v[24:27], a[192:199], v3
ds_read_b128 v[16:19], v15 offset:49152
v_smfmac_f32_16x16x64_bf16 v[60:63], v[24:27], v[80:87], v3
ds_read_b128 v[20:23], v15 offset:50176
s_waitcnt lgkmcnt(6)
v_smfmac_f32_16x16x64_bf16 v[64:67], v[24:27], v[32:39], v3
ds_read_b128 v[32:35], v15 offset:51200
s_waitcnt lgkmcnt(5)
v_smfmac_f32_16x16x64_bf16 v[68:71], v[24:27], v[40:47], v3
ds_read_b128 v[36:39], v15 offset:52224
s_waitcnt lgkmcnt(4)
v_smfmac_f32_16x16x64_bf16 v[48:51], v[28:31], a[56:63], v3
ds_read_b64_tr_b16 v[24:25], v2 offset:8192
v_smfmac_f32_16x16x64_bf16 v[52:55], v[28:31], a[128:135], v3
ds_read_b64_tr_b16 v[26:27], v2 offset:8704
v_smfmac_f32_16x16x64_bf16 v[56:59], v[28:31], a[200:207], v3
ds_read_b128 v[40:43], v14 offset:0
v_smfmac_f32_16x16x64_bf16 v[60:63], v[28:31], v[88:95], v3
ds_read_b128 v[44:47], v14 offset:1024
s_waitcnt lgkmcnt(6)
v_smfmac_f32_16x16x64_bf16 v[64:67], v[28:31], v[16:23], v3
v_add_u32 v15, 152576, v1
s_waitcnt lgkmcnt(4)
v_smfmac_f32_16x16x64_bf16 v[68:71], v[28:31], v[32:39], v3
s_waitcnt lgkmcnt(2)
v_smfmac_f32_16x16x64_bf16 v[48:51], v[24:27], a[64:71], v3
v_smfmac_f32_16x16x64_bf16 v[52:55], v[24:27], a[136:143], v3
v_smfmac_f32_16x16x64_bf16 v[56:59], v[24:27], a[208:215], v3
v_smfmac_f32_16x16x64_bf16 v[60:63], v[24:27], v[96:103], v3
s_waitcnt lgkmcnt(0)
v_smfmac_f32_16x16x64_bf16 v[64:67], v[24:27], v[40:47], v3
v_smfmac_f32_16x16x64_bf16 v[68:71], v[24:27], v[248:255], v3
s_nop 3
v_add_f32 v56, v56, v57
v_add_f32 v58, v58, v59
v_add_f32 v48, v48, v49
v_add_f32 v50, v50, v51
v_cvt_pk_bf16_f32 v24, v56, v58
v_cvt_pk_bf16_f32 v25, v48, v50
ds_write_b64 v4, v[24:25] offset:0
v_add_f32 v60, v60, v61
v_add_f32 v62, v62, v63
v_add_f32 v52, v52, v53
v_add_f32 v54, v54, v55
v_cvt_pk_bf16_f32 v26, v60, v62
v_cvt_pk_bf16_f32 v27, v52, v54
ds_write_b64 v4, v[26:27] offset:512
v_add_f32 v64, v64, v65
v_add_f32 v66, v66, v67
v_cvt_pk_bf16_f32 v28, v64, v66
v_add_f32 v68, v68, v69
v_add_f32 v70, v70, v71
v_cvt_pk_bf16_f32 v29, v68, v70
s_add_u32 s61, s63, s65
buffer_load_dwordx4 v[16:19], v1, s[4:7], s61 offen sc1
buffer_load_dwordx4 v[20:23], v1, s[4:7], s61 offen offset:1024 sc1
s_waitcnt vmcnt(3) lgkmcnt(0)
s_barrier
ds_read_b64_tr_b16 v[48:49], v5 offset:0
ds_read_b64_tr_b16 v[50:51], v5 offset:256
ds_read_b128 v[32:35], v15 offset:2048
ds_read_b128 v[36:39], v15 offset:3072
ds_read_b64_tr_b16 v[52:53], v5 offset:1024
ds_read_b64_tr_b16 v[54:55], v5 offset:1280
ds_read_b128 v[40:43], v15 offset:4096
ds_read_b128 v[44:47], v15 offset:5120
ds_read_b64_tr_b16 v[64:65], v5 offset:2048
ds_read_b64_tr_b16 v[66:67], v5 offset:2304
ds_read_b64_tr_b16 v[68:69], v5 offset:3072
ds_read_b64_tr_b16 v[70:71], v5 offset:3328
s_add_u32 s61, s77, s78
buffer_store_dwordx2 v[28:29], v2, s[4:7], s61 offen sc1
v_mov_b64 v[24:25], 0
v_mov_b64 v[26:27], s[98:99]
s_waitcnt lgkmcnt(10)
s_nop 0
v_mfma_f32_16x16x32_bf16 v[24:27], v[48:51], v[48:51], v[24:27]
s_waitcnt lgkmcnt(8)
v_mfma_f32_16x16x32_bf16 v[56:59], v[32:35], v[48:51], 0
v_mfma_f32_16x16x32_bf16 v[60:63], v[36:39], v[48:51], 0
ds_read_b128 v[32:35], v15 offset:6144
ds_read_b128 v[36:39], v15 offset:7168
s_waitcnt lgkmcnt(8)
v_mfma_f32_16x16x32_bf16 v[24:27], v[52:55], v[52:55], v[24:27]
s_waitcnt lgkmcnt(6)
v_mfma_f32_16x16x32_bf16 v[56:59], v[40:43], v[52:55], v[56:59]
v_mfma_f32_16x16x32_bf16 v[60:63], v[44:47], v[52:55], v[60:63]
ds_read_b128 v[40:43], v15 offset:8192
ds_read_b128 v[44:47], v15 offset:9216
s_waitcnt lgkmcnt(6)
v_mfma_f32_16x16x32_bf16 v[24:27], v[64:67], v[64:67], v[24:27]
s_waitcnt lgkmcnt(2)
v_mfma_f32_16x16x32_bf16 v[56:59], v[32:35], v[64:67], v[56:59]
v_mfma_f32_16x16x32_bf16 v[60:63], v[36:39], v[64:67], v[60:63]
v_mfma_f32_16x16x32_bf16 v[24:27], v[68:71], v[68:71], v[24:27]
s_waitcnt lgkmcnt(0)
v_mfma_f32_16x16x32_bf16 v[56:59], v[40:43], v[68:71], v[56:59]
v_mfma_f32_16x16x32_bf16 v[60:63], v[44:47], v[68:71], v[60:63]
s_mov_b32 exec_lo, 0x33333333
s_mov_b32 exec_hi, 0x33333333
s_cmp_ge_u32 s3, 2
s_cbranch_scc1 km23_474
s_bitcmp1_b32 s3, 0
s_cbranch_scc1 km_475
buffer_store_dwordx4 v[48:51], v12, s[4:7], s77 offen offset:0 sc1
s_branch kmd_473
km_475:
buffer_store_dwordx4 v[52:55], v12, s[4:7], s77 offen offset:512 sc1
s_branch kmd_473
km23_474:
s_bitcmp1_b32 s3, 0
s_cbranch_scc1 km_476
buffer_store_dwordx4 v[64:67], v12, s[4:7], s77 offen offset:1024 sc1
s_branch kmd_473
km_476:
buffer_store_dwordx4 v[68:71], v12, s[4:7], s77 offen offset:1536 sc1
kmd_473:
s_mov_b64 exec, -1
s_cmp_eq_u32 s62, 63
s_cbranch_scc1 chain_done_243
v_mov_b32 v36, 0x3f803f80
v_mov_b32 v37, 0x3f803f80
v_mov_b32 v45, 0
v_mov_b32 v46, 0
v_mov_b64 v[38:39], v[36:37]
v_max3_f32 v32, v24, v25, v56
v_max3_f32 v32, v32, v57, v58
v_max3_f32 v32, v32, v59, v60
v_max3_f32 v32, v32, v61, v62
v_max_f32 v32, v32, v63
v_mov_b32 v33, v32
s_add_u32 s63, s63, 786432
s_add_u32 s62, s62, 1
v_permlane16_swap_b32 v33, v32
v_max_f32 v32, v32, v33
v_mov_b32 v33, v32
s_and_b32 s64, s62, 1
s_nop 0
v_permlane32_swap_b32 v33, v32
v_max_f32 v32, v32, v33
v_mul_f32 v32, s66, v32
v_pk_fma_f32 v[24:25], v[24:25], s[66:67], v[32:33] op_sel_hi:[1,0,0] neg_lo:[0,0,1] neg_hi:[0,0,1]
v_pk_fma_f32 v[56:57], v[56:57], s[66:67], v[32:33] op_sel_hi:[1,0,0] neg_lo:[0,0,1] neg_hi:[0,0,1]
v_pk_fma_f32 v[58:59], v[58:59], s[66:67], v[32:33] op_sel_hi:[1,0,0] neg_lo:[0,0,1] neg_hi:[0,0,1]
v_pk_fma_f32 v[60:61], v[60:61], s[66:67], v[32:33] op_sel_hi:[1,0,0] neg_lo:[0,0,1] neg_hi:[0,0,1]
v_pk_fma_f32 v[62:63], v[62:63], s[66:67], v[32:33] op_sel_hi:[1,0,0] neg_lo:[0,0,1] neg_hi:[0,0,1]
v_exp_f32 v24, v24
v_exp_f32 v25, v25
v_exp_f32 v56, v56
v_exp_f32 v57, v57
v_cvt_pk_bf16_f32 v44, v24, v25
v_cvt_pk_bf16_f32 v47, v24, v25
v_exp_f32 v58, v58
v_exp_f32 v59, v59
v_mfma_f32_16x16x16_bf16 v[48:51], v[36:37], v[44:45], 0
v_exp_f32 v60, v60
v_mfma_f32_16x16x16_bf16 v[68:71], v[28:29], v[46:47], 0
v_exp_f32 v61, v61
v_mfma_f32_16x16x16_bf16 v[64:67], v[28:29], v[44:45], 0
v_exp_f32 v62, v62
v_exp_f32 v63, v63
v_cvt_pk_bf16_f32 v40, v56, v57
v_cvt_pk_bf16_f32 v41, v58, v59
v_cvt_pk_bf16_f32 v42, v60, v61
v_cvt_pk_bf16_f32 v43, v62, v63
s_waitcnt vmcnt(2)
s_nop 0
v_mfma_f32_16x16x32_bf16 v[48:51], v[36:39], v[40:43], v[48:51]
v_mfma_f32_16x16x32_bf16 v[68:71], v[20:23], v[40:43], v[68:71]
v_mfma_f32_16x16x32_bf16 v[64:67], v[16:19], v[40:43], v[64:67]
v_mov_b32 v13, s64
v_mov_b64 v[24:25], 0
v_mov_b64 v[26:27], 0
v_mov_b64 v[56:57], 0
v_mov_b64 v[58:59], 0
v_mov_b64 v[60:61], 0
v_mov_b64 v[62:63], 0
v_rcp_f32 v52, v48
s_nop 0
v_pk_mul_f32 v[68:69], v[68:69], v[52:53] op_sel_hi:[1,0]
v_pk_mul_f32 v[70:71], v[70:71], v[52:53] op_sel_hi:[1,0]
s_nop 0
v_cvt_pk_bf16_f32 v50, v68, v70
v_cvt_pk_bf16_f32 v51, v69, v71
v_pk_mul_f32 v[64:65], v[64:65], v[52:53] op_sel_hi:[1,0]
v_pk_mul_f32 v[66:67], v[66:67], v[52:53] op_sel_hi:[1,0]
s_mov_b32 exec_lo, 0xcccccccc
s_mov_b32 exec_hi, 0xcccccccc
ds_write_b32 v6, v50 offset:256
ds_write_b32 v6, v51 offset:272
s_mov_b64 exec, -1
v_cvt_pk_bf16_f32 v48, v64, v66
v_cvt_pk_bf16_f32 v49, v65, v67
s_mov_b32 exec_lo, 0xcccccccc
s_mov_b32 exec_hi, 0xcccccccc
ds_write_b32 v6, v48
ds_write_b32 v6, v49 offset:16
s_mov_b64 exec, -1
v_mov_b64 v[32:33], 0
v_mov_b64 v[34:35], 0
v_mov_b64 v[36:37], 0
v_mov_b64 v[38:39], 0
v_mov_b64 v[40:41], 0
v_mov_b64 v[42:43], 0
v_mov_b64 v[44:45], 0
v_mov_b64 v[46:47], 0
v_add_u32 v20, 152576, v1
s_waitcnt lgkmcnt(0)
s_barrier
ds_read_b128 v[48:51], v20 offset:0
ds_read_b128 v[52:55], v20 offset:1024
v_mov_b64 v[64:65], 0
v_mov_b64 v[66:67], 0
v_mov_b64 v[68:69], 0
v_mov_b64 v[70:71], 0
buffer_load_dword v23, v7, s[4:7], s58 offen sc1
s_add_u32 s45, s74, 32768
s_waitcnt lgkmcnt(0)
v_smfmac_f32_16x16x64_bf16 v[24:27], v[48:51], v[232:239], v3
v_smfmac_f32_16x16x64_bf16 v[24:27], v[52:55], v[240:247], v3
v_smfmac_f32_16x16x64_bf16 v[32:35], v[48:51], v[104:111], v3
v_smfmac_f32_16x16x64_bf16 v[36:39], v[48:51], v[120:127], v3
v_smfmac_f32_16x16x64_bf16 v[40:43], v[48:51], v[136:143], v3
v_smfmac_f32_16x16x64_bf16 v[44:47], v[48:51], v[152:159], v3
s_nop 3
v_add_f32 v24, v24, v25
v_add_f32 v26, v26, v27
v_smfmac_f32_16x16x64_bf16 v[32:35], v[52:55], v[112:119], v3
v_cvt_pk_bf16_f32 v24, v24, v26
v_smfmac_f32_16x16x64_bf16 v[36:39], v[52:55], v[128:135], v3
s_nop 0
v_permlane32_swap_b32 v24, v26
v_smfmac_f32_16x16x64_bf16 v[40:43], v[52:55], v[144:151], v3
s_nop 0
v_permlane16_swap_b32 v24, v25
v_permlane16_swap_b32 v26, v27
v_smfmac_f32_16x16x64_bf16 v[44:47], v[52:55], v[160:167], v3
v_and_or_b32 v24, v24, s70, v13
v_smfmac_f32_16x16x64_bf16 v[56:59], v[48:51], v[168:175], v3
s_mov_b64 exec, 0xffff
buffer_store_dwordx4 v[24:27], v9, s[4:7], s49 offen
s_mov_b64 exec, -1
v_smfmac_f32_16x16x64_bf16 v[60:63], v[48:51], v[184:191], v3
v_add_f32 v32, v32, v33
v_add_f32 v34, v34, v35
v_smfmac_f32_16x16x64_bf16 v[64:67], v[48:51], v[200:207], v3
v_cvt_pk_bf16_f32 v28, v32, v34
v_add_f32 v36, v36, v37
v_smfmac_f32_16x16x64_bf16 v[68:71], v[48:51], v[216:223], v3
v_add_f32 v38, v38, v39
v_cvt_pk_bf16_f32 v29, v36, v38
v_smfmac_f32_16x16x64_bf16 v[56:59], v[52:55], v[176:183], v3
v_add_f32 v40, v40, v41
v_add_f32 v42, v42, v43
v_smfmac_f32_16x16x64_bf16 v[60:63], v[52:55], v[192:199], v3
v_cvt_pk_bf16_f32 v30, v40, v42
v_add_f32 v44, v44, v45
v_smfmac_f32_16x16x64_bf16 v[64:67], v[52:55], v[208:215], v3
v_add_f32 v46, v46, v47
v_cvt_pk_bf16_f32 v31, v44, v46
v_smfmac_f32_16x16x64_bf16 v[68:71], v[52:55], v[224:231], v3
v_and_or_b32 v28, v28, s70, v13
buffer_store_dwordx4 v[28:31], v9, s[4:7], s74 offen
v_add_f32 v56, v56, v57
v_add_f32 v58, v58, v59
v_cvt_pk_bf16_f32 v32, v56, v58
v_add_f32 v60, v60, v61
v_add_f32 v62, v62, v63
v_cvt_pk_bf16_f32 v33, v60, v62
v_add_f32 v64, v64, v65
v_add_f32 v66, v66, v67
v_cvt_pk_bf16_f32 v34, v64, v66
v_add_f32 v68, v68, v69
v_add_f32 v70, v70, v71
v_cvt_pk_bf16_f32 v35, v68, v70
v_and_or_b32 v32, v32, s70, v13
buffer_store_dwordx4 v[32:35], v9, s[4:7], s45 offen
s_add_u32 s77, s77, 131072
v_mov_b64 v[48:49], 0
v_mov_b64 v[50:51], 0
v_mov_b64 v[52:53], 0
v_mov_b64 v[54:55], 0
v_mov_b64 v[56:57], 0
v_mov_b64 v[58:59], 0
v_mov_b64 v[60:61], 0
v_mov_b64 v[62:63], 0
v_mov_b64 v[64:65], 0
v_mov_b64 v[66:67], 0
v_mov_b64 v[68:69], 0
v_mov_b64 v[70:71], 0
s_lshl_b32 s60, s3, 12
v_add_u32 v15, s60, v1
s_cmp_eq_u32 s48, 0
s_cbranch_scc1 noown_477
v_and_b32 v20, 15, v0
v_and_b32 v21, 1, v0
v_lshlrev_b32 v21, 4, v21
v_mov_b32 v22, 0x3f80
v_lshlrev_b32 v21, v21, v22
v_lshrrev_b32 v22, 1, v20
v_cmp_eq_u32 vcc, 0, v22
s_nop 1
v_cndmask_b32 v16, 0, v21, vcc
v_cmp_eq_u32 vcc, 1, v22
s_nop 1
v_cndmask_b32 v17, 0, v21, vcc
v_cmp_eq_u32 vcc, 2, v22
s_nop 1
v_cndmask_b32 v18, 0, v21, vcc
v_cmp_eq_u32 vcc, 3, v22
s_nop 1
v_cndmask_b32 v19, 0, v21, vcc
s_sleep 2
s_mov_b32 s67, 0
s_mov_b32 s97, 15
h1_480:
buffer_load_dwordx4 v[32:35], v1, s[4:7], s75 offen offset:0 sc1
buffer_load_dwordx4 v[36:39], v1, s[4:7], s75 offen offset:1024 sc1
buffer_load_dwordx4 v[40:43], v1, s[4:7], s75 offen offset:2048 sc1
buffer_load_dwordx4 v[44:47], v1, s[4:7], s75 offen offset:3072 sc1
s_add_u32 s67, s67, 1
s_cmp_gt_u32 s67, 400000
s_cbranch_scc1 chain_fail_242
s_waitcnt vmcnt(3)
v_mfma_f32_16x16x32_bf16 v[24:27], v[32:35], v[16:19], 0
v_xor_b32 v28, v32, v13
s_waitcnt vmcnt(2)
v_mfma_f32_16x16x32_bf16 v[24:27], v[36:39], v[16:19], v[24:27]
v_bitop3_b32 v28, v28, v36, v13 bitop3:0xf6
s_waitcnt vmcnt(1)
v_mfma_f32_16x16x32_bf16 v[24:27], v[40:43], v[16:19], v[24:27]
v_bitop3_b32 v28, v28, v40, v13 bitop3:0xf6
s_waitcnt vmcnt(0)
v_mfma_f32_16x16x32_bf16 v[24:27], v[44:47], v[16:19], v[24:27]
v_bitop3_b32 v28, v28, v44, v13 bitop3:0xf6
v_and_b32 v28, 1, v28
v_cmp_ne_u32 vcc, 0, v28
s_nop 0
s_cbranch_vccnz h1_480
s_add_u32 s60, s79, s76
s_nop 1
v_permlane32_swap_b32 v24, v26
v_permlane32_swap_b32 v25, v27
v_add_f32 v24, v24, v26
v_add_f32 v25, v25, v27
v_cvt_pk_bf16_f32 v30, v24, v25
s_mov_b32 exec_lo, s72
s_mov_b32 exec_hi, s72
v_min_u32 v30, s70, v30
buffer_store_dword v30, v10, s[4:7], s60 offen
v_mov_b32 v28, -1
s_add_u32 s60, s73, s76
buffer_store_dword v28, v10, s[4:7], s60 offen
s_mov_b64 exec, -1
noown_477:
s_lshl_b32 s45, s3, 11
s_add_u32 s45, s45, s79
s_lshl_b32 s46, s3, 8
s_add_u32 s46, s46, 8192
s_add_u32 s46, s46, s79
v_and_b32 v20, 0xf0, v1
v_add_u32 v21, s68, v20
s_barrier
s_sleep 1
s_mov_b32 s67, 0
h2_481:
buffer_load_dwordx4 v[24:27], v1, s[4:7], s45 offen offset:0 sc1
buffer_load_dwordx4 v[28:31], v1, s[4:7], s45 offen offset:1024 sc1
buffer_load_dwordx4 v[32:35], v20, s[4:7], s46 offen sc1
s_add_u32 s67, s67, 1
s_cmp_gt_u32 s67, 400000
s_cbranch_scc1 chain_fail_242
s_waitcnt vmcnt(2)
ds_write2_b64 v11, v[24:25], v[26:27] offset1:32
v_max3_u32 v40, v24, v25, v26
v_max3_u32 v40, v40, v26, v27
s_waitcnt vmcnt(1)
ds_write2_b64 v11, v[28:29], v[30:31] offset0:128 offset1:160
v_max3_u32 v40, v28, v29, v40
v_max3_u32 v40, v40, v30, v31
s_waitcnt vmcnt(0)
ds_write_b128 v21, v[32:35]
v_max3_u32 v40, v32, v33, v40
v_max3_u32 v40, v40, v34, v35
v_cmp_eq_u32 vcc, -1, v40
s_nop 0
s_cbranch_vccnz h2_481
s_cmp_eq_u32 s3, 3
s_cbranch_scc1 io_478
io_end_479:
s_mov_b32 s60, s79
s_mov_b32 s79, s71
s_mov_b32 s71, s73
s_mov_b32 s73, s60
s_waitcnt lgkmcnt(0)
s_barrier
s_branch chain_loop_472
io_478:
s_sub_u32 s62, s62, 1
s_add_u32 s62, s62, 1
s_add_u32 s61, s62, 1
v_cmp_gt_u32 vcc, s61, v23
s_nop 0
s_and_b32 vcc_lo, vcc_lo, 15
s_cbranch_scc0 io_end_479
s_add_u32 s61, s62, 1
s_mov_b32 s67, 0
sp_loop_482:
buffer_load_dword v32, v7, s[4:7], s58 offen sc1
s_add_u32 s67, s67, 1
s_cmp_gt_u32 s67, 150000
s_cbranch_scc1 sp_bad_484
s_waitcnt vmcnt(0)
v_cmp_gt_u32 vcc, s61, v32
s_nop 0
s_and_b32 vcc_lo, vcc_lo, 15
s_cbranch_scc0 sp_ok_483
s_sleep 1
s_branch sp_loop_482
sp_bad_484:
s_mov_b32 s98, 1792
s_branch L_fail
sp_ok_483:
s_branch io_end_479
chain_foreign_467:
s_mov_b32 s62, 0
s_lshl_b32 s65, s3, 11
s_add_u32 s65, s65, 16384
s_mul_i32 s63, s51, 24576
s_add_u32 s63, s63, s53
s_mul_i32 s77, s51, 4096
s_add_u32 s77, s77, s54
v_mov_b64 v[48:49], 0
v_mov_b64 v[50:51], 0
v_mov_b64 v[52:53], 0
v_mov_b64 v[54:55], 0
v_mov_b64 v[56:57], 0
v_mov_b64 v[58:59], 0
v_mov_b64 v[60:61], 0
v_mov_b64 v[62:63], 0
v_mov_b64 v[64:65], 0
v_mov_b64 v[66:67], 0
v_mov_b64 v[68:69], 0
v_mov_b64 v[70:71], 0
s_lshl_b32 s60, s3, 12
v_add_u32 v15, s60, v1
s_lshl_b32 s60, s3, 11
s_add_u32 s60, s60, 131072
v_add_u32 v14, s60, v1
s_cmp_lg_u32 s3, 3
s_cbranch_scc1 kx0_485
s_add_u32 s61, s62, 1
s_mov_b32 s67, 0
sp_loop_486:
buffer_load_dword v32, v7, s[4:7], s58 offen sc1
s_add_u32 s67, s67, 1
s_cmp_gt_u32 s67, 150000
s_cbranch_scc1 sp_bad_488
s_waitcnt vmcnt(0)
v_cmp_gt_u32 vcc, s61, v32
s_nop 0
s_and_b32 vcc_lo, vcc_lo, 15
s_cbranch_scc0 sp_ok_487
s_sleep 1
s_branch sp_loop_486
sp_bad_488:
s_mov_b32 s98, 1792
s_branch L_fail
sp_ok_487:
kx0_485:
s_barrier
chain_loop_489:
ds_read_b64_tr_b16 v[24:25], v2 offset:0
ds_read_b64_tr_b16 v[26:27], v2 offset:512
ds_read_b128 v[32:35], v15 offset:0
ds_read_b128 v[36:39], v15 offset:1024
ds_read_b64_tr_b16 v[28:29], v2 offset:1024
ds_read_b64_tr_b16 v[30:31], v2 offset:1536
s_sub_u32 s60, s65, 8192
s_add_u32 m0, s60, 146432
s_add_u32 s60, s60, s63
v_lshlrev_b32 v13, 5, v0
s_add_u32 s61, s63, s65
buffer_load_dwordx4 v1, s[4:7], s60 offen offset:0 sc1 lds
buffer_load_dwordx4 v1, s[4:7], s60 offen offset:1024 sc1 lds
buffer_load_dword v13, v13, s[4:7], s61 offen sc1
v_mov_b32 v42, s62
buffer_store_dword v42, v8, s[4:7], s58 offen sc1
s_waitcnt lgkmcnt(4)
v_smfmac_f32_16x16x64_bf16 v[48:51], v[24:27], a[0:7], v3
ds_read_b128 v[40:43], v15 offset:2048
v_smfmac_f32_16x16x64_bf16 v[52:55], v[24:27], a[72:79], v3
ds_read_b128 v[44:47], v15 offset:3072
v_smfmac_f32_16x16x64_bf16 v[56:59], v[24:27], a[144:151], v3
ds_read_b128 v[16:19], v15 offset:16384
v_smfmac_f32_16x16x64_bf16 v[60:63], v[24:27], a[216:223], v3
ds_read_b128 v[20:23], v15 offset:17408
s_waitcnt lgkmcnt(6)
v_smfmac_f32_16x16x64_bf16 v[64:67], v[24:27], v[32:39], v3
ds_read_b128 v[32:35], v15 offset:18432
s_waitcnt lgkmcnt(3)
v_smfmac_f32_16x16x64_bf16 v[68:71], v[24:27], v[40:47], v3
ds_read_b128 v[36:39], v15 offset:19456
v_smfmac_f32_16x16x64_bf16 v[48:51], v[28:31], a[8:15], v3
ds_read_b64_tr_b16 v[24:25], v2 offset:2048
v_smfmac_f32_16x16x64_bf16 v[52:55], v[28:31], a[80:87], v3
ds_read_b64_tr_b16 v[26:27], v2 offset:2560
v_smfmac_f32_16x16x64_bf16 v[56:59], v[28:31], a[152:159], v3
ds_read_b128 v[40:43], v15 offset:32768
v_smfmac_f32_16x16x64_bf16 v[60:63], v[28:31], a[224:231], v3
ds_read_b128 v[44:47], v15 offset:33792
s_waitcnt lgkmcnt(6)
v_smfmac_f32_16x16x64_bf16 v[64:67], v[28:31], v[16:23], v3
ds_read_b128 v[16:19], v15 offset:34816
s_waitcnt lgkmcnt(5)
v_smfmac_f32_16x16x64_bf16 v[68:71], v[28:31], v[32:39], v3
ds_read_b128 v[20:23], v15 offset:35840
s_waitcnt lgkmcnt(4)
v_smfmac_f32_16x16x64_bf16 v[48:51], v[24:27], a[16:23], v3
ds_read_b64_tr_b16 v[28:29], v2 offset:3072
v_smfmac_f32_16x16x64_bf16 v[52:55], v[24:27], a[88:95], v3
ds_read_b64_tr_b16 v[30:31], v2 offset:3584
v_smfmac_f32_16x16x64_bf16 v[56:59], v[24:27], a[160:167], v3
ds_read_b128 v[32:35], v15 offset:49152
v_smfmac_f32_16x16x64_bf16 v[60:63], v[24:27], a[232:239], v3
ds_read_b128 v[36:39], v15 offset:50176
s_waitcnt lgkmcnt(6)
v_smfmac_f32_16x16x64_bf16 v[64:67], v[24:27], v[40:47], v3
ds_read_b128 v[40:43], v15 offset:51200
s_waitcnt lgkmcnt(5)
v_smfmac_f32_16x16x64_bf16 v[68:71], v[24:27], v[16:23], v3
ds_read_b128 v[44:47], v15 offset:52224
s_waitcnt lgkmcnt(4)
v_smfmac_f32_16x16x64_bf16 v[48:51], v[28:31], a[24:31], v3
ds_read_b64_tr_b16 v[24:25], v2 offset:4096
v_smfmac_f32_16x16x64_bf16 v[52:55], v[28:31], a[96:103], v3
ds_read_b64_tr_b16 v[26:27], v2 offset:4608
v_smfmac_f32_16x16x64_bf16 v[56:59], v[28:31], a[168:175], v3
v_add_u32 v15, 65536, v15
ds_read_b128 v[16:19], v15 offset:0
v_smfmac_f32_16x16x64_bf16 v[60:63], v[28:31], a[240:247], v3
ds_read_b128 v[20:23], v15 offset:1024
s_waitcnt lgkmcnt(6)
v_smfmac_f32_16x16x64_bf16 v[64:67], v[28:31], v[32:39], v3
ds_read_b128 v[32:35], v15 offset:2048
s_waitcnt lgkmcnt(5)
v_smfmac_f32_16x16x64_bf16 v[68:71], v[28:31], v[40:47], v3
ds_read_b128 v[36:39], v15 offset:3072
s_waitcnt lgkmcnt(4)
v_smfmac_f32_16x16x64_bf16 v[48:51], v[24:27], a[32:39], v3
ds_read_b64_tr_b16 v[28:29], v2 offset:5120
v_smfmac_f32_16x16x64_bf16 v[52:55], v[24:27], a[104:111], v3
ds_read_b64_tr_b16 v[30:31], v2 offset:5632
v_smfmac_f32_16x16x64_bf16 v[56:59], v[24:27], a[176:183], v3
ds_read_b128 v[40:43], v15 offset:16384
v_smfmac_f32_16x16x64_bf16 v[60:63], v[24:27], a[248:255], v3
ds_read_b128 v[44:47], v15 offset:17408
s_waitcnt lgkmcnt(6)
v_smfmac_f32_16x16x64_bf16 v[64:67], v[24:27], v[16:23], v3
ds_read_b128 v[16:19], v15 offset:18432
s_waitcnt lgkmcnt(5)
v_smfmac_f32_16x16x64_bf16 v[68:71], v[24:27], v[32:39], v3
ds_read_b128 v[20:23], v15 offset:19456
s_waitcnt lgkmcnt(4)
v_smfmac_f32_16x16x64_bf16 v[48:51], v[28:31], a[40:47], v3
ds_read_b64_tr_b16 v[24:25], v2 offset:6144
v_smfmac_f32_16x16x64_bf16 v[52:55], v[28:31], a[112:119], v3
ds_read_b64_tr_b16 v[26:27], v2 offset:6656
v_smfmac_f32_16x16x64_bf16 v[56:59], v[28:31], a[184:191], v3
ds_read_b128 v[32:35], v15 offset:32768
v_smfmac_f32_16x16x64_bf16 v[60:63], v[28:31], v[72:79], v3
ds_read_b128 v[36:39], v15 offset:33792
s_waitcnt lgkmcnt(6)
v_smfmac_f32_16x16x64_bf16 v[64:67], v[28:31], v[40:47], v3
ds_read_b128 v[40:43], v15 offset:34816
s_waitcnt lgkmcnt(5)
v_smfmac_f32_16x16x64_bf16 v[68:71], v[28:31], v[16:23], v3
ds_read_b128 v[44:47], v15 offset:35840
s_waitcnt lgkmcnt(4)
v_smfmac_f32_16x16x64_bf16 v[48:51], v[24:27], a[48:55], v3
ds_read_b64_tr_b16 v[28:29], v2 offset:7168
v_smfmac_f32_16x16x64_bf16 v[52:55], v[24:27], a[120:127], v3
ds_read_b64_tr_b16 v[30:31], v2 offset:7680
v_smfmac_f32_16x16x64_bf16 v[56:59], v[24:27], a[192:199], v3
ds_read_b128 v[16:19], v15 offset:49152
v_smfmac_f32_16x16x64_bf16 v[60:63], v[24:27], v[80:87], v3
ds_read_b128 v[20:23], v15 offset:50176
s_waitcnt lgkmcnt(6)
v_smfmac_f32_16x16x64_bf16 v[64:67], v[24:27], v[32:39], v3
ds_read_b128 v[32:35], v15 offset:51200
s_waitcnt lgkmcnt(5)
v_smfmac_f32_16x16x64_bf16 v[68:71], v[24:27], v[40:47], v3
ds_read_b128 v[36:39], v15 offset:52224
s_waitcnt lgkmcnt(4)
v_smfmac_f32_16x16x64_bf16 v[48:51], v[28:31], a[56:63], v3
ds_read_b64_tr_b16 v[24:25], v2 offset:8192
v_smfmac_f32_16x16x64_bf16 v[52:55], v[28:31], a[128:135], v3
ds_read_b64_tr_b16 v[26:27], v2 offset:8704
v_smfmac_f32_16x16x64_bf16 v[56:59], v[28:31], a[200:207], v3
ds_read_b128 v[40:43], v14 offset:0
v_smfmac_f32_16x16x64_bf16 v[60:63], v[28:31], v[88:95], v3
ds_read_b128 v[44:47], v14 offset:1024
s_waitcnt lgkmcnt(6)
v_smfmac_f32_16x16x64_bf16 v[64:67], v[28:31], v[16:23], v3
v_add_u32 v15, 152576, v1
s_waitcnt lgkmcnt(4)
v_smfmac_f32_16x16x64_bf16 v[68:71], v[28:31], v[32:39], v3
s_waitcnt lgkmcnt(2)
v_smfmac_f32_16x16x64_bf16 v[48:51], v[24:27], a[64:71], v3
v_smfmac_f32_16x16x64_bf16 v[52:55], v[24:27], a[136:143], v3
v_smfmac_f32_16x16x64_bf16 v[56:59], v[24:27], a[208:215], v3
v_smfmac_f32_16x16x64_bf16 v[60:63], v[24:27], v[96:103], v3
s_waitcnt lgkmcnt(0)
v_smfmac_f32_16x16x64_bf16 v[64:67], v[24:27], v[40:47], v3
v_smfmac_f32_16x16x64_bf16 v[68:71], v[24:27], v[248:255], v3
s_nop 3
v_add_f32 v56, v56, v57
v_add_f32 v58, v58, v59
v_add_f32 v48, v48, v49
v_add_f32 v50, v50, v51
v_cvt_pk_bf16_f32 v24, v56, v58
v_cvt_pk_bf16_f32 v25, v48, v50
ds_write_b64 v4, v[24:25] offset:0
v_add_f32 v60, v60, v61
v_add_f32 v62, v62, v63
v_add_f32 v52, v52, v53
v_add_f32 v54, v54, v55
v_cvt_pk_bf16_f32 v26, v60, v62
v_cvt_pk_bf16_f32 v27, v52, v54
ds_write_b64 v4, v[26:27] offset:512
v_add_f32 v64, v64, v65
v_add_f32 v66, v66, v67
v_cvt_pk_bf16_f32 v28, v64, v66
v_add_f32 v68, v68, v69
v_add_f32 v70, v70, v71
v_cvt_pk_bf16_f32 v29, v68, v70
s_add_u32 s61, s63, s65
buffer_load_dwordx4 v[16:19], v1, s[4:7], s61 offen sc1
buffer_load_dwordx4 v[20:23], v1, s[4:7], s61 offen offset:1024 sc1
s_waitcnt vmcnt(3) lgkmcnt(0)
s_barrier
ds_read_b64_tr_b16 v[48:49], v5 offset:0
ds_read_b64_tr_b16 v[50:51], v5 offset:256
ds_read_b128 v[32:35], v15 offset:2048
ds_read_b128 v[36:39], v15 offset:3072
ds_read_b64_tr_b16 v[52:53], v5 offset:1024
ds_read_b64_tr_b16 v[54:55], v5 offset:1280
ds_read_b128 v[40:43], v15 offset:4096
ds_read_b128 v[44:47], v15 offset:5120
ds_read_b64_tr_b16 v[64:65], v5 offset:2048
ds_read_b64_tr_b16 v[66:67], v5 offset:2304
ds_read_b64_tr_b16 v[68:69], v5 offset:3072
ds_read_b64_tr_b16 v[70:71], v5 offset:3328
s_add_u32 s61, s77, s78
buffer_store_dwordx2 v[28:29], v2, s[4:7], s61 offen sc1
v_mov_b64 v[24:25], 0
v_mov_b64 v[26:27], s[98:99]
s_waitcnt lgkmcnt(10)
s_nop 0
v_mfma_f32_16x16x32_bf16 v[24:27], v[48:51], v[48:51], v[24:27]
s_waitcnt lgkmcnt(8)
v_mfma_f32_16x16x32_bf16 v[56:59], v[32:35], v[48:51], 0
v_mfma_f32_16x16x32_bf16 v[60:63], v[36:39], v[48:51], 0
ds_read_b128 v[32:35], v15 offset:6144
ds_read_b128 v[36:39], v15 offset:7168
s_waitcnt lgkmcnt(8)
v_mfma_f32_16x16x32_bf16 v[24:27], v[52:55], v[52:55], v[24:27]
s_waitcnt lgkmcnt(6)
v_mfma_f32_16x16x32_bf16 v[56:59], v[40:43], v[52:55], v[56:59]
v_mfma_f32_16x16x32_bf16 v[60:63], v[44:47], v[52:55], v[60:63]
ds_read_b128 v[40:43], v15 offset:8192
ds_read_b128 v[44:47], v15 offset:9216
s_waitcnt lgkmcnt(6)
v_mfma_f32_16x16x32_bf16 v[24:27], v[64:67], v[64:67], v[24:27]
s_waitcnt lgkmcnt(2)
v_mfma_f32_16x16x32_bf16 v[56:59], v[32:35], v[64:67], v[56:59]
v_mfma_f32_16x16x32_bf16 v[60:63], v[36:39], v[64:67], v[60:63]
v_mfma_f32_16x16x32_bf16 v[24:27], v[68:71], v[68:71], v[24:27]
s_waitcnt lgkmcnt(0)
v_mfma_f32_16x16x32_bf16 v[56:59], v[40:43], v[68:71], v[56:59]
v_mfma_f32_16x16x32_bf16 v[60:63], v[44:47], v[68:71], v[60:63]
s_mov_b32 exec_lo, 0x33333333
s_mov_b32 exec_hi, 0x33333333
s_cmp_ge_u32 s3, 2
s_cbranch_scc1 km23_491
s_bitcmp1_b32 s3, 0
s_cbranch_scc1 km_492
buffer_store_dwordx4 v[48:51], v12, s[4:7], s77 offen offset:0 sc1
s_branch kmd_490
km_492:
buffer_store_dwordx4 v[52:55], v12, s[4:7], s77 offen offset:512 sc1
s_branch kmd_490
km23_491:
s_bitcmp1_b32 s3, 0
s_cbranch_scc1 km_493
buffer_store_dwordx4 v[64:67], v12, s[4:7], s77 offen offset:1024 sc1
s_branch kmd_490
km_493:
buffer_store_dwordx4 v[68:71], v12, s[4:7], s77 offen offset:1536 sc1
kmd_490:
s_mov_b64 exec, -1
s_cmp_eq_u32 s62, 63
s_cbranch_scc1 chain_done_243
v_mov_b32 v36, 0x3f803f80
v_mov_b32 v37, 0x3f803f80
v_mov_b32 v45, 0
v_mov_b32 v46, 0
v_mov_b64 v[38:39], v[36:37]
v_max3_f32 v32, v24, v25, v56
v_max3_f32 v32, v32, v57, v58
v_max3_f32 v32, v32, v59, v60
v_max3_f32 v32, v32, v61, v62
v_max_f32 v32, v32, v63
v_mov_b32 v33, v32
s_add_u32 s63, s63, 786432
s_add_u32 s62, s62, 1
v_permlane16_swap_b32 v33, v32
v_max_f32 v32, v32, v33
v_mov_b32 v33, v32
s_and_b32 s64, s62, 1
s_nop 0
v_permlane32_swap_b32 v33, v32
v_max_f32 v32, v32, v33
v_mul_f32 v32, s66, v32
v_pk_fma_f32 v[24:25], v[24:25], s[66:67], v[32:33] op_sel_hi:[1,0,0] neg_lo:[0,0,1] neg_hi:[0,0,1]
v_pk_fma_f32 v[56:57], v[56:57], s[66:67], v[32:33] op_sel_hi:[1,0,0] neg_lo:[0,0,1] neg_hi:[0,0,1]
v_pk_fma_f32 v[58:59], v[58:59], s[66:67], v[32:33] op_sel_hi:[1,0,0] neg_lo:[0,0,1] neg_hi:[0,0,1]
v_pk_fma_f32 v[60:61], v[60:61], s[66:67], v[32:33] op_sel_hi:[1,0,0] neg_lo:[0,0,1] neg_hi:[0,0,1]
v_pk_fma_f32 v[62:63], v[62:63], s[66:67], v[32:33] op_sel_hi:[1,0,0] neg_lo:[0,0,1] neg_hi:[0,0,1]
v_exp_f32 v24, v24
v_exp_f32 v25, v25
v_exp_f32 v56, v56
v_exp_f32 v57, v57
v_cvt_pk_bf16_f32 v44, v24, v25
v_cvt_pk_bf16_f32 v47, v24, v25
v_exp_f32 v58, v58
v_exp_f32 v59, v59
v_mfma_f32_16x16x16_bf16 v[48:51], v[36:37], v[44:45], 0
v_exp_f32 v60, v60
v_mfma_f32_16x16x16_bf16 v[68:71], v[28:29], v[46:47], 0
v_exp_f32 v61, v61
v_mfma_f32_16x16x16_bf16 v[64:67], v[28:29], v[44:45], 0
v_exp_f32 v62, v62
v_exp_f32 v63, v63
v_cvt_pk_bf16_f32 v40, v56, v57
v_cvt_pk_bf16_f32 v41, v58, v59
v_cvt_pk_bf16_f32 v42, v60, v61
v_cvt_pk_bf16_f32 v43, v62, v63
s_waitcnt vmcnt(2)
s_nop 0
v_mfma_f32_16x16x32_bf16 v[48:51], v[36:39], v[40:43], v[48:51]
v_mfma_f32_16x16x32_bf16 v[68:71], v[20:23], v[40:43], v[68:71]
v_mfma_f32_16x16x32_bf16 v[64:67], v[16:19], v[40:43], v[64:67]
v_mov_b32 v13, s64
v_mov_b64 v[24:25], 0
v_mov_b64 v[26:27], 0
v_mov_b64 v[56:57], 0
v_mov_b64 v[58:59], 0
v_mov_b64 v[60:61], 0
v_mov_b64 v[62:63], 0
v_rcp_f32 v52, v48
s_nop 0
v_pk_mul_f32 v[68:69], v[68:69], v[52:53] op_sel_hi:[1,0]
v_pk_mul_f32 v[70:71], v[70:71], v[52:53] op_sel_hi:[1,0]
s_nop 0
v_cvt_pk_bf16_f32 v50, v68, v70
v_cvt_pk_bf16_f32 v51, v69, v71
v_pk_mul_f32 v[64:65], v[64:65], v[52:53] op_sel_hi:[1,0]
v_pk_mul_f32 v[66:67], v[66:67], v[52:53] op_sel_hi:[1,0]
s_mov_b32 exec_lo, 0xcccccccc
s_mov_b32 exec_hi, 0xcccccccc
ds_write_b32 v6, v50 offset:256
ds_write_b32 v6, v51 offset:272
s_mov_b64 exec, -1
v_cvt_pk_bf16_f32 v48, v64, v66
v_cvt_pk_bf16_f32 v49, v65, v67
s_mov_b32 exec_lo, 0xcccccccc
s_mov_b32 exec_hi, 0xcccccccc
ds_write_b32 v6, v48
ds_write_b32 v6, v49 offset:16
s_mov_b64 exec, -1
v_mov_b64 v[32:33], 0
v_mov_b64 v[34:35], 0
v_mov_b64 v[36:37], 0
v_mov_b64 v[38:39], 0
v_mov_b64 v[40:41], 0
v_mov_b64 v[42:43], 0
v_mov_b64 v[44:45], 0
v_mov_b64 v[46:47], 0
v_add_u32 v20, 152576, v1
s_waitcnt lgkmcnt(0)
s_barrier
ds_read_b128 v[48:51], v20 offset:0
ds_read_b128 v[52:55], v20 offset:1024
v_mov_b64 v[64:65], 0
v_mov_b64 v[66:67], 0
v_mov_b64 v[68:69], 0
v_mov_b64 v[70:71], 0
buffer_load_dword v23, v7, s[4:7], s58 offen sc1
s_add_u32 s45, s74, 32768
s_waitcnt lgkmcnt(0)
v_smfmac_f32_16x16x64_bf16 v[24:27], v[48:51], v[232:239], v3
v_smfmac_f32_16x16x64_bf16 v[24:27], v[52:55], v[240:247], v3
v_smfmac_f32_16x16x64_bf16 v[32:35], v[48:51], v[104:111], v3
v_smfmac_f32_16x16x64_bf16 v[36:39], v[48:51], v[120:127], v3
v_smfmac_f32_16x16x64_bf16 v[40:43], v[48:51], v[136:143], v3
v_smfmac_f32_16x16x64_bf16 v[44:47], v[48:51], v[152:159], v3
s_nop 3
v_add_f32 v24, v24, v25
v_add_f32 v26, v26, v27
v_smfmac_f32_16x16x64_bf16 v[32:35], v[52:55], v[112:119], v3
v_cvt_pk_bf16_f32 v24, v24, v26
v_smfmac_f32_16x16x64_bf16 v[36:39], v[52:55], v[128:135], v3
s_nop 0
v_permlane32_swap_b32 v24, v26
v_smfmac_f32_16x16x64_bf16 v[40:43], v[52:55], v[144:151], v3
s_nop 0
v_permlane16_swap_b32 v24, v25
v_permlane16_swap_b32 v26, v27
v_smfmac_f32_16x16x64_bf16 v[44:47], v[52:55], v[160:167], v3
v_and_or_b32 v24, v24, s70, v13
v_smfmac_f32_16x16x64_bf16 v[56:59], v[48:51], v[168:175], v3
s_mov_b64 exec, 0xffff
buffer_store_dwordx4 v[24:27], v9, s[4:7], s49 offen sc1
s_mov_b64 exec, -1
v_smfmac_f32_16x16x64_bf16 v[60:63], v[48:51], v[184:191], v3
v_add_f32 v32, v32, v33
v_add_f32 v34, v34, v35
v_smfmac_f32_16x16x64_bf16 v[64:67], v[48:51], v[200:207], v3
v_cvt_pk_bf16_f32 v28, v32, v34
v_add_f32 v36, v36, v37
v_smfmac_f32_16x16x64_bf16 v[68:71], v[48:51], v[216:223], v3
v_add_f32 v38, v38, v39
v_cvt_pk_bf16_f32 v29, v36, v38
v_smfmac_f32_16x16x64_bf16 v[56:59], v[52:55], v[176:183], v3
v_add_f32 v40, v40, v41
v_add_f32 v42, v42, v43
v_smfmac_f32_16x16x64_bf16 v[60:63], v[52:55], v[192:199], v3
v_cvt_pk_bf16_f32 v30, v40, v42
v_add_f32 v44, v44, v45
v_smfmac_f32_16x16x64_bf16 v[64:67], v[52:55], v[208:215], v3
v_add_f32 v46, v46, v47
v_cvt_pk_bf16_f32 v31, v44, v46
v_smfmac_f32_16x16x64_bf16 v[68:71], v[52:55], v[224:231], v3
v_and_or_b32 v28, v28, s70, v13
buffer_store_dwordx4 v[28:31], v9, s[4:7], s74 offen sc1
v_add_f32 v56, v56, v57
v_add_f32 v58, v58, v59
v_cvt_pk_bf16_f32 v32, v56, v58
v_add_f32 v60, v60, v61
v_add_f32 v62, v62, v63
v_cvt_pk_bf16_f32 v33, v60, v62
v_add_f32 v64, v64, v65
v_add_f32 v66, v66, v67
v_cvt_pk_bf16_f32 v34, v64, v66
v_add_f32 v68, v68, v69
v_add_f32 v70, v70, v71
v_cvt_pk_bf16_f32 v35, v68, v70
v_and_or_b32 v32, v32, s70, v13
buffer_store_dwordx4 v[32:35], v9, s[4:7], s45 offen sc1
s_add_u32 s77, s77, 131072
v_mov_b64 v[48:49], 0
v_mov_b64 v[50:51], 0
v_mov_b64 v[52:53], 0
v_mov_b64 v[54:55], 0
v_mov_b64 v[56:57], 0
v_mov_b64 v[58:59], 0
v_mov_b64 v[60:61], 0
v_mov_b64 v[62:63], 0
v_mov_b64 v[64:65], 0
v_mov_b64 v[66:67], 0
v_mov_b64 v[68:69], 0
v_mov_b64 v[70:71], 0
s_lshl_b32 s60, s3, 12
v_add_u32 v15, s60, v1
s_cmp_eq_u32 s48, 0
s_cbranch_scc1 noown_494
v_and_b32 v20, 15, v0
v_and_b32 v21, 1, v0
v_lshlrev_b32 v21, 4, v21
v_mov_b32 v22, 0x3f80
v_lshlrev_b32 v21, v21, v22
v_lshrrev_b32 v22, 1, v20
v_cmp_eq_u32 vcc, 0, v22
s_nop 1
v_cndmask_b32 v16, 0, v21, vcc
v_cmp_eq_u32 vcc, 1, v22
s_nop 1
v_cndmask_b32 v17, 0, v21, vcc
v_cmp_eq_u32 vcc, 2, v22
s_nop 1
v_cndmask_b32 v18, 0, v21, vcc
v_cmp_eq_u32 vcc, 3, v22
s_nop 1
v_cndmask_b32 v19, 0, v21, vcc
s_sleep 2
s_mov_b32 s67, 0
s_mov_b32 s97, 15
h1_497:
buffer_load_dwordx4 v[32:35], v1, s[4:7], s75 offen offset:0 sc1
buffer_load_dwordx4 v[36:39], v1, s[4:7], s75 offen offset:1024 sc1
buffer_load_dwordx4 v[40:43], v1, s[4:7], s75 offen offset:2048 sc1
buffer_load_dwordx4 v[44:47], v1, s[4:7], s75 offen offset:3072 sc1
s_add_u32 s67, s67, 1
s_cmp_gt_u32 s67, 400000
s_cbranch_scc1 chain_fail_242
s_waitcnt vmcnt(3)
v_mfma_f32_16x16x32_bf16 v[24:27], v[32:35], v[16:19], 0
v_xor_b32 v28, v32, v13
s_waitcnt vmcnt(2)
v_mfma_f32_16x16x32_bf16 v[24:27], v[36:39], v[16:19], v[24:27]
v_bitop3_b32 v28, v28, v36, v13 bitop3:0xf6
s_waitcnt vmcnt(1)
v_mfma_f32_16x16x32_bf16 v[24:27], v[40:43], v[16:19], v[24:27]
v_bitop3_b32 v28, v28, v40, v13 bitop3:0xf6
s_waitcnt vmcnt(0)
v_mfma_f32_16x16x32_bf16 v[24:27], v[44:47], v[16:19], v[24:27]
v_bitop3_b32 v28, v28, v44, v13 bitop3:0xf6
v_and_b32 v28, 1, v28
v_cmp_ne_u32 vcc, 0, v28
s_nop 0
s_cbranch_vccnz h1_497
s_add_u32 s60, s79, s76
s_nop 1
v_permlane32_swap_b32 v24, v26
v_permlane32_swap_b32 v25, v27
v_add_f32 v24, v24, v26
v_add_f32 v25, v25, v27
v_cvt_pk_bf16_f32 v30, v24, v25
s_mov_b32 exec_lo, s72
s_mov_b32 exec_hi, s72
v_min_u32 v30, s70, v30
buffer_store_dword v30, v10, s[4:7], s60 offen sc1
v_mov_b32 v28, -1
s_add_u32 s60, s73, s76
buffer_store_dword v28, v10, s[4:7], s60 offen sc1
s_mov_b64 exec, -1
noown_494:
s_lshl_b32 s45, s3, 11
s_add_u32 s45, s45, s79
s_lshl_b32 s46, s3, 8
s_add_u32 s46, s46, 8192
s_add_u32 s46, s46, s79
v_and_b32 v20, 0xf0, v1
v_add_u32 v21, s68, v20
s_barrier
s_sleep 1
s_mov_b32 s67, 0
h2_498:
buffer_load_dwordx4 v[24:27], v1, s[4:7], s45 offen offset:0 sc1
buffer_load_dwordx4 v[28:31], v1, s[4:7], s45 offen offset:1024 sc1
buffer_load_dwordx4 v[32:35], v20, s[4:7], s46 offen sc1
s_add_u32 s67, s67, 1
s_cmp_gt_u32 s67, 400000
s_cbranch_scc1 chain_fail_242
s_waitcnt vmcnt(2)
ds_write2_b64 v11, v[24:25], v[26:27] offset1:32
v_max3_u32 v40, v24, v25, v26
v_max3_u32 v40, v40, v26, v27
s_waitcnt vmcnt(1)
ds_write2_b64 v11, v[28:29], v[30:31] offset0:128 offset1:160
v_max3_u32 v40, v28, v29, v40
v_max3_u32 v40, v40, v30, v31
s_waitcnt vmcnt(0)
ds_write_b128 v21, v[32:35]
v_max3_u32 v40, v32, v33, v40
v_max3_u32 v40, v40, v34, v35
v_cmp_eq_u32 vcc, -1, v40
s_nop 0
s_cbranch_vccnz h2_498
s_cmp_eq_u32 s3, 3
s_cbranch_scc1 io_495
io_end_496:
s_mov_b32 s60, s79
s_mov_b32 s79, s71
s_mov_b32 s71, s73
s_mov_b32 s73, s60
s_waitcnt lgkmcnt(0)
s_barrier
s_branch chain_loop_489
io_495:
s_sub_u32 s62, s62, 1
s_add_u32 s62, s62, 1
s_add_u32 s61, s62, 1
v_cmp_gt_u32 vcc, s61, v23
s_nop 0
s_and_b32 vcc_lo, vcc_lo, 15
s_cbranch_scc0 io_end_496
s_add_u32 s61, s62, 1
s_mov_b32 s67, 0
sp_loop_499:
buffer_load_dword v32, v7, s[4:7], s58 offen sc1
s_add_u32 s67, s67, 1
s_cmp_gt_u32 s67, 150000
s_cbranch_scc1 sp_bad_501
s_waitcnt vmcnt(0)
v_cmp_gt_u32 vcc, s61, v32
s_nop 0
s_and_b32 vcc_lo, vcc_lo, 15
s_cbranch_scc0 sp_ok_500
s_sleep 1
s_branch sp_loop_499
sp_bad_501:
s_mov_b32 s98, 1792
s_branch L_fail
sp_ok_500:
s_branch io_end_496
chain_fail_242:
v_mov_b32 v24, 0xdead
v_mov_b32 v25, 252
buffer_store_dword v24, v25, s[12:15], 0 offen
s_waitcnt vmcnt(0)
s_endpgm
chain_done_243:
s_mov_b32 s62, 64
s_waitcnt vmcnt(0)
s_barrier
v_mov_b32 v24, s62
buffer_store_dword v24, v8, s[4:7], s58 offen sc1
s_endpgm
.p2align 2
L_roles:
.short 0,0,0,0,0,0,0,0,0,0,0,0,0,0,0,0,0,0,0,0,0,0,0,0,0,0,0,0,0,0,0,0
.short 0,0,0,0,0,0,0,0,0,0,0,0,0,0,0,0,0,0,0,0,0,0,0,0,0,0,0,0,0,0,0,0
.short 0,1,2,3,4,5,256,257,258,6,7,8,9,10,11,259,260,261,512,513,514,768,769,1024,1025,1280,1281,1282,1283,1284,1285,1286
.short 12,13,14,15,16,17,262,263,264,18,19,20,21,22,23,265,266,267,515,516,517,770,771,1026,1027,1287,1288,1289,1290,1291,1292,1293
.short 24,25,26,27,28,29,268,269,270,518,519,520,772,773,521,522,523,774,775,1028,1029,1294,1295,1296,1297,1298,1299,1300,1301,1302,1303,1304
.short 30,31,32,33,34,35,271,272,273,524,525,526,776,777,527,528,529,778,779,1030,1031,1305,1306,1307,1308,1309,1310,1311,1312,1313,1314,1315
.short 36,37,38,39,40,41,274,275,276,530,531,532,780,781,1032,1033,1034,1035,1316,1317,1318,1319,1320,1321,1322,1323,1324,1325,1326,1327,1328,1329
.short 42,43,44,45,46,47,277,278,279,533,534,535,782,783,1036,1037,1038,1039,1330,1331,1332,1333,1334,1335,1336,1337,1338,1339,1340,1341,1342,1343
L_writers:
.byte 2,2,3,3,4,4,5,5,6,6,6,6,7,7,7,7,2,2,2,2,2,2,2,3,3,3,3,3,3,3,4,4,4,4,4,4,4,4,4,4,4,5,5,5,5,5,5,5,5,5,5,5,6,6,6,6,6,6,6,6,6,6,6,6
.byte 6,6,7,7,7,7,7,7,7,7,7,7,7,7,7,7,0,0,0,0,0,0,0,0,0,0,0,0,0,0,0,0,0,0,0,0,0,0,0,0,0,0,0,0,0,0,0,0,2,2,2,2,3,3,3,3,4,4,4,4,4,4,4,4
.byte 5,5,5,5,5,5,5,5,6,6,6,6,7,7,7,7,2,2,2,3,3,3,4,4,4,4,4,4,5,5,5,5,5,5,6,6,6,7,7,7,2,2,3,3,4,4,5,5,6,6,6,6,7,7,7,7,2,2,2,2,2,2,2,2
.byte 2,2,2,2,3,3,3,3,3,3,3,3,3,3,3,3,4,4,4,4,4,4,5,5,5,5,5,5,6,6,6,6,6,6,7,7,7,7,7,7,2,2,2,2,2,2,3,3,3,3,3,3,4,4,4,5,5,5,6,6,6,7,7,7
.byte 2,2,3,3,4,4,5,5,6,6,6,6,7,7,7,7,2,2,2,2,2,2,2,3,3,3,3,3,3,3,4,4,4,4,4,4,4,4,4,4,4,5,5,5,5,5,5,5,5,5,5,5,6,6,6,6,6,6,6,6,6,6,6,6
.byte 6,6,7,7,7,7,7,7,7,7,7,7,7,7,7,7,1,1,1,1,1,1,1,1,1,1,1,1,1,1,1,1,1,1,1,1,1,1,1,1,1,1,1,1,1,1,1,1,2,2,2,2,3,3,3,3,4,4,4,4,4,4,4,4
.byte 5,5,5,5,5,5,5,5,6,6,6,6,7,7,7,7,2,2,2,3,3,3,4,4,4,4,4,4,5,5,5,5,5,5,6,6,6,7,7,7,2,2,3,3,4,4,5,5,6,6,6,6,7,7,7,7,2,2,2,2,2,2,2,2
.byte 2,2,2,2,3,3,3,3,3,3,3,3,3,3,3,3,4,4,4,4,4,4,5,5,5,5,5,5,6,6,6,6,6,6,7,7,7,7,7,7,2,2,2,2,2,2,3,3,3,3,3,3,4,4,4,5,5,5,6,6,6,7,7,7
L_code_end:
.section .rodata,"a"
.p2align 6
.amdhsa_kernel interleave_layers__memory_aug_recurrent_mem_tr__glu_gated_swiglu__prompt_kernel
  .amdhsa_next_free_vgpr 512
  .amdhsa_next_free_sgpr 102
  .amdhsa_accum_offset 256
  .amdhsa_group_segment_fixed_size 0
  .amdhsa_kernarg_size 112
  .amdhsa_user_sgpr_count 2
  .amdhsa_user_sgpr_kernarg_segment_ptr 1
  .amdhsa_system_sgpr_workgroup_id_x 1
  .amdhsa_float_denorm_mode_32 3
.end_amdhsa_kernel
```

```asm
; @launch grid=(256,1,1) block=(256,1,1) lds=163840
.amdgcn_target "amdgcn-amd-amdhsa--gfx950"
.text
.globl interleave_layers__memory_aug_recurrent_mem_tr__glu_gated_swiglu__prompt_kernel
.p2align 8
.type interleave_layers__memory_aug_recurrent_mem_tr__glu_gated_swiglu__prompt_kernel,@function
interleave_layers__memory_aug_recurrent_mem_tr__glu_gated_swiglu__prompt_kernel:
s_cmp_lt_u32 s2, 256
s_cbranch_scc1 L_go
L_end:
s_endpgm
L_go:
s_getpc_b64 s[56:57]
L_pc0:
s_sub_u32 s56, s56, L_pc0-interleave_layers__memory_aug_recurrent_mem_tr__glu_gated_swiglu__prompt_kernel
s_subb_u32 s57, s57, 0
s_lshr_b32 s58, s2, 3
s_and_b32 s58, s58, 31
s_mul_i32 s58, s58, (L_code_end-interleave_layers__memory_aug_recurrent_mem_tr__glu_gated_swiglu__prompt_kernel+32*4096-1)/(32*4096)*4096
v_lshlrev_b32 v2, 4, v0
v_add_u32 v2, s58, v2
v_add_u32 v3, 0, v2
v_min_u32 v3, L_code_end-interleave_layers__memory_aug_recurrent_mem_tr__glu_gated_swiglu__prompt_kernel-16, v3
global_load_dwordx4 v[200:203], v3, s[56:57]
v_add_u32 v3, 4096, v2
v_min_u32 v3, L_code_end-interleave_layers__memory_aug_recurrent_mem_tr__glu_gated_swiglu__prompt_kernel-16, v3
global_load_dwordx4 v[204:207], v3, s[56:57]
s_load_dwordx4 s[20:23], s[0:1], 0
s_load_dwordx4 s[24:27], s[0:1], 16
s_load_dwordx4 s[28:31], s[0:1], 32
s_load_dwordx4 s[32:35], s[0:1], 64
s_load_dwordx4 s[36:39], s[0:1], 80
s_load_dwordx4 s[40:43], s[0:1], 96
v_lshrrev_b32 v1, 6, v0
v_and_b32 v0, 63, v0
v_readfirstlane_b32 s3, v1
s_waitcnt lgkmcnt(0)
s_mov_b32 s4, s42
s_and_b32 s5, s43, 0xffff
s_mov_b32 s6, 268435456
s_mov_b32 s7, 0x20000
s_mov_b32 s12, s40
s_and_b32 s13, s41, 0xffff
s_mov_b32 s14, 256
s_mov_b32 s15, 0x20000
s_getreg_b32 s50, hwreg(HW_REG_XCC_ID, 0, 4)
s_and_b32 s50, s50, 7
s_cmp_lg_u32 s3, 0
s_cbranch_scc1 tk_1
v_mov_b32 v2, 1
s_lshl_b32 s51, s50, 2
s_cmp_ge_u32 s50, 2
s_cselect_b32 s52, 128, 0
s_add_u32 s51, s51, s52
v_mov_b32 v3, s51
s_mov_b64 exec, 1
buffer_atomic_add v2, v3, s[12:15], 0 offen sc0
s_waitcnt vmcnt(0)
v_readfirstlane_b32 s51, v2
s_mov_b32 s52, 1
s_cmp_lt_u32 s51, 32
s_cbranch_scc1 native_2
v_mov_b32 v2, 1
v_mov_b32 v3, 32
buffer_atomic_add v2, v3, s[12:15], 0 offen sc0
s_waitcnt vmcnt(0)
v_readfirstlane_b32 s53, v2
s_mov_b64 exec, 0xff
v_lshlrev_b32 v3, 2, v0
v_add_u32 v5, 128, v3
v_cmp_le_u32 vcc, 2, v0
s_nop 1
v_cndmask_b32 v3, v3, v5, vcc
s_mov_b32 s98, 0
olp_3:
buffer_load_dword v4, v3, s[12:15], 0 offen sc1
s_add_u32 s98, s98, 1
s_cmp_gt_u32 s98, 150000
s_cbranch_scc1 obad_4
s_waitcnt vmcnt(0)
s_mov_b32 s54, 0
v_readlane_b32 s55, v4, 0
s_nop 0
s_add_u32 s54, s54, s55
v_readlane_b32 s55, v4, 1
s_nop 0
s_add_u32 s54, s54, s55
v_readlane_b32 s55, v4, 2
s_nop 0
s_add_u32 s54, s54, s55
v_readlane_b32 s55, v4, 3
s_nop 0
s_add_u32 s54, s54, s55
v_readlane_b32 s55, v4, 4
s_nop 0
s_add_u32 s54, s54, s55
v_readlane_b32 s55, v4, 5
s_nop 0
s_add_u32 s54, s54, s55
v_readlane_b32 s55, v4, 6
s_nop 0
s_add_u32 s54, s54, s55
v_readlane_b32 s55, v4, 7
s_nop 0
s_add_u32 s54, s54, s55
s_cmp_lt_u32 s54, 256
s_cbranch_scc1 olp_3
v_readlane_b32 s55, v4, 0
s_nop 0
s_min_u32 s55, s55, 32
s_sub_u32 s54, 32, s55
s_cmp_ge_u32 s53, s54
s_cbranch_scc1 onx_6
s_mov_b32 s50, 0
s_add_u32 s51, s55, s53
s_branch ofin_5
onx_6:
s_sub_u32 s53, s53, s54
v_readlane_b32 s55, v4, 1
s_nop 0
s_min_u32 s55, s55, 32
s_sub_u32 s54, 32, s55
s_cmp_ge_u32 s53, s54
s_cbranch_scc1 onx_7
s_mov_b32 s50, 1
s_add_u32 s51, s55, s53
s_branch ofin_5
onx_7:
s_sub_u32 s53, s53, s54
v_readlane_b32 s55, v4, 2
s_nop 0
s_min_u32 s55, s55, 32
s_sub_u32 s54, 32, s55
s_cmp_ge_u32 s53, s54
s_cbranch_scc1 onx_8
s_mov_b32 s50, 2
s_add_u32 s51, s55, s53
s_branch ofin_5
onx_8:
s_sub_u32 s53, s53, s54
v_readlane_b32 s55, v4, 3
s_nop 0
s_min_u32 s55, s55, 32
s_sub_u32 s54, 32, s55
s_cmp_ge_u32 s53, s54
s_cbranch_scc1 onx_9
s_mov_b32 s50, 3
s_add_u32 s51, s55, s53
s_branch ofin_5
onx_9:
s_sub_u32 s53, s53, s54
v_readlane_b32 s55, v4, 4
s_nop 0
s_min_u32 s55, s55, 32
s_sub_u32 s54, 32, s55
s_cmp_ge_u32 s53, s54
s_cbranch_scc1 onx_10
s_mov_b32 s50, 4
s_add_u32 s51, s55, s53
s_branch ofin_5
onx_10:
s_sub_u32 s53, s53, s54
v_readlane_b32 s55, v4, 5
s_nop 0
s_min_u32 s55, s55, 32
s_sub_u32 s54, 32, s55
s_cmp_ge_u32 s53, s54
s_cbranch_scc1 onx_11
s_mov_b32 s50, 5
s_add_u32 s51, s55, s53
s_branch ofin_5
onx_11:
s_sub_u32 s53, s53, s54
v_readlane_b32 s55, v4, 6
s_nop 0
s_min_u32 s55, s55, 32
s_sub_u32 s54, 32, s55
s_cmp_ge_u32 s53, s54
s_cbranch_scc1 onx_12
s_mov_b32 s50, 6
s_add_u32 s51, s55, s53
s_branch ofin_5
onx_12:
s_sub_u32 s53, s53, s54
v_readlane_b32 s55, v4, 7
s_nop 0
s_min_u32 s55, s55, 32
s_sub_u32 s54, 32, s55
s_cmp_ge_u32 s53, s54
s_cbranch_scc1 onx_13
s_mov_b32 s50, 7
s_add_u32 s51, s55, s53
s_branch ofin_5
onx_13:
s_sub_u32 s53, s53, s54
obad_4:
s_mov_b32 s50, 8
ofin_5:
s_mov_b32 s52, 0x10001
native_2:
s_mov_b64 exec, 1
v_mov_b32 v3, 0
v_mov_b32 v4, s50
v_mov_b32 v5, s51
v_mov_b32 v6, s52
v_mov_b32 v7, 0
ds_write_b128 v3, v[4:7]
s_mov_b64 exec, -1
s_waitcnt lgkmcnt(0)
tk_1:
s_barrier
v_mov_b32 v3, 0
ds_read_b128 v[4:7], v3
s_waitcnt lgkmcnt(0)
v_readfirstlane_b32 s50, v4
v_readfirstlane_b32 s51, v5
v_readfirstlane_b32 s52, v6
s_barrier
s_cmp_ge_u32 s50, 8
s_cbranch_scc1 L_end
s_cmp_ge_u32 s51, 32
s_cbranch_scc1 L_end
s_mov_b32 s100, s50
s_cmp_lt_u32 s50, 2
s_cbranch_scc1 L_chain
s_getpc_b64 s[96:97]
pc_14:
s_add_u32 s96, s96, L_roles-pc_14
s_addc_u32 s97, s97, 0
s_lshl_b32 s53, s50, 5
s_add_u32 s53, s53, s51
s_lshl_b32 s53, s53, 1
v_mov_b32 v1, s53
global_load_ushort v1, v1, s[96:97]
s_waitcnt vmcnt(0)
v_readfirstlane_b32 s53, v1
s_nop 0
s_and_b32 s74, s53, 0xff
s_lshr_b32 s53, s53, 8
s_cmp_eq_u32 s53, 0
s_cbranch_scc1 H_up
s_cmp_eq_u32 s53, 1
s_cbranch_scc1 H_dn
s_cmp_eq_u32 s53, 2
s_cbranch_scc1 H_wo
s_cmp_eq_u32 s53, 3
s_cbranch_scc1 H_att
s_cmp_eq_u32 s53, 4
s_cbranch_scc1 H_red
H_qkv:
s_lshl_b32 s75, s74, 2
s_add_u32 s75, s75, s3
s_mul_i32 s76, s75, 3
v_bfe_u32 v1, v0, 4, 1
v_lshlrev_b32 v1, 10, v1
v_lshrrev_b32 v2, 5, v0
v_lshl_add_u32 v1, v2, 8, v1
v_and_b32 v2, 15, v0
v_lshl_add_u32 v5, v2, 4, v1
v_lshlrev_b32 v6, 4, v0
s_add_u32 s77, s76, 0
s_lshr_b32 s78, s77, 8
s_and_b32 s77, s77, 255
s_lshl_b32 s48, s77, 5
s_cmp_eq_u32 s78, 0
s_cselect_b32 s80, s24, s26
s_cselect_b32 s81, s25, s27
s_cmp_eq_u32 s78, 2
s_cselect_b32 s80, s28, s80
s_cselect_b32 s81, s29, s81
s_mov_b32 s8, s80
s_and_b32 s9, s81, 0xffff
s_mov_b32 s10, 4718592
s_mov_b32 s11, 0x20000
s_lshr_b32 s79, s77, 3
s_mul_i32 s79, s79, 24576
s_lshl_b32 s82, s78, 13
s_add_u32 s79, s79, s82
s_and_b32 s82, s77, 7
s_lshl_b32 s83, s82, 10
s_and_b32 s84, s82, 1
s_lshl_b32 s84, s84, 9
s_andn2_b32 s82, s83, 1024
s_add_u32 s82, s82, s84
s_cmp_eq_u32 s78, 2
s_cselect_b32 s82, s83, s82
s_cselect_b64 vcc, -1, 0
s_add_u32 s79, s79, s82
v_cndmask_b32 v7, v5, v6, vcc
v_add_u32 v19, s79, v7
s_add_u32 s77, s76, 1
s_lshr_b32 s78, s77, 8
s_and_b32 s77, s77, 255
s_lshl_b32 s49, s77, 5
s_cmp_eq_u32 s78, 0
s_cselect_b32 s80, s24, s26
s_cselect_b32 s81, s25, s27
s_cmp_eq_u32 s78, 2
s_cselect_b32 s80, s28, s80
s_cselect_b32 s81, s29, s81
s_mov_b32 s12, s80
s_and_b32 s13, s81, 0xffff
s_mov_b32 s14, 4718592
s_mov_b32 s15, 0x20000
s_lshr_b32 s79, s77, 3
s_mul_i32 s79, s79, 24576
s_lshl_b32 s82, s78, 13
s_add_u32 s79, s79, s82
s_and_b32 s82, s77, 7
s_lshl_b32 s83, s82, 10
s_and_b32 s84, s82, 1
s_lshl_b32 s84, s84, 9
s_andn2_b32 s82, s83, 1024
s_add_u32 s82, s82, s84
s_cmp_eq_u32 s78, 2
s_cselect_b32 s82, s83, s82
s_cselect_b64 vcc, -1, 0
s_add_u32 s79, s79, s82
v_cndmask_b32 v7, v5, v6, vcc
v_add_u32 v20, s79, v7
s_add_u32 s77, s76, 2
s_lshr_b32 s78, s77, 8
s_and_b32 s77, s77, 255
s_lshl_b32 s50, s77, 5
s_cmp_eq_u32 s78, 0
s_cselect_b32 s80, s24, s26
s_cselect_b32 s81, s25, s27
s_cmp_eq_u32 s78, 2
s_cselect_b32 s80, s28, s80
s_cselect_b32 s81, s29, s81
s_mov_b32 s16, s80
s_and_b32 s17, s81, 0xffff
s_mov_b32 s18, 4718592
s_mov_b32 s19, 0x20000
s_lshr_b32 s79, s77, 3
s_mul_i32 s79, s79, 24576
s_lshl_b32 s82, s78, 13
s_add_u32 s79, s79, s82
s_and_b32 s82, s77, 7
s_lshl_b32 s83, s82, 10
s_and_b32 s84, s82, 1
s_lshl_b32 s84, s84, 9
s_andn2_b32 s82, s83, 1024
s_add_u32 s82, s82, s84
s_cmp_eq_u32 s78, 2
s_cselect_b32 s82, s83, s82
s_cselect_b64 vcc, -1, 0
s_add_u32 s79, s79, s82
v_cndmask_b32 v7, v5, v6, vcc
v_add_u32 v21, s79, v7
v_lshrrev_b32 v1, 5, v0
v_bfe_u32 v2, v0, 3, 1
v_lshl_add_u32 v1, v1, 1, v2
v_bfe_u32 v2, v0, 4, 1
v_bfe_u32 v3, v0, 1, 2
v_lshlrev_b32 v1, 3, v1
v_lshl_add_u32 v1, v2, 2, v1
v_add_u32 v1, v1, v3
v_mul_u32_u24 v1, 8192, v1
v_and_b32 v2, 1, v0
v_lshl_add_u32 v63, v2, 4, v1
s_mul_i32 s70, s3, 40960
v_lshrrev_b32 v1, 5, v0
v_lshlrev_b32 v1, 9, v1
v_bfe_u32 v2, v0, 4, 1
v_lshl_add_u32 v1, v2, 7, v1
v_add_u32 v1, s70, v1
v_and_b32 v2, 15, v0
v_lshl_add_u32 v2, v2, 3, v1
v_add_u32 v60, 0, v2
v_add_u32 v61, 1024, v2
v_add_u32 v62, 2048, v2
s_add_u32 m0, s70, 0
s_add_u32 s71, s48, 0
buffer_load_dwordx4 v63, s[8:11], s71 offen lds
s_add_u32 m0, s70, 1024
s_add_u32 s71, s49, 0
buffer_load_dwordx4 v63, s[12:15], s71 offen lds
s_add_u32 m0, s70, 2048
s_add_u32 s71, s50, 0
buffer_load_dwordx4 v63, s[16:19], s71 offen lds
s_add_u32 m0, s70, 3072
s_add_u32 s71, s48, 262144
buffer_load_dwordx4 v63, s[8:11], s71 offen lds
s_add_u32 m0, s70, 4096
s_add_u32 s71, s49, 262144
buffer_load_dwordx4 v63, s[12:15], s71 offen lds
s_add_u32 m0, s70, 5120
s_add_u32 s71, s50, 262144
buffer_load_dwordx4 v63, s[16:19], s71 offen lds
s_add_u32 m0, s70, 6144
s_add_u32 s71, s48, 524288
buffer_load_dwordx4 v63, s[8:11], s71 offen lds
s_add_u32 m0, s70, 7168
s_add_u32 s71, s49, 524288
buffer_load_dwordx4 v63, s[12:15], s71 offen lds
s_add_u32 m0, s70, 8192
s_add_u32 s71, s50, 524288
buffer_load_dwordx4 v63, s[16:19], s71 offen lds
s_add_u32 m0, s70, 9216
s_add_u32 s71, s48, 786432
buffer_load_dwordx4 v63, s[8:11], s71 offen lds
s_add_u32 m0, s70, 10240
s_add_u32 s71, s49, 786432
buffer_load_dwordx4 v63, s[12:15], s71 offen lds
s_add_u32 m0, s70, 11264
s_add_u32 s71, s50, 786432
buffer_load_dwordx4 v63, s[16:19], s71 offen lds
s_add_u32 m0, s70, 12288
s_add_u32 s71, s48, 1048576
buffer_load_dwordx4 v63, s[8:11], s71 offen lds
s_add_u32 m0, s70, 13312
s_add_u32 s71, s49, 1048576
buffer_load_dwordx4 v63, s[12:15], s71 offen lds
s_add_u32 m0, s70, 14336
s_add_u32 s71, s50, 1048576
buffer_load_dwordx4 v63, s[16:19], s71 offen lds
s_add_u32 m0, s70, 15360
s_add_u32 s71, s48, 1310720
buffer_load_dwordx4 v63, s[8:11], s71 offen lds
s_add_u32 m0, s70, 16384
s_add_u32 s71, s49, 1310720
buffer_load_dwordx4 v63, s[12:15], s71 offen lds
s_add_u32 m0, s70, 17408
s_add_u32 s71, s50, 1310720
buffer_load_dwordx4 v63, s[16:19], s71 offen lds
s_add_u32 m0, s70, 18432
s_add_u32 s71, s48, 1572864
buffer_load_dwordx4 v63, s[8:11], s71 offen lds
s_add_u32 m0, s70, 19456
s_add_u32 s71, s49, 1572864
buffer_load_dwordx4 v63, s[12:15], s71 offen lds
s_add_u32 m0, s70, 20480
s_add_u32 s71, s50, 1572864
buffer_load_dwordx4 v63, s[16:19], s71 offen lds
s_add_u32 m0, s70, 21504
s_add_u32 s71, s48, 1835008
buffer_load_dwordx4 v63, s[8:11], s71 offen lds
s_add_u32 m0, s70, 22528
s_add_u32 s71, s49, 1835008
buffer_load_dwordx4 v63, s[12:15], s71 offen lds
s_add_u32 m0, s70, 23552
s_add_u32 s71, s50, 1835008
buffer_load_dwordx4 v63, s[16:19], s71 offen lds
s_add_u32 m0, s70, 24576
s_add_u32 s71, s48, 2097152
buffer_load_dwordx4 v63, s[8:11], s71 offen lds
s_add_u32 m0, s70, 25600
s_add_u32 s71, s49, 2097152
buffer_load_dwordx4 v63, s[12:15], s71 offen lds
s_add_u32 m0, s70, 26624
s_add_u32 s71, s50, 2097152
buffer_load_dwordx4 v63, s[16:19], s71 offen lds
s_add_u32 m0, s70, 27648
s_add_u32 s71, s48, 2359296
buffer_load_dwordx4 v63, s[8:11], s71 offen lds
s_add_u32 m0, s70, 28672
s_add_u32 s71, s49, 2359296
buffer_load_dwordx4 v63, s[12:15], s71 offen lds
s_add_u32 m0, s70, 29696
s_add_u32 s71, s50, 2359296
buffer_load_dwordx4 v63, s[16:19], s71 offen lds
s_add_u32 m0, s70, 30720
s_add_u32 s71, s48, 2621440
buffer_load_dwordx4 v63, s[8:11], s71 offen lds
s_add_u32 m0, s70, 31744
s_add_u32 s71, s49, 2621440
buffer_load_dwordx4 v63, s[12:15], s71 offen lds
s_add_u32 m0, s70, 32768
s_add_u32 s71, s50, 2621440
buffer_load_dwordx4 v63, s[16:19], s71 offen lds
s_add_u32 m0, s70, 33792
s_add_u32 s71, s48, 2883584
buffer_load_dwordx4 v63, s[8:11], s71 offen lds
s_add_u32 m0, s70, 34816
s_add_u32 s71, s49, 2883584
buffer_load_dwordx4 v63, s[12:15], s71 offen lds
s_add_u32 m0, s70, 35840
s_add_u32 s71, s50, 2883584
buffer_load_dwordx4 v63, s[16:19], s71 offen lds
s_add_u32 m0, s70, 36864
s_add_u32 s71, s48, 3145728
buffer_load_dwordx4 v63, s[8:11], s71 offen lds
s_add_u32 m0, s70, 37888
s_add_u32 s71, s49, 3145728
buffer_load_dwordx4 v63, s[12:15], s71 offen lds
s_add_u32 m0, s70, 38912
s_add_u32 s71, s50, 3145728
buffer_load_dwordx4 v63, s[16:19], s71 offen lds
s_waitcnt vmcnt(36)
ds_read_b64_tr_b16 a[0:1], v60 offset:0
ds_read_b64_tr_b16 a[2:3], v60 offset:256
ds_read_b64_tr_b16 a[72:73], v61 offset:0
ds_read_b64_tr_b16 a[74:75], v61 offset:256
ds_read_b64_tr_b16 a[144:145], v62 offset:0
ds_read_b64_tr_b16 a[146:147], v62 offset:256
s_waitcnt lgkmcnt(0)
s_add_u32 m0, s70, 0
s_add_u32 s71, s48, 3407872
buffer_load_dwordx4 v63, s[8:11], s71 offen lds
s_add_u32 m0, s70, 1024
s_add_u32 s71, s49, 3407872
buffer_load_dwordx4 v63, s[12:15], s71 offen lds
s_add_u32 m0, s70, 2048
s_add_u32 s71, s50, 3407872
buffer_load_dwordx4 v63, s[16:19], s71 offen lds
s_waitcnt vmcnt(36)
ds_read_b64_tr_b16 a[4:5], v60 offset:3072
ds_read_b64_tr_b16 a[6:7], v60 offset:3328
ds_read_b64_tr_b16 a[76:77], v61 offset:3072
ds_read_b64_tr_b16 a[78:79], v61 offset:3328
ds_read_b64_tr_b16 a[148:149], v62 offset:3072
ds_read_b64_tr_b16 a[150:151], v62 offset:3328
s_waitcnt lgkmcnt(0)
s_add_u32 m0, s70, 3072
s_add_u32 s71, s48, 3670016
buffer_load_dwordx4 v63, s[8:11], s71 offen lds
s_add_u32 m0, s70, 4096
s_add_u32 s71, s49, 3670016
buffer_load_dwordx4 v63, s[12:15], s71 offen lds
s_add_u32 m0, s70, 5120
s_add_u32 s71, s50, 3670016
buffer_load_dwordx4 v63, s[16:19], s71 offen lds
s_waitcnt vmcnt(36)
ds_read_b64_tr_b16 a[8:9], v60 offset:6144
ds_read_b64_tr_b16 a[10:11], v60 offset:6400
ds_read_b64_tr_b16 a[80:81], v61 offset:6144
ds_read_b64_tr_b16 a[82:83], v61 offset:6400
ds_read_b64_tr_b16 a[152:153], v62 offset:6144
ds_read_b64_tr_b16 a[154:155], v62 offset:6400
s_waitcnt lgkmcnt(0)
s_add_u32 m0, s70, 6144
s_add_u32 s71, s48, 3932160
buffer_load_dwordx4 v63, s[8:11], s71 offen lds
s_add_u32 m0, s70, 7168
s_add_u32 s71, s49, 3932160
buffer_load_dwordx4 v63, s[12:15], s71 offen lds
s_add_u32 m0, s70, 8192
s_add_u32 s71, s50, 3932160
buffer_load_dwordx4 v63, s[16:19], s71 offen lds
s_waitcnt vmcnt(36)
ds_read_b64_tr_b16 a[12:13], v60 offset:9216
ds_read_b64_tr_b16 a[14:15], v60 offset:9472
ds_read_b64_tr_b16 a[84:85], v61 offset:9216
ds_read_b64_tr_b16 a[86:87], v61 offset:9472
ds_read_b64_tr_b16 a[156:157], v62 offset:9216
ds_read_b64_tr_b16 a[158:159], v62 offset:9472
s_waitcnt lgkmcnt(0)
s_add_u32 m0, s70, 9216
s_add_u32 s71, s48, 4194304
buffer_load_dwordx4 v63, s[8:11], s71 offen lds
s_add_u32 m0, s70, 10240
s_add_u32 s71, s49, 4194304
buffer_load_dwordx4 v63, s[12:15], s71 offen lds
s_add_u32 m0, s70, 11264
s_add_u32 s71, s50, 4194304
buffer_load_dwordx4 v63, s[16:19], s71 offen lds
s_waitcnt vmcnt(36)
ds_read_b64_tr_b16 a[16:17], v60 offset:12288
ds_read_b64_tr_b16 a[18:19], v60 offset:12544
ds_read_b64_tr_b16 a[88:89], v61 offset:12288
ds_read_b64_tr_b16 a[90:91], v61 offset:12544
ds_read_b64_tr_b16 a[160:161], v62 offset:12288
ds_read_b64_tr_b16 a[162:163], v62 offset:12544
s_waitcnt lgkmcnt(0)
s_add_u32 m0, s70, 12288
s_add_u32 s71, s48, 4456448
buffer_load_dwordx4 v63, s[8:11], s71 offen lds
s_add_u32 m0, s70, 13312
s_add_u32 s71, s49, 4456448
buffer_load_dwordx4 v63, s[12:15], s71 offen lds
s_add_u32 m0, s70, 14336
s_add_u32 s71, s50, 4456448
buffer_load_dwordx4 v63, s[16:19], s71 offen lds
s_waitcnt vmcnt(36)
ds_read_b64_tr_b16 a[20:21], v60 offset:15360
ds_read_b64_tr_b16 a[22:23], v60 offset:15616
ds_read_b64_tr_b16 a[92:93], v61 offset:15360
ds_read_b64_tr_b16 a[94:95], v61 offset:15616
ds_read_b64_tr_b16 a[164:165], v62 offset:15360
ds_read_b64_tr_b16 a[166:167], v62 offset:15616
s_waitcnt vmcnt(33)
ds_read_b64_tr_b16 a[24:25], v60 offset:18432
ds_read_b64_tr_b16 a[26:27], v60 offset:18688
ds_read_b64_tr_b16 a[96:97], v61 offset:18432
ds_read_b64_tr_b16 a[98:99], v61 offset:18688
ds_read_b64_tr_b16 a[168:169], v62 offset:18432
ds_read_b64_tr_b16 a[170:171], v62 offset:18688
s_waitcnt vmcnt(30)
ds_read_b64_tr_b16 a[28:29], v60 offset:21504
ds_read_b64_tr_b16 a[30:31], v60 offset:21760
ds_read_b64_tr_b16 a[100:101], v61 offset:21504
ds_read_b64_tr_b16 a[102:103], v61 offset:21760
ds_read_b64_tr_b16 a[172:173], v62 offset:21504
ds_read_b64_tr_b16 a[174:175], v62 offset:21760
s_waitcnt vmcnt(27)
ds_read_b64_tr_b16 a[32:33], v60 offset:24576
ds_read_b64_tr_b16 a[34:35], v60 offset:24832
ds_read_b64_tr_b16 a[104:105], v61 offset:24576
ds_read_b64_tr_b16 a[106:107], v61 offset:24832
ds_read_b64_tr_b16 a[176:177], v62 offset:24576
ds_read_b64_tr_b16 a[178:179], v62 offset:24832
s_waitcnt vmcnt(24)
ds_read_b64_tr_b16 a[36:37], v60 offset:27648
ds_read_b64_tr_b16 a[38:39], v60 offset:27904
ds_read_b64_tr_b16 a[108:109], v61 offset:27648
ds_read_b64_tr_b16 a[110:111], v61 offset:27904
ds_read_b64_tr_b16 a[180:181], v62 offset:27648
ds_read_b64_tr_b16 a[182:183], v62 offset:27904
s_waitcnt vmcnt(21)
ds_read_b64_tr_b16 a[40:41], v60 offset:30720
ds_read_b64_tr_b16 a[42:43], v60 offset:30976
ds_read_b64_tr_b16 a[112:113], v61 offset:30720
ds_read_b64_tr_b16 a[114:115], v61 offset:30976
ds_read_b64_tr_b16 a[184:185], v62 offset:30720
ds_read_b64_tr_b16 a[186:187], v62 offset:30976
s_waitcnt vmcnt(18)
ds_read_b64_tr_b16 a[44:45], v60 offset:33792
ds_read_b64_tr_b16 a[46:47], v60 offset:34048
ds_read_b64_tr_b16 a[116:117], v61 offset:33792
ds_read_b64_tr_b16 a[118:119], v61 offset:34048
ds_read_b64_tr_b16 a[188:189], v62 offset:33792
ds_read_b64_tr_b16 a[190:191], v62 offset:34048
s_waitcnt vmcnt(15)
ds_read_b64_tr_b16 a[48:49], v60 offset:36864
ds_read_b64_tr_b16 a[50:51], v60 offset:37120
ds_read_b64_tr_b16 a[120:121], v61 offset:36864
ds_read_b64_tr_b16 a[122:123], v61 offset:37120
ds_read_b64_tr_b16 a[192:193], v62 offset:36864
ds_read_b64_tr_b16 a[194:195], v62 offset:37120
s_waitcnt vmcnt(12)
ds_read_b64_tr_b16 a[52:53], v60 offset:0
ds_read_b64_tr_b16 a[54:55], v60 offset:256
ds_read_b64_tr_b16 a[124:125], v61 offset:0
ds_read_b64_tr_b16 a[126:127], v61 offset:256
ds_read_b64_tr_b16 a[196:197], v62 offset:0
ds_read_b64_tr_b16 a[198:199], v62 offset:256
s_waitcnt vmcnt(9)
ds_read_b64_tr_b16 a[56:57], v60 offset:3072
ds_read_b64_tr_b16 a[58:59], v60 offset:3328
ds_read_b64_tr_b16 a[128:129], v61 offset:3072
ds_read_b64_tr_b16 a[130:131], v61 offset:3328
ds_read_b64_tr_b16 a[200:201], v62 offset:3072
ds_read_b64_tr_b16 a[202:203], v62 offset:3328
s_waitcnt vmcnt(6)
ds_read_b64_tr_b16 a[60:61], v60 offset:6144
ds_read_b64_tr_b16 a[62:63], v60 offset:6400
ds_read_b64_tr_b16 a[132:133], v61 offset:6144
ds_read_b64_tr_b16 a[134:135], v61 offset:6400
ds_read_b64_tr_b16 a[204:205], v62 offset:6144
ds_read_b64_tr_b16 a[206:207], v62 offset:6400
s_waitcnt vmcnt(3)
ds_read_b64_tr_b16 a[64:65], v60 offset:9216
ds_read_b64_tr_b16 a[66:67], v60 offset:9472
ds_read_b64_tr_b16 a[136:137], v61 offset:9216
ds_read_b64_tr_b16 a[138:139], v61 offset:9472
ds_read_b64_tr_b16 a[208:209], v62 offset:9216
ds_read_b64_tr_b16 a[210:211], v62 offset:9472
s_waitcnt vmcnt(0)
ds_read_b64_tr_b16 a[68:69], v60 offset:12288
ds_read_b64_tr_b16 a[70:71], v60 offset:12544
ds_read_b64_tr_b16 a[140:141], v61 offset:12288
ds_read_b64_tr_b16 a[142:143], v61 offset:12544
ds_read_b64_tr_b16 a[212:213], v62 offset:12288
ds_read_b64_tr_b16 a[214:215], v62 offset:12544
s_waitcnt lgkmcnt(0)
v_lshrrev_b32 v1, 3, v0
v_bfe_u32 v2, v0, 1, 2
v_lshrrev_b32 v3, 5, v0
v_lshlrev_b32 v3, 1, v3
v_xor_b32 v2, v2, v3
v_mul_u32_u24 v1, 2304, v1
v_lshl_add_u32 v1, v2, 5, v1
v_and_b32 v2, 1, v0
v_lshl_add_u32 v1, v2, 4, v1
s_and_b32 s70, s3, 1
s_mul_i32 s70, s70, 18432
s_lshr_b32 s71, s3, 1
s_lshl_b32 s71, s71, 7
s_add_u32 s70, s70, s71
v_add_u32 v1, s70, v1
v_add_u32 v8, 4096, v1
v_add_u32 v9, 3328, v1
v_add_u32 v10, 2560, v1
v_add_u32 v11, 1792, v1
v_add_u32 v12, 5120, v1
v_add_u32 v13, 4352, v1
v_add_u32 v14, 3584, v1
v_add_u32 v15, 2816, v1
v_add_u32 v16, 6144, v1
v_bfe_u32 v1, v0, 1, 3
v_lshlrev_b32 v1, 7, v1
v_lshrrev_b32 v2, 4, v0
v_bfe_u32 v3, v0, 3, 1
v_lshlrev_b32 v3, 1, v3
v_xor_b32 v2, v2, v3
v_lshl_add_u32 v1, v2, 5, v1
v_and_b32 v2, 1, v0
v_lshl_add_u32 v17, v2, 4, v1
v_and_b32 v2, 31, v0
v_add_u32 v1, 0, v2
v_mul_u32_u24 v1, 128, v1
v_lshrrev_b32 v3, 5, v0
v_xor_b32 v3, 1, v3
v_mul_u32_u24 v3, 32768, v3
v_add_u32 v1, 0, v1
v_add_u32 v1, v1, v3
v_mov_b32 v3, 2147483632
s_cmp_eq_u32 s3, 0
s_cselect_b32 s71, 16, 0
v_cmp_gt_u32 vcc, s71, v2
s_nop 1
v_cndmask_b32 v22, v3, v1, vcc
s_mov_b32 s56, 0xffff
s_mul_i32 s70, s74, 128
s_add_u32 s70, s70, 2048
v_mov_b32 v1, s70
s_min_u32 s71, s71, 1
v_cmp_gt_u32 vcc, s71, v0
s_nop 1
v_cndmask_b32 v44, v3, v1, vcc
v_add_u32 v45, 65536, v44
s_getpc_b64 s[96:97]
pc_15:
s_add_u32 s96, s96, L_writers-pc_15
s_addc_u32 s97, s97, 0
v_subrev_u32 v23, 0, v22
v_lshrrev_b32 v23, 7, v23
v_cmp_gt_u32 vcc, 0x200, v23
s_nop 1
v_cndmask_b32 v23, 0, v23, vcc
global_load_ubyte v23, v23, s[96:97]
s_mov_b32 s44, 3702784
s_mov_b32 s45, 60366848
s_mov_b32 s52, 1
s_mov_b32 s53, 32768
s_mov_b32 s46, 1343488
s_mov_b32 s47, 10035200
s_mov_b32 s54, 1
s_mov_b32 s55, 0
s_mov_b32 s25, 64
s_mov_b32 s20, 36864
s_mov_b32 s21, 786432
s_cmp_lt_u32 s75, 170
s_cbranch_scc1 G_sss18
s_cmp_eq_u32 s75, 170
s_cbranch_scc1 G_ssv18
s_mov_b32 s8, s42
s_and_b32 s9, s43, 0xffff
s_mov_b32 s10, 0
s_mov_b32 s11, 0x20000
s_mov_b32 s22, 0
s_mul_i32 s48, s3, 9216
s_add_u32 s49, s48, 36864
s_add_u32 s50, s48, 73728
s_add_u32 s51, s48, 110592
s_mov_b32 s57, 0xbfb8aa3b
v_add_u32 v28, 0, v17
v_add_u32 v29, 36864, v17
v_add_u32 v30, 73728, v17
v_add_u32 v31, 110592, v17
v_lshlrev_b32 v1, 2, v0
v_add_u32 v32, 147456, v1
s_lshl_b32 s70, s3, 8
v_add_u32 v18, s70, v32
v_mov_b64 v[224:225], 0
v_mov_b64 v[236:237], 0
v_mov_b64 v[226:227], 0
v_mov_b64 v[238:239], 0
v_mov_b64 v[228:229], 0
v_mov_b64 v[240:241], 0
v_mov_b64 v[230:231], 0
v_mov_b64 v[242:243], 0
s_mov_b32 s12, s40
s_and_b32 s13, s41, 0xffff
s_mov_b32 s14, 256
s_mov_b32 s15, 0x20000
v_lshlrev_b32 v26, 2, v0
v_add_u32 v27, 128, v26
v_cmp_le_u32 vcc, 2, v0
s_nop 1
v_cndmask_b32 v26, v26, v27, vcc
v_mov_b32 v27, 192
v_cmp_eq_u32 vcc, 8, v0
s_nop 1
v_cndmask_b32 v26, v26, v27, vcc
v_mov_b32 v27, 2147483632
v_cmp_lt_u32 vcc, 8, v0
s_nop 1
v_cndmask_b32 v26, v26, v27, vcc
s_mov_b32 s98, 0
wi_loop_21:
buffer_load_dword v27, v26, s[12:15], 0 offen sc1
s_add_u32 s98, s98, 1
s_cmp_gt_u32 s98, 150000
s_cbranch_scc1 wi_bad_23
s_waitcnt vmcnt(0)
v_cmp_eq_u32 vcc, 32, v27
s_nop 0
s_and_b32 s97, vcc_lo, 0x1ff
s_cmp_eq_u32 s97, 0x1ff
s_cbranch_scc1 wi_ok_22
v_cmp_lt_u32 vcc, 32, v27
s_nop 0
s_and_b32 s96, vcc_lo, 0xff
s_cselect_b32 s96, 0x100, 0
s_and_b32 s96, s96, s97
s_cbranch_scc1 wi_over_24
s_sleep 8
s_branch wi_loop_21
wi_bad_23:
s_mov_b32 s98, 512
s_branch L_fail
wi_over_24:
s_mov_b32 s100, 255
wi_ok_22:
v_add_u32 v26, 65536, v22
v_cmp_eq_u32 vcc, s100, v23
s_nop 1
v_cndmask_b32 v22, v22, v26, vcc
s_mov_b32 s90, 0
s_mov_b32 s91, 1879048192
s_mov_b32 s93, 1879048192
v_mov_b32 v34, 2147483632
s_barrier
s_mov_b32 s95, 1
s_cmp_lg_u32 s3, 0
s_cbranch_scc1 sp_ok_26_j
s_mov_b32 s23, 0
sp_loop_25:
buffer_load_dword v33, v22, s[4:7], 0 offen sc1
s_add_u32 s23, s23, 1
s_cmp_gt_u32 s23, 150000
s_cbranch_scc1 sp_bad_27
s_waitcnt vmcnt(0)
sp_loop_25_e:
v_cmp_gt_u32 vcc, s52, v33
v_cmp_gt_u32 s[58:59], s54, v33
s_and_b32 vcc_lo, vcc_lo, s56
s_cbranch_scc0 sp_ok_26
s_cmp_gt_u32 s23, 4
s_cselect_b32 s70, 0, s56
s_cmp_lg_u32 s95, 0
s_cselect_b32 s70, 0, s70
s_or_b32 s59, s59, s70
s_and_b32 s59, s59, s56
s_cbranch_scc0 sp_ok_26
s_sleep 1
s_branch sp_loop_25
sp_bad_27:
s_mov_b32 s98, 1025
s_branch L_fail
sp_ok_26:
ds_write_b32 v18, v33
s_waitcnt lgkmcnt(0)
sp_ok_26_j:
s_barrier
ds_read_b32 v33, v32
s_waitcnt lgkmcnt(0)
v_cmp_gt_u32 vcc, s52, v33
v_cmp_gt_u32 s[58:59], s54, v33
s_and_b32 vcc_lo, vcc_lo, s56
s_cselect_b32 s70, 0, 1
s_and_b32 s59, s59, s56
s_cselect_b32 s71, 0, 1
s_or_b32 s76, s70, s71
s_cselect_b32 s10, 268435456, 0
s_cmp_lg_u32 s70, 0
s_cselect_b64 s[72:73], s[52:53], s[54:55]
s_cselect_b64 s[58:59], s[44:45], s[46:47]
s_mul_i32 s74, s72, s20
s_add_u32 s74, s74, s58
s_mul_i32 s75, s72, s21
s_add_u32 s75, s75, s59
s_andn2_b32 s71, s71, s70
s_add_u32 s52, s52, s70
s_add_u32 s54, s54, s71
s_mov_b32 s77, s76
s_add_u32 m0, s48, 0
s_nop 0
buffer_load_dwordx4 v8, s[4:7], s74 offen offset:0 sc1 lds
buffer_load_dwordx4 v9, s[4:7], s74 offen offset:1024 sc1 lds
buffer_load_dwordx4 v10, s[4:7], s74 offen offset:2048 sc1 lds
buffer_load_dwordx4 v11, s[4:7], s74 offen offset:3072 sc1 lds
s_add_u32 m0, s48, 4096
s_nop 0
buffer_load_dwordx4 v12, s[4:7], s74 offen offset:0 sc1 lds
buffer_load_dwordx4 v13, s[4:7], s74 offen offset:1024 sc1 lds
buffer_load_dwordx4 v14, s[4:7], s74 offen offset:2048 sc1 lds
buffer_load_dwordx4 v15, s[4:7], s74 offen offset:3072 sc1 lds
s_add_u32 m0, s48, 8192
s_nop 0
buffer_load_dwordx4 v16, s[4:7], s74 offen offset:0 sc1 lds
buffer_load_dword v24, v22, s[4:7], 0 offen sc1
buffer_store_dword v27, v34, s[4:7], 0 offen
v_mov_b32 v27, s90
s_waitcnt vmcnt(9)
s_barrier
buffer_store_dword v27, v45, s[4:7], s91 offen
buffer_store_dword v27, v44, s[4:7], s91 offen sc1
s_mov_b32 s91, 1879048192
ds_read_b128 v[64:67], v28 offset:0
ds_read_b128 v[68:71], v28 offset:9216
ds_read_b128 v[72:75], v28 offset:18432
ds_read_b128 v[76:79], v28 offset:27648
ds_read_b128 v[80:83], v28 offset:1024
ds_read_b128 v[84:87], v28 offset:10240
ds_read_b128 v[88:91], v28 offset:19456
ds_read_b128 v[92:95], v28 offset:28672
s_waitcnt vmcnt(8)
s_barrier
s_branch g_body_16
g_body_16:
s_waitcnt lgkmcnt(4)
v_mfma_f32_16x16x32_bf16 v[208:211], v[64:67], a[0:3], 0
ds_read_b128 v[96:99], v28 offset:2048
v_mfma_f32_16x16x32_bf16 v[212:215], v[68:71], a[0:3], 0
ds_read_b128 v[100:103], v28 offset:11264
v_mfma_f32_16x16x32_bf16 v[216:219], v[64:67], a[72:75], 0
v_mfma_f32_16x16x32_bf16 v[208:211], v[72:75], a[4:7], v[208:211]
ds_read_b128 v[104:107], v28 offset:20480
v_cvt_pk_bf16_f32 v56, v224, v225
v_mfma_f32_16x16x32_bf16 v[212:215], v[76:79], a[4:7], v[212:215]
ds_read_b128 v[108:111], v28 offset:29696
v_cvt_pk_bf16_f32 v57, v226, v227
v_mfma_f32_16x16x32_bf16 v[220:223], v[68:71], a[72:75], 0
v_cvt_pk_bf16_f32 v58, v228, v229
s_waitcnt lgkmcnt(4)
v_mfma_f32_16x16x32_bf16 v[208:211], v[80:83], a[8:11], v[208:211]
ds_read_b128 v[112:115], v28 offset:3072
v_cvt_pk_bf16_f32 v59, v230, v231
v_mfma_f32_16x16x32_bf16 v[212:215], v[84:87], a[8:11], v[212:215]
ds_read_b128 v[116:119], v28 offset:12288
v_mfma_f32_16x16x32_bf16 v[216:219], v[72:75], a[76:79], v[216:219]
buffer_store_dwordx4 v[56:59], v21, s[4:7], s93 offen sc1
v_mfma_f32_16x16x32_bf16 v[208:211], v[88:91], a[12:15], v[208:211]
ds_read_b128 v[120:123], v28 offset:21504
v_mfma_f32_16x16x32_bf16 v[212:215], v[92:95], a[12:15], v[212:215]
ds_read_b128 v[124:127], v28 offset:30720
v_mfma_f32_16x16x32_bf16 v[220:223], v[76:79], a[76:79], v[220:223]
s_waitcnt lgkmcnt(4)
v_mfma_f32_16x16x32_bf16 v[208:211], v[96:99], a[16:19], v[208:211]
ds_read_b128 v[128:131], v28 offset:4096
v_mfma_f32_16x16x32_bf16 v[212:215], v[100:103], a[16:19], v[212:215]
ds_read_b128 v[132:135], v28 offset:13312
v_mfma_f32_16x16x32_bf16 v[216:219], v[80:83], a[80:83], v[216:219]
v_mfma_f32_16x16x32_bf16 v[208:211], v[104:107], a[20:23], v[208:211]
ds_read_b128 v[136:139], v28 offset:22528
v_mfma_f32_16x16x32_bf16 v[212:215], v[108:111], a[20:23], v[212:215]
ds_read_b128 v[140:143], v28 offset:31744
v_mfma_f32_16x16x32_bf16 v[220:223], v[84:87], a[80:83], v[220:223]
s_waitcnt vmcnt(5)
s_barrier
s_waitcnt lgkmcnt(4)
v_mfma_f32_16x16x32_bf16 v[208:211], v[112:115], a[24:27], v[208:211]
ds_read_b128 v[144:147], v28 offset:5120
v_mov_b32 v27, s90
v_mfma_f32_16x16x32_bf16 v[212:215], v[116:119], a[24:27], v[212:215]
ds_read_b128 v[148:151], v28 offset:14336
v_mfma_f32_16x16x32_bf16 v[216:219], v[88:91], a[84:87], v[216:219]
v_mfma_f32_16x16x32_bf16 v[208:211], v[120:123], a[28:31], v[208:211]
ds_read_b128 v[152:155], v28 offset:23552
v_mfma_f32_16x16x32_bf16 v[212:215], v[124:127], a[28:31], v[212:215]
ds_read_b128 v[156:159], v28 offset:32768
v_mfma_f32_16x16x32_bf16 v[220:223], v[92:95], a[84:87], v[220:223]
s_waitcnt lgkmcnt(4)
v_mfma_f32_16x16x32_bf16 v[208:211], v[128:131], a[32:35], v[208:211]
ds_read_b128 v[160:163], v28 offset:6144
v_mfma_f32_16x16x32_bf16 v[212:215], v[132:135], a[32:35], v[212:215]
ds_read_b128 v[164:167], v28 offset:15360
v_mfma_f32_16x16x32_bf16 v[216:219], v[96:99], a[88:91], v[216:219]
v_mfma_f32_16x16x32_bf16 v[208:211], v[136:139], a[36:39], v[208:211]
ds_read_b128 v[168:171], v28 offset:24576
v_mfma_f32_16x16x32_bf16 v[212:215], v[140:143], a[36:39], v[212:215]
ds_read_b128 v[172:175], v28 offset:33792
v_mfma_f32_16x16x32_bf16 v[220:223], v[100:103], a[88:91], v[220:223]
s_waitcnt lgkmcnt(4)
v_mfma_f32_16x16x32_bf16 v[208:211], v[144:147], a[40:43], v[208:211]
ds_read_b128 v[176:179], v28 offset:7168
v_mfma_f32_16x16x32_bf16 v[212:215], v[148:151], a[40:43], v[212:215]
ds_read_b128 v[180:183], v28 offset:16384
s_waitcnt vmcnt(4)
ds_write_b32 v18, v24
v_mfma_f32_16x16x32_bf16 v[216:219], v[104:107], a[92:95], v[216:219]
v_mfma_f32_16x16x32_bf16 v[208:211], v[152:155], a[44:47], v[208:211]
ds_read_b128 v[184:187], v28 offset:25600
v_mfma_f32_16x16x32_bf16 v[212:215], v[156:159], a[44:47], v[212:215]
ds_read_b128 v[188:191], v28 offset:34816
s_waitcnt lgkmcnt(2)
s_barrier
v_mfma_f32_16x16x32_bf16 v[220:223], v[108:111], a[92:95], v[220:223]
ds_read_b32 v33, v32
v_mfma_f32_16x16x32_bf16 v[208:211], v[160:163], a[48:51], v[208:211]
ds_read_b128 v[192:195], v28 offset:8192
v_mfma_f32_16x16x32_bf16 v[212:215], v[164:167], a[48:51], v[212:215]
ds_read_b128 v[196:199], v28 offset:17408
v_mfma_f32_16x16x32_bf16 v[216:219], v[112:115], a[96:99], v[216:219]
s_waitcnt lgkmcnt(2)
v_cmp_gt_u32 vcc, s52, v33
v_mfma_f32_16x16x32_bf16 v[208:211], v[168:171], a[52:55], v[208:211]
ds_read_b128 v[200:203], v28 offset:26624
v_cmp_gt_u32 s[58:59], s54, v33
v_mfma_f32_16x16x32_bf16 v[212:215], v[172:175], a[52:55], v[212:215]
ds_read_b128 v[204:207], v28 offset:35840
s_and_b32 vcc_lo, vcc_lo, s56
s_cselect_b32 s70, 0, 1
v_mfma_f32_16x16x32_bf16 v[220:223], v[116:119], a[96:99], v[220:223]
v_mfma_f32_16x16x32_bf16 v[208:211], v[176:179], a[56:59], v[208:211]
s_and_b32 s59, s59, s56
s_cselect_b32 s71, 0, s77
v_mfma_f32_16x16x32_bf16 v[212:215], v[180:183], a[56:59], v[212:215]
s_or_b32 s82, s70, s71
s_cselect_b32 s10, 268435456, 0
v_mfma_f32_16x16x32_bf16 v[216:219], v[120:123], a[100:103], v[216:219]
s_cmp_lg_u32 s70, 0
s_cselect_b64 s[78:79], s[52:53], s[54:55]
s_cselect_b64 s[58:59], s[44:45], s[46:47]
v_mfma_f32_16x16x32_bf16 v[208:211], v[184:187], a[60:63], v[208:211]
s_mul_i32 s80, s78, s20
s_add_u32 s80, s80, s58
v_mfma_f32_16x16x32_bf16 v[212:215], v[188:191], a[60:63], v[212:215]
s_add_u32 m0, s49, 0
s_mul_i32 s81, s78, s21
s_add_u32 s81, s81, s59
v_mfma_f32_16x16x32_bf16 v[220:223], v[124:127], a[100:103], v[220:223]
buffer_load_dwordx4 v8, s[8:11], s80 offen offset:0 sc1 lds
s_waitcnt lgkmcnt(0)
v_mfma_f32_16x16x32_bf16 v[208:211], v[192:195], a[64:67], v[208:211]
s_andn2_b32 s71, s71, s70
s_add_u32 s52, s52, s70
s_add_u32 s54, s54, s71
v_mfma_f32_16x16x32_bf16 v[212:215], v[196:199], a[64:67], v[212:215]
s_mov_b32 s83, s82
v_mfma_f32_16x16x32_bf16 v[216:219], v[128:131], a[104:107], v[216:219]
buffer_load_dwordx4 v9, s[8:11], s80 offen offset:1024 sc1 lds
v_mfma_f32_16x16x32_bf16 v[208:211], v[200:203], a[68:71], v[208:211]
v_mfma_f32_16x16x32_bf16 v[212:215], v[204:207], a[68:71], v[212:215]
v_mfma_f32_16x16x32_bf16 v[220:223], v[132:135], a[104:107], v[220:223]
buffer_load_dwordx4 v10, s[8:11], s80 offen offset:2048 sc1 lds
v_mfma_f32_16x16x32_bf16 v[216:219], v[136:139], a[108:111], v[216:219]
v_mfma_f32_16x16x32_bf16 v[220:223], v[140:143], a[108:111], v[220:223]
v_mfma_f32_16x16x32_bf16 v[216:219], v[144:147], a[112:115], v[216:219]
buffer_load_dwordx4 v11, s[8:11], s80 offen offset:3072 sc1 lds
v_mfma_f32_16x16x32_bf16 v[220:223], v[148:151], a[112:115], v[220:223]
v_mfma_f32_16x16x32_bf16 v[216:219], v[152:155], a[116:119], v[216:219]
s_add_u32 m0, s49, 4096
v_cvt_pk_bf16_f32 v48, v208, v209
v_mfma_f32_16x16x32_bf16 v[220:223], v[156:159], a[116:119], v[220:223]
buffer_load_dwordx4 v12, s[8:11], s80 offen offset:0 sc1 lds
v_mfma_f32_16x16x32_bf16 v[216:219], v[160:163], a[120:123], v[216:219]
v_cvt_pk_bf16_f32 v49, v210, v211
v_cvt_pk_bf16_f32 v50, v212, v213
v_mfma_f32_16x16x32_bf16 v[220:223], v[164:167], a[120:123], v[220:223]
v_cvt_pk_bf16_f32 v51, v214, v215
v_mfma_f32_16x16x32_bf16 v[216:219], v[168:171], a[124:127], v[216:219]
buffer_load_dwordx4 v13, s[8:11], s80 offen offset:1024 sc1 lds
v_mfma_f32_16x16x32_bf16 v[220:223], v[172:175], a[124:127], v[220:223]
buffer_store_dwordx4 v[48:51], v19, s[4:7], s75 offen sc1
v_mfma_f32_16x16x32_bf16 v[216:219], v[176:179], a[128:131], v[216:219]
v_mfma_f32_16x16x32_bf16 v[220:223], v[180:183], a[128:131], v[220:223]
buffer_load_dwordx4 v14, s[8:11], s80 offen offset:2048 sc1 lds
v_mfma_f32_16x16x32_bf16 v[216:219], v[184:187], a[132:135], v[216:219]
v_mfma_f32_16x16x32_bf16 v[220:223], v[188:191], a[132:135], v[220:223]
v_mfma_f32_16x16x32_bf16 v[216:219], v[192:195], a[136:139], v[216:219]
buffer_load_dwordx4 v15, s[8:11], s80 offen offset:3072 sc1 lds
v_mfma_f32_16x16x32_bf16 v[220:223], v[196:199], a[136:139], v[220:223]
v_mfma_f32_16x16x32_bf16 v[216:219], v[200:203], a[140:143], v[216:219]
s_add_u32 m0, s49, 8192
v_mfma_f32_16x16x32_bf16 v[220:223], v[204:207], a[140:143], v[220:223]
buffer_load_dwordx4 v16, s[8:11], s80 offen offset:0 sc1 lds
v_mfma_f32_16x16x32_bf16 v[224:227], v[64:67], a[144:147], 0
v_mfma_f32_16x16x32_bf16 v[228:231], v[68:71], a[144:147], 0
v_mfma_f32_16x16x32_bf16 v[224:227], v[72:75], a[148:151], v[224:227]
v_mfma_f32_16x16x32_bf16 v[228:231], v[76:79], a[148:151], v[228:231]
v_mfma_f32_16x16x32_bf16 v[224:227], v[80:83], a[152:155], v[224:227]
buffer_load_dword v24, v22, s[4:7], 0 offen sc1
v_mfma_f32_16x16x32_bf16 v[228:231], v[84:87], a[152:155], v[228:231]
v_cvt_pk_bf16_f32 v52, v216, v217
v_cvt_pk_bf16_f32 v53, v218, v219
v_mfma_f32_16x16x32_bf16 v[224:227], v[88:91], a[156:159], v[224:227]
s_waitcnt vmcnt(11)
s_barrier
v_mfma_f32_16x16x32_bf16 v[228:231], v[92:95], a[156:159], v[228:231]
buffer_store_dword v27, v45, s[4:7], s91 offen
v_mfma_f32_16x16x32_bf16 v[224:227], v[96:99], a[160:163], v[224:227]
buffer_store_dword v27, v44, s[4:7], s91 offen sc1
v_mfma_f32_16x16x32_bf16 v[228:231], v[100:103], a[160:163], v[228:231]
v_cvt_pk_bf16_f32 v54, v220, v221
v_cvt_pk_bf16_f32 v55, v222, v223
v_mfma_f32_16x16x32_bf16 v[224:227], v[104:107], a[164:167], v[224:227]
buffer_store_dwordx4 v[52:55], v20, s[4:7], s75 offen sc1
v_mfma_f32_16x16x32_bf16 v[228:231], v[108:111], a[164:167], v[228:231]
v_mfma_f32_16x16x32_bf16 v[224:227], v[112:115], a[168:171], v[224:227]
v_mfma_f32_16x16x32_bf16 v[228:231], v[116:119], a[168:171], v[228:231]
v_mfma_f32_16x16x32_bf16 v[224:227], v[120:123], a[172:175], v[224:227]
v_mfma_f32_16x16x32_bf16 v[228:231], v[124:127], a[172:175], v[228:231]
v_mfma_f32_16x16x32_bf16 v[224:227], v[128:131], a[176:179], v[224:227]
v_mfma_f32_16x16x32_bf16 v[228:231], v[132:135], a[176:179], v[228:231]
v_mfma_f32_16x16x32_bf16 v[224:227], v[136:139], a[180:183], v[224:227]
v_mfma_f32_16x16x32_bf16 v[228:231], v[140:143], a[180:183], v[228:231]
v_mfma_f32_16x16x32_bf16 v[224:227], v[144:147], a[184:187], v[224:227]
v_mfma_f32_16x16x32_bf16 v[228:231], v[148:151], a[184:187], v[228:231]
v_mfma_f32_16x16x32_bf16 v[224:227], v[152:155], a[188:191], v[224:227]
v_mfma_f32_16x16x32_bf16 v[228:231], v[156:159], a[188:191], v[228:231]
v_mfma_f32_16x16x32_bf16 v[224:227], v[160:163], a[192:195], v[224:227]
s_waitcnt vmcnt(12)
s_barrier
v_mfma_f32_16x16x32_bf16 v[228:231], v[164:167], a[192:195], v[228:231]
v_mfma_f32_16x16x32_bf16 v[224:227], v[168:171], a[196:199], v[224:227]
s_cmp_eq_u32 s82, 0
s_cbranch_scc1 g_slow_28
v_mfma_f32_16x16x32_bf16 v[228:231], v[172:175], a[196:199], v[228:231]
ds_read_b128 v[64:67], v29 offset:0
v_mfma_f32_16x16x32_bf16 v[224:227], v[176:179], a[200:203], v[224:227]
ds_read_b128 v[68:71], v29 offset:9216
v_mfma_f32_16x16x32_bf16 v[228:231], v[180:183], a[200:203], v[228:231]
ds_read_b128 v[72:75], v29 offset:18432
v_mfma_f32_16x16x32_bf16 v[224:227], v[184:187], a[204:207], v[224:227]
ds_read_b128 v[76:79], v29 offset:27648
v_mfma_f32_16x16x32_bf16 v[228:231], v[188:191], a[204:207], v[228:231]
ds_read_b128 v[80:83], v29 offset:1024
v_mfma_f32_16x16x32_bf16 v[224:227], v[192:195], a[208:211], v[224:227]
ds_read_b128 v[84:87], v29 offset:10240
v_mfma_f32_16x16x32_bf16 v[228:231], v[196:199], a[208:211], v[228:231]
ds_read_b128 v[88:91], v29 offset:19456
v_mfma_f32_16x16x32_bf16 v[224:227], v[200:203], a[212:215], v[224:227]
ds_read_b128 v[92:95], v29 offset:28672
v_mfma_f32_16x16x32_bf16 v[228:231], v[204:207], a[212:215], v[228:231]
s_waitcnt vmcnt(9)
s_barrier
g_body_17:
s_waitcnt lgkmcnt(4)
v_mfma_f32_16x16x32_bf16 v[208:211], v[64:67], a[0:3], 0
ds_read_b128 v[96:99], v29 offset:2048
v_mfma_f32_16x16x32_bf16 v[212:215], v[68:71], a[0:3], 0
ds_read_b128 v[100:103], v29 offset:11264
v_mfma_f32_16x16x32_bf16 v[216:219], v[64:67], a[72:75], 0
v_mfma_f32_16x16x32_bf16 v[208:211], v[72:75], a[4:7], v[208:211]
ds_read_b128 v[104:107], v29 offset:20480
v_cvt_pk_bf16_f32 v56, v224, v225
v_mfma_f32_16x16x32_bf16 v[212:215], v[76:79], a[4:7], v[212:215]
ds_read_b128 v[108:111], v29 offset:29696
v_cvt_pk_bf16_f32 v57, v226, v227
v_mfma_f32_16x16x32_bf16 v[220:223], v[68:71], a[72:75], 0
v_cvt_pk_bf16_f32 v58, v228, v229
s_waitcnt lgkmcnt(4)
v_mfma_f32_16x16x32_bf16 v[208:211], v[80:83], a[8:11], v[208:211]
ds_read_b128 v[112:115], v29 offset:3072
v_cvt_pk_bf16_f32 v59, v230, v231
v_mfma_f32_16x16x32_bf16 v[212:215], v[84:87], a[8:11], v[212:215]
ds_read_b128 v[116:119], v29 offset:12288
v_mfma_f32_16x16x32_bf16 v[216:219], v[72:75], a[76:79], v[216:219]
buffer_store_dwordx4 v[56:59], v21, s[4:7], s75 offen sc1
v_mfma_f32_16x16x32_bf16 v[208:211], v[88:91], a[12:15], v[208:211]
ds_read_b128 v[120:123], v29 offset:21504
v_mfma_f32_16x16x32_bf16 v[212:215], v[92:95], a[12:15], v[212:215]
ds_read_b128 v[124:127], v29 offset:30720
v_mfma_f32_16x16x32_bf16 v[220:223], v[76:79], a[76:79], v[220:223]
s_waitcnt lgkmcnt(4)
v_mfma_f32_16x16x32_bf16 v[208:211], v[96:99], a[16:19], v[208:211]
ds_read_b128 v[128:131], v29 offset:4096
v_mfma_f32_16x16x32_bf16 v[212:215], v[100:103], a[16:19], v[212:215]
ds_read_b128 v[132:135], v29 offset:13312
v_mfma_f32_16x16x32_bf16 v[216:219], v[80:83], a[80:83], v[216:219]
v_mfma_f32_16x16x32_bf16 v[208:211], v[104:107], a[20:23], v[208:211]
ds_read_b128 v[136:139], v29 offset:22528
v_mfma_f32_16x16x32_bf16 v[212:215], v[108:111], a[20:23], v[212:215]
ds_read_b128 v[140:143], v29 offset:31744
v_mfma_f32_16x16x32_bf16 v[220:223], v[84:87], a[80:83], v[220:223]
s_waitcnt vmcnt(5)
s_barrier
s_waitcnt lgkmcnt(4)
v_mfma_f32_16x16x32_bf16 v[208:211], v[112:115], a[24:27], v[208:211]
ds_read_b128 v[144:147], v29 offset:5120
v_mov_b32 v27, s72
v_mfma_f32_16x16x32_bf16 v[212:215], v[116:119], a[24:27], v[212:215]
ds_read_b128 v[148:151], v29 offset:14336
v_mfma_f32_16x16x32_bf16 v[216:219], v[88:91], a[84:87], v[216:219]
v_mfma_f32_16x16x32_bf16 v[208:211], v[120:123], a[28:31], v[208:211]
ds_read_b128 v[152:155], v29 offset:23552
v_mfma_f32_16x16x32_bf16 v[212:215], v[124:127], a[28:31], v[212:215]
ds_read_b128 v[156:159], v29 offset:32768
v_mfma_f32_16x16x32_bf16 v[220:223], v[92:95], a[84:87], v[220:223]
s_waitcnt lgkmcnt(4)
v_mfma_f32_16x16x32_bf16 v[208:211], v[128:131], a[32:35], v[208:211]
ds_read_b128 v[160:163], v29 offset:6144
v_mfma_f32_16x16x32_bf16 v[212:215], v[132:135], a[32:35], v[212:215]
ds_read_b128 v[164:167], v29 offset:15360
v_mfma_f32_16x16x32_bf16 v[216:219], v[96:99], a[88:91], v[216:219]
v_mfma_f32_16x16x32_bf16 v[208:211], v[136:139], a[36:39], v[208:211]
ds_read_b128 v[168:171], v29 offset:24576
v_mfma_f32_16x16x32_bf16 v[212:215], v[140:143], a[36:39], v[212:215]
ds_read_b128 v[172:175], v29 offset:33792
v_mfma_f32_16x16x32_bf16 v[220:223], v[100:103], a[88:91], v[220:223]
s_waitcnt lgkmcnt(4)
v_mfma_f32_16x16x32_bf16 v[208:211], v[144:147], a[40:43], v[208:211]
ds_read_b128 v[176:179], v29 offset:7168
v_mfma_f32_16x16x32_bf16 v[212:215], v[148:151], a[40:43], v[212:215]
ds_read_b128 v[180:183], v29 offset:16384
s_waitcnt vmcnt(4)
ds_write_b32 v18, v24
v_mfma_f32_16x16x32_bf16 v[216:219], v[104:107], a[92:95], v[216:219]
v_mfma_f32_16x16x32_bf16 v[208:211], v[152:155], a[44:47], v[208:211]
ds_read_b128 v[184:187], v29 offset:25600
v_mfma_f32_16x16x32_bf16 v[212:215], v[156:159], a[44:47], v[212:215]
ds_read_b128 v[188:191], v29 offset:34816
s_waitcnt lgkmcnt(2)
s_barrier
v_mfma_f32_16x16x32_bf16 v[220:223], v[108:111], a[92:95], v[220:223]
ds_read_b32 v33, v32
v_mfma_f32_16x16x32_bf16 v[208:211], v[160:163], a[48:51], v[208:211]
ds_read_b128 v[192:195], v29 offset:8192
v_mfma_f32_16x16x32_bf16 v[212:215], v[164:167], a[48:51], v[212:215]
ds_read_b128 v[196:199], v29 offset:17408
v_mfma_f32_16x16x32_bf16 v[216:219], v[112:115], a[96:99], v[216:219]
s_waitcnt lgkmcnt(2)
v_cmp_gt_u32 vcc, s52, v33
v_mfma_f32_16x16x32_bf16 v[208:211], v[168:171], a[52:55], v[208:211]
ds_read_b128 v[200:203], v29 offset:26624
v_cmp_gt_u32 s[58:59], s54, v33
v_mfma_f32_16x16x32_bf16 v[212:215], v[172:175], a[52:55], v[212:215]
ds_read_b128 v[204:207], v29 offset:35840
s_and_b32 vcc_lo, vcc_lo, s56
s_cselect_b32 s70, 0, 1
v_mfma_f32_16x16x32_bf16 v[220:223], v[116:119], a[96:99], v[220:223]
v_mfma_f32_16x16x32_bf16 v[208:211], v[176:179], a[56:59], v[208:211]
s_and_b32 s59, s59, s56
s_cselect_b32 s71, 0, s83
v_mfma_f32_16x16x32_bf16 v[212:215], v[180:183], a[56:59], v[212:215]
s_or_b32 s88, s70, s71
s_cselect_b32 s10, 268435456, 0
v_mfma_f32_16x16x32_bf16 v[216:219], v[120:123], a[100:103], v[216:219]
s_cmp_lg_u32 s70, 0
s_cselect_b64 s[84:85], s[52:53], s[54:55]
s_cselect_b64 s[58:59], s[44:45], s[46:47]
v_mfma_f32_16x16x32_bf16 v[208:211], v[184:187], a[60:63], v[208:211]
s_mul_i32 s86, s84, s20
s_add_u32 s86, s86, s58
v_mfma_f32_16x16x32_bf16 v[212:215], v[188:191], a[60:63], v[212:215]
s_add_u32 m0, s50, 0
s_mul_i32 s87, s84, s21
s_add_u32 s87, s87, s59
v_mfma_f32_16x16x32_bf16 v[220:223], v[124:127], a[100:103], v[220:223]
buffer_load_dwordx4 v8, s[8:11], s86 offen offset:0 sc1 lds
s_waitcnt lgkmcnt(0)
v_mfma_f32_16x16x32_bf16 v[208:211], v[192:195], a[64:67], v[208:211]
s_andn2_b32 s71, s71, s70
s_add_u32 s52, s52, s70
s_add_u32 s54, s54, s71
v_mfma_f32_16x16x32_bf16 v[212:215], v[196:199], a[64:67], v[212:215]
s_mov_b32 s89, s88
v_mfma_f32_16x16x32_bf16 v[216:219], v[128:131], a[104:107], v[216:219]
buffer_load_dwordx4 v9, s[8:11], s86 offen offset:1024 sc1 lds
v_mfma_f32_16x16x32_bf16 v[208:211], v[200:203], a[68:71], v[208:211]
v_mfma_f32_16x16x32_bf16 v[212:215], v[204:207], a[68:71], v[212:215]
v_mfma_f32_16x16x32_bf16 v[220:223], v[132:135], a[104:107], v[220:223]
buffer_load_dwordx4 v10, s[8:11], s86 offen offset:2048 sc1 lds
v_mfma_f32_16x16x32_bf16 v[216:219], v[136:139], a[108:111], v[216:219]
v_mfma_f32_16x16x32_bf16 v[220:223], v[140:143], a[108:111], v[220:223]
v_mfma_f32_16x16x32_bf16 v[216:219], v[144:147], a[112:115], v[216:219]
buffer_load_dwordx4 v11, s[8:11], s86 offen offset:3072 sc1 lds
v_mfma_f32_16x16x32_bf16 v[220:223], v[148:151], a[112:115], v[220:223]
v_mfma_f32_16x16x32_bf16 v[216:219], v[152:155], a[116:119], v[216:219]
s_add_u32 m0, s50, 4096
v_cvt_pk_bf16_f32 v48, v208, v209
v_mfma_f32_16x16x32_bf16 v[220:223], v[156:159], a[116:119], v[220:223]
buffer_load_dwordx4 v12, s[8:11], s86 offen offset:0 sc1 lds
v_mfma_f32_16x16x32_bf16 v[216:219], v[160:163], a[120:123], v[216:219]
v_cvt_pk_bf16_f32 v49, v210, v211
v_cvt_pk_bf16_f32 v50, v212, v213
v_mfma_f32_16x16x32_bf16 v[220:223], v[164:167], a[120:123], v[220:223]
v_cvt_pk_bf16_f32 v51, v214, v215
v_mfma_f32_16x16x32_bf16 v[216:219], v[168:171], a[124:127], v[216:219]
buffer_load_dwordx4 v13, s[8:11], s86 offen offset:1024 sc1 lds
v_mfma_f32_16x16x32_bf16 v[220:223], v[172:175], a[124:127], v[220:223]
buffer_store_dwordx4 v[48:51], v19, s[4:7], s81 offen sc1
v_mfma_f32_16x16x32_bf16 v[216:219], v[176:179], a[128:131], v[216:219]
v_mfma_f32_16x16x32_bf16 v[220:223], v[180:183], a[128:131], v[220:223]
buffer_load_dwordx4 v14, s[8:11], s86 offen offset:2048 sc1 lds
v_mfma_f32_16x16x32_bf16 v[216:219], v[184:187], a[132:135], v[216:219]
v_mfma_f32_16x16x32_bf16 v[220:223], v[188:191], a[132:135], v[220:223]
v_mfma_f32_16x16x32_bf16 v[216:219], v[192:195], a[136:139], v[216:219]
buffer_load_dwordx4 v15, s[8:11], s86 offen offset:3072 sc1 lds
v_mfma_f32_16x16x32_bf16 v[220:223], v[196:199], a[136:139], v[220:223]
v_mfma_f32_16x16x32_bf16 v[216:219], v[200:203], a[140:143], v[216:219]
s_add_u32 m0, s50, 8192
v_mfma_f32_16x16x32_bf16 v[220:223], v[204:207], a[140:143], v[220:223]
buffer_load_dwordx4 v16, s[8:11], s86 offen offset:0 sc1 lds
v_mfma_f32_16x16x32_bf16 v[224:227], v[64:67], a[144:147], 0
v_mfma_f32_16x16x32_bf16 v[228:231], v[68:71], a[144:147], 0
v_mfma_f32_16x16x32_bf16 v[224:227], v[72:75], a[148:151], v[224:227]
v_mfma_f32_16x16x32_bf16 v[228:231], v[76:79], a[148:151], v[228:231]
v_mfma_f32_16x16x32_bf16 v[224:227], v[80:83], a[152:155], v[224:227]
buffer_load_dword v24, v22, s[4:7], 0 offen sc1
v_mfma_f32_16x16x32_bf16 v[228:231], v[84:87], a[152:155], v[228:231]
v_cvt_pk_bf16_f32 v52, v216, v217
v_cvt_pk_bf16_f32 v53, v218, v219
v_mfma_f32_16x16x32_bf16 v[224:227], v[88:91], a[156:159], v[224:227]
s_waitcnt vmcnt(11)
s_barrier
v_mfma_f32_16x16x32_bf16 v[228:231], v[92:95], a[156:159], v[228:231]
buffer_store_dword v27, v45, s[4:7], s73 offen
v_mfma_f32_16x16x32_bf16 v[224:227], v[96:99], a[160:163], v[224:227]
buffer_store_dword v27, v44, s[4:7], s73 offen sc1
v_mfma_f32_16x16x32_bf16 v[228:231], v[100:103], a[160:163], v[228:231]
v_cvt_pk_bf16_f32 v54, v220, v221
v_cvt_pk_bf16_f32 v55, v222, v223
v_mfma_f32_16x16x32_bf16 v[224:227], v[104:107], a[164:167], v[224:227]
buffer_store_dwordx4 v[52:55], v20, s[4:7], s81 offen sc1
v_mfma_f32_16x16x32_bf16 v[228:231], v[108:111], a[164:167], v[228:231]
v_mfma_f32_16x16x32_bf16 v[224:227], v[112:115], a[168:171], v[224:227]
v_mfma_f32_16x16x32_bf16 v[228:231], v[116:119], a[168:171], v[228:231]
v_mfma_f32_16x16x32_bf16 v[224:227], v[120:123], a[172:175], v[224:227]
v_mfma_f32_16x16x32_bf16 v[228:231], v[124:127], a[172:175], v[228:231]
v_mfma_f32_16x16x32_bf16 v[224:227], v[128:131], a[176:179], v[224:227]
v_mfma_f32_16x16x32_bf16 v[228:231], v[132:135], a[176:179], v[228:231]
v_mfma_f32_16x16x32_bf16 v[224:227], v[136:139], a[180:183], v[224:227]
v_mfma_f32_16x16x32_bf16 v[228:231], v[140:143], a[180:183], v[228:231]
v_mfma_f32_16x16x32_bf16 v[224:227], v[144:147], a[184:187], v[224:227]
v_mfma_f32_16x16x32_bf16 v[228:231], v[148:151], a[184:187], v[228:231]
v_mfma_f32_16x16x32_bf16 v[224:227], v[152:155], a[188:191], v[224:227]
v_mfma_f32_16x16x32_bf16 v[228:231], v[156:159], a[188:191], v[228:231]
v_mfma_f32_16x16x32_bf16 v[224:227], v[160:163], a[192:195], v[224:227]
s_waitcnt vmcnt(12)
s_barrier
v_mfma_f32_16x16x32_bf16 v[228:231], v[164:167], a[192:195], v[228:231]
v_mfma_f32_16x16x32_bf16 v[224:227], v[168:171], a[196:199], v[224:227]
s_cmp_eq_u32 s88, 0
s_cbranch_scc1 g_slow_29
v_mfma_f32_16x16x32_bf16 v[228:231], v[172:175], a[196:199], v[228:231]
ds_read_b128 v[64:67], v30 offset:0
v_mfma_f32_16x16x32_bf16 v[224:227], v[176:179], a[200:203], v[224:227]
ds_read_b128 v[68:71], v30 offset:9216
v_mfma_f32_16x16x32_bf16 v[228:231], v[180:183], a[200:203], v[228:231]
ds_read_b128 v[72:75], v30 offset:18432
v_mfma_f32_16x16x32_bf16 v[224:227], v[184:187], a[204:207], v[224:227]
ds_read_b128 v[76:79], v30 offset:27648
v_mfma_f32_16x16x32_bf16 v[228:231], v[188:191], a[204:207], v[228:231]
ds_read_b128 v[80:83], v30 offset:1024
v_mfma_f32_16x16x32_bf16 v[224:227], v[192:195], a[208:211], v[224:227]
ds_read_b128 v[84:87], v30 offset:10240
v_mfma_f32_16x16x32_bf16 v[228:231], v[196:199], a[208:211], v[228:231]
ds_read_b128 v[88:91], v30 offset:19456
v_mfma_f32_16x16x32_bf16 v[224:227], v[200:203], a[212:215], v[224:227]
ds_read_b128 v[92:95], v30 offset:28672
v_mfma_f32_16x16x32_bf16 v[228:231], v[204:207], a[212:215], v[228:231]
s_waitcnt vmcnt(9)
s_barrier
g_body_18:
s_waitcnt lgkmcnt(4)
v_mfma_f32_16x16x32_bf16 v[208:211], v[64:67], a[0:3], 0
ds_read_b128 v[96:99], v30 offset:2048
v_mfma_f32_16x16x32_bf16 v[212:215], v[68:71], a[0:3], 0
ds_read_b128 v[100:103], v30 offset:11264
v_mfma_f32_16x16x32_bf16 v[216:219], v[64:67], a[72:75], 0
v_mfma_f32_16x16x32_bf16 v[208:211], v[72:75], a[4:7], v[208:211]
ds_read_b128 v[104:107], v30 offset:20480
v_cvt_pk_bf16_f32 v56, v224, v225
v_mfma_f32_16x16x32_bf16 v[212:215], v[76:79], a[4:7], v[212:215]
ds_read_b128 v[108:111], v30 offset:29696
v_cvt_pk_bf16_f32 v57, v226, v227
v_mfma_f32_16x16x32_bf16 v[220:223], v[68:71], a[72:75], 0
v_cvt_pk_bf16_f32 v58, v228, v229
s_waitcnt lgkmcnt(4)
v_mfma_f32_16x16x32_bf16 v[208:211], v[80:83], a[8:11], v[208:211]
ds_read_b128 v[112:115], v30 offset:3072
v_cvt_pk_bf16_f32 v59, v230, v231
v_mfma_f32_16x16x32_bf16 v[212:215], v[84:87], a[8:11], v[212:215]
ds_read_b128 v[116:119], v30 offset:12288
v_mfma_f32_16x16x32_bf16 v[216:219], v[72:75], a[76:79], v[216:219]
buffer_store_dwordx4 v[56:59], v21, s[4:7], s81 offen sc1
v_mfma_f32_16x16x32_bf16 v[208:211], v[88:91], a[12:15], v[208:211]
ds_read_b128 v[120:123], v30 offset:21504
v_mfma_f32_16x16x32_bf16 v[212:215], v[92:95], a[12:15], v[212:215]
ds_read_b128 v[124:127], v30 offset:30720
v_mfma_f32_16x16x32_bf16 v[220:223], v[76:79], a[76:79], v[220:223]
s_waitcnt lgkmcnt(4)
v_mfma_f32_16x16x32_bf16 v[208:211], v[96:99], a[16:19], v[208:211]
ds_read_b128 v[128:131], v30 offset:4096
v_mfma_f32_16x16x32_bf16 v[212:215], v[100:103], a[16:19], v[212:215]
ds_read_b128 v[132:135], v30 offset:13312
v_mfma_f32_16x16x32_bf16 v[216:219], v[80:83], a[80:83], v[216:219]
v_mfma_f32_16x16x32_bf16 v[208:211], v[104:107], a[20:23], v[208:211]
ds_read_b128 v[136:139], v30 offset:22528
v_mfma_f32_16x16x32_bf16 v[212:215], v[108:111], a[20:23], v[212:215]
ds_read_b128 v[140:143], v30 offset:31744
v_mfma_f32_16x16x32_bf16 v[220:223], v[84:87], a[80:83], v[220:223]
s_waitcnt vmcnt(5)
s_barrier
s_waitcnt lgkmcnt(4)
v_mfma_f32_16x16x32_bf16 v[208:211], v[112:115], a[24:27], v[208:211]
ds_read_b128 v[144:147], v30 offset:5120
v_mov_b32 v27, s78
v_mfma_f32_16x16x32_bf16 v[212:215], v[116:119], a[24:27], v[212:215]
ds_read_b128 v[148:151], v30 offset:14336
v_mfma_f32_16x16x32_bf16 v[216:219], v[88:91], a[84:87], v[216:219]
v_mfma_f32_16x16x32_bf16 v[208:211], v[120:123], a[28:31], v[208:211]
ds_read_b128 v[152:155], v30 offset:23552
v_mfma_f32_16x16x32_bf16 v[212:215], v[124:127], a[28:31], v[212:215]
ds_read_b128 v[156:159], v30 offset:32768
v_mfma_f32_16x16x32_bf16 v[220:223], v[92:95], a[84:87], v[220:223]
s_waitcnt lgkmcnt(4)
v_mfma_f32_16x16x32_bf16 v[208:211], v[128:131], a[32:35], v[208:211]
ds_read_b128 v[160:163], v30 offset:6144
v_mfma_f32_16x16x32_bf16 v[212:215], v[132:135], a[32:35], v[212:215]
ds_read_b128 v[164:167], v30 offset:15360
v_mfma_f32_16x16x32_bf16 v[216:219], v[96:99], a[88:91], v[216:219]
v_mfma_f32_16x16x32_bf16 v[208:211], v[136:139], a[36:39], v[208:211]
ds_read_b128 v[168:171], v30 offset:24576
v_mfma_f32_16x16x32_bf16 v[212:215], v[140:143], a[36:39], v[212:215]
ds_read_b128 v[172:175], v30 offset:33792
v_mfma_f32_16x16x32_bf16 v[220:223], v[100:103], a[88:91], v[220:223]
s_waitcnt lgkmcnt(4)
v_mfma_f32_16x16x32_bf16 v[208:211], v[144:147], a[40:43], v[208:211]
ds_read_b128 v[176:179], v30 offset:7168
v_mfma_f32_16x16x32_bf16 v[212:215], v[148:151], a[40:43], v[212:215]
ds_read_b128 v[180:183], v30 offset:16384
s_waitcnt vmcnt(4)
ds_write_b32 v18, v24
v_mfma_f32_16x16x32_bf16 v[216:219], v[104:107], a[92:95], v[216:219]
v_mfma_f32_16x16x32_bf16 v[208:211], v[152:155], a[44:47], v[208:211]
ds_read_b128 v[184:187], v30 offset:25600
v_mfma_f32_16x16x32_bf16 v[212:215], v[156:159], a[44:47], v[212:215]
ds_read_b128 v[188:191], v30 offset:34816
s_waitcnt lgkmcnt(2)
s_barrier
v_mfma_f32_16x16x32_bf16 v[220:223], v[108:111], a[92:95], v[220:223]
ds_read_b32 v33, v32
v_mfma_f32_16x16x32_bf16 v[208:211], v[160:163], a[48:51], v[208:211]
ds_read_b128 v[192:195], v30 offset:8192
v_mfma_f32_16x16x32_bf16 v[212:215], v[164:167], a[48:51], v[212:215]
ds_read_b128 v[196:199], v30 offset:17408
v_mfma_f32_16x16x32_bf16 v[216:219], v[112:115], a[96:99], v[216:219]
s_waitcnt lgkmcnt(2)
v_cmp_gt_u32 vcc, s52, v33
v_mfma_f32_16x16x32_bf16 v[208:211], v[168:171], a[52:55], v[208:211]
ds_read_b128 v[200:203], v30 offset:26624
v_cmp_gt_u32 s[58:59], s54, v33
v_mfma_f32_16x16x32_bf16 v[212:215], v[172:175], a[52:55], v[212:215]
ds_read_b128 v[204:207], v30 offset:35840
s_and_b32 vcc_lo, vcc_lo, s56
s_cselect_b32 s70, 0, 1
v_mfma_f32_16x16x32_bf16 v[220:223], v[116:119], a[96:99], v[220:223]
v_mfma_f32_16x16x32_bf16 v[208:211], v[176:179], a[56:59], v[208:211]
s_and_b32 s59, s59, s56
s_cselect_b32 s71, 0, s89
v_mfma_f32_16x16x32_bf16 v[212:215], v[180:183], a[56:59], v[212:215]
s_or_b32 s94, s70, s71
s_cselect_b32 s10, 268435456, 0
v_mfma_f32_16x16x32_bf16 v[216:219], v[120:123], a[100:103], v[216:219]
s_cmp_lg_u32 s70, 0
s_cselect_b64 s[90:91], s[52:53], s[54:55]
s_cselect_b64 s[58:59], s[44:45], s[46:47]
v_mfma_f32_16x16x32_bf16 v[208:211], v[184:187], a[60:63], v[208:211]
s_mul_i32 s92, s90, s20
s_add_u32 s92, s92, s58
v_mfma_f32_16x16x32_bf16 v[212:215], v[188:191], a[60:63], v[212:215]
s_add_u32 m0, s51, 0
s_mul_i32 s93, s90, s21
s_add_u32 s93, s93, s59
v_mfma_f32_16x16x32_bf16 v[220:223], v[124:127], a[100:103], v[220:223]
buffer_load_dwordx4 v8, s[8:11], s92 offen offset:0 sc1 lds
s_waitcnt lgkmcnt(0)
v_mfma_f32_16x16x32_bf16 v[208:211], v[192:195], a[64:67], v[208:211]
s_andn2_b32 s71, s71, s70
s_add_u32 s52, s52, s70
s_add_u32 s54, s54, s71
v_mfma_f32_16x16x32_bf16 v[212:215], v[196:199], a[64:67], v[212:215]
s_mov_b32 s95, s94
v_mfma_f32_16x16x32_bf16 v[216:219], v[128:131], a[104:107], v[216:219]
buffer_load_dwordx4 v9, s[8:11], s92 offen offset:1024 sc1 lds
v_mfma_f32_16x16x32_bf16 v[208:211], v[200:203], a[68:71], v[208:211]
v_mfma_f32_16x16x32_bf16 v[212:215], v[204:207], a[68:71], v[212:215]
v_mfma_f32_16x16x32_bf16 v[220:223], v[132:135], a[104:107], v[220:223]
buffer_load_dwordx4 v10, s[8:11], s92 offen offset:2048 sc1 lds
v_mfma_f32_16x16x32_bf16 v[216:219], v[136:139], a[108:111], v[216:219]
v_mfma_f32_16x16x32_bf16 v[220:223], v[140:143], a[108:111], v[220:223]
v_mfma_f32_16x16x32_bf16 v[216:219], v[144:147], a[112:115], v[216:219]
buffer_load_dwordx4 v11, s[8:11], s92 offen offset:3072 sc1 lds
v_mfma_f32_16x16x32_bf16 v[220:223], v[148:151], a[112:115], v[220:223]
v_mfma_f32_16x16x32_bf16 v[216:219], v[152:155], a[116:119], v[216:219]
s_add_u32 m0, s51, 4096
v_cvt_pk_bf16_f32 v48, v208, v209
v_mfma_f32_16x16x32_bf16 v[220:223], v[156:159], a[116:119], v[220:223]
buffer_load_dwordx4 v12, s[8:11], s92 offen offset:0 sc1 lds
v_mfma_f32_16x16x32_bf16 v[216:219], v[160:163], a[120:123], v[216:219]
v_cvt_pk_bf16_f32 v49, v210, v211
v_cvt_pk_bf16_f32 v50, v212, v213
v_mfma_f32_16x16x32_bf16 v[220:223], v[164:167], a[120:123], v[220:223]
v_cvt_pk_bf16_f32 v51, v214, v215
v_mfma_f32_16x16x32_bf16 v[216:219], v[168:171], a[124:127], v[216:219]
buffer_load_dwordx4 v13, s[8:11], s92 offen offset:1024 sc1 lds
v_mfma_f32_16x16x32_bf16 v[220:223], v[172:175], a[124:127], v[220:223]
buffer_store_dwordx4 v[48:51], v19, s[4:7], s87 offen sc1
v_mfma_f32_16x16x32_bf16 v[216:219], v[176:179], a[128:131], v[216:219]
v_mfma_f32_16x16x32_bf16 v[220:223], v[180:183], a[128:131], v[220:223]
buffer_load_dwordx4 v14, s[8:11], s92 offen offset:2048 sc1 lds
v_mfma_f32_16x16x32_bf16 v[216:219], v[184:187], a[132:135], v[216:219]
v_mfma_f32_16x16x32_bf16 v[220:223], v[188:191], a[132:135], v[220:223]
v_mfma_f32_16x16x32_bf16 v[216:219], v[192:195], a[136:139], v[216:219]
buffer_load_dwordx4 v15, s[8:11], s92 offen offset:3072 sc1 lds
v_mfma_f32_16x16x32_bf16 v[220:223], v[196:199], a[136:139], v[220:223]
v_mfma_f32_16x16x32_bf16 v[216:219], v[200:203], a[140:143], v[216:219]
s_add_u32 m0, s51, 8192
v_mfma_f32_16x16x32_bf16 v[220:223], v[204:207], a[140:143], v[220:223]
buffer_load_dwordx4 v16, s[8:11], s92 offen offset:0 sc1 lds
v_mfma_f32_16x16x32_bf16 v[224:227], v[64:67], a[144:147], 0
v_mfma_f32_16x16x32_bf16 v[228:231], v[68:71], a[144:147], 0
v_mfma_f32_16x16x32_bf16 v[224:227], v[72:75], a[148:151], v[224:227]
v_mfma_f32_16x16x32_bf16 v[228:231], v[76:79], a[148:151], v[228:231]
v_mfma_f32_16x16x32_bf16 v[224:227], v[80:83], a[152:155], v[224:227]
buffer_load_dword v24, v22, s[4:7], 0 offen sc1
v_mfma_f32_16x16x32_bf16 v[228:231], v[84:87], a[152:155], v[228:231]
v_cvt_pk_bf16_f32 v52, v216, v217
v_cvt_pk_bf16_f32 v53, v218, v219
v_mfma_f32_16x16x32_bf16 v[224:227], v[88:91], a[156:159], v[224:227]
s_waitcnt vmcnt(11)
s_barrier
v_mfma_f32_16x16x32_bf16 v[228:231], v[92:95], a[156:159], v[228:231]
buffer_store_dword v27, v45, s[4:7], s79 offen
v_mfma_f32_16x16x32_bf16 v[224:227], v[96:99], a[160:163], v[224:227]
buffer_store_dword v27, v44, s[4:7], s79 offen sc1
v_mfma_f32_16x16x32_bf16 v[228:231], v[100:103], a[160:163], v[228:231]
v_cvt_pk_bf16_f32 v54, v220, v221
v_cvt_pk_bf16_f32 v55, v222, v223
v_mfma_f32_16x16x32_bf16 v[224:227], v[104:107], a[164:167], v[224:227]
buffer_store_dwordx4 v[52:55], v20, s[4:7], s87 offen sc1
v_mfma_f32_16x16x32_bf16 v[228:231], v[108:111], a[164:167], v[228:231]
v_mfma_f32_16x16x32_bf16 v[224:227], v[112:115], a[168:171], v[224:227]
v_mfma_f32_16x16x32_bf16 v[228:231], v[116:119], a[168:171], v[228:231]
v_mfma_f32_16x16x32_bf16 v[224:227], v[120:123], a[172:175], v[224:227]
v_mfma_f32_16x16x32_bf16 v[228:231], v[124:127], a[172:175], v[228:231]
v_mfma_f32_16x16x32_bf16 v[224:227], v[128:131], a[176:179], v[224:227]
v_mfma_f32_16x16x32_bf16 v[228:231], v[132:135], a[176:179], v[228:231]
v_mfma_f32_16x16x32_bf16 v[224:227], v[136:139], a[180:183], v[224:227]
v_mfma_f32_16x16x32_bf16 v[228:231], v[140:143], a[180:183], v[228:231]
v_mfma_f32_16x16x32_bf16 v[224:227], v[144:147], a[184:187], v[224:227]
v_mfma_f32_16x16x32_bf16 v[228:231], v[148:151], a[184:187], v[228:231]
v_mfma_f32_16x16x32_bf16 v[224:227], v[152:155], a[188:191], v[224:227]
v_mfma_f32_16x16x32_bf16 v[228:231], v[156:159], a[188:191], v[228:231]
v_mfma_f32_16x16x32_bf16 v[224:227], v[160:163], a[192:195], v[224:227]
s_waitcnt vmcnt(12)
s_barrier
v_mfma_f32_16x16x32_bf16 v[228:231], v[164:167], a[192:195], v[228:231]
v_mfma_f32_16x16x32_bf16 v[224:227], v[168:171], a[196:199], v[224:227]
s_cmp_eq_u32 s94, 0
s_cbranch_scc1 g_slow_30
v_mfma_f32_16x16x32_bf16 v[228:231], v[172:175], a[196:199], v[228:231]
ds_read_b128 v[64:67], v31 offset:0
v_mfma_f32_16x16x32_bf16 v[224:227], v[176:179], a[200:203], v[224:227]
ds_read_b128 v[68:71], v31 offset:9216
v_mfma_f32_16x16x32_bf16 v[228:231], v[180:183], a[200:203], v[228:231]
ds_read_b128 v[72:75], v31 offset:18432
v_mfma_f32_16x16x32_bf16 v[224:227], v[184:187], a[204:207], v[224:227]
ds_read_b128 v[76:79], v31 offset:27648
v_mfma_f32_16x16x32_bf16 v[228:231], v[188:191], a[204:207], v[228:231]
ds_read_b128 v[80:83], v31 offset:1024
v_mfma_f32_16x16x32_bf16 v[224:227], v[192:195], a[208:211], v[224:227]
ds_read_b128 v[84:87], v31 offset:10240
v_mfma_f32_16x16x32_bf16 v[228:231], v[196:199], a[208:211], v[228:231]
ds_read_b128 v[88:91], v31 offset:19456
v_mfma_f32_16x16x32_bf16 v[224:227], v[200:203], a[212:215], v[224:227]
ds_read_b128 v[92:95], v31 offset:28672
v_mfma_f32_16x16x32_bf16 v[228:231], v[204:207], a[212:215], v[228:231]
s_waitcnt vmcnt(9)
s_barrier
g_body_19:
s_waitcnt lgkmcnt(4)
v_mfma_f32_16x16x32_bf16 v[208:211], v[64:67], a[0:3], 0
ds_read_b128 v[96:99], v31 offset:2048
v_mfma_f32_16x16x32_bf16 v[212:215], v[68:71], a[0:3], 0
ds_read_b128 v[100:103], v31 offset:11264
v_mfma_f32_16x16x32_bf16 v[216:219], v[64:67], a[72:75], 0
v_mfma_f32_16x16x32_bf16 v[208:211], v[72:75], a[4:7], v[208:211]
ds_read_b128 v[104:107], v31 offset:20480
v_cvt_pk_bf16_f32 v56, v224, v225
v_mfma_f32_16x16x32_bf16 v[212:215], v[76:79], a[4:7], v[212:215]
ds_read_b128 v[108:111], v31 offset:29696
v_cvt_pk_bf16_f32 v57, v226, v227
v_mfma_f32_16x16x32_bf16 v[220:223], v[68:71], a[72:75], 0
v_cvt_pk_bf16_f32 v58, v228, v229
s_waitcnt lgkmcnt(4)
v_mfma_f32_16x16x32_bf16 v[208:211], v[80:83], a[8:11], v[208:211]
ds_read_b128 v[112:115], v31 offset:3072
v_cvt_pk_bf16_f32 v59, v230, v231
v_mfma_f32_16x16x32_bf16 v[212:215], v[84:87], a[8:11], v[212:215]
ds_read_b128 v[116:119], v31 offset:12288
v_mfma_f32_16x16x32_bf16 v[216:219], v[72:75], a[76:79], v[216:219]
buffer_store_dwordx4 v[56:59], v21, s[4:7], s87 offen sc1
v_mfma_f32_16x16x32_bf16 v[208:211], v[88:91], a[12:15], v[208:211]
ds_read_b128 v[120:123], v31 offset:21504
v_mfma_f32_16x16x32_bf16 v[212:215], v[92:95], a[12:15], v[212:215]
ds_read_b128 v[124:127], v31 offset:30720
v_mfma_f32_16x16x32_bf16 v[220:223], v[76:79], a[76:79], v[220:223]
s_waitcnt lgkmcnt(4)
v_mfma_f32_16x16x32_bf16 v[208:211], v[96:99], a[16:19], v[208:211]
ds_read_b128 v[128:131], v31 offset:4096
v_mfma_f32_16x16x32_bf16 v[212:215], v[100:103], a[16:19], v[212:215]
ds_read_b128 v[132:135], v31 offset:13312
v_mfma_f32_16x16x32_bf16 v[216:219], v[80:83], a[80:83], v[216:219]
v_mfma_f32_16x16x32_bf16 v[208:211], v[104:107], a[20:23], v[208:211]
ds_read_b128 v[136:139], v31 offset:22528
v_mfma_f32_16x16x32_bf16 v[212:215], v[108:111], a[20:23], v[212:215]
ds_read_b128 v[140:143], v31 offset:31744
v_mfma_f32_16x16x32_bf16 v[220:223], v[84:87], a[80:83], v[220:223]
s_waitcnt vmcnt(5)
s_barrier
s_waitcnt lgkmcnt(4)
v_mfma_f32_16x16x32_bf16 v[208:211], v[112:115], a[24:27], v[208:211]
ds_read_b128 v[144:147], v31 offset:5120
v_mov_b32 v27, s84
v_mfma_f32_16x16x32_bf16 v[212:215], v[116:119], a[24:27], v[212:215]
ds_read_b128 v[148:151], v31 offset:14336
v_mfma_f32_16x16x32_bf16 v[216:219], v[88:91], a[84:87], v[216:219]
v_mfma_f32_16x16x32_bf16 v[208:211], v[120:123], a[28:31], v[208:211]
ds_read_b128 v[152:155], v31 offset:23552
v_mfma_f32_16x16x32_bf16 v[212:215], v[124:127], a[28:31], v[212:215]
ds_read_b128 v[156:159], v31 offset:32768
v_mfma_f32_16x16x32_bf16 v[220:223], v[92:95], a[84:87], v[220:223]
s_waitcnt lgkmcnt(4)
v_mfma_f32_16x16x32_bf16 v[208:211], v[128:131], a[32:35], v[208:211]
ds_read_b128 v[160:163], v31 offset:6144
v_mfma_f32_16x16x32_bf16 v[212:215], v[132:135], a[32:35], v[212:215]
ds_read_b128 v[164:167], v31 offset:15360
v_mfma_f32_16x16x32_bf16 v[216:219], v[96:99], a[88:91], v[216:219]
v_mfma_f32_16x16x32_bf16 v[208:211], v[136:139], a[36:39], v[208:211]
ds_read_b128 v[168:171], v31 offset:24576
v_mfma_f32_16x16x32_bf16 v[212:215], v[140:143], a[36:39], v[212:215]
ds_read_b128 v[172:175], v31 offset:33792
v_mfma_f32_16x16x32_bf16 v[220:223], v[100:103], a[88:91], v[220:223]
s_waitcnt lgkmcnt(4)
v_mfma_f32_16x16x32_bf16 v[208:211], v[144:147], a[40:43], v[208:211]
ds_read_b128 v[176:179], v31 offset:7168
v_mfma_f32_16x16x32_bf16 v[212:215], v[148:151], a[40:43], v[212:215]
ds_read_b128 v[180:183], v31 offset:16384
s_waitcnt vmcnt(4)
ds_write_b32 v18, v24
v_mfma_f32_16x16x32_bf16 v[216:219], v[104:107], a[92:95], v[216:219]
v_mfma_f32_16x16x32_bf16 v[208:211], v[152:155], a[44:47], v[208:211]
ds_read_b128 v[184:187], v31 offset:25600
v_mfma_f32_16x16x32_bf16 v[212:215], v[156:159], a[44:47], v[212:215]
ds_read_b128 v[188:191], v31 offset:34816
s_waitcnt lgkmcnt(2)
s_barrier
v_mfma_f32_16x16x32_bf16 v[220:223], v[108:111], a[92:95], v[220:223]
ds_read_b32 v33, v32
v_mfma_f32_16x16x32_bf16 v[208:211], v[160:163], a[48:51], v[208:211]
ds_read_b128 v[192:195], v31 offset:8192
v_mfma_f32_16x16x32_bf16 v[212:215], v[164:167], a[48:51], v[212:215]
ds_read_b128 v[196:199], v31 offset:17408
v_mfma_f32_16x16x32_bf16 v[216:219], v[112:115], a[96:99], v[216:219]
s_waitcnt lgkmcnt(2)
v_cmp_gt_u32 vcc, s52, v33
v_mfma_f32_16x16x32_bf16 v[208:211], v[168:171], a[52:55], v[208:211]
ds_read_b128 v[200:203], v31 offset:26624
v_cmp_gt_u32 s[58:59], s54, v33
v_mfma_f32_16x16x32_bf16 v[212:215], v[172:175], a[52:55], v[212:215]
ds_read_b128 v[204:207], v31 offset:35840
s_and_b32 vcc_lo, vcc_lo, s56
s_cselect_b32 s70, 0, 1
v_mfma_f32_16x16x32_bf16 v[220:223], v[116:119], a[96:99], v[220:223]
v_mfma_f32_16x16x32_bf16 v[208:211], v[176:179], a[56:59], v[208:211]
s_and_b32 s59, s59, s56
s_cselect_b32 s71, 0, s95
v_mfma_f32_16x16x32_bf16 v[212:215], v[180:183], a[56:59], v[212:215]
s_or_b32 s76, s70, s71
s_cselect_b32 s10, 268435456, 0
v_mfma_f32_16x16x32_bf16 v[216:219], v[120:123], a[100:103], v[216:219]
s_cmp_lg_u32 s70, 0
s_cselect_b64 s[72:73], s[52:53], s[54:55]
s_cselect_b64 s[58:59], s[44:45], s[46:47]
v_mfma_f32_16x16x32_bf16 v[208:211], v[184:187], a[60:63], v[208:211]
s_mul_i32 s74, s72, s20
s_add_u32 s74, s74, s58
v_mfma_f32_16x16x32_bf16 v[212:215], v[188:191], a[60:63], v[212:215]
s_add_u32 m0, s48, 0
s_mul_i32 s75, s72, s21
s_add_u32 s75, s75, s59
v_mfma_f32_16x16x32_bf16 v[220:223], v[124:127], a[100:103], v[220:223]
buffer_load_dwordx4 v8, s[8:11], s74 offen offset:0 sc1 lds
s_waitcnt lgkmcnt(0)
v_mfma_f32_16x16x32_bf16 v[208:211], v[192:195], a[64:67], v[208:211]
s_andn2_b32 s71, s71, s70
s_add_u32 s52, s52, s70
s_add_u32 s54, s54, s71
v_mfma_f32_16x16x32_bf16 v[212:215], v[196:199], a[64:67], v[212:215]
s_mov_b32 s77, s76
v_mfma_f32_16x16x32_bf16 v[216:219], v[128:131], a[104:107], v[216:219]
buffer_load_dwordx4 v9, s[8:11], s74 offen offset:1024 sc1 lds
v_mfma_f32_16x16x32_bf16 v[208:211], v[200:203], a[68:71], v[208:211]
v_mfma_f32_16x16x32_bf16 v[212:215], v[204:207], a[68:71], v[212:215]
v_mfma_f32_16x16x32_bf16 v[220:223], v[132:135], a[104:107], v[220:223]
buffer_load_dwordx4 v10, s[8:11], s74 offen offset:2048 sc1 lds
v_mfma_f32_16x16x32_bf16 v[216:219], v[136:139], a[108:111], v[216:219]
v_mfma_f32_16x16x32_bf16 v[220:223], v[140:143], a[108:111], v[220:223]
v_mfma_f32_16x16x32_bf16 v[216:219], v[144:147], a[112:115], v[216:219]
buffer_load_dwordx4 v11, s[8:11], s74 offen offset:3072 sc1 lds
v_mfma_f32_16x16x32_bf16 v[220:223], v[148:151], a[112:115], v[220:223]
v_mfma_f32_16x16x32_bf16 v[216:219], v[152:155], a[116:119], v[216:219]
s_add_u32 m0, s48, 4096
v_cvt_pk_bf16_f32 v48, v208, v209
v_mfma_f32_16x16x32_bf16 v[220:223], v[156:159], a[116:119], v[220:223]
buffer_load_dwordx4 v12, s[8:11], s74 offen offset:0 sc1 lds
v_mfma_f32_16x16x32_bf16 v[216:219], v[160:163], a[120:123], v[216:219]
v_cvt_pk_bf16_f32 v49, v210, v211
v_cvt_pk_bf16_f32 v50, v212, v213
v_mfma_f32_16x16x32_bf16 v[220:223], v[164:167], a[120:123], v[220:223]
v_cvt_pk_bf16_f32 v51, v214, v215
v_mfma_f32_16x16x32_bf16 v[216:219], v[168:171], a[124:127], v[216:219]
buffer_load_dwordx4 v13, s[8:11], s74 offen offset:1024 sc1 lds
v_mfma_f32_16x16x32_bf16 v[220:223], v[172:175], a[124:127], v[220:223]
buffer_store_dwordx4 v[48:51], v19, s[4:7], s93 offen sc1
v_mfma_f32_16x16x32_bf16 v[216:219], v[176:179], a[128:131], v[216:219]
v_mfma_f32_16x16x32_bf16 v[220:223], v[180:183], a[128:131], v[220:223]
buffer_load_dwordx4 v14, s[8:11], s74 offen offset:2048 sc1 lds
v_mfma_f32_16x16x32_bf16 v[216:219], v[184:187], a[132:135], v[216:219]
v_mfma_f32_16x16x32_bf16 v[220:223], v[188:191], a[132:135], v[220:223]
v_mfma_f32_16x16x32_bf16 v[216:219], v[192:195], a[136:139], v[216:219]
buffer_load_dwordx4 v15, s[8:11], s74 offen offset:3072 sc1 lds
v_mfma_f32_16x16x32_bf16 v[220:223], v[196:199], a[136:139], v[220:223]
v_mfma_f32_16x16x32_bf16 v[216:219], v[200:203], a[140:143], v[216:219]
s_add_u32 m0, s48, 8192
v_mfma_f32_16x16x32_bf16 v[220:223], v[204:207], a[140:143], v[220:223]
buffer_load_dwordx4 v16, s[8:11], s74 offen offset:0 sc1 lds
v_mfma_f32_16x16x32_bf16 v[224:227], v[64:67], a[144:147], 0
v_mfma_f32_16x16x32_bf16 v[228:231], v[68:71], a[144:147], 0
v_mfma_f32_16x16x32_bf16 v[224:227], v[72:75], a[148:151], v[224:227]
v_mfma_f32_16x16x32_bf16 v[228:231], v[76:79], a[148:151], v[228:231]
v_mfma_f32_16x16x32_bf16 v[224:227], v[80:83], a[152:155], v[224:227]
buffer_load_dword v24, v22, s[4:7], 0 offen sc1
v_mfma_f32_16x16x32_bf16 v[228:231], v[84:87], a[152:155], v[228:231]
v_cvt_pk_bf16_f32 v52, v216, v217
v_cvt_pk_bf16_f32 v53, v218, v219
v_mfma_f32_16x16x32_bf16 v[224:227], v[88:91], a[156:159], v[224:227]
s_waitcnt vmcnt(11)
s_barrier
v_mfma_f32_16x16x32_bf16 v[228:231], v[92:95], a[156:159], v[228:231]
buffer_store_dword v27, v45, s[4:7], s85 offen
v_mfma_f32_16x16x32_bf16 v[224:227], v[96:99], a[160:163], v[224:227]
buffer_store_dword v27, v44, s[4:7], s85 offen sc1
v_mfma_f32_16x16x32_bf16 v[228:231], v[100:103], a[160:163], v[228:231]
v_cvt_pk_bf16_f32 v54, v220, v221
v_cvt_pk_bf16_f32 v55, v222, v223
v_mfma_f32_16x16x32_bf16 v[224:227], v[104:107], a[164:167], v[224:227]
buffer_store_dwordx4 v[52:55], v20, s[4:7], s93 offen sc1
v_mfma_f32_16x16x32_bf16 v[228:231], v[108:111], a[164:167], v[228:231]
v_mfma_f32_16x16x32_bf16 v[224:227], v[112:115], a[168:171], v[224:227]
v_mfma_f32_16x16x32_bf16 v[228:231], v[116:119], a[168:171], v[228:231]
v_mfma_f32_16x16x32_bf16 v[224:227], v[120:123], a[172:175], v[224:227]
v_mfma_f32_16x16x32_bf16 v[228:231], v[124:127], a[172:175], v[228:231]
v_mfma_f32_16x16x32_bf16 v[224:227], v[128:131], a[176:179], v[224:227]
v_mfma_f32_16x16x32_bf16 v[228:231], v[132:135], a[176:179], v[228:231]
v_mfma_f32_16x16x32_bf16 v[224:227], v[136:139], a[180:183], v[224:227]
v_mfma_f32_16x16x32_bf16 v[228:231], v[140:143], a[180:183], v[228:231]
v_mfma_f32_16x16x32_bf16 v[224:227], v[144:147], a[184:187], v[224:227]
v_mfma_f32_16x16x32_bf16 v[228:231], v[148:151], a[184:187], v[228:231]
v_mfma_f32_16x16x32_bf16 v[224:227], v[152:155], a[188:191], v[224:227]
v_mfma_f32_16x16x32_bf16 v[228:231], v[156:159], a[188:191], v[228:231]
v_mfma_f32_16x16x32_bf16 v[224:227], v[160:163], a[192:195], v[224:227]
s_waitcnt vmcnt(12)
s_barrier
v_mfma_f32_16x16x32_bf16 v[228:231], v[164:167], a[192:195], v[228:231]
v_mfma_f32_16x16x32_bf16 v[224:227], v[168:171], a[196:199], v[224:227]
s_cmp_eq_u32 s76, 0
s_cbranch_scc1 g_slow_31
v_mfma_f32_16x16x32_bf16 v[228:231], v[172:175], a[196:199], v[228:231]
ds_read_b128 v[64:67], v28 offset:0
v_mfma_f32_16x16x32_bf16 v[224:227], v[176:179], a[200:203], v[224:227]
ds_read_b128 v[68:71], v28 offset:9216
v_mfma_f32_16x16x32_bf16 v[228:231], v[180:183], a[200:203], v[228:231]
ds_read_b128 v[72:75], v28 offset:18432
v_mfma_f32_16x16x32_bf16 v[224:227], v[184:187], a[204:207], v[224:227]
ds_read_b128 v[76:79], v28 offset:27648
v_mfma_f32_16x16x32_bf16 v[228:231], v[188:191], a[204:207], v[228:231]
ds_read_b128 v[80:83], v28 offset:1024
v_mfma_f32_16x16x32_bf16 v[224:227], v[192:195], a[208:211], v[224:227]
ds_read_b128 v[84:87], v28 offset:10240
v_mfma_f32_16x16x32_bf16 v[228:231], v[196:199], a[208:211], v[228:231]
ds_read_b128 v[88:91], v28 offset:19456
v_mfma_f32_16x16x32_bf16 v[224:227], v[200:203], a[212:215], v[224:227]
ds_read_b128 v[92:95], v28 offset:28672
v_mfma_f32_16x16x32_bf16 v[228:231], v[204:207], a[212:215], v[228:231]
s_waitcnt vmcnt(9)
s_barrier
s_branch g_body_16
g_slow_28:
v_mfma_f32_16x16x32_bf16 v[228:231], v[172:175], a[196:199], v[228:231]
v_mfma_f32_16x16x32_bf16 v[224:227], v[176:179], a[200:203], v[224:227]
v_mfma_f32_16x16x32_bf16 v[228:231], v[180:183], a[200:203], v[228:231]
v_mfma_f32_16x16x32_bf16 v[224:227], v[184:187], a[204:207], v[224:227]
v_mfma_f32_16x16x32_bf16 v[228:231], v[188:191], a[204:207], v[228:231]
v_mfma_f32_16x16x32_bf16 v[224:227], v[192:195], a[208:211], v[224:227]
v_mfma_f32_16x16x32_bf16 v[228:231], v[196:199], a[208:211], v[228:231]
v_mfma_f32_16x16x32_bf16 v[224:227], v[200:203], a[212:215], v[224:227]
v_mfma_f32_16x16x32_bf16 v[228:231], v[204:207], a[212:215], v[228:231]
s_nop 6
v_cvt_pk_bf16_f32 v56, v224, v225
v_cvt_pk_bf16_f32 v57, v226, v227
v_cvt_pk_bf16_f32 v58, v228, v229
v_cvt_pk_bf16_f32 v59, v230, v231
buffer_store_dwordx4 v[56:59], v21, s[4:7], s75 offen sc1
s_mov_b32 s75, 1879048192
s_waitcnt vmcnt(4)
ds_write_b32 v18, v24
s_waitcnt lgkmcnt(0)
s_barrier
ds_read_b32 v33, v32
s_waitcnt lgkmcnt(0)
v_cmp_gt_u32 vcc, s52, v33
v_cmp_gt_u32 s[58:59], s54, v33
s_and_b32 vcc_lo, vcc_lo, s56
s_cselect_b32 s70, 0, 1
s_and_b32 s59, s59, s56
s_cselect_b32 s71, 0, s77
s_or_b32 s82, s70, s71
s_cselect_b32 s10, 268435456, 0
s_cmp_lg_u32 s70, 0
s_cselect_b64 s[78:79], s[52:53], s[54:55]
s_cselect_b64 s[58:59], s[44:45], s[46:47]
s_mul_i32 s80, s78, s20
s_add_u32 s80, s80, s58
s_mul_i32 s81, s78, s21
s_add_u32 s81, s81, s59
s_andn2_b32 s71, s71, s70
s_add_u32 s52, s52, s70
s_add_u32 s54, s54, s71
s_mov_b32 s83, s82
s_cmp_lg_u32 s82, 0
s_cbranch_scc1 g_go_32
v_mov_b32 v27, s72
s_waitcnt vmcnt(0)
s_barrier
s_add_u32 s70, s52, s54
s_cmp_eq_u32 s70, 130
s_cbranch_scc1 g_fin_20
s_cmp_lg_u32 s3, 0
s_cbranch_scc1 sp_ok_34_j
s_mov_b32 s23, 0
buffer_load_dword v33, v22, s[4:7], 0 offen sc1
buffer_store_dword v27, v45, s[4:7], s73 offen
buffer_store_dword v27, v44, s[4:7], s73 offen sc1
s_waitcnt vmcnt(2)
s_branch sp_loop_33_e
sp_loop_33:
buffer_load_dword v33, v22, s[4:7], 0 offen sc1
s_add_u32 s23, s23, 1
s_cmp_gt_u32 s23, 150000
s_cbranch_scc1 sp_bad_35
s_waitcnt vmcnt(0)
sp_loop_33_e:
v_cmp_gt_u32 vcc, s52, v33
v_cmp_gt_u32 s[58:59], s54, v33
s_and_b32 vcc_lo, vcc_lo, s56
s_cbranch_scc0 sp_ok_34
s_cmp_gt_u32 s23, 4
s_cselect_b32 s70, 0, s56
s_cmp_lg_u32 s77, 0
s_cselect_b32 s70, 0, s70
s_or_b32 s59, s59, s70
s_and_b32 s59, s59, s56
s_cbranch_scc0 sp_ok_34
s_sleep 1
s_branch sp_loop_33
sp_bad_35:
s_mov_b32 s98, 1025
s_branch L_fail
sp_ok_34:
ds_write_b32 v18, v33
s_waitcnt lgkmcnt(0)
sp_ok_34_j:
s_barrier
ds_read_b32 v33, v32
s_waitcnt lgkmcnt(0)
s_mov_b32 s73, 1879048192
v_cmp_gt_u32 vcc, s52, v33
v_cmp_gt_u32 s[58:59], s54, v33
s_and_b32 vcc_lo, vcc_lo, s56
s_cselect_b32 s70, 0, 1
s_and_b32 s59, s59, s56
s_cselect_b32 s71, 0, 1
s_or_b32 s82, s70, s71
s_cselect_b32 s10, 268435456, 0
s_cmp_lg_u32 s70, 0
s_cselect_b64 s[78:79], s[52:53], s[54:55]
s_cselect_b64 s[58:59], s[44:45], s[46:47]
s_mul_i32 s80, s78, s20
s_add_u32 s80, s80, s58
s_mul_i32 s81, s78, s21
s_add_u32 s81, s81, s59
s_andn2_b32 s71, s71, s70
s_add_u32 s52, s52, s70
s_add_u32 s54, s54, s71
s_mov_b32 s83, s82
g_go_32:
s_add_u32 m0, s49, 0
s_nop 0
buffer_load_dwordx4 v8, s[4:7], s80 offen offset:0 sc1 lds
buffer_load_dwordx4 v9, s[4:7], s80 offen offset:1024 sc1 lds
buffer_load_dwordx4 v10, s[4:7], s80 offen offset:2048 sc1 lds
buffer_load_dwordx4 v11, s[4:7], s80 offen offset:3072 sc1 lds
s_add_u32 m0, s49, 4096
s_nop 0
buffer_load_dwordx4 v12, s[4:7], s80 offen offset:0 sc1 lds
buffer_load_dwordx4 v13, s[4:7], s80 offen offset:1024 sc1 lds
buffer_load_dwordx4 v14, s[4:7], s80 offen offset:2048 sc1 lds
buffer_load_dwordx4 v15, s[4:7], s80 offen offset:3072 sc1 lds
s_add_u32 m0, s49, 8192
s_nop 0
buffer_load_dwordx4 v16, s[4:7], s80 offen offset:0 sc1 lds
buffer_load_dword v24, v22, s[4:7], 0 offen sc1
buffer_store_dword v27, v34, s[4:7], 0 offen
v_mov_b32 v27, s72
s_waitcnt vmcnt(9)
s_barrier
buffer_store_dword v27, v45, s[4:7], s73 offen
buffer_store_dword v27, v44, s[4:7], s73 offen sc1
s_mov_b32 s73, 1879048192
ds_read_b128 v[64:67], v29 offset:0
ds_read_b128 v[68:71], v29 offset:9216
ds_read_b128 v[72:75], v29 offset:18432
ds_read_b128 v[76:79], v29 offset:27648
ds_read_b128 v[80:83], v29 offset:1024
ds_read_b128 v[84:87], v29 offset:10240
ds_read_b128 v[88:91], v29 offset:19456
ds_read_b128 v[92:95], v29 offset:28672
s_waitcnt vmcnt(8)
s_barrier
s_branch g_body_17
g_slow_29:
v_mfma_f32_16x16x32_bf16 v[228:231], v[172:175], a[196:199], v[228:231]
v_mfma_f32_16x16x32_bf16 v[224:227], v[176:179], a[200:203], v[224:227]
v_mfma_f32_16x16x32_bf16 v[228:231], v[180:183], a[200:203], v[228:231]
v_mfma_f32_16x16x32_bf16 v[224:227], v[184:187], a[204:207], v[224:227]
v_mfma_f32_16x16x32_bf16 v[228:231], v[188:191], a[204:207], v[228:231]
v_mfma_f32_16x16x32_bf16 v[224:227], v[192:195], a[208:211], v[224:227]
v_mfma_f32_16x16x32_bf16 v[228:231], v[196:199], a[208:211], v[228:231]
v_mfma_f32_16x16x32_bf16 v[224:227], v[200:203], a[212:215], v[224:227]
v_mfma_f32_16x16x32_bf16 v[228:231], v[204:207], a[212:215], v[228:231]
s_nop 6
v_cvt_pk_bf16_f32 v56, v224, v225
v_cvt_pk_bf16_f32 v57, v226, v227
v_cvt_pk_bf16_f32 v58, v228, v229
v_cvt_pk_bf16_f32 v59, v230, v231
buffer_store_dwordx4 v[56:59], v21, s[4:7], s81 offen sc1
s_mov_b32 s81, 1879048192
s_waitcnt vmcnt(4)
ds_write_b32 v18, v24
s_waitcnt lgkmcnt(0)
s_barrier
ds_read_b32 v33, v32
s_waitcnt lgkmcnt(0)
v_cmp_gt_u32 vcc, s52, v33
v_cmp_gt_u32 s[58:59], s54, v33
s_and_b32 vcc_lo, vcc_lo, s56
s_cselect_b32 s70, 0, 1
s_and_b32 s59, s59, s56
s_cselect_b32 s71, 0, s83
s_or_b32 s88, s70, s71
s_cselect_b32 s10, 268435456, 0
s_cmp_lg_u32 s70, 0
s_cselect_b64 s[84:85], s[52:53], s[54:55]
s_cselect_b64 s[58:59], s[44:45], s[46:47]
s_mul_i32 s86, s84, s20
s_add_u32 s86, s86, s58
s_mul_i32 s87, s84, s21
s_add_u32 s87, s87, s59
s_andn2_b32 s71, s71, s70
s_add_u32 s52, s52, s70
s_add_u32 s54, s54, s71
s_mov_b32 s89, s88
s_cmp_lg_u32 s88, 0
s_cbranch_scc1 g_go_36
v_mov_b32 v27, s78
s_waitcnt vmcnt(0)
s_barrier
s_add_u32 s70, s52, s54
s_cmp_eq_u32 s70, 130
s_cbranch_scc1 g_fin_20
s_cmp_lg_u32 s3, 0
s_cbranch_scc1 sp_ok_38_j
s_mov_b32 s23, 0
buffer_load_dword v33, v22, s[4:7], 0 offen sc1
buffer_store_dword v27, v45, s[4:7], s79 offen
buffer_store_dword v27, v44, s[4:7], s79 offen sc1
s_waitcnt vmcnt(2)
s_branch sp_loop_37_e
sp_loop_37:
buffer_load_dword v33, v22, s[4:7], 0 offen sc1
s_add_u32 s23, s23, 1
s_cmp_gt_u32 s23, 150000
s_cbranch_scc1 sp_bad_39
s_waitcnt vmcnt(0)
sp_loop_37_e:
v_cmp_gt_u32 vcc, s52, v33
v_cmp_gt_u32 s[58:59], s54, v33
s_and_b32 vcc_lo, vcc_lo, s56
s_cbranch_scc0 sp_ok_38
s_cmp_gt_u32 s23, 4
s_cselect_b32 s70, 0, s56
s_cmp_lg_u32 s83, 0
s_cselect_b32 s70, 0, s70
s_or_b32 s59, s59, s70
s_and_b32 s59, s59, s56
s_cbranch_scc0 sp_ok_38
s_sleep 1
s_branch sp_loop_37
sp_bad_39:
s_mov_b32 s98, 1025
s_branch L_fail
sp_ok_38:
ds_write_b32 v18, v33
s_waitcnt lgkmcnt(0)
sp_ok_38_j:
s_barrier
ds_read_b32 v33, v32
s_waitcnt lgkmcnt(0)
s_mov_b32 s79, 1879048192
v_cmp_gt_u32 vcc, s52, v33
v_cmp_gt_u32 s[58:59], s54, v33
s_and_b32 vcc_lo, vcc_lo, s56
s_cselect_b32 s70, 0, 1
s_and_b32 s59, s59, s56
s_cselect_b32 s71, 0, 1
s_or_b32 s88, s70, s71
s_cselect_b32 s10, 268435456, 0
s_cmp_lg_u32 s70, 0
s_cselect_b64 s[84:85], s[52:53], s[54:55]
s_cselect_b64 s[58:59], s[44:45], s[46:47]
s_mul_i32 s86, s84, s20
s_add_u32 s86, s86, s58
s_mul_i32 s87, s84, s21
s_add_u32 s87, s87, s59
s_andn2_b32 s71, s71, s70
s_add_u32 s52, s52, s70
s_add_u32 s54, s54, s71
s_mov_b32 s89, s88
g_go_36:
s_add_u32 m0, s50, 0
s_nop 0
buffer_load_dwordx4 v8, s[4:7], s86 offen offset:0 sc1 lds
buffer_load_dwordx4 v9, s[4:7], s86 offen offset:1024 sc1 lds
buffer_load_dwordx4 v10, s[4:7], s86 offen offset:2048 sc1 lds
buffer_load_dwordx4 v11, s[4:7], s86 offen offset:3072 sc1 lds
s_add_u32 m0, s50, 4096
s_nop 0
buffer_load_dwordx4 v12, s[4:7], s86 offen offset:0 sc1 lds
buffer_load_dwordx4 v13, s[4:7], s86 offen offset:1024 sc1 lds
buffer_load_dwordx4 v14, s[4:7], s86 offen offset:2048 sc1 lds
buffer_load_dwordx4 v15, s[4:7], s86 offen offset:3072 sc1 lds
s_add_u32 m0, s50, 8192
s_nop 0
buffer_load_dwordx4 v16, s[4:7], s86 offen offset:0 sc1 lds
buffer_load_dword v24, v22, s[4:7], 0 offen sc1
buffer_store_dword v27, v34, s[4:7], 0 offen
v_mov_b32 v27, s78
s_waitcnt vmcnt(9)
s_barrier
buffer_store_dword v27, v45, s[4:7], s79 offen
buffer_store_dword v27, v44, s[4:7], s79 offen sc1
s_mov_b32 s79, 1879048192
ds_read_b128 v[64:67], v30 offset:0
ds_read_b128 v[68:71], v30 offset:9216
ds_read_b128 v[72:75], v30 offset:18432
ds_read_b128 v[76:79], v30 offset:27648
ds_read_b128 v[80:83], v30 offset:1024
ds_read_b128 v[84:87], v30 offset:10240
ds_read_b128 v[88:91], v30 offset:19456
ds_read_b128 v[92:95], v30 offset:28672
s_waitcnt vmcnt(8)
s_barrier
s_branch g_body_18
g_slow_30:
v_mfma_f32_16x16x32_bf16 v[228:231], v[172:175], a[196:199], v[228:231]
v_mfma_f32_16x16x32_bf16 v[224:227], v[176:179], a[200:203], v[224:227]
v_mfma_f32_16x16x32_bf16 v[228:231], v[180:183], a[200:203], v[228:231]
v_mfma_f32_16x16x32_bf16 v[224:227], v[184:187], a[204:207], v[224:227]
v_mfma_f32_16x16x32_bf16 v[228:231], v[188:191], a[204:207], v[228:231]
v_mfma_f32_16x16x32_bf16 v[224:227], v[192:195], a[208:211], v[224:227]
v_mfma_f32_16x16x32_bf16 v[228:231], v[196:199], a[208:211], v[228:231]
v_mfma_f32_16x16x32_bf16 v[224:227], v[200:203], a[212:215], v[224:227]
v_mfma_f32_16x16x32_bf16 v[228:231], v[204:207], a[212:215], v[228:231]
s_nop 6
v_cvt_pk_bf16_f32 v56, v224, v225
v_cvt_pk_bf16_f32 v57, v226, v227
v_cvt_pk_bf16_f32 v58, v228, v229
v_cvt_pk_bf16_f32 v59, v230, v231
buffer_store_dwordx4 v[56:59], v21, s[4:7], s87 offen sc1
s_mov_b32 s87, 1879048192
s_waitcnt vmcnt(4)
ds_write_b32 v18, v24
s_waitcnt lgkmcnt(0)
s_barrier
ds_read_b32 v33, v32
s_waitcnt lgkmcnt(0)
v_cmp_gt_u32 vcc, s52, v33
v_cmp_gt_u32 s[58:59], s54, v33
s_and_b32 vcc_lo, vcc_lo, s56
s_cselect_b32 s70, 0, 1
s_and_b32 s59, s59, s56
s_cselect_b32 s71, 0, s89
s_or_b32 s94, s70, s71
s_cselect_b32 s10, 268435456, 0
s_cmp_lg_u32 s70, 0
s_cselect_b64 s[90:91], s[52:53], s[54:55]
s_cselect_b64 s[58:59], s[44:45], s[46:47]
s_mul_i32 s92, s90, s20
s_add_u32 s92, s92, s58
s_mul_i32 s93, s90, s21
s_add_u32 s93, s93, s59
s_andn2_b32 s71, s71, s70
s_add_u32 s52, s52, s70
s_add_u32 s54, s54, s71
s_mov_b32 s95, s94
s_cmp_lg_u32 s94, 0
s_cbranch_scc1 g_go_40
v_mov_b32 v27, s84
s_waitcnt vmcnt(0)
s_barrier
s_add_u32 s70, s52, s54
s_cmp_eq_u32 s70, 130
s_cbranch_scc1 g_fin_20
s_cmp_lg_u32 s3, 0
s_cbranch_scc1 sp_ok_42_j
s_mov_b32 s23, 0
buffer_load_dword v33, v22, s[4:7], 0 offen sc1
buffer_store_dword v27, v45, s[4:7], s85 offen
buffer_store_dword v27, v44, s[4:7], s85 offen sc1
s_waitcnt vmcnt(2)
s_branch sp_loop_41_e
sp_loop_41:
buffer_load_dword v33, v22, s[4:7], 0 offen sc1
s_add_u32 s23, s23, 1
s_cmp_gt_u32 s23, 150000
s_cbranch_scc1 sp_bad_43
s_waitcnt vmcnt(0)
sp_loop_41_e:
v_cmp_gt_u32 vcc, s52, v33
v_cmp_gt_u32 s[58:59], s54, v33
s_and_b32 vcc_lo, vcc_lo, s56
s_cbranch_scc0 sp_ok_42
s_cmp_gt_u32 s23, 4
s_cselect_b32 s70, 0, s56
s_cmp_lg_u32 s89, 0
s_cselect_b32 s70, 0, s70
s_or_b32 s59, s59, s70
s_and_b32 s59, s59, s56
s_cbranch_scc0 sp_ok_42
s_sleep 1
s_branch sp_loop_41
sp_bad_43:
s_mov_b32 s98, 1025
s_branch L_fail
sp_ok_42:
ds_write_b32 v18, v33
s_waitcnt lgkmcnt(0)
sp_ok_42_j:
s_barrier
ds_read_b32 v33, v32
s_waitcnt lgkmcnt(0)
s_mov_b32 s85, 1879048192
v_cmp_gt_u32 vcc, s52, v33
v_cmp_gt_u32 s[58:59], s54, v33
s_and_b32 vcc_lo, vcc_lo, s56
s_cselect_b32 s70, 0, 1
s_and_b32 s59, s59, s56
s_cselect_b32 s71, 0, 1
s_or_b32 s94, s70, s71
s_cselect_b32 s10, 268435456, 0
s_cmp_lg_u32 s70, 0
s_cselect_b64 s[90:91], s[52:53], s[54:55]
s_cselect_b64 s[58:59], s[44:45], s[46:47]
s_mul_i32 s92, s90, s20
s_add_u32 s92, s92, s58
s_mul_i32 s93, s90, s21
s_add_u32 s93, s93, s59
s_andn2_b32 s71, s71, s70
s_add_u32 s52, s52, s70
s_add_u32 s54, s54, s71
s_mov_b32 s95, s94
g_go_40:
s_add_u32 m0, s51, 0
s_nop 0
buffer_load_dwordx4 v8, s[4:7], s92 offen offset:0 sc1 lds
buffer_load_dwordx4 v9, s[4:7], s92 offen offset:1024 sc1 lds
buffer_load_dwordx4 v10, s[4:7], s92 offen offset:2048 sc1 lds
buffer_load_dwordx4 v11, s[4:7], s92 offen offset:3072 sc1 lds
s_add_u32 m0, s51, 4096
s_nop 0
buffer_load_dwordx4 v12, s[4:7], s92 offen offset:0 sc1 lds
buffer_load_dwordx4 v13, s[4:7], s92 offen offset:1024 sc1 lds
buffer_load_dwordx4 v14, s[4:7], s92 offen offset:2048 sc1 lds
buffer_load_dwordx4 v15, s[4:7], s92 offen offset:3072 sc1 lds
s_add_u32 m0, s51, 8192
s_nop 0
buffer_load_dwordx4 v16, s[4:7], s92 offen offset:0 sc1 lds
buffer_load_dword v24, v22, s[4:7], 0 offen sc1
buffer_store_dword v27, v34, s[4:7], 0 offen
v_mov_b32 v27, s84
s_waitcnt vmcnt(9)
s_barrier
buffer_store_dword v27, v45, s[4:7], s85 offen
buffer_store_dword v27, v44, s[4:7], s85 offen sc1
s_mov_b32 s85, 1879048192
ds_read_b128 v[64:67], v31 offset:0
ds_read_b128 v[68:71], v31 offset:9216
ds_read_b128 v[72:75], v31 offset:18432
ds_read_b128 v[76:79], v31 offset:27648
ds_read_b128 v[80:83], v31 offset:1024
ds_read_b128 v[84:87], v31 offset:10240
ds_read_b128 v[88:91], v31 offset:19456
ds_read_b128 v[92:95], v31 offset:28672
s_waitcnt vmcnt(8)
s_barrier
s_branch g_body_19
g_slow_31:
v_mfma_f32_16x16x32_bf16 v[228:231], v[172:175], a[196:199], v[228:231]
v_mfma_f32_16x16x32_bf16 v[224:227], v[176:179], a[200:203], v[224:227]
v_mfma_f32_16x16x32_bf16 v[228:231], v[180:183], a[200:203], v[228:231]
v_mfma_f32_16x16x32_bf16 v[224:227], v[184:187], a[204:207], v[224:227]
v_mfma_f32_16x16x32_bf16 v[228:231], v[188:191], a[204:207], v[228:231]
v_mfma_f32_16x16x32_bf16 v[224:227], v[192:195], a[208:211], v[224:227]
v_mfma_f32_16x16x32_bf16 v[228:231], v[196:199], a[208:211], v[228:231]
v_mfma_f32_16x16x32_bf16 v[224:227], v[200:203], a[212:215], v[224:227]
v_mfma_f32_16x16x32_bf16 v[228:231], v[204:207], a[212:215], v[228:231]
s_nop 6
v_cvt_pk_bf16_f32 v56, v224, v225
v_cvt_pk_bf16_f32 v57, v226, v227
v_cvt_pk_bf16_f32 v58, v228, v229
v_cvt_pk_bf16_f32 v59, v230, v231
buffer_store_dwordx4 v[56:59], v21, s[4:7], s93 offen sc1
s_mov_b32 s93, 1879048192
s_waitcnt vmcnt(4)
ds_write_b32 v18, v24
s_waitcnt lgkmcnt(0)
s_barrier
ds_read_b32 v33, v32
s_waitcnt lgkmcnt(0)
v_cmp_gt_u32 vcc, s52, v33
v_cmp_gt_u32 s[58:59], s54, v33
s_and_b32 vcc_lo, vcc_lo, s56
s_cselect_b32 s70, 0, 1
s_and_b32 s59, s59, s56
s_cselect_b32 s71, 0, s95
s_or_b32 s76, s70, s71
s_cselect_b32 s10, 268435456, 0
s_cmp_lg_u32 s70, 0
s_cselect_b64 s[72:73], s[52:53], s[54:55]
s_cselect_b64 s[58:59], s[44:45], s[46:47]
s_mul_i32 s74, s72, s20
s_add_u32 s74, s74, s58
s_mul_i32 s75, s72, s21
s_add_u32 s75, s75, s59
s_andn2_b32 s71, s71, s70
s_add_u32 s52, s52, s70
s_add_u32 s54, s54, s71
s_mov_b32 s77, s76
s_cmp_lg_u32 s76, 0
s_cbranch_scc1 g_go_44
v_mov_b32 v27, s90
s_waitcnt vmcnt(0)
s_barrier
s_add_u32 s70, s52, s54
s_cmp_eq_u32 s70, 130
s_cbranch_scc1 g_fin_20
s_cmp_lg_u32 s3, 0
s_cbranch_scc1 sp_ok_46_j
s_mov_b32 s23, 0
buffer_load_dword v33, v22, s[4:7], 0 offen sc1
buffer_store_dword v27, v45, s[4:7], s91 offen
buffer_store_dword v27, v44, s[4:7], s91 offen sc1
s_waitcnt vmcnt(2)
s_branch sp_loop_45_e
sp_loop_45:
buffer_load_dword v33, v22, s[4:7], 0 offen sc1
s_add_u32 s23, s23, 1
s_cmp_gt_u32 s23, 150000
s_cbranch_scc1 sp_bad_47
s_waitcnt vmcnt(0)
sp_loop_45_e:
v_cmp_gt_u32 vcc, s52, v33
v_cmp_gt_u32 s[58:59], s54, v33
s_and_b32 vcc_lo, vcc_lo, s56
s_cbranch_scc0 sp_ok_46
s_cmp_gt_u32 s23, 4
s_cselect_b32 s70, 0, s56
s_cmp_lg_u32 s95, 0
s_cselect_b32 s70, 0, s70
s_or_b32 s59, s59, s70
s_and_b32 s59, s59, s56
s_cbranch_scc0 sp_ok_46
s_sleep 1
s_branch sp_loop_45
sp_bad_47:
s_mov_b32 s98, 1025
s_branch L_fail
sp_ok_46:
ds_write_b32 v18, v33
s_waitcnt lgkmcnt(0)
sp_ok_46_j:
s_barrier
ds_read_b32 v33, v32
s_waitcnt lgkmcnt(0)
s_mov_b32 s91, 1879048192
v_cmp_gt_u32 vcc, s52, v33
v_cmp_gt_u32 s[58:59], s54, v33
s_and_b32 vcc_lo, vcc_lo, s56
s_cselect_b32 s70, 0, 1
s_and_b32 s59, s59, s56
s_cselect_b32 s71, 0, 1
s_or_b32 s76, s70, s71
s_cselect_b32 s10, 268435456, 0
s_cmp_lg_u32 s70, 0
s_cselect_b64 s[72:73], s[52:53], s[54:55]
s_cselect_b64 s[58:59], s[44:45], s[46:47]
s_mul_i32 s74, s72, s20
s_add_u32 s74, s74, s58
s_mul_i32 s75, s72, s21
s_add_u32 s75, s75, s59
s_andn2_b32 s71, s71, s70
s_add_u32 s52, s52, s70
s_add_u32 s54, s54, s71
s_mov_b32 s77, s76
g_go_44:
s_add_u32 m0, s48, 0
s_nop 0
buffer_load_dwordx4 v8, s[4:7], s74 offen offset:0 sc1 lds
buffer_load_dwordx4 v9, s[4:7], s74 offen offset:1024 sc1 lds
buffer_load_dwordx4 v10, s[4:7], s74 offen offset:2048 sc1 lds
buffer_load_dwordx4 v11, s[4:7], s74 offen offset:3072 sc1 lds
s_add_u32 m0, s48, 4096
s_nop 0
buffer_load_dwordx4 v12, s[4:7], s74 offen offset:0 sc1 lds
buffer_load_dwordx4 v13, s[4:7], s74 offen offset:1024 sc1 lds
buffer_load_dwordx4 v14, s[4:7], s74 offen offset:2048 sc1 lds
buffer_load_dwordx4 v15, s[4:7], s74 offen offset:3072 sc1 lds
s_add_u32 m0, s48, 8192
s_nop 0
buffer_load_dwordx4 v16, s[4:7], s74 offen offset:0 sc1 lds
buffer_load_dword v24, v22, s[4:7], 0 offen sc1
buffer_store_dword v27, v34, s[4:7], 0 offen
v_mov_b32 v27, s90
s_waitcnt vmcnt(9)
s_barrier
buffer_store_dword v27, v45, s[4:7], s91 offen
buffer_store_dword v27, v44, s[4:7], s91 offen sc1
s_mov_b32 s91, 1879048192
ds_read_b128 v[64:67], v28 offset:0
ds_read_b128 v[68:71], v28 offset:9216
ds_read_b128 v[72:75], v28 offset:18432
ds_read_b128 v[76:79], v28 offset:27648
ds_read_b128 v[80:83], v28 offset:1024
ds_read_b128 v[84:87], v28 offset:10240
ds_read_b128 v[88:91], v28 offset:19456
ds_read_b128 v[92:95], v28 offset:28672
s_waitcnt vmcnt(8)
s_barrier
s_branch g_body_16
g_fin_20:
buffer_store_dword v27, v45, s[4:7], s91 offen
buffer_store_dword v27, v44, s[4:7], s91 offen sc1
s_endpgm
G_ssv18:
s_mov_b32 s8, s42
s_and_b32 s9, s43, 0xffff
s_mov_b32 s10, 0
s_mov_b32 s11, 0x20000
s_mov_b32 s22, 0
s_mul_i32 s48, s3, 9216
s_add_u32 s49, s48, 36864
s_add_u32 s50, s48, 73728
s_add_u32 s51, s48, 110592
s_mov_b32 s57, 0xbfb8aa3b
v_add_u32 v28, 0, v17
v_add_u32 v29, 36864, v17
v_add_u32 v30, 73728, v17
v_add_u32 v31, 110592, v17
v_lshlrev_b32 v1, 2, v0
v_add_u32 v32, 147456, v1
s_lshl_b32 s70, s3, 8
v_add_u32 v18, s70, v32
v_mov_b64 v[224:225], 0
v_mov_b64 v[236:237], 0
v_mov_b64 v[226:227], 0
v_mov_b64 v[238:239], 0
v_mov_b64 v[228:229], 0
v_mov_b64 v[240:241], 0
v_mov_b64 v[230:231], 0
v_mov_b64 v[242:243], 0
s_mov_b32 s12, s40
s_and_b32 s13, s41, 0xffff
s_mov_b32 s14, 256
s_mov_b32 s15, 0x20000
v_lshlrev_b32 v26, 2, v0
v_add_u32 v27, 128, v26
v_cmp_le_u32 vcc, 2, v0
s_nop 1
v_cndmask_b32 v26, v26, v27, vcc
v_mov_b32 v27, 192
v_cmp_eq_u32 vcc, 8, v0
s_nop 1
v_cndmask_b32 v26, v26, v27, vcc
v_mov_b32 v27, 2147483632
v_cmp_lt_u32 vcc, 8, v0
s_nop 1
v_cndmask_b32 v26, v26, v27, vcc
s_mov_b32 s98, 0
wi_loop_53:
buffer_load_dword v27, v26, s[12:15], 0 offen sc1
s_add_u32 s98, s98, 1
s_cmp_gt_u32 s98, 150000
s_cbranch_scc1 wi_bad_55
s_waitcnt vmcnt(0)
v_cmp_eq_u32 vcc, 32, v27
s_nop 0
s_and_b32 s97, vcc_lo, 0x1ff
s_cmp_eq_u32 s97, 0x1ff
s_cbranch_scc1 wi_ok_54
v_cmp_lt_u32 vcc, 32, v27
s_nop 0
s_and_b32 s96, vcc_lo, 0xff
s_cselect_b32 s96, 0x100, 0
s_and_b32 s96, s96, s97
s_cbranch_scc1 wi_over_56
s_sleep 8
s_branch wi_loop_53
wi_bad_55:
s_mov_b32 s98, 512
s_branch L_fail
wi_over_56:
s_mov_b32 s100, 255
wi_ok_54:
v_add_u32 v26, 65536, v22
v_cmp_eq_u32 vcc, s100, v23
s_nop 1
v_cndmask_b32 v22, v22, v26, vcc
s_mov_b32 s90, 0
s_mov_b32 s91, 1879048192
s_mov_b32 s93, 1879048192
v_mov_b32 v34, 2147483632
s_barrier
s_mov_b32 s95, 1
s_cmp_lg_u32 s3, 0
s_cbranch_scc1 sp_ok_58_j
s_mov_b32 s23, 0
sp_loop_57:
buffer_load_dword v33, v22, s[4:7], 0 offen sc1
s_add_u32 s23, s23, 1
s_cmp_gt_u32 s23, 150000
s_cbranch_scc1 sp_bad_59
s_waitcnt vmcnt(0)
sp_loop_57_e:
v_cmp_gt_u32 vcc, s52, v33
v_cmp_gt_u32 s[58:59], s54, v33
s_and_b32 vcc_lo, vcc_lo, s56
s_cbranch_scc0 sp_ok_58
s_cmp_gt_u32 s23, 4
s_cselect_b32 s70, 0, s56
s_cmp_lg_u32 s95, 0
s_cselect_b32 s70, 0, s70
s_or_b32 s59, s59, s70
s_and_b32 s59, s59, s56
s_cbranch_scc0 sp_ok_58
s_sleep 1
s_branch sp_loop_57
sp_bad_59:
s_mov_b32 s98, 1026
s_branch L_fail
sp_ok_58:
ds_write_b32 v18, v33
s_waitcnt lgkmcnt(0)
sp_ok_58_j:
s_barrier
ds_read_b32 v33, v32
s_waitcnt lgkmcnt(0)
v_cmp_gt_u32 vcc, s52, v33
v_cmp_gt_u32 s[58:59], s54, v33
s_and_b32 vcc_lo, vcc_lo, s56
s_cselect_b32 s70, 0, 1
s_and_b32 s59, s59, s56
s_cselect_b32 s71, 0, 1
s_or_b32 s76, s70, s71
s_cselect_b32 s10, 268435456, 0
s_cmp_lg_u32 s70, 0
s_cselect_b64 s[72:73], s[52:53], s[54:55]
s_cselect_b64 s[58:59], s[44:45], s[46:47]
s_mul_i32 s74, s72, s20
s_add_u32 s74, s74, s58
s_mul_i32 s75, s72, s21
s_add_u32 s75, s75, s59
s_andn2_b32 s71, s71, s70
s_add_u32 s52, s52, s70
s_add_u32 s54, s54, s71
s_mov_b32 s77, s76
s_add_u32 m0, s48, 0
s_nop 0
buffer_load_dwordx4 v8, s[4:7], s74 offen offset:0 sc1 lds
buffer_load_dwordx4 v9, s[4:7], s74 offen offset:1024 sc1 lds
buffer_load_dwordx4 v10, s[4:7], s74 offen offset:2048 sc1 lds
buffer_load_dwordx4 v11, s[4:7], s74 offen offset:3072 sc1 lds
s_add_u32 m0, s48, 4096
s_nop 0
buffer_load_dwordx4 v12, s[4:7], s74 offen offset:0 sc1 lds
buffer_load_dwordx4 v13, s[4:7], s74 offen offset:1024 sc1 lds
buffer_load_dwordx4 v14, s[4:7], s74 offen offset:2048 sc1 lds
buffer_load_dwordx4 v15, s[4:7], s74 offen offset:3072 sc1 lds
s_add_u32 m0, s48, 8192
s_nop 0
buffer_load_dwordx4 v16, s[4:7], s74 offen offset:0 sc1 lds
buffer_load_dword v24, v22, s[4:7], 0 offen sc1
buffer_store_dword v27, v34, s[4:7], 0 offen
v_mov_b32 v27, s90
s_waitcnt vmcnt(9)
s_barrier
buffer_store_dword v27, v45, s[4:7], s91 offen
buffer_store_dword v27, v44, s[4:7], s91 offen sc1
s_mov_b32 s91, 1879048192
ds_read_b128 v[64:67], v28 offset:0
ds_read_b128 v[68:71], v28 offset:9216
ds_read_b128 v[72:75], v28 offset:18432
ds_read_b128 v[76:79], v28 offset:27648
ds_read_b128 v[80:83], v28 offset:1024
ds_read_b128 v[84:87], v28 offset:10240
ds_read_b128 v[88:91], v28 offset:19456
ds_read_b128 v[92:95], v28 offset:28672
s_waitcnt vmcnt(8)
s_barrier
s_branch g_body_48
g_body_48:
s_waitcnt lgkmcnt(4)
v_mfma_f32_16x16x32_bf16 v[208:211], a[0:3], v[64:67], 0
ds_read_b128 v[96:99], v28 offset:2048
v_mfma_f32_16x16x32_bf16 v[212:215], a[0:3], v[68:71], 0
ds_read_b128 v[100:103], v28 offset:11264
v_mfma_f32_16x16x32_bf16 v[216:219], a[72:75], v[64:67], 0
v_mfma_f32_16x16x32_bf16 v[208:211], a[4:7], v[72:75], v[208:211]
ds_read_b128 v[104:107], v28 offset:20480
v_cvt_pk_bf16_f32 v56, v224, v225
v_mfma_f32_16x16x32_bf16 v[212:215], a[4:7], v[76:79], v[212:215]
ds_read_b128 v[108:111], v28 offset:29696
v_cvt_pk_bf16_f32 v57, v226, v227
v_mfma_f32_16x16x32_bf16 v[220:223], a[72:75], v[68:71], 0
v_cvt_pk_bf16_f32 v58, v228, v229
s_waitcnt lgkmcnt(4)
v_mfma_f32_16x16x32_bf16 v[208:211], a[8:11], v[80:83], v[208:211]
ds_read_b128 v[112:115], v28 offset:3072
v_cvt_pk_bf16_f32 v59, v230, v231
v_mfma_f32_16x16x32_bf16 v[212:215], a[8:11], v[84:87], v[212:215]
ds_read_b128 v[116:119], v28 offset:12288
v_mfma_f32_16x16x32_bf16 v[216:219], a[76:79], v[72:75], v[216:219]
buffer_store_dwordx4 v[56:59], v21, s[4:7], s93 offen sc1
v_mfma_f32_16x16x32_bf16 v[208:211], a[12:15], v[88:91], v[208:211]
ds_read_b128 v[120:123], v28 offset:21504
v_mfma_f32_16x16x32_bf16 v[212:215], a[12:15], v[92:95], v[212:215]
ds_read_b128 v[124:127], v28 offset:30720
v_mfma_f32_16x16x32_bf16 v[220:223], a[76:79], v[76:79], v[220:223]
s_waitcnt lgkmcnt(4)
v_mfma_f32_16x16x32_bf16 v[208:211], a[16:19], v[96:99], v[208:211]
ds_read_b128 v[128:131], v28 offset:4096
v_mfma_f32_16x16x32_bf16 v[212:215], a[16:19], v[100:103], v[212:215]
ds_read_b128 v[132:135], v28 offset:13312
v_mfma_f32_16x16x32_bf16 v[216:219], a[80:83], v[80:83], v[216:219]
v_mfma_f32_16x16x32_bf16 v[208:211], a[20:23], v[104:107], v[208:211]
ds_read_b128 v[136:139], v28 offset:22528
v_mfma_f32_16x16x32_bf16 v[212:215], a[20:23], v[108:111], v[212:215]
ds_read_b128 v[140:143], v28 offset:31744
v_mfma_f32_16x16x32_bf16 v[220:223], a[80:83], v[84:87], v[220:223]
s_waitcnt vmcnt(5)
s_barrier
s_waitcnt lgkmcnt(4)
v_mfma_f32_16x16x32_bf16 v[208:211], a[24:27], v[112:115], v[208:211]
ds_read_b128 v[144:147], v28 offset:5120
v_mov_b32 v27, s90
v_mfma_f32_16x16x32_bf16 v[212:215], a[24:27], v[116:119], v[212:215]
ds_read_b128 v[148:151], v28 offset:14336
v_mfma_f32_16x16x32_bf16 v[216:219], a[84:87], v[88:91], v[216:219]
v_mfma_f32_16x16x32_bf16 v[208:211], a[28:31], v[120:123], v[208:211]
ds_read_b128 v[152:155], v28 offset:23552
v_mfma_f32_16x16x32_bf16 v[212:215], a[28:31], v[124:127], v[212:215]
ds_read_b128 v[156:159], v28 offset:32768
v_mfma_f32_16x16x32_bf16 v[220:223], a[84:87], v[92:95], v[220:223]
s_waitcnt lgkmcnt(4)
v_mfma_f32_16x16x32_bf16 v[208:211], a[32:35], v[128:131], v[208:211]
ds_read_b128 v[160:163], v28 offset:6144
v_mfma_f32_16x16x32_bf16 v[212:215], a[32:35], v[132:135], v[212:215]
ds_read_b128 v[164:167], v28 offset:15360
v_mfma_f32_16x16x32_bf16 v[216:219], a[88:91], v[96:99], v[216:219]
v_mfma_f32_16x16x32_bf16 v[208:211], a[36:39], v[136:139], v[208:211]
ds_read_b128 v[168:171], v28 offset:24576
v_mfma_f32_16x16x32_bf16 v[212:215], a[36:39], v[140:143], v[212:215]
ds_read_b128 v[172:175], v28 offset:33792
v_mfma_f32_16x16x32_bf16 v[220:223], a[88:91], v[100:103], v[220:223]
s_waitcnt lgkmcnt(4)
v_mfma_f32_16x16x32_bf16 v[208:211], a[40:43], v[144:147], v[208:211]
ds_read_b128 v[176:179], v28 offset:7168
v_mfma_f32_16x16x32_bf16 v[212:215], a[40:43], v[148:151], v[212:215]
ds_read_b128 v[180:183], v28 offset:16384
s_waitcnt vmcnt(4)
ds_write_b32 v18, v24
v_mfma_f32_16x16x32_bf16 v[216:219], a[92:95], v[104:107], v[216:219]
v_mfma_f32_16x16x32_bf16 v[208:211], a[44:47], v[152:155], v[208:211]
ds_read_b128 v[184:187], v28 offset:25600
v_mfma_f32_16x16x32_bf16 v[212:215], a[44:47], v[156:159], v[212:215]
ds_read_b128 v[188:191], v28 offset:34816
s_waitcnt lgkmcnt(2)
s_barrier
v_mfma_f32_16x16x32_bf16 v[220:223], a[92:95], v[108:111], v[220:223]
ds_read_b32 v33, v32
v_mfma_f32_16x16x32_bf16 v[208:211], a[48:51], v[160:163], v[208:211]
ds_read_b128 v[192:195], v28 offset:8192
v_mfma_f32_16x16x32_bf16 v[212:215], a[48:51], v[164:167], v[212:215]
ds_read_b128 v[196:199], v28 offset:17408
v_mfma_f32_16x16x32_bf16 v[216:219], a[96:99], v[112:115], v[216:219]
s_waitcnt lgkmcnt(2)
v_cmp_gt_u32 vcc, s52, v33
v_mfma_f32_16x16x32_bf16 v[208:211], a[52:55], v[168:171], v[208:211]
ds_read_b128 v[200:203], v28 offset:26624
v_cmp_gt_u32 s[58:59], s54, v33
v_mfma_f32_16x16x32_bf16 v[212:215], a[52:55], v[172:175], v[212:215]
ds_read_b128 v[204:207], v28 offset:35840
s_and_b32 vcc_lo, vcc_lo, s56
s_cselect_b32 s70, 0, 1
v_mfma_f32_16x16x32_bf16 v[220:223], a[96:99], v[116:119], v[220:223]
v_mfma_f32_16x16x32_bf16 v[208:211], a[56:59], v[176:179], v[208:211]
s_and_b32 s59, s59, s56
s_cselect_b32 s71, 0, s77
v_mfma_f32_16x16x32_bf16 v[212:215], a[56:59], v[180:183], v[212:215]
s_or_b32 s82, s70, s71
s_cselect_b32 s10, 268435456, 0
v_mfma_f32_16x16x32_bf16 v[216:219], a[100:103], v[120:123], v[216:219]
s_cmp_lg_u32 s70, 0
s_cselect_b64 s[78:79], s[52:53], s[54:55]
s_cselect_b64 s[58:59], s[44:45], s[46:47]
v_mfma_f32_16x16x32_bf16 v[208:211], a[60:63], v[184:187], v[208:211]
s_mul_i32 s80, s78, s20
s_add_u32 s80, s80, s58
v_mfma_f32_16x16x32_bf16 v[212:215], a[60:63], v[188:191], v[212:215]
s_add_u32 m0, s49, 0
s_mul_i32 s81, s78, s21
s_add_u32 s81, s81, s59
v_mfma_f32_16x16x32_bf16 v[220:223], a[100:103], v[124:127], v[220:223]
buffer_load_dwordx4 v8, s[8:11], s80 offen offset:0 sc1 lds
s_waitcnt lgkmcnt(0)
v_mfma_f32_16x16x32_bf16 v[208:211], a[64:67], v[192:195], v[208:211]
s_andn2_b32 s71, s71, s70
s_add_u32 s52, s52, s70
s_add_u32 s54, s54, s71
v_mfma_f32_16x16x32_bf16 v[212:215], a[64:67], v[196:199], v[212:215]
s_mov_b32 s83, s82
v_mfma_f32_16x16x32_bf16 v[216:219], a[104:107], v[128:131], v[216:219]
buffer_load_dwordx4 v9, s[8:11], s80 offen offset:1024 sc1 lds
v_mfma_f32_16x16x32_bf16 v[208:211], a[68:71], v[200:203], v[208:211]
v_mfma_f32_16x16x32_bf16 v[212:215], a[68:71], v[204:207], v[212:215]
v_mfma_f32_16x16x32_bf16 v[220:223], a[104:107], v[132:135], v[220:223]
buffer_load_dwordx4 v10, s[8:11], s80 offen offset:2048 sc1 lds
v_mfma_f32_16x16x32_bf16 v[216:219], a[108:111], v[136:139], v[216:219]
v_mfma_f32_16x16x32_bf16 v[220:223], a[108:111], v[140:143], v[220:223]
v_mfma_f32_16x16x32_bf16 v[216:219], a[112:115], v[144:147], v[216:219]
buffer_load_dwordx4 v11, s[8:11], s80 offen offset:3072 sc1 lds
v_mfma_f32_16x16x32_bf16 v[220:223], a[112:115], v[148:151], v[220:223]
v_mfma_f32_16x16x32_bf16 v[216:219], a[116:119], v[152:155], v[216:219]
s_add_u32 m0, s49, 4096
v_cvt_pk_bf16_f32 v48, v208, v209
v_mfma_f32_16x16x32_bf16 v[220:223], a[116:119], v[156:159], v[220:223]
buffer_load_dwordx4 v12, s[8:11], s80 offen offset:0 sc1 lds
v_mfma_f32_16x16x32_bf16 v[216:219], a[120:123], v[160:163], v[216:219]
v_cvt_pk_bf16_f32 v49, v210, v211
v_cvt_pk_bf16_f32 v50, v212, v213
v_mfma_f32_16x16x32_bf16 v[220:223], a[120:123], v[164:167], v[220:223]
v_cvt_pk_bf16_f32 v51, v214, v215
v_mfma_f32_16x16x32_bf16 v[216:219], a[124:127], v[168:171], v[216:219]
buffer_load_dwordx4 v13, s[8:11], s80 offen offset:1024 sc1 lds
v_mfma_f32_16x16x32_bf16 v[220:223], a[124:127], v[172:175], v[220:223]
v_permlane16_swap_b32 v48, v50
v_mfma_f32_16x16x32_bf16 v[216:219], a[128:131], v[176:179], v[216:219]
v_permlane16_swap_b32 v49, v51
v_mfma_f32_16x16x32_bf16 v[220:223], a[128:131], v[180:183], v[220:223]
buffer_load_dwordx4 v14, s[8:11], s80 offen offset:2048 sc1 lds
v_mfma_f32_16x16x32_bf16 v[216:219], a[132:135], v[184:187], v[216:219]
buffer_store_dwordx4 v[48:51], v19, s[4:7], s75 offen sc1
v_mfma_f32_16x16x32_bf16 v[220:223], a[132:135], v[188:191], v[220:223]
v_mfma_f32_16x16x32_bf16 v[216:219], a[136:139], v[192:195], v[216:219]
buffer_load_dwordx4 v15, s[8:11], s80 offen offset:3072 sc1 lds
v_mfma_f32_16x16x32_bf16 v[220:223], a[136:139], v[196:199], v[220:223]
v_mfma_f32_16x16x32_bf16 v[216:219], a[140:143], v[200:203], v[216:219]
s_add_u32 m0, s49, 8192
v_mfma_f32_16x16x32_bf16 v[220:223], a[140:143], v[204:207], v[220:223]
buffer_load_dwordx4 v16, s[8:11], s80 offen offset:0 sc1 lds
v_mfma_f32_16x16x32_bf16 v[224:227], v[64:67], a[144:147], 0
v_mfma_f32_16x16x32_bf16 v[228:231], v[68:71], a[144:147], 0
v_mfma_f32_16x16x32_bf16 v[224:227], v[72:75], a[148:151], v[224:227]
v_mfma_f32_16x16x32_bf16 v[228:231], v[76:79], a[148:151], v[228:231]
v_mfma_f32_16x16x32_bf16 v[224:227], v[80:83], a[152:155], v[224:227]
buffer_load_dword v24, v22, s[4:7], 0 offen sc1
v_mfma_f32_16x16x32_bf16 v[228:231], v[84:87], a[152:155], v[228:231]
v_cvt_pk_bf16_f32 v52, v216, v217
v_cvt_pk_bf16_f32 v53, v218, v219
v_mfma_f32_16x16x32_bf16 v[224:227], v[88:91], a[156:159], v[224:227]
s_waitcnt vmcnt(11)
s_barrier
v_mfma_f32_16x16x32_bf16 v[228:231], v[92:95], a[156:159], v[228:231]
buffer_store_dword v27, v45, s[4:7], s91 offen
v_mfma_f32_16x16x32_bf16 v[224:227], v[96:99], a[160:163], v[224:227]
buffer_store_dword v27, v44, s[4:7], s91 offen sc1
v_mfma_f32_16x16x32_bf16 v[228:231], v[100:103], a[160:163], v[228:231]
v_cvt_pk_bf16_f32 v54, v220, v221
v_cvt_pk_bf16_f32 v55, v222, v223
v_mfma_f32_16x16x32_bf16 v[224:227], v[104:107], a[164:167], v[224:227]
v_permlane16_swap_b32 v52, v54
v_mfma_f32_16x16x32_bf16 v[228:231], v[108:111], a[164:167], v[228:231]
v_permlane16_swap_b32 v53, v55
v_mfma_f32_16x16x32_bf16 v[224:227], v[112:115], a[168:171], v[224:227]
buffer_store_dwordx4 v[52:55], v20, s[4:7], s75 offen sc1
v_mfma_f32_16x16x32_bf16 v[228:231], v[116:119], a[168:171], v[228:231]
v_mfma_f32_16x16x32_bf16 v[224:227], v[120:123], a[172:175], v[224:227]
v_mfma_f32_16x16x32_bf16 v[228:231], v[124:127], a[172:175], v[228:231]
v_mfma_f32_16x16x32_bf16 v[224:227], v[128:131], a[176:179], v[224:227]
v_mfma_f32_16x16x32_bf16 v[228:231], v[132:135], a[176:179], v[228:231]
v_mfma_f32_16x16x32_bf16 v[224:227], v[136:139], a[180:183], v[224:227]
v_mfma_f32_16x16x32_bf16 v[228:231], v[140:143], a[180:183], v[228:231]
v_mfma_f32_16x16x32_bf16 v[224:227], v[144:147], a[184:187], v[224:227]
v_mfma_f32_16x16x32_bf16 v[228:231], v[148:151], a[184:187], v[228:231]
v_mfma_f32_16x16x32_bf16 v[224:227], v[152:155], a[188:191], v[224:227]
v_mfma_f32_16x16x32_bf16 v[228:231], v[156:159], a[188:191], v[228:231]
v_mfma_f32_16x16x32_bf16 v[224:227], v[160:163], a[192:195], v[224:227]
s_waitcnt vmcnt(12)
s_barrier
v_mfma_f32_16x16x32_bf16 v[228:231], v[164:167], a[192:195], v[228:231]
v_mfma_f32_16x16x32_bf16 v[224:227], v[168:171], a[196:199], v[224:227]
s_cmp_eq_u32 s82, 0
s_cbranch_scc1 g_slow_60
v_mfma_f32_16x16x32_bf16 v[228:231], v[172:175], a[196:199], v[228:231]
ds_read_b128 v[64:67], v29 offset:0
v_mfma_f32_16x16x32_bf16 v[224:227], v[176:179], a[200:203], v[224:227]
ds_read_b128 v[68:71], v29 offset:9216
v_mfma_f32_16x16x32_bf16 v[228:231], v[180:183], a[200:203], v[228:231]
ds_read_b128 v[72:75], v29 offset:18432
v_mfma_f32_16x16x32_bf16 v[224:227], v[184:187], a[204:207], v[224:227]
ds_read_b128 v[76:79], v29 offset:27648
v_mfma_f32_16x16x32_bf16 v[228:231], v[188:191], a[204:207], v[228:231]
ds_read_b128 v[80:83], v29 offset:1024
v_mfma_f32_16x16x32_bf16 v[224:227], v[192:195], a[208:211], v[224:227]
ds_read_b128 v[84:87], v29 offset:10240
v_mfma_f32_16x16x32_bf16 v[228:231], v[196:199], a[208:211], v[228:231]
ds_read_b128 v[88:91], v29 offset:19456
v_mfma_f32_16x16x32_bf16 v[224:227], v[200:203], a[212:215], v[224:227]
ds_read_b128 v[92:95], v29 offset:28672
v_mfma_f32_16x16x32_bf16 v[228:231], v[204:207], a[212:215], v[228:231]
s_waitcnt vmcnt(9)
s_barrier
g_body_49:
s_waitcnt lgkmcnt(4)
v_mfma_f32_16x16x32_bf16 v[208:211], a[0:3], v[64:67], 0
ds_read_b128 v[96:99], v29 offset:2048
v_mfma_f32_16x16x32_bf16 v[212:215], a[0:3], v[68:71], 0
ds_read_b128 v[100:103], v29 offset:11264
v_mfma_f32_16x16x32_bf16 v[216:219], a[72:75], v[64:67], 0
v_mfma_f32_16x16x32_bf16 v[208:211], a[4:7], v[72:75], v[208:211]
ds_read_b128 v[104:107], v29 offset:20480
v_cvt_pk_bf16_f32 v56, v224, v225
v_mfma_f32_16x16x32_bf16 v[212:215], a[4:7], v[76:79], v[212:215]
ds_read_b128 v[108:111], v29 offset:29696
v_cvt_pk_bf16_f32 v57, v226, v227
v_mfma_f32_16x16x32_bf16 v[220:223], a[72:75], v[68:71], 0
v_cvt_pk_bf16_f32 v58, v228, v229
s_waitcnt lgkmcnt(4)
v_mfma_f32_16x16x32_bf16 v[208:211], a[8:11], v[80:83], v[208:211]
ds_read_b128 v[112:115], v29 offset:3072
v_cvt_pk_bf16_f32 v59, v230, v231
v_mfma_f32_16x16x32_bf16 v[212:215], a[8:11], v[84:87], v[212:215]
ds_read_b128 v[116:119], v29 offset:12288
v_mfma_f32_16x16x32_bf16 v[216:219], a[76:79], v[72:75], v[216:219]
buffer_store_dwordx4 v[56:59], v21, s[4:7], s75 offen sc1
v_mfma_f32_16x16x32_bf16 v[208:211], a[12:15], v[88:91], v[208:211]
ds_read_b128 v[120:123], v29 offset:21504
v_mfma_f32_16x16x32_bf16 v[212:215], a[12:15], v[92:95], v[212:215]
ds_read_b128 v[124:127], v29 offset:30720
v_mfma_f32_16x16x32_bf16 v[220:223], a[76:79], v[76:79], v[220:223]
s_waitcnt lgkmcnt(4)
v_mfma_f32_16x16x32_bf16 v[208:211], a[16:19], v[96:99], v[208:211]
ds_read_b128 v[128:131], v29 offset:4096
v_mfma_f32_16x16x32_bf16 v[212:215], a[16:19], v[100:103], v[212:215]
ds_read_b128 v[132:135], v29 offset:13312
v_mfma_f32_16x16x32_bf16 v[216:219], a[80:83], v[80:83], v[216:219]
v_mfma_f32_16x16x32_bf16 v[208:211], a[20:23], v[104:107], v[208:211]
ds_read_b128 v[136:139], v29 offset:22528
v_mfma_f32_16x16x32_bf16 v[212:215], a[20:23], v[108:111], v[212:215]
ds_read_b128 v[140:143], v29 offset:31744
v_mfma_f32_16x16x32_bf16 v[220:223], a[80:83], v[84:87], v[220:223]
s_waitcnt vmcnt(5)
s_barrier
s_waitcnt lgkmcnt(4)
v_mfma_f32_16x16x32_bf16 v[208:211], a[24:27], v[112:115], v[208:211]
ds_read_b128 v[144:147], v29 offset:5120
v_mov_b32 v27, s72
v_mfma_f32_16x16x32_bf16 v[212:215], a[24:27], v[116:119], v[212:215]
ds_read_b128 v[148:151], v29 offset:14336
v_mfma_f32_16x16x32_bf16 v[216:219], a[84:87], v[88:91], v[216:219]
v_mfma_f32_16x16x32_bf16 v[208:211], a[28:31], v[120:123], v[208:211]
ds_read_b128 v[152:155], v29 offset:23552
v_mfma_f32_16x16x32_bf16 v[212:215], a[28:31], v[124:127], v[212:215]
ds_read_b128 v[156:159], v29 offset:32768
v_mfma_f32_16x16x32_bf16 v[220:223], a[84:87], v[92:95], v[220:223]
s_waitcnt lgkmcnt(4)
v_mfma_f32_16x16x32_bf16 v[208:211], a[32:35], v[128:131], v[208:211]
ds_read_b128 v[160:163], v29 offset:6144
v_mfma_f32_16x16x32_bf16 v[212:215], a[32:35], v[132:135], v[212:215]
ds_read_b128 v[164:167], v29 offset:15360
v_mfma_f32_16x16x32_bf16 v[216:219], a[88:91], v[96:99], v[216:219]
v_mfma_f32_16x16x32_bf16 v[208:211], a[36:39], v[136:139], v[208:211]
ds_read_b128 v[168:171], v29 offset:24576
v_mfma_f32_16x16x32_bf16 v[212:215], a[36:39], v[140:143], v[212:215]
ds_read_b128 v[172:175], v29 offset:33792
v_mfma_f32_16x16x32_bf16 v[220:223], a[88:91], v[100:103], v[220:223]
s_waitcnt lgkmcnt(4)
v_mfma_f32_16x16x32_bf16 v[208:211], a[40:43], v[144:147], v[208:211]
ds_read_b128 v[176:179], v29 offset:7168
v_mfma_f32_16x16x32_bf16 v[212:215], a[40:43], v[148:151], v[212:215]
ds_read_b128 v[180:183], v29 offset:16384
s_waitcnt vmcnt(4)
ds_write_b32 v18, v24
v_mfma_f32_16x16x32_bf16 v[216:219], a[92:95], v[104:107], v[216:219]
v_mfma_f32_16x16x32_bf16 v[208:211], a[44:47], v[152:155], v[208:211]
ds_read_b128 v[184:187], v29 offset:25600
v_mfma_f32_16x16x32_bf16 v[212:215], a[44:47], v[156:159], v[212:215]
ds_read_b128 v[188:191], v29 offset:34816
s_waitcnt lgkmcnt(2)
s_barrier
v_mfma_f32_16x16x32_bf16 v[220:223], a[92:95], v[108:111], v[220:223]
ds_read_b32 v33, v32
v_mfma_f32_16x16x32_bf16 v[208:211], a[48:51], v[160:163], v[208:211]
ds_read_b128 v[192:195], v29 offset:8192
v_mfma_f32_16x16x32_bf16 v[212:215], a[48:51], v[164:167], v[212:215]
ds_read_b128 v[196:199], v29 offset:17408
v_mfma_f32_16x16x32_bf16 v[216:219], a[96:99], v[112:115], v[216:219]
s_waitcnt lgkmcnt(2)
v_cmp_gt_u32 vcc, s52, v33
v_mfma_f32_16x16x32_bf16 v[208:211], a[52:55], v[168:171], v[208:211]
ds_read_b128 v[200:203], v29 offset:26624
v_cmp_gt_u32 s[58:59], s54, v33
v_mfma_f32_16x16x32_bf16 v[212:215], a[52:55], v[172:175], v[212:215]
ds_read_b128 v[204:207], v29 offset:35840
s_and_b32 vcc_lo, vcc_lo, s56
s_cselect_b32 s70, 0, 1
v_mfma_f32_16x16x32_bf16 v[220:223], a[96:99], v[116:119], v[220:223]
v_mfma_f32_16x16x32_bf16 v[208:211], a[56:59], v[176:179], v[208:211]
s_and_b32 s59, s59, s56
s_cselect_b32 s71, 0, s83
v_mfma_f32_16x16x32_bf16 v[212:215], a[56:59], v[180:183], v[212:215]
s_or_b32 s88, s70, s71
s_cselect_b32 s10, 268435456, 0
v_mfma_f32_16x16x32_bf16 v[216:219], a[100:103], v[120:123], v[216:219]
s_cmp_lg_u32 s70, 0
s_cselect_b64 s[84:85], s[52:53], s[54:55]
s_cselect_b64 s[58:59], s[44:45], s[46:47]
v_mfma_f32_16x16x32_bf16 v[208:211], a[60:63], v[184:187], v[208:211]
s_mul_i32 s86, s84, s20
s_add_u32 s86, s86, s58
v_mfma_f32_16x16x32_bf16 v[212:215], a[60:63], v[188:191], v[212:215]
s_add_u32 m0, s50, 0
s_mul_i32 s87, s84, s21
s_add_u32 s87, s87, s59
v_mfma_f32_16x16x32_bf16 v[220:223], a[100:103], v[124:127], v[220:223]
buffer_load_dwordx4 v8, s[8:11], s86 offen offset:0 sc1 lds
s_waitcnt lgkmcnt(0)
v_mfma_f32_16x16x32_bf16 v[208:211], a[64:67], v[192:195], v[208:211]
s_andn2_b32 s71, s71, s70
s_add_u32 s52, s52, s70
s_add_u32 s54, s54, s71
v_mfma_f32_16x16x32_bf16 v[212:215], a[64:67], v[196:199], v[212:215]
s_mov_b32 s89, s88
v_mfma_f32_16x16x32_bf16 v[216:219], a[104:107], v[128:131], v[216:219]
buffer_load_dwordx4 v9, s[8:11], s86 offen offset:1024 sc1 lds
v_mfma_f32_16x16x32_bf16 v[208:211], a[68:71], v[200:203], v[208:211]
v_mfma_f32_16x16x32_bf16 v[212:215], a[68:71], v[204:207], v[212:215]
v_mfma_f32_16x16x32_bf16 v[220:223], a[104:107], v[132:135], v[220:223]
buffer_load_dwordx4 v10, s[8:11], s86 offen offset:2048 sc1 lds
v_mfma_f32_16x16x32_bf16 v[216:219], a[108:111], v[136:139], v[216:219]
v_mfma_f32_16x16x32_bf16 v[220:223], a[108:111], v[140:143], v[220:223]
v_mfma_f32_16x16x32_bf16 v[216:219], a[112:115], v[144:147], v[216:219]
buffer_load_dwordx4 v11, s[8:11], s86 offen offset:3072 sc1 lds
v_mfma_f32_16x16x32_bf16 v[220:223], a[112:115], v[148:151], v[220:223]
v_mfma_f32_16x16x32_bf16 v[216:219], a[116:119], v[152:155], v[216:219]
s_add_u32 m0, s50, 4096
v_cvt_pk_bf16_f32 v48, v208, v209
v_mfma_f32_16x16x32_bf16 v[220:223], a[116:119], v[156:159], v[220:223]
buffer_load_dwordx4 v12, s[8:11], s86 offen offset:0 sc1 lds
v_mfma_f32_16x16x32_bf16 v[216:219], a[120:123], v[160:163], v[216:219]
v_cvt_pk_bf16_f32 v49, v210, v211
v_cvt_pk_bf16_f32 v50, v212, v213
v_mfma_f32_16x16x32_bf16 v[220:223], a[120:123], v[164:167], v[220:223]
v_cvt_pk_bf16_f32 v51, v214, v215
v_mfma_f32_16x16x32_bf16 v[216:219], a[124:127], v[168:171], v[216:219]
buffer_load_dwordx4 v13, s[8:11], s86 offen offset:1024 sc1 lds
v_mfma_f32_16x16x32_bf16 v[220:223], a[124:127], v[172:175], v[220:223]
v_permlane16_swap_b32 v48, v50
v_mfma_f32_16x16x32_bf16 v[216:219], a[128:131], v[176:179], v[216:219]
v_permlane16_swap_b32 v49, v51
v_mfma_f32_16x16x32_bf16 v[220:223], a[128:131], v[180:183], v[220:223]
buffer_load_dwordx4 v14, s[8:11], s86 offen offset:2048 sc1 lds
v_mfma_f32_16x16x32_bf16 v[216:219], a[132:135], v[184:187], v[216:219]
buffer_store_dwordx4 v[48:51], v19, s[4:7], s81 offen sc1
v_mfma_f32_16x16x32_bf16 v[220:223], a[132:135], v[188:191], v[220:223]
v_mfma_f32_16x16x32_bf16 v[216:219], a[136:139], v[192:195], v[216:219]
buffer_load_dwordx4 v15, s[8:11], s86 offen offset:3072 sc1 lds
v_mfma_f32_16x16x32_bf16 v[220:223], a[136:139], v[196:199], v[220:223]
v_mfma_f32_16x16x32_bf16 v[216:219], a[140:143], v[200:203], v[216:219]
s_add_u32 m0, s50, 8192
v_mfma_f32_16x16x32_bf16 v[220:223], a[140:143], v[204:207], v[220:223]
buffer_load_dwordx4 v16, s[8:11], s86 offen offset:0 sc1 lds
v_mfma_f32_16x16x32_bf16 v[224:227], v[64:67], a[144:147], 0
v_mfma_f32_16x16x32_bf16 v[228:231], v[68:71], a[144:147], 0
v_mfma_f32_16x16x32_bf16 v[224:227], v[72:75], a[148:151], v[224:227]
v_mfma_f32_16x16x32_bf16 v[228:231], v[76:79], a[148:151], v[228:231]
v_mfma_f32_16x16x32_bf16 v[224:227], v[80:83], a[152:155], v[224:227]
buffer_load_dword v24, v22, s[4:7], 0 offen sc1
v_mfma_f32_16x16x32_bf16 v[228:231], v[84:87], a[152:155], v[228:231]
v_cvt_pk_bf16_f32 v52, v216, v217
v_cvt_pk_bf16_f32 v53, v218, v219
v_mfma_f32_16x16x32_bf16 v[224:227], v[88:91], a[156:159], v[224:227]
s_waitcnt vmcnt(11)
s_barrier
v_mfma_f32_16x16x32_bf16 v[228:231], v[92:95], a[156:159], v[228:231]
buffer_store_dword v27, v45, s[4:7], s73 offen
v_mfma_f32_16x16x32_bf16 v[224:227], v[96:99], a[160:163], v[224:227]
buffer_store_dword v27, v44, s[4:7], s73 offen sc1
v_mfma_f32_16x16x32_bf16 v[228:231], v[100:103], a[160:163], v[228:231]
v_cvt_pk_bf16_f32 v54, v220, v221
v_cvt_pk_bf16_f32 v55, v222, v223
v_mfma_f32_16x16x32_bf16 v[224:227], v[104:107], a[164:167], v[224:227]
v_permlane16_swap_b32 v52, v54
v_mfma_f32_16x16x32_bf16 v[228:231], v[108:111], a[164:167], v[228:231]
v_permlane16_swap_b32 v53, v55
v_mfma_f32_16x16x32_bf16 v[224:227], v[112:115], a[168:171], v[224:227]
buffer_store_dwordx4 v[52:55], v20, s[4:7], s81 offen sc1
v_mfma_f32_16x16x32_bf16 v[228:231], v[116:119], a[168:171], v[228:231]
v_mfma_f32_16x16x32_bf16 v[224:227], v[120:123], a[172:175], v[224:227]
v_mfma_f32_16x16x32_bf16 v[228:231], v[124:127], a[172:175], v[228:231]
v_mfma_f32_16x16x32_bf16 v[224:227], v[128:131], a[176:179], v[224:227]
v_mfma_f32_16x16x32_bf16 v[228:231], v[132:135], a[176:179], v[228:231]
v_mfma_f32_16x16x32_bf16 v[224:227], v[136:139], a[180:183], v[224:227]
v_mfma_f32_16x16x32_bf16 v[228:231], v[140:143], a[180:183], v[228:231]
v_mfma_f32_16x16x32_bf16 v[224:227], v[144:147], a[184:187], v[224:227]
v_mfma_f32_16x16x32_bf16 v[228:231], v[148:151], a[184:187], v[228:231]
v_mfma_f32_16x16x32_bf16 v[224:227], v[152:155], a[188:191], v[224:227]
v_mfma_f32_16x16x32_bf16 v[228:231], v[156:159], a[188:191], v[228:231]
v_mfma_f32_16x16x32_bf16 v[224:227], v[160:163], a[192:195], v[224:227]
s_waitcnt vmcnt(12)
s_barrier
v_mfma_f32_16x16x32_bf16 v[228:231], v[164:167], a[192:195], v[228:231]
v_mfma_f32_16x16x32_bf16 v[224:227], v[168:171], a[196:199], v[224:227]
s_cmp_eq_u32 s88, 0
s_cbranch_scc1 g_slow_61
v_mfma_f32_16x16x32_bf16 v[228:231], v[172:175], a[196:199], v[228:231]
ds_read_b128 v[64:67], v30 offset:0
v_mfma_f32_16x16x32_bf16 v[224:227], v[176:179], a[200:203], v[224:227]
ds_read_b128 v[68:71], v30 offset:9216
v_mfma_f32_16x16x32_bf16 v[228:231], v[180:183], a[200:203], v[228:231]
ds_read_b128 v[72:75], v30 offset:18432
v_mfma_f32_16x16x32_bf16 v[224:227], v[184:187], a[204:207], v[224:227]
ds_read_b128 v[76:79], v30 offset:27648
v_mfma_f32_16x16x32_bf16 v[228:231], v[188:191], a[204:207], v[228:231]
ds_read_b128 v[80:83], v30 offset:1024
v_mfma_f32_16x16x32_bf16 v[224:227], v[192:195], a[208:211], v[224:227]
ds_read_b128 v[84:87], v30 offset:10240
v_mfma_f32_16x16x32_bf16 v[228:231], v[196:199], a[208:211], v[228:231]
ds_read_b128 v[88:91], v30 offset:19456
v_mfma_f32_16x16x32_bf16 v[224:227], v[200:203], a[212:215], v[224:227]
ds_read_b128 v[92:95], v30 offset:28672
v_mfma_f32_16x16x32_bf16 v[228:231], v[204:207], a[212:215], v[228:231]
s_waitcnt vmcnt(9)
s_barrier
g_body_50:
s_waitcnt lgkmcnt(4)
v_mfma_f32_16x16x32_bf16 v[208:211], a[0:3], v[64:67], 0
ds_read_b128 v[96:99], v30 offset:2048
v_mfma_f32_16x16x32_bf16 v[212:215], a[0:3], v[68:71], 0
ds_read_b128 v[100:103], v30 offset:11264
v_mfma_f32_16x16x32_bf16 v[216:219], a[72:75], v[64:67], 0
v_mfma_f32_16x16x32_bf16 v[208:211], a[4:7], v[72:75], v[208:211]
ds_read_b128 v[104:107], v30 offset:20480
v_cvt_pk_bf16_f32 v56, v224, v225
v_mfma_f32_16x16x32_bf16 v[212:215], a[4:7], v[76:79], v[212:215]
ds_read_b128 v[108:111], v30 offset:29696
v_cvt_pk_bf16_f32 v57, v226, v227
v_mfma_f32_16x16x32_bf16 v[220:223], a[72:75], v[68:71], 0
v_cvt_pk_bf16_f32 v58, v228, v229
s_waitcnt lgkmcnt(4)
v_mfma_f32_16x16x32_bf16 v[208:211], a[8:11], v[80:83], v[208:211]
ds_read_b128 v[112:115], v30 offset:3072
v_cvt_pk_bf16_f32 v59, v230, v231
v_mfma_f32_16x16x32_bf16 v[212:215], a[8:11], v[84:87], v[212:215]
ds_read_b128 v[116:119], v30 offset:12288
v_mfma_f32_16x16x32_bf16 v[216:219], a[76:79], v[72:75], v[216:219]
buffer_store_dwordx4 v[56:59], v21, s[4:7], s81 offen sc1
v_mfma_f32_16x16x32_bf16 v[208:211], a[12:15], v[88:91], v[208:211]
ds_read_b128 v[120:123], v30 offset:21504
v_mfma_f32_16x16x32_bf16 v[212:215], a[12:15], v[92:95], v[212:215]
ds_read_b128 v[124:127], v30 offset:30720
v_mfma_f32_16x16x32_bf16 v[220:223], a[76:79], v[76:79], v[220:223]
s_waitcnt lgkmcnt(4)
v_mfma_f32_16x16x32_bf16 v[208:211], a[16:19], v[96:99], v[208:211]
ds_read_b128 v[128:131], v30 offset:4096
v_mfma_f32_16x16x32_bf16 v[212:215], a[16:19], v[100:103], v[212:215]
ds_read_b128 v[132:135], v30 offset:13312
v_mfma_f32_16x16x32_bf16 v[216:219], a[80:83], v[80:83], v[216:219]
v_mfma_f32_16x16x32_bf16 v[208:211], a[20:23], v[104:107], v[208:211]
ds_read_b128 v[136:139], v30 offset:22528
v_mfma_f32_16x16x32_bf16 v[212:215], a[20:23], v[108:111], v[212:215]
ds_read_b128 v[140:143], v30 offset:31744
v_mfma_f32_16x16x32_bf16 v[220:223], a[80:83], v[84:87], v[220:223]
s_waitcnt vmcnt(5)
s_barrier
s_waitcnt lgkmcnt(4)
v_mfma_f32_16x16x32_bf16 v[208:211], a[24:27], v[112:115], v[208:211]
ds_read_b128 v[144:147], v30 offset:5120
v_mov_b32 v27, s78
v_mfma_f32_16x16x32_bf16 v[212:215], a[24:27], v[116:119], v[212:215]
ds_read_b128 v[148:151], v30 offset:14336
v_mfma_f32_16x16x32_bf16 v[216:219], a[84:87], v[88:91], v[216:219]
v_mfma_f32_16x16x32_bf16 v[208:211], a[28:31], v[120:123], v[208:211]
ds_read_b128 v[152:155], v30 offset:23552
v_mfma_f32_16x16x32_bf16 v[212:215], a[28:31], v[124:127], v[212:215]
ds_read_b128 v[156:159], v30 offset:32768
v_mfma_f32_16x16x32_bf16 v[220:223], a[84:87], v[92:95], v[220:223]
s_waitcnt lgkmcnt(4)
v_mfma_f32_16x16x32_bf16 v[208:211], a[32:35], v[128:131], v[208:211]
ds_read_b128 v[160:163], v30 offset:6144
v_mfma_f32_16x16x32_bf16 v[212:215], a[32:35], v[132:135], v[212:215]
ds_read_b128 v[164:167], v30 offset:15360
v_mfma_f32_16x16x32_bf16 v[216:219], a[88:91], v[96:99], v[216:219]
v_mfma_f32_16x16x32_bf16 v[208:211], a[36:39], v[136:139], v[208:211]
ds_read_b128 v[168:171], v30 offset:24576
v_mfma_f32_16x16x32_bf16 v[212:215], a[36:39], v[140:143], v[212:215]
ds_read_b128 v[172:175], v30 offset:33792
v_mfma_f32_16x16x32_bf16 v[220:223], a[88:91], v[100:103], v[220:223]
s_waitcnt lgkmcnt(4)
v_mfma_f32_16x16x32_bf16 v[208:211], a[40:43], v[144:147], v[208:211]
ds_read_b128 v[176:179], v30 offset:7168
v_mfma_f32_16x16x32_bf16 v[212:215], a[40:43], v[148:151], v[212:215]
ds_read_b128 v[180:183], v30 offset:16384
s_waitcnt vmcnt(4)
ds_write_b32 v18, v24
v_mfma_f32_16x16x32_bf16 v[216:219], a[92:95], v[104:107], v[216:219]
v_mfma_f32_16x16x32_bf16 v[208:211], a[44:47], v[152:155], v[208:211]
ds_read_b128 v[184:187], v30 offset:25600
v_mfma_f32_16x16x32_bf16 v[212:215], a[44:47], v[156:159], v[212:215]
ds_read_b128 v[188:191], v30 offset:34816
s_waitcnt lgkmcnt(2)
s_barrier
v_mfma_f32_16x16x32_bf16 v[220:223], a[92:95], v[108:111], v[220:223]
ds_read_b32 v33, v32
v_mfma_f32_16x16x32_bf16 v[208:211], a[48:51], v[160:163], v[208:211]
ds_read_b128 v[192:195], v30 offset:8192
v_mfma_f32_16x16x32_bf16 v[212:215], a[48:51], v[164:167], v[212:215]
ds_read_b128 v[196:199], v30 offset:17408
v_mfma_f32_16x16x32_bf16 v[216:219], a[96:99], v[112:115], v[216:219]
s_waitcnt lgkmcnt(2)
v_cmp_gt_u32 vcc, s52, v33
v_mfma_f32_16x16x32_bf16 v[208:211], a[52:55], v[168:171], v[208:211]
ds_read_b128 v[200:203], v30 offset:26624
v_cmp_gt_u32 s[58:59], s54, v33
v_mfma_f32_16x16x32_bf16 v[212:215], a[52:55], v[172:175], v[212:215]
ds_read_b128 v[204:207], v30 offset:35840
s_and_b32 vcc_lo, vcc_lo, s56
s_cselect_b32 s70, 0, 1
v_mfma_f32_16x16x32_bf16 v[220:223], a[96:99], v[116:119], v[220:223]
v_mfma_f32_16x16x32_bf16 v[208:211], a[56:59], v[176:179], v[208:211]
s_and_b32 s59, s59, s56
s_cselect_b32 s71, 0, s89
v_mfma_f32_16x16x32_bf16 v[212:215], a[56:59], v[180:183], v[212:215]
s_or_b32 s94, s70, s71
s_cselect_b32 s10, 268435456, 0
v_mfma_f32_16x16x32_bf16 v[216:219], a[100:103], v[120:123], v[216:219]
s_cmp_lg_u32 s70, 0
s_cselect_b64 s[90:91], s[52:53], s[54:55]
s_cselect_b64 s[58:59], s[44:45], s[46:47]
v_mfma_f32_16x16x32_bf16 v[208:211], a[60:63], v[184:187], v[208:211]
s_mul_i32 s92, s90, s20
s_add_u32 s92, s92, s58
v_mfma_f32_16x16x32_bf16 v[212:215], a[60:63], v[188:191], v[212:215]
s_add_u32 m0, s51, 0
s_mul_i32 s93, s90, s21
s_add_u32 s93, s93, s59
v_mfma_f32_16x16x32_bf16 v[220:223], a[100:103], v[124:127], v[220:223]
buffer_load_dwordx4 v8, s[8:11], s92 offen offset:0 sc1 lds
s_waitcnt lgkmcnt(0)
v_mfma_f32_16x16x32_bf16 v[208:211], a[64:67], v[192:195], v[208:211]
s_andn2_b32 s71, s71, s70
s_add_u32 s52, s52, s70
s_add_u32 s54, s54, s71
v_mfma_f32_16x16x32_bf16 v[212:215], a[64:67], v[196:199], v[212:215]
s_mov_b32 s95, s94
v_mfma_f32_16x16x32_bf16 v[216:219], a[104:107], v[128:131], v[216:219]
buffer_load_dwordx4 v9, s[8:11], s92 offen offset:1024 sc1 lds
v_mfma_f32_16x16x32_bf16 v[208:211], a[68:71], v[200:203], v[208:211]
v_mfma_f32_16x16x32_bf16 v[212:215], a[68:71], v[204:207], v[212:215]
v_mfma_f32_16x16x32_bf16 v[220:223], a[104:107], v[132:135], v[220:223]
buffer_load_dwordx4 v10, s[8:11], s92 offen offset:2048 sc1 lds
v_mfma_f32_16x16x32_bf16 v[216:219], a[108:111], v[136:139], v[216:219]
v_mfma_f32_16x16x32_bf16 v[220:223], a[108:111], v[140:143], v[220:223]
v_mfma_f32_16x16x32_bf16 v[216:219], a[112:115], v[144:147], v[216:219]
buffer_load_dwordx4 v11, s[8:11], s92 offen offset:3072 sc1 lds
v_mfma_f32_16x16x32_bf16 v[220:223], a[112:115], v[148:151], v[220:223]
v_mfma_f32_16x16x32_bf16 v[216:219], a[116:119], v[152:155], v[216:219]
s_add_u32 m0, s51, 4096
v_cvt_pk_bf16_f32 v48, v208, v209
v_mfma_f32_16x16x32_bf16 v[220:223], a[116:119], v[156:159], v[220:223]
buffer_load_dwordx4 v12, s[8:11], s92 offen offset:0 sc1 lds
v_mfma_f32_16x16x32_bf16 v[216:219], a[120:123], v[160:163], v[216:219]
v_cvt_pk_bf16_f32 v49, v210, v211
v_cvt_pk_bf16_f32 v50, v212, v213
v_mfma_f32_16x16x32_bf16 v[220:223], a[120:123], v[164:167], v[220:223]
v_cvt_pk_bf16_f32 v51, v214, v215
v_mfma_f32_16x16x32_bf16 v[216:219], a[124:127], v[168:171], v[216:219]
buffer_load_dwordx4 v13, s[8:11], s92 offen offset:1024 sc1 lds
v_mfma_f32_16x16x32_bf16 v[220:223], a[124:127], v[172:175], v[220:223]
v_permlane16_swap_b32 v48, v50
v_mfma_f32_16x16x32_bf16 v[216:219], a[128:131], v[176:179], v[216:219]
v_permlane16_swap_b32 v49, v51
v_mfma_f32_16x16x32_bf16 v[220:223], a[128:131], v[180:183], v[220:223]
buffer_load_dwordx4 v14, s[8:11], s92 offen offset:2048 sc1 lds
v_mfma_f32_16x16x32_bf16 v[216:219], a[132:135], v[184:187], v[216:219]
buffer_store_dwordx4 v[48:51], v19, s[4:7], s87 offen sc1
v_mfma_f32_16x16x32_bf16 v[220:223], a[132:135], v[188:191], v[220:223]
v_mfma_f32_16x16x32_bf16 v[216:219], a[136:139], v[192:195], v[216:219]
buffer_load_dwordx4 v15, s[8:11], s92 offen offset:3072 sc1 lds
v_mfma_f32_16x16x32_bf16 v[220:223], a[136:139], v[196:199], v[220:223]
v_mfma_f32_16x16x32_bf16 v[216:219], a[140:143], v[200:203], v[216:219]
s_add_u32 m0, s51, 8192
v_mfma_f32_16x16x32_bf16 v[220:223], a[140:143], v[204:207], v[220:223]
buffer_load_dwordx4 v16, s[8:11], s92 offen offset:0 sc1 lds
v_mfma_f32_16x16x32_bf16 v[224:227], v[64:67], a[144:147], 0
v_mfma_f32_16x16x32_bf16 v[228:231], v[68:71], a[144:147], 0
v_mfma_f32_16x16x32_bf16 v[224:227], v[72:75], a[148:151], v[224:227]
v_mfma_f32_16x16x32_bf16 v[228:231], v[76:79], a[148:151], v[228:231]
v_mfma_f32_16x16x32_bf16 v[224:227], v[80:83], a[152:155], v[224:227]
buffer_load_dword v24, v22, s[4:7], 0 offen sc1
v_mfma_f32_16x16x32_bf16 v[228:231], v[84:87], a[152:155], v[228:231]
v_cvt_pk_bf16_f32 v52, v216, v217
v_cvt_pk_bf16_f32 v53, v218, v219
v_mfma_f32_16x16x32_bf16 v[224:227], v[88:91], a[156:159], v[224:227]
s_waitcnt vmcnt(11)
s_barrier
v_mfma_f32_16x16x32_bf16 v[228:231], v[92:95], a[156:159], v[228:231]
buffer_store_dword v27, v45, s[4:7], s79 offen
v_mfma_f32_16x16x32_bf16 v[224:227], v[96:99], a[160:163], v[224:227]
buffer_store_dword v27, v44, s[4:7], s79 offen sc1
v_mfma_f32_16x16x32_bf16 v[228:231], v[100:103], a[160:163], v[228:231]
v_cvt_pk_bf16_f32 v54, v220, v221
v_cvt_pk_bf16_f32 v55, v222, v223
v_mfma_f32_16x16x32_bf16 v[224:227], v[104:107], a[164:167], v[224:227]
v_permlane16_swap_b32 v52, v54
v_mfma_f32_16x16x32_bf16 v[228:231], v[108:111], a[164:167], v[228:231]
v_permlane16_swap_b32 v53, v55
v_mfma_f32_16x16x32_bf16 v[224:227], v[112:115], a[168:171], v[224:227]
buffer_store_dwordx4 v[52:55], v20, s[4:7], s87 offen sc1
v_mfma_f32_16x16x32_bf16 v[228:231], v[116:119], a[168:171], v[228:231]
v_mfma_f32_16x16x32_bf16 v[224:227], v[120:123], a[172:175], v[224:227]
v_mfma_f32_16x16x32_bf16 v[228:231], v[124:127], a[172:175], v[228:231]
v_mfma_f32_16x16x32_bf16 v[224:227], v[128:131], a[176:179], v[224:227]
v_mfma_f32_16x16x32_bf16 v[228:231], v[132:135], a[176:179], v[228:231]
v_mfma_f32_16x16x32_bf16 v[224:227], v[136:139], a[180:183], v[224:227]
v_mfma_f32_16x16x32_bf16 v[228:231], v[140:143], a[180:183], v[228:231]
v_mfma_f32_16x16x32_bf16 v[224:227], v[144:147], a[184:187], v[224:227]
v_mfma_f32_16x16x32_bf16 v[228:231], v[148:151], a[184:187], v[228:231]
v_mfma_f32_16x16x32_bf16 v[224:227], v[152:155], a[188:191], v[224:227]
v_mfma_f32_16x16x32_bf16 v[228:231], v[156:159], a[188:191], v[228:231]
v_mfma_f32_16x16x32_bf16 v[224:227], v[160:163], a[192:195], v[224:227]
s_waitcnt vmcnt(12)
s_barrier
v_mfma_f32_16x16x32_bf16 v[228:231], v[164:167], a[192:195], v[228:231]
v_mfma_f32_16x16x32_bf16 v[224:227], v[168:171], a[196:199], v[224:227]
s_cmp_eq_u32 s94, 0
s_cbranch_scc1 g_slow_62
v_mfma_f32_16x16x32_bf16 v[228:231], v[172:175], a[196:199], v[228:231]
ds_read_b128 v[64:67], v31 offset:0
v_mfma_f32_16x16x32_bf16 v[224:227], v[176:179], a[200:203], v[224:227]
ds_read_b128 v[68:71], v31 offset:9216
v_mfma_f32_16x16x32_bf16 v[228:231], v[180:183], a[200:203], v[228:231]
ds_read_b128 v[72:75], v31 offset:18432
v_mfma_f32_16x16x32_bf16 v[224:227], v[184:187], a[204:207], v[224:227]
ds_read_b128 v[76:79], v31 offset:27648
v_mfma_f32_16x16x32_bf16 v[228:231], v[188:191], a[204:207], v[228:231]
ds_read_b128 v[80:83], v31 offset:1024
v_mfma_f32_16x16x32_bf16 v[224:227], v[192:195], a[208:211], v[224:227]
ds_read_b128 v[84:87], v31 offset:10240
v_mfma_f32_16x16x32_bf16 v[228:231], v[196:199], a[208:211], v[228:231]
ds_read_b128 v[88:91], v31 offset:19456
v_mfma_f32_16x16x32_bf16 v[224:227], v[200:203], a[212:215], v[224:227]
ds_read_b128 v[92:95], v31 offset:28672
v_mfma_f32_16x16x32_bf16 v[228:231], v[204:207], a[212:215], v[228:231]
s_waitcnt vmcnt(9)
s_barrier
g_body_51:
s_waitcnt lgkmcnt(4)
v_mfma_f32_16x16x32_bf16 v[208:211], a[0:3], v[64:67], 0
ds_read_b128 v[96:99], v31 offset:2048
v_mfma_f32_16x16x32_bf16 v[212:215], a[0:3], v[68:71], 0
ds_read_b128 v[100:103], v31 offset:11264
v_mfma_f32_16x16x32_bf16 v[216:219], a[72:75], v[64:67], 0
v_mfma_f32_16x16x32_bf16 v[208:211], a[4:7], v[72:75], v[208:211]
ds_read_b128 v[104:107], v31 offset:20480
v_cvt_pk_bf16_f32 v56, v224, v225
v_mfma_f32_16x16x32_bf16 v[212:215], a[4:7], v[76:79], v[212:215]
ds_read_b128 v[108:111], v31 offset:29696
v_cvt_pk_bf16_f32 v57, v226, v227
v_mfma_f32_16x16x32_bf16 v[220:223], a[72:75], v[68:71], 0
v_cvt_pk_bf16_f32 v58, v228, v229
s_waitcnt lgkmcnt(4)
v_mfma_f32_16x16x32_bf16 v[208:211], a[8:11], v[80:83], v[208:211]
ds_read_b128 v[112:115], v31 offset:3072
v_cvt_pk_bf16_f32 v59, v230, v231
v_mfma_f32_16x16x32_bf16 v[212:215], a[8:11], v[84:87], v[212:215]
ds_read_b128 v[116:119], v31 offset:12288
v_mfma_f32_16x16x32_bf16 v[216:219], a[76:79], v[72:75], v[216:219]
buffer_store_dwordx4 v[56:59], v21, s[4:7], s87 offen sc1
v_mfma_f32_16x16x32_bf16 v[208:211], a[12:15], v[88:91], v[208:211]
ds_read_b128 v[120:123], v31 offset:21504
v_mfma_f32_16x16x32_bf16 v[212:215], a[12:15], v[92:95], v[212:215]
ds_read_b128 v[124:127], v31 offset:30720
v_mfma_f32_16x16x32_bf16 v[220:223], a[76:79], v[76:79], v[220:223]
s_waitcnt lgkmcnt(4)
v_mfma_f32_16x16x32_bf16 v[208:211], a[16:19], v[96:99], v[208:211]
ds_read_b128 v[128:131], v31 offset:4096
v_mfma_f32_16x16x32_bf16 v[212:215], a[16:19], v[100:103], v[212:215]
ds_read_b128 v[132:135], v31 offset:13312
v_mfma_f32_16x16x32_bf16 v[216:219], a[80:83], v[80:83], v[216:219]
v_mfma_f32_16x16x32_bf16 v[208:211], a[20:23], v[104:107], v[208:211]
ds_read_b128 v[136:139], v31 offset:22528
v_mfma_f32_16x16x32_bf16 v[212:215], a[20:23], v[108:111], v[212:215]
ds_read_b128 v[140:143], v31 offset:31744
v_mfma_f32_16x16x32_bf16 v[220:223], a[80:83], v[84:87], v[220:223]
s_waitcnt vmcnt(5)
s_barrier
s_waitcnt lgkmcnt(4)
v_mfma_f32_16x16x32_bf16 v[208:211], a[24:27], v[112:115], v[208:211]
ds_read_b128 v[144:147], v31 offset:5120
v_mov_b32 v27, s84
v_mfma_f32_16x16x32_bf16 v[212:215], a[24:27], v[116:119], v[212:215]
ds_read_b128 v[148:151], v31 offset:14336
v_mfma_f32_16x16x32_bf16 v[216:219], a[84:87], v[88:91], v[216:219]
v_mfma_f32_16x16x32_bf16 v[208:211], a[28:31], v[120:123], v[208:211]
ds_read_b128 v[152:155], v31 offset:23552
v_mfma_f32_16x16x32_bf16 v[212:215], a[28:31], v[124:127], v[212:215]
ds_read_b128 v[156:159], v31 offset:32768
v_mfma_f32_16x16x32_bf16 v[220:223], a[84:87], v[92:95], v[220:223]
s_waitcnt lgkmcnt(4)
v_mfma_f32_16x16x32_bf16 v[208:211], a[32:35], v[128:131], v[208:211]
ds_read_b128 v[160:163], v31 offset:6144
v_mfma_f32_16x16x32_bf16 v[212:215], a[32:35], v[132:135], v[212:215]
ds_read_b128 v[164:167], v31 offset:15360
v_mfma_f32_16x16x32_bf16 v[216:219], a[88:91], v[96:99], v[216:219]
v_mfma_f32_16x16x32_bf16 v[208:211], a[36:39], v[136:139], v[208:211]
ds_read_b128 v[168:171], v31 offset:24576
v_mfma_f32_16x16x32_bf16 v[212:215], a[36:39], v[140:143], v[212:215]
ds_read_b128 v[172:175], v31 offset:33792
v_mfma_f32_16x16x32_bf16 v[220:223], a[88:91], v[100:103], v[220:223]
s_waitcnt lgkmcnt(4)
v_mfma_f32_16x16x32_bf16 v[208:211], a[40:43], v[144:147], v[208:211]
ds_read_b128 v[176:179], v31 offset:7168
v_mfma_f32_16x16x32_bf16 v[212:215], a[40:43], v[148:151], v[212:215]
ds_read_b128 v[180:183], v31 offset:16384
s_waitcnt vmcnt(4)
ds_write_b32 v18, v24
v_mfma_f32_16x16x32_bf16 v[216:219], a[92:95], v[104:107], v[216:219]
v_mfma_f32_16x16x32_bf16 v[208:211], a[44:47], v[152:155], v[208:211]
ds_read_b128 v[184:187], v31 offset:25600
v_mfma_f32_16x16x32_bf16 v[212:215], a[44:47], v[156:159], v[212:215]
ds_read_b128 v[188:191], v31 offset:34816
s_waitcnt lgkmcnt(2)
s_barrier
v_mfma_f32_16x16x32_bf16 v[220:223], a[92:95], v[108:111], v[220:223]
ds_read_b32 v33, v32
v_mfma_f32_16x16x32_bf16 v[208:211], a[48:51], v[160:163], v[208:211]
ds_read_b128 v[192:195], v31 offset:8192
v_mfma_f32_16x16x32_bf16 v[212:215], a[48:51], v[164:167], v[212:215]
ds_read_b128 v[196:199], v31 offset:17408
v_mfma_f32_16x16x32_bf16 v[216:219], a[96:99], v[112:115], v[216:219]
s_waitcnt lgkmcnt(2)
v_cmp_gt_u32 vcc, s52, v33
v_mfma_f32_16x16x32_bf16 v[208:211], a[52:55], v[168:171], v[208:211]
ds_read_b128 v[200:203], v31 offset:26624
v_cmp_gt_u32 s[58:59], s54, v33
v_mfma_f32_16x16x32_bf16 v[212:215], a[52:55], v[172:175], v[212:215]
ds_read_b128 v[204:207], v31 offset:35840
s_and_b32 vcc_lo, vcc_lo, s56
s_cselect_b32 s70, 0, 1
v_mfma_f32_16x16x32_bf16 v[220:223], a[96:99], v[116:119], v[220:223]
v_mfma_f32_16x16x32_bf16 v[208:211], a[56:59], v[176:179], v[208:211]
s_and_b32 s59, s59, s56
s_cselect_b32 s71, 0, s95
v_mfma_f32_16x16x32_bf16 v[212:215], a[56:59], v[180:183], v[212:215]
s_or_b32 s76, s70, s71
s_cselect_b32 s10, 268435456, 0
v_mfma_f32_16x16x32_bf16 v[216:219], a[100:103], v[120:123], v[216:219]
s_cmp_lg_u32 s70, 0
s_cselect_b64 s[72:73], s[52:53], s[54:55]
s_cselect_b64 s[58:59], s[44:45], s[46:47]
v_mfma_f32_16x16x32_bf16 v[208:211], a[60:63], v[184:187], v[208:211]
s_mul_i32 s74, s72, s20
s_add_u32 s74, s74, s58
v_mfma_f32_16x16x32_bf16 v[212:215], a[60:63], v[188:191], v[212:215]
s_add_u32 m0, s48, 0
s_mul_i32 s75, s72, s21
s_add_u32 s75, s75, s59
v_mfma_f32_16x16x32_bf16 v[220:223], a[100:103], v[124:127], v[220:223]
buffer_load_dwordx4 v8, s[8:11], s74 offen offset:0 sc1 lds
s_waitcnt lgkmcnt(0)
v_mfma_f32_16x16x32_bf16 v[208:211], a[64:67], v[192:195], v[208:211]
s_andn2_b32 s71, s71, s70
s_add_u32 s52, s52, s70
s_add_u32 s54, s54, s71
v_mfma_f32_16x16x32_bf16 v[212:215], a[64:67], v[196:199], v[212:215]
s_mov_b32 s77, s76
v_mfma_f32_16x16x32_bf16 v[216:219], a[104:107], v[128:131], v[216:219]
buffer_load_dwordx4 v9, s[8:11], s74 offen offset:1024 sc1 lds
v_mfma_f32_16x16x32_bf16 v[208:211], a[68:71], v[200:203], v[208:211]
v_mfma_f32_16x16x32_bf16 v[212:215], a[68:71], v[204:207], v[212:215]
v_mfma_f32_16x16x32_bf16 v[220:223], a[104:107], v[132:135], v[220:223]
buffer_load_dwordx4 v10, s[8:11], s74 offen offset:2048 sc1 lds
v_mfma_f32_16x16x32_bf16 v[216:219], a[108:111], v[136:139], v[216:219]
v_mfma_f32_16x16x32_bf16 v[220:223], a[108:111], v[140:143], v[220:223]
v_mfma_f32_16x16x32_bf16 v[216:219], a[112:115], v[144:147], v[216:219]
buffer_load_dwordx4 v11, s[8:11], s74 offen offset:3072 sc1 lds
v_mfma_f32_16x16x32_bf16 v[220:223], a[112:115], v[148:151], v[220:223]
v_mfma_f32_16x16x32_bf16 v[216:219], a[116:119], v[152:155], v[216:219]
s_add_u32 m0, s48, 4096
v_cvt_pk_bf16_f32 v48, v208, v209
v_mfma_f32_16x16x32_bf16 v[220:223], a[116:119], v[156:159], v[220:223]
buffer_load_dwordx4 v12, s[8:11], s74 offen offset:0 sc1 lds
v_mfma_f32_16x16x32_bf16 v[216:219], a[120:123], v[160:163], v[216:219]
v_cvt_pk_bf16_f32 v49, v210, v211
v_cvt_pk_bf16_f32 v50, v212, v213
v_mfma_f32_16x16x32_bf16 v[220:223], a[120:123], v[164:167], v[220:223]
v_cvt_pk_bf16_f32 v51, v214, v215
v_mfma_f32_16x16x32_bf16 v[216:219], a[124:127], v[168:171], v[216:219]
buffer_load_dwordx4 v13, s[8:11], s74 offen offset:1024 sc1 lds
v_mfma_f32_16x16x32_bf16 v[220:223], a[124:127], v[172:175], v[220:223]
v_permlane16_swap_b32 v48, v50
v_mfma_f32_16x16x32_bf16 v[216:219], a[128:131], v[176:179], v[216:219]
v_permlane16_swap_b32 v49, v51
v_mfma_f32_16x16x32_bf16 v[220:223], a[128:131], v[180:183], v[220:223]
buffer_load_dwordx4 v14, s[8:11], s74 offen offset:2048 sc1 lds
v_mfma_f32_16x16x32_bf16 v[216:219], a[132:135], v[184:187], v[216:219]
buffer_store_dwordx4 v[48:51], v19, s[4:7], s93 offen sc1
v_mfma_f32_16x16x32_bf16 v[220:223], a[132:135], v[188:191], v[220:223]
v_mfma_f32_16x16x32_bf16 v[216:219], a[136:139], v[192:195], v[216:219]
buffer_load_dwordx4 v15, s[8:11], s74 offen offset:3072 sc1 lds
v_mfma_f32_16x16x32_bf16 v[220:223], a[136:139], v[196:199], v[220:223]
v_mfma_f32_16x16x32_bf16 v[216:219], a[140:143], v[200:203], v[216:219]
s_add_u32 m0, s48, 8192
v_mfma_f32_16x16x32_bf16 v[220:223], a[140:143], v[204:207], v[220:223]
buffer_load_dwordx4 v16, s[8:11], s74 offen offset:0 sc1 lds
v_mfma_f32_16x16x32_bf16 v[224:227], v[64:67], a[144:147], 0
v_mfma_f32_16x16x32_bf16 v[228:231], v[68:71], a[144:147], 0
v_mfma_f32_16x16x32_bf16 v[224:227], v[72:75], a[148:151], v[224:227]
v_mfma_f32_16x16x32_bf16 v[228:231], v[76:79], a[148:151], v[228:231]
v_mfma_f32_16x16x32_bf16 v[224:227], v[80:83], a[152:155], v[224:227]
buffer_load_dword v24, v22, s[4:7], 0 offen sc1
v_mfma_f32_16x16x32_bf16 v[228:231], v[84:87], a[152:155], v[228:231]
v_cvt_pk_bf16_f32 v52, v216, v217
v_cvt_pk_bf16_f32 v53, v218, v219
v_mfma_f32_16x16x32_bf16 v[224:227], v[88:91], a[156:159], v[224:227]
s_waitcnt vmcnt(11)
s_barrier
v_mfma_f32_16x16x32_bf16 v[228:231], v[92:95], a[156:159], v[228:231]
buffer_store_dword v27, v45, s[4:7], s85 offen
v_mfma_f32_16x16x32_bf16 v[224:227], v[96:99], a[160:163], v[224:227]
buffer_store_dword v27, v44, s[4:7], s85 offen sc1
v_mfma_f32_16x16x32_bf16 v[228:231], v[100:103], a[160:163], v[228:231]
v_cvt_pk_bf16_f32 v54, v220, v221
v_cvt_pk_bf16_f32 v55, v222, v223
v_mfma_f32_16x16x32_bf16 v[224:227], v[104:107], a[164:167], v[224:227]
v_permlane16_swap_b32 v52, v54
v_mfma_f32_16x16x32_bf16 v[228:231], v[108:111], a[164:167], v[228:231]
v_permlane16_swap_b32 v53, v55
v_mfma_f32_16x16x32_bf16 v[224:227], v[112:115], a[168:171], v[224:227]
buffer_store_dwordx4 v[52:55], v20, s[4:7], s93 offen sc1
v_mfma_f32_16x16x32_bf16 v[228:231], v[116:119], a[168:171], v[228:231]
v_mfma_f32_16x16x32_bf16 v[224:227], v[120:123], a[172:175], v[224:227]
v_mfma_f32_16x16x32_bf16 v[228:231], v[124:127], a[172:175], v[228:231]
v_mfma_f32_16x16x32_bf16 v[224:227], v[128:131], a[176:179], v[224:227]
v_mfma_f32_16x16x32_bf16 v[228:231], v[132:135], a[176:179], v[228:231]
v_mfma_f32_16x16x32_bf16 v[224:227], v[136:139], a[180:183], v[224:227]
v_mfma_f32_16x16x32_bf16 v[228:231], v[140:143], a[180:183], v[228:231]
v_mfma_f32_16x16x32_bf16 v[224:227], v[144:147], a[184:187], v[224:227]
v_mfma_f32_16x16x32_bf16 v[228:231], v[148:151], a[184:187], v[228:231]
v_mfma_f32_16x16x32_bf16 v[224:227], v[152:155], a[188:191], v[224:227]
v_mfma_f32_16x16x32_bf16 v[228:231], v[156:159], a[188:191], v[228:231]
v_mfma_f32_16x16x32_bf16 v[224:227], v[160:163], a[192:195], v[224:227]
s_waitcnt vmcnt(12)
s_barrier
v_mfma_f32_16x16x32_bf16 v[228:231], v[164:167], a[192:195], v[228:231]
v_mfma_f32_16x16x32_bf16 v[224:227], v[168:171], a[196:199], v[224:227]
s_cmp_eq_u32 s76, 0
s_cbranch_scc1 g_slow_63
v_mfma_f32_16x16x32_bf16 v[228:231], v[172:175], a[196:199], v[228:231]
ds_read_b128 v[64:67], v28 offset:0
v_mfma_f32_16x16x32_bf16 v[224:227], v[176:179], a[200:203], v[224:227]
ds_read_b128 v[68:71], v28 offset:9216
v_mfma_f32_16x16x32_bf16 v[228:231], v[180:183], a[200:203], v[228:231]
ds_read_b128 v[72:75], v28 offset:18432
v_mfma_f32_16x16x32_bf16 v[224:227], v[184:187], a[204:207], v[224:227]
ds_read_b128 v[76:79], v28 offset:27648
v_mfma_f32_16x16x32_bf16 v[228:231], v[188:191], a[204:207], v[228:231]
ds_read_b128 v[80:83], v28 offset:1024
v_mfma_f32_16x16x32_bf16 v[224:227], v[192:195], a[208:211], v[224:227]
ds_read_b128 v[84:87], v28 offset:10240
v_mfma_f32_16x16x32_bf16 v[228:231], v[196:199], a[208:211], v[228:231]
ds_read_b128 v[88:91], v28 offset:19456
v_mfma_f32_16x16x32_bf16 v[224:227], v[200:203], a[212:215], v[224:227]
ds_read_b128 v[92:95], v28 offset:28672
v_mfma_f32_16x16x32_bf16 v[228:231], v[204:207], a[212:215], v[228:231]
s_waitcnt vmcnt(9)
s_barrier
s_branch g_body_48
g_slow_60:
v_mfma_f32_16x16x32_bf16 v[228:231], v[172:175], a[196:199], v[228:231]
v_mfma_f32_16x16x32_bf16 v[224:227], v[176:179], a[200:203], v[224:227]
v_mfma_f32_16x16x32_bf16 v[228:231], v[180:183], a[200:203], v[228:231]
v_mfma_f32_16x16x32_bf16 v[224:227], v[184:187], a[204:207], v[224:227]
v_mfma_f32_16x16x32_bf16 v[228:231], v[188:191], a[204:207], v[228:231]
v_mfma_f32_16x16x32_bf16 v[224:227], v[192:195], a[208:211], v[224:227]
v_mfma_f32_16x16x32_bf16 v[228:231], v[196:199], a[208:211], v[228:231]
v_mfma_f32_16x16x32_bf16 v[224:227], v[200:203], a[212:215], v[224:227]
v_mfma_f32_16x16x32_bf16 v[228:231], v[204:207], a[212:215], v[228:231]
s_nop 6
v_cvt_pk_bf16_f32 v56, v224, v225
v_cvt_pk_bf16_f32 v57, v226, v227
v_cvt_pk_bf16_f32 v58, v228, v229
v_cvt_pk_bf16_f32 v59, v230, v231
buffer_store_dwordx4 v[56:59], v21, s[4:7], s75 offen sc1
s_mov_b32 s75, 1879048192
s_waitcnt vmcnt(4)
ds_write_b32 v18, v24
s_waitcnt lgkmcnt(0)
s_barrier
ds_read_b32 v33, v32
s_waitcnt lgkmcnt(0)
v_cmp_gt_u32 vcc, s52, v33
v_cmp_gt_u32 s[58:59], s54, v33
s_and_b32 vcc_lo, vcc_lo, s56
s_cselect_b32 s70, 0, 1
s_and_b32 s59, s59, s56
s_cselect_b32 s71, 0, s77
s_or_b32 s82, s70, s71
s_cselect_b32 s10, 268435456, 0
s_cmp_lg_u32 s70, 0
s_cselect_b64 s[78:79], s[52:53], s[54:55]
s_cselect_b64 s[58:59], s[44:45], s[46:47]
s_mul_i32 s80, s78, s20
s_add_u32 s80, s80, s58
s_mul_i32 s81, s78, s21
s_add_u32 s81, s81, s59
s_andn2_b32 s71, s71, s70
s_add_u32 s52, s52, s70
s_add_u32 s54, s54, s71
s_mov_b32 s83, s82
s_cmp_lg_u32 s82, 0
s_cbranch_scc1 g_go_64
v_mov_b32 v27, s72
s_waitcnt vmcnt(0)
s_barrier
s_add_u32 s70, s52, s54
s_cmp_eq_u32 s70, 130
s_cbranch_scc1 g_fin_52
s_cmp_lg_u32 s3, 0
s_cbranch_scc1 sp_ok_66_j
s_mov_b32 s23, 0
buffer_load_dword v33, v22, s[4:7], 0 offen sc1
buffer_store_dword v27, v45, s[4:7], s73 offen
buffer_store_dword v27, v44, s[4:7], s73 offen sc1
s_waitcnt vmcnt(2)
s_branch sp_loop_65_e
sp_loop_65:
buffer_load_dword v33, v22, s[4:7], 0 offen sc1
s_add_u32 s23, s23, 1
s_cmp_gt_u32 s23, 150000
s_cbranch_scc1 sp_bad_67
s_waitcnt vmcnt(0)
sp_loop_65_e:
v_cmp_gt_u32 vcc, s52, v33
v_cmp_gt_u32 s[58:59], s54, v33
s_and_b32 vcc_lo, vcc_lo, s56
s_cbranch_scc0 sp_ok_66
s_cmp_gt_u32 s23, 4
s_cselect_b32 s70, 0, s56
s_cmp_lg_u32 s77, 0
s_cselect_b32 s70, 0, s70
s_or_b32 s59, s59, s70
s_and_b32 s59, s59, s56
s_cbranch_scc0 sp_ok_66
s_sleep 1
s_branch sp_loop_65
sp_bad_67:
s_mov_b32 s98, 1026
s_branch L_fail
sp_ok_66:
ds_write_b32 v18, v33
s_waitcnt lgkmcnt(0)
sp_ok_66_j:
s_barrier
ds_read_b32 v33, v32
s_waitcnt lgkmcnt(0)
s_mov_b32 s73, 1879048192
v_cmp_gt_u32 vcc, s52, v33
v_cmp_gt_u32 s[58:59], s54, v33
s_and_b32 vcc_lo, vcc_lo, s56
s_cselect_b32 s70, 0, 1
s_and_b32 s59, s59, s56
s_cselect_b32 s71, 0, 1
s_or_b32 s82, s70, s71
s_cselect_b32 s10, 268435456, 0
s_cmp_lg_u32 s70, 0
s_cselect_b64 s[78:79], s[52:53], s[54:55]
s_cselect_b64 s[58:59], s[44:45], s[46:47]
s_mul_i32 s80, s78, s20
s_add_u32 s80, s80, s58
s_mul_i32 s81, s78, s21
s_add_u32 s81, s81, s59
s_andn2_b32 s71, s71, s70
s_add_u32 s52, s52, s70
s_add_u32 s54, s54, s71
s_mov_b32 s83, s82
g_go_64:
s_add_u32 m0, s49, 0
s_nop 0
buffer_load_dwordx4 v8, s[4:7], s80 offen offset:0 sc1 lds
buffer_load_dwordx4 v9, s[4:7], s80 offen offset:1024 sc1 lds
buffer_load_dwordx4 v10, s[4:7], s80 offen offset:2048 sc1 lds
buffer_load_dwordx4 v11, s[4:7], s80 offen offset:3072 sc1 lds
s_add_u32 m0, s49, 4096
s_nop 0
buffer_load_dwordx4 v12, s[4:7], s80 offen offset:0 sc1 lds
buffer_load_dwordx4 v13, s[4:7], s80 offen offset:1024 sc1 lds
buffer_load_dwordx4 v14, s[4:7], s80 offen offset:2048 sc1 lds
buffer_load_dwordx4 v15, s[4:7], s80 offen offset:3072 sc1 lds
s_add_u32 m0, s49, 8192
s_nop 0
buffer_load_dwordx4 v16, s[4:7], s80 offen offset:0 sc1 lds
buffer_load_dword v24, v22, s[4:7], 0 offen sc1
buffer_store_dword v27, v34, s[4:7], 0 offen
v_mov_b32 v27, s72
s_waitcnt vmcnt(9)
s_barrier
buffer_store_dword v27, v45, s[4:7], s73 offen
buffer_store_dword v27, v44, s[4:7], s73 offen sc1
s_mov_b32 s73, 1879048192
ds_read_b128 v[64:67], v29 offset:0
ds_read_b128 v[68:71], v29 offset:9216
ds_read_b128 v[72:75], v29 offset:18432
ds_read_b128 v[76:79], v29 offset:27648
ds_read_b128 v[80:83], v29 offset:1024
ds_read_b128 v[84:87], v29 offset:10240
ds_read_b128 v[88:91], v29 offset:19456
ds_read_b128 v[92:95], v29 offset:28672
s_waitcnt vmcnt(8)
s_barrier
s_branch g_body_49
g_slow_61:
v_mfma_f32_16x16x32_bf16 v[228:231], v[172:175], a[196:199], v[228:231]
v_mfma_f32_16x16x32_bf16 v[224:227], v[176:179], a[200:203], v[224:227]
v_mfma_f32_16x16x32_bf16 v[228:231], v[180:183], a[200:203], v[228:231]
v_mfma_f32_16x16x32_bf16 v[224:227], v[184:187], a[204:207], v[224:227]
v_mfma_f32_16x16x32_bf16 v[228:231], v[188:191], a[204:207], v[228:231]
v_mfma_f32_16x16x32_bf16 v[224:227], v[192:195], a[208:211], v[224:227]
v_mfma_f32_16x16x32_bf16 v[228:231], v[196:199], a[208:211], v[228:231]
v_mfma_f32_16x16x32_bf16 v[224:227], v[200:203], a[212:215], v[224:227]
v_mfma_f32_16x16x32_bf16 v[228:231], v[204:207], a[212:215], v[228:231]
s_nop 6
v_cvt_pk_bf16_f32 v56, v224, v225
v_cvt_pk_bf16_f32 v57, v226, v227
v_cvt_pk_bf16_f32 v58, v228, v229
v_cvt_pk_bf16_f32 v59, v230, v231
buffer_store_dwordx4 v[56:59], v21, s[4:7], s81 offen sc1
s_mov_b32 s81, 1879048192
s_waitcnt vmcnt(4)
ds_write_b32 v18, v24
s_waitcnt lgkmcnt(0)
s_barrier
ds_read_b32 v33, v32
s_waitcnt lgkmcnt(0)
v_cmp_gt_u32 vcc, s52, v33
v_cmp_gt_u32 s[58:59], s54, v33
s_and_b32 vcc_lo, vcc_lo, s56
s_cselect_b32 s70, 0, 1
s_and_b32 s59, s59, s56
s_cselect_b32 s71, 0, s83
s_or_b32 s88, s70, s71
s_cselect_b32 s10, 268435456, 0
s_cmp_lg_u32 s70, 0
s_cselect_b64 s[84:85], s[52:53], s[54:55]
s_cselect_b64 s[58:59], s[44:45], s[46:47]
s_mul_i32 s86, s84, s20
s_add_u32 s86, s86, s58
s_mul_i32 s87, s84, s21
s_add_u32 s87, s87, s59
s_andn2_b32 s71, s71, s70
s_add_u32 s52, s52, s70
s_add_u32 s54, s54, s71
s_mov_b32 s89, s88
s_cmp_lg_u32 s88, 0
s_cbranch_scc1 g_go_68
v_mov_b32 v27, s78
s_waitcnt vmcnt(0)
s_barrier
s_add_u32 s70, s52, s54
s_cmp_eq_u32 s70, 130
s_cbranch_scc1 g_fin_52
s_cmp_lg_u32 s3, 0
s_cbranch_scc1 sp_ok_70_j
s_mov_b32 s23, 0
buffer_load_dword v33, v22, s[4:7], 0 offen sc1
buffer_store_dword v27, v45, s[4:7], s79 offen
buffer_store_dword v27, v44, s[4:7], s79 offen sc1
s_waitcnt vmcnt(2)
s_branch sp_loop_69_e
sp_loop_69:
buffer_load_dword v33, v22, s[4:7], 0 offen sc1
s_add_u32 s23, s23, 1
s_cmp_gt_u32 s23, 150000
s_cbranch_scc1 sp_bad_71
s_waitcnt vmcnt(0)
sp_loop_69_e:
v_cmp_gt_u32 vcc, s52, v33
v_cmp_gt_u32 s[58:59], s54, v33
s_and_b32 vcc_lo, vcc_lo, s56
s_cbranch_scc0 sp_ok_70
s_cmp_gt_u32 s23, 4
s_cselect_b32 s70, 0, s56
s_cmp_lg_u32 s83, 0
s_cselect_b32 s70, 0, s70
s_or_b32 s59, s59, s70
s_and_b32 s59, s59, s56
s_cbranch_scc0 sp_ok_70
s_sleep 1
s_branch sp_loop_69
sp_bad_71:
s_mov_b32 s98, 1026
s_branch L_fail
sp_ok_70:
ds_write_b32 v18, v33
s_waitcnt lgkmcnt(0)
sp_ok_70_j:
s_barrier
ds_read_b32 v33, v32
s_waitcnt lgkmcnt(0)
s_mov_b32 s79, 1879048192
v_cmp_gt_u32 vcc, s52, v33
v_cmp_gt_u32 s[58:59], s54, v33
s_and_b32 vcc_lo, vcc_lo, s56
s_cselect_b32 s70, 0, 1
s_and_b32 s59, s59, s56
s_cselect_b32 s71, 0, 1
s_or_b32 s88, s70, s71
s_cselect_b32 s10, 268435456, 0
s_cmp_lg_u32 s70, 0
s_cselect_b64 s[84:85], s[52:53], s[54:55]
s_cselect_b64 s[58:59], s[44:45], s[46:47]
s_mul_i32 s86, s84, s20
s_add_u32 s86, s86, s58
s_mul_i32 s87, s84, s21
s_add_u32 s87, s87, s59
s_andn2_b32 s71, s71, s70
s_add_u32 s52, s52, s70
s_add_u32 s54, s54, s71
s_mov_b32 s89, s88
g_go_68:
s_add_u32 m0, s50, 0
s_nop 0
buffer_load_dwordx4 v8, s[4:7], s86 offen offset:0 sc1 lds
buffer_load_dwordx4 v9, s[4:7], s86 offen offset:1024 sc1 lds
buffer_load_dwordx4 v10, s[4:7], s86 offen offset:2048 sc1 lds
buffer_load_dwordx4 v11, s[4:7], s86 offen offset:3072 sc1 lds
s_add_u32 m0, s50, 4096
s_nop 0
buffer_load_dwordx4 v12, s[4:7], s86 offen offset:0 sc1 lds
buffer_load_dwordx4 v13, s[4:7], s86 offen offset:1024 sc1 lds
buffer_load_dwordx4 v14, s[4:7], s86 offen offset:2048 sc1 lds
buffer_load_dwordx4 v15, s[4:7], s86 offen offset:3072 sc1 lds
s_add_u32 m0, s50, 8192
s_nop 0
buffer_load_dwordx4 v16, s[4:7], s86 offen offset:0 sc1 lds
buffer_load_dword v24, v22, s[4:7], 0 offen sc1
buffer_store_dword v27, v34, s[4:7], 0 offen
v_mov_b32 v27, s78
s_waitcnt vmcnt(9)
s_barrier
buffer_store_dword v27, v45, s[4:7], s79 offen
buffer_store_dword v27, v44, s[4:7], s79 offen sc1
s_mov_b32 s79, 1879048192
ds_read_b128 v[64:67], v30 offset:0
ds_read_b128 v[68:71], v30 offset:9216
ds_read_b128 v[72:75], v30 offset:18432
ds_read_b128 v[76:79], v30 offset:27648
ds_read_b128 v[80:83], v30 offset:1024
ds_read_b128 v[84:87], v30 offset:10240
ds_read_b128 v[88:91], v30 offset:19456
ds_read_b128 v[92:95], v30 offset:28672
s_waitcnt vmcnt(8)
s_barrier
s_branch g_body_50
g_slow_62:
v_mfma_f32_16x16x32_bf16 v[228:231], v[172:175], a[196:199], v[228:231]
v_mfma_f32_16x16x32_bf16 v[224:227], v[176:179], a[200:203], v[224:227]
v_mfma_f32_16x16x32_bf16 v[228:231], v[180:183], a[200:203], v[228:231]
v_mfma_f32_16x16x32_bf16 v[224:227], v[184:187], a[204:207], v[224:227]
v_mfma_f32_16x16x32_bf16 v[228:231], v[188:191], a[204:207], v[228:231]
v_mfma_f32_16x16x32_bf16 v[224:227], v[192:195], a[208:211], v[224:227]
v_mfma_f32_16x16x32_bf16 v[228:231], v[196:199], a[208:211], v[228:231]
v_mfma_f32_16x16x32_bf16 v[224:227], v[200:203], a[212:215], v[224:227]
v_mfma_f32_16x16x32_bf16 v[228:231], v[204:207], a[212:215], v[228:231]
s_nop 6
v_cvt_pk_bf16_f32 v56, v224, v225
v_cvt_pk_bf16_f32 v57, v226, v227
v_cvt_pk_bf16_f32 v58, v228, v229
v_cvt_pk_bf16_f32 v59, v230, v231
buffer_store_dwordx4 v[56:59], v21, s[4:7], s87 offen sc1
s_mov_b32 s87, 1879048192
s_waitcnt vmcnt(4)
ds_write_b32 v18, v24
s_waitcnt lgkmcnt(0)
s_barrier
ds_read_b32 v33, v32
s_waitcnt lgkmcnt(0)
v_cmp_gt_u32 vcc, s52, v33
v_cmp_gt_u32 s[58:59], s54, v33
s_and_b32 vcc_lo, vcc_lo, s56
s_cselect_b32 s70, 0, 1
s_and_b32 s59, s59, s56
s_cselect_b32 s71, 0, s89
s_or_b32 s94, s70, s71
s_cselect_b32 s10, 268435456, 0
s_cmp_lg_u32 s70, 0
s_cselect_b64 s[90:91], s[52:53], s[54:55]
s_cselect_b64 s[58:59], s[44:45], s[46:47]
s_mul_i32 s92, s90, s20
s_add_u32 s92, s92, s58
s_mul_i32 s93, s90, s21
s_add_u32 s93, s93, s59
s_andn2_b32 s71, s71, s70
s_add_u32 s52, s52, s70
s_add_u32 s54, s54, s71
s_mov_b32 s95, s94
s_cmp_lg_u32 s94, 0
s_cbranch_scc1 g_go_72
v_mov_b32 v27, s84
s_waitcnt vmcnt(0)
s_barrier
s_add_u32 s70, s52, s54
s_cmp_eq_u32 s70, 130
s_cbranch_scc1 g_fin_52
s_cmp_lg_u32 s3, 0
s_cbranch_scc1 sp_ok_74_j
s_mov_b32 s23, 0
buffer_load_dword v33, v22, s[4:7], 0 offen sc1
buffer_store_dword v27, v45, s[4:7], s85 offen
buffer_store_dword v27, v44, s[4:7], s85 offen sc1
s_waitcnt vmcnt(2)
s_branch sp_loop_73_e
sp_loop_73:
buffer_load_dword v33, v22, s[4:7], 0 offen sc1
s_add_u32 s23, s23, 1
s_cmp_gt_u32 s23, 150000
s_cbranch_scc1 sp_bad_75
s_waitcnt vmcnt(0)
sp_loop_73_e:
v_cmp_gt_u32 vcc, s52, v33
v_cmp_gt_u32 s[58:59], s54, v33
s_and_b32 vcc_lo, vcc_lo, s56
s_cbranch_scc0 sp_ok_74
s_cmp_gt_u32 s23, 4
s_cselect_b32 s70, 0, s56
s_cmp_lg_u32 s89, 0
s_cselect_b32 s70, 0, s70
s_or_b32 s59, s59, s70
s_and_b32 s59, s59, s56
s_cbranch_scc0 sp_ok_74
s_sleep 1
s_branch sp_loop_73
sp_bad_75:
s_mov_b32 s98, 1026
s_branch L_fail
sp_ok_74:
ds_write_b32 v18, v33
s_waitcnt lgkmcnt(0)
sp_ok_74_j:
s_barrier
ds_read_b32 v33, v32
s_waitcnt lgkmcnt(0)
s_mov_b32 s85, 1879048192
v_cmp_gt_u32 vcc, s52, v33
v_cmp_gt_u32 s[58:59], s54, v33
s_and_b32 vcc_lo, vcc_lo, s56
s_cselect_b32 s70, 0, 1
s_and_b32 s59, s59, s56
s_cselect_b32 s71, 0, 1
s_or_b32 s94, s70, s71
s_cselect_b32 s10, 268435456, 0
s_cmp_lg_u32 s70, 0
s_cselect_b64 s[90:91], s[52:53], s[54:55]
s_cselect_b64 s[58:59], s[44:45], s[46:47]
s_mul_i32 s92, s90, s20
s_add_u32 s92, s92, s58
s_mul_i32 s93, s90, s21
s_add_u32 s93, s93, s59
s_andn2_b32 s71, s71, s70
s_add_u32 s52, s52, s70
s_add_u32 s54, s54, s71
s_mov_b32 s95, s94
g_go_72:
s_add_u32 m0, s51, 0
s_nop 0
buffer_load_dwordx4 v8, s[4:7], s92 offen offset:0 sc1 lds
buffer_load_dwordx4 v9, s[4:7], s92 offen offset:1024 sc1 lds
buffer_load_dwordx4 v10, s[4:7], s92 offen offset:2048 sc1 lds
buffer_load_dwordx4 v11, s[4:7], s92 offen offset:3072 sc1 lds
s_add_u32 m0, s51, 4096
s_nop 0
buffer_load_dwordx4 v12, s[4:7], s92 offen offset:0 sc1 lds
buffer_load_dwordx4 v13, s[4:7], s92 offen offset:1024 sc1 lds
buffer_load_dwordx4 v14, s[4:7], s92 offen offset:2048 sc1 lds
buffer_load_dwordx4 v15, s[4:7], s92 offen offset:3072 sc1 lds
s_add_u32 m0, s51, 8192
s_nop 0
buffer_load_dwordx4 v16, s[4:7], s92 offen offset:0 sc1 lds
buffer_load_dword v24, v22, s[4:7], 0 offen sc1
buffer_store_dword v27, v34, s[4:7], 0 offen
v_mov_b32 v27, s84
s_waitcnt vmcnt(9)
s_barrier
buffer_store_dword v27, v45, s[4:7], s85 offen
buffer_store_dword v27, v44, s[4:7], s85 offen sc1
s_mov_b32 s85, 1879048192
ds_read_b128 v[64:67], v31 offset:0
ds_read_b128 v[68:71], v31 offset:9216
ds_read_b128 v[72:75], v31 offset:18432
ds_read_b128 v[76:79], v31 offset:27648
ds_read_b128 v[80:83], v31 offset:1024
ds_read_b128 v[84:87], v31 offset:10240
ds_read_b128 v[88:91], v31 offset:19456
ds_read_b128 v[92:95], v31 offset:28672
s_waitcnt vmcnt(8)
s_barrier
s_branch g_body_51
g_slow_63:
v_mfma_f32_16x16x32_bf16 v[228:231], v[172:175], a[196:199], v[228:231]
v_mfma_f32_16x16x32_bf16 v[224:227], v[176:179], a[200:203], v[224:227]
v_mfma_f32_16x16x32_bf16 v[228:231], v[180:183], a[200:203], v[228:231]
v_mfma_f32_16x16x32_bf16 v[224:227], v[184:187], a[204:207], v[224:227]
v_mfma_f32_16x16x32_bf16 v[228:231], v[188:191], a[204:207], v[228:231]
v_mfma_f32_16x16x32_bf16 v[224:227], v[192:195], a[208:211], v[224:227]
v_mfma_f32_16x16x32_bf16 v[228:231], v[196:199], a[208:211], v[228:231]
v_mfma_f32_16x16x32_bf16 v[224:227], v[200:203], a[212:215], v[224:227]
v_mfma_f32_16x16x32_bf16 v[228:231], v[204:207], a[212:215], v[228:231]
s_nop 6
v_cvt_pk_bf16_f32 v56, v224, v225
v_cvt_pk_bf16_f32 v57, v226, v227
v_cvt_pk_bf16_f32 v58, v228, v229
v_cvt_pk_bf16_f32 v59, v230, v231
buffer_store_dwordx4 v[56:59], v21, s[4:7], s93 offen sc1
s_mov_b32 s93, 1879048192
s_waitcnt vmcnt(4)
ds_write_b32 v18, v24
s_waitcnt lgkmcnt(0)
s_barrier
ds_read_b32 v33, v32
s_waitcnt lgkmcnt(0)
v_cmp_gt_u32 vcc, s52, v33
v_cmp_gt_u32 s[58:59], s54, v33
s_and_b32 vcc_lo, vcc_lo, s56
s_cselect_b32 s70, 0, 1
s_and_b32 s59, s59, s56
s_cselect_b32 s71, 0, s95
s_or_b32 s76, s70, s71
s_cselect_b32 s10, 268435456, 0
s_cmp_lg_u32 s70, 0
s_cselect_b64 s[72:73], s[52:53], s[54:55]
s_cselect_b64 s[58:59], s[44:45], s[46:47]
s_mul_i32 s74, s72, s20
s_add_u32 s74, s74, s58
s_mul_i32 s75, s72, s21
s_add_u32 s75, s75, s59
s_andn2_b32 s71, s71, s70
s_add_u32 s52, s52, s70
s_add_u32 s54, s54, s71
s_mov_b32 s77, s76
s_cmp_lg_u32 s76, 0
s_cbranch_scc1 g_go_76
v_mov_b32 v27, s90
s_waitcnt vmcnt(0)
s_barrier
s_add_u32 s70, s52, s54
s_cmp_eq_u32 s70, 130
s_cbranch_scc1 g_fin_52
s_cmp_lg_u32 s3, 0
s_cbranch_scc1 sp_ok_78_j
s_mov_b32 s23, 0
buffer_load_dword v33, v22, s[4:7], 0 offen sc1
buffer_store_dword v27, v45, s[4:7], s91 offen
buffer_store_dword v27, v44, s[4:7], s91 offen sc1
s_waitcnt vmcnt(2)
s_branch sp_loop_77_e
sp_loop_77:
buffer_load_dword v33, v22, s[4:7], 0 offen sc1
s_add_u32 s23, s23, 1
s_cmp_gt_u32 s23, 150000
s_cbranch_scc1 sp_bad_79
s_waitcnt vmcnt(0)
sp_loop_77_e:
v_cmp_gt_u32 vcc, s52, v33
v_cmp_gt_u32 s[58:59], s54, v33
s_and_b32 vcc_lo, vcc_lo, s56
s_cbranch_scc0 sp_ok_78
s_cmp_gt_u32 s23, 4
s_cselect_b32 s70, 0, s56
s_cmp_lg_u32 s95, 0
s_cselect_b32 s70, 0, s70
s_or_b32 s59, s59, s70
s_and_b32 s59, s59, s56
s_cbranch_scc0 sp_ok_78
s_sleep 1
s_branch sp_loop_77
sp_bad_79:
s_mov_b32 s98, 1026
s_branch L_fail
sp_ok_78:
ds_write_b32 v18, v33
s_waitcnt lgkmcnt(0)
sp_ok_78_j:
s_barrier
ds_read_b32 v33, v32
s_waitcnt lgkmcnt(0)
s_mov_b32 s91, 1879048192
v_cmp_gt_u32 vcc, s52, v33
v_cmp_gt_u32 s[58:59], s54, v33
s_and_b32 vcc_lo, vcc_lo, s56
s_cselect_b32 s70, 0, 1
s_and_b32 s59, s59, s56
s_cselect_b32 s71, 0, 1
s_or_b32 s76, s70, s71
s_cselect_b32 s10, 268435456, 0
s_cmp_lg_u32 s70, 0
s_cselect_b64 s[72:73], s[52:53], s[54:55]
s_cselect_b64 s[58:59], s[44:45], s[46:47]
s_mul_i32 s74, s72, s20
s_add_u32 s74, s74, s58
s_mul_i32 s75, s72, s21
s_add_u32 s75, s75, s59
s_andn2_b32 s71, s71, s70
s_add_u32 s52, s52, s70
s_add_u32 s54, s54, s71
s_mov_b32 s77, s76
g_go_76:
s_add_u32 m0, s48, 0
s_nop 0
buffer_load_dwordx4 v8, s[4:7], s74 offen offset:0 sc1 lds
buffer_load_dwordx4 v9, s[4:7], s74 offen offset:1024 sc1 lds
buffer_load_dwordx4 v10, s[4:7], s74 offen offset:2048 sc1 lds
buffer_load_dwordx4 v11, s[4:7], s74 offen offset:3072 sc1 lds
s_add_u32 m0, s48, 4096
s_nop 0
buffer_load_dwordx4 v12, s[4:7], s74 offen offset:0 sc1 lds
buffer_load_dwordx4 v13, s[4:7], s74 offen offset:1024 sc1 lds
buffer_load_dwordx4 v14, s[4:7], s74 offen offset:2048 sc1 lds
buffer_load_dwordx4 v15, s[4:7], s74 offen offset:3072 sc1 lds
s_add_u32 m0, s48, 8192
s_nop 0
buffer_load_dwordx4 v16, s[4:7], s74 offen offset:0 sc1 lds
buffer_load_dword v24, v22, s[4:7], 0 offen sc1
buffer_store_dword v27, v34, s[4:7], 0 offen
v_mov_b32 v27, s90
s_waitcnt vmcnt(9)
s_barrier
buffer_store_dword v27, v45, s[4:7], s91 offen
buffer_store_dword v27, v44, s[4:7], s91 offen sc1
s_mov_b32 s91, 1879048192
ds_read_b128 v[64:67], v28 offset:0
ds_read_b128 v[68:71], v28 offset:9216
ds_read_b128 v[72:75], v28 offset:18432
ds_read_b128 v[76:79], v28 offset:27648
ds_read_b128 v[80:83], v28 offset:1024
ds_read_b128 v[84:87], v28 offset:10240
ds_read_b128 v[88:91], v28 offset:19456
ds_read_b128 v[92:95], v28 offset:28672
s_waitcnt vmcnt(8)
s_barrier
s_branch g_body_48
g_fin_52:
buffer_store_dword v27, v45, s[4:7], s91 offen
buffer_store_dword v27, v44, s[4:7], s91 offen sc1
s_endpgm
G_sss18:
s_mov_b32 s8, s42
s_and_b32 s9, s43, 0xffff
s_mov_b32 s10, 0
s_mov_b32 s11, 0x20000
s_mov_b32 s22, 0
s_mul_i32 s48, s3, 9216
s_add_u32 s49, s48, 36864
s_add_u32 s50, s48, 73728
s_add_u32 s51, s48, 110592
s_mov_b32 s57, 0xbfb8aa3b
v_add_u32 v28, 0, v17
v_add_u32 v29, 36864, v17
v_add_u32 v30, 73728, v17
v_add_u32 v31, 110592, v17
v_lshlrev_b32 v1, 2, v0
v_add_u32 v32, 147456, v1
s_lshl_b32 s70, s3, 8
v_add_u32 v18, s70, v32
v_mov_b64 v[224:225], 0
v_mov_b64 v[236:237], 0
v_mov_b64 v[226:227], 0
v_mov_b64 v[238:239], 0
v_mov_b64 v[228:229], 0
v_mov_b64 v[240:241], 0
v_mov_b64 v[230:231], 0
v_mov_b64 v[242:243], 0
s_mov_b32 s12, s40
s_and_b32 s13, s41, 0xffff
s_mov_b32 s14, 256
s_mov_b32 s15, 0x20000
v_lshlrev_b32 v26, 2, v0
v_add_u32 v27, 128, v26
v_cmp_le_u32 vcc, 2, v0
s_nop 1
v_cndmask_b32 v26, v26, v27, vcc
v_mov_b32 v27, 192
v_cmp_eq_u32 vcc, 8, v0
s_nop 1
v_cndmask_b32 v26, v26, v27, vcc
v_mov_b32 v27, 2147483632
v_cmp_lt_u32 vcc, 8, v0
s_nop 1
v_cndmask_b32 v26, v26, v27, vcc
s_mov_b32 s98, 0
wi_loop_85:
buffer_load_dword v27, v26, s[12:15], 0 offen sc1
s_add_u32 s98, s98, 1
s_cmp_gt_u32 s98, 150000
s_cbranch_scc1 wi_bad_87
s_waitcnt vmcnt(0)
v_cmp_eq_u32 vcc, 32, v27
s_nop 0
s_and_b32 s97, vcc_lo, 0x1ff
s_cmp_eq_u32 s97, 0x1ff
s_cbranch_scc1 wi_ok_86
v_cmp_lt_u32 vcc, 32, v27
s_nop 0
s_and_b32 s96, vcc_lo, 0xff
s_cselect_b32 s96, 0x100, 0
s_and_b32 s96, s96, s97
s_cbranch_scc1 wi_over_88
s_sleep 8
s_branch wi_loop_85
wi_bad_87:
s_mov_b32 s98, 512
s_branch L_fail
wi_over_88:
s_mov_b32 s100, 255
wi_ok_86:
v_add_u32 v26, 65536, v22
v_cmp_eq_u32 vcc, s100, v23
s_nop 1
v_cndmask_b32 v22, v22, v26, vcc
s_mov_b32 s90, 0
s_mov_b32 s91, 1879048192
s_mov_b32 s93, 1879048192
v_mov_b32 v34, 2147483632
s_barrier
s_mov_b32 s95, 1
s_cmp_lg_u32 s3, 0
s_cbranch_scc1 sp_ok_90_j
s_mov_b32 s23, 0
sp_loop_89:
buffer_load_dword v33, v22, s[4:7], 0 offen sc1
s_add_u32 s23, s23, 1
s_cmp_gt_u32 s23, 150000
s_cbranch_scc1 sp_bad_91
s_waitcnt vmcnt(0)
sp_loop_89_e:
v_cmp_gt_u32 vcc, s52, v33
v_cmp_gt_u32 s[58:59], s54, v33
s_and_b32 vcc_lo, vcc_lo, s56
s_cbranch_scc0 sp_ok_90
s_cmp_gt_u32 s23, 4
s_cselect_b32 s70, 0, s56
s_cmp_lg_u32 s95, 0
s_cselect_b32 s70, 0, s70
s_or_b32 s59, s59, s70
s_and_b32 s59, s59, s56
s_cbranch_scc0 sp_ok_90
s_sleep 1
s_branch sp_loop_89
sp_bad_91:
s_mov_b32 s98, 1027
s_branch L_fail
sp_ok_90:
ds_write_b32 v18, v33
s_waitcnt lgkmcnt(0)
sp_ok_90_j:
s_barrier
ds_read_b32 v33, v32
s_waitcnt lgkmcnt(0)
v_cmp_gt_u32 vcc, s52, v33
v_cmp_gt_u32 s[58:59], s54, v33
s_and_b32 vcc_lo, vcc_lo, s56
s_cselect_b32 s70, 0, 1
s_and_b32 s59, s59, s56
s_cselect_b32 s71, 0, 1
s_or_b32 s76, s70, s71
s_cselect_b32 s10, 268435456, 0
s_cmp_lg_u32 s70, 0
s_cselect_b64 s[72:73], s[52:53], s[54:55]
s_cselect_b64 s[58:59], s[44:45], s[46:47]
s_mul_i32 s74, s72, s20
s_add_u32 s74, s74, s58
s_mul_i32 s75, s72, s21
s_add_u32 s75, s75, s59
s_andn2_b32 s71, s71, s70
s_add_u32 s52, s52, s70
s_add_u32 s54, s54, s71
s_mov_b32 s77, s76
s_add_u32 m0, s48, 0
s_nop 0
buffer_load_dwordx4 v8, s[4:7], s74 offen offset:0 sc1 lds
buffer_load_dwordx4 v9, s[4:7], s74 offen offset:1024 sc1 lds
buffer_load_dwordx4 v10, s[4:7], s74 offen offset:2048 sc1 lds
buffer_load_dwordx4 v11, s[4:7], s74 offen offset:3072 sc1 lds
s_add_u32 m0, s48, 4096
s_nop 0
buffer_load_dwordx4 v12, s[4:7], s74 offen offset:0 sc1 lds
buffer_load_dwordx4 v13, s[4:7], s74 offen offset:1024 sc1 lds
buffer_load_dwordx4 v14, s[4:7], s74 offen offset:2048 sc1 lds
buffer_load_dwordx4 v15, s[4:7], s74 offen offset:3072 sc1 lds
s_add_u32 m0, s48, 8192
s_nop 0
buffer_load_dwordx4 v16, s[4:7], s74 offen offset:0 sc1 lds
buffer_load_dword v24, v22, s[4:7], 0 offen sc1
buffer_store_dword v27, v34, s[4:7], 0 offen
v_mov_b32 v27, s90
s_waitcnt vmcnt(9)
s_barrier
buffer_store_dword v27, v45, s[4:7], s91 offen
buffer_store_dword v27, v44, s[4:7], s91 offen sc1
s_mov_b32 s91, 1879048192
ds_read_b128 v[64:67], v28 offset:0
ds_read_b128 v[68:71], v28 offset:9216
ds_read_b128 v[72:75], v28 offset:18432
ds_read_b128 v[76:79], v28 offset:27648
ds_read_b128 v[80:83], v28 offset:1024
ds_read_b128 v[84:87], v28 offset:10240
ds_read_b128 v[88:91], v28 offset:19456
ds_read_b128 v[92:95], v28 offset:28672
s_waitcnt vmcnt(8)
s_barrier
s_branch g_body_80
g_body_80:
s_waitcnt lgkmcnt(4)
v_mfma_f32_16x16x32_bf16 v[208:211], a[0:3], v[64:67], 0
ds_read_b128 v[96:99], v28 offset:2048
v_mfma_f32_16x16x32_bf16 v[212:215], a[0:3], v[68:71], 0
ds_read_b128 v[100:103], v28 offset:11264
v_mfma_f32_16x16x32_bf16 v[216:219], a[72:75], v[64:67], 0
v_mfma_f32_16x16x32_bf16 v[208:211], a[4:7], v[72:75], v[208:211]
ds_read_b128 v[104:107], v28 offset:20480
v_cvt_pk_bf16_f32 v56, v224, v225
v_mfma_f32_16x16x32_bf16 v[212:215], a[4:7], v[76:79], v[212:215]
ds_read_b128 v[108:111], v28 offset:29696
v_cvt_pk_bf16_f32 v57, v226, v227
v_mfma_f32_16x16x32_bf16 v[220:223], a[72:75], v[68:71], 0
v_cvt_pk_bf16_f32 v58, v228, v229
s_waitcnt lgkmcnt(4)
v_mfma_f32_16x16x32_bf16 v[208:211], a[8:11], v[80:83], v[208:211]
ds_read_b128 v[112:115], v28 offset:3072
v_cvt_pk_bf16_f32 v59, v230, v231
v_mfma_f32_16x16x32_bf16 v[212:215], a[8:11], v[84:87], v[212:215]
ds_read_b128 v[116:119], v28 offset:12288
v_permlane16_swap_b32 v56, v58
v_mfma_f32_16x16x32_bf16 v[216:219], a[76:79], v[72:75], v[216:219]
v_permlane16_swap_b32 v57, v59
v_mfma_f32_16x16x32_bf16 v[208:211], a[12:15], v[88:91], v[208:211]
ds_read_b128 v[120:123], v28 offset:21504
v_mfma_f32_16x16x32_bf16 v[212:215], a[12:15], v[92:95], v[212:215]
ds_read_b128 v[124:127], v28 offset:30720
v_mfma_f32_16x16x32_bf16 v[220:223], a[76:79], v[76:79], v[220:223]
s_waitcnt lgkmcnt(4)
v_mfma_f32_16x16x32_bf16 v[208:211], a[16:19], v[96:99], v[208:211]
ds_read_b128 v[128:131], v28 offset:4096
v_mfma_f32_16x16x32_bf16 v[212:215], a[16:19], v[100:103], v[212:215]
ds_read_b128 v[132:135], v28 offset:13312
v_mfma_f32_16x16x32_bf16 v[216:219], a[80:83], v[80:83], v[216:219]
buffer_store_dwordx4 v[56:59], v21, s[4:7], s93 offen sc1
v_mfma_f32_16x16x32_bf16 v[208:211], a[20:23], v[104:107], v[208:211]
ds_read_b128 v[136:139], v28 offset:22528
v_mfma_f32_16x16x32_bf16 v[212:215], a[20:23], v[108:111], v[212:215]
ds_read_b128 v[140:143], v28 offset:31744
v_mfma_f32_16x16x32_bf16 v[220:223], a[80:83], v[84:87], v[220:223]
s_waitcnt vmcnt(5)
s_barrier
s_waitcnt lgkmcnt(4)
v_mfma_f32_16x16x32_bf16 v[208:211], a[24:27], v[112:115], v[208:211]
ds_read_b128 v[144:147], v28 offset:5120
v_mov_b32 v27, s90
v_mfma_f32_16x16x32_bf16 v[212:215], a[24:27], v[116:119], v[212:215]
ds_read_b128 v[148:151], v28 offset:14336
v_mfma_f32_16x16x32_bf16 v[216:219], a[84:87], v[88:91], v[216:219]
v_mfma_f32_16x16x32_bf16 v[208:211], a[28:31], v[120:123], v[208:211]
ds_read_b128 v[152:155], v28 offset:23552
v_mfma_f32_16x16x32_bf16 v[212:215], a[28:31], v[124:127], v[212:215]
ds_read_b128 v[156:159], v28 offset:32768
v_mfma_f32_16x16x32_bf16 v[220:223], a[84:87], v[92:95], v[220:223]
s_waitcnt lgkmcnt(4)
v_mfma_f32_16x16x32_bf16 v[208:211], a[32:35], v[128:131], v[208:211]
ds_read_b128 v[160:163], v28 offset:6144
v_mfma_f32_16x16x32_bf16 v[212:215], a[32:35], v[132:135], v[212:215]
ds_read_b128 v[164:167], v28 offset:15360
v_mfma_f32_16x16x32_bf16 v[216:219], a[88:91], v[96:99], v[216:219]
v_mfma_f32_16x16x32_bf16 v[208:211], a[36:39], v[136:139], v[208:211]
ds_read_b128 v[168:171], v28 offset:24576
v_mfma_f32_16x16x32_bf16 v[212:215], a[36:39], v[140:143], v[212:215]
ds_read_b128 v[172:175], v28 offset:33792
v_mfma_f32_16x16x32_bf16 v[220:223], a[88:91], v[100:103], v[220:223]
s_waitcnt lgkmcnt(4)
v_mfma_f32_16x16x32_bf16 v[208:211], a[40:43], v[144:147], v[208:211]
ds_read_b128 v[176:179], v28 offset:7168
v_mfma_f32_16x16x32_bf16 v[212:215], a[40:43], v[148:151], v[212:215]
ds_read_b128 v[180:183], v28 offset:16384
s_waitcnt vmcnt(4)
ds_write_b32 v18, v24
v_mfma_f32_16x16x32_bf16 v[216:219], a[92:95], v[104:107], v[216:219]
v_mfma_f32_16x16x32_bf16 v[208:211], a[44:47], v[152:155], v[208:211]
ds_read_b128 v[184:187], v28 offset:25600
v_mfma_f32_16x16x32_bf16 v[212:215], a[44:47], v[156:159], v[212:215]
ds_read_b128 v[188:191], v28 offset:34816
s_waitcnt lgkmcnt(2)
s_barrier
v_mfma_f32_16x16x32_bf16 v[220:223], a[92:95], v[108:111], v[220:223]
ds_read_b32 v33, v32
v_mfma_f32_16x16x32_bf16 v[208:211], a[48:51], v[160:163], v[208:211]
ds_read_b128 v[192:195], v28 offset:8192
v_mfma_f32_16x16x32_bf16 v[212:215], a[48:51], v[164:167], v[212:215]
ds_read_b128 v[196:199], v28 offset:17408
v_mfma_f32_16x16x32_bf16 v[216:219], a[96:99], v[112:115], v[216:219]
s_waitcnt lgkmcnt(2)
v_cmp_gt_u32 vcc, s52, v33
v_mfma_f32_16x16x32_bf16 v[208:211], a[52:55], v[168:171], v[208:211]
ds_read_b128 v[200:203], v28 offset:26624
v_cmp_gt_u32 s[58:59], s54, v33
v_mfma_f32_16x16x32_bf16 v[212:215], a[52:55], v[172:175], v[212:215]
ds_read_b128 v[204:207], v28 offset:35840
s_and_b32 vcc_lo, vcc_lo, s56
s_cselect_b32 s70, 0, 1
v_mfma_f32_16x16x32_bf16 v[220:223], a[96:99], v[116:119], v[220:223]
v_mfma_f32_16x16x32_bf16 v[208:211], a[56:59], v[176:179], v[208:211]
s_and_b32 s59, s59, s56
s_cselect_b32 s71, 0, s77
v_mfma_f32_16x16x32_bf16 v[212:215], a[56:59], v[180:183], v[212:215]
s_or_b32 s82, s70, s71
s_cselect_b32 s10, 268435456, 0
v_mfma_f32_16x16x32_bf16 v[216:219], a[100:103], v[120:123], v[216:219]
s_cmp_lg_u32 s70, 0
s_cselect_b64 s[78:79], s[52:53], s[54:55]
s_cselect_b64 s[58:59], s[44:45], s[46:47]
v_mfma_f32_16x16x32_bf16 v[208:211], a[60:63], v[184:187], v[208:211]
s_mul_i32 s80, s78, s20
s_add_u32 s80, s80, s58
v_mfma_f32_16x16x32_bf16 v[212:215], a[60:63], v[188:191], v[212:215]
s_add_u32 m0, s49, 0
s_mul_i32 s81, s78, s21
s_add_u32 s81, s81, s59
v_mfma_f32_16x16x32_bf16 v[220:223], a[100:103], v[124:127], v[220:223]
buffer_load_dwordx4 v8, s[8:11], s80 offen offset:0 sc1 lds
s_waitcnt lgkmcnt(0)
v_mfma_f32_16x16x32_bf16 v[208:211], a[64:67], v[192:195], v[208:211]
s_andn2_b32 s71, s71, s70
s_add_u32 s52, s52, s70
s_add_u32 s54, s54, s71
v_mfma_f32_16x16x32_bf16 v[212:215], a[64:67], v[196:199], v[212:215]
s_mov_b32 s83, s82
v_mfma_f32_16x16x32_bf16 v[216:219], a[104:107], v[128:131], v[216:219]
buffer_load_dwordx4 v9, s[8:11], s80 offen offset:1024 sc1 lds
v_mfma_f32_16x16x32_bf16 v[208:211], a[68:71], v[200:203], v[208:211]
v_mfma_f32_16x16x32_bf16 v[212:215], a[68:71], v[204:207], v[212:215]
v_mfma_f32_16x16x32_bf16 v[220:223], a[104:107], v[132:135], v[220:223]
buffer_load_dwordx4 v10, s[8:11], s80 offen offset:2048 sc1 lds
v_mfma_f32_16x16x32_bf16 v[216:219], a[108:111], v[136:139], v[216:219]
v_mfma_f32_16x16x32_bf16 v[220:223], a[108:111], v[140:143], v[220:223]
v_mfma_f32_16x16x32_bf16 v[216:219], a[112:115], v[144:147], v[216:219]
buffer_load_dwordx4 v11, s[8:11], s80 offen offset:3072 sc1 lds
v_mfma_f32_16x16x32_bf16 v[220:223], a[112:115], v[148:151], v[220:223]
v_mfma_f32_16x16x32_bf16 v[216:219], a[116:119], v[152:155], v[216:219]
s_add_u32 m0, s49, 4096
v_cvt_pk_bf16_f32 v48, v208, v209
v_mfma_f32_16x16x32_bf16 v[220:223], a[116:119], v[156:159], v[220:223]
buffer_load_dwordx4 v12, s[8:11], s80 offen offset:0 sc1 lds
v_mfma_f32_16x16x32_bf16 v[216:219], a[120:123], v[160:163], v[216:219]
v_cvt_pk_bf16_f32 v49, v210, v211
v_cvt_pk_bf16_f32 v50, v212, v213
v_mfma_f32_16x16x32_bf16 v[220:223], a[120:123], v[164:167], v[220:223]
v_cvt_pk_bf16_f32 v51, v214, v215
v_mfma_f32_16x16x32_bf16 v[216:219], a[124:127], v[168:171], v[216:219]
buffer_load_dwordx4 v13, s[8:11], s80 offen offset:1024 sc1 lds
v_mfma_f32_16x16x32_bf16 v[220:223], a[124:127], v[172:175], v[220:223]
v_permlane16_swap_b32 v48, v50
v_mfma_f32_16x16x32_bf16 v[216:219], a[128:131], v[176:179], v[216:219]
v_permlane16_swap_b32 v49, v51
v_mfma_f32_16x16x32_bf16 v[220:223], a[128:131], v[180:183], v[220:223]
buffer_load_dwordx4 v14, s[8:11], s80 offen offset:2048 sc1 lds
v_mfma_f32_16x16x32_bf16 v[216:219], a[132:135], v[184:187], v[216:219]
buffer_store_dwordx4 v[48:51], v19, s[4:7], s75 offen sc1
v_mfma_f32_16x16x32_bf16 v[220:223], a[132:135], v[188:191], v[220:223]
v_mfma_f32_16x16x32_bf16 v[216:219], a[136:139], v[192:195], v[216:219]
buffer_load_dwordx4 v15, s[8:11], s80 offen offset:3072 sc1 lds
v_mfma_f32_16x16x32_bf16 v[220:223], a[136:139], v[196:199], v[220:223]
v_mfma_f32_16x16x32_bf16 v[216:219], a[140:143], v[200:203], v[216:219]
s_add_u32 m0, s49, 8192
v_mfma_f32_16x16x32_bf16 v[220:223], a[140:143], v[204:207], v[220:223]
buffer_load_dwordx4 v16, s[8:11], s80 offen offset:0 sc1 lds
v_mfma_f32_16x16x32_bf16 v[224:227], a[144:147], v[64:67], 0
v_mfma_f32_16x16x32_bf16 v[228:231], a[144:147], v[68:71], 0
v_mfma_f32_16x16x32_bf16 v[224:227], a[148:151], v[72:75], v[224:227]
v_mfma_f32_16x16x32_bf16 v[228:231], a[148:151], v[76:79], v[228:231]
v_mfma_f32_16x16x32_bf16 v[224:227], a[152:155], v[80:83], v[224:227]
buffer_load_dword v24, v22, s[4:7], 0 offen sc1
v_mfma_f32_16x16x32_bf16 v[228:231], a[152:155], v[84:87], v[228:231]
v_cvt_pk_bf16_f32 v52, v216, v217
v_cvt_pk_bf16_f32 v53, v218, v219
v_mfma_f32_16x16x32_bf16 v[224:227], a[156:159], v[88:91], v[224:227]
s_waitcnt vmcnt(11)
s_barrier
v_mfma_f32_16x16x32_bf16 v[228:231], a[156:159], v[92:95], v[228:231]
buffer_store_dword v27, v45, s[4:7], s91 offen
v_mfma_f32_16x16x32_bf16 v[224:227], a[160:163], v[96:99], v[224:227]
buffer_store_dword v27, v44, s[4:7], s91 offen sc1
v_mfma_f32_16x16x32_bf16 v[228:231], a[160:163], v[100:103], v[228:231]
v_cvt_pk_bf16_f32 v54, v220, v221
v_cvt_pk_bf16_f32 v55, v222, v223
v_mfma_f32_16x16x32_bf16 v[224:227], a[164:167], v[104:107], v[224:227]
v_permlane16_swap_b32 v52, v54
v_mfma_f32_16x16x32_bf16 v[228:231], a[164:167], v[108:111], v[228:231]
v_permlane16_swap_b32 v53, v55
v_mfma_f32_16x16x32_bf16 v[224:227], a[168:171], v[112:115], v[224:227]
buffer_store_dwordx4 v[52:55], v20, s[4:7], s75 offen sc1
v_mfma_f32_16x16x32_bf16 v[228:231], a[168:171], v[116:119], v[228:231]
v_mfma_f32_16x16x32_bf16 v[224:227], a[172:175], v[120:123], v[224:227]
v_mfma_f32_16x16x32_bf16 v[228:231], a[172:175], v[124:127], v[228:231]
v_mfma_f32_16x16x32_bf16 v[224:227], a[176:179], v[128:131], v[224:227]
v_mfma_f32_16x16x32_bf16 v[228:231], a[176:179], v[132:135], v[228:231]
v_mfma_f32_16x16x32_bf16 v[224:227], a[180:183], v[136:139], v[224:227]
v_mfma_f32_16x16x32_bf16 v[228:231], a[180:183], v[140:143], v[228:231]
v_mfma_f32_16x16x32_bf16 v[224:227], a[184:187], v[144:147], v[224:227]
v_mfma_f32_16x16x32_bf16 v[228:231], a[184:187], v[148:151], v[228:231]
v_mfma_f32_16x16x32_bf16 v[224:227], a[188:191], v[152:155], v[224:227]
v_mfma_f32_16x16x32_bf16 v[228:231], a[188:191], v[156:159], v[228:231]
v_mfma_f32_16x16x32_bf16 v[224:227], a[192:195], v[160:163], v[224:227]
s_waitcnt vmcnt(12)
s_barrier
v_mfma_f32_16x16x32_bf16 v[228:231], a[192:195], v[164:167], v[228:231]
v_mfma_f32_16x16x32_bf16 v[224:227], a[196:199], v[168:171], v[224:227]
s_cmp_eq_u32 s82, 0
s_cbranch_scc1 g_slow_92
v_mfma_f32_16x16x32_bf16 v[228:231], a[196:199], v[172:175], v[228:231]
ds_read_b128 v[64:67], v29 offset:0
v_mfma_f32_16x16x32_bf16 v[224:227], a[200:203], v[176:179], v[224:227]
ds_read_b128 v[68:71], v29 offset:9216
v_mfma_f32_16x16x32_bf16 v[228:231], a[200:203], v[180:183], v[228:231]
ds_read_b128 v[72:75], v29 offset:18432
v_mfma_f32_16x16x32_bf16 v[224:227], a[204:207], v[184:187], v[224:227]
ds_read_b128 v[76:79], v29 offset:27648
v_mfma_f32_16x16x32_bf16 v[228:231], a[204:207], v[188:191], v[228:231]
ds_read_b128 v[80:83], v29 offset:1024
v_mfma_f32_16x16x32_bf16 v[224:227], a[208:211], v[192:195], v[224:227]
ds_read_b128 v[84:87], v29 offset:10240
v_mfma_f32_16x16x32_bf16 v[228:231], a[208:211], v[196:199], v[228:231]
ds_read_b128 v[88:91], v29 offset:19456
v_mfma_f32_16x16x32_bf16 v[224:227], a[212:215], v[200:203], v[224:227]
ds_read_b128 v[92:95], v29 offset:28672
v_mfma_f32_16x16x32_bf16 v[228:231], a[212:215], v[204:207], v[228:231]
s_waitcnt vmcnt(9)
s_barrier
g_body_81:
s_waitcnt lgkmcnt(4)
v_mfma_f32_16x16x32_bf16 v[208:211], a[0:3], v[64:67], 0
ds_read_b128 v[96:99], v29 offset:2048
v_mfma_f32_16x16x32_bf16 v[212:215], a[0:3], v[68:71], 0
ds_read_b128 v[100:103], v29 offset:11264
v_mfma_f32_16x16x32_bf16 v[216:219], a[72:75], v[64:67], 0
v_mfma_f32_16x16x32_bf16 v[208:211], a[4:7], v[72:75], v[208:211]
ds_read_b128 v[104:107], v29 offset:20480
v_cvt_pk_bf16_f32 v56, v224, v225
v_mfma_f32_16x16x32_bf16 v[212:215], a[4:7], v[76:79], v[212:215]
ds_read_b128 v[108:111], v29 offset:29696
v_cvt_pk_bf16_f32 v57, v226, v227
v_mfma_f32_16x16x32_bf16 v[220:223], a[72:75], v[68:71], 0
v_cvt_pk_bf16_f32 v58, v228, v229
s_waitcnt lgkmcnt(4)
v_mfma_f32_16x16x32_bf16 v[208:211], a[8:11], v[80:83], v[208:211]
ds_read_b128 v[112:115], v29 offset:3072
v_cvt_pk_bf16_f32 v59, v230, v231
v_mfma_f32_16x16x32_bf16 v[212:215], a[8:11], v[84:87], v[212:215]
ds_read_b128 v[116:119], v29 offset:12288
v_permlane16_swap_b32 v56, v58
v_mfma_f32_16x16x32_bf16 v[216:219], a[76:79], v[72:75], v[216:219]
v_permlane16_swap_b32 v57, v59
v_mfma_f32_16x16x32_bf16 v[208:211], a[12:15], v[88:91], v[208:211]
ds_read_b128 v[120:123], v29 offset:21504
v_mfma_f32_16x16x32_bf16 v[212:215], a[12:15], v[92:95], v[212:215]
ds_read_b128 v[124:127], v29 offset:30720
v_mfma_f32_16x16x32_bf16 v[220:223], a[76:79], v[76:79], v[220:223]
s_waitcnt lgkmcnt(4)
v_mfma_f32_16x16x32_bf16 v[208:211], a[16:19], v[96:99], v[208:211]
ds_read_b128 v[128:131], v29 offset:4096
v_mfma_f32_16x16x32_bf16 v[212:215], a[16:19], v[100:103], v[212:215]
ds_read_b128 v[132:135], v29 offset:13312
v_mfma_f32_16x16x32_bf16 v[216:219], a[80:83], v[80:83], v[216:219]
buffer_store_dwordx4 v[56:59], v21, s[4:7], s75 offen sc1
v_mfma_f32_16x16x32_bf16 v[208:211], a[20:23], v[104:107], v[208:211]
ds_read_b128 v[136:139], v29 offset:22528
v_mfma_f32_16x16x32_bf16 v[212:215], a[20:23], v[108:111], v[212:215]
ds_read_b128 v[140:143], v29 offset:31744
v_mfma_f32_16x16x32_bf16 v[220:223], a[80:83], v[84:87], v[220:223]
s_waitcnt vmcnt(5)
s_barrier
s_waitcnt lgkmcnt(4)
v_mfma_f32_16x16x32_bf16 v[208:211], a[24:27], v[112:115], v[208:211]
ds_read_b128 v[144:147], v29 offset:5120
v_mov_b32 v27, s72
v_mfma_f32_16x16x32_bf16 v[212:215], a[24:27], v[116:119], v[212:215]
ds_read_b128 v[148:151], v29 offset:14336
v_mfma_f32_16x16x32_bf16 v[216:219], a[84:87], v[88:91], v[216:219]
v_mfma_f32_16x16x32_bf16 v[208:211], a[28:31], v[120:123], v[208:211]
ds_read_b128 v[152:155], v29 offset:23552
v_mfma_f32_16x16x32_bf16 v[212:215], a[28:31], v[124:127], v[212:215]
ds_read_b128 v[156:159], v29 offset:32768
v_mfma_f32_16x16x32_bf16 v[220:223], a[84:87], v[92:95], v[220:223]
s_waitcnt lgkmcnt(4)
v_mfma_f32_16x16x32_bf16 v[208:211], a[32:35], v[128:131], v[208:211]
ds_read_b128 v[160:163], v29 offset:6144
v_mfma_f32_16x16x32_bf16 v[212:215], a[32:35], v[132:135], v[212:215]
ds_read_b128 v[164:167], v29 offset:15360
v_mfma_f32_16x16x32_bf16 v[216:219], a[88:91], v[96:99], v[216:219]
v_mfma_f32_16x16x32_bf16 v[208:211], a[36:39], v[136:139], v[208:211]
ds_read_b128 v[168:171], v29 offset:24576
v_mfma_f32_16x16x32_bf16 v[212:215], a[36:39], v[140:143], v[212:215]
ds_read_b128 v[172:175], v29 offset:33792
v_mfma_f32_16x16x32_bf16 v[220:223], a[88:91], v[100:103], v[220:223]
s_waitcnt lgkmcnt(4)
v_mfma_f32_16x16x32_bf16 v[208:211], a[40:43], v[144:147], v[208:211]
ds_read_b128 v[176:179], v29 offset:7168
v_mfma_f32_16x16x32_bf16 v[212:215], a[40:43], v[148:151], v[212:215]
ds_read_b128 v[180:183], v29 offset:16384
s_waitcnt vmcnt(4)
ds_write_b32 v18, v24
v_mfma_f32_16x16x32_bf16 v[216:219], a[92:95], v[104:107], v[216:219]
v_mfma_f32_16x16x32_bf16 v[208:211], a[44:47], v[152:155], v[208:211]
ds_read_b128 v[184:187], v29 offset:25600
v_mfma_f32_16x16x32_bf16 v[212:215], a[44:47], v[156:159], v[212:215]
ds_read_b128 v[188:191], v29 offset:34816
s_waitcnt lgkmcnt(2)
s_barrier
v_mfma_f32_16x16x32_bf16 v[220:223], a[92:95], v[108:111], v[220:223]
ds_read_b32 v33, v32
v_mfma_f32_16x16x32_bf16 v[208:211], a[48:51], v[160:163], v[208:211]
ds_read_b128 v[192:195], v29 offset:8192
v_mfma_f32_16x16x32_bf16 v[212:215], a[48:51], v[164:167], v[212:215]
ds_read_b128 v[196:199], v29 offset:17408
v_mfma_f32_16x16x32_bf16 v[216:219], a[96:99], v[112:115], v[216:219]
s_waitcnt lgkmcnt(2)
v_cmp_gt_u32 vcc, s52, v33
v_mfma_f32_16x16x32_bf16 v[208:211], a[52:55], v[168:171], v[208:211]
ds_read_b128 v[200:203], v29 offset:26624
v_cmp_gt_u32 s[58:59], s54, v33
v_mfma_f32_16x16x32_bf16 v[212:215], a[52:55], v[172:175], v[212:215]
ds_read_b128 v[204:207], v29 offset:35840
s_and_b32 vcc_lo, vcc_lo, s56
s_cselect_b32 s70, 0, 1
v_mfma_f32_16x16x32_bf16 v[220:223], a[96:99], v[116:119], v[220:223]
v_mfma_f32_16x16x32_bf16 v[208:211], a[56:59], v[176:179], v[208:211]
s_and_b32 s59, s59, s56
s_cselect_b32 s71, 0, s83
v_mfma_f32_16x16x32_bf16 v[212:215], a[56:59], v[180:183], v[212:215]
s_or_b32 s88, s70, s71
s_cselect_b32 s10, 268435456, 0
v_mfma_f32_16x16x32_bf16 v[216:219], a[100:103], v[120:123], v[216:219]
s_cmp_lg_u32 s70, 0
s_cselect_b64 s[84:85], s[52:53], s[54:55]
s_cselect_b64 s[58:59], s[44:45], s[46:47]
v_mfma_f32_16x16x32_bf16 v[208:211], a[60:63], v[184:187], v[208:211]
s_mul_i32 s86, s84, s20
s_add_u32 s86, s86, s58
v_mfma_f32_16x16x32_bf16 v[212:215], a[60:63], v[188:191], v[212:215]
s_add_u32 m0, s50, 0
s_mul_i32 s87, s84, s21
s_add_u32 s87, s87, s59
v_mfma_f32_16x16x32_bf16 v[220:223], a[100:103], v[124:127], v[220:223]
buffer_load_dwordx4 v8, s[8:11], s86 offen offset:0 sc1 lds
s_waitcnt lgkmcnt(0)
v_mfma_f32_16x16x32_bf16 v[208:211], a[64:67], v[192:195], v[208:211]
s_andn2_b32 s71, s71, s70
s_add_u32 s52, s52, s70
s_add_u32 s54, s54, s71
v_mfma_f32_16x16x32_bf16 v[212:215], a[64:67], v[196:199], v[212:215]
s_mov_b32 s89, s88
v_mfma_f32_16x16x32_bf16 v[216:219], a[104:107], v[128:131], v[216:219]
buffer_load_dwordx4 v9, s[8:11], s86 offen offset:1024 sc1 lds
v_mfma_f32_16x16x32_bf16 v[208:211], a[68:71], v[200:203], v[208:211]
v_mfma_f32_16x16x32_bf16 v[212:215], a[68:71], v[204:207], v[212:215]
v_mfma_f32_16x16x32_bf16 v[220:223], a[104:107], v[132:135], v[220:223]
buffer_load_dwordx4 v10, s[8:11], s86 offen offset:2048 sc1 lds
v_mfma_f32_16x16x32_bf16 v[216:219], a[108:111], v[136:139], v[216:219]
v_mfma_f32_16x16x32_bf16 v[220:223], a[108:111], v[140:143], v[220:223]
v_mfma_f32_16x16x32_bf16 v[216:219], a[112:115], v[144:147], v[216:219]
buffer_load_dwordx4 v11, s[8:11], s86 offen offset:3072 sc1 lds
v_mfma_f32_16x16x32_bf16 v[220:223], a[112:115], v[148:151], v[220:223]
v_mfma_f32_16x16x32_bf16 v[216:219], a[116:119], v[152:155], v[216:219]
s_add_u32 m0, s50, 4096
v_cvt_pk_bf16_f32 v48, v208, v209
v_mfma_f32_16x16x32_bf16 v[220:223], a[116:119], v[156:159], v[220:223]
buffer_load_dwordx4 v12, s[8:11], s86 offen offset:0 sc1 lds
v_mfma_f32_16x16x32_bf16 v[216:219], a[120:123], v[160:163], v[216:219]
v_cvt_pk_bf16_f32 v49, v210, v211
v_cvt_pk_bf16_f32 v50, v212, v213
v_mfma_f32_16x16x32_bf16 v[220:223], a[120:123], v[164:167], v[220:223]
v_cvt_pk_bf16_f32 v51, v214, v215
v_mfma_f32_16x16x32_bf16 v[216:219], a[124:127], v[168:171], v[216:219]
buffer_load_dwordx4 v13, s[8:11], s86 offen offset:1024 sc1 lds
v_mfma_f32_16x16x32_bf16 v[220:223], a[124:127], v[172:175], v[220:223]
v_permlane16_swap_b32 v48, v50
v_mfma_f32_16x16x32_bf16 v[216:219], a[128:131], v[176:179], v[216:219]
v_permlane16_swap_b32 v49, v51
v_mfma_f32_16x16x32_bf16 v[220:223], a[128:131], v[180:183], v[220:223]
buffer_load_dwordx4 v14, s[8:11], s86 offen offset:2048 sc1 lds
v_mfma_f32_16x16x32_bf16 v[216:219], a[132:135], v[184:187], v[216:219]
buffer_store_dwordx4 v[48:51], v19, s[4:7], s81 offen sc1
v_mfma_f32_16x16x32_bf16 v[220:223], a[132:135], v[188:191], v[220:223]
v_mfma_f32_16x16x32_bf16 v[216:219], a[136:139], v[192:195], v[216:219]
buffer_load_dwordx4 v15, s[8:11], s86 offen offset:3072 sc1 lds
v_mfma_f32_16x16x32_bf16 v[220:223], a[136:139], v[196:199], v[220:223]
v_mfma_f32_16x16x32_bf16 v[216:219], a[140:143], v[200:203], v[216:219]
s_add_u32 m0, s50, 8192
v_mfma_f32_16x16x32_bf16 v[220:223], a[140:143], v[204:207], v[220:223]
buffer_load_dwordx4 v16, s[8:11], s86 offen offset:0 sc1 lds
v_mfma_f32_16x16x32_bf16 v[224:227], a[144:147], v[64:67], 0
v_mfma_f32_16x16x32_bf16 v[228:231], a[144:147], v[68:71], 0
v_mfma_f32_16x16x32_bf16 v[224:227], a[148:151], v[72:75], v[224:227]
v_mfma_f32_16x16x32_bf16 v[228:231], a[148:151], v[76:79], v[228:231]
v_mfma_f32_16x16x32_bf16 v[224:227], a[152:155], v[80:83], v[224:227]
buffer_load_dword v24, v22, s[4:7], 0 offen sc1
v_mfma_f32_16x16x32_bf16 v[228:231], a[152:155], v[84:87], v[228:231]
v_cvt_pk_bf16_f32 v52, v216, v217
v_cvt_pk_bf16_f32 v53, v218, v219
v_mfma_f32_16x16x32_bf16 v[224:227], a[156:159], v[88:91], v[224:227]
s_waitcnt vmcnt(11)
s_barrier
v_mfma_f32_16x16x32_bf16 v[228:231], a[156:159], v[92:95], v[228:231]
buffer_store_dword v27, v45, s[4:7], s73 offen
v_mfma_f32_16x16x32_bf16 v[224:227], a[160:163], v[96:99], v[224:227]
buffer_store_dword v27, v44, s[4:7], s73 offen sc1
v_mfma_f32_16x16x32_bf16 v[228:231], a[160:163], v[100:103], v[228:231]
v_cvt_pk_bf16_f32 v54, v220, v221
v_cvt_pk_bf16_f32 v55, v222, v223
v_mfma_f32_16x16x32_bf16 v[224:227], a[164:167], v[104:107], v[224:227]
v_permlane16_swap_b32 v52, v54
v_mfma_f32_16x16x32_bf16 v[228:231], a[164:167], v[108:111], v[228:231]
v_permlane16_swap_b32 v53, v55
v_mfma_f32_16x16x32_bf16 v[224:227], a[168:171], v[112:115], v[224:227]
buffer_store_dwordx4 v[52:55], v20, s[4:7], s81 offen sc1
v_mfma_f32_16x16x32_bf16 v[228:231], a[168:171], v[116:119], v[228:231]
v_mfma_f32_16x16x32_bf16 v[224:227], a[172:175], v[120:123], v[224:227]
v_mfma_f32_16x16x32_bf16 v[228:231], a[172:175], v[124:127], v[228:231]
v_mfma_f32_16x16x32_bf16 v[224:227], a[176:179], v[128:131], v[224:227]
v_mfma_f32_16x16x32_bf16 v[228:231], a[176:179], v[132:135], v[228:231]
v_mfma_f32_16x16x32_bf16 v[224:227], a[180:183], v[136:139], v[224:227]
v_mfma_f32_16x16x32_bf16 v[228:231], a[180:183], v[140:143], v[228:231]
v_mfma_f32_16x16x32_bf16 v[224:227], a[184:187], v[144:147], v[224:227]
v_mfma_f32_16x16x32_bf16 v[228:231], a[184:187], v[148:151], v[228:231]
v_mfma_f32_16x16x32_bf16 v[224:227], a[188:191], v[152:155], v[224:227]
v_mfma_f32_16x16x32_bf16 v[228:231], a[188:191], v[156:159], v[228:231]
v_mfma_f32_16x16x32_bf16 v[224:227], a[192:195], v[160:163], v[224:227]
s_waitcnt vmcnt(12)
s_barrier
v_mfma_f32_16x16x32_bf16 v[228:231], a[192:195], v[164:167], v[228:231]
v_mfma_f32_16x16x32_bf16 v[224:227], a[196:199], v[168:171], v[224:227]
s_cmp_eq_u32 s88, 0
s_cbranch_scc1 g_slow_93
v_mfma_f32_16x16x32_bf16 v[228:231], a[196:199], v[172:175], v[228:231]
ds_read_b128 v[64:67], v30 offset:0
v_mfma_f32_16x16x32_bf16 v[224:227], a[200:203], v[176:179], v[224:227]
ds_read_b128 v[68:71], v30 offset:9216
v_mfma_f32_16x16x32_bf16 v[228:231], a[200:203], v[180:183], v[228:231]
ds_read_b128 v[72:75], v30 offset:18432
v_mfma_f32_16x16x32_bf16 v[224:227], a[204:207], v[184:187], v[224:227]
ds_read_b128 v[76:79], v30 offset:27648
v_mfma_f32_16x16x32_bf16 v[228:231], a[204:207], v[188:191], v[228:231]
ds_read_b128 v[80:83], v30 offset:1024
v_mfma_f32_16x16x32_bf16 v[224:227], a[208:211], v[192:195], v[224:227]
ds_read_b128 v[84:87], v30 offset:10240
v_mfma_f32_16x16x32_bf16 v[228:231], a[208:211], v[196:199], v[228:231]
ds_read_b128 v[88:91], v30 offset:19456
v_mfma_f32_16x16x32_bf16 v[224:227], a[212:215], v[200:203], v[224:227]
ds_read_b128 v[92:95], v30 offset:28672
v_mfma_f32_16x16x32_bf16 v[228:231], a[212:215], v[204:207], v[228:231]
s_waitcnt vmcnt(9)
s_barrier
g_body_82:
s_waitcnt lgkmcnt(4)
v_mfma_f32_16x16x32_bf16 v[208:211], a[0:3], v[64:67], 0
ds_read_b128 v[96:99], v30 offset:2048
v_mfma_f32_16x16x32_bf16 v[212:215], a[0:3], v[68:71], 0
ds_read_b128 v[100:103], v30 offset:11264
v_mfma_f32_16x16x32_bf16 v[216:219], a[72:75], v[64:67], 0
v_mfma_f32_16x16x32_bf16 v[208:211], a[4:7], v[72:75], v[208:211]
ds_read_b128 v[104:107], v30 offset:20480
v_cvt_pk_bf16_f32 v56, v224, v225
v_mfma_f32_16x16x32_bf16 v[212:215], a[4:7], v[76:79], v[212:215]
ds_read_b128 v[108:111], v30 offset:29696
v_cvt_pk_bf16_f32 v57, v226, v227
v_mfma_f32_16x16x32_bf16 v[220:223], a[72:75], v[68:71], 0
v_cvt_pk_bf16_f32 v58, v228, v229
s_waitcnt lgkmcnt(4)
v_mfma_f32_16x16x32_bf16 v[208:211], a[8:11], v[80:83], v[208:211]
ds_read_b128 v[112:115], v30 offset:3072
v_cvt_pk_bf16_f32 v59, v230, v231
v_mfma_f32_16x16x32_bf16 v[212:215], a[8:11], v[84:87], v[212:215]
ds_read_b128 v[116:119], v30 offset:12288
v_permlane16_swap_b32 v56, v58
v_mfma_f32_16x16x32_bf16 v[216:219], a[76:79], v[72:75], v[216:219]
v_permlane16_swap_b32 v57, v59
v_mfma_f32_16x16x32_bf16 v[208:211], a[12:15], v[88:91], v[208:211]
ds_read_b128 v[120:123], v30 offset:21504
v_mfma_f32_16x16x32_bf16 v[212:215], a[12:15], v[92:95], v[212:215]
ds_read_b128 v[124:127], v30 offset:30720
v_mfma_f32_16x16x32_bf16 v[220:223], a[76:79], v[76:79], v[220:223]
s_waitcnt lgkmcnt(4)
v_mfma_f32_16x16x32_bf16 v[208:211], a[16:19], v[96:99], v[208:211]
ds_read_b128 v[128:131], v30 offset:4096
v_mfma_f32_16x16x32_bf16 v[212:215], a[16:19], v[100:103], v[212:215]
ds_read_b128 v[132:135], v30 offset:13312
v_mfma_f32_16x16x32_bf16 v[216:219], a[80:83], v[80:83], v[216:219]
buffer_store_dwordx4 v[56:59], v21, s[4:7], s81 offen sc1
v_mfma_f32_16x16x32_bf16 v[208:211], a[20:23], v[104:107], v[208:211]
ds_read_b128 v[136:139], v30 offset:22528
v_mfma_f32_16x16x32_bf16 v[212:215], a[20:23], v[108:111], v[212:215]
ds_read_b128 v[140:143], v30 offset:31744
v_mfma_f32_16x16x32_bf16 v[220:223], a[80:83], v[84:87], v[220:223]
s_waitcnt vmcnt(5)
s_barrier
s_waitcnt lgkmcnt(4)
v_mfma_f32_16x16x32_bf16 v[208:211], a[24:27], v[112:115], v[208:211]
ds_read_b128 v[144:147], v30 offset:5120
v_mov_b32 v27, s78
v_mfma_f32_16x16x32_bf16 v[212:215], a[24:27], v[116:119], v[212:215]
ds_read_b128 v[148:151], v30 offset:14336
v_mfma_f32_16x16x32_bf16 v[216:219], a[84:87], v[88:91], v[216:219]
v_mfma_f32_16x16x32_bf16 v[208:211], a[28:31], v[120:123], v[208:211]
ds_read_b128 v[152:155], v30 offset:23552
v_mfma_f32_16x16x32_bf16 v[212:215], a[28:31], v[124:127], v[212:215]
ds_read_b128 v[156:159], v30 offset:32768
v_mfma_f32_16x16x32_bf16 v[220:223], a[84:87], v[92:95], v[220:223]
s_waitcnt lgkmcnt(4)
v_mfma_f32_16x16x32_bf16 v[208:211], a[32:35], v[128:131], v[208:211]
ds_read_b128 v[160:163], v30 offset:6144
v_mfma_f32_16x16x32_bf16 v[212:215], a[32:35], v[132:135], v[212:215]
ds_read_b128 v[164:167], v30 offset:15360
v_mfma_f32_16x16x32_bf16 v[216:219], a[88:91], v[96:99], v[216:219]
v_mfma_f32_16x16x32_bf16 v[208:211], a[36:39], v[136:139], v[208:211]
ds_read_b128 v[168:171], v30 offset:24576
v_mfma_f32_16x16x32_bf16 v[212:215], a[36:39], v[140:143], v[212:215]
ds_read_b128 v[172:175], v30 offset:33792
v_mfma_f32_16x16x32_bf16 v[220:223], a[88:91], v[100:103], v[220:223]
s_waitcnt lgkmcnt(4)
v_mfma_f32_16x16x32_bf16 v[208:211], a[40:43], v[144:147], v[208:211]
ds_read_b128 v[176:179], v30 offset:7168
v_mfma_f32_16x16x32_bf16 v[212:215], a[40:43], v[148:151], v[212:215]
ds_read_b128 v[180:183], v30 offset:16384
s_waitcnt vmcnt(4)
ds_write_b32 v18, v24
v_mfma_f32_16x16x32_bf16 v[216:219], a[92:95], v[104:107], v[216:219]
v_mfma_f32_16x16x32_bf16 v[208:211], a[44:47], v[152:155], v[208:211]
ds_read_b128 v[184:187], v30 offset:25600
v_mfma_f32_16x16x32_bf16 v[212:215], a[44:47], v[156:159], v[212:215]
ds_read_b128 v[188:191], v30 offset:34816
s_waitcnt lgkmcnt(2)
s_barrier
v_mfma_f32_16x16x32_bf16 v[220:223], a[92:95], v[108:111], v[220:223]
ds_read_b32 v33, v32
v_mfma_f32_16x16x32_bf16 v[208:211], a[48:51], v[160:163], v[208:211]
ds_read_b128 v[192:195], v30 offset:8192
v_mfma_f32_16x16x32_bf16 v[212:215], a[48:51], v[164:167], v[212:215]
ds_read_b128 v[196:199], v30 offset:17408
v_mfma_f32_16x16x32_bf16 v[216:219], a[96:99], v[112:115], v[216:219]
s_waitcnt lgkmcnt(2)
v_cmp_gt_u32 vcc, s52, v33
v_mfma_f32_16x16x32_bf16 v[208:211], a[52:55], v[168:171], v[208:211]
ds_read_b128 v[200:203], v30 offset:26624
v_cmp_gt_u32 s[58:59], s54, v33
v_mfma_f32_16x16x32_bf16 v[212:215], a[52:55], v[172:175], v[212:215]
ds_read_b128 v[204:207], v30 offset:35840
s_and_b32 vcc_lo, vcc_lo, s56
s_cselect_b32 s70, 0, 1
v_mfma_f32_16x16x32_bf16 v[220:223], a[96:99], v[116:119], v[220:223]
v_mfma_f32_16x16x32_bf16 v[208:211], a[56:59], v[176:179], v[208:211]
s_and_b32 s59, s59, s56
s_cselect_b32 s71, 0, s89
v_mfma_f32_16x16x32_bf16 v[212:215], a[56:59], v[180:183], v[212:215]
s_or_b32 s94, s70, s71
s_cselect_b32 s10, 268435456, 0
v_mfma_f32_16x16x32_bf16 v[216:219], a[100:103], v[120:123], v[216:219]
s_cmp_lg_u32 s70, 0
s_cselect_b64 s[90:91], s[52:53], s[54:55]
s_cselect_b64 s[58:59], s[44:45], s[46:47]
v_mfma_f32_16x16x32_bf16 v[208:211], a[60:63], v[184:187], v[208:211]
s_mul_i32 s92, s90, s20
s_add_u32 s92, s92, s58
v_mfma_f32_16x16x32_bf16 v[212:215], a[60:63], v[188:191], v[212:215]
s_add_u32 m0, s51, 0
s_mul_i32 s93, s90, s21
s_add_u32 s93, s93, s59
v_mfma_f32_16x16x32_bf16 v[220:223], a[100:103], v[124:127], v[220:223]
buffer_load_dwordx4 v8, s[8:11], s92 offen offset:0 sc1 lds
s_waitcnt lgkmcnt(0)
v_mfma_f32_16x16x32_bf16 v[208:211], a[64:67], v[192:195], v[208:211]
s_andn2_b32 s71, s71, s70
s_add_u32 s52, s52, s70
s_add_u32 s54, s54, s71
v_mfma_f32_16x16x32_bf16 v[212:215], a[64:67], v[196:199], v[212:215]
s_mov_b32 s95, s94
v_mfma_f32_16x16x32_bf16 v[216:219], a[104:107], v[128:131], v[216:219]
buffer_load_dwordx4 v9, s[8:11], s92 offen offset:1024 sc1 lds
v_mfma_f32_16x16x32_bf16 v[208:211], a[68:71], v[200:203], v[208:211]
v_mfma_f32_16x16x32_bf16 v[212:215], a[68:71], v[204:207], v[212:215]
v_mfma_f32_16x16x32_bf16 v[220:223], a[104:107], v[132:135], v[220:223]
buffer_load_dwordx4 v10, s[8:11], s92 offen offset:2048 sc1 lds
v_mfma_f32_16x16x32_bf16 v[216:219], a[108:111], v[136:139], v[216:219]
v_mfma_f32_16x16x32_bf16 v[220:223], a[108:111], v[140:143], v[220:223]
v_mfma_f32_16x16x32_bf16 v[216:219], a[112:115], v[144:147], v[216:219]
buffer_load_dwordx4 v11, s[8:11], s92 offen offset:3072 sc1 lds
v_mfma_f32_16x16x32_bf16 v[220:223], a[112:115], v[148:151], v[220:223]
v_mfma_f32_16x16x32_bf16 v[216:219], a[116:119], v[152:155], v[216:219]
s_add_u32 m0, s51, 4096
v_cvt_pk_bf16_f32 v48, v208, v209
v_mfma_f32_16x16x32_bf16 v[220:223], a[116:119], v[156:159], v[220:223]
buffer_load_dwordx4 v12, s[8:11], s92 offen offset:0 sc1 lds
v_mfma_f32_16x16x32_bf16 v[216:219], a[120:123], v[160:163], v[216:219]
v_cvt_pk_bf16_f32 v49, v210, v211
v_cvt_pk_bf16_f32 v50, v212, v213
v_mfma_f32_16x16x32_bf16 v[220:223], a[120:123], v[164:167], v[220:223]
v_cvt_pk_bf16_f32 v51, v214, v215
v_mfma_f32_16x16x32_bf16 v[216:219], a[124:127], v[168:171], v[216:219]
buffer_load_dwordx4 v13, s[8:11], s92 offen offset:1024 sc1 lds
v_mfma_f32_16x16x32_bf16 v[220:223], a[124:127], v[172:175], v[220:223]
v_permlane16_swap_b32 v48, v50
v_mfma_f32_16x16x32_bf16 v[216:219], a[128:131], v[176:179], v[216:219]
v_permlane16_swap_b32 v49, v51
v_mfma_f32_16x16x32_bf16 v[220:223], a[128:131], v[180:183], v[220:223]
buffer_load_dwordx4 v14, s[8:11], s92 offen offset:2048 sc1 lds
v_mfma_f32_16x16x32_bf16 v[216:219], a[132:135], v[184:187], v[216:219]
buffer_store_dwordx4 v[48:51], v19, s[4:7], s87 offen sc1
v_mfma_f32_16x16x32_bf16 v[220:223], a[132:135], v[188:191], v[220:223]
v_mfma_f32_16x16x32_bf16 v[216:219], a[136:139], v[192:195], v[216:219]
buffer_load_dwordx4 v15, s[8:11], s92 offen offset:3072 sc1 lds
v_mfma_f32_16x16x32_bf16 v[220:223], a[136:139], v[196:199], v[220:223]
v_mfma_f32_16x16x32_bf16 v[216:219], a[140:143], v[200:203], v[216:219]
s_add_u32 m0, s51, 8192
v_mfma_f32_16x16x32_bf16 v[220:223], a[140:143], v[204:207], v[220:223]
buffer_load_dwordx4 v16, s[8:11], s92 offen offset:0 sc1 lds
v_mfma_f32_16x16x32_bf16 v[224:227], a[144:147], v[64:67], 0
v_mfma_f32_16x16x32_bf16 v[228:231], a[144:147], v[68:71], 0
v_mfma_f32_16x16x32_bf16 v[224:227], a[148:151], v[72:75], v[224:227]
v_mfma_f32_16x16x32_bf16 v[228:231], a[148:151], v[76:79], v[228:231]
v_mfma_f32_16x16x32_bf16 v[224:227], a[152:155], v[80:83], v[224:227]
buffer_load_dword v24, v22, s[4:7], 0 offen sc1
v_mfma_f32_16x16x32_bf16 v[228:231], a[152:155], v[84:87], v[228:231]
v_cvt_pk_bf16_f32 v52, v216, v217
v_cvt_pk_bf16_f32 v53, v218, v219
v_mfma_f32_16x16x32_bf16 v[224:227], a[156:159], v[88:91], v[224:227]
s_waitcnt vmcnt(11)
s_barrier
v_mfma_f32_16x16x32_bf16 v[228:231], a[156:159], v[92:95], v[228:231]
buffer_store_dword v27, v45, s[4:7], s79 offen
v_mfma_f32_16x16x32_bf16 v[224:227], a[160:163], v[96:99], v[224:227]
buffer_store_dword v27, v44, s[4:7], s79 offen sc1
v_mfma_f32_16x16x32_bf16 v[228:231], a[160:163], v[100:103], v[228:231]
v_cvt_pk_bf16_f32 v54, v220, v221
v_cvt_pk_bf16_f32 v55, v222, v223
v_mfma_f32_16x16x32_bf16 v[224:227], a[164:167], v[104:107], v[224:227]
v_permlane16_swap_b32 v52, v54
v_mfma_f32_16x16x32_bf16 v[228:231], a[164:167], v[108:111], v[228:231]
v_permlane16_swap_b32 v53, v55
v_mfma_f32_16x16x32_bf16 v[224:227], a[168:171], v[112:115], v[224:227]
buffer_store_dwordx4 v[52:55], v20, s[4:7], s87 offen sc1
v_mfma_f32_16x16x32_bf16 v[228:231], a[168:171], v[116:119], v[228:231]
v_mfma_f32_16x16x32_bf16 v[224:227], a[172:175], v[120:123], v[224:227]
v_mfma_f32_16x16x32_bf16 v[228:231], a[172:175], v[124:127], v[228:231]
v_mfma_f32_16x16x32_bf16 v[224:227], a[176:179], v[128:131], v[224:227]
v_mfma_f32_16x16x32_bf16 v[228:231], a[176:179], v[132:135], v[228:231]
v_mfma_f32_16x16x32_bf16 v[224:227], a[180:183], v[136:139], v[224:227]
v_mfma_f32_16x16x32_bf16 v[228:231], a[180:183], v[140:143], v[228:231]
v_mfma_f32_16x16x32_bf16 v[224:227], a[184:187], v[144:147], v[224:227]
v_mfma_f32_16x16x32_bf16 v[228:231], a[184:187], v[148:151], v[228:231]
v_mfma_f32_16x16x32_bf16 v[224:227], a[188:191], v[152:155], v[224:227]
v_mfma_f32_16x16x32_bf16 v[228:231], a[188:191], v[156:159], v[228:231]
v_mfma_f32_16x16x32_bf16 v[224:227], a[192:195], v[160:163], v[224:227]
s_waitcnt vmcnt(12)
s_barrier
v_mfma_f32_16x16x32_bf16 v[228:231], a[192:195], v[164:167], v[228:231]
v_mfma_f32_16x16x32_bf16 v[224:227], a[196:199], v[168:171], v[224:227]
s_cmp_eq_u32 s94, 0
s_cbranch_scc1 g_slow_94
v_mfma_f32_16x16x32_bf16 v[228:231], a[196:199], v[172:175], v[228:231]
ds_read_b128 v[64:67], v31 offset:0
v_mfma_f32_16x16x32_bf16 v[224:227], a[200:203], v[176:179], v[224:227]
ds_read_b128 v[68:71], v31 offset:9216
v_mfma_f32_16x16x32_bf16 v[228:231], a[200:203], v[180:183], v[228:231]
ds_read_b128 v[72:75], v31 offset:18432
v_mfma_f32_16x16x32_bf16 v[224:227], a[204:207], v[184:187], v[224:227]
ds_read_b128 v[76:79], v31 offset:27648
v_mfma_f32_16x16x32_bf16 v[228:231], a[204:207], v[188:191], v[228:231]
ds_read_b128 v[80:83], v31 offset:1024
v_mfma_f32_16x16x32_bf16 v[224:227], a[208:211], v[192:195], v[224:227]
ds_read_b128 v[84:87], v31 offset:10240
v_mfma_f32_16x16x32_bf16 v[228:231], a[208:211], v[196:199], v[228:231]
ds_read_b128 v[88:91], v31 offset:19456
v_mfma_f32_16x16x32_bf16 v[224:227], a[212:215], v[200:203], v[224:227]
ds_read_b128 v[92:95], v31 offset:28672
v_mfma_f32_16x16x32_bf16 v[228:231], a[212:215], v[204:207], v[228:231]
s_waitcnt vmcnt(9)
s_barrier
g_body_83:
s_waitcnt lgkmcnt(4)
v_mfma_f32_16x16x32_bf16 v[208:211], a[0:3], v[64:67], 0
ds_read_b128 v[96:99], v31 offset:2048
v_mfma_f32_16x16x32_bf16 v[212:215], a[0:3], v[68:71], 0
ds_read_b128 v[100:103], v31 offset:11264
v_mfma_f32_16x16x32_bf16 v[216:219], a[72:75], v[64:67], 0
v_mfma_f32_16x16x32_bf16 v[208:211], a[4:7], v[72:75], v[208:211]
ds_read_b128 v[104:107], v31 offset:20480
v_cvt_pk_bf16_f32 v56, v224, v225
v_mfma_f32_16x16x32_bf16 v[212:215], a[4:7], v[76:79], v[212:215]
ds_read_b128 v[108:111], v31 offset:29696
v_cvt_pk_bf16_f32 v57, v226, v227
v_mfma_f32_16x16x32_bf16 v[220:223], a[72:75], v[68:71], 0
v_cvt_pk_bf16_f32 v58, v228, v229
s_waitcnt lgkmcnt(4)
v_mfma_f32_16x16x32_bf16 v[208:211], a[8:11], v[80:83], v[208:211]
ds_read_b128 v[112:115], v31 offset:3072
v_cvt_pk_bf16_f32 v59, v230, v231
v_mfma_f32_16x16x32_bf16 v[212:215], a[8:11], v[84:87], v[212:215]
ds_read_b128 v[116:119], v31 offset:12288
v_permlane16_swap_b32 v56, v58
v_mfma_f32_16x16x32_bf16 v[216:219], a[76:79], v[72:75], v[216:219]
v_permlane16_swap_b32 v57, v59
v_mfma_f32_16x16x32_bf16 v[208:211], a[12:15], v[88:91], v[208:211]
ds_read_b128 v[120:123], v31 offset:21504
v_mfma_f32_16x16x32_bf16 v[212:215], a[12:15], v[92:95], v[212:215]
ds_read_b128 v[124:127], v31 offset:30720
v_mfma_f32_16x16x32_bf16 v[220:223], a[76:79], v[76:79], v[220:223]
s_waitcnt lgkmcnt(4)
v_mfma_f32_16x16x32_bf16 v[208:211], a[16:19], v[96:99], v[208:211]
ds_read_b128 v[128:131], v31 offset:4096
v_mfma_f32_16x16x32_bf16 v[212:215], a[16:19], v[100:103], v[212:215]
ds_read_b128 v[132:135], v31 offset:13312
v_mfma_f32_16x16x32_bf16 v[216:219], a[80:83], v[80:83], v[216:219]
buffer_store_dwordx4 v[56:59], v21, s[4:7], s87 offen sc1
v_mfma_f32_16x16x32_bf16 v[208:211], a[20:23], v[104:107], v[208:211]
ds_read_b128 v[136:139], v31 offset:22528
v_mfma_f32_16x16x32_bf16 v[212:215], a[20:23], v[108:111], v[212:215]
ds_read_b128 v[140:143], v31 offset:31744
v_mfma_f32_16x16x32_bf16 v[220:223], a[80:83], v[84:87], v[220:223]
s_waitcnt vmcnt(5)
s_barrier
s_waitcnt lgkmcnt(4)
v_mfma_f32_16x16x32_bf16 v[208:211], a[24:27], v[112:115], v[208:211]
ds_read_b128 v[144:147], v31 offset:5120
v_mov_b32 v27, s84
v_mfma_f32_16x16x32_bf16 v[212:215], a[24:27], v[116:119], v[212:215]
ds_read_b128 v[148:151], v31 offset:14336
v_mfma_f32_16x16x32_bf16 v[216:219], a[84:87], v[88:91], v[216:219]
v_mfma_f32_16x16x32_bf16 v[208:211], a[28:31], v[120:123], v[208:211]
ds_read_b128 v[152:155], v31 offset:23552
v_mfma_f32_16x16x32_bf16 v[212:215], a[28:31], v[124:127], v[212:215]
ds_read_b128 v[156:159], v31 offset:32768
v_mfma_f32_16x16x32_bf16 v[220:223], a[84:87], v[92:95], v[220:223]
s_waitcnt lgkmcnt(4)
v_mfma_f32_16x16x32_bf16 v[208:211], a[32:35], v[128:131], v[208:211]
ds_read_b128 v[160:163], v31 offset:6144
v_mfma_f32_16x16x32_bf16 v[212:215], a[32:35], v[132:135], v[212:215]
ds_read_b128 v[164:167], v31 offset:15360
v_mfma_f32_16x16x32_bf16 v[216:219], a[88:91], v[96:99], v[216:219]
v_mfma_f32_16x16x32_bf16 v[208:211], a[36:39], v[136:139], v[208:211]
ds_read_b128 v[168:171], v31 offset:24576
v_mfma_f32_16x16x32_bf16 v[212:215], a[36:39], v[140:143], v[212:215]
ds_read_b128 v[172:175], v31 offset:33792
v_mfma_f32_16x16x32_bf16 v[220:223], a[88:91], v[100:103], v[220:223]
s_waitcnt lgkmcnt(4)
v_mfma_f32_16x16x32_bf16 v[208:211], a[40:43], v[144:147], v[208:211]
ds_read_b128 v[176:179], v31 offset:7168
v_mfma_f32_16x16x32_bf16 v[212:215], a[40:43], v[148:151], v[212:215]
ds_read_b128 v[180:183], v31 offset:16384
s_waitcnt vmcnt(4)
ds_write_b32 v18, v24
v_mfma_f32_16x16x32_bf16 v[216:219], a[92:95], v[104:107], v[216:219]
v_mfma_f32_16x16x32_bf16 v[208:211], a[44:47], v[152:155], v[208:211]
ds_read_b128 v[184:187], v31 offset:25600
v_mfma_f32_16x16x32_bf16 v[212:215], a[44:47], v[156:159], v[212:215]
ds_read_b128 v[188:191], v31 offset:34816
s_waitcnt lgkmcnt(2)
s_barrier
v_mfma_f32_16x16x32_bf16 v[220:223], a[92:95], v[108:111], v[220:223]
ds_read_b32 v33, v32
v_mfma_f32_16x16x32_bf16 v[208:211], a[48:51], v[160:163], v[208:211]
ds_read_b128 v[192:195], v31 offset:8192
v_mfma_f32_16x16x32_bf16 v[212:215], a[48:51], v[164:167], v[212:215]
ds_read_b128 v[196:199], v31 offset:17408
v_mfma_f32_16x16x32_bf16 v[216:219], a[96:99], v[112:115], v[216:219]
s_waitcnt lgkmcnt(2)
v_cmp_gt_u32 vcc, s52, v33
v_mfma_f32_16x16x32_bf16 v[208:211], a[52:55], v[168:171], v[208:211]
ds_read_b128 v[200:203], v31 offset:26624
v_cmp_gt_u32 s[58:59], s54, v33
v_mfma_f32_16x16x32_bf16 v[212:215], a[52:55], v[172:175], v[212:215]
ds_read_b128 v[204:207], v31 offset:35840
s_and_b32 vcc_lo, vcc_lo, s56
s_cselect_b32 s70, 0, 1
v_mfma_f32_16x16x32_bf16 v[220:223], a[96:99], v[116:119], v[220:223]
v_mfma_f32_16x16x32_bf16 v[208:211], a[56:59], v[176:179], v[208:211]
s_and_b32 s59, s59, s56
s_cselect_b32 s71, 0, s95
v_mfma_f32_16x16x32_bf16 v[212:215], a[56:59], v[180:183], v[212:215]
s_or_b32 s76, s70, s71
s_cselect_b32 s10, 268435456, 0
v_mfma_f32_16x16x32_bf16 v[216:219], a[100:103], v[120:123], v[216:219]
s_cmp_lg_u32 s70, 0
s_cselect_b64 s[72:73], s[52:53], s[54:55]
s_cselect_b64 s[58:59], s[44:45], s[46:47]
v_mfma_f32_16x16x32_bf16 v[208:211], a[60:63], v[184:187], v[208:211]
s_mul_i32 s74, s72, s20
s_add_u32 s74, s74, s58
v_mfma_f32_16x16x32_bf16 v[212:215], a[60:63], v[188:191], v[212:215]
s_add_u32 m0, s48, 0
s_mul_i32 s75, s72, s21
s_add_u32 s75, s75, s59
v_mfma_f32_16x16x32_bf16 v[220:223], a[100:103], v[124:127], v[220:223]
buffer_load_dwordx4 v8, s[8:11], s74 offen offset:0 sc1 lds
s_waitcnt lgkmcnt(0)
v_mfma_f32_16x16x32_bf16 v[208:211], a[64:67], v[192:195], v[208:211]
s_andn2_b32 s71, s71, s70
s_add_u32 s52, s52, s70
s_add_u32 s54, s54, s71
v_mfma_f32_16x16x32_bf16 v[212:215], a[64:67], v[196:199], v[212:215]
s_mov_b32 s77, s76
v_mfma_f32_16x16x32_bf16 v[216:219], a[104:107], v[128:131], v[216:219]
buffer_load_dwordx4 v9, s[8:11], s74 offen offset:1024 sc1 lds
v_mfma_f32_16x16x32_bf16 v[208:211], a[68:71], v[200:203], v[208:211]
v_mfma_f32_16x16x32_bf16 v[212:215], a[68:71], v[204:207], v[212:215]
v_mfma_f32_16x16x32_bf16 v[220:223], a[104:107], v[132:135], v[220:223]
buffer_load_dwordx4 v10, s[8:11], s74 offen offset:2048 sc1 lds
v_mfma_f32_16x16x32_bf16 v[216:219], a[108:111], v[136:139], v[216:219]
v_mfma_f32_16x16x32_bf16 v[220:223], a[108:111], v[140:143], v[220:223]
v_mfma_f32_16x16x32_bf16 v[216:219], a[112:115], v[144:147], v[216:219]
buffer_load_dwordx4 v11, s[8:11], s74 offen offset:3072 sc1 lds
v_mfma_f32_16x16x32_bf16 v[220:223], a[112:115], v[148:151], v[220:223]
v_mfma_f32_16x16x32_bf16 v[216:219], a[116:119], v[152:155], v[216:219]
s_add_u32 m0, s48, 4096
v_cvt_pk_bf16_f32 v48, v208, v209
v_mfma_f32_16x16x32_bf16 v[220:223], a[116:119], v[156:159], v[220:223]
buffer_load_dwordx4 v12, s[8:11], s74 offen offset:0 sc1 lds
v_mfma_f32_16x16x32_bf16 v[216:219], a[120:123], v[160:163], v[216:219]
v_cvt_pk_bf16_f32 v49, v210, v211
v_cvt_pk_bf16_f32 v50, v212, v213
v_mfma_f32_16x16x32_bf16 v[220:223], a[120:123], v[164:167], v[220:223]
v_cvt_pk_bf16_f32 v51, v214, v215
v_mfma_f32_16x16x32_bf16 v[216:219], a[124:127], v[168:171], v[216:219]
buffer_load_dwordx4 v13, s[8:11], s74 offen offset:1024 sc1 lds
v_mfma_f32_16x16x32_bf16 v[220:223], a[124:127], v[172:175], v[220:223]
v_permlane16_swap_b32 v48, v50
v_mfma_f32_16x16x32_bf16 v[216:219], a[128:131], v[176:179], v[216:219]
v_permlane16_swap_b32 v49, v51
v_mfma_f32_16x16x32_bf16 v[220:223], a[128:131], v[180:183], v[220:223]
buffer_load_dwordx4 v14, s[8:11], s74 offen offset:2048 sc1 lds
v_mfma_f32_16x16x32_bf16 v[216:219], a[132:135], v[184:187], v[216:219]
buffer_store_dwordx4 v[48:51], v19, s[4:7], s93 offen sc1
v_mfma_f32_16x16x32_bf16 v[220:223], a[132:135], v[188:191], v[220:223]
v_mfma_f32_16x16x32_bf16 v[216:219], a[136:139], v[192:195], v[216:219]
buffer_load_dwordx4 v15, s[8:11], s74 offen offset:3072 sc1 lds
v_mfma_f32_16x16x32_bf16 v[220:223], a[136:139], v[196:199], v[220:223]
v_mfma_f32_16x16x32_bf16 v[216:219], a[140:143], v[200:203], v[216:219]
s_add_u32 m0, s48, 8192
v_mfma_f32_16x16x32_bf16 v[220:223], a[140:143], v[204:207], v[220:223]
buffer_load_dwordx4 v16, s[8:11], s74 offen offset:0 sc1 lds
v_mfma_f32_16x16x32_bf16 v[224:227], a[144:147], v[64:67], 0
v_mfma_f32_16x16x32_bf16 v[228:231], a[144:147], v[68:71], 0
v_mfma_f32_16x16x32_bf16 v[224:227], a[148:151], v[72:75], v[224:227]
v_mfma_f32_16x16x32_bf16 v[228:231], a[148:151], v[76:79], v[228:231]
v_mfma_f32_16x16x32_bf16 v[224:227], a[152:155], v[80:83], v[224:227]
buffer_load_dword v24, v22, s[4:7], 0 offen sc1
v_mfma_f32_16x16x32_bf16 v[228:231], a[152:155], v[84:87], v[228:231]
v_cvt_pk_bf16_f32 v52, v216, v217
v_cvt_pk_bf16_f32 v53, v218, v219
v_mfma_f32_16x16x32_bf16 v[224:227], a[156:159], v[88:91], v[224:227]
s_waitcnt vmcnt(11)
s_barrier
v_mfma_f32_16x16x32_bf16 v[228:231], a[156:159], v[92:95], v[228:231]
buffer_store_dword v27, v45, s[4:7], s85 offen
v_mfma_f32_16x16x32_bf16 v[224:227], a[160:163], v[96:99], v[224:227]
buffer_store_dword v27, v44, s[4:7], s85 offen sc1
v_mfma_f32_16x16x32_bf16 v[228:231], a[160:163], v[100:103], v[228:231]
v_cvt_pk_bf16_f32 v54, v220, v221
v_cvt_pk_bf16_f32 v55, v222, v223
v_mfma_f32_16x16x32_bf16 v[224:227], a[164:167], v[104:107], v[224:227]
v_permlane16_swap_b32 v52, v54
v_mfma_f32_16x16x32_bf16 v[228:231], a[164:167], v[108:111], v[228:231]
v_permlane16_swap_b32 v53, v55
v_mfma_f32_16x16x32_bf16 v[224:227], a[168:171], v[112:115], v[224:227]
buffer_store_dwordx4 v[52:55], v20, s[4:7], s93 offen sc1
v_mfma_f32_16x16x32_bf16 v[228:231], a[168:171], v[116:119], v[228:231]
v_mfma_f32_16x16x32_bf16 v[224:227], a[172:175], v[120:123], v[224:227]
v_mfma_f32_16x16x32_bf16 v[228:231], a[172:175], v[124:127], v[228:231]
v_mfma_f32_16x16x32_bf16 v[224:227], a[176:179], v[128:131], v[224:227]
v_mfma_f32_16x16x32_bf16 v[228:231], a[176:179], v[132:135], v[228:231]
v_mfma_f32_16x16x32_bf16 v[224:227], a[180:183], v[136:139], v[224:227]
v_mfma_f32_16x16x32_bf16 v[228:231], a[180:183], v[140:143], v[228:231]
v_mfma_f32_16x16x32_bf16 v[224:227], a[184:187], v[144:147], v[224:227]
v_mfma_f32_16x16x32_bf16 v[228:231], a[184:187], v[148:151], v[228:231]
v_mfma_f32_16x16x32_bf16 v[224:227], a[188:191], v[152:155], v[224:227]
v_mfma_f32_16x16x32_bf16 v[228:231], a[188:191], v[156:159], v[228:231]
v_mfma_f32_16x16x32_bf16 v[224:227], a[192:195], v[160:163], v[224:227]
s_waitcnt vmcnt(12)
s_barrier
v_mfma_f32_16x16x32_bf16 v[228:231], a[192:195], v[164:167], v[228:231]
v_mfma_f32_16x16x32_bf16 v[224:227], a[196:199], v[168:171], v[224:227]
s_cmp_eq_u32 s76, 0
s_cbranch_scc1 g_slow_95
v_mfma_f32_16x16x32_bf16 v[228:231], a[196:199], v[172:175], v[228:231]
ds_read_b128 v[64:67], v28 offset:0
v_mfma_f32_16x16x32_bf16 v[224:227], a[200:203], v[176:179], v[224:227]
ds_read_b128 v[68:71], v28 offset:9216
v_mfma_f32_16x16x32_bf16 v[228:231], a[200:203], v[180:183], v[228:231]
ds_read_b128 v[72:75], v28 offset:18432
v_mfma_f32_16x16x32_bf16 v[224:227], a[204:207], v[184:187], v[224:227]
ds_read_b128 v[76:79], v28 offset:27648
v_mfma_f32_16x16x32_bf16 v[228:231], a[204:207], v[188:191], v[228:231]
ds_read_b128 v[80:83], v28 offset:1024
v_mfma_f32_16x16x32_bf16 v[224:227], a[208:211], v[192:195], v[224:227]
ds_read_b128 v[84:87], v28 offset:10240
v_mfma_f32_16x16x32_bf16 v[228:231], a[208:211], v[196:199], v[228:231]
ds_read_b128 v[88:91], v28 offset:19456
v_mfma_f32_16x16x32_bf16 v[224:227], a[212:215], v[200:203], v[224:227]
ds_read_b128 v[92:95], v28 offset:28672
v_mfma_f32_16x16x32_bf16 v[228:231], a[212:215], v[204:207], v[228:231]
s_waitcnt vmcnt(9)
s_barrier
s_branch g_body_80
g_slow_92:
v_mfma_f32_16x16x32_bf16 v[228:231], a[196:199], v[172:175], v[228:231]
v_mfma_f32_16x16x32_bf16 v[224:227], a[200:203], v[176:179], v[224:227]
v_mfma_f32_16x16x32_bf16 v[228:231], a[200:203], v[180:183], v[228:231]
v_mfma_f32_16x16x32_bf16 v[224:227], a[204:207], v[184:187], v[224:227]
v_mfma_f32_16x16x32_bf16 v[228:231], a[204:207], v[188:191], v[228:231]
v_mfma_f32_16x16x32_bf16 v[224:227], a[208:211], v[192:195], v[224:227]
v_mfma_f32_16x16x32_bf16 v[228:231], a[208:211], v[196:199], v[228:231]
v_mfma_f32_16x16x32_bf16 v[224:227], a[212:215], v[200:203], v[224:227]
v_mfma_f32_16x16x32_bf16 v[228:231], a[212:215], v[204:207], v[228:231]
s_nop 6
v_cvt_pk_bf16_f32 v56, v224, v225
v_cvt_pk_bf16_f32 v57, v226, v227
v_cvt_pk_bf16_f32 v58, v228, v229
v_cvt_pk_bf16_f32 v59, v230, v231
s_nop 0
v_permlane16_swap_b32 v56, v58
v_permlane16_swap_b32 v57, v59
buffer_store_dwordx4 v[56:59], v21, s[4:7], s75 offen sc1
s_mov_b32 s75, 1879048192
s_waitcnt vmcnt(4)
ds_write_b32 v18, v24
s_waitcnt lgkmcnt(0)
s_barrier
ds_read_b32 v33, v32
s_waitcnt lgkmcnt(0)
v_cmp_gt_u32 vcc, s52, v33
v_cmp_gt_u32 s[58:59], s54, v33
s_and_b32 vcc_lo, vcc_lo, s56
s_cselect_b32 s70, 0, 1
s_and_b32 s59, s59, s56
s_cselect_b32 s71, 0, s77
s_or_b32 s82, s70, s71
s_cselect_b32 s10, 268435456, 0
s_cmp_lg_u32 s70, 0
s_cselect_b64 s[78:79], s[52:53], s[54:55]
s_cselect_b64 s[58:59], s[44:45], s[46:47]
s_mul_i32 s80, s78, s20
s_add_u32 s80, s80, s58
s_mul_i32 s81, s78, s21
s_add_u32 s81, s81, s59
s_andn2_b32 s71, s71, s70
s_add_u32 s52, s52, s70
s_add_u32 s54, s54, s71
s_mov_b32 s83, s82
s_cmp_lg_u32 s82, 0
s_cbranch_scc1 g_go_96
v_mov_b32 v27, s72
s_waitcnt vmcnt(0)
s_barrier
s_add_u32 s70, s52, s54
s_cmp_eq_u32 s70, 130
s_cbranch_scc1 g_fin_84
s_cmp_lg_u32 s3, 0
s_cbranch_scc1 sp_ok_98_j
s_mov_b32 s23, 0
buffer_load_dword v33, v22, s[4:7], 0 offen sc1
buffer_store_dword v27, v45, s[4:7], s73 offen
buffer_store_dword v27, v44, s[4:7], s73 offen sc1
s_waitcnt vmcnt(2)
s_branch sp_loop_97_e
sp_loop_97:
buffer_load_dword v33, v22, s[4:7], 0 offen sc1
s_add_u32 s23, s23, 1
s_cmp_gt_u32 s23, 150000
s_cbranch_scc1 sp_bad_99
s_waitcnt vmcnt(0)
sp_loop_97_e:
v_cmp_gt_u32 vcc, s52, v33
v_cmp_gt_u32 s[58:59], s54, v33
s_and_b32 vcc_lo, vcc_lo, s56
s_cbranch_scc0 sp_ok_98
s_cmp_gt_u32 s23, 4
s_cselect_b32 s70, 0, s56
s_cmp_lg_u32 s77, 0
s_cselect_b32 s70, 0, s70
s_or_b32 s59, s59, s70
s_and_b32 s59, s59, s56
s_cbranch_scc0 sp_ok_98
s_sleep 1
s_branch sp_loop_97
sp_bad_99:
s_mov_b32 s98, 1027
s_branch L_fail
sp_ok_98:
ds_write_b32 v18, v33
s_waitcnt lgkmcnt(0)
sp_ok_98_j:
s_barrier
ds_read_b32 v33, v32
s_waitcnt lgkmcnt(0)
s_mov_b32 s73, 1879048192
v_cmp_gt_u32 vcc, s52, v33
v_cmp_gt_u32 s[58:59], s54, v33
s_and_b32 vcc_lo, vcc_lo, s56
s_cselect_b32 s70, 0, 1
s_and_b32 s59, s59, s56
s_cselect_b32 s71, 0, 1
s_or_b32 s82, s70, s71
s_cselect_b32 s10, 268435456, 0
s_cmp_lg_u32 s70, 0
s_cselect_b64 s[78:79], s[52:53], s[54:55]
s_cselect_b64 s[58:59], s[44:45], s[46:47]
s_mul_i32 s80, s78, s20
s_add_u32 s80, s80, s58
s_mul_i32 s81, s78, s21
s_add_u32 s81, s81, s59
s_andn2_b32 s71, s71, s70
s_add_u32 s52, s52, s70
s_add_u32 s54, s54, s71
s_mov_b32 s83, s82
g_go_96:
s_add_u32 m0, s49, 0
s_nop 0
buffer_load_dwordx4 v8, s[4:7], s80 offen offset:0 sc1 lds
buffer_load_dwordx4 v9, s[4:7], s80 offen offset:1024 sc1 lds
buffer_load_dwordx4 v10, s[4:7], s80 offen offset:2048 sc1 lds
buffer_load_dwordx4 v11, s[4:7], s80 offen offset:3072 sc1 lds
s_add_u32 m0, s49, 4096
s_nop 0
buffer_load_dwordx4 v12, s[4:7], s80 offen offset:0 sc1 lds
buffer_load_dwordx4 v13, s[4:7], s80 offen offset:1024 sc1 lds
buffer_load_dwordx4 v14, s[4:7], s80 offen offset:2048 sc1 lds
buffer_load_dwordx4 v15, s[4:7], s80 offen offset:3072 sc1 lds
s_add_u32 m0, s49, 8192
s_nop 0
buffer_load_dwordx4 v16, s[4:7], s80 offen offset:0 sc1 lds
buffer_load_dword v24, v22, s[4:7], 0 offen sc1
buffer_store_dword v27, v34, s[4:7], 0 offen
v_mov_b32 v27, s72
s_waitcnt vmcnt(9)
s_barrier
buffer_store_dword v27, v45, s[4:7], s73 offen
buffer_store_dword v27, v44, s[4:7], s73 offen sc1
s_mov_b32 s73, 1879048192
ds_read_b128 v[64:67], v29 offset:0
ds_read_b128 v[68:71], v29 offset:9216
ds_read_b128 v[72:75], v29 offset:18432
ds_read_b128 v[76:79], v29 offset:27648
ds_read_b128 v[80:83], v29 offset:1024
ds_read_b128 v[84:87], v29 offset:10240
ds_read_b128 v[88:91], v29 offset:19456
ds_read_b128 v[92:95], v29 offset:28672
s_waitcnt vmcnt(8)
s_barrier
s_branch g_body_81
g_slow_93:
v_mfma_f32_16x16x32_bf16 v[228:231], a[196:199], v[172:175], v[228:231]
v_mfma_f32_16x16x32_bf16 v[224:227], a[200:203], v[176:179], v[224:227]
v_mfma_f32_16x16x32_bf16 v[228:231], a[200:203], v[180:183], v[228:231]
v_mfma_f32_16x16x32_bf16 v[224:227], a[204:207], v[184:187], v[224:227]
v_mfma_f32_16x16x32_bf16 v[228:231], a[204:207], v[188:191], v[228:231]
v_mfma_f32_16x16x32_bf16 v[224:227], a[208:211], v[192:195], v[224:227]
v_mfma_f32_16x16x32_bf16 v[228:231], a[208:211], v[196:199], v[228:231]
v_mfma_f32_16x16x32_bf16 v[224:227], a[212:215], v[200:203], v[224:227]
v_mfma_f32_16x16x32_bf16 v[228:231], a[212:215], v[204:207], v[228:231]
s_nop 6
v_cvt_pk_bf16_f32 v56, v224, v225
v_cvt_pk_bf16_f32 v57, v226, v227
v_cvt_pk_bf16_f32 v58, v228, v229
v_cvt_pk_bf16_f32 v59, v230, v231
s_nop 0
v_permlane16_swap_b32 v56, v58
v_permlane16_swap_b32 v57, v59
buffer_store_dwordx4 v[56:59], v21, s[4:7], s81 offen sc1
s_mov_b32 s81, 1879048192
s_waitcnt vmcnt(4)
ds_write_b32 v18, v24
s_waitcnt lgkmcnt(0)
s_barrier
ds_read_b32 v33, v32
s_waitcnt lgkmcnt(0)
v_cmp_gt_u32 vcc, s52, v33
v_cmp_gt_u32 s[58:59], s54, v33
s_and_b32 vcc_lo, vcc_lo, s56
s_cselect_b32 s70, 0, 1
s_and_b32 s59, s59, s56
s_cselect_b32 s71, 0, s83
s_or_b32 s88, s70, s71
s_cselect_b32 s10, 268435456, 0
s_cmp_lg_u32 s70, 0
s_cselect_b64 s[84:85], s[52:53], s[54:55]
s_cselect_b64 s[58:59], s[44:45], s[46:47]
s_mul_i32 s86, s84, s20
s_add_u32 s86, s86, s58
s_mul_i32 s87, s84, s21
s_add_u32 s87, s87, s59
s_andn2_b32 s71, s71, s70
s_add_u32 s52, s52, s70
s_add_u32 s54, s54, s71
s_mov_b32 s89, s88
s_cmp_lg_u32 s88, 0
s_cbranch_scc1 g_go_100
v_mov_b32 v27, s78
s_waitcnt vmcnt(0)
s_barrier
s_add_u32 s70, s52, s54
s_cmp_eq_u32 s70, 130
s_cbranch_scc1 g_fin_84
s_cmp_lg_u32 s3, 0
s_cbranch_scc1 sp_ok_102_j
s_mov_b32 s23, 0
buffer_load_dword v33, v22, s[4:7], 0 offen sc1
buffer_store_dword v27, v45, s[4:7], s79 offen
buffer_store_dword v27, v44, s[4:7], s79 offen sc1
s_waitcnt vmcnt(2)
s_branch sp_loop_101_e
sp_loop_101:
buffer_load_dword v33, v22, s[4:7], 0 offen sc1
s_add_u32 s23, s23, 1
s_cmp_gt_u32 s23, 150000
s_cbranch_scc1 sp_bad_103
s_waitcnt vmcnt(0)
sp_loop_101_e:
v_cmp_gt_u32 vcc, s52, v33
v_cmp_gt_u32 s[58:59], s54, v33
s_and_b32 vcc_lo, vcc_lo, s56
s_cbranch_scc0 sp_ok_102
s_cmp_gt_u32 s23, 4
s_cselect_b32 s70, 0, s56
s_cmp_lg_u32 s83, 0
s_cselect_b32 s70, 0, s70
s_or_b32 s59, s59, s70
s_and_b32 s59, s59, s56
s_cbranch_scc0 sp_ok_102
s_sleep 1
s_branch sp_loop_101
sp_bad_103:
s_mov_b32 s98, 1027
s_branch L_fail
sp_ok_102:
ds_write_b32 v18, v33
s_waitcnt lgkmcnt(0)
sp_ok_102_j:
s_barrier
ds_read_b32 v33, v32
s_waitcnt lgkmcnt(0)
s_mov_b32 s79, 1879048192
v_cmp_gt_u32 vcc, s52, v33
v_cmp_gt_u32 s[58:59], s54, v33
s_and_b32 vcc_lo, vcc_lo, s56
s_cselect_b32 s70, 0, 1
s_and_b32 s59, s59, s56
s_cselect_b32 s71, 0, 1
s_or_b32 s88, s70, s71
s_cselect_b32 s10, 268435456, 0
s_cmp_lg_u32 s70, 0
s_cselect_b64 s[84:85], s[52:53], s[54:55]
s_cselect_b64 s[58:59], s[44:45], s[46:47]
s_mul_i32 s86, s84, s20
s_add_u32 s86, s86, s58
s_mul_i32 s87, s84, s21
s_add_u32 s87, s87, s59
s_andn2_b32 s71, s71, s70
s_add_u32 s52, s52, s70
s_add_u32 s54, s54, s71
s_mov_b32 s89, s88
g_go_100:
s_add_u32 m0, s50, 0
s_nop 0
buffer_load_dwordx4 v8, s[4:7], s86 offen offset:0 sc1 lds
buffer_load_dwordx4 v9, s[4:7], s86 offen offset:1024 sc1 lds
buffer_load_dwordx4 v10, s[4:7], s86 offen offset:2048 sc1 lds
buffer_load_dwordx4 v11, s[4:7], s86 offen offset:3072 sc1 lds
s_add_u32 m0, s50, 4096
s_nop 0
buffer_load_dwordx4 v12, s[4:7], s86 offen offset:0 sc1 lds
buffer_load_dwordx4 v13, s[4:7], s86 offen offset:1024 sc1 lds
buffer_load_dwordx4 v14, s[4:7], s86 offen offset:2048 sc1 lds
buffer_load_dwordx4 v15, s[4:7], s86 offen offset:3072 sc1 lds
s_add_u32 m0, s50, 8192
s_nop 0
buffer_load_dwordx4 v16, s[4:7], s86 offen offset:0 sc1 lds
buffer_load_dword v24, v22, s[4:7], 0 offen sc1
buffer_store_dword v27, v34, s[4:7], 0 offen
v_mov_b32 v27, s78
s_waitcnt vmcnt(9)
s_barrier
buffer_store_dword v27, v45, s[4:7], s79 offen
buffer_store_dword v27, v44, s[4:7], s79 offen sc1
s_mov_b32 s79, 1879048192
ds_read_b128 v[64:67], v30 offset:0
ds_read_b128 v[68:71], v30 offset:9216
ds_read_b128 v[72:75], v30 offset:18432
ds_read_b128 v[76:79], v30 offset:27648
ds_read_b128 v[80:83], v30 offset:1024
ds_read_b128 v[84:87], v30 offset:10240
ds_read_b128 v[88:91], v30 offset:19456
ds_read_b128 v[92:95], v30 offset:28672
s_waitcnt vmcnt(8)
s_barrier
s_branch g_body_82
g_slow_94:
v_mfma_f32_16x16x32_bf16 v[228:231], a[196:199], v[172:175], v[228:231]
v_mfma_f32_16x16x32_bf16 v[224:227], a[200:203], v[176:179], v[224:227]
v_mfma_f32_16x16x32_bf16 v[228:231], a[200:203], v[180:183], v[228:231]
v_mfma_f32_16x16x32_bf16 v[224:227], a[204:207], v[184:187], v[224:227]
v_mfma_f32_16x16x32_bf16 v[228:231], a[204:207], v[188:191], v[228:231]
v_mfma_f32_16x16x32_bf16 v[224:227], a[208:211], v[192:195], v[224:227]
v_mfma_f32_16x16x32_bf16 v[228:231], a[208:211], v[196:199], v[228:231]
v_mfma_f32_16x16x32_bf16 v[224:227], a[212:215], v[200:203], v[224:227]
v_mfma_f32_16x16x32_bf16 v[228:231], a[212:215], v[204:207], v[228:231]
s_nop 6
v_cvt_pk_bf16_f32 v56, v224, v225
v_cvt_pk_bf16_f32 v57, v226, v227
v_cvt_pk_bf16_f32 v58, v228, v229
v_cvt_pk_bf16_f32 v59, v230, v231
s_nop 0
v_permlane16_swap_b32 v56, v58
v_permlane16_swap_b32 v57, v59
buffer_store_dwordx4 v[56:59], v21, s[4:7], s87 offen sc1
s_mov_b32 s87, 1879048192
s_waitcnt vmcnt(4)
ds_write_b32 v18, v24
s_waitcnt lgkmcnt(0)
s_barrier
ds_read_b32 v33, v32
s_waitcnt lgkmcnt(0)
v_cmp_gt_u32 vcc, s52, v33
v_cmp_gt_u32 s[58:59], s54, v33
s_and_b32 vcc_lo, vcc_lo, s56
s_cselect_b32 s70, 0, 1
s_and_b32 s59, s59, s56
s_cselect_b32 s71, 0, s89
s_or_b32 s94, s70, s71
s_cselect_b32 s10, 268435456, 0
s_cmp_lg_u32 s70, 0
s_cselect_b64 s[90:91], s[52:53], s[54:55]
s_cselect_b64 s[58:59], s[44:45], s[46:47]
s_mul_i32 s92, s90, s20
s_add_u32 s92, s92, s58
s_mul_i32 s93, s90, s21
s_add_u32 s93, s93, s59
s_andn2_b32 s71, s71, s70
s_add_u32 s52, s52, s70
s_add_u32 s54, s54, s71
s_mov_b32 s95, s94
s_cmp_lg_u32 s94, 0
s_cbranch_scc1 g_go_104
v_mov_b32 v27, s84
s_waitcnt vmcnt(0)
s_barrier
s_add_u32 s70, s52, s54
s_cmp_eq_u32 s70, 130
s_cbranch_scc1 g_fin_84
s_cmp_lg_u32 s3, 0
s_cbranch_scc1 sp_ok_106_j
s_mov_b32 s23, 0
buffer_load_dword v33, v22, s[4:7], 0 offen sc1
buffer_store_dword v27, v45, s[4:7], s85 offen
buffer_store_dword v27, v44, s[4:7], s85 offen sc1
s_waitcnt vmcnt(2)
s_branch sp_loop_105_e
sp_loop_105:
buffer_load_dword v33, v22, s[4:7], 0 offen sc1
s_add_u32 s23, s23, 1
s_cmp_gt_u32 s23, 150000
s_cbranch_scc1 sp_bad_107
s_waitcnt vmcnt(0)
sp_loop_105_e:
v_cmp_gt_u32 vcc, s52, v33
v_cmp_gt_u32 s[58:59], s54, v33
s_and_b32 vcc_lo, vcc_lo, s56
s_cbranch_scc0 sp_ok_106
s_cmp_gt_u32 s23, 4
s_cselect_b32 s70, 0, s56
s_cmp_lg_u32 s89, 0
s_cselect_b32 s70, 0, s70
s_or_b32 s59, s59, s70
s_and_b32 s59, s59, s56
s_cbranch_scc0 sp_ok_106
s_sleep 1
s_branch sp_loop_105
sp_bad_107:
s_mov_b32 s98, 1027
s_branch L_fail
sp_ok_106:
ds_write_b32 v18, v33
s_waitcnt lgkmcnt(0)
sp_ok_106_j:
s_barrier
ds_read_b32 v33, v32
s_waitcnt lgkmcnt(0)
s_mov_b32 s85, 1879048192
v_cmp_gt_u32 vcc, s52, v33
v_cmp_gt_u32 s[58:59], s54, v33
s_and_b32 vcc_lo, vcc_lo, s56
s_cselect_b32 s70, 0, 1
s_and_b32 s59, s59, s56
s_cselect_b32 s71, 0, 1
s_or_b32 s94, s70, s71
s_cselect_b32 s10, 268435456, 0
s_cmp_lg_u32 s70, 0
s_cselect_b64 s[90:91], s[52:53], s[54:55]
s_cselect_b64 s[58:59], s[44:45], s[46:47]
s_mul_i32 s92, s90, s20
s_add_u32 s92, s92, s58
s_mul_i32 s93, s90, s21
s_add_u32 s93, s93, s59
s_andn2_b32 s71, s71, s70
s_add_u32 s52, s52, s70
s_add_u32 s54, s54, s71
s_mov_b32 s95, s94
g_go_104:
s_add_u32 m0, s51, 0
s_nop 0
buffer_load_dwordx4 v8, s[4:7], s92 offen offset:0 sc1 lds
buffer_load_dwordx4 v9, s[4:7], s92 offen offset:1024 sc1 lds
buffer_load_dwordx4 v10, s[4:7], s92 offen offset:2048 sc1 lds
buffer_load_dwordx4 v11, s[4:7], s92 offen offset:3072 sc1 lds
s_add_u32 m0, s51, 4096
s_nop 0
buffer_load_dwordx4 v12, s[4:7], s92 offen offset:0 sc1 lds
buffer_load_dwordx4 v13, s[4:7], s92 offen offset:1024 sc1 lds
buffer_load_dwordx4 v14, s[4:7], s92 offen offset:2048 sc1 lds
buffer_load_dwordx4 v15, s[4:7], s92 offen offset:3072 sc1 lds
s_add_u32 m0, s51, 8192
s_nop 0
buffer_load_dwordx4 v16, s[4:7], s92 offen offset:0 sc1 lds
buffer_load_dword v24, v22, s[4:7], 0 offen sc1
buffer_store_dword v27, v34, s[4:7], 0 offen
v_mov_b32 v27, s84
s_waitcnt vmcnt(9)
s_barrier
buffer_store_dword v27, v45, s[4:7], s85 offen
buffer_store_dword v27, v44, s[4:7], s85 offen sc1
s_mov_b32 s85, 1879048192
ds_read_b128 v[64:67], v31 offset:0
ds_read_b128 v[68:71], v31 offset:9216
ds_read_b128 v[72:75], v31 offset:18432
ds_read_b128 v[76:79], v31 offset:27648
ds_read_b128 v[80:83], v31 offset:1024
ds_read_b128 v[84:87], v31 offset:10240
ds_read_b128 v[88:91], v31 offset:19456
ds_read_b128 v[92:95], v31 offset:28672
s_waitcnt vmcnt(8)
s_barrier
s_branch g_body_83
g_slow_95:
v_mfma_f32_16x16x32_bf16 v[228:231], a[196:199], v[172:175], v[228:231]
v_mfma_f32_16x16x32_bf16 v[224:227], a[200:203], v[176:179], v[224:227]
v_mfma_f32_16x16x32_bf16 v[228:231], a[200:203], v[180:183], v[228:231]
v_mfma_f32_16x16x32_bf16 v[224:227], a[204:207], v[184:187], v[224:227]
v_mfma_f32_16x16x32_bf16 v[228:231], a[204:207], v[188:191], v[228:231]
v_mfma_f32_16x16x32_bf16 v[224:227], a[208:211], v[192:195], v[224:227]
v_mfma_f32_16x16x32_bf16 v[228:231], a[208:211], v[196:199], v[228:231]
v_mfma_f32_16x16x32_bf16 v[224:227], a[212:215], v[200:203], v[224:227]
v_mfma_f32_16x16x32_bf16 v[228:231], a[212:215], v[204:207], v[228:231]
s_nop 6
v_cvt_pk_bf16_f32 v56, v224, v225
v_cvt_pk_bf16_f32 v57, v226, v227
v_cvt_pk_bf16_f32 v58, v228, v229
v_cvt_pk_bf16_f32 v59, v230, v231
s_nop 0
v_permlane16_swap_b32 v56, v58
v_permlane16_swap_b32 v57, v59
buffer_store_dwordx4 v[56:59], v21, s[4:7], s93 offen sc1
s_mov_b32 s93, 1879048192
s_waitcnt vmcnt(4)
ds_write_b32 v18, v24
s_waitcnt lgkmcnt(0)
s_barrier
ds_read_b32 v33, v32
s_waitcnt lgkmcnt(0)
v_cmp_gt_u32 vcc, s52, v33
v_cmp_gt_u32 s[58:59], s54, v33
s_and_b32 vcc_lo, vcc_lo, s56
s_cselect_b32 s70, 0, 1
s_and_b32 s59, s59, s56
s_cselect_b32 s71, 0, s95
s_or_b32 s76, s70, s71
s_cselect_b32 s10, 268435456, 0
s_cmp_lg_u32 s70, 0
s_cselect_b64 s[72:73], s[52:53], s[54:55]
s_cselect_b64 s[58:59], s[44:45], s[46:47]
s_mul_i32 s74, s72, s20
s_add_u32 s74, s74, s58
s_mul_i32 s75, s72, s21
s_add_u32 s75, s75, s59
s_andn2_b32 s71, s71, s70
s_add_u32 s52, s52, s70
s_add_u32 s54, s54, s71
s_mov_b32 s77, s76
s_cmp_lg_u32 s76, 0
s_cbranch_scc1 g_go_108
v_mov_b32 v27, s90
s_waitcnt vmcnt(0)
s_barrier
s_add_u32 s70, s52, s54
s_cmp_eq_u32 s70, 130
s_cbranch_scc1 g_fin_84
s_cmp_lg_u32 s3, 0
s_cbranch_scc1 sp_ok_110_j
s_mov_b32 s23, 0
buffer_load_dword v33, v22, s[4:7], 0 offen sc1
buffer_store_dword v27, v45, s[4:7], s91 offen
buffer_store_dword v27, v44, s[4:7], s91 offen sc1
s_waitcnt vmcnt(2)
s_branch sp_loop_109_e
sp_loop_109:
buffer_load_dword v33, v22, s[4:7], 0 offen sc1
s_add_u32 s23, s23, 1
s_cmp_gt_u32 s23, 150000
s_cbranch_scc1 sp_bad_111
s_waitcnt vmcnt(0)
sp_loop_109_e:
v_cmp_gt_u32 vcc, s52, v33
v_cmp_gt_u32 s[58:59], s54, v33
s_and_b32 vcc_lo, vcc_lo, s56
s_cbranch_scc0 sp_ok_110
s_cmp_gt_u32 s23, 4
s_cselect_b32 s70, 0, s56
s_cmp_lg_u32 s95, 0
s_cselect_b32 s70, 0, s70
s_or_b32 s59, s59, s70
s_and_b32 s59, s59, s56
s_cbranch_scc0 sp_ok_110
s_sleep 1
s_branch sp_loop_109
sp_bad_111:
s_mov_b32 s98, 1027
s_branch L_fail
sp_ok_110:
ds_write_b32 v18, v33
s_waitcnt lgkmcnt(0)
sp_ok_110_j:
s_barrier
ds_read_b32 v33, v32
s_waitcnt lgkmcnt(0)
s_mov_b32 s91, 1879048192
v_cmp_gt_u32 vcc, s52, v33
v_cmp_gt_u32 s[58:59], s54, v33
s_and_b32 vcc_lo, vcc_lo, s56
s_cselect_b32 s70, 0, 1
s_and_b32 s59, s59, s56
s_cselect_b32 s71, 0, 1
s_or_b32 s76, s70, s71
s_cselect_b32 s10, 268435456, 0
s_cmp_lg_u32 s70, 0
s_cselect_b64 s[72:73], s[52:53], s[54:55]
s_cselect_b64 s[58:59], s[44:45], s[46:47]
s_mul_i32 s74, s72, s20
s_add_u32 s74, s74, s58
s_mul_i32 s75, s72, s21
s_add_u32 s75, s75, s59
s_andn2_b32 s71, s71, s70
s_add_u32 s52, s52, s70
s_add_u32 s54, s54, s71
s_mov_b32 s77, s76
g_go_108:
s_add_u32 m0, s48, 0
s_nop 0
buffer_load_dwordx4 v8, s[4:7], s74 offen offset:0 sc1 lds
buffer_load_dwordx4 v9, s[4:7], s74 offen offset:1024 sc1 lds
buffer_load_dwordx4 v10, s[4:7], s74 offen offset:2048 sc1 lds
buffer_load_dwordx4 v11, s[4:7], s74 offen offset:3072 sc1 lds
s_add_u32 m0, s48, 4096
s_nop 0
buffer_load_dwordx4 v12, s[4:7], s74 offen offset:0 sc1 lds
buffer_load_dwordx4 v13, s[4:7], s74 offen offset:1024 sc1 lds
buffer_load_dwordx4 v14, s[4:7], s74 offen offset:2048 sc1 lds
buffer_load_dwordx4 v15, s[4:7], s74 offen offset:3072 sc1 lds
s_add_u32 m0, s48, 8192
s_nop 0
buffer_load_dwordx4 v16, s[4:7], s74 offen offset:0 sc1 lds
buffer_load_dword v24, v22, s[4:7], 0 offen sc1
buffer_store_dword v27, v34, s[4:7], 0 offen
v_mov_b32 v27, s90
s_waitcnt vmcnt(9)
s_barrier
buffer_store_dword v27, v45, s[4:7], s91 offen
buffer_store_dword v27, v44, s[4:7], s91 offen sc1
s_mov_b32 s91, 1879048192
ds_read_b128 v[64:67], v28 offset:0
ds_read_b128 v[68:71], v28 offset:9216
ds_read_b128 v[72:75], v28 offset:18432
ds_read_b128 v[76:79], v28 offset:27648
ds_read_b128 v[80:83], v28 offset:1024
ds_read_b128 v[84:87], v28 offset:10240
ds_read_b128 v[88:91], v28 offset:19456
ds_read_b128 v[92:95], v28 offset:28672
s_waitcnt vmcnt(8)
s_barrier
s_branch g_body_80
g_fin_84:
buffer_store_dword v27, v45, s[4:7], s91 offen
buffer_store_dword v27, v44, s[4:7], s91 offen sc1
s_endpgm
H_dn:
s_mul_i32 s75, s74, 43
s_lshr_b32 s75, s75, 7
s_mul_i32 s76, s75, 3
s_sub_u32 s76, s74, s76
s_mov_b32 s8, s36
s_and_b32 s9, s37, 0xffff
s_mov_b32 s10, 5308416
s_mov_b32 s11, 0x20000
s_mul_i32 s77, s76, 12
s_mul_i32 s78, s3, 3
s_add_u32 s77, s77, s78
s_mul_i32 s78, s75, 663552
v_bfe_u32 v1, v0, 4, 1
v_bfe_u32 v2, v0, 1, 3
v_lshl_add_u32 v1, v1, 3, v2
v_mul_u32_u24 v1, 2304, v1
v_lshrrev_b32 v2, 5, v0
v_lshl_add_u32 v1, v2, 5, v1
v_and_b32 v2, 1, v0
v_lshl_add_u32 v5, v2, 4, v1
s_mul_i32 s79, s75, 36864
s_add_u32 s80, s77, 0
s_lshl_b32 s81, s80, 5
s_add_u32 s48, s81, s78
s_lshl_b32 s81, s80, 6
s_add_u32 s81, s81, s79
v_add_u32 v19, s81, v5
s_add_u32 s80, s77, 1
s_lshl_b32 s81, s80, 5
s_add_u32 s49, s81, s78
s_lshl_b32 s81, s80, 6
s_add_u32 s81, s81, s79
v_add_u32 v20, s81, v5
s_add_u32 s80, s77, 2
s_lshl_b32 s81, s80, 5
s_add_u32 s50, s81, s78
s_lshl_b32 s81, s80, 6
s_add_u32 s81, s81, s79
v_add_u32 v21, s81, v5
v_lshrrev_b32 v1, 5, v0
v_bfe_u32 v2, v0, 3, 1
v_lshl_add_u32 v1, v1, 1, v2
v_bfe_u32 v2, v0, 4, 1
v_bfe_u32 v3, v0, 1, 2
v_lshlrev_b32 v1, 3, v1
v_lshl_add_u32 v1, v2, 2, v1
v_add_u32 v1, v1, v3
v_mul_u32_u24 v1, 1152, v1
v_and_b32 v2, 1, v0
v_lshl_add_u32 v63, v2, 4, v1
s_mul_i32 s70, s3, 40960
v_lshrrev_b32 v1, 5, v0
v_lshlrev_b32 v1, 9, v1
v_bfe_u32 v2, v0, 4, 1
v_lshl_add_u32 v1, v2, 7, v1
v_add_u32 v1, s70, v1
v_and_b32 v2, 15, v0
v_lshl_add_u32 v2, v2, 3, v1
v_add_u32 v60, 0, v2
v_add_u32 v61, 1024, v2
v_add_u32 v62, 2048, v2
s_add_u32 m0, s70, 0
s_add_u32 s71, s48, 0
buffer_load_dwordx4 v63, s[8:11], s71 offen lds
s_add_u32 m0, s70, 1024
s_add_u32 s71, s49, 0
buffer_load_dwordx4 v63, s[8:11], s71 offen lds
s_add_u32 m0, s70, 2048
s_add_u32 s71, s50, 0
buffer_load_dwordx4 v63, s[8:11], s71 offen lds
s_add_u32 m0, s70, 3072
s_add_u32 s71, s48, 36864
buffer_load_dwordx4 v63, s[8:11], s71 offen lds
s_add_u32 m0, s70, 4096
s_add_u32 s71, s49, 36864
buffer_load_dwordx4 v63, s[8:11], s71 offen lds
s_add_u32 m0, s70, 5120
s_add_u32 s71, s50, 36864
buffer_load_dwordx4 v63, s[8:11], s71 offen lds
s_add_u32 m0, s70, 6144
s_add_u32 s71, s48, 73728
buffer_load_dwordx4 v63, s[8:11], s71 offen lds
s_add_u32 m0, s70, 7168
s_add_u32 s71, s49, 73728
buffer_load_dwordx4 v63, s[8:11], s71 offen lds
s_add_u32 m0, s70, 8192
s_add_u32 s71, s50, 73728
buffer_load_dwordx4 v63, s[8:11], s71 offen lds
s_add_u32 m0, s70, 9216
s_add_u32 s71, s48, 110592
buffer_load_dwordx4 v63, s[8:11], s71 offen lds
s_add_u32 m0, s70, 10240
s_add_u32 s71, s49, 110592
buffer_load_dwordx4 v63, s[8:11], s71 offen lds
s_add_u32 m0, s70, 11264
s_add_u32 s71, s50, 110592
buffer_load_dwordx4 v63, s[8:11], s71 offen lds
s_add_u32 m0, s70, 12288
s_add_u32 s71, s48, 147456
buffer_load_dwordx4 v63, s[8:11], s71 offen lds
s_add_u32 m0, s70, 13312
s_add_u32 s71, s49, 147456
buffer_load_dwordx4 v63, s[8:11], s71 offen lds
s_add_u32 m0, s70, 14336
s_add_u32 s71, s50, 147456
buffer_load_dwordx4 v63, s[8:11], s71 offen lds
s_add_u32 m0, s70, 15360
s_add_u32 s71, s48, 184320
buffer_load_dwordx4 v63, s[8:11], s71 offen lds
s_add_u32 m0, s70, 16384
s_add_u32 s71, s49, 184320
buffer_load_dwordx4 v63, s[8:11], s71 offen lds
s_add_u32 m0, s70, 17408
s_add_u32 s71, s50, 184320
buffer_load_dwordx4 v63, s[8:11], s71 offen lds
s_add_u32 m0, s70, 18432
s_add_u32 s71, s48, 221184
buffer_load_dwordx4 v63, s[8:11], s71 offen lds
s_add_u32 m0, s70, 19456
s_add_u32 s71, s49, 221184
buffer_load_dwordx4 v63, s[8:11], s71 offen lds
s_add_u32 m0, s70, 20480
s_add_u32 s71, s50, 221184
buffer_load_dwordx4 v63, s[8:11], s71 offen lds
s_add_u32 m0, s70, 21504
s_add_u32 s71, s48, 258048
buffer_load_dwordx4 v63, s[8:11], s71 offen lds
s_add_u32 m0, s70, 22528
s_add_u32 s71, s49, 258048
buffer_load_dwordx4 v63, s[8:11], s71 offen lds
s_add_u32 m0, s70, 23552
s_add_u32 s71, s50, 258048
buffer_load_dwordx4 v63, s[8:11], s71 offen lds
s_add_u32 m0, s70, 24576
s_add_u32 s71, s48, 294912
buffer_load_dwordx4 v63, s[8:11], s71 offen lds
s_add_u32 m0, s70, 25600
s_add_u32 s71, s49, 294912
buffer_load_dwordx4 v63, s[8:11], s71 offen lds
s_add_u32 m0, s70, 26624
s_add_u32 s71, s50, 294912
buffer_load_dwordx4 v63, s[8:11], s71 offen lds
s_add_u32 m0, s70, 27648
s_add_u32 s71, s48, 331776
buffer_load_dwordx4 v63, s[8:11], s71 offen lds
s_add_u32 m0, s70, 28672
s_add_u32 s71, s49, 331776
buffer_load_dwordx4 v63, s[8:11], s71 offen lds
s_add_u32 m0, s70, 29696
s_add_u32 s71, s50, 331776
buffer_load_dwordx4 v63, s[8:11], s71 offen lds
s_add_u32 m0, s70, 30720
s_add_u32 s71, s48, 368640
buffer_load_dwordx4 v63, s[8:11], s71 offen lds
s_add_u32 m0, s70, 31744
s_add_u32 s71, s49, 368640
buffer_load_dwordx4 v63, s[8:11], s71 offen lds
s_add_u32 m0, s70, 32768
s_add_u32 s71, s50, 368640
buffer_load_dwordx4 v63, s[8:11], s71 offen lds
s_add_u32 m0, s70, 33792
s_add_u32 s71, s48, 405504
buffer_load_dwordx4 v63, s[8:11], s71 offen lds
s_add_u32 m0, s70, 34816
s_add_u32 s71, s49, 405504
buffer_load_dwordx4 v63, s[8:11], s71 offen lds
s_add_u32 m0, s70, 35840
s_add_u32 s71, s50, 405504
buffer_load_dwordx4 v63, s[8:11], s71 offen lds
s_add_u32 m0, s70, 36864
s_add_u32 s71, s48, 442368
buffer_load_dwordx4 v63, s[8:11], s71 offen lds
s_add_u32 m0, s70, 37888
s_add_u32 s71, s49, 442368
buffer_load_dwordx4 v63, s[8:11], s71 offen lds
s_add_u32 m0, s70, 38912
s_add_u32 s71, s50, 442368
buffer_load_dwordx4 v63, s[8:11], s71 offen lds
s_waitcnt vmcnt(36)
ds_read_b64_tr_b16 a[0:1], v60 offset:0
ds_read_b64_tr_b16 a[2:3], v60 offset:256
ds_read_b64_tr_b16 a[72:73], v61 offset:0
ds_read_b64_tr_b16 a[74:75], v61 offset:256
ds_read_b64_tr_b16 a[144:145], v62 offset:0
ds_read_b64_tr_b16 a[146:147], v62 offset:256
s_waitcnt lgkmcnt(0)
s_add_u32 m0, s70, 0
s_add_u32 s71, s48, 479232
buffer_load_dwordx4 v63, s[8:11], s71 offen lds
s_add_u32 m0, s70, 1024
s_add_u32 s71, s49, 479232
buffer_load_dwordx4 v63, s[8:11], s71 offen lds
s_add_u32 m0, s70, 2048
s_add_u32 s71, s50, 479232
buffer_load_dwordx4 v63, s[8:11], s71 offen lds
s_waitcnt vmcnt(36)
ds_read_b64_tr_b16 a[4:5], v60 offset:3072
ds_read_b64_tr_b16 a[6:7], v60 offset:3328
ds_read_b64_tr_b16 a[76:77], v61 offset:3072
ds_read_b64_tr_b16 a[78:79], v61 offset:3328
ds_read_b64_tr_b16 a[148:149], v62 offset:3072
ds_read_b64_tr_b16 a[150:151], v62 offset:3328
s_waitcnt lgkmcnt(0)
s_add_u32 m0, s70, 3072
s_add_u32 s71, s48, 516096
buffer_load_dwordx4 v63, s[8:11], s71 offen lds
s_add_u32 m0, s70, 4096
s_add_u32 s71, s49, 516096
buffer_load_dwordx4 v63, s[8:11], s71 offen lds
s_add_u32 m0, s70, 5120
s_add_u32 s71, s50, 516096
buffer_load_dwordx4 v63, s[8:11], s71 offen lds
s_waitcnt vmcnt(36)
ds_read_b64_tr_b16 a[8:9], v60 offset:6144
ds_read_b64_tr_b16 a[10:11], v60 offset:6400
ds_read_b64_tr_b16 a[80:81], v61 offset:6144
ds_read_b64_tr_b16 a[82:83], v61 offset:6400
ds_read_b64_tr_b16 a[152:153], v62 offset:6144
ds_read_b64_tr_b16 a[154:155], v62 offset:6400
s_waitcnt lgkmcnt(0)
s_add_u32 m0, s70, 6144
s_add_u32 s71, s48, 552960
buffer_load_dwordx4 v63, s[8:11], s71 offen lds
s_add_u32 m0, s70, 7168
s_add_u32 s71, s49, 552960
buffer_load_dwordx4 v63, s[8:11], s71 offen lds
s_add_u32 m0, s70, 8192
s_add_u32 s71, s50, 552960
buffer_load_dwordx4 v63, s[8:11], s71 offen lds
s_waitcnt vmcnt(36)
ds_read_b64_tr_b16 a[12:13], v60 offset:9216
ds_read_b64_tr_b16 a[14:15], v60 offset:9472
ds_read_b64_tr_b16 a[84:85], v61 offset:9216
ds_read_b64_tr_b16 a[86:87], v61 offset:9472
ds_read_b64_tr_b16 a[156:157], v62 offset:9216
ds_read_b64_tr_b16 a[158:159], v62 offset:9472
s_waitcnt lgkmcnt(0)
s_add_u32 m0, s70, 9216
s_add_u32 s71, s48, 589824
buffer_load_dwordx4 v63, s[8:11], s71 offen lds
s_add_u32 m0, s70, 10240
s_add_u32 s71, s49, 589824
buffer_load_dwordx4 v63, s[8:11], s71 offen lds
s_add_u32 m0, s70, 11264
s_add_u32 s71, s50, 589824
buffer_load_dwordx4 v63, s[8:11], s71 offen lds
s_waitcnt vmcnt(36)
ds_read_b64_tr_b16 a[16:17], v60 offset:12288
ds_read_b64_tr_b16 a[18:19], v60 offset:12544
ds_read_b64_tr_b16 a[88:89], v61 offset:12288
ds_read_b64_tr_b16 a[90:91], v61 offset:12544
ds_read_b64_tr_b16 a[160:161], v62 offset:12288
ds_read_b64_tr_b16 a[162:163], v62 offset:12544
s_waitcnt lgkmcnt(0)
s_add_u32 m0, s70, 12288
s_add_u32 s71, s48, 626688
buffer_load_dwordx4 v63, s[8:11], s71 offen lds
s_add_u32 m0, s70, 13312
s_add_u32 s71, s49, 626688
buffer_load_dwordx4 v63, s[8:11], s71 offen lds
s_add_u32 m0, s70, 14336
s_add_u32 s71, s50, 626688
buffer_load_dwordx4 v63, s[8:11], s71 offen lds
s_waitcnt vmcnt(36)
ds_read_b64_tr_b16 a[20:21], v60 offset:15360
ds_read_b64_tr_b16 a[22:23], v60 offset:15616
ds_read_b64_tr_b16 a[92:93], v61 offset:15360
ds_read_b64_tr_b16 a[94:95], v61 offset:15616
ds_read_b64_tr_b16 a[164:165], v62 offset:15360
ds_read_b64_tr_b16 a[166:167], v62 offset:15616
s_waitcnt vmcnt(33)
ds_read_b64_tr_b16 a[24:25], v60 offset:18432
ds_read_b64_tr_b16 a[26:27], v60 offset:18688
ds_read_b64_tr_b16 a[96:97], v61 offset:18432
ds_read_b64_tr_b16 a[98:99], v61 offset:18688
ds_read_b64_tr_b16 a[168:169], v62 offset:18432
ds_read_b64_tr_b16 a[170:171], v62 offset:18688
s_waitcnt vmcnt(30)
ds_read_b64_tr_b16 a[28:29], v60 offset:21504
ds_read_b64_tr_b16 a[30:31], v60 offset:21760
ds_read_b64_tr_b16 a[100:101], v61 offset:21504
ds_read_b64_tr_b16 a[102:103], v61 offset:21760
ds_read_b64_tr_b16 a[172:173], v62 offset:21504
ds_read_b64_tr_b16 a[174:175], v62 offset:21760
s_waitcnt vmcnt(27)
ds_read_b64_tr_b16 a[32:33], v60 offset:24576
ds_read_b64_tr_b16 a[34:35], v60 offset:24832
ds_read_b64_tr_b16 a[104:105], v61 offset:24576
ds_read_b64_tr_b16 a[106:107], v61 offset:24832
ds_read_b64_tr_b16 a[176:177], v62 offset:24576
ds_read_b64_tr_b16 a[178:179], v62 offset:24832
s_waitcnt vmcnt(24)
ds_read_b64_tr_b16 a[36:37], v60 offset:27648
ds_read_b64_tr_b16 a[38:39], v60 offset:27904
ds_read_b64_tr_b16 a[108:109], v61 offset:27648
ds_read_b64_tr_b16 a[110:111], v61 offset:27904
ds_read_b64_tr_b16 a[180:181], v62 offset:27648
ds_read_b64_tr_b16 a[182:183], v62 offset:27904
s_waitcnt vmcnt(21)
ds_read_b64_tr_b16 a[40:41], v60 offset:30720
ds_read_b64_tr_b16 a[42:43], v60 offset:30976
ds_read_b64_tr_b16 a[112:113], v61 offset:30720
ds_read_b64_tr_b16 a[114:115], v61 offset:30976
ds_read_b64_tr_b16 a[184:185], v62 offset:30720
ds_read_b64_tr_b16 a[186:187], v62 offset:30976
s_waitcnt vmcnt(18)
ds_read_b64_tr_b16 a[44:45], v60 offset:33792
ds_read_b64_tr_b16 a[46:47], v60 offset:34048
ds_read_b64_tr_b16 a[116:117], v61 offset:33792
ds_read_b64_tr_b16 a[118:119], v61 offset:34048
ds_read_b64_tr_b16 a[188:189], v62 offset:33792
ds_read_b64_tr_b16 a[190:191], v62 offset:34048
s_waitcnt vmcnt(15)
ds_read_b64_tr_b16 a[48:49], v60 offset:36864
ds_read_b64_tr_b16 a[50:51], v60 offset:37120
ds_read_b64_tr_b16 a[120:121], v61 offset:36864
ds_read_b64_tr_b16 a[122:123], v61 offset:37120
ds_read_b64_tr_b16 a[192:193], v62 offset:36864
ds_read_b64_tr_b16 a[194:195], v62 offset:37120
s_waitcnt vmcnt(12)
ds_read_b64_tr_b16 a[52:53], v60 offset:0
ds_read_b64_tr_b16 a[54:55], v60 offset:256
ds_read_b64_tr_b16 a[124:125], v61 offset:0
ds_read_b64_tr_b16 a[126:127], v61 offset:256
ds_read_b64_tr_b16 a[196:197], v62 offset:0
ds_read_b64_tr_b16 a[198:199], v62 offset:256
s_waitcnt vmcnt(9)
ds_read_b64_tr_b16 a[56:57], v60 offset:3072
ds_read_b64_tr_b16 a[58:59], v60 offset:3328
ds_read_b64_tr_b16 a[128:129], v61 offset:3072
ds_read_b64_tr_b16 a[130:131], v61 offset:3328
ds_read_b64_tr_b16 a[200:201], v62 offset:3072
ds_read_b64_tr_b16 a[202:203], v62 offset:3328
s_waitcnt vmcnt(6)
ds_read_b64_tr_b16 a[60:61], v60 offset:6144
ds_read_b64_tr_b16 a[62:63], v60 offset:6400
ds_read_b64_tr_b16 a[132:133], v61 offset:6144
ds_read_b64_tr_b16 a[134:135], v61 offset:6400
ds_read_b64_tr_b16 a[204:205], v62 offset:6144
ds_read_b64_tr_b16 a[206:207], v62 offset:6400
s_waitcnt vmcnt(3)
ds_read_b64_tr_b16 a[64:65], v60 offset:9216
ds_read_b64_tr_b16 a[66:67], v60 offset:9472
ds_read_b64_tr_b16 a[136:137], v61 offset:9216
ds_read_b64_tr_b16 a[138:139], v61 offset:9472
ds_read_b64_tr_b16 a[208:209], v62 offset:9216
ds_read_b64_tr_b16 a[210:211], v62 offset:9472
s_waitcnt vmcnt(0)
ds_read_b64_tr_b16 a[68:69], v60 offset:12288
ds_read_b64_tr_b16 a[70:71], v60 offset:12544
ds_read_b64_tr_b16 a[140:141], v61 offset:12288
ds_read_b64_tr_b16 a[142:143], v61 offset:12544
ds_read_b64_tr_b16 a[212:213], v62 offset:12288
ds_read_b64_tr_b16 a[214:215], v62 offset:12544
s_waitcnt lgkmcnt(0)
v_lshlrev_b32 v17, 4, v0
s_lshl_b32 s70, s3, 10
v_add_u32 v1, s70, v17
v_add_u32 v8, 4096, v1
v_add_u32 v9, 7168, v1
v_add_u32 v10, 10240, v1
v_add_u32 v11, 13312, v1
v_add_u32 v12, 20480, v1
v_add_u32 v13, 23552, v1
v_add_u32 v14, 26624, v1
v_add_u32 v15, 29696, v1
v_add_u32 v16, 36864, v1
s_mul_i32 s77, s75, 6
v_and_b32 v2, 31, v0
v_add_u32 v1, s77, v2
v_mul_u32_u24 v1, 128, v1
v_lshrrev_b32 v3, 5, v0
v_mul_u32_u24 v3, 32768, v3
v_add_u32 v1, 23552, v1
v_add_u32 v1, v1, v3
v_mov_b32 v3, 2147483632
s_cmp_eq_u32 s3, 0
s_cselect_b32 s71, 6, 0
v_cmp_gt_u32 vcc, s71, v2
s_nop 1
v_cndmask_b32 v22, v3, v1, vcc
s_mov_b32 s56, 0x3f
s_mul_i32 s70, s74, 128
s_add_u32 s70, s70, 29696
v_mov_b32 v1, s70
s_min_u32 s71, s71, 1
v_cmp_gt_u32 vcc, s71, v0
s_nop 1
v_cndmask_b32 v44, v3, v1, vcc
v_add_u32 v45, 65536, v44
s_getpc_b64 s[96:97]
pc_112:
s_add_u32 s96, s96, L_writers-pc_112
s_addc_u32 s97, s97, 0
v_subrev_u32 v23, 0, v22
v_lshrrev_b32 v23, 7, v23
v_cmp_gt_u32 vcc, 0x200, v23
s_nop 1
v_cndmask_b32 v23, 0, v23, vcc
global_load_ubyte v23, v23, s[96:97]
s_mul_i32 s77, s75, 36864
s_add_u32 s44, s77, 161517568
s_mov_b32 s45, 218144768
s_mov_b32 s52, 1
s_mov_b32 s53, 0
s_add_u32 s46, s77, 180391936
s_mov_b32 s47, 218144768
s_mov_b32 s54, 1
s_mov_b32 s55, 32768
s_mov_b32 s25, 200
s_mov_b32 s20, 294912
s_mov_b32 s21, 294912
s_branch G_sss18
H_wo:
s_mul_i32 s75, s74, 43
s_lshr_b32 s75, s75, 7
s_mul_i32 s76, s75, 3
s_sub_u32 s76, s74, s76
s_mov_b32 s8, s30
s_and_b32 s9, s31, 0xffff
s_mov_b32 s10, 4718592
s_mov_b32 s11, 0x20000
s_mul_i32 s77, s76, 12
s_mul_i32 s78, s3, 3
s_add_u32 s77, s77, s78
s_mul_i32 s78, s75, 589824
v_bfe_u32 v1, v0, 4, 1
v_bfe_u32 v2, v0, 1, 3
v_lshl_add_u32 v1, v1, 3, v2
v_mul_u32_u24 v1, 2304, v1
v_lshrrev_b32 v2, 5, v0
v_lshl_add_u32 v1, v2, 5, v1
v_and_b32 v2, 1, v0
v_lshl_add_u32 v5, v2, 4, v1
s_mul_i32 s79, s75, 36864
s_add_u32 s80, s77, 0
s_lshl_b32 s81, s80, 5
s_add_u32 s48, s81, s78
s_lshl_b32 s81, s80, 6
s_add_u32 s81, s81, s79
v_add_u32 v19, s81, v5
s_add_u32 s80, s77, 1
s_lshl_b32 s81, s80, 5
s_add_u32 s49, s81, s78
s_lshl_b32 s81, s80, 6
s_add_u32 s81, s81, s79
v_add_u32 v20, s81, v5
s_add_u32 s80, s77, 2
s_lshl_b32 s81, s80, 5
s_add_u32 s50, s81, s78
s_lshl_b32 s81, s80, 6
s_add_u32 s81, s81, s79
v_add_u32 v21, s81, v5
v_lshrrev_b32 v1, 5, v0
v_bfe_u32 v2, v0, 3, 1
v_lshl_add_u32 v1, v1, 1, v2
v_bfe_u32 v2, v0, 4, 1
v_bfe_u32 v3, v0, 1, 2
v_lshlrev_b32 v1, 2, v1
v_lshl_add_u32 v1, v2, 4, v1
v_add_u32 v1, v1, v3
v_mul_u32_u24 v1, 1152, v1
v_and_b32 v2, 1, v0
v_lshl_add_u32 v63, v2, 4, v1
s_mul_i32 s70, s3, 40960
v_lshrrev_b32 v1, 5, v0
v_lshlrev_b32 v1, 9, v1
v_bfe_u32 v2, v0, 4, 1
v_lshl_add_u32 v1, v2, 7, v1
v_add_u32 v1, s70, v1
v_and_b32 v2, 15, v0
v_lshl_add_u32 v2, v2, 3, v1
v_add_u32 v60, 0, v2
v_add_u32 v61, 1024, v2
v_add_u32 v62, 2048, v2
s_add_u32 m0, s70, 0
s_add_u32 s71, s48, 0
buffer_load_dwordx4 v63, s[8:11], s71 offen lds
s_add_u32 m0, s70, 1024
s_add_u32 s71, s49, 0
buffer_load_dwordx4 v63, s[8:11], s71 offen lds
s_add_u32 m0, s70, 2048
s_add_u32 s71, s50, 0
buffer_load_dwordx4 v63, s[8:11], s71 offen lds
s_add_u32 m0, s70, 3072
s_add_u32 s71, s48, 36864
buffer_load_dwordx4 v63, s[8:11], s71 offen lds
s_add_u32 m0, s70, 4096
s_add_u32 s71, s49, 36864
buffer_load_dwordx4 v63, s[8:11], s71 offen lds
s_add_u32 m0, s70, 5120
s_add_u32 s71, s50, 36864
buffer_load_dwordx4 v63, s[8:11], s71 offen lds
s_add_u32 m0, s70, 6144
s_add_u32 s71, s48, 73728
buffer_load_dwordx4 v63, s[8:11], s71 offen lds
s_add_u32 m0, s70, 7168
s_add_u32 s71, s49, 73728
buffer_load_dwordx4 v63, s[8:11], s71 offen lds
s_add_u32 m0, s70, 8192
s_add_u32 s71, s50, 73728
buffer_load_dwordx4 v63, s[8:11], s71 offen lds
s_add_u32 m0, s70, 9216
s_add_u32 s71, s48, 110592
buffer_load_dwordx4 v63, s[8:11], s71 offen lds
s_add_u32 m0, s70, 10240
s_add_u32 s71, s49, 110592
buffer_load_dwordx4 v63, s[8:11], s71 offen lds
s_add_u32 m0, s70, 11264
s_add_u32 s71, s50, 110592
buffer_load_dwordx4 v63, s[8:11], s71 offen lds
s_add_u32 m0, s70, 12288
s_add_u32 s71, s48, 147456
buffer_load_dwordx4 v63, s[8:11], s71 offen lds
s_add_u32 m0, s70, 13312
s_add_u32 s71, s49, 147456
buffer_load_dwordx4 v63, s[8:11], s71 offen lds
s_add_u32 m0, s70, 14336
s_add_u32 s71, s50, 147456
buffer_load_dwordx4 v63, s[8:11], s71 offen lds
s_add_u32 m0, s70, 15360
s_add_u32 s71, s48, 184320
buffer_load_dwordx4 v63, s[8:11], s71 offen lds
s_add_u32 m0, s70, 16384
s_add_u32 s71, s49, 184320
buffer_load_dwordx4 v63, s[8:11], s71 offen lds
s_add_u32 m0, s70, 17408
s_add_u32 s71, s50, 184320
buffer_load_dwordx4 v63, s[8:11], s71 offen lds
s_add_u32 m0, s70, 18432
s_add_u32 s71, s48, 221184
buffer_load_dwordx4 v63, s[8:11], s71 offen lds
s_add_u32 m0, s70, 19456
s_add_u32 s71, s49, 221184
buffer_load_dwordx4 v63, s[8:11], s71 offen lds
s_add_u32 m0, s70, 20480
s_add_u32 s71, s50, 221184
buffer_load_dwordx4 v63, s[8:11], s71 offen lds
s_add_u32 m0, s70, 21504
s_add_u32 s71, s48, 258048
buffer_load_dwordx4 v63, s[8:11], s71 offen lds
s_add_u32 m0, s70, 22528
s_add_u32 s71, s49, 258048
buffer_load_dwordx4 v63, s[8:11], s71 offen lds
s_add_u32 m0, s70, 23552
s_add_u32 s71, s50, 258048
buffer_load_dwordx4 v63, s[8:11], s71 offen lds
s_add_u32 m0, s70, 24576
s_add_u32 s71, s48, 294912
buffer_load_dwordx4 v63, s[8:11], s71 offen lds
s_add_u32 m0, s70, 25600
s_add_u32 s71, s49, 294912
buffer_load_dwordx4 v63, s[8:11], s71 offen lds
s_add_u32 m0, s70, 26624
s_add_u32 s71, s50, 294912
buffer_load_dwordx4 v63, s[8:11], s71 offen lds
s_add_u32 m0, s70, 27648
s_add_u32 s71, s48, 331776
buffer_load_dwordx4 v63, s[8:11], s71 offen lds
s_add_u32 m0, s70, 28672
s_add_u32 s71, s49, 331776
buffer_load_dwordx4 v63, s[8:11], s71 offen lds
s_add_u32 m0, s70, 29696
s_add_u32 s71, s50, 331776
buffer_load_dwordx4 v63, s[8:11], s71 offen lds
s_add_u32 m0, s70, 30720
s_add_u32 s71, s48, 368640
buffer_load_dwordx4 v63, s[8:11], s71 offen lds
s_add_u32 m0, s70, 31744
s_add_u32 s71, s49, 368640
buffer_load_dwordx4 v63, s[8:11], s71 offen lds
s_add_u32 m0, s70, 32768
s_add_u32 s71, s50, 368640
buffer_load_dwordx4 v63, s[8:11], s71 offen lds
s_add_u32 m0, s70, 33792
s_add_u32 s71, s48, 405504
buffer_load_dwordx4 v63, s[8:11], s71 offen lds
s_add_u32 m0, s70, 34816
s_add_u32 s71, s49, 405504
buffer_load_dwordx4 v63, s[8:11], s71 offen lds
s_add_u32 m0, s70, 35840
s_add_u32 s71, s50, 405504
buffer_load_dwordx4 v63, s[8:11], s71 offen lds
s_add_u32 m0, s70, 36864
s_add_u32 s71, s48, 442368
buffer_load_dwordx4 v63, s[8:11], s71 offen lds
s_add_u32 m0, s70, 37888
s_add_u32 s71, s49, 442368
buffer_load_dwordx4 v63, s[8:11], s71 offen lds
s_add_u32 m0, s70, 38912
s_add_u32 s71, s50, 442368
buffer_load_dwordx4 v63, s[8:11], s71 offen lds
s_waitcnt vmcnt(36)
ds_read_b64_tr_b16 a[0:1], v60 offset:0
ds_read_b64_tr_b16 a[2:3], v60 offset:256
ds_read_b64_tr_b16 a[72:73], v61 offset:0
ds_read_b64_tr_b16 a[74:75], v61 offset:256
ds_read_b64_tr_b16 a[144:145], v62 offset:0
ds_read_b64_tr_b16 a[146:147], v62 offset:256
s_waitcnt lgkmcnt(0)
s_add_u32 m0, s70, 0
s_add_u32 s71, s48, 479232
buffer_load_dwordx4 v63, s[8:11], s71 offen lds
s_add_u32 m0, s70, 1024
s_add_u32 s71, s49, 479232
buffer_load_dwordx4 v63, s[8:11], s71 offen lds
s_add_u32 m0, s70, 2048
s_add_u32 s71, s50, 479232
buffer_load_dwordx4 v63, s[8:11], s71 offen lds
s_waitcnt vmcnt(36)
ds_read_b64_tr_b16 a[4:5], v60 offset:3072
ds_read_b64_tr_b16 a[6:7], v60 offset:3328
ds_read_b64_tr_b16 a[76:77], v61 offset:3072
ds_read_b64_tr_b16 a[78:79], v61 offset:3328
ds_read_b64_tr_b16 a[148:149], v62 offset:3072
ds_read_b64_tr_b16 a[150:151], v62 offset:3328
s_waitcnt lgkmcnt(0)
s_add_u32 m0, s70, 3072
s_add_u32 s71, s48, 516096
buffer_load_dwordx4 v63, s[8:11], s71 offen lds
s_add_u32 m0, s70, 4096
s_add_u32 s71, s49, 516096
buffer_load_dwordx4 v63, s[8:11], s71 offen lds
s_add_u32 m0, s70, 5120
s_add_u32 s71, s50, 516096
buffer_load_dwordx4 v63, s[8:11], s71 offen lds
s_waitcnt vmcnt(36)
ds_read_b64_tr_b16 a[8:9], v60 offset:6144
ds_read_b64_tr_b16 a[10:11], v60 offset:6400
ds_read_b64_tr_b16 a[80:81], v61 offset:6144
ds_read_b64_tr_b16 a[82:83], v61 offset:6400
ds_read_b64_tr_b16 a[152:153], v62 offset:6144
ds_read_b64_tr_b16 a[154:155], v62 offset:6400
s_waitcnt lgkmcnt(0)
s_add_u32 m0, s70, 6144
s_add_u32 s71, s48, 552960
buffer_load_dwordx4 v63, s[8:11], s71 offen lds
s_add_u32 m0, s70, 7168
s_add_u32 s71, s49, 552960
buffer_load_dwordx4 v63, s[8:11], s71 offen lds
s_add_u32 m0, s70, 8192
s_add_u32 s71, s50, 552960
buffer_load_dwordx4 v63, s[8:11], s71 offen lds
s_waitcnt vmcnt(36)
ds_read_b64_tr_b16 a[12:13], v60 offset:9216
ds_read_b64_tr_b16 a[14:15], v60 offset:9472
ds_read_b64_tr_b16 a[84:85], v61 offset:9216
ds_read_b64_tr_b16 a[86:87], v61 offset:9472
ds_read_b64_tr_b16 a[156:157], v62 offset:9216
ds_read_b64_tr_b16 a[158:159], v62 offset:9472
s_waitcnt vmcnt(33)
ds_read_b64_tr_b16 a[16:17], v60 offset:12288
ds_read_b64_tr_b16 a[18:19], v60 offset:12544
ds_read_b64_tr_b16 a[88:89], v61 offset:12288
ds_read_b64_tr_b16 a[90:91], v61 offset:12544
ds_read_b64_tr_b16 a[160:161], v62 offset:12288
ds_read_b64_tr_b16 a[162:163], v62 offset:12544
s_waitcnt vmcnt(30)
ds_read_b64_tr_b16 a[20:21], v60 offset:15360
ds_read_b64_tr_b16 a[22:23], v60 offset:15616
ds_read_b64_tr_b16 a[92:93], v61 offset:15360
ds_read_b64_tr_b16 a[94:95], v61 offset:15616
ds_read_b64_tr_b16 a[164:165], v62 offset:15360
ds_read_b64_tr_b16 a[166:167], v62 offset:15616
s_waitcnt vmcnt(27)
ds_read_b64_tr_b16 a[24:25], v60 offset:18432
ds_read_b64_tr_b16 a[26:27], v60 offset:18688
ds_read_b64_tr_b16 a[96:97], v61 offset:18432
ds_read_b64_tr_b16 a[98:99], v61 offset:18688
ds_read_b64_tr_b16 a[168:169], v62 offset:18432
ds_read_b64_tr_b16 a[170:171], v62 offset:18688
s_waitcnt vmcnt(24)
ds_read_b64_tr_b16 a[28:29], v60 offset:21504
ds_read_b64_tr_b16 a[30:31], v60 offset:21760
ds_read_b64_tr_b16 a[100:101], v61 offset:21504
ds_read_b64_tr_b16 a[102:103], v61 offset:21760
ds_read_b64_tr_b16 a[172:173], v62 offset:21504
ds_read_b64_tr_b16 a[174:175], v62 offset:21760
s_waitcnt vmcnt(21)
ds_read_b64_tr_b16 a[32:33], v60 offset:24576
ds_read_b64_tr_b16 a[34:35], v60 offset:24832
ds_read_b64_tr_b16 a[104:105], v61 offset:24576
ds_read_b64_tr_b16 a[106:107], v61 offset:24832
ds_read_b64_tr_b16 a[176:177], v62 offset:24576
ds_read_b64_tr_b16 a[178:179], v62 offset:24832
s_waitcnt vmcnt(18)
ds_read_b64_tr_b16 a[36:37], v60 offset:27648
ds_read_b64_tr_b16 a[38:39], v60 offset:27904
ds_read_b64_tr_b16 a[108:109], v61 offset:27648
ds_read_b64_tr_b16 a[110:111], v61 offset:27904
ds_read_b64_tr_b16 a[180:181], v62 offset:27648
ds_read_b64_tr_b16 a[182:183], v62 offset:27904
s_waitcnt vmcnt(15)
ds_read_b64_tr_b16 a[40:41], v60 offset:30720
ds_read_b64_tr_b16 a[42:43], v60 offset:30976
ds_read_b64_tr_b16 a[112:113], v61 offset:30720
ds_read_b64_tr_b16 a[114:115], v61 offset:30976
ds_read_b64_tr_b16 a[184:185], v62 offset:30720
ds_read_b64_tr_b16 a[186:187], v62 offset:30976
s_waitcnt vmcnt(12)
ds_read_b64_tr_b16 a[44:45], v60 offset:33792
ds_read_b64_tr_b16 a[46:47], v60 offset:34048
ds_read_b64_tr_b16 a[116:117], v61 offset:33792
ds_read_b64_tr_b16 a[118:119], v61 offset:34048
ds_read_b64_tr_b16 a[188:189], v62 offset:33792
ds_read_b64_tr_b16 a[190:191], v62 offset:34048
s_waitcnt vmcnt(9)
ds_read_b64_tr_b16 a[48:49], v60 offset:36864
ds_read_b64_tr_b16 a[50:51], v60 offset:37120
ds_read_b64_tr_b16 a[120:121], v61 offset:36864
ds_read_b64_tr_b16 a[122:123], v61 offset:37120
ds_read_b64_tr_b16 a[192:193], v62 offset:36864
ds_read_b64_tr_b16 a[194:195], v62 offset:37120
s_waitcnt vmcnt(6)
ds_read_b64_tr_b16 a[52:53], v60 offset:0
ds_read_b64_tr_b16 a[54:55], v60 offset:256
ds_read_b64_tr_b16 a[124:125], v61 offset:0
ds_read_b64_tr_b16 a[126:127], v61 offset:256
ds_read_b64_tr_b16 a[196:197], v62 offset:0
ds_read_b64_tr_b16 a[198:199], v62 offset:256
s_waitcnt vmcnt(3)
ds_read_b64_tr_b16 a[56:57], v60 offset:3072
ds_read_b64_tr_b16 a[58:59], v60 offset:3328
ds_read_b64_tr_b16 a[128:129], v61 offset:3072
ds_read_b64_tr_b16 a[130:131], v61 offset:3328
ds_read_b64_tr_b16 a[200:201], v62 offset:3072
ds_read_b64_tr_b16 a[202:203], v62 offset:3328
s_waitcnt vmcnt(0)
ds_read_b64_tr_b16 a[60:61], v60 offset:6144
ds_read_b64_tr_b16 a[62:63], v60 offset:6400
ds_read_b64_tr_b16 a[132:133], v61 offset:6144
ds_read_b64_tr_b16 a[134:135], v61 offset:6400
ds_read_b64_tr_b16 a[204:205], v62 offset:6144
ds_read_b64_tr_b16 a[206:207], v62 offset:6400
s_waitcnt lgkmcnt(0)
v_lshlrev_b32 v17, 4, v0
s_lshl_b32 s70, s3, 10
v_add_u32 v1, s70, v17
v_add_u32 v8, 4096, v1
v_add_u32 v9, 7168, v1
v_add_u32 v10, 10240, v1
v_add_u32 v11, 13312, v1
v_add_u32 v12, 20480, v1
v_add_u32 v13, 23552, v1
v_add_u32 v14, 26624, v1
v_add_u32 v15, 29696, v1
s_mul_i32 s77, s75, 4
v_and_b32 v2, 31, v0
v_add_u32 v1, s77, v2
v_mul_u32_u24 v1, 128, v1
v_lshrrev_b32 v3, 5, v0
v_mul_u32_u24 v3, 32768, v3
v_add_u32 v1, 14336, v1
v_add_u32 v1, v1, v3
v_mov_b32 v3, 2147483632
s_cmp_eq_u32 s3, 0
s_cselect_b32 s71, 4, 0
v_cmp_gt_u32 vcc, s71, v2
s_nop 1
v_cndmask_b32 v22, v3, v1, vcc
s_mov_b32 s56, 0xf
s_mul_i32 s70, s74, 128
s_add_u32 s70, s70, 18432
v_mov_b32 v1, s70
s_min_u32 s71, s71, 1
v_cmp_gt_u32 vcc, s71, v0
s_nop 1
v_cndmask_b32 v44, v3, v1, vcc
v_add_u32 v45, 65536, v44
s_getpc_b64 s[96:97]
pc_113:
s_add_u32 s96, s96, L_writers-pc_113
s_addc_u32 s97, s97, 0
v_subrev_u32 v23, 0, v22
v_lshrrev_b32 v23, 7, v23
v_cmp_gt_u32 vcc, 0x200, v23
s_nop 1
v_cndmask_b32 v23, 0, v23, vcc
global_load_ubyte v23, v23, s[96:97]
s_mul_i32 s77, s75, 32768
s_add_u32 s44, s77, 127995904
s_mov_b32 s45, 199270400
s_mov_b32 s52, 1
s_mov_b32 s53, 0
s_add_u32 s46, s77, 144773120
s_mov_b32 s47, 199270400
s_mov_b32 s54, 1
s_mov_b32 s55, 32768
s_mov_b32 s25, 200
s_mov_b32 s20, 262144
s_mov_b32 s21, 294912
s_mov_b32 s8, s42
s_and_b32 s9, s43, 0xffff
s_mov_b32 s10, 0
s_mov_b32 s11, 0x20000
s_mov_b32 s22, 0
s_mul_i32 s48, s3, 8192
s_add_u32 s49, s48, 36864
s_add_u32 s50, s48, 73728
s_add_u32 s51, s48, 110592
s_mov_b32 s57, 0xbfb8aa3b
v_add_u32 v28, 0, v17
v_add_u32 v29, 36864, v17
v_add_u32 v30, 73728, v17
v_add_u32 v31, 110592, v17
v_lshlrev_b32 v1, 2, v0
v_add_u32 v32, 147456, v1
s_lshl_b32 s70, s3, 8
v_add_u32 v18, s70, v32
v_mov_b64 v[224:225], 0
v_mov_b64 v[236:237], 0
v_mov_b64 v[226:227], 0
v_mov_b64 v[238:239], 0
v_mov_b64 v[228:229], 0
v_mov_b64 v[240:241], 0
v_mov_b64 v[230:231], 0
v_mov_b64 v[242:243], 0
s_mov_b32 s12, s40
s_and_b32 s13, s41, 0xffff
s_mov_b32 s14, 256
s_mov_b32 s15, 0x20000
v_lshlrev_b32 v26, 2, v0
v_add_u32 v27, 128, v26
v_cmp_le_u32 vcc, 2, v0
s_nop 1
v_cndmask_b32 v26, v26, v27, vcc
v_mov_b32 v27, 192
v_cmp_eq_u32 vcc, 8, v0
s_nop 1
v_cndmask_b32 v26, v26, v27, vcc
v_mov_b32 v27, 2147483632
v_cmp_lt_u32 vcc, 8, v0
s_nop 1
v_cndmask_b32 v26, v26, v27, vcc
s_mov_b32 s98, 0
wi_loop_119:
buffer_load_dword v27, v26, s[12:15], 0 offen sc1
s_add_u32 s98, s98, 1
s_cmp_gt_u32 s98, 150000
s_cbranch_scc1 wi_bad_121
s_waitcnt vmcnt(0)
v_cmp_eq_u32 vcc, 32, v27
s_nop 0
s_and_b32 s97, vcc_lo, 0x1ff
s_cmp_eq_u32 s97, 0x1ff
s_cbranch_scc1 wi_ok_120
v_cmp_lt_u32 vcc, 32, v27
s_nop 0
s_and_b32 s96, vcc_lo, 0xff
s_cselect_b32 s96, 0x100, 0
s_and_b32 s96, s96, s97
s_cbranch_scc1 wi_over_122
s_sleep 8
s_branch wi_loop_119
wi_bad_121:
s_mov_b32 s98, 512
s_branch L_fail
wi_over_122:
s_mov_b32 s100, 255
wi_ok_120:
v_add_u32 v26, 65536, v22
v_cmp_eq_u32 vcc, s100, v23
s_nop 1
v_cndmask_b32 v22, v22, v26, vcc
s_mov_b32 s90, 0
s_mov_b32 s91, 1879048192
s_mov_b32 s93, 1879048192
v_mov_b32 v34, 2147483632
s_barrier
s_mov_b32 s95, 1
s_cmp_lg_u32 s3, 0
s_cbranch_scc1 sp_ok_124_j
s_mov_b32 s23, 0
sp_loop_123:
buffer_load_dword v33, v22, s[4:7], 0 offen sc1
s_add_u32 s23, s23, 1
s_cmp_gt_u32 s23, 150000
s_cbranch_scc1 sp_bad_125
s_waitcnt vmcnt(0)
sp_loop_123_e:
v_cmp_gt_u32 vcc, s52, v33
v_cmp_gt_u32 s[58:59], s54, v33
s_and_b32 vcc_lo, vcc_lo, s56
s_cbranch_scc0 sp_ok_124
s_cmp_gt_u32 s23, 4
s_cselect_b32 s70, 0, s56
s_cmp_lg_u32 s95, 0
s_cselect_b32 s70, 0, s70
s_or_b32 s59, s59, s70
s_and_b32 s59, s59, s56
s_cbranch_scc0 sp_ok_124
s_sleep 1
s_branch sp_loop_123
sp_bad_125:
s_mov_b32 s98, 1029
s_branch L_fail
sp_ok_124:
ds_write_b32 v18, v33
s_waitcnt lgkmcnt(0)
sp_ok_124_j:
s_barrier
ds_read_b32 v33, v32
s_waitcnt lgkmcnt(0)
v_cmp_gt_u32 vcc, s52, v33
v_cmp_gt_u32 s[58:59], s54, v33
s_and_b32 vcc_lo, vcc_lo, s56
s_cselect_b32 s70, 0, 1
s_and_b32 s59, s59, s56
s_cselect_b32 s71, 0, 1
s_or_b32 s76, s70, s71
s_cselect_b32 s10, 268435456, 0
s_cmp_lg_u32 s70, 0
s_cselect_b64 s[72:73], s[52:53], s[54:55]
s_cselect_b64 s[58:59], s[44:45], s[46:47]
s_mul_i32 s74, s72, s20
s_add_u32 s74, s74, s58
s_mul_i32 s75, s72, s21
s_add_u32 s75, s75, s59
s_andn2_b32 s71, s71, s70
s_add_u32 s52, s52, s70
s_add_u32 s54, s54, s71
s_mov_b32 s77, s76
s_add_u32 m0, s48, 0
s_nop 0
buffer_load_dwordx4 v8, s[4:7], s74 offen offset:0 sc1 lds
buffer_load_dwordx4 v9, s[4:7], s74 offen offset:1024 sc1 lds
buffer_load_dwordx4 v10, s[4:7], s74 offen offset:2048 sc1 lds
buffer_load_dwordx4 v11, s[4:7], s74 offen offset:3072 sc1 lds
s_add_u32 m0, s48, 4096
s_nop 0
buffer_load_dwordx4 v12, s[4:7], s74 offen offset:0 sc1 lds
buffer_load_dwordx4 v13, s[4:7], s74 offen offset:1024 sc1 lds
buffer_load_dwordx4 v14, s[4:7], s74 offen offset:2048 sc1 lds
buffer_load_dwordx4 v15, s[4:7], s74 offen offset:3072 sc1 lds
buffer_load_dword v24, v22, s[4:7], 0 offen sc1
buffer_store_dword v27, v34, s[4:7], 0 offen
v_mov_b32 v27, s90
s_waitcnt vmcnt(8)
s_barrier
buffer_store_dword v27, v45, s[4:7], s91 offen
buffer_store_dword v27, v44, s[4:7], s91 offen sc1
s_mov_b32 s91, 1879048192
ds_read_b128 v[64:67], v28 offset:0
ds_read_b128 v[68:71], v28 offset:8192
ds_read_b128 v[72:75], v28 offset:16384
ds_read_b128 v[76:79], v28 offset:24576
ds_read_b128 v[80:83], v28 offset:1024
ds_read_b128 v[84:87], v28 offset:9216
ds_read_b128 v[88:91], v28 offset:17408
ds_read_b128 v[92:95], v28 offset:25600
s_waitcnt vmcnt(7)
s_barrier
s_branch g_body_114
g_body_114:
s_waitcnt lgkmcnt(4)
v_mfma_f32_16x16x32_bf16 v[208:211], a[0:3], v[64:67], 0
ds_read_b128 v[96:99], v28 offset:2048
v_mfma_f32_16x16x32_bf16 v[212:215], a[0:3], v[68:71], 0
ds_read_b128 v[100:103], v28 offset:10240
v_mfma_f32_16x16x32_bf16 v[216:219], a[72:75], v[64:67], 0
v_mfma_f32_16x16x32_bf16 v[208:211], a[4:7], v[72:75], v[208:211]
ds_read_b128 v[104:107], v28 offset:18432
v_cvt_pk_bf16_f32 v56, v224, v225
v_mfma_f32_16x16x32_bf16 v[212:215], a[4:7], v[76:79], v[212:215]
ds_read_b128 v[108:111], v28 offset:26624
v_cvt_pk_bf16_f32 v57, v226, v227
v_mfma_f32_16x16x32_bf16 v[220:223], a[72:75], v[68:71], 0
v_cvt_pk_bf16_f32 v58, v228, v229
s_waitcnt lgkmcnt(4)
v_mfma_f32_16x16x32_bf16 v[208:211], a[8:11], v[80:83], v[208:211]
ds_read_b128 v[112:115], v28 offset:3072
v_cvt_pk_bf16_f32 v59, v230, v231
v_mfma_f32_16x16x32_bf16 v[212:215], a[8:11], v[84:87], v[212:215]
ds_read_b128 v[116:119], v28 offset:11264
v_permlane16_swap_b32 v56, v58
v_mfma_f32_16x16x32_bf16 v[216:219], a[76:79], v[72:75], v[216:219]
v_permlane16_swap_b32 v57, v59
v_mfma_f32_16x16x32_bf16 v[208:211], a[12:15], v[88:91], v[208:211]
ds_read_b128 v[120:123], v28 offset:19456
v_mfma_f32_16x16x32_bf16 v[212:215], a[12:15], v[92:95], v[212:215]
ds_read_b128 v[124:127], v28 offset:27648
v_mfma_f32_16x16x32_bf16 v[220:223], a[76:79], v[76:79], v[220:223]
s_waitcnt lgkmcnt(4)
v_mfma_f32_16x16x32_bf16 v[208:211], a[16:19], v[96:99], v[208:211]
ds_read_b128 v[128:131], v28 offset:4096
v_mfma_f32_16x16x32_bf16 v[212:215], a[16:19], v[100:103], v[212:215]
ds_read_b128 v[132:135], v28 offset:12288
v_mfma_f32_16x16x32_bf16 v[216:219], a[80:83], v[80:83], v[216:219]
buffer_store_dwordx4 v[56:59], v21, s[4:7], s93 offen sc1
v_mfma_f32_16x16x32_bf16 v[208:211], a[20:23], v[104:107], v[208:211]
ds_read_b128 v[136:139], v28 offset:20480
v_mfma_f32_16x16x32_bf16 v[212:215], a[20:23], v[108:111], v[212:215]
ds_read_b128 v[140:143], v28 offset:28672
v_mfma_f32_16x16x32_bf16 v[220:223], a[80:83], v[84:87], v[220:223]
s_waitcnt vmcnt(5)
s_barrier
s_waitcnt lgkmcnt(4)
v_mfma_f32_16x16x32_bf16 v[208:211], a[24:27], v[112:115], v[208:211]
ds_read_b128 v[144:147], v28 offset:5120
v_mov_b32 v27, s90
v_mfma_f32_16x16x32_bf16 v[212:215], a[24:27], v[116:119], v[212:215]
ds_read_b128 v[148:151], v28 offset:13312
v_mfma_f32_16x16x32_bf16 v[216:219], a[84:87], v[88:91], v[216:219]
v_mfma_f32_16x16x32_bf16 v[208:211], a[28:31], v[120:123], v[208:211]
ds_read_b128 v[152:155], v28 offset:21504
v_mfma_f32_16x16x32_bf16 v[212:215], a[28:31], v[124:127], v[212:215]
ds_read_b128 v[156:159], v28 offset:29696
v_mfma_f32_16x16x32_bf16 v[220:223], a[84:87], v[92:95], v[220:223]
s_waitcnt lgkmcnt(4)
v_mfma_f32_16x16x32_bf16 v[208:211], a[32:35], v[128:131], v[208:211]
ds_read_b128 v[160:163], v28 offset:6144
v_mfma_f32_16x16x32_bf16 v[212:215], a[32:35], v[132:135], v[212:215]
ds_read_b128 v[164:167], v28 offset:14336
v_mfma_f32_16x16x32_bf16 v[216:219], a[88:91], v[96:99], v[216:219]
v_mfma_f32_16x16x32_bf16 v[208:211], a[36:39], v[136:139], v[208:211]
ds_read_b128 v[168:171], v28 offset:22528
s_waitcnt vmcnt(4)
ds_write_b32 v18, v24
v_mfma_f32_16x16x32_bf16 v[212:215], a[36:39], v[140:143], v[212:215]
ds_read_b128 v[172:175], v28 offset:30720
v_mfma_f32_16x16x32_bf16 v[220:223], a[88:91], v[100:103], v[220:223]
s_waitcnt lgkmcnt(5)
v_mfma_f32_16x16x32_bf16 v[208:211], a[40:43], v[144:147], v[208:211]
ds_read_b128 v[176:179], v28 offset:7168
s_waitcnt lgkmcnt(2)
s_barrier
v_mfma_f32_16x16x32_bf16 v[212:215], a[40:43], v[148:151], v[212:215]
ds_read_b128 v[180:183], v28 offset:15360
ds_read_b32 v33, v32
v_mfma_f32_16x16x32_bf16 v[216:219], a[92:95], v[104:107], v[216:219]
v_mfma_f32_16x16x32_bf16 v[208:211], a[44:47], v[152:155], v[208:211]
ds_read_b128 v[184:187], v28 offset:23552
v_mfma_f32_16x16x32_bf16 v[212:215], a[44:47], v[156:159], v[212:215]
ds_read_b128 v[188:191], v28 offset:31744
s_waitcnt lgkmcnt(2)
v_cmp_gt_u32 vcc, s52, v33
v_mfma_f32_16x16x32_bf16 v[220:223], a[92:95], v[108:111], v[220:223]
v_cmp_gt_u32 s[58:59], s54, v33
v_mfma_f32_16x16x32_bf16 v[208:211], a[48:51], v[160:163], v[208:211]
s_and_b32 vcc_lo, vcc_lo, s56
s_cselect_b32 s70, 0, 1
v_mfma_f32_16x16x32_bf16 v[212:215], a[48:51], v[164:167], v[212:215]
s_and_b32 s59, s59, s56
s_cselect_b32 s71, 0, s77
v_mfma_f32_16x16x32_bf16 v[216:219], a[96:99], v[112:115], v[216:219]
s_or_b32 s82, s70, s71
s_cselect_b32 s10, 268435456, 0
v_mfma_f32_16x16x32_bf16 v[208:211], a[52:55], v[168:171], v[208:211]
s_cmp_lg_u32 s70, 0
s_cselect_b64 s[78:79], s[52:53], s[54:55]
s_cselect_b64 s[58:59], s[44:45], s[46:47]
v_mfma_f32_16x16x32_bf16 v[212:215], a[52:55], v[172:175], v[212:215]
s_mul_i32 s80, s78, s20
s_add_u32 s80, s80, s58
v_mfma_f32_16x16x32_bf16 v[220:223], a[96:99], v[116:119], v[220:223]
s_add_u32 m0, s49, 0
s_waitcnt lgkmcnt(0)
v_mfma_f32_16x16x32_bf16 v[208:211], a[56:59], v[176:179], v[208:211]
buffer_load_dwordx4 v8, s[8:11], s80 offen offset:0 sc1 lds
v_mfma_f32_16x16x32_bf16 v[212:215], a[56:59], v[180:183], v[212:215]
s_mul_i32 s81, s78, s21
s_add_u32 s81, s81, s59
s_andn2_b32 s71, s71, s70
v_mfma_f32_16x16x32_bf16 v[216:219], a[100:103], v[120:123], v[216:219]
s_add_u32 s52, s52, s70
s_add_u32 s54, s54, s71
s_mov_b32 s83, s82
v_mfma_f32_16x16x32_bf16 v[208:211], a[60:63], v[184:187], v[208:211]
buffer_load_dwordx4 v9, s[8:11], s80 offen offset:1024 sc1 lds
v_mfma_f32_16x16x32_bf16 v[212:215], a[60:63], v[188:191], v[212:215]
v_mfma_f32_16x16x32_bf16 v[220:223], a[100:103], v[124:127], v[220:223]
v_mfma_f32_16x16x32_bf16 v[216:219], a[104:107], v[128:131], v[216:219]
buffer_load_dwordx4 v10, s[8:11], s80 offen offset:2048 sc1 lds
v_mfma_f32_16x16x32_bf16 v[220:223], a[104:107], v[132:135], v[220:223]
v_mfma_f32_16x16x32_bf16 v[216:219], a[108:111], v[136:139], v[216:219]
v_mfma_f32_16x16x32_bf16 v[220:223], a[108:111], v[140:143], v[220:223]
buffer_load_dwordx4 v11, s[8:11], s80 offen offset:3072 sc1 lds
v_mfma_f32_16x16x32_bf16 v[216:219], a[112:115], v[144:147], v[216:219]
v_cvt_pk_bf16_f32 v48, v208, v209
v_cvt_pk_bf16_f32 v49, v210, v211
v_mfma_f32_16x16x32_bf16 v[220:223], a[112:115], v[148:151], v[220:223]
s_add_u32 m0, s49, 4096
v_cvt_pk_bf16_f32 v50, v212, v213
v_mfma_f32_16x16x32_bf16 v[216:219], a[116:119], v[152:155], v[216:219]
buffer_load_dwordx4 v12, s[8:11], s80 offen offset:0 sc1 lds
v_mfma_f32_16x16x32_bf16 v[220:223], a[116:119], v[156:159], v[220:223]
v_cvt_pk_bf16_f32 v51, v214, v215
v_mfma_f32_16x16x32_bf16 v[216:219], a[120:123], v[160:163], v[216:219]
v_permlane16_swap_b32 v48, v50
v_mfma_f32_16x16x32_bf16 v[220:223], a[120:123], v[164:167], v[220:223]
buffer_load_dwordx4 v13, s[8:11], s80 offen offset:1024 sc1 lds
v_mfma_f32_16x16x32_bf16 v[216:219], a[124:127], v[168:171], v[216:219]
v_permlane16_swap_b32 v49, v51
v_mfma_f32_16x16x32_bf16 v[220:223], a[124:127], v[172:175], v[220:223]
buffer_store_dwordx4 v[48:51], v19, s[4:7], s75 offen sc1
v_mfma_f32_16x16x32_bf16 v[216:219], a[128:131], v[176:179], v[216:219]
buffer_load_dwordx4 v14, s[8:11], s80 offen offset:2048 sc1 lds
v_mfma_f32_16x16x32_bf16 v[220:223], a[128:131], v[180:183], v[220:223]
v_mfma_f32_16x16x32_bf16 v[216:219], a[132:135], v[184:187], v[216:219]
v_mfma_f32_16x16x32_bf16 v[220:223], a[132:135], v[188:191], v[220:223]
buffer_load_dwordx4 v15, s[8:11], s80 offen offset:3072 sc1 lds
v_mfma_f32_16x16x32_bf16 v[224:227], a[144:147], v[64:67], 0
v_mfma_f32_16x16x32_bf16 v[228:231], a[144:147], v[68:71], 0
v_mfma_f32_16x16x32_bf16 v[224:227], a[148:151], v[72:75], v[224:227]
v_mfma_f32_16x16x32_bf16 v[228:231], a[148:151], v[76:79], v[228:231]
buffer_load_dword v24, v22, s[4:7], 0 offen sc1
v_mfma_f32_16x16x32_bf16 v[224:227], a[152:155], v[80:83], v[224:227]
v_mfma_f32_16x16x32_bf16 v[228:231], a[152:155], v[84:87], v[228:231]
s_waitcnt vmcnt(10)
s_barrier
v_mfma_f32_16x16x32_bf16 v[224:227], a[156:159], v[88:91], v[224:227]
buffer_store_dword v27, v45, s[4:7], s91 offen
v_mfma_f32_16x16x32_bf16 v[228:231], a[156:159], v[92:95], v[228:231]
buffer_store_dword v27, v44, s[4:7], s91 offen sc1
v_mfma_f32_16x16x32_bf16 v[224:227], a[160:163], v[96:99], v[224:227]
v_cvt_pk_bf16_f32 v52, v216, v217
v_cvt_pk_bf16_f32 v53, v218, v219
v_mfma_f32_16x16x32_bf16 v[228:231], a[160:163], v[100:103], v[228:231]
v_cvt_pk_bf16_f32 v54, v220, v221
v_cvt_pk_bf16_f32 v55, v222, v223
v_mfma_f32_16x16x32_bf16 v[224:227], a[164:167], v[104:107], v[224:227]
v_permlane16_swap_b32 v52, v54
v_mfma_f32_16x16x32_bf16 v[228:231], a[164:167], v[108:111], v[228:231]
v_permlane16_swap_b32 v53, v55
v_mfma_f32_16x16x32_bf16 v[224:227], a[168:171], v[112:115], v[224:227]
buffer_store_dwordx4 v[52:55], v20, s[4:7], s75 offen sc1
v_mfma_f32_16x16x32_bf16 v[228:231], a[168:171], v[116:119], v[228:231]
v_mfma_f32_16x16x32_bf16 v[224:227], a[172:175], v[120:123], v[224:227]
v_mfma_f32_16x16x32_bf16 v[228:231], a[172:175], v[124:127], v[228:231]
v_mfma_f32_16x16x32_bf16 v[224:227], a[176:179], v[128:131], v[224:227]
v_mfma_f32_16x16x32_bf16 v[228:231], a[176:179], v[132:135], v[228:231]
v_mfma_f32_16x16x32_bf16 v[224:227], a[180:183], v[136:139], v[224:227]
v_mfma_f32_16x16x32_bf16 v[228:231], a[180:183], v[140:143], v[228:231]
v_mfma_f32_16x16x32_bf16 v[224:227], a[184:187], v[144:147], v[224:227]
s_waitcnt vmcnt(11)
s_barrier
v_mfma_f32_16x16x32_bf16 v[228:231], a[184:187], v[148:151], v[228:231]
v_mfma_f32_16x16x32_bf16 v[224:227], a[188:191], v[152:155], v[224:227]
s_cmp_eq_u32 s82, 0
s_cbranch_scc1 g_slow_126
v_mfma_f32_16x16x32_bf16 v[228:231], a[188:191], v[156:159], v[228:231]
ds_read_b128 v[64:67], v29 offset:0
v_mfma_f32_16x16x32_bf16 v[224:227], a[192:195], v[160:163], v[224:227]
ds_read_b128 v[68:71], v29 offset:8192
v_mfma_f32_16x16x32_bf16 v[228:231], a[192:195], v[164:167], v[228:231]
ds_read_b128 v[72:75], v29 offset:16384
v_mfma_f32_16x16x32_bf16 v[224:227], a[196:199], v[168:171], v[224:227]
ds_read_b128 v[76:79], v29 offset:24576
v_mfma_f32_16x16x32_bf16 v[228:231], a[196:199], v[172:175], v[228:231]
ds_read_b128 v[80:83], v29 offset:1024
v_mfma_f32_16x16x32_bf16 v[224:227], a[200:203], v[176:179], v[224:227]
ds_read_b128 v[84:87], v29 offset:9216
v_mfma_f32_16x16x32_bf16 v[228:231], a[200:203], v[180:183], v[228:231]
ds_read_b128 v[88:91], v29 offset:17408
v_mfma_f32_16x16x32_bf16 v[224:227], a[204:207], v[184:187], v[224:227]
ds_read_b128 v[92:95], v29 offset:25600
v_mfma_f32_16x16x32_bf16 v[228:231], a[204:207], v[188:191], v[228:231]
s_waitcnt vmcnt(8)
s_barrier
g_body_115:
s_waitcnt lgkmcnt(4)
v_mfma_f32_16x16x32_bf16 v[208:211], a[0:3], v[64:67], 0
ds_read_b128 v[96:99], v29 offset:2048
v_mfma_f32_16x16x32_bf16 v[212:215], a[0:3], v[68:71], 0
ds_read_b128 v[100:103], v29 offset:10240
v_mfma_f32_16x16x32_bf16 v[216:219], a[72:75], v[64:67], 0
v_mfma_f32_16x16x32_bf16 v[208:211], a[4:7], v[72:75], v[208:211]
ds_read_b128 v[104:107], v29 offset:18432
v_cvt_pk_bf16_f32 v56, v224, v225
v_mfma_f32_16x16x32_bf16 v[212:215], a[4:7], v[76:79], v[212:215]
ds_read_b128 v[108:111], v29 offset:26624
v_cvt_pk_bf16_f32 v57, v226, v227
v_mfma_f32_16x16x32_bf16 v[220:223], a[72:75], v[68:71], 0
v_cvt_pk_bf16_f32 v58, v228, v229
s_waitcnt lgkmcnt(4)
v_mfma_f32_16x16x32_bf16 v[208:211], a[8:11], v[80:83], v[208:211]
ds_read_b128 v[112:115], v29 offset:3072
v_cvt_pk_bf16_f32 v59, v230, v231
v_mfma_f32_16x16x32_bf16 v[212:215], a[8:11], v[84:87], v[212:215]
ds_read_b128 v[116:119], v29 offset:11264
v_permlane16_swap_b32 v56, v58
v_mfma_f32_16x16x32_bf16 v[216:219], a[76:79], v[72:75], v[216:219]
v_permlane16_swap_b32 v57, v59
v_mfma_f32_16x16x32_bf16 v[208:211], a[12:15], v[88:91], v[208:211]
ds_read_b128 v[120:123], v29 offset:19456
v_mfma_f32_16x16x32_bf16 v[212:215], a[12:15], v[92:95], v[212:215]
ds_read_b128 v[124:127], v29 offset:27648
v_mfma_f32_16x16x32_bf16 v[220:223], a[76:79], v[76:79], v[220:223]
s_waitcnt lgkmcnt(4)
v_mfma_f32_16x16x32_bf16 v[208:211], a[16:19], v[96:99], v[208:211]
ds_read_b128 v[128:131], v29 offset:4096
v_mfma_f32_16x16x32_bf16 v[212:215], a[16:19], v[100:103], v[212:215]
ds_read_b128 v[132:135], v29 offset:12288
v_mfma_f32_16x16x32_bf16 v[216:219], a[80:83], v[80:83], v[216:219]
buffer_store_dwordx4 v[56:59], v21, s[4:7], s75 offen sc1
v_mfma_f32_16x16x32_bf16 v[208:211], a[20:23], v[104:107], v[208:211]
ds_read_b128 v[136:139], v29 offset:20480
v_mfma_f32_16x16x32_bf16 v[212:215], a[20:23], v[108:111], v[212:215]
ds_read_b128 v[140:143], v29 offset:28672
v_mfma_f32_16x16x32_bf16 v[220:223], a[80:83], v[84:87], v[220:223]
s_waitcnt vmcnt(5)
s_barrier
s_waitcnt lgkmcnt(4)
v_mfma_f32_16x16x32_bf16 v[208:211], a[24:27], v[112:115], v[208:211]
ds_read_b128 v[144:147], v29 offset:5120
v_mov_b32 v27, s72
v_mfma_f32_16x16x32_bf16 v[212:215], a[24:27], v[116:119], v[212:215]
ds_read_b128 v[148:151], v29 offset:13312
v_mfma_f32_16x16x32_bf16 v[216:219], a[84:87], v[88:91], v[216:219]
v_mfma_f32_16x16x32_bf16 v[208:211], a[28:31], v[120:123], v[208:211]
ds_read_b128 v[152:155], v29 offset:21504
v_mfma_f32_16x16x32_bf16 v[212:215], a[28:31], v[124:127], v[212:215]
ds_read_b128 v[156:159], v29 offset:29696
v_mfma_f32_16x16x32_bf16 v[220:223], a[84:87], v[92:95], v[220:223]
s_waitcnt lgkmcnt(4)
v_mfma_f32_16x16x32_bf16 v[208:211], a[32:35], v[128:131], v[208:211]
ds_read_b128 v[160:163], v29 offset:6144
v_mfma_f32_16x16x32_bf16 v[212:215], a[32:35], v[132:135], v[212:215]
ds_read_b128 v[164:167], v29 offset:14336
v_mfma_f32_16x16x32_bf16 v[216:219], a[88:91], v[96:99], v[216:219]
v_mfma_f32_16x16x32_bf16 v[208:211], a[36:39], v[136:139], v[208:211]
ds_read_b128 v[168:171], v29 offset:22528
s_waitcnt vmcnt(4)
ds_write_b32 v18, v24
v_mfma_f32_16x16x32_bf16 v[212:215], a[36:39], v[140:143], v[212:215]
ds_read_b128 v[172:175], v29 offset:30720
v_mfma_f32_16x16x32_bf16 v[220:223], a[88:91], v[100:103], v[220:223]
s_waitcnt lgkmcnt(5)
v_mfma_f32_16x16x32_bf16 v[208:211], a[40:43], v[144:147], v[208:211]
ds_read_b128 v[176:179], v29 offset:7168
s_waitcnt lgkmcnt(2)
s_barrier
v_mfma_f32_16x16x32_bf16 v[212:215], a[40:43], v[148:151], v[212:215]
ds_read_b128 v[180:183], v29 offset:15360
ds_read_b32 v33, v32
v_mfma_f32_16x16x32_bf16 v[216:219], a[92:95], v[104:107], v[216:219]
v_mfma_f32_16x16x32_bf16 v[208:211], a[44:47], v[152:155], v[208:211]
ds_read_b128 v[184:187], v29 offset:23552
v_mfma_f32_16x16x32_bf16 v[212:215], a[44:47], v[156:159], v[212:215]
ds_read_b128 v[188:191], v29 offset:31744
s_waitcnt lgkmcnt(2)
v_cmp_gt_u32 vcc, s52, v33
v_mfma_f32_16x16x32_bf16 v[220:223], a[92:95], v[108:111], v[220:223]
v_cmp_gt_u32 s[58:59], s54, v33
v_mfma_f32_16x16x32_bf16 v[208:211], a[48:51], v[160:163], v[208:211]
s_and_b32 vcc_lo, vcc_lo, s56
s_cselect_b32 s70, 0, 1
v_mfma_f32_16x16x32_bf16 v[212:215], a[48:51], v[164:167], v[212:215]
s_and_b32 s59, s59, s56
s_cselect_b32 s71, 0, s83
v_mfma_f32_16x16x32_bf16 v[216:219], a[96:99], v[112:115], v[216:219]
s_or_b32 s88, s70, s71
s_cselect_b32 s10, 268435456, 0
v_mfma_f32_16x16x32_bf16 v[208:211], a[52:55], v[168:171], v[208:211]
s_cmp_lg_u32 s70, 0
s_cselect_b64 s[84:85], s[52:53], s[54:55]
s_cselect_b64 s[58:59], s[44:45], s[46:47]
v_mfma_f32_16x16x32_bf16 v[212:215], a[52:55], v[172:175], v[212:215]
s_mul_i32 s86, s84, s20
s_add_u32 s86, s86, s58
v_mfma_f32_16x16x32_bf16 v[220:223], a[96:99], v[116:119], v[220:223]
s_add_u32 m0, s50, 0
s_waitcnt lgkmcnt(0)
v_mfma_f32_16x16x32_bf16 v[208:211], a[56:59], v[176:179], v[208:211]
buffer_load_dwordx4 v8, s[8:11], s86 offen offset:0 sc1 lds
v_mfma_f32_16x16x32_bf16 v[212:215], a[56:59], v[180:183], v[212:215]
s_mul_i32 s87, s84, s21
s_add_u32 s87, s87, s59
s_andn2_b32 s71, s71, s70
v_mfma_f32_16x16x32_bf16 v[216:219], a[100:103], v[120:123], v[216:219]
s_add_u32 s52, s52, s70
s_add_u32 s54, s54, s71
s_mov_b32 s89, s88
v_mfma_f32_16x16x32_bf16 v[208:211], a[60:63], v[184:187], v[208:211]
buffer_load_dwordx4 v9, s[8:11], s86 offen offset:1024 sc1 lds
v_mfma_f32_16x16x32_bf16 v[212:215], a[60:63], v[188:191], v[212:215]
v_mfma_f32_16x16x32_bf16 v[220:223], a[100:103], v[124:127], v[220:223]
v_mfma_f32_16x16x32_bf16 v[216:219], a[104:107], v[128:131], v[216:219]
buffer_load_dwordx4 v10, s[8:11], s86 offen offset:2048 sc1 lds
v_mfma_f32_16x16x32_bf16 v[220:223], a[104:107], v[132:135], v[220:223]
v_mfma_f32_16x16x32_bf16 v[216:219], a[108:111], v[136:139], v[216:219]
v_mfma_f32_16x16x32_bf16 v[220:223], a[108:111], v[140:143], v[220:223]
buffer_load_dwordx4 v11, s[8:11], s86 offen offset:3072 sc1 lds
v_mfma_f32_16x16x32_bf16 v[216:219], a[112:115], v[144:147], v[216:219]
v_cvt_pk_bf16_f32 v48, v208, v209
v_cvt_pk_bf16_f32 v49, v210, v211
v_mfma_f32_16x16x32_bf16 v[220:223], a[112:115], v[148:151], v[220:223]
s_add_u32 m0, s50, 4096
v_cvt_pk_bf16_f32 v50, v212, v213
v_mfma_f32_16x16x32_bf16 v[216:219], a[116:119], v[152:155], v[216:219]
buffer_load_dwordx4 v12, s[8:11], s86 offen offset:0 sc1 lds
v_mfma_f32_16x16x32_bf16 v[220:223], a[116:119], v[156:159], v[220:223]
v_cvt_pk_bf16_f32 v51, v214, v215
v_mfma_f32_16x16x32_bf16 v[216:219], a[120:123], v[160:163], v[216:219]
v_permlane16_swap_b32 v48, v50
v_mfma_f32_16x16x32_bf16 v[220:223], a[120:123], v[164:167], v[220:223]
buffer_load_dwordx4 v13, s[8:11], s86 offen offset:1024 sc1 lds
v_mfma_f32_16x16x32_bf16 v[216:219], a[124:127], v[168:171], v[216:219]
v_permlane16_swap_b32 v49, v51
v_mfma_f32_16x16x32_bf16 v[220:223], a[124:127], v[172:175], v[220:223]
buffer_store_dwordx4 v[48:51], v19, s[4:7], s81 offen sc1
v_mfma_f32_16x16x32_bf16 v[216:219], a[128:131], v[176:179], v[216:219]
buffer_load_dwordx4 v14, s[8:11], s86 offen offset:2048 sc1 lds
v_mfma_f32_16x16x32_bf16 v[220:223], a[128:131], v[180:183], v[220:223]
v_mfma_f32_16x16x32_bf16 v[216:219], a[132:135], v[184:187], v[216:219]
v_mfma_f32_16x16x32_bf16 v[220:223], a[132:135], v[188:191], v[220:223]
buffer_load_dwordx4 v15, s[8:11], s86 offen offset:3072 sc1 lds
v_mfma_f32_16x16x32_bf16 v[224:227], a[144:147], v[64:67], 0
v_mfma_f32_16x16x32_bf16 v[228:231], a[144:147], v[68:71], 0
v_mfma_f32_16x16x32_bf16 v[224:227], a[148:151], v[72:75], v[224:227]
v_mfma_f32_16x16x32_bf16 v[228:231], a[148:151], v[76:79], v[228:231]
buffer_load_dword v24, v22, s[4:7], 0 offen sc1
v_mfma_f32_16x16x32_bf16 v[224:227], a[152:155], v[80:83], v[224:227]
v_mfma_f32_16x16x32_bf16 v[228:231], a[152:155], v[84:87], v[228:231]
s_waitcnt vmcnt(10)
s_barrier
v_mfma_f32_16x16x32_bf16 v[224:227], a[156:159], v[88:91], v[224:227]
buffer_store_dword v27, v45, s[4:7], s73 offen
v_mfma_f32_16x16x32_bf16 v[228:231], a[156:159], v[92:95], v[228:231]
buffer_store_dword v27, v44, s[4:7], s73 offen sc1
v_mfma_f32_16x16x32_bf16 v[224:227], a[160:163], v[96:99], v[224:227]
v_cvt_pk_bf16_f32 v52, v216, v217
v_cvt_pk_bf16_f32 v53, v218, v219
v_mfma_f32_16x16x32_bf16 v[228:231], a[160:163], v[100:103], v[228:231]
v_cvt_pk_bf16_f32 v54, v220, v221
v_cvt_pk_bf16_f32 v55, v222, v223
v_mfma_f32_16x16x32_bf16 v[224:227], a[164:167], v[104:107], v[224:227]
v_permlane16_swap_b32 v52, v54
v_mfma_f32_16x16x32_bf16 v[228:231], a[164:167], v[108:111], v[228:231]
v_permlane16_swap_b32 v53, v55
v_mfma_f32_16x16x32_bf16 v[224:227], a[168:171], v[112:115], v[224:227]
buffer_store_dwordx4 v[52:55], v20, s[4:7], s81 offen sc1
v_mfma_f32_16x16x32_bf16 v[228:231], a[168:171], v[116:119], v[228:231]
v_mfma_f32_16x16x32_bf16 v[224:227], a[172:175], v[120:123], v[224:227]
v_mfma_f32_16x16x32_bf16 v[228:231], a[172:175], v[124:127], v[228:231]
v_mfma_f32_16x16x32_bf16 v[224:227], a[176:179], v[128:131], v[224:227]
v_mfma_f32_16x16x32_bf16 v[228:231], a[176:179], v[132:135], v[228:231]
v_mfma_f32_16x16x32_bf16 v[224:227], a[180:183], v[136:139], v[224:227]
v_mfma_f32_16x16x32_bf16 v[228:231], a[180:183], v[140:143], v[228:231]
v_mfma_f32_16x16x32_bf16 v[224:227], a[184:187], v[144:147], v[224:227]
s_waitcnt vmcnt(11)
s_barrier
v_mfma_f32_16x16x32_bf16 v[228:231], a[184:187], v[148:151], v[228:231]
v_mfma_f32_16x16x32_bf16 v[224:227], a[188:191], v[152:155], v[224:227]
s_cmp_eq_u32 s88, 0
s_cbranch_scc1 g_slow_127
v_mfma_f32_16x16x32_bf16 v[228:231], a[188:191], v[156:159], v[228:231]
ds_read_b128 v[64:67], v30 offset:0
v_mfma_f32_16x16x32_bf16 v[224:227], a[192:195], v[160:163], v[224:227]
ds_read_b128 v[68:71], v30 offset:8192
v_mfma_f32_16x16x32_bf16 v[228:231], a[192:195], v[164:167], v[228:231]
ds_read_b128 v[72:75], v30 offset:16384
v_mfma_f32_16x16x32_bf16 v[224:227], a[196:199], v[168:171], v[224:227]
ds_read_b128 v[76:79], v30 offset:24576
v_mfma_f32_16x16x32_bf16 v[228:231], a[196:199], v[172:175], v[228:231]
ds_read_b128 v[80:83], v30 offset:1024
v_mfma_f32_16x16x32_bf16 v[224:227], a[200:203], v[176:179], v[224:227]
ds_read_b128 v[84:87], v30 offset:9216
v_mfma_f32_16x16x32_bf16 v[228:231], a[200:203], v[180:183], v[228:231]
ds_read_b128 v[88:91], v30 offset:17408
v_mfma_f32_16x16x32_bf16 v[224:227], a[204:207], v[184:187], v[224:227]
ds_read_b128 v[92:95], v30 offset:25600
v_mfma_f32_16x16x32_bf16 v[228:231], a[204:207], v[188:191], v[228:231]
s_waitcnt vmcnt(8)
s_barrier
g_body_116:
s_waitcnt lgkmcnt(4)
v_mfma_f32_16x16x32_bf16 v[208:211], a[0:3], v[64:67], 0
ds_read_b128 v[96:99], v30 offset:2048
v_mfma_f32_16x16x32_bf16 v[212:215], a[0:3], v[68:71], 0
ds_read_b128 v[100:103], v30 offset:10240
v_mfma_f32_16x16x32_bf16 v[216:219], a[72:75], v[64:67], 0
v_mfma_f32_16x16x32_bf16 v[208:211], a[4:7], v[72:75], v[208:211]
ds_read_b128 v[104:107], v30 offset:18432
v_cvt_pk_bf16_f32 v56, v224, v225
v_mfma_f32_16x16x32_bf16 v[212:215], a[4:7], v[76:79], v[212:215]
ds_read_b128 v[108:111], v30 offset:26624
v_cvt_pk_bf16_f32 v57, v226, v227
v_mfma_f32_16x16x32_bf16 v[220:223], a[72:75], v[68:71], 0
v_cvt_pk_bf16_f32 v58, v228, v229
s_waitcnt lgkmcnt(4)
v_mfma_f32_16x16x32_bf16 v[208:211], a[8:11], v[80:83], v[208:211]
ds_read_b128 v[112:115], v30 offset:3072
v_cvt_pk_bf16_f32 v59, v230, v231
v_mfma_f32_16x16x32_bf16 v[212:215], a[8:11], v[84:87], v[212:215]
ds_read_b128 v[116:119], v30 offset:11264
v_permlane16_swap_b32 v56, v58
v_mfma_f32_16x16x32_bf16 v[216:219], a[76:79], v[72:75], v[216:219]
v_permlane16_swap_b32 v57, v59
v_mfma_f32_16x16x32_bf16 v[208:211], a[12:15], v[88:91], v[208:211]
ds_read_b128 v[120:123], v30 offset:19456
v_mfma_f32_16x16x32_bf16 v[212:215], a[12:15], v[92:95], v[212:215]
ds_read_b128 v[124:127], v30 offset:27648
v_mfma_f32_16x16x32_bf16 v[220:223], a[76:79], v[76:79], v[220:223]
s_waitcnt lgkmcnt(4)
v_mfma_f32_16x16x32_bf16 v[208:211], a[16:19], v[96:99], v[208:211]
ds_read_b128 v[128:131], v30 offset:4096
v_mfma_f32_16x16x32_bf16 v[212:215], a[16:19], v[100:103], v[212:215]
ds_read_b128 v[132:135], v30 offset:12288
v_mfma_f32_16x16x32_bf16 v[216:219], a[80:83], v[80:83], v[216:219]
buffer_store_dwordx4 v[56:59], v21, s[4:7], s81 offen sc1
v_mfma_f32_16x16x32_bf16 v[208:211], a[20:23], v[104:107], v[208:211]
ds_read_b128 v[136:139], v30 offset:20480
v_mfma_f32_16x16x32_bf16 v[212:215], a[20:23], v[108:111], v[212:215]
ds_read_b128 v[140:143], v30 offset:28672
v_mfma_f32_16x16x32_bf16 v[220:223], a[80:83], v[84:87], v[220:223]
s_waitcnt vmcnt(5)
s_barrier
s_waitcnt lgkmcnt(4)
v_mfma_f32_16x16x32_bf16 v[208:211], a[24:27], v[112:115], v[208:211]
ds_read_b128 v[144:147], v30 offset:5120
v_mov_b32 v27, s78
v_mfma_f32_16x16x32_bf16 v[212:215], a[24:27], v[116:119], v[212:215]
ds_read_b128 v[148:151], v30 offset:13312
v_mfma_f32_16x16x32_bf16 v[216:219], a[84:87], v[88:91], v[216:219]
v_mfma_f32_16x16x32_bf16 v[208:211], a[28:31], v[120:123], v[208:211]
ds_read_b128 v[152:155], v30 offset:21504
v_mfma_f32_16x16x32_bf16 v[212:215], a[28:31], v[124:127], v[212:215]
ds_read_b128 v[156:159], v30 offset:29696
v_mfma_f32_16x16x32_bf16 v[220:223], a[84:87], v[92:95], v[220:223]
s_waitcnt lgkmcnt(4)
v_mfma_f32_16x16x32_bf16 v[208:211], a[32:35], v[128:131], v[208:211]
ds_read_b128 v[160:163], v30 offset:6144
v_mfma_f32_16x16x32_bf16 v[212:215], a[32:35], v[132:135], v[212:215]
ds_read_b128 v[164:167], v30 offset:14336
v_mfma_f32_16x16x32_bf16 v[216:219], a[88:91], v[96:99], v[216:219]
v_mfma_f32_16x16x32_bf16 v[208:211], a[36:39], v[136:139], v[208:211]
ds_read_b128 v[168:171], v30 offset:22528
s_waitcnt vmcnt(4)
ds_write_b32 v18, v24
v_mfma_f32_16x16x32_bf16 v[212:215], a[36:39], v[140:143], v[212:215]
ds_read_b128 v[172:175], v30 offset:30720
v_mfma_f32_16x16x32_bf16 v[220:223], a[88:91], v[100:103], v[220:223]
s_waitcnt lgkmcnt(5)
v_mfma_f32_16x16x32_bf16 v[208:211], a[40:43], v[144:147], v[208:211]
ds_read_b128 v[176:179], v30 offset:7168
s_waitcnt lgkmcnt(2)
s_barrier
v_mfma_f32_16x16x32_bf16 v[212:215], a[40:43], v[148:151], v[212:215]
ds_read_b128 v[180:183], v30 offset:15360
ds_read_b32 v33, v32
v_mfma_f32_16x16x32_bf16 v[216:219], a[92:95], v[104:107], v[216:219]
v_mfma_f32_16x16x32_bf16 v[208:211], a[44:47], v[152:155], v[208:211]
ds_read_b128 v[184:187], v30 offset:23552
v_mfma_f32_16x16x32_bf16 v[212:215], a[44:47], v[156:159], v[212:215]
ds_read_b128 v[188:191], v30 offset:31744
s_waitcnt lgkmcnt(2)
v_cmp_gt_u32 vcc, s52, v33
v_mfma_f32_16x16x32_bf16 v[220:223], a[92:95], v[108:111], v[220:223]
v_cmp_gt_u32 s[58:59], s54, v33
v_mfma_f32_16x16x32_bf16 v[208:211], a[48:51], v[160:163], v[208:211]
s_and_b32 vcc_lo, vcc_lo, s56
s_cselect_b32 s70, 0, 1
v_mfma_f32_16x16x32_bf16 v[212:215], a[48:51], v[164:167], v[212:215]
s_and_b32 s59, s59, s56
s_cselect_b32 s71, 0, s89
v_mfma_f32_16x16x32_bf16 v[216:219], a[96:99], v[112:115], v[216:219]
s_or_b32 s94, s70, s71
s_cselect_b32 s10, 268435456, 0
v_mfma_f32_16x16x32_bf16 v[208:211], a[52:55], v[168:171], v[208:211]
s_cmp_lg_u32 s70, 0
s_cselect_b64 s[90:91], s[52:53], s[54:55]
s_cselect_b64 s[58:59], s[44:45], s[46:47]
v_mfma_f32_16x16x32_bf16 v[212:215], a[52:55], v[172:175], v[212:215]
s_mul_i32 s92, s90, s20
s_add_u32 s92, s92, s58
v_mfma_f32_16x16x32_bf16 v[220:223], a[96:99], v[116:119], v[220:223]
s_add_u32 m0, s51, 0
s_waitcnt lgkmcnt(0)
v_mfma_f32_16x16x32_bf16 v[208:211], a[56:59], v[176:179], v[208:211]
buffer_load_dwordx4 v8, s[8:11], s92 offen offset:0 sc1 lds
v_mfma_f32_16x16x32_bf16 v[212:215], a[56:59], v[180:183], v[212:215]
s_mul_i32 s93, s90, s21
s_add_u32 s93, s93, s59
s_andn2_b32 s71, s71, s70
v_mfma_f32_16x16x32_bf16 v[216:219], a[100:103], v[120:123], v[216:219]
s_add_u32 s52, s52, s70
s_add_u32 s54, s54, s71
s_mov_b32 s95, s94
v_mfma_f32_16x16x32_bf16 v[208:211], a[60:63], v[184:187], v[208:211]
buffer_load_dwordx4 v9, s[8:11], s92 offen offset:1024 sc1 lds
v_mfma_f32_16x16x32_bf16 v[212:215], a[60:63], v[188:191], v[212:215]
v_mfma_f32_16x16x32_bf16 v[220:223], a[100:103], v[124:127], v[220:223]
v_mfma_f32_16x16x32_bf16 v[216:219], a[104:107], v[128:131], v[216:219]
buffer_load_dwordx4 v10, s[8:11], s92 offen offset:2048 sc1 lds
v_mfma_f32_16x16x32_bf16 v[220:223], a[104:107], v[132:135], v[220:223]
v_mfma_f32_16x16x32_bf16 v[216:219], a[108:111], v[136:139], v[216:219]
v_mfma_f32_16x16x32_bf16 v[220:223], a[108:111], v[140:143], v[220:223]
buffer_load_dwordx4 v11, s[8:11], s92 offen offset:3072 sc1 lds
v_mfma_f32_16x16x32_bf16 v[216:219], a[112:115], v[144:147], v[216:219]
v_cvt_pk_bf16_f32 v48, v208, v209
v_cvt_pk_bf16_f32 v49, v210, v211
v_mfma_f32_16x16x32_bf16 v[220:223], a[112:115], v[148:151], v[220:223]
s_add_u32 m0, s51, 4096
v_cvt_pk_bf16_f32 v50, v212, v213
v_mfma_f32_16x16x32_bf16 v[216:219], a[116:119], v[152:155], v[216:219]
buffer_load_dwordx4 v12, s[8:11], s92 offen offset:0 sc1 lds
v_mfma_f32_16x16x32_bf16 v[220:223], a[116:119], v[156:159], v[220:223]
v_cvt_pk_bf16_f32 v51, v214, v215
v_mfma_f32_16x16x32_bf16 v[216:219], a[120:123], v[160:163], v[216:219]
v_permlane16_swap_b32 v48, v50
v_mfma_f32_16x16x32_bf16 v[220:223], a[120:123], v[164:167], v[220:223]
buffer_load_dwordx4 v13, s[8:11], s92 offen offset:1024 sc1 lds
v_mfma_f32_16x16x32_bf16 v[216:219], a[124:127], v[168:171], v[216:219]
v_permlane16_swap_b32 v49, v51
v_mfma_f32_16x16x32_bf16 v[220:223], a[124:127], v[172:175], v[220:223]
buffer_store_dwordx4 v[48:51], v19, s[4:7], s87 offen sc1
v_mfma_f32_16x16x32_bf16 v[216:219], a[128:131], v[176:179], v[216:219]
buffer_load_dwordx4 v14, s[8:11], s92 offen offset:2048 sc1 lds
v_mfma_f32_16x16x32_bf16 v[220:223], a[128:131], v[180:183], v[220:223]
v_mfma_f32_16x16x32_bf16 v[216:219], a[132:135], v[184:187], v[216:219]
v_mfma_f32_16x16x32_bf16 v[220:223], a[132:135], v[188:191], v[220:223]
buffer_load_dwordx4 v15, s[8:11], s92 offen offset:3072 sc1 lds
v_mfma_f32_16x16x32_bf16 v[224:227], a[144:147], v[64:67], 0
v_mfma_f32_16x16x32_bf16 v[228:231], a[144:147], v[68:71], 0
v_mfma_f32_16x16x32_bf16 v[224:227], a[148:151], v[72:75], v[224:227]
v_mfma_f32_16x16x32_bf16 v[228:231], a[148:151], v[76:79], v[228:231]
buffer_load_dword v24, v22, s[4:7], 0 offen sc1
v_mfma_f32_16x16x32_bf16 v[224:227], a[152:155], v[80:83], v[224:227]
v_mfma_f32_16x16x32_bf16 v[228:231], a[152:155], v[84:87], v[228:231]
s_waitcnt vmcnt(10)
s_barrier
v_mfma_f32_16x16x32_bf16 v[224:227], a[156:159], v[88:91], v[224:227]
buffer_store_dword v27, v45, s[4:7], s79 offen
v_mfma_f32_16x16x32_bf16 v[228:231], a[156:159], v[92:95], v[228:231]
buffer_store_dword v27, v44, s[4:7], s79 offen sc1
v_mfma_f32_16x16x32_bf16 v[224:227], a[160:163], v[96:99], v[224:227]
v_cvt_pk_bf16_f32 v52, v216, v217
v_cvt_pk_bf16_f32 v53, v218, v219
v_mfma_f32_16x16x32_bf16 v[228:231], a[160:163], v[100:103], v[228:231]
v_cvt_pk_bf16_f32 v54, v220, v221
v_cvt_pk_bf16_f32 v55, v222, v223
v_mfma_f32_16x16x32_bf16 v[224:227], a[164:167], v[104:107], v[224:227]
v_permlane16_swap_b32 v52, v54
v_mfma_f32_16x16x32_bf16 v[228:231], a[164:167], v[108:111], v[228:231]
v_permlane16_swap_b32 v53, v55
v_mfma_f32_16x16x32_bf16 v[224:227], a[168:171], v[112:115], v[224:227]
buffer_store_dwordx4 v[52:55], v20, s[4:7], s87 offen sc1
v_mfma_f32_16x16x32_bf16 v[228:231], a[168:171], v[116:119], v[228:231]
v_mfma_f32_16x16x32_bf16 v[224:227], a[172:175], v[120:123], v[224:227]
v_mfma_f32_16x16x32_bf16 v[228:231], a[172:175], v[124:127], v[228:231]
v_mfma_f32_16x16x32_bf16 v[224:227], a[176:179], v[128:131], v[224:227]
v_mfma_f32_16x16x32_bf16 v[228:231], a[176:179], v[132:135], v[228:231]
v_mfma_f32_16x16x32_bf16 v[224:227], a[180:183], v[136:139], v[224:227]
v_mfma_f32_16x16x32_bf16 v[228:231], a[180:183], v[140:143], v[228:231]
v_mfma_f32_16x16x32_bf16 v[224:227], a[184:187], v[144:147], v[224:227]
s_waitcnt vmcnt(11)
s_barrier
v_mfma_f32_16x16x32_bf16 v[228:231], a[184:187], v[148:151], v[228:231]
v_mfma_f32_16x16x32_bf16 v[224:227], a[188:191], v[152:155], v[224:227]
s_cmp_eq_u32 s94, 0
s_cbranch_scc1 g_slow_128
v_mfma_f32_16x16x32_bf16 v[228:231], a[188:191], v[156:159], v[228:231]
ds_read_b128 v[64:67], v31 offset:0
v_mfma_f32_16x16x32_bf16 v[224:227], a[192:195], v[160:163], v[224:227]
ds_read_b128 v[68:71], v31 offset:8192
v_mfma_f32_16x16x32_bf16 v[228:231], a[192:195], v[164:167], v[228:231]
ds_read_b128 v[72:75], v31 offset:16384
v_mfma_f32_16x16x32_bf16 v[224:227], a[196:199], v[168:171], v[224:227]
ds_read_b128 v[76:79], v31 offset:24576
v_mfma_f32_16x16x32_bf16 v[228:231], a[196:199], v[172:175], v[228:231]
ds_read_b128 v[80:83], v31 offset:1024
v_mfma_f32_16x16x32_bf16 v[224:227], a[200:203], v[176:179], v[224:227]
ds_read_b128 v[84:87], v31 offset:9216
v_mfma_f32_16x16x32_bf16 v[228:231], a[200:203], v[180:183], v[228:231]
ds_read_b128 v[88:91], v31 offset:17408
v_mfma_f32_16x16x32_bf16 v[224:227], a[204:207], v[184:187], v[224:227]
ds_read_b128 v[92:95], v31 offset:25600
v_mfma_f32_16x16x32_bf16 v[228:231], a[204:207], v[188:191], v[228:231]
s_waitcnt vmcnt(8)
s_barrier
g_body_117:
s_waitcnt lgkmcnt(4)
v_mfma_f32_16x16x32_bf16 v[208:211], a[0:3], v[64:67], 0
ds_read_b128 v[96:99], v31 offset:2048
v_mfma_f32_16x16x32_bf16 v[212:215], a[0:3], v[68:71], 0
ds_read_b128 v[100:103], v31 offset:10240
v_mfma_f32_16x16x32_bf16 v[216:219], a[72:75], v[64:67], 0
v_mfma_f32_16x16x32_bf16 v[208:211], a[4:7], v[72:75], v[208:211]
ds_read_b128 v[104:107], v31 offset:18432
v_cvt_pk_bf16_f32 v56, v224, v225
v_mfma_f32_16x16x32_bf16 v[212:215], a[4:7], v[76:79], v[212:215]
ds_read_b128 v[108:111], v31 offset:26624
v_cvt_pk_bf16_f32 v57, v226, v227
v_mfma_f32_16x16x32_bf16 v[220:223], a[72:75], v[68:71], 0
v_cvt_pk_bf16_f32 v58, v228, v229
s_waitcnt lgkmcnt(4)
v_mfma_f32_16x16x32_bf16 v[208:211], a[8:11], v[80:83], v[208:211]
ds_read_b128 v[112:115], v31 offset:3072
v_cvt_pk_bf16_f32 v59, v230, v231
v_mfma_f32_16x16x32_bf16 v[212:215], a[8:11], v[84:87], v[212:215]
ds_read_b128 v[116:119], v31 offset:11264
v_permlane16_swap_b32 v56, v58
v_mfma_f32_16x16x32_bf16 v[216:219], a[76:79], v[72:75], v[216:219]
v_permlane16_swap_b32 v57, v59
v_mfma_f32_16x16x32_bf16 v[208:211], a[12:15], v[88:91], v[208:211]
ds_read_b128 v[120:123], v31 offset:19456
v_mfma_f32_16x16x32_bf16 v[212:215], a[12:15], v[92:95], v[212:215]
ds_read_b128 v[124:127], v31 offset:27648
v_mfma_f32_16x16x32_bf16 v[220:223], a[76:79], v[76:79], v[220:223]
s_waitcnt lgkmcnt(4)
v_mfma_f32_16x16x32_bf16 v[208:211], a[16:19], v[96:99], v[208:211]
ds_read_b128 v[128:131], v31 offset:4096
v_mfma_f32_16x16x32_bf16 v[212:215], a[16:19], v[100:103], v[212:215]
ds_read_b128 v[132:135], v31 offset:12288
v_mfma_f32_16x16x32_bf16 v[216:219], a[80:83], v[80:83], v[216:219]
buffer_store_dwordx4 v[56:59], v21, s[4:7], s87 offen sc1
v_mfma_f32_16x16x32_bf16 v[208:211], a[20:23], v[104:107], v[208:211]
ds_read_b128 v[136:139], v31 offset:20480
v_mfma_f32_16x16x32_bf16 v[212:215], a[20:23], v[108:111], v[212:215]
ds_read_b128 v[140:143], v31 offset:28672
v_mfma_f32_16x16x32_bf16 v[220:223], a[80:83], v[84:87], v[220:223]
s_waitcnt vmcnt(5)
s_barrier
s_waitcnt lgkmcnt(4)
v_mfma_f32_16x16x32_bf16 v[208:211], a[24:27], v[112:115], v[208:211]
ds_read_b128 v[144:147], v31 offset:5120
v_mov_b32 v27, s84
v_mfma_f32_16x16x32_bf16 v[212:215], a[24:27], v[116:119], v[212:215]
ds_read_b128 v[148:151], v31 offset:13312
v_mfma_f32_16x16x32_bf16 v[216:219], a[84:87], v[88:91], v[216:219]
v_mfma_f32_16x16x32_bf16 v[208:211], a[28:31], v[120:123], v[208:211]
ds_read_b128 v[152:155], v31 offset:21504
v_mfma_f32_16x16x32_bf16 v[212:215], a[28:31], v[124:127], v[212:215]
ds_read_b128 v[156:159], v31 offset:29696
v_mfma_f32_16x16x32_bf16 v[220:223], a[84:87], v[92:95], v[220:223]
s_waitcnt lgkmcnt(4)
v_mfma_f32_16x16x32_bf16 v[208:211], a[32:35], v[128:131], v[208:211]
ds_read_b128 v[160:163], v31 offset:6144
v_mfma_f32_16x16x32_bf16 v[212:215], a[32:35], v[132:135], v[212:215]
ds_read_b128 v[164:167], v31 offset:14336
v_mfma_f32_16x16x32_bf16 v[216:219], a[88:91], v[96:99], v[216:219]
v_mfma_f32_16x16x32_bf16 v[208:211], a[36:39], v[136:139], v[208:211]
ds_read_b128 v[168:171], v31 offset:22528
s_waitcnt vmcnt(4)
ds_write_b32 v18, v24
v_mfma_f32_16x16x32_bf16 v[212:215], a[36:39], v[140:143], v[212:215]
ds_read_b128 v[172:175], v31 offset:30720
v_mfma_f32_16x16x32_bf16 v[220:223], a[88:91], v[100:103], v[220:223]
s_waitcnt lgkmcnt(5)
v_mfma_f32_16x16x32_bf16 v[208:211], a[40:43], v[144:147], v[208:211]
ds_read_b128 v[176:179], v31 offset:7168
s_waitcnt lgkmcnt(2)
s_barrier
v_mfma_f32_16x16x32_bf16 v[212:215], a[40:43], v[148:151], v[212:215]
ds_read_b128 v[180:183], v31 offset:15360
ds_read_b32 v33, v32
v_mfma_f32_16x16x32_bf16 v[216:219], a[92:95], v[104:107], v[216:219]
v_mfma_f32_16x16x32_bf16 v[208:211], a[44:47], v[152:155], v[208:211]
ds_read_b128 v[184:187], v31 offset:23552
v_mfma_f32_16x16x32_bf16 v[212:215], a[44:47], v[156:159], v[212:215]
ds_read_b128 v[188:191], v31 offset:31744
s_waitcnt lgkmcnt(2)
v_cmp_gt_u32 vcc, s52, v33
v_mfma_f32_16x16x32_bf16 v[220:223], a[92:95], v[108:111], v[220:223]
v_cmp_gt_u32 s[58:59], s54, v33
v_mfma_f32_16x16x32_bf16 v[208:211], a[48:51], v[160:163], v[208:211]
s_and_b32 vcc_lo, vcc_lo, s56
s_cselect_b32 s70, 0, 1
v_mfma_f32_16x16x32_bf16 v[212:215], a[48:51], v[164:167], v[212:215]
s_and_b32 s59, s59, s56
s_cselect_b32 s71, 0, s95
v_mfma_f32_16x16x32_bf16 v[216:219], a[96:99], v[112:115], v[216:219]
s_or_b32 s76, s70, s71
s_cselect_b32 s10, 268435456, 0
v_mfma_f32_16x16x32_bf16 v[208:211], a[52:55], v[168:171], v[208:211]
s_cmp_lg_u32 s70, 0
s_cselect_b64 s[72:73], s[52:53], s[54:55]
s_cselect_b64 s[58:59], s[44:45], s[46:47]
v_mfma_f32_16x16x32_bf16 v[212:215], a[52:55], v[172:175], v[212:215]
s_mul_i32 s74, s72, s20
s_add_u32 s74, s74, s58
v_mfma_f32_16x16x32_bf16 v[220:223], a[96:99], v[116:119], v[220:223]
s_add_u32 m0, s48, 0
s_waitcnt lgkmcnt(0)
v_mfma_f32_16x16x32_bf16 v[208:211], a[56:59], v[176:179], v[208:211]
buffer_load_dwordx4 v8, s[8:11], s74 offen offset:0 sc1 lds
v_mfma_f32_16x16x32_bf16 v[212:215], a[56:59], v[180:183], v[212:215]
s_mul_i32 s75, s72, s21
s_add_u32 s75, s75, s59
s_andn2_b32 s71, s71, s70
v_mfma_f32_16x16x32_bf16 v[216:219], a[100:103], v[120:123], v[216:219]
s_add_u32 s52, s52, s70
s_add_u32 s54, s54, s71
s_mov_b32 s77, s76
v_mfma_f32_16x16x32_bf16 v[208:211], a[60:63], v[184:187], v[208:211]
buffer_load_dwordx4 v9, s[8:11], s74 offen offset:1024 sc1 lds
v_mfma_f32_16x16x32_bf16 v[212:215], a[60:63], v[188:191], v[212:215]
v_mfma_f32_16x16x32_bf16 v[220:223], a[100:103], v[124:127], v[220:223]
v_mfma_f32_16x16x32_bf16 v[216:219], a[104:107], v[128:131], v[216:219]
buffer_load_dwordx4 v10, s[8:11], s74 offen offset:2048 sc1 lds
v_mfma_f32_16x16x32_bf16 v[220:223], a[104:107], v[132:135], v[220:223]
v_mfma_f32_16x16x32_bf16 v[216:219], a[108:111], v[136:139], v[216:219]
v_mfma_f32_16x16x32_bf16 v[220:223], a[108:111], v[140:143], v[220:223]
buffer_load_dwordx4 v11, s[8:11], s74 offen offset:3072 sc1 lds
v_mfma_f32_16x16x32_bf16 v[216:219], a[112:115], v[144:147], v[216:219]
v_cvt_pk_bf16_f32 v48, v208, v209
v_cvt_pk_bf16_f32 v49, v210, v211
v_mfma_f32_16x16x32_bf16 v[220:223], a[112:115], v[148:151], v[220:223]
s_add_u32 m0, s48, 4096
v_cvt_pk_bf16_f32 v50, v212, v213
v_mfma_f32_16x16x32_bf16 v[216:219], a[116:119], v[152:155], v[216:219]
buffer_load_dwordx4 v12, s[8:11], s74 offen offset:0 sc1 lds
v_mfma_f32_16x16x32_bf16 v[220:223], a[116:119], v[156:159], v[220:223]
v_cvt_pk_bf16_f32 v51, v214, v215
v_mfma_f32_16x16x32_bf16 v[216:219], a[120:123], v[160:163], v[216:219]
v_permlane16_swap_b32 v48, v50
v_mfma_f32_16x16x32_bf16 v[220:223], a[120:123], v[164:167], v[220:223]
buffer_load_dwordx4 v13, s[8:11], s74 offen offset:1024 sc1 lds
v_mfma_f32_16x16x32_bf16 v[216:219], a[124:127], v[168:171], v[216:219]
v_permlane16_swap_b32 v49, v51
v_mfma_f32_16x16x32_bf16 v[220:223], a[124:127], v[172:175], v[220:223]
buffer_store_dwordx4 v[48:51], v19, s[4:7], s93 offen sc1
v_mfma_f32_16x16x32_bf16 v[216:219], a[128:131], v[176:179], v[216:219]
buffer_load_dwordx4 v14, s[8:11], s74 offen offset:2048 sc1 lds
v_mfma_f32_16x16x32_bf16 v[220:223], a[128:131], v[180:183], v[220:223]
v_mfma_f32_16x16x32_bf16 v[216:219], a[132:135], v[184:187], v[216:219]
v_mfma_f32_16x16x32_bf16 v[220:223], a[132:135], v[188:191], v[220:223]
buffer_load_dwordx4 v15, s[8:11], s74 offen offset:3072 sc1 lds
v_mfma_f32_16x16x32_bf16 v[224:227], a[144:147], v[64:67], 0
v_mfma_f32_16x16x32_bf16 v[228:231], a[144:147], v[68:71], 0
v_mfma_f32_16x16x32_bf16 v[224:227], a[148:151], v[72:75], v[224:227]
v_mfma_f32_16x16x32_bf16 v[228:231], a[148:151], v[76:79], v[228:231]
buffer_load_dword v24, v22, s[4:7], 0 offen sc1
v_mfma_f32_16x16x32_bf16 v[224:227], a[152:155], v[80:83], v[224:227]
v_mfma_f32_16x16x32_bf16 v[228:231], a[152:155], v[84:87], v[228:231]
s_waitcnt vmcnt(10)
s_barrier
v_mfma_f32_16x16x32_bf16 v[224:227], a[156:159], v[88:91], v[224:227]
buffer_store_dword v27, v45, s[4:7], s85 offen
v_mfma_f32_16x16x32_bf16 v[228:231], a[156:159], v[92:95], v[228:231]
buffer_store_dword v27, v44, s[4:7], s85 offen sc1
v_mfma_f32_16x16x32_bf16 v[224:227], a[160:163], v[96:99], v[224:227]
v_cvt_pk_bf16_f32 v52, v216, v217
v_cvt_pk_bf16_f32 v53, v218, v219
v_mfma_f32_16x16x32_bf16 v[228:231], a[160:163], v[100:103], v[228:231]
v_cvt_pk_bf16_f32 v54, v220, v221
v_cvt_pk_bf16_f32 v55, v222, v223
v_mfma_f32_16x16x32_bf16 v[224:227], a[164:167], v[104:107], v[224:227]
v_permlane16_swap_b32 v52, v54
v_mfma_f32_16x16x32_bf16 v[228:231], a[164:167], v[108:111], v[228:231]
v_permlane16_swap_b32 v53, v55
v_mfma_f32_16x16x32_bf16 v[224:227], a[168:171], v[112:115], v[224:227]
buffer_store_dwordx4 v[52:55], v20, s[4:7], s93 offen sc1
v_mfma_f32_16x16x32_bf16 v[228:231], a[168:171], v[116:119], v[228:231]
v_mfma_f32_16x16x32_bf16 v[224:227], a[172:175], v[120:123], v[224:227]
v_mfma_f32_16x16x32_bf16 v[228:231], a[172:175], v[124:127], v[228:231]
v_mfma_f32_16x16x32_bf16 v[224:227], a[176:179], v[128:131], v[224:227]
v_mfma_f32_16x16x32_bf16 v[228:231], a[176:179], v[132:135], v[228:231]
v_mfma_f32_16x16x32_bf16 v[224:227], a[180:183], v[136:139], v[224:227]
v_mfma_f32_16x16x32_bf16 v[228:231], a[180:183], v[140:143], v[228:231]
v_mfma_f32_16x16x32_bf16 v[224:227], a[184:187], v[144:147], v[224:227]
s_waitcnt vmcnt(11)
s_barrier
v_mfma_f32_16x16x32_bf16 v[228:231], a[184:187], v[148:151], v[228:231]
v_mfma_f32_16x16x32_bf16 v[224:227], a[188:191], v[152:155], v[224:227]
s_cmp_eq_u32 s76, 0
s_cbranch_scc1 g_slow_129
v_mfma_f32_16x16x32_bf16 v[228:231], a[188:191], v[156:159], v[228:231]
ds_read_b128 v[64:67], v28 offset:0
v_mfma_f32_16x16x32_bf16 v[224:227], a[192:195], v[160:163], v[224:227]
ds_read_b128 v[68:71], v28 offset:8192
v_mfma_f32_16x16x32_bf16 v[228:231], a[192:195], v[164:167], v[228:231]
ds_read_b128 v[72:75], v28 offset:16384
v_mfma_f32_16x16x32_bf16 v[224:227], a[196:199], v[168:171], v[224:227]
ds_read_b128 v[76:79], v28 offset:24576
v_mfma_f32_16x16x32_bf16 v[228:231], a[196:199], v[172:175], v[228:231]
ds_read_b128 v[80:83], v28 offset:1024
v_mfma_f32_16x16x32_bf16 v[224:227], a[200:203], v[176:179], v[224:227]
ds_read_b128 v[84:87], v28 offset:9216
v_mfma_f32_16x16x32_bf16 v[228:231], a[200:203], v[180:183], v[228:231]
ds_read_b128 v[88:91], v28 offset:17408
v_mfma_f32_16x16x32_bf16 v[224:227], a[204:207], v[184:187], v[224:227]
ds_read_b128 v[92:95], v28 offset:25600
v_mfma_f32_16x16x32_bf16 v[228:231], a[204:207], v[188:191], v[228:231]
s_waitcnt vmcnt(8)
s_barrier
s_branch g_body_114
g_slow_126:
v_mfma_f32_16x16x32_bf16 v[228:231], a[188:191], v[156:159], v[228:231]
v_mfma_f32_16x16x32_bf16 v[224:227], a[192:195], v[160:163], v[224:227]
v_mfma_f32_16x16x32_bf16 v[228:231], a[192:195], v[164:167], v[228:231]
v_mfma_f32_16x16x32_bf16 v[224:227], a[196:199], v[168:171], v[224:227]
v_mfma_f32_16x16x32_bf16 v[228:231], a[196:199], v[172:175], v[228:231]
v_mfma_f32_16x16x32_bf16 v[224:227], a[200:203], v[176:179], v[224:227]
v_mfma_f32_16x16x32_bf16 v[228:231], a[200:203], v[180:183], v[228:231]
v_mfma_f32_16x16x32_bf16 v[224:227], a[204:207], v[184:187], v[224:227]
v_mfma_f32_16x16x32_bf16 v[228:231], a[204:207], v[188:191], v[228:231]
s_nop 6
v_cvt_pk_bf16_f32 v56, v224, v225
v_cvt_pk_bf16_f32 v57, v226, v227
v_cvt_pk_bf16_f32 v58, v228, v229
v_cvt_pk_bf16_f32 v59, v230, v231
s_nop 0
v_permlane16_swap_b32 v56, v58
v_permlane16_swap_b32 v57, v59
buffer_store_dwordx4 v[56:59], v21, s[4:7], s75 offen sc1
s_mov_b32 s75, 1879048192
s_waitcnt vmcnt(4)
ds_write_b32 v18, v24
s_waitcnt lgkmcnt(0)
s_barrier
ds_read_b32 v33, v32
s_waitcnt lgkmcnt(0)
v_cmp_gt_u32 vcc, s52, v33
v_cmp_gt_u32 s[58:59], s54, v33
s_and_b32 vcc_lo, vcc_lo, s56
s_cselect_b32 s70, 0, 1
s_and_b32 s59, s59, s56
s_cselect_b32 s71, 0, s77
s_or_b32 s82, s70, s71
s_cselect_b32 s10, 268435456, 0
s_cmp_lg_u32 s70, 0
s_cselect_b64 s[78:79], s[52:53], s[54:55]
s_cselect_b64 s[58:59], s[44:45], s[46:47]
s_mul_i32 s80, s78, s20
s_add_u32 s80, s80, s58
s_mul_i32 s81, s78, s21
s_add_u32 s81, s81, s59
s_andn2_b32 s71, s71, s70
s_add_u32 s52, s52, s70
s_add_u32 s54, s54, s71
s_mov_b32 s83, s82
s_cmp_lg_u32 s82, 0
s_cbranch_scc1 g_go_130
v_mov_b32 v27, s72
s_waitcnt vmcnt(0)
s_barrier
s_add_u32 s70, s52, s54
s_cmp_eq_u32 s70, 130
s_cbranch_scc1 g_fin_118
s_cmp_lg_u32 s3, 0
s_cbranch_scc1 sp_ok_132_j
s_mov_b32 s23, 0
buffer_load_dword v33, v22, s[4:7], 0 offen sc1
buffer_store_dword v27, v45, s[4:7], s73 offen
buffer_store_dword v27, v44, s[4:7], s73 offen sc1
s_waitcnt vmcnt(2)
s_branch sp_loop_131_e
sp_loop_131:
buffer_load_dword v33, v22, s[4:7], 0 offen sc1
s_add_u32 s23, s23, 1
s_cmp_gt_u32 s23, 150000
s_cbranch_scc1 sp_bad_133
s_waitcnt vmcnt(0)
sp_loop_131_e:
v_cmp_gt_u32 vcc, s52, v33
v_cmp_gt_u32 s[58:59], s54, v33
s_and_b32 vcc_lo, vcc_lo, s56
s_cbranch_scc0 sp_ok_132
s_cmp_gt_u32 s23, 4
s_cselect_b32 s70, 0, s56
s_cmp_lg_u32 s77, 0
s_cselect_b32 s70, 0, s70
s_or_b32 s59, s59, s70
s_and_b32 s59, s59, s56
s_cbranch_scc0 sp_ok_132
s_sleep 1
s_branch sp_loop_131
sp_bad_133:
s_mov_b32 s98, 1029
s_branch L_fail
sp_ok_132:
ds_write_b32 v18, v33
s_waitcnt lgkmcnt(0)
sp_ok_132_j:
s_barrier
ds_read_b32 v33, v32
s_waitcnt lgkmcnt(0)
s_mov_b32 s73, 1879048192
v_cmp_gt_u32 vcc, s52, v33
v_cmp_gt_u32 s[58:59], s54, v33
s_and_b32 vcc_lo, vcc_lo, s56
s_cselect_b32 s70, 0, 1
s_and_b32 s59, s59, s56
s_cselect_b32 s71, 0, 1
s_or_b32 s82, s70, s71
s_cselect_b32 s10, 268435456, 0
s_cmp_lg_u32 s70, 0
s_cselect_b64 s[78:79], s[52:53], s[54:55]
s_cselect_b64 s[58:59], s[44:45], s[46:47]
s_mul_i32 s80, s78, s20
s_add_u32 s80, s80, s58
s_mul_i32 s81, s78, s21
s_add_u32 s81, s81, s59
s_andn2_b32 s71, s71, s70
s_add_u32 s52, s52, s70
s_add_u32 s54, s54, s71
s_mov_b32 s83, s82
g_go_130:
s_add_u32 m0, s49, 0
s_nop 0
buffer_load_dwordx4 v8, s[4:7], s80 offen offset:0 sc1 lds
buffer_load_dwordx4 v9, s[4:7], s80 offen offset:1024 sc1 lds
buffer_load_dwordx4 v10, s[4:7], s80 offen offset:2048 sc1 lds
buffer_load_dwordx4 v11, s[4:7], s80 offen offset:3072 sc1 lds
s_add_u32 m0, s49, 4096
s_nop 0
buffer_load_dwordx4 v12, s[4:7], s80 offen offset:0 sc1 lds
buffer_load_dwordx4 v13, s[4:7], s80 offen offset:1024 sc1 lds
buffer_load_dwordx4 v14, s[4:7], s80 offen offset:2048 sc1 lds
buffer_load_dwordx4 v15, s[4:7], s80 offen offset:3072 sc1 lds
buffer_load_dword v24, v22, s[4:7], 0 offen sc1
buffer_store_dword v27, v34, s[4:7], 0 offen
v_mov_b32 v27, s72
s_waitcnt vmcnt(8)
s_barrier
buffer_store_dword v27, v45, s[4:7], s73 offen
buffer_store_dword v27, v44, s[4:7], s73 offen sc1
s_mov_b32 s73, 1879048192
ds_read_b128 v[64:67], v29 offset:0
ds_read_b128 v[68:71], v29 offset:8192
ds_read_b128 v[72:75], v29 offset:16384
ds_read_b128 v[76:79], v29 offset:24576
ds_read_b128 v[80:83], v29 offset:1024
ds_read_b128 v[84:87], v29 offset:9216
ds_read_b128 v[88:91], v29 offset:17408
ds_read_b128 v[92:95], v29 offset:25600
s_waitcnt vmcnt(7)
s_barrier
s_branch g_body_115
g_slow_127:
v_mfma_f32_16x16x32_bf16 v[228:231], a[188:191], v[156:159], v[228:231]
v_mfma_f32_16x16x32_bf16 v[224:227], a[192:195], v[160:163], v[224:227]
v_mfma_f32_16x16x32_bf16 v[228:231], a[192:195], v[164:167], v[228:231]
v_mfma_f32_16x16x32_bf16 v[224:227], a[196:199], v[168:171], v[224:227]
v_mfma_f32_16x16x32_bf16 v[228:231], a[196:199], v[172:175], v[228:231]
v_mfma_f32_16x16x32_bf16 v[224:227], a[200:203], v[176:179], v[224:227]
v_mfma_f32_16x16x32_bf16 v[228:231], a[200:203], v[180:183], v[228:231]
v_mfma_f32_16x16x32_bf16 v[224:227], a[204:207], v[184:187], v[224:227]
v_mfma_f32_16x16x32_bf16 v[228:231], a[204:207], v[188:191], v[228:231]
s_nop 6
v_cvt_pk_bf16_f32 v56, v224, v225
v_cvt_pk_bf16_f32 v57, v226, v227
v_cvt_pk_bf16_f32 v58, v228, v229
v_cvt_pk_bf16_f32 v59, v230, v231
s_nop 0
v_permlane16_swap_b32 v56, v58
v_permlane16_swap_b32 v57, v59
buffer_store_dwordx4 v[56:59], v21, s[4:7], s81 offen sc1
s_mov_b32 s81, 1879048192
s_waitcnt vmcnt(4)
ds_write_b32 v18, v24
s_waitcnt lgkmcnt(0)
s_barrier
ds_read_b32 v33, v32
s_waitcnt lgkmcnt(0)
v_cmp_gt_u32 vcc, s52, v33
v_cmp_gt_u32 s[58:59], s54, v33
s_and_b32 vcc_lo, vcc_lo, s56
s_cselect_b32 s70, 0, 1
s_and_b32 s59, s59, s56
s_cselect_b32 s71, 0, s83
s_or_b32 s88, s70, s71
s_cselect_b32 s10, 268435456, 0
s_cmp_lg_u32 s70, 0
s_cselect_b64 s[84:85], s[52:53], s[54:55]
s_cselect_b64 s[58:59], s[44:45], s[46:47]
s_mul_i32 s86, s84, s20
s_add_u32 s86, s86, s58
s_mul_i32 s87, s84, s21
s_add_u32 s87, s87, s59
s_andn2_b32 s71, s71, s70
s_add_u32 s52, s52, s70
s_add_u32 s54, s54, s71
s_mov_b32 s89, s88
s_cmp_lg_u32 s88, 0
s_cbranch_scc1 g_go_134
v_mov_b32 v27, s78
s_waitcnt vmcnt(0)
s_barrier
s_add_u32 s70, s52, s54
s_cmp_eq_u32 s70, 130
s_cbranch_scc1 g_fin_118
s_cmp_lg_u32 s3, 0
s_cbranch_scc1 sp_ok_136_j
s_mov_b32 s23, 0
buffer_load_dword v33, v22, s[4:7], 0 offen sc1
buffer_store_dword v27, v45, s[4:7], s79 offen
buffer_store_dword v27, v44, s[4:7], s79 offen sc1
s_waitcnt vmcnt(2)
s_branch sp_loop_135_e
sp_loop_135:
buffer_load_dword v33, v22, s[4:7], 0 offen sc1
s_add_u32 s23, s23, 1
s_cmp_gt_u32 s23, 150000
s_cbranch_scc1 sp_bad_137
s_waitcnt vmcnt(0)
sp_loop_135_e:
v_cmp_gt_u32 vcc, s52, v33
v_cmp_gt_u32 s[58:59], s54, v33
s_and_b32 vcc_lo, vcc_lo, s56
s_cbranch_scc0 sp_ok_136
s_cmp_gt_u32 s23, 4
s_cselect_b32 s70, 0, s56
s_cmp_lg_u32 s83, 0
s_cselect_b32 s70, 0, s70
s_or_b32 s59, s59, s70
s_and_b32 s59, s59, s56
s_cbranch_scc0 sp_ok_136
s_sleep 1
s_branch sp_loop_135
sp_bad_137:
s_mov_b32 s98, 1029
s_branch L_fail
sp_ok_136:
ds_write_b32 v18, v33
s_waitcnt lgkmcnt(0)
sp_ok_136_j:
s_barrier
ds_read_b32 v33, v32
s_waitcnt lgkmcnt(0)
s_mov_b32 s79, 1879048192
v_cmp_gt_u32 vcc, s52, v33
v_cmp_gt_u32 s[58:59], s54, v33
s_and_b32 vcc_lo, vcc_lo, s56
s_cselect_b32 s70, 0, 1
s_and_b32 s59, s59, s56
s_cselect_b32 s71, 0, 1
s_or_b32 s88, s70, s71
s_cselect_b32 s10, 268435456, 0
s_cmp_lg_u32 s70, 0
s_cselect_b64 s[84:85], s[52:53], s[54:55]
s_cselect_b64 s[58:59], s[44:45], s[46:47]
s_mul_i32 s86, s84, s20
s_add_u32 s86, s86, s58
s_mul_i32 s87, s84, s21
s_add_u32 s87, s87, s59
s_andn2_b32 s71, s71, s70
s_add_u32 s52, s52, s70
s_add_u32 s54, s54, s71
s_mov_b32 s89, s88
g_go_134:
s_add_u32 m0, s50, 0
s_nop 0
buffer_load_dwordx4 v8, s[4:7], s86 offen offset:0 sc1 lds
buffer_load_dwordx4 v9, s[4:7], s86 offen offset:1024 sc1 lds
buffer_load_dwordx4 v10, s[4:7], s86 offen offset:2048 sc1 lds
buffer_load_dwordx4 v11, s[4:7], s86 offen offset:3072 sc1 lds
s_add_u32 m0, s50, 4096
s_nop 0
buffer_load_dwordx4 v12, s[4:7], s86 offen offset:0 sc1 lds
buffer_load_dwordx4 v13, s[4:7], s86 offen offset:1024 sc1 lds
buffer_load_dwordx4 v14, s[4:7], s86 offen offset:2048 sc1 lds
buffer_load_dwordx4 v15, s[4:7], s86 offen offset:3072 sc1 lds
buffer_load_dword v24, v22, s[4:7], 0 offen sc1
buffer_store_dword v27, v34, s[4:7], 0 offen
v_mov_b32 v27, s78
s_waitcnt vmcnt(8)
s_barrier
buffer_store_dword v27, v45, s[4:7], s79 offen
buffer_store_dword v27, v44, s[4:7], s79 offen sc1
s_mov_b32 s79, 1879048192
ds_read_b128 v[64:67], v30 offset:0
ds_read_b128 v[68:71], v30 offset:8192
ds_read_b128 v[72:75], v30 offset:16384
ds_read_b128 v[76:79], v30 offset:24576
ds_read_b128 v[80:83], v30 offset:1024
ds_read_b128 v[84:87], v30 offset:9216
ds_read_b128 v[88:91], v30 offset:17408
ds_read_b128 v[92:95], v30 offset:25600
s_waitcnt vmcnt(7)
s_barrier
s_branch g_body_116
g_slow_128:
v_mfma_f32_16x16x32_bf16 v[228:231], a[188:191], v[156:159], v[228:231]
v_mfma_f32_16x16x32_bf16 v[224:227], a[192:195], v[160:163], v[224:227]
v_mfma_f32_16x16x32_bf16 v[228:231], a[192:195], v[164:167], v[228:231]
v_mfma_f32_16x16x32_bf16 v[224:227], a[196:199], v[168:171], v[224:227]
v_mfma_f32_16x16x32_bf16 v[228:231], a[196:199], v[172:175], v[228:231]
v_mfma_f32_16x16x32_bf16 v[224:227], a[200:203], v[176:179], v[224:227]
v_mfma_f32_16x16x32_bf16 v[228:231], a[200:203], v[180:183], v[228:231]
v_mfma_f32_16x16x32_bf16 v[224:227], a[204:207], v[184:187], v[224:227]
v_mfma_f32_16x16x32_bf16 v[228:231], a[204:207], v[188:191], v[228:231]
s_nop 6
v_cvt_pk_bf16_f32 v56, v224, v225
v_cvt_pk_bf16_f32 v57, v226, v227
v_cvt_pk_bf16_f32 v58, v228, v229
v_cvt_pk_bf16_f32 v59, v230, v231
s_nop 0
v_permlane16_swap_b32 v56, v58
v_permlane16_swap_b32 v57, v59
buffer_store_dwordx4 v[56:59], v21, s[4:7], s87 offen sc1
s_mov_b32 s87, 1879048192
s_waitcnt vmcnt(4)
ds_write_b32 v18, v24
s_waitcnt lgkmcnt(0)
s_barrier
ds_read_b32 v33, v32
s_waitcnt lgkmcnt(0)
v_cmp_gt_u32 vcc, s52, v33
v_cmp_gt_u32 s[58:59], s54, v33
s_and_b32 vcc_lo, vcc_lo, s56
s_cselect_b32 s70, 0, 1
s_and_b32 s59, s59, s56
s_cselect_b32 s71, 0, s89
s_or_b32 s94, s70, s71
s_cselect_b32 s10, 268435456, 0
s_cmp_lg_u32 s70, 0
s_cselect_b64 s[90:91], s[52:53], s[54:55]
s_cselect_b64 s[58:59], s[44:45], s[46:47]
s_mul_i32 s92, s90, s20
s_add_u32 s92, s92, s58
s_mul_i32 s93, s90, s21
s_add_u32 s93, s93, s59
s_andn2_b32 s71, s71, s70
s_add_u32 s52, s52, s70
s_add_u32 s54, s54, s71
s_mov_b32 s95, s94
s_cmp_lg_u32 s94, 0
s_cbranch_scc1 g_go_138
v_mov_b32 v27, s84
s_waitcnt vmcnt(0)
s_barrier
s_add_u32 s70, s52, s54
s_cmp_eq_u32 s70, 130
s_cbranch_scc1 g_fin_118
s_cmp_lg_u32 s3, 0
s_cbranch_scc1 sp_ok_140_j
s_mov_b32 s23, 0
buffer_load_dword v33, v22, s[4:7], 0 offen sc1
buffer_store_dword v27, v45, s[4:7], s85 offen
buffer_store_dword v27, v44, s[4:7], s85 offen sc1
s_waitcnt vmcnt(2)
s_branch sp_loop_139_e
sp_loop_139:
buffer_load_dword v33, v22, s[4:7], 0 offen sc1
s_add_u32 s23, s23, 1
s_cmp_gt_u32 s23, 150000
s_cbranch_scc1 sp_bad_141
s_waitcnt vmcnt(0)
sp_loop_139_e:
v_cmp_gt_u32 vcc, s52, v33
v_cmp_gt_u32 s[58:59], s54, v33
s_and_b32 vcc_lo, vcc_lo, s56
s_cbranch_scc0 sp_ok_140
s_cmp_gt_u32 s23, 4
s_cselect_b32 s70, 0, s56
s_cmp_lg_u32 s89, 0
s_cselect_b32 s70, 0, s70
s_or_b32 s59, s59, s70
s_and_b32 s59, s59, s56
s_cbranch_scc0 sp_ok_140
s_sleep 1
s_branch sp_loop_139
sp_bad_141:
s_mov_b32 s98, 1029
s_branch L_fail
sp_ok_140:
ds_write_b32 v18, v33
s_waitcnt lgkmcnt(0)
sp_ok_140_j:
s_barrier
ds_read_b32 v33, v32
s_waitcnt lgkmcnt(0)
s_mov_b32 s85, 1879048192
v_cmp_gt_u32 vcc, s52, v33
v_cmp_gt_u32 s[58:59], s54, v33
s_and_b32 vcc_lo, vcc_lo, s56
s_cselect_b32 s70, 0, 1
s_and_b32 s59, s59, s56
s_cselect_b32 s71, 0, 1
s_or_b32 s94, s70, s71
s_cselect_b32 s10, 268435456, 0
s_cmp_lg_u32 s70, 0
s_cselect_b64 s[90:91], s[52:53], s[54:55]
s_cselect_b64 s[58:59], s[44:45], s[46:47]
s_mul_i32 s92, s90, s20
s_add_u32 s92, s92, s58
s_mul_i32 s93, s90, s21
s_add_u32 s93, s93, s59
s_andn2_b32 s71, s71, s70
s_add_u32 s52, s52, s70
s_add_u32 s54, s54, s71
s_mov_b32 s95, s94
g_go_138:
s_add_u32 m0, s51, 0
s_nop 0
buffer_load_dwordx4 v8, s[4:7], s92 offen offset:0 sc1 lds
buffer_load_dwordx4 v9, s[4:7], s92 offen offset:1024 sc1 lds
buffer_load_dwordx4 v10, s[4:7], s92 offen offset:2048 sc1 lds
buffer_load_dwordx4 v11, s[4:7], s92 offen offset:3072 sc1 lds
s_add_u32 m0, s51, 4096
s_nop 0
buffer_load_dwordx4 v12, s[4:7], s92 offen offset:0 sc1 lds
buffer_load_dwordx4 v13, s[4:7], s92 offen offset:1024 sc1 lds
buffer_load_dwordx4 v14, s[4:7], s92 offen offset:2048 sc1 lds
buffer_load_dwordx4 v15, s[4:7], s92 offen offset:3072 sc1 lds
buffer_load_dword v24, v22, s[4:7], 0 offen sc1
buffer_store_dword v27, v34, s[4:7], 0 offen
v_mov_b32 v27, s84
s_waitcnt vmcnt(8)
s_barrier
buffer_store_dword v27, v45, s[4:7], s85 offen
buffer_store_dword v27, v44, s[4:7], s85 offen sc1
s_mov_b32 s85, 1879048192
ds_read_b128 v[64:67], v31 offset:0
ds_read_b128 v[68:71], v31 offset:8192
ds_read_b128 v[72:75], v31 offset:16384
ds_read_b128 v[76:79], v31 offset:24576
ds_read_b128 v[80:83], v31 offset:1024
ds_read_b128 v[84:87], v31 offset:9216
ds_read_b128 v[88:91], v31 offset:17408
ds_read_b128 v[92:95], v31 offset:25600
s_waitcnt vmcnt(7)
s_barrier
s_branch g_body_117
g_slow_129:
v_mfma_f32_16x16x32_bf16 v[228:231], a[188:191], v[156:159], v[228:231]
v_mfma_f32_16x16x32_bf16 v[224:227], a[192:195], v[160:163], v[224:227]
v_mfma_f32_16x16x32_bf16 v[228:231], a[192:195], v[164:167], v[228:231]
v_mfma_f32_16x16x32_bf16 v[224:227], a[196:199], v[168:171], v[224:227]
v_mfma_f32_16x16x32_bf16 v[228:231], a[196:199], v[172:175], v[228:231]
v_mfma_f32_16x16x32_bf16 v[224:227], a[200:203], v[176:179], v[224:227]
v_mfma_f32_16x16x32_bf16 v[228:231], a[200:203], v[180:183], v[228:231]
v_mfma_f32_16x16x32_bf16 v[224:227], a[204:207], v[184:187], v[224:227]
v_mfma_f32_16x16x32_bf16 v[228:231], a[204:207], v[188:191], v[228:231]
s_nop 6
v_cvt_pk_bf16_f32 v56, v224, v225
v_cvt_pk_bf16_f32 v57, v226, v227
v_cvt_pk_bf16_f32 v58, v228, v229
v_cvt_pk_bf16_f32 v59, v230, v231
s_nop 0
v_permlane16_swap_b32 v56, v58
v_permlane16_swap_b32 v57, v59
buffer_store_dwordx4 v[56:59], v21, s[4:7], s93 offen sc1
s_mov_b32 s93, 1879048192
s_waitcnt vmcnt(4)
ds_write_b32 v18, v24
s_waitcnt lgkmcnt(0)
s_barrier
ds_read_b32 v33, v32
s_waitcnt lgkmcnt(0)
v_cmp_gt_u32 vcc, s52, v33
v_cmp_gt_u32 s[58:59], s54, v33
s_and_b32 vcc_lo, vcc_lo, s56
s_cselect_b32 s70, 0, 1
s_and_b32 s59, s59, s56
s_cselect_b32 s71, 0, s95
s_or_b32 s76, s70, s71
s_cselect_b32 s10, 268435456, 0
s_cmp_lg_u32 s70, 0
s_cselect_b64 s[72:73], s[52:53], s[54:55]
s_cselect_b64 s[58:59], s[44:45], s[46:47]
s_mul_i32 s74, s72, s20
s_add_u32 s74, s74, s58
s_mul_i32 s75, s72, s21
s_add_u32 s75, s75, s59
s_andn2_b32 s71, s71, s70
s_add_u32 s52, s52, s70
s_add_u32 s54, s54, s71
s_mov_b32 s77, s76
s_cmp_lg_u32 s76, 0
s_cbranch_scc1 g_go_142
v_mov_b32 v27, s90
s_waitcnt vmcnt(0)
s_barrier
s_add_u32 s70, s52, s54
s_cmp_eq_u32 s70, 130
s_cbranch_scc1 g_fin_118
s_cmp_lg_u32 s3, 0
s_cbranch_scc1 sp_ok_144_j
s_mov_b32 s23, 0
buffer_load_dword v33, v22, s[4:7], 0 offen sc1
buffer_store_dword v27, v45, s[4:7], s91 offen
buffer_store_dword v27, v44, s[4:7], s91 offen sc1
s_waitcnt vmcnt(2)
s_branch sp_loop_143_e
sp_loop_143:
buffer_load_dword v33, v22, s[4:7], 0 offen sc1
s_add_u32 s23, s23, 1
s_cmp_gt_u32 s23, 150000
s_cbranch_scc1 sp_bad_145
s_waitcnt vmcnt(0)
sp_loop_143_e:
v_cmp_gt_u32 vcc, s52, v33
v_cmp_gt_u32 s[58:59], s54, v33
s_and_b32 vcc_lo, vcc_lo, s56
s_cbranch_scc0 sp_ok_144
s_cmp_gt_u32 s23, 4
s_cselect_b32 s70, 0, s56
s_cmp_lg_u32 s95, 0
s_cselect_b32 s70, 0, s70
s_or_b32 s59, s59, s70
s_and_b32 s59, s59, s56
s_cbranch_scc0 sp_ok_144
s_sleep 1
s_branch sp_loop_143
sp_bad_145:
s_mov_b32 s98, 1029
s_branch L_fail
sp_ok_144:
ds_write_b32 v18, v33
s_waitcnt lgkmcnt(0)
sp_ok_144_j:
s_barrier
ds_read_b32 v33, v32
s_waitcnt lgkmcnt(0)
s_mov_b32 s91, 1879048192
v_cmp_gt_u32 vcc, s52, v33
v_cmp_gt_u32 s[58:59], s54, v33
s_and_b32 vcc_lo, vcc_lo, s56
s_cselect_b32 s70, 0, 1
s_and_b32 s59, s59, s56
s_cselect_b32 s71, 0, 1
s_or_b32 s76, s70, s71
s_cselect_b32 s10, 268435456, 0
s_cmp_lg_u32 s70, 0
s_cselect_b64 s[72:73], s[52:53], s[54:55]
s_cselect_b64 s[58:59], s[44:45], s[46:47]
s_mul_i32 s74, s72, s20
s_add_u32 s74, s74, s58
s_mul_i32 s75, s72, s21
s_add_u32 s75, s75, s59
s_andn2_b32 s71, s71, s70
s_add_u32 s52, s52, s70
s_add_u32 s54, s54, s71
s_mov_b32 s77, s76
g_go_142:
s_add_u32 m0, s48, 0
s_nop 0
buffer_load_dwordx4 v8, s[4:7], s74 offen offset:0 sc1 lds
buffer_load_dwordx4 v9, s[4:7], s74 offen offset:1024 sc1 lds
buffer_load_dwordx4 v10, s[4:7], s74 offen offset:2048 sc1 lds
buffer_load_dwordx4 v11, s[4:7], s74 offen offset:3072 sc1 lds
s_add_u32 m0, s48, 4096
s_nop 0
buffer_load_dwordx4 v12, s[4:7], s74 offen offset:0 sc1 lds
buffer_load_dwordx4 v13, s[4:7], s74 offen offset:1024 sc1 lds
buffer_load_dwordx4 v14, s[4:7], s74 offen offset:2048 sc1 lds
buffer_load_dwordx4 v15, s[4:7], s74 offen offset:3072 sc1 lds
buffer_load_dword v24, v22, s[4:7], 0 offen sc1
buffer_store_dword v27, v34, s[4:7], 0 offen
v_mov_b32 v27, s90
s_waitcnt vmcnt(8)
s_barrier
buffer_store_dword v27, v45, s[4:7], s91 offen
buffer_store_dword v27, v44, s[4:7], s91 offen sc1
s_mov_b32 s91, 1879048192
ds_read_b128 v[64:67], v28 offset:0
ds_read_b128 v[68:71], v28 offset:8192
ds_read_b128 v[72:75], v28 offset:16384
ds_read_b128 v[76:79], v28 offset:24576
ds_read_b128 v[80:83], v28 offset:1024
ds_read_b128 v[84:87], v28 offset:9216
ds_read_b128 v[88:91], v28 offset:17408
ds_read_b128 v[92:95], v28 offset:25600
s_waitcnt vmcnt(7)
s_barrier
s_branch g_body_114
g_fin_118:
buffer_store_dword v27, v45, s[4:7], s91 offen
buffer_store_dword v27, v44, s[4:7], s91 offen sc1
s_endpgm
H_up:
s_mov_b32 s8, s32
s_and_b32 s9, s33, 0xffff
s_mov_b32 s10, 5308416
s_mov_b32 s11, 0x20000
s_mov_b32 s12, s34
s_and_b32 s13, s35, 0xffff
s_mov_b32 s14, 5308416
s_mov_b32 s15, 0x20000
s_mul_i32 s75, s74, 192
s_lshl_b32 s76, s3, 5
s_add_u32 s48, s75, s76
s_mov_b32 s49, s48
s_lshr_b32 s77, s3, 1
s_lshl_b32 s76, s77, 5
s_add_u32 s76, s76, s75
s_add_u32 s50, s76, 128
s_mov_b32 s51, s50
s_mul_i32 s75, s74, 6144
v_lshrrev_b32 v1, 5, v0
v_lshlrev_b32 v1, 10, v1
v_and_b32 v2, 15, v0
v_lshl_add_u32 v1, v2, 4, v1
v_bfe_u32 v2, v0, 4, 1
v_lshl_add_u32 v1, v2, 3, v1
s_lshl_b32 s76, s3, 8
s_add_u32 s76, s76, s75
s_add_u32 s76, s76, 4096
v_add_u32 v19, s76, v1
v_bfe_u32 v1, v0, 4, 1
v_lshlrev_b32 v1, 10, v1
v_lshrrev_b32 v2, 5, v0
v_lshl_add_u32 v1, v2, 8, v1
v_and_b32 v2, 15, v0
v_lshl_add_u32 v5, v2, 4, v1
s_lshl_b32 s76, s77, 11
s_add_u32 s76, s76, s75
s_and_b32 s77, s3, 1
s_lshl_b32 s77, s77, 9
s_add_u32 s76, s76, s77
v_add_u32 v20, s76, v5
v_lshrrev_b32 v1, 5, v0
v_bfe_u32 v2, v0, 3, 1
v_lshl_add_u32 v1, v1, 1, v2
v_bfe_u32 v2, v0, 4, 1
v_bfe_u32 v3, v0, 1, 2
v_lshlrev_b32 v1, 3, v1
v_lshl_add_u32 v1, v2, 2, v1
v_add_u32 v1, v1, v3
v_mul_u32_u24 v1, 9216, v1
v_and_b32 v2, 1, v0
v_lshl_add_u32 v63, v2, 4, v1
s_mul_i32 s70, s3, 40960
v_lshrrev_b32 v1, 5, v0
v_lshlrev_b32 v1, 9, v1
v_bfe_u32 v2, v0, 4, 1
v_lshl_add_u32 v1, v2, 7, v1
v_add_u32 v1, s70, v1
v_and_b32 v2, 15, v0
v_lshl_add_u32 v2, v2, 3, v1
v_mov_b32 v61, v2
v_add_u32 v62, 1024, v2
v_bfe_u32 v2, v0, 2, 2
v_lshl_add_u32 v1, v2, 5, v1
v_bfe_u32 v2, v0, 1, 1
v_lshl_add_u32 v1, v2, 10, v1
v_and_b32 v2, 1, v0
v_lshl_add_u32 v1, v2, 3, v1
s_and_b32 s71, s3, 1
s_lshl_b32 s71, s71, 4
s_add_u32 s71, s71, 2048
v_add_u32 v60, s71, v1
s_add_u32 m0, s70, 0
s_add_u32 s71, s48, 0
buffer_load_dwordx4 v63, s[8:11], s71 offen lds
s_add_u32 m0, s70, 1024
s_add_u32 s71, s49, 0
buffer_load_dwordx4 v63, s[12:15], s71 offen lds
s_add_u32 m0, s70, 2048
s_add_u32 s71, s50, 0
buffer_load_dwordx4 v63, s[8:11], s71 offen lds
s_add_u32 m0, s70, 3072
s_add_u32 s71, s51, 0
buffer_load_dwordx4 v63, s[12:15], s71 offen lds
s_add_u32 m0, s70, 4096
s_add_u32 s71, s48, 294912
buffer_load_dwordx4 v63, s[8:11], s71 offen lds
s_add_u32 m0, s70, 5120
s_add_u32 s71, s49, 294912
buffer_load_dwordx4 v63, s[12:15], s71 offen lds
s_add_u32 m0, s70, 6144
s_add_u32 s71, s50, 294912
buffer_load_dwordx4 v63, s[8:11], s71 offen lds
s_add_u32 m0, s70, 7168
s_add_u32 s71, s51, 294912
buffer_load_dwordx4 v63, s[12:15], s71 offen lds
s_add_u32 m0, s70, 8192
s_add_u32 s71, s48, 589824
buffer_load_dwordx4 v63, s[8:11], s71 offen lds
s_add_u32 m0, s70, 9216
s_add_u32 s71, s49, 589824
buffer_load_dwordx4 v63, s[12:15], s71 offen lds
s_add_u32 m0, s70, 10240
s_add_u32 s71, s50, 589824
buffer_load_dwordx4 v63, s[8:11], s71 offen lds
s_add_u32 m0, s70, 11264
s_add_u32 s71, s51, 589824
buffer_load_dwordx4 v63, s[12:15], s71 offen lds
s_add_u32 m0, s70, 12288
s_add_u32 s71, s48, 884736
buffer_load_dwordx4 v63, s[8:11], s71 offen lds
s_add_u32 m0, s70, 13312
s_add_u32 s71, s49, 884736
buffer_load_dwordx4 v63, s[12:15], s71 offen lds
s_add_u32 m0, s70, 14336
s_add_u32 s71, s50, 884736
buffer_load_dwordx4 v63, s[8:11], s71 offen lds
s_add_u32 m0, s70, 15360
s_add_u32 s71, s51, 884736
buffer_load_dwordx4 v63, s[12:15], s71 offen lds
s_add_u32 m0, s70, 16384
s_add_u32 s71, s48, 1179648
buffer_load_dwordx4 v63, s[8:11], s71 offen lds
s_add_u32 m0, s70, 17408
s_add_u32 s71, s49, 1179648
buffer_load_dwordx4 v63, s[12:15], s71 offen lds
s_add_u32 m0, s70, 18432
s_add_u32 s71, s50, 1179648
buffer_load_dwordx4 v63, s[8:11], s71 offen lds
s_add_u32 m0, s70, 19456
s_add_u32 s71, s51, 1179648
buffer_load_dwordx4 v63, s[12:15], s71 offen lds
s_add_u32 m0, s70, 20480
s_add_u32 s71, s48, 1474560
buffer_load_dwordx4 v63, s[8:11], s71 offen lds
s_add_u32 m0, s70, 21504
s_add_u32 s71, s49, 1474560
buffer_load_dwordx4 v63, s[12:15], s71 offen lds
s_add_u32 m0, s70, 22528
s_add_u32 s71, s50, 1474560
buffer_load_dwordx4 v63, s[8:11], s71 offen lds
s_add_u32 m0, s70, 23552
s_add_u32 s71, s51, 1474560
buffer_load_dwordx4 v63, s[12:15], s71 offen lds
s_add_u32 m0, s70, 24576
s_add_u32 s71, s48, 1769472
buffer_load_dwordx4 v63, s[8:11], s71 offen lds
s_add_u32 m0, s70, 25600
s_add_u32 s71, s49, 1769472
buffer_load_dwordx4 v63, s[12:15], s71 offen lds
s_add_u32 m0, s70, 26624
s_add_u32 s71, s50, 1769472
buffer_load_dwordx4 v63, s[8:11], s71 offen lds
s_add_u32 m0, s70, 27648
s_add_u32 s71, s51, 1769472
buffer_load_dwordx4 v63, s[12:15], s71 offen lds
s_add_u32 m0, s70, 28672
s_add_u32 s71, s48, 2064384
buffer_load_dwordx4 v63, s[8:11], s71 offen lds
s_add_u32 m0, s70, 29696
s_add_u32 s71, s49, 2064384
buffer_load_dwordx4 v63, s[12:15], s71 offen lds
s_add_u32 m0, s70, 30720
s_add_u32 s71, s50, 2064384
buffer_load_dwordx4 v63, s[8:11], s71 offen lds
s_add_u32 m0, s70, 31744
s_add_u32 s71, s51, 2064384
buffer_load_dwordx4 v63, s[12:15], s71 offen lds
s_add_u32 m0, s70, 32768
s_add_u32 s71, s48, 2359296
buffer_load_dwordx4 v63, s[8:11], s71 offen lds
s_add_u32 m0, s70, 33792
s_add_u32 s71, s49, 2359296
buffer_load_dwordx4 v63, s[12:15], s71 offen lds
s_add_u32 m0, s70, 34816
s_add_u32 s71, s50, 2359296
buffer_load_dwordx4 v63, s[8:11], s71 offen lds
s_add_u32 m0, s70, 35840
s_add_u32 s71, s51, 2359296
buffer_load_dwordx4 v63, s[12:15], s71 offen lds
s_add_u32 m0, s70, 36864
s_add_u32 s71, s48, 2654208
buffer_load_dwordx4 v63, s[8:11], s71 offen lds
s_add_u32 m0, s70, 37888
s_add_u32 s71, s49, 2654208
buffer_load_dwordx4 v63, s[12:15], s71 offen lds
s_add_u32 m0, s70, 38912
s_add_u32 s71, s50, 2654208
buffer_load_dwordx4 v63, s[8:11], s71 offen lds
s_add_u32 m0, s70, 39936
s_add_u32 s71, s51, 2654208
buffer_load_dwordx4 v63, s[12:15], s71 offen lds
s_waitcnt vmcnt(36)
ds_read_b64_tr_b16 a[0:1], v60 offset:0
ds_read_b64_tr_b16 a[2:3], v60 offset:256
ds_read_b64_tr_b16 a[72:73], v61 offset:0
ds_read_b64_tr_b16 a[74:75], v61 offset:256
ds_read_b64_tr_b16 a[144:145], v62 offset:0
ds_read_b64_tr_b16 a[146:147], v62 offset:256
s_waitcnt lgkmcnt(0)
s_add_u32 m0, s70, 0
s_add_u32 s71, s48, 2949120
buffer_load_dwordx4 v63, s[8:11], s71 offen lds
s_add_u32 m0, s70, 1024
s_add_u32 s71, s49, 2949120
buffer_load_dwordx4 v63, s[12:15], s71 offen lds
s_add_u32 m0, s70, 2048
s_add_u32 s71, s50, 2949120
buffer_load_dwordx4 v63, s[8:11], s71 offen lds
s_add_u32 m0, s70, 3072
s_add_u32 s71, s51, 2949120
buffer_load_dwordx4 v63, s[12:15], s71 offen lds
s_waitcnt vmcnt(36)
ds_read_b64_tr_b16 a[4:5], v60 offset:4096
ds_read_b64_tr_b16 a[6:7], v60 offset:4352
ds_read_b64_tr_b16 a[76:77], v61 offset:4096
ds_read_b64_tr_b16 a[78:79], v61 offset:4352
ds_read_b64_tr_b16 a[148:149], v62 offset:4096
ds_read_b64_tr_b16 a[150:151], v62 offset:4352
s_waitcnt lgkmcnt(0)
s_add_u32 m0, s70, 4096
s_add_u32 s71, s48, 3244032
buffer_load_dwordx4 v63, s[8:11], s71 offen lds
s_add_u32 m0, s70, 5120
s_add_u32 s71, s49, 3244032
buffer_load_dwordx4 v63, s[12:15], s71 offen lds
s_add_u32 m0, s70, 6144
s_add_u32 s71, s50, 3244032
buffer_load_dwordx4 v63, s[8:11], s71 offen lds
s_add_u32 m0, s70, 7168
s_add_u32 s71, s51, 3244032
buffer_load_dwordx4 v63, s[12:15], s71 offen lds
s_waitcnt vmcnt(36)
ds_read_b64_tr_b16 a[8:9], v60 offset:8192
ds_read_b64_tr_b16 a[10:11], v60 offset:8448
ds_read_b64_tr_b16 a[80:81], v61 offset:8192
ds_read_b64_tr_b16 a[82:83], v61 offset:8448
ds_read_b64_tr_b16 a[152:153], v62 offset:8192
ds_read_b64_tr_b16 a[154:155], v62 offset:8448
s_waitcnt lgkmcnt(0)
s_add_u32 m0, s70, 8192
s_add_u32 s71, s48, 3538944
buffer_load_dwordx4 v63, s[8:11], s71 offen lds
s_add_u32 m0, s70, 9216
s_add_u32 s71, s49, 3538944
buffer_load_dwordx4 v63, s[12:15], s71 offen lds
s_add_u32 m0, s70, 10240
s_add_u32 s71, s50, 3538944
buffer_load_dwordx4 v63, s[8:11], s71 offen lds
s_add_u32 m0, s70, 11264
s_add_u32 s71, s51, 3538944
buffer_load_dwordx4 v63, s[12:15], s71 offen lds
s_waitcnt vmcnt(36)
ds_read_b64_tr_b16 a[12:13], v60 offset:12288
ds_read_b64_tr_b16 a[14:15], v60 offset:12544
ds_read_b64_tr_b16 a[84:85], v61 offset:12288
ds_read_b64_tr_b16 a[86:87], v61 offset:12544
ds_read_b64_tr_b16 a[156:157], v62 offset:12288
ds_read_b64_tr_b16 a[158:159], v62 offset:12544
s_waitcnt lgkmcnt(0)
s_add_u32 m0, s70, 12288
s_add_u32 s71, s48, 3833856
buffer_load_dwordx4 v63, s[8:11], s71 offen lds
s_add_u32 m0, s70, 13312
s_add_u32 s71, s49, 3833856
buffer_load_dwordx4 v63, s[12:15], s71 offen lds
s_add_u32 m0, s70, 14336
s_add_u32 s71, s50, 3833856
buffer_load_dwordx4 v63, s[8:11], s71 offen lds
s_add_u32 m0, s70, 15360
s_add_u32 s71, s51, 3833856
buffer_load_dwordx4 v63, s[12:15], s71 offen lds
s_waitcnt vmcnt(36)
ds_read_b64_tr_b16 a[16:17], v60 offset:16384
ds_read_b64_tr_b16 a[18:19], v60 offset:16640
ds_read_b64_tr_b16 a[88:89], v61 offset:16384
ds_read_b64_tr_b16 a[90:91], v61 offset:16640
ds_read_b64_tr_b16 a[160:161], v62 offset:16384
ds_read_b64_tr_b16 a[162:163], v62 offset:16640
s_waitcnt lgkmcnt(0)
s_add_u32 m0, s70, 16384
s_add_u32 s71, s48, 4128768
buffer_load_dwordx4 v63, s[8:11], s71 offen lds
s_add_u32 m0, s70, 17408
s_add_u32 s71, s49, 4128768
buffer_load_dwordx4 v63, s[12:15], s71 offen lds
s_add_u32 m0, s70, 18432
s_add_u32 s71, s50, 4128768
buffer_load_dwordx4 v63, s[8:11], s71 offen lds
s_add_u32 m0, s70, 19456
s_add_u32 s71, s51, 4128768
buffer_load_dwordx4 v63, s[12:15], s71 offen lds
s_waitcnt vmcnt(36)
ds_read_b64_tr_b16 a[20:21], v60 offset:20480
ds_read_b64_tr_b16 a[22:23], v60 offset:20736
ds_read_b64_tr_b16 a[92:93], v61 offset:20480
ds_read_b64_tr_b16 a[94:95], v61 offset:20736
ds_read_b64_tr_b16 a[164:165], v62 offset:20480
ds_read_b64_tr_b16 a[166:167], v62 offset:20736
s_waitcnt lgkmcnt(0)
s_add_u32 m0, s70, 20480
s_add_u32 s71, s48, 4423680
buffer_load_dwordx4 v63, s[8:11], s71 offen lds
s_add_u32 m0, s70, 21504
s_add_u32 s71, s49, 4423680
buffer_load_dwordx4 v63, s[12:15], s71 offen lds
s_add_u32 m0, s70, 22528
s_add_u32 s71, s50, 4423680
buffer_load_dwordx4 v63, s[8:11], s71 offen lds
s_add_u32 m0, s70, 23552
s_add_u32 s71, s51, 4423680
buffer_load_dwordx4 v63, s[12:15], s71 offen lds
s_waitcnt vmcnt(36)
ds_read_b64_tr_b16 a[24:25], v60 offset:24576
ds_read_b64_tr_b16 a[26:27], v60 offset:24832
ds_read_b64_tr_b16 a[96:97], v61 offset:24576
ds_read_b64_tr_b16 a[98:99], v61 offset:24832
ds_read_b64_tr_b16 a[168:169], v62 offset:24576
ds_read_b64_tr_b16 a[170:171], v62 offset:24832
s_waitcnt lgkmcnt(0)
s_add_u32 m0, s70, 24576
s_add_u32 s71, s48, 4718592
buffer_load_dwordx4 v63, s[8:11], s71 offen lds
s_add_u32 m0, s70, 25600
s_add_u32 s71, s49, 4718592
buffer_load_dwordx4 v63, s[12:15], s71 offen lds
s_add_u32 m0, s70, 26624
s_add_u32 s71, s50, 4718592
buffer_load_dwordx4 v63, s[8:11], s71 offen lds
s_add_u32 m0, s70, 27648
s_add_u32 s71, s51, 4718592
buffer_load_dwordx4 v63, s[12:15], s71 offen lds
s_waitcnt vmcnt(36)
ds_read_b64_tr_b16 a[28:29], v60 offset:28672
ds_read_b64_tr_b16 a[30:31], v60 offset:28928
ds_read_b64_tr_b16 a[100:101], v61 offset:28672
ds_read_b64_tr_b16 a[102:103], v61 offset:28928
ds_read_b64_tr_b16 a[172:173], v62 offset:28672
ds_read_b64_tr_b16 a[174:175], v62 offset:28928
s_waitcnt lgkmcnt(0)
s_add_u32 m0, s70, 28672
s_add_u32 s71, s48, 5013504
buffer_load_dwordx4 v63, s[8:11], s71 offen lds
s_add_u32 m0, s70, 29696
s_add_u32 s71, s49, 5013504
buffer_load_dwordx4 v63, s[12:15], s71 offen lds
s_add_u32 m0, s70, 30720
s_add_u32 s71, s50, 5013504
buffer_load_dwordx4 v63, s[8:11], s71 offen lds
s_add_u32 m0, s70, 31744
s_add_u32 s71, s51, 5013504
buffer_load_dwordx4 v63, s[12:15], s71 offen lds
s_waitcnt vmcnt(36)
ds_read_b64_tr_b16 a[32:33], v60 offset:32768
ds_read_b64_tr_b16 a[34:35], v60 offset:33024
ds_read_b64_tr_b16 a[104:105], v61 offset:32768
ds_read_b64_tr_b16 a[106:107], v61 offset:33024
ds_read_b64_tr_b16 a[176:177], v62 offset:32768
ds_read_b64_tr_b16 a[178:179], v62 offset:33024
s_waitcnt vmcnt(32)
ds_read_b64_tr_b16 a[36:37], v60 offset:36864
ds_read_b64_tr_b16 a[38:39], v60 offset:37120
ds_read_b64_tr_b16 a[108:109], v61 offset:36864
ds_read_b64_tr_b16 a[110:111], v61 offset:37120
ds_read_b64_tr_b16 a[180:181], v62 offset:36864
ds_read_b64_tr_b16 a[182:183], v62 offset:37120
s_waitcnt vmcnt(28)
ds_read_b64_tr_b16 a[40:41], v60 offset:0
ds_read_b64_tr_b16 a[42:43], v60 offset:256
ds_read_b64_tr_b16 a[112:113], v61 offset:0
ds_read_b64_tr_b16 a[114:115], v61 offset:256
ds_read_b64_tr_b16 a[184:185], v62 offset:0
ds_read_b64_tr_b16 a[186:187], v62 offset:256
s_waitcnt vmcnt(24)
ds_read_b64_tr_b16 a[44:45], v60 offset:4096
ds_read_b64_tr_b16 a[46:47], v60 offset:4352
ds_read_b64_tr_b16 a[116:117], v61 offset:4096
ds_read_b64_tr_b16 a[118:119], v61 offset:4352
ds_read_b64_tr_b16 a[188:189], v62 offset:4096
ds_read_b64_tr_b16 a[190:191], v62 offset:4352
s_waitcnt vmcnt(20)
ds_read_b64_tr_b16 a[48:49], v60 offset:8192
ds_read_b64_tr_b16 a[50:51], v60 offset:8448
ds_read_b64_tr_b16 a[120:121], v61 offset:8192
ds_read_b64_tr_b16 a[122:123], v61 offset:8448
ds_read_b64_tr_b16 a[192:193], v62 offset:8192
ds_read_b64_tr_b16 a[194:195], v62 offset:8448
s_waitcnt vmcnt(16)
ds_read_b64_tr_b16 a[52:53], v60 offset:12288
ds_read_b64_tr_b16 a[54:55], v60 offset:12544
ds_read_b64_tr_b16 a[124:125], v61 offset:12288
ds_read_b64_tr_b16 a[126:127], v61 offset:12544
ds_read_b64_tr_b16 a[196:197], v62 offset:12288
ds_read_b64_tr_b16 a[198:199], v62 offset:12544
s_waitcnt vmcnt(12)
ds_read_b64_tr_b16 a[56:57], v60 offset:16384
ds_read_b64_tr_b16 a[58:59], v60 offset:16640
ds_read_b64_tr_b16 a[128:129], v61 offset:16384
ds_read_b64_tr_b16 a[130:131], v61 offset:16640
ds_read_b64_tr_b16 a[200:201], v62 offset:16384
ds_read_b64_tr_b16 a[202:203], v62 offset:16640
s_waitcnt vmcnt(8)
ds_read_b64_tr_b16 a[60:61], v60 offset:20480
ds_read_b64_tr_b16 a[62:63], v60 offset:20736
ds_read_b64_tr_b16 a[132:133], v61 offset:20480
ds_read_b64_tr_b16 a[134:135], v61 offset:20736
ds_read_b64_tr_b16 a[204:205], v62 offset:20480
ds_read_b64_tr_b16 a[206:207], v62 offset:20736
s_waitcnt vmcnt(4)
ds_read_b64_tr_b16 a[64:65], v60 offset:24576
ds_read_b64_tr_b16 a[66:67], v60 offset:24832
ds_read_b64_tr_b16 a[136:137], v61 offset:24576
ds_read_b64_tr_b16 a[138:139], v61 offset:24832
ds_read_b64_tr_b16 a[208:209], v62 offset:24576
ds_read_b64_tr_b16 a[210:211], v62 offset:24832
s_waitcnt vmcnt(0)
ds_read_b64_tr_b16 a[68:69], v60 offset:28672
ds_read_b64_tr_b16 a[70:71], v60 offset:28928
ds_read_b64_tr_b16 a[140:141], v61 offset:28672
ds_read_b64_tr_b16 a[142:143], v61 offset:28928
ds_read_b64_tr_b16 a[212:213], v62 offset:28672
ds_read_b64_tr_b16 a[214:215], v62 offset:28928
s_waitcnt lgkmcnt(0)
v_lshrrev_b32 v1, 3, v0
v_bfe_u32 v2, v0, 1, 2
v_lshrrev_b32 v3, 5, v0
v_lshlrev_b32 v3, 1, v3
v_xor_b32 v2, v2, v3
v_mul_u32_u24 v1, 2304, v1
v_lshl_add_u32 v1, v2, 5, v1
v_and_b32 v2, 1, v0
v_lshl_add_u32 v1, v2, 4, v1
s_and_b32 s70, s3, 1
s_mul_i32 s70, s70, 18432
s_lshr_b32 s71, s3, 1
s_lshl_b32 s71, s71, 7
s_add_u32 s70, s70, s71
v_add_u32 v1, s70, v1
v_add_u32 v8, 4096, v1
v_add_u32 v9, 3328, v1
v_add_u32 v10, 2560, v1
v_add_u32 v11, 1792, v1
v_add_u32 v12, 5120, v1
v_add_u32 v13, 4352, v1
v_add_u32 v14, 3584, v1
v_add_u32 v15, 2816, v1
v_add_u32 v16, 6144, v1
v_bfe_u32 v1, v0, 1, 3
v_lshlrev_b32 v1, 7, v1
v_lshrrev_b32 v2, 4, v0
v_bfe_u32 v3, v0, 3, 1
v_lshlrev_b32 v3, 1, v3
v_xor_b32 v2, v2, v3
v_lshl_add_u32 v1, v2, 5, v1
v_and_b32 v2, 1, v0
v_lshl_add_u32 v17, v2, 4, v1
v_and_b32 v2, 31, v0
v_add_u32 v1, 0, v2
v_mul_u32_u24 v1, 128, v1
v_lshrrev_b32 v3, 5, v0
v_mul_u32_u24 v3, 32768, v3
v_add_u32 v1, 21504, v1
v_add_u32 v1, v1, v3
v_mov_b32 v3, 2147483632
s_cmp_eq_u32 s3, 0
s_cselect_b32 s71, 16, 0
v_cmp_gt_u32 vcc, s71, v2
s_nop 1
v_cndmask_b32 v22, v3, v1, vcc
s_mov_b32 s56, 0xffff
s_mul_i32 s70, s74, 128
s_add_u32 s70, s70, 23552
v_mov_b32 v1, s70
s_min_u32 s71, s71, 1
v_cmp_gt_u32 vcc, s71, v0
s_nop 1
v_cndmask_b32 v44, v3, v1, vcc
v_add_u32 v45, 65536, v44
s_getpc_b64 s[96:97]
pc_146:
s_add_u32 s96, s96, L_writers-pc_146
s_addc_u32 s97, s97, 0
v_subrev_u32 v23, 0, v22
v_lshrrev_b32 v23, 7, v23
v_cmp_gt_u32 vcc, 0x200, v23
s_nop 1
v_cndmask_b32 v23, 0, v23, vcc
global_load_ubyte v23, v23, s[96:97]
s_mov_b32 s44, 6062080
s_mov_b32 s45, 161521664
s_mov_b32 s52, 1
s_mov_b32 s53, 0
s_mov_b32 s46, 8421376
s_mov_b32 s47, 180396032
s_mov_b32 s54, 1
s_mov_b32 s55, 32768
s_mov_b32 s25, 200
s_mov_b32 s20, 36864
s_mov_b32 s21, 294912
s_mov_b32 s8, s42
s_and_b32 s9, s43, 0xffff
s_mov_b32 s10, 0
s_mov_b32 s11, 0x20000
s_mov_b32 s22, 0
s_mul_i32 s48, s3, 9216
s_add_u32 s49, s48, 36864
s_add_u32 s50, s48, 73728
s_add_u32 s51, s48, 110592
s_mov_b32 s57, 0xbfb8aa3b
v_add_u32 v28, 0, v17
v_add_u32 v29, 36864, v17
v_add_u32 v30, 73728, v17
v_add_u32 v31, 110592, v17
v_lshlrev_b32 v1, 2, v0
v_add_u32 v32, 147456, v1
s_lshl_b32 s70, s3, 8
v_add_u32 v18, s70, v32
v_mov_b64 v[224:225], 0
v_mov_b64 v[236:237], 0
v_mov_b64 v[226:227], 0
v_mov_b64 v[238:239], 0
v_mov_b64 v[228:229], 0
v_mov_b64 v[240:241], 0
v_mov_b64 v[230:231], 0
v_mov_b64 v[242:243], 0
s_mov_b32 s12, s40
s_and_b32 s13, s41, 0xffff
s_mov_b32 s14, 256
s_mov_b32 s15, 0x20000
v_lshlrev_b32 v26, 2, v0
v_add_u32 v27, 128, v26
v_cmp_le_u32 vcc, 2, v0
s_nop 1
v_cndmask_b32 v26, v26, v27, vcc
v_mov_b32 v27, 192
v_cmp_eq_u32 vcc, 8, v0
s_nop 1
v_cndmask_b32 v26, v26, v27, vcc
v_mov_b32 v27, 2147483632
v_cmp_lt_u32 vcc, 8, v0
s_nop 1
v_cndmask_b32 v26, v26, v27, vcc
s_mov_b32 s98, 0
wi_loop_152:
buffer_load_dword v27, v26, s[12:15], 0 offen sc1
s_add_u32 s98, s98, 1
s_cmp_gt_u32 s98, 150000
s_cbranch_scc1 wi_bad_154
s_waitcnt vmcnt(0)
v_cmp_eq_u32 vcc, 32, v27
s_nop 0
s_and_b32 s97, vcc_lo, 0x1ff
s_cmp_eq_u32 s97, 0x1ff
s_cbranch_scc1 wi_ok_153
v_cmp_lt_u32 vcc, 32, v27
s_nop 0
s_and_b32 s96, vcc_lo, 0xff
s_cselect_b32 s96, 0x100, 0
s_and_b32 s96, s96, s97
s_cbranch_scc1 wi_over_155
s_sleep 8
s_branch wi_loop_152
wi_bad_154:
s_mov_b32 s98, 512
s_branch L_fail
wi_over_155:
s_mov_b32 s100, 255
wi_ok_153:
v_add_u32 v26, 65536, v22
v_cmp_eq_u32 vcc, s100, v23
s_nop 1
v_cndmask_b32 v22, v22, v26, vcc
v_mov_b32 v26, 2147483632
s_cmp_lg_u32 s100, 255
s_cselect_b64 vcc, -1, 0
v_cndmask_b32 v44, v44, v26, vcc
s_cselect_b32 s38, 1, 0
s_mov_b32 s90, 0
s_mov_b32 s91, 1879048192
s_mov_b32 s93, 1879048192
v_mov_b32 v34, 2147483632
s_barrier
s_mov_b32 s95, 1
s_cmp_lg_u32 s3, 0
s_cbranch_scc1 sp_ok_157_j
s_mov_b32 s23, 0
sp_loop_156:
buffer_load_dword v33, v22, s[4:7], 0 offen sc1
s_add_u32 s23, s23, 1
s_cmp_gt_u32 s23, 150000
s_cbranch_scc1 sp_bad_158
s_waitcnt vmcnt(0)
sp_loop_156_e:
v_cmp_gt_u32 vcc, s52, v33
v_cmp_gt_u32 s[58:59], s54, v33
s_and_b32 vcc_lo, vcc_lo, s56
s_cbranch_scc0 sp_ok_157
s_cmp_gt_u32 s23, 4
s_cselect_b32 s70, 0, s56
s_cmp_lg_u32 s95, 0
s_cselect_b32 s70, 0, s70
s_or_b32 s59, s59, s70
s_and_b32 s59, s59, s56
s_cbranch_scc0 sp_ok_157
s_sleep 1
s_branch sp_loop_156
sp_bad_158:
s_mov_b32 s98, 1028
s_branch L_fail
sp_ok_157:
ds_write_b32 v18, v33
s_waitcnt lgkmcnt(0)
sp_ok_157_j:
s_barrier
ds_read_b32 v33, v32
s_waitcnt lgkmcnt(0)
v_cmp_gt_u32 vcc, s52, v33
v_cmp_gt_u32 s[58:59], s54, v33
s_and_b32 vcc_lo, vcc_lo, s56
s_cselect_b32 s70, 0, 1
s_and_b32 s59, s59, s56
s_cselect_b32 s71, 0, 1
s_or_b32 s76, s70, s71
s_cselect_b32 s10, 268435456, 0
s_cmp_lg_u32 s70, 0
s_cselect_b64 s[72:73], s[52:53], s[54:55]
s_cselect_b64 s[58:59], s[44:45], s[46:47]
s_mul_i32 s74, s72, s20
s_add_u32 s74, s74, s58
s_mul_i32 s75, s72, s21
s_add_u32 s75, s75, s59
s_andn2_b32 s71, s71, s70
s_add_u32 s52, s52, s70
s_add_u32 s54, s54, s71
s_mov_b32 s77, s76
s_add_u32 m0, s48, 0
s_nop 0
buffer_load_dwordx4 v8, s[4:7], s74 offen offset:0 sc1 lds
buffer_load_dwordx4 v9, s[4:7], s74 offen offset:1024 sc1 lds
buffer_load_dwordx4 v10, s[4:7], s74 offen offset:2048 sc1 lds
buffer_load_dwordx4 v11, s[4:7], s74 offen offset:3072 sc1 lds
s_add_u32 m0, s48, 4096
s_nop 0
buffer_load_dwordx4 v12, s[4:7], s74 offen offset:0 sc1 lds
buffer_load_dwordx4 v13, s[4:7], s74 offen offset:1024 sc1 lds
buffer_load_dwordx4 v14, s[4:7], s74 offen offset:2048 sc1 lds
buffer_load_dwordx4 v15, s[4:7], s74 offen offset:3072 sc1 lds
s_add_u32 m0, s48, 8192
s_nop 0
buffer_load_dwordx4 v16, s[4:7], s74 offen offset:0 sc1 lds
buffer_load_dword v24, v22, s[4:7], 0 offen sc1
buffer_store_dword v27, v34, s[4:7], 0 offen
v_mov_b32 v27, s90
s_waitcnt vmcnt(9)
s_barrier
buffer_store_dword v27, v45, s[4:7], s91 offen
buffer_store_dword v27, v44, s[4:7], s91 offen sc1
s_mov_b32 s91, 1879048192
ds_read_b128 v[64:67], v28 offset:0
ds_read_b128 v[68:71], v28 offset:9216
ds_read_b128 v[72:75], v28 offset:18432
ds_read_b128 v[76:79], v28 offset:27648
ds_read_b128 v[80:83], v28 offset:1024
ds_read_b128 v[84:87], v28 offset:10240
ds_read_b128 v[88:91], v28 offset:19456
ds_read_b128 v[92:95], v28 offset:28672
s_waitcnt vmcnt(8)
s_barrier
s_branch g_body_147
g_body_147:
s_waitcnt lgkmcnt(4)
v_mfma_f32_16x16x32_bf16 v[208:211], a[0:3], v[64:67], 0
ds_read_b128 v[96:99], v28 offset:2048
v_mfma_f32_16x16x32_bf16 v[212:215], a[0:3], v[68:71], 0
ds_read_b128 v[100:103], v28 offset:11264
v_mfma_f32_16x16x32_bf16 v[208:211], a[4:7], v[72:75], v[208:211]
ds_read_b128 v[104:107], v28 offset:20480
v_mfma_f32_16x16x32_bf16 v[212:215], a[4:7], v[76:79], v[212:215]
ds_read_b128 v[108:111], v28 offset:29696
v_mul_f32 v224, v224, v236
v_mul_f32 v225, v225, v237
v_mul_f32 v226, v226, v238
v_mul_f32 v227, v227, v239
v_mul_f32 v228, v228, v240
v_mfma_f32_16x16x32_bf16 v[216:219], a[72:75], v[64:67], 0
v_mul_f32 v229, v229, v241
s_waitcnt lgkmcnt(4)
v_mfma_f32_16x16x32_bf16 v[208:211], a[8:11], v[80:83], v[208:211]
ds_read_b128 v[112:115], v28 offset:3072
v_mul_f32 v230, v230, v242
v_mfma_f32_16x16x32_bf16 v[212:215], a[8:11], v[84:87], v[212:215]
ds_read_b128 v[116:119], v28 offset:12288
v_mul_f32 v231, v231, v243
v_mfma_f32_16x16x32_bf16 v[208:211], a[12:15], v[88:91], v[208:211]
ds_read_b128 v[120:123], v28 offset:21504
v_cvt_pk_bf16_f32 v52, v224, v225
v_mfma_f32_16x16x32_bf16 v[212:215], a[12:15], v[92:95], v[212:215]
ds_read_b128 v[124:127], v28 offset:30720
v_cvt_pk_bf16_f32 v53, v226, v227
v_mfma_f32_16x16x32_bf16 v[220:223], a[72:75], v[68:71], 0
v_cvt_pk_bf16_f32 v54, v228, v229
s_waitcnt lgkmcnt(4)
v_mfma_f32_16x16x32_bf16 v[208:211], a[16:19], v[96:99], v[208:211]
ds_read_b128 v[128:131], v28 offset:4096
v_cvt_pk_bf16_f32 v55, v230, v231
v_mfma_f32_16x16x32_bf16 v[212:215], a[16:19], v[100:103], v[212:215]
ds_read_b128 v[132:135], v28 offset:13312
v_permlane16_swap_b32 v52, v54
v_mfma_f32_16x16x32_bf16 v[208:211], a[20:23], v[104:107], v[208:211]
ds_read_b128 v[136:139], v28 offset:22528
v_permlane16_swap_b32 v53, v55
v_mfma_f32_16x16x32_bf16 v[212:215], a[20:23], v[108:111], v[212:215]
ds_read_b128 v[140:143], v28 offset:31744
buffer_store_dwordx4 v[52:55], v20, s[4:7], s93 offen sc1
v_mfma_f32_16x16x32_bf16 v[216:219], a[76:79], v[72:75], v[216:219]
s_waitcnt vmcnt(5)
s_barrier
s_waitcnt lgkmcnt(4)
v_mfma_f32_16x16x32_bf16 v[208:211], a[24:27], v[112:115], v[208:211]
ds_read_b128 v[144:147], v28 offset:5120
v_mov_b32 v27, s90
v_mfma_f32_16x16x32_bf16 v[212:215], a[24:27], v[116:119], v[212:215]
ds_read_b128 v[148:151], v28 offset:14336
v_mfma_f32_16x16x32_bf16 v[208:211], a[28:31], v[120:123], v[208:211]
ds_read_b128 v[152:155], v28 offset:23552
v_mfma_f32_16x16x32_bf16 v[212:215], a[28:31], v[124:127], v[212:215]
ds_read_b128 v[156:159], v28 offset:32768
v_mfma_f32_16x16x32_bf16 v[220:223], a[76:79], v[76:79], v[220:223]
s_waitcnt lgkmcnt(4)
v_mfma_f32_16x16x32_bf16 v[208:211], a[32:35], v[128:131], v[208:211]
ds_read_b128 v[160:163], v28 offset:6144
v_mfma_f32_16x16x32_bf16 v[212:215], a[32:35], v[132:135], v[212:215]
ds_read_b128 v[164:167], v28 offset:15360
v_mfma_f32_16x16x32_bf16 v[208:211], a[36:39], v[136:139], v[208:211]
ds_read_b128 v[168:171], v28 offset:24576
v_mfma_f32_16x16x32_bf16 v[212:215], a[36:39], v[140:143], v[212:215]
ds_read_b128 v[172:175], v28 offset:33792
v_mfma_f32_16x16x32_bf16 v[216:219], a[80:83], v[80:83], v[216:219]
s_waitcnt lgkmcnt(4)
v_mfma_f32_16x16x32_bf16 v[208:211], a[40:43], v[144:147], v[208:211]
ds_read_b128 v[176:179], v28 offset:7168
v_mfma_f32_16x16x32_bf16 v[212:215], a[40:43], v[148:151], v[212:215]
ds_read_b128 v[180:183], v28 offset:16384
v_mfma_f32_16x16x32_bf16 v[208:211], a[44:47], v[152:155], v[208:211]
ds_read_b128 v[184:187], v28 offset:25600
v_mfma_f32_16x16x32_bf16 v[212:215], a[44:47], v[156:159], v[212:215]
ds_read_b128 v[188:191], v28 offset:34816
v_mfma_f32_16x16x32_bf16 v[220:223], a[80:83], v[84:87], v[220:223]
s_waitcnt lgkmcnt(4)
v_mfma_f32_16x16x32_bf16 v[208:211], a[48:51], v[160:163], v[208:211]
ds_read_b128 v[192:195], v28 offset:8192
v_mfma_f32_16x16x32_bf16 v[212:215], a[48:51], v[164:167], v[212:215]
ds_read_b128 v[196:199], v28 offset:17408
s_waitcnt vmcnt(4)
ds_write_b32 v18, v24
v_mfma_f32_16x16x32_bf16 v[208:211], a[52:55], v[168:171], v[208:211]
ds_read_b128 v[200:203], v28 offset:26624
v_mfma_f32_16x16x32_bf16 v[212:215], a[52:55], v[172:175], v[212:215]
ds_read_b128 v[204:207], v28 offset:35840
v_mfma_f32_16x16x32_bf16 v[216:219], a[84:87], v[88:91], v[216:219]
s_waitcnt lgkmcnt(2)
s_barrier
v_mfma_f32_16x16x32_bf16 v[208:211], a[56:59], v[176:179], v[208:211]
ds_read_b32 v33, v32
v_mfma_f32_16x16x32_bf16 v[212:215], a[56:59], v[180:183], v[212:215]
v_mfma_f32_16x16x32_bf16 v[208:211], a[60:63], v[184:187], v[208:211]
v_mfma_f32_16x16x32_bf16 v[212:215], a[60:63], v[188:191], v[212:215]
s_waitcnt lgkmcnt(0)
v_cmp_gt_u32 vcc, s52, v33
v_mfma_f32_16x16x32_bf16 v[220:223], a[84:87], v[92:95], v[220:223]
v_cmp_gt_u32 s[58:59], s54, v33
v_mfma_f32_16x16x32_bf16 v[208:211], a[64:67], v[192:195], v[208:211]
s_and_b32 vcc_lo, vcc_lo, s56
s_cselect_b32 s70, 0, 1
v_mfma_f32_16x16x32_bf16 v[212:215], a[64:67], v[196:199], v[212:215]
s_and_b32 s59, s59, s56
s_cselect_b32 s71, 0, s77
v_mfma_f32_16x16x32_bf16 v[208:211], a[68:71], v[200:203], v[208:211]
s_or_b32 s82, s70, s71
s_cselect_b32 s10, 268435456, 0
v_mfma_f32_16x16x32_bf16 v[212:215], a[68:71], v[204:207], v[212:215]
s_cmp_lg_u32 s70, 0
s_cselect_b64 s[78:79], s[52:53], s[54:55]
s_cselect_b64 s[58:59], s[44:45], s[46:47]
v_mfma_f32_16x16x32_bf16 v[216:219], a[88:91], v[96:99], v[216:219]
s_mul_i32 s80, s78, s20
s_add_u32 s80, s80, s58
v_mfma_f32_16x16x32_bf16 v[220:223], a[88:91], v[100:103], v[220:223]
s_add_u32 m0, s49, 0
s_mul_i32 s81, s78, s21
s_add_u32 s81, s81, s59
v_mfma_f32_16x16x32_bf16 v[216:219], a[92:95], v[104:107], v[216:219]
buffer_load_dwordx4 v8, s[8:11], s80 offen offset:0 sc1 lds
v_mfma_f32_16x16x32_bf16 v[220:223], a[92:95], v[108:111], v[220:223]
s_andn2_b32 s71, s71, s70
s_add_u32 s52, s52, s70
s_add_u32 s54, s54, s71
v_mfma_f32_16x16x32_bf16 v[216:219], a[96:99], v[112:115], v[216:219]
s_mov_b32 s83, s82
v_mfma_f32_16x16x32_bf16 v[220:223], a[96:99], v[116:119], v[220:223]
buffer_load_dwordx4 v9, s[8:11], s80 offen offset:1024 sc1 lds
v_mfma_f32_16x16x32_bf16 v[216:219], a[100:103], v[120:123], v[216:219]
v_permlane32_swap_b32 v208, v212
v_mfma_f32_16x16x32_bf16 v[220:223], a[100:103], v[124:127], v[220:223]
v_permlane32_swap_b32 v209, v213
v_mfma_f32_16x16x32_bf16 v[216:219], a[104:107], v[128:131], v[216:219]
buffer_load_dwordx4 v10, s[8:11], s80 offen offset:2048 sc1 lds
v_mfma_f32_16x16x32_bf16 v[220:223], a[104:107], v[132:135], v[220:223]
v_permlane32_swap_b32 v210, v214
v_mfma_f32_16x16x32_bf16 v[216:219], a[108:111], v[136:139], v[216:219]
v_permlane32_swap_b32 v211, v215
v_mfma_f32_16x16x32_bf16 v[220:223], a[108:111], v[140:143], v[220:223]
buffer_load_dwordx4 v11, s[8:11], s80 offen offset:3072 sc1 lds
v_mfma_f32_16x16x32_bf16 v[216:219], a[112:115], v[144:147], v[216:219]
v_mul_f32 v232, s57, v208
v_mul_f32 v233, s57, v209
v_mfma_f32_16x16x32_bf16 v[220:223], a[112:115], v[148:151], v[220:223]
s_add_u32 m0, s49, 4096
v_mul_f32 v234, s57, v210
v_mfma_f32_16x16x32_bf16 v[216:219], a[116:119], v[152:155], v[216:219]
buffer_load_dwordx4 v12, s[8:11], s80 offen offset:0 sc1 lds
v_mfma_f32_16x16x32_bf16 v[220:223], a[116:119], v[156:159], v[220:223]
v_mul_f32 v235, s57, v211
v_mfma_f32_16x16x32_bf16 v[216:219], a[120:123], v[160:163], v[216:219]
v_exp_f32 v232, v232
v_mfma_f32_16x16x32_bf16 v[220:223], a[120:123], v[164:167], v[220:223]
buffer_load_dwordx4 v13, s[8:11], s80 offen offset:1024 sc1 lds
v_mfma_f32_16x16x32_bf16 v[216:219], a[124:127], v[168:171], v[216:219]
v_exp_f32 v233, v233
v_mfma_f32_16x16x32_bf16 v[220:223], a[124:127], v[172:175], v[220:223]
v_exp_f32 v234, v234
v_mfma_f32_16x16x32_bf16 v[216:219], a[128:131], v[176:179], v[216:219]
buffer_load_dwordx4 v14, s[8:11], s80 offen offset:2048 sc1 lds
v_mfma_f32_16x16x32_bf16 v[220:223], a[128:131], v[180:183], v[220:223]
v_exp_f32 v235, v235
v_mfma_f32_16x16x32_bf16 v[216:219], a[132:135], v[184:187], v[216:219]
v_add_f32 v232, 1.0, v232
v_add_f32 v233, 1.0, v233
v_mfma_f32_16x16x32_bf16 v[220:223], a[132:135], v[188:191], v[220:223]
buffer_load_dwordx4 v15, s[8:11], s80 offen offset:3072 sc1 lds
v_mfma_f32_16x16x32_bf16 v[216:219], a[136:139], v[192:195], v[216:219]
v_add_f32 v234, 1.0, v234
v_add_f32 v235, 1.0, v235
v_mfma_f32_16x16x32_bf16 v[220:223], a[136:139], v[196:199], v[220:223]
s_add_u32 m0, s49, 8192
v_mfma_f32_16x16x32_bf16 v[216:219], a[140:143], v[200:203], v[216:219]
buffer_load_dwordx4 v16, s[8:11], s80 offen offset:0 sc1 lds
v_mfma_f32_16x16x32_bf16 v[220:223], a[140:143], v[204:207], v[220:223]
v_rcp_f32 v232, v232
v_mfma_f32_16x16x32_bf16 v[224:227], a[144:147], v[64:67], 0
v_rcp_f32 v233, v233
v_mfma_f32_16x16x32_bf16 v[228:231], a[144:147], v[68:71], 0
v_rcp_f32 v234, v234
v_mfma_f32_16x16x32_bf16 v[224:227], a[148:151], v[72:75], v[224:227]
v_rcp_f32 v235, v235
v_mfma_f32_16x16x32_bf16 v[228:231], a[148:151], v[76:79], v[228:231]
v_mul_f32 v212, v208, v212
v_mul_f32 v213, v209, v213
v_mfma_f32_16x16x32_bf16 v[224:227], a[152:155], v[80:83], v[224:227]
buffer_load_dword v24, v22, s[4:7], 0 offen sc1
v_mfma_f32_16x16x32_bf16 v[228:231], a[152:155], v[84:87], v[228:231]
v_mul_f32 v214, v210, v214
v_mul_f32 v215, v211, v215
v_mul_f32 v236, s57, v216
v_mul_f32 v237, s57, v217
v_mul_f32 v238, s57, v218
v_mul_f32 v239, s57, v219
v_exp_f32 v236, v236
v_exp_f32 v237, v237
v_exp_f32 v238, v238
v_exp_f32 v239, v239
v_add_f32 v236, 1.0, v236
v_add_f32 v237, 1.0, v237
v_add_f32 v238, 1.0, v238
v_add_f32 v239, 1.0, v239
v_rcp_f32 v236, v236
v_rcp_f32 v237, v237
v_mfma_f32_16x16x32_bf16 v[224:227], a[156:159], v[88:91], v[224:227]
s_waitcnt vmcnt(10)
s_barrier
v_mfma_f32_16x16x32_bf16 v[228:231], a[156:159], v[92:95], v[228:231]
buffer_store_dword v27, v45, s[4:7], s91 offen
v_mfma_f32_16x16x32_bf16 v[224:227], a[160:163], v[96:99], v[224:227]
buffer_store_dword v27, v44, s[4:7], s91 offen sc1
v_mfma_f32_16x16x32_bf16 v[228:231], a[160:163], v[100:103], v[228:231]
v_mul_f32 v212, v212, v232
v_mul_f32 v213, v213, v233
v_mfma_f32_16x16x32_bf16 v[224:227], a[164:167], v[104:107], v[224:227]
v_mul_f32 v214, v214, v234
v_mul_f32 v215, v215, v235
v_mfma_f32_16x16x32_bf16 v[228:231], a[164:167], v[108:111], v[228:231]
v_cvt_pk_bf16_f32 v48, v212, v213
v_cvt_pk_bf16_f32 v49, v214, v215
v_mfma_f32_16x16x32_bf16 v[224:227], a[168:171], v[112:115], v[224:227]
buffer_store_dwordx2 v[48:49], v19, s[4:7], s75 offen sc1
v_mfma_f32_16x16x32_bf16 v[228:231], a[168:171], v[116:119], v[228:231]
v_rcp_f32 v238, v238
v_mfma_f32_16x16x32_bf16 v[224:227], a[172:175], v[120:123], v[224:227]
v_rcp_f32 v239, v239
v_mfma_f32_16x16x32_bf16 v[228:231], a[172:175], v[124:127], v[228:231]
v_mul_f32 v240, s57, v220
v_mul_f32 v241, s57, v221
v_mfma_f32_16x16x32_bf16 v[224:227], a[176:179], v[128:131], v[224:227]
v_mul_f32 v242, s57, v222
v_mul_f32 v243, s57, v223
v_mfma_f32_16x16x32_bf16 v[228:231], a[176:179], v[132:135], v[228:231]
v_mul_f32 v236, v216, v236
v_mul_f32 v237, v217, v237
v_mfma_f32_16x16x32_bf16 v[224:227], a[180:183], v[136:139], v[224:227]
v_mul_f32 v238, v218, v238
v_mul_f32 v239, v219, v239
v_mfma_f32_16x16x32_bf16 v[228:231], a[180:183], v[140:143], v[228:231]
v_exp_f32 v240, v240
v_mfma_f32_16x16x32_bf16 v[224:227], a[184:187], v[144:147], v[224:227]
v_exp_f32 v241, v241
v_mfma_f32_16x16x32_bf16 v[228:231], a[184:187], v[148:151], v[228:231]
v_exp_f32 v242, v242
v_mfma_f32_16x16x32_bf16 v[224:227], a[188:191], v[152:155], v[224:227]
v_exp_f32 v243, v243
v_mfma_f32_16x16x32_bf16 v[228:231], a[188:191], v[156:159], v[228:231]
v_add_f32 v240, 1.0, v240
v_add_f32 v241, 1.0, v241
v_mfma_f32_16x16x32_bf16 v[224:227], a[192:195], v[160:163], v[224:227]
s_waitcnt vmcnt(11)
s_barrier
v_mfma_f32_16x16x32_bf16 v[228:231], a[192:195], v[164:167], v[228:231]
v_add_f32 v242, 1.0, v242
v_add_f32 v243, 1.0, v243
v_mfma_f32_16x16x32_bf16 v[224:227], a[196:199], v[168:171], v[224:227]
s_cmp_eq_u32 s82, 0
s_cbranch_scc1 g_slow_159
v_mfma_f32_16x16x32_bf16 v[228:231], a[196:199], v[172:175], v[228:231]
v_rcp_f32 v240, v240
ds_read_b128 v[64:67], v29 offset:0
v_mfma_f32_16x16x32_bf16 v[224:227], a[200:203], v[176:179], v[224:227]
v_rcp_f32 v241, v241
ds_read_b128 v[68:71], v29 offset:9216
v_mfma_f32_16x16x32_bf16 v[228:231], a[200:203], v[180:183], v[228:231]
v_rcp_f32 v242, v242
ds_read_b128 v[72:75], v29 offset:18432
v_mfma_f32_16x16x32_bf16 v[224:227], a[204:207], v[184:187], v[224:227]
v_rcp_f32 v243, v243
ds_read_b128 v[76:79], v29 offset:27648
v_mfma_f32_16x16x32_bf16 v[228:231], a[204:207], v[188:191], v[228:231]
v_mul_f32 v240, v220, v240
ds_read_b128 v[80:83], v29 offset:1024
v_mfma_f32_16x16x32_bf16 v[224:227], a[208:211], v[192:195], v[224:227]
v_mul_f32 v241, v221, v241
ds_read_b128 v[84:87], v29 offset:10240
v_mfma_f32_16x16x32_bf16 v[228:231], a[208:211], v[196:199], v[228:231]
v_mul_f32 v242, v222, v242
ds_read_b128 v[88:91], v29 offset:19456
v_mfma_f32_16x16x32_bf16 v[224:227], a[212:215], v[200:203], v[224:227]
v_mul_f32 v243, v223, v243
ds_read_b128 v[92:95], v29 offset:28672
v_mfma_f32_16x16x32_bf16 v[228:231], a[212:215], v[204:207], v[228:231]
s_waitcnt vmcnt(8)
s_barrier
g_body_148:
s_waitcnt lgkmcnt(4)
v_mfma_f32_16x16x32_bf16 v[208:211], a[0:3], v[64:67], 0
ds_read_b128 v[96:99], v29 offset:2048
v_mfma_f32_16x16x32_bf16 v[212:215], a[0:3], v[68:71], 0
ds_read_b128 v[100:103], v29 offset:11264
v_mfma_f32_16x16x32_bf16 v[208:211], a[4:7], v[72:75], v[208:211]
ds_read_b128 v[104:107], v29 offset:20480
v_mfma_f32_16x16x32_bf16 v[212:215], a[4:7], v[76:79], v[212:215]
ds_read_b128 v[108:111], v29 offset:29696
v_mul_f32 v224, v224, v236
v_mul_f32 v225, v225, v237
v_mul_f32 v226, v226, v238
v_mul_f32 v227, v227, v239
v_mul_f32 v228, v228, v240
v_mfma_f32_16x16x32_bf16 v[216:219], a[72:75], v[64:67], 0
v_mul_f32 v229, v229, v241
s_waitcnt lgkmcnt(4)
v_mfma_f32_16x16x32_bf16 v[208:211], a[8:11], v[80:83], v[208:211]
ds_read_b128 v[112:115], v29 offset:3072
v_mul_f32 v230, v230, v242
v_mfma_f32_16x16x32_bf16 v[212:215], a[8:11], v[84:87], v[212:215]
ds_read_b128 v[116:119], v29 offset:12288
v_mul_f32 v231, v231, v243
v_mfma_f32_16x16x32_bf16 v[208:211], a[12:15], v[88:91], v[208:211]
ds_read_b128 v[120:123], v29 offset:21504
v_cvt_pk_bf16_f32 v52, v224, v225
v_mfma_f32_16x16x32_bf16 v[212:215], a[12:15], v[92:95], v[212:215]
ds_read_b128 v[124:127], v29 offset:30720
v_cvt_pk_bf16_f32 v53, v226, v227
v_mfma_f32_16x16x32_bf16 v[220:223], a[72:75], v[68:71], 0
v_cvt_pk_bf16_f32 v54, v228, v229
s_waitcnt lgkmcnt(4)
v_mfma_f32_16x16x32_bf16 v[208:211], a[16:19], v[96:99], v[208:211]
ds_read_b128 v[128:131], v29 offset:4096
v_cvt_pk_bf16_f32 v55, v230, v231
v_mfma_f32_16x16x32_bf16 v[212:215], a[16:19], v[100:103], v[212:215]
ds_read_b128 v[132:135], v29 offset:13312
v_permlane16_swap_b32 v52, v54
v_mfma_f32_16x16x32_bf16 v[208:211], a[20:23], v[104:107], v[208:211]
ds_read_b128 v[136:139], v29 offset:22528
v_permlane16_swap_b32 v53, v55
v_mfma_f32_16x16x32_bf16 v[212:215], a[20:23], v[108:111], v[212:215]
ds_read_b128 v[140:143], v29 offset:31744
buffer_store_dwordx4 v[52:55], v20, s[4:7], s75 offen sc1
v_mfma_f32_16x16x32_bf16 v[216:219], a[76:79], v[72:75], v[216:219]
s_waitcnt vmcnt(5)
s_barrier
s_waitcnt lgkmcnt(4)
v_mfma_f32_16x16x32_bf16 v[208:211], a[24:27], v[112:115], v[208:211]
ds_read_b128 v[144:147], v29 offset:5120
v_mov_b32 v27, s72
v_mfma_f32_16x16x32_bf16 v[212:215], a[24:27], v[116:119], v[212:215]
ds_read_b128 v[148:151], v29 offset:14336
v_mfma_f32_16x16x32_bf16 v[208:211], a[28:31], v[120:123], v[208:211]
ds_read_b128 v[152:155], v29 offset:23552
v_mfma_f32_16x16x32_bf16 v[212:215], a[28:31], v[124:127], v[212:215]
ds_read_b128 v[156:159], v29 offset:32768
v_mfma_f32_16x16x32_bf16 v[220:223], a[76:79], v[76:79], v[220:223]
s_waitcnt lgkmcnt(4)
v_mfma_f32_16x16x32_bf16 v[208:211], a[32:35], v[128:131], v[208:211]
ds_read_b128 v[160:163], v29 offset:6144
v_mfma_f32_16x16x32_bf16 v[212:215], a[32:35], v[132:135], v[212:215]
ds_read_b128 v[164:167], v29 offset:15360
v_mfma_f32_16x16x32_bf16 v[208:211], a[36:39], v[136:139], v[208:211]
ds_read_b128 v[168:171], v29 offset:24576
v_mfma_f32_16x16x32_bf16 v[212:215], a[36:39], v[140:143], v[212:215]
ds_read_b128 v[172:175], v29 offset:33792
v_mfma_f32_16x16x32_bf16 v[216:219], a[80:83], v[80:83], v[216:219]
s_waitcnt lgkmcnt(4)
v_mfma_f32_16x16x32_bf16 v[208:211], a[40:43], v[144:147], v[208:211]
ds_read_b128 v[176:179], v29 offset:7168
v_mfma_f32_16x16x32_bf16 v[212:215], a[40:43], v[148:151], v[212:215]
ds_read_b128 v[180:183], v29 offset:16384
v_mfma_f32_16x16x32_bf16 v[208:211], a[44:47], v[152:155], v[208:211]
ds_read_b128 v[184:187], v29 offset:25600
v_mfma_f32_16x16x32_bf16 v[212:215], a[44:47], v[156:159], v[212:215]
ds_read_b128 v[188:191], v29 offset:34816
v_mfma_f32_16x16x32_bf16 v[220:223], a[80:83], v[84:87], v[220:223]
s_waitcnt lgkmcnt(4)
v_mfma_f32_16x16x32_bf16 v[208:211], a[48:51], v[160:163], v[208:211]
ds_read_b128 v[192:195], v29 offset:8192
v_mfma_f32_16x16x32_bf16 v[212:215], a[48:51], v[164:167], v[212:215]
ds_read_b128 v[196:199], v29 offset:17408
s_waitcnt vmcnt(4)
ds_write_b32 v18, v24
v_mfma_f32_16x16x32_bf16 v[208:211], a[52:55], v[168:171], v[208:211]
ds_read_b128 v[200:203], v29 offset:26624
v_mfma_f32_16x16x32_bf16 v[212:215], a[52:55], v[172:175], v[212:215]
ds_read_b128 v[204:207], v29 offset:35840
v_mfma_f32_16x16x32_bf16 v[216:219], a[84:87], v[88:91], v[216:219]
s_waitcnt lgkmcnt(2)
s_barrier
v_mfma_f32_16x16x32_bf16 v[208:211], a[56:59], v[176:179], v[208:211]
ds_read_b32 v33, v32
v_mfma_f32_16x16x32_bf16 v[212:215], a[56:59], v[180:183], v[212:215]
v_mfma_f32_16x16x32_bf16 v[208:211], a[60:63], v[184:187], v[208:211]
v_mfma_f32_16x16x32_bf16 v[212:215], a[60:63], v[188:191], v[212:215]
s_waitcnt lgkmcnt(0)
v_cmp_gt_u32 vcc, s52, v33
v_mfma_f32_16x16x32_bf16 v[220:223], a[84:87], v[92:95], v[220:223]
v_cmp_gt_u32 s[58:59], s54, v33
v_mfma_f32_16x16x32_bf16 v[208:211], a[64:67], v[192:195], v[208:211]
s_and_b32 vcc_lo, vcc_lo, s56
s_cselect_b32 s70, 0, 1
v_mfma_f32_16x16x32_bf16 v[212:215], a[64:67], v[196:199], v[212:215]
s_and_b32 s59, s59, s56
s_cselect_b32 s71, 0, s83
v_mfma_f32_16x16x32_bf16 v[208:211], a[68:71], v[200:203], v[208:211]
s_or_b32 s88, s70, s71
s_cselect_b32 s10, 268435456, 0
v_mfma_f32_16x16x32_bf16 v[212:215], a[68:71], v[204:207], v[212:215]
s_cmp_lg_u32 s70, 0
s_cselect_b64 s[84:85], s[52:53], s[54:55]
s_cselect_b64 s[58:59], s[44:45], s[46:47]
v_mfma_f32_16x16x32_bf16 v[216:219], a[88:91], v[96:99], v[216:219]
s_mul_i32 s86, s84, s20
s_add_u32 s86, s86, s58
v_mfma_f32_16x16x32_bf16 v[220:223], a[88:91], v[100:103], v[220:223]
s_add_u32 m0, s50, 0
s_mul_i32 s87, s84, s21
s_add_u32 s87, s87, s59
v_mfma_f32_16x16x32_bf16 v[216:219], a[92:95], v[104:107], v[216:219]
buffer_load_dwordx4 v8, s[8:11], s86 offen offset:0 sc1 lds
v_mfma_f32_16x16x32_bf16 v[220:223], a[92:95], v[108:111], v[220:223]
s_andn2_b32 s71, s71, s70
s_add_u32 s52, s52, s70
s_add_u32 s54, s54, s71
v_mfma_f32_16x16x32_bf16 v[216:219], a[96:99], v[112:115], v[216:219]
s_mov_b32 s89, s88
v_mfma_f32_16x16x32_bf16 v[220:223], a[96:99], v[116:119], v[220:223]
buffer_load_dwordx4 v9, s[8:11], s86 offen offset:1024 sc1 lds
v_mfma_f32_16x16x32_bf16 v[216:219], a[100:103], v[120:123], v[216:219]
v_permlane32_swap_b32 v208, v212
v_mfma_f32_16x16x32_bf16 v[220:223], a[100:103], v[124:127], v[220:223]
v_permlane32_swap_b32 v209, v213
v_mfma_f32_16x16x32_bf16 v[216:219], a[104:107], v[128:131], v[216:219]
buffer_load_dwordx4 v10, s[8:11], s86 offen offset:2048 sc1 lds
v_mfma_f32_16x16x32_bf16 v[220:223], a[104:107], v[132:135], v[220:223]
v_permlane32_swap_b32 v210, v214
v_mfma_f32_16x16x32_bf16 v[216:219], a[108:111], v[136:139], v[216:219]
v_permlane32_swap_b32 v211, v215
v_mfma_f32_16x16x32_bf16 v[220:223], a[108:111], v[140:143], v[220:223]
buffer_load_dwordx4 v11, s[8:11], s86 offen offset:3072 sc1 lds
v_mfma_f32_16x16x32_bf16 v[216:219], a[112:115], v[144:147], v[216:219]
v_mul_f32 v232, s57, v208
v_mul_f32 v233, s57, v209
v_mfma_f32_16x16x32_bf16 v[220:223], a[112:115], v[148:151], v[220:223]
s_add_u32 m0, s50, 4096
v_mul_f32 v234, s57, v210
v_mfma_f32_16x16x32_bf16 v[216:219], a[116:119], v[152:155], v[216:219]
buffer_load_dwordx4 v12, s[8:11], s86 offen offset:0 sc1 lds
v_mfma_f32_16x16x32_bf16 v[220:223], a[116:119], v[156:159], v[220:223]
v_mul_f32 v235, s57, v211
v_mfma_f32_16x16x32_bf16 v[216:219], a[120:123], v[160:163], v[216:219]
v_exp_f32 v232, v232
v_mfma_f32_16x16x32_bf16 v[220:223], a[120:123], v[164:167], v[220:223]
buffer_load_dwordx4 v13, s[8:11], s86 offen offset:1024 sc1 lds
v_mfma_f32_16x16x32_bf16 v[216:219], a[124:127], v[168:171], v[216:219]
v_exp_f32 v233, v233
v_mfma_f32_16x16x32_bf16 v[220:223], a[124:127], v[172:175], v[220:223]
v_exp_f32 v234, v234
v_mfma_f32_16x16x32_bf16 v[216:219], a[128:131], v[176:179], v[216:219]
buffer_load_dwordx4 v14, s[8:11], s86 offen offset:2048 sc1 lds
v_mfma_f32_16x16x32_bf16 v[220:223], a[128:131], v[180:183], v[220:223]
v_exp_f32 v235, v235
v_mfma_f32_16x16x32_bf16 v[216:219], a[132:135], v[184:187], v[216:219]
v_add_f32 v232, 1.0, v232
v_add_f32 v233, 1.0, v233
v_mfma_f32_16x16x32_bf16 v[220:223], a[132:135], v[188:191], v[220:223]
buffer_load_dwordx4 v15, s[8:11], s86 offen offset:3072 sc1 lds
v_mfma_f32_16x16x32_bf16 v[216:219], a[136:139], v[192:195], v[216:219]
v_add_f32 v234, 1.0, v234
v_add_f32 v235, 1.0, v235
v_mfma_f32_16x16x32_bf16 v[220:223], a[136:139], v[196:199], v[220:223]
s_add_u32 m0, s50, 8192
v_mfma_f32_16x16x32_bf16 v[216:219], a[140:143], v[200:203], v[216:219]
buffer_load_dwordx4 v16, s[8:11], s86 offen offset:0 sc1 lds
v_mfma_f32_16x16x32_bf16 v[220:223], a[140:143], v[204:207], v[220:223]
v_rcp_f32 v232, v232
v_mfma_f32_16x16x32_bf16 v[224:227], a[144:147], v[64:67], 0
v_rcp_f32 v233, v233
v_mfma_f32_16x16x32_bf16 v[228:231], a[144:147], v[68:71], 0
v_rcp_f32 v234, v234
v_mfma_f32_16x16x32_bf16 v[224:227], a[148:151], v[72:75], v[224:227]
v_rcp_f32 v235, v235
v_mfma_f32_16x16x32_bf16 v[228:231], a[148:151], v[76:79], v[228:231]
v_mul_f32 v212, v208, v212
v_mul_f32 v213, v209, v213
v_mfma_f32_16x16x32_bf16 v[224:227], a[152:155], v[80:83], v[224:227]
buffer_load_dword v24, v22, s[4:7], 0 offen sc1
v_mfma_f32_16x16x32_bf16 v[228:231], a[152:155], v[84:87], v[228:231]
v_mul_f32 v214, v210, v214
v_mul_f32 v215, v211, v215
v_mul_f32 v236, s57, v216
v_mul_f32 v237, s57, v217
v_mul_f32 v238, s57, v218
v_mul_f32 v239, s57, v219
v_exp_f32 v236, v236
v_exp_f32 v237, v237
v_exp_f32 v238, v238
v_exp_f32 v239, v239
v_add_f32 v236, 1.0, v236
v_add_f32 v237, 1.0, v237
v_add_f32 v238, 1.0, v238
v_add_f32 v239, 1.0, v239
v_rcp_f32 v236, v236
v_rcp_f32 v237, v237
v_mfma_f32_16x16x32_bf16 v[224:227], a[156:159], v[88:91], v[224:227]
s_waitcnt vmcnt(10)
s_barrier
v_mfma_f32_16x16x32_bf16 v[228:231], a[156:159], v[92:95], v[228:231]
buffer_store_dword v27, v45, s[4:7], s73 offen
v_mfma_f32_16x16x32_bf16 v[224:227], a[160:163], v[96:99], v[224:227]
buffer_store_dword v27, v44, s[4:7], s73 offen sc1
v_mfma_f32_16x16x32_bf16 v[228:231], a[160:163], v[100:103], v[228:231]
v_mul_f32 v212, v212, v232
v_mul_f32 v213, v213, v233
v_mfma_f32_16x16x32_bf16 v[224:227], a[164:167], v[104:107], v[224:227]
v_mul_f32 v214, v214, v234
v_mul_f32 v215, v215, v235
v_mfma_f32_16x16x32_bf16 v[228:231], a[164:167], v[108:111], v[228:231]
v_cvt_pk_bf16_f32 v48, v212, v213
v_cvt_pk_bf16_f32 v49, v214, v215
v_mfma_f32_16x16x32_bf16 v[224:227], a[168:171], v[112:115], v[224:227]
buffer_store_dwordx2 v[48:49], v19, s[4:7], s81 offen sc1
v_mfma_f32_16x16x32_bf16 v[228:231], a[168:171], v[116:119], v[228:231]
v_rcp_f32 v238, v238
v_mfma_f32_16x16x32_bf16 v[224:227], a[172:175], v[120:123], v[224:227]
v_rcp_f32 v239, v239
v_mfma_f32_16x16x32_bf16 v[228:231], a[172:175], v[124:127], v[228:231]
v_mul_f32 v240, s57, v220
v_mul_f32 v241, s57, v221
v_mfma_f32_16x16x32_bf16 v[224:227], a[176:179], v[128:131], v[224:227]
v_mul_f32 v242, s57, v222
v_mul_f32 v243, s57, v223
v_mfma_f32_16x16x32_bf16 v[228:231], a[176:179], v[132:135], v[228:231]
v_mul_f32 v236, v216, v236
v_mul_f32 v237, v217, v237
v_mfma_f32_16x16x32_bf16 v[224:227], a[180:183], v[136:139], v[224:227]
v_mul_f32 v238, v218, v238
v_mul_f32 v239, v219, v239
v_mfma_f32_16x16x32_bf16 v[228:231], a[180:183], v[140:143], v[228:231]
v_exp_f32 v240, v240
v_mfma_f32_16x16x32_bf16 v[224:227], a[184:187], v[144:147], v[224:227]
v_exp_f32 v241, v241
v_mfma_f32_16x16x32_bf16 v[228:231], a[184:187], v[148:151], v[228:231]
v_exp_f32 v242, v242
v_mfma_f32_16x16x32_bf16 v[224:227], a[188:191], v[152:155], v[224:227]
v_exp_f32 v243, v243
v_mfma_f32_16x16x32_bf16 v[228:231], a[188:191], v[156:159], v[228:231]
v_add_f32 v240, 1.0, v240
v_add_f32 v241, 1.0, v241
v_mfma_f32_16x16x32_bf16 v[224:227], a[192:195], v[160:163], v[224:227]
s_waitcnt vmcnt(11)
s_barrier
v_mfma_f32_16x16x32_bf16 v[228:231], a[192:195], v[164:167], v[228:231]
v_add_f32 v242, 1.0, v242
v_add_f32 v243, 1.0, v243
v_mfma_f32_16x16x32_bf16 v[224:227], a[196:199], v[168:171], v[224:227]
s_cmp_eq_u32 s88, 0
s_cbranch_scc1 g_slow_160
v_mfma_f32_16x16x32_bf16 v[228:231], a[196:199], v[172:175], v[228:231]
v_rcp_f32 v240, v240
ds_read_b128 v[64:67], v30 offset:0
v_mfma_f32_16x16x32_bf16 v[224:227], a[200:203], v[176:179], v[224:227]
v_rcp_f32 v241, v241
ds_read_b128 v[68:71], v30 offset:9216
v_mfma_f32_16x16x32_bf16 v[228:231], a[200:203], v[180:183], v[228:231]
v_rcp_f32 v242, v242
ds_read_b128 v[72:75], v30 offset:18432
v_mfma_f32_16x16x32_bf16 v[224:227], a[204:207], v[184:187], v[224:227]
v_rcp_f32 v243, v243
ds_read_b128 v[76:79], v30 offset:27648
v_mfma_f32_16x16x32_bf16 v[228:231], a[204:207], v[188:191], v[228:231]
v_mul_f32 v240, v220, v240
ds_read_b128 v[80:83], v30 offset:1024
v_mfma_f32_16x16x32_bf16 v[224:227], a[208:211], v[192:195], v[224:227]
v_mul_f32 v241, v221, v241
ds_read_b128 v[84:87], v30 offset:10240
v_mfma_f32_16x16x32_bf16 v[228:231], a[208:211], v[196:199], v[228:231]
v_mul_f32 v242, v222, v242
ds_read_b128 v[88:91], v30 offset:19456
v_mfma_f32_16x16x32_bf16 v[224:227], a[212:215], v[200:203], v[224:227]
v_mul_f32 v243, v223, v243
ds_read_b128 v[92:95], v30 offset:28672
v_mfma_f32_16x16x32_bf16 v[228:231], a[212:215], v[204:207], v[228:231]
s_waitcnt vmcnt(8)
s_barrier
g_body_149:
s_waitcnt lgkmcnt(4)
v_mfma_f32_16x16x32_bf16 v[208:211], a[0:3], v[64:67], 0
ds_read_b128 v[96:99], v30 offset:2048
v_mfma_f32_16x16x32_bf16 v[212:215], a[0:3], v[68:71], 0
ds_read_b128 v[100:103], v30 offset:11264
v_mfma_f32_16x16x32_bf16 v[208:211], a[4:7], v[72:75], v[208:211]
ds_read_b128 v[104:107], v30 offset:20480
v_mfma_f32_16x16x32_bf16 v[212:215], a[4:7], v[76:79], v[212:215]
ds_read_b128 v[108:111], v30 offset:29696
v_mul_f32 v224, v224, v236
v_mul_f32 v225, v225, v237
v_mul_f32 v226, v226, v238
v_mul_f32 v227, v227, v239
v_mul_f32 v228, v228, v240
v_mfma_f32_16x16x32_bf16 v[216:219], a[72:75], v[64:67], 0
v_mul_f32 v229, v229, v241
s_waitcnt lgkmcnt(4)
v_mfma_f32_16x16x32_bf16 v[208:211], a[8:11], v[80:83], v[208:211]
ds_read_b128 v[112:115], v30 offset:3072
v_mul_f32 v230, v230, v242
v_mfma_f32_16x16x32_bf16 v[212:215], a[8:11], v[84:87], v[212:215]
ds_read_b128 v[116:119], v30 offset:12288
v_mul_f32 v231, v231, v243
v_mfma_f32_16x16x32_bf16 v[208:211], a[12:15], v[88:91], v[208:211]
ds_read_b128 v[120:123], v30 offset:21504
v_cvt_pk_bf16_f32 v52, v224, v225
v_mfma_f32_16x16x32_bf16 v[212:215], a[12:15], v[92:95], v[212:215]
ds_read_b128 v[124:127], v30 offset:30720
v_cvt_pk_bf16_f32 v53, v226, v227
v_mfma_f32_16x16x32_bf16 v[220:223], a[72:75], v[68:71], 0
v_cvt_pk_bf16_f32 v54, v228, v229
s_waitcnt lgkmcnt(4)
v_mfma_f32_16x16x32_bf16 v[208:211], a[16:19], v[96:99], v[208:211]
ds_read_b128 v[128:131], v30 offset:4096
v_cvt_pk_bf16_f32 v55, v230, v231
v_mfma_f32_16x16x32_bf16 v[212:215], a[16:19], v[100:103], v[212:215]
ds_read_b128 v[132:135], v30 offset:13312
v_permlane16_swap_b32 v52, v54
v_mfma_f32_16x16x32_bf16 v[208:211], a[20:23], v[104:107], v[208:211]
ds_read_b128 v[136:139], v30 offset:22528
v_permlane16_swap_b32 v53, v55
v_mfma_f32_16x16x32_bf16 v[212:215], a[20:23], v[108:111], v[212:215]
ds_read_b128 v[140:143], v30 offset:31744
buffer_store_dwordx4 v[52:55], v20, s[4:7], s81 offen sc1
v_mfma_f32_16x16x32_bf16 v[216:219], a[76:79], v[72:75], v[216:219]
s_waitcnt vmcnt(5)
s_barrier
s_waitcnt lgkmcnt(4)
v_mfma_f32_16x16x32_bf16 v[208:211], a[24:27], v[112:115], v[208:211]
ds_read_b128 v[144:147], v30 offset:5120
v_mov_b32 v27, s78
v_mfma_f32_16x16x32_bf16 v[212:215], a[24:27], v[116:119], v[212:215]
ds_read_b128 v[148:151], v30 offset:14336
v_mfma_f32_16x16x32_bf16 v[208:211], a[28:31], v[120:123], v[208:211]
ds_read_b128 v[152:155], v30 offset:23552
v_mfma_f32_16x16x32_bf16 v[212:215], a[28:31], v[124:127], v[212:215]
ds_read_b128 v[156:159], v30 offset:32768
v_mfma_f32_16x16x32_bf16 v[220:223], a[76:79], v[76:79], v[220:223]
s_waitcnt lgkmcnt(4)
v_mfma_f32_16x16x32_bf16 v[208:211], a[32:35], v[128:131], v[208:211]
ds_read_b128 v[160:163], v30 offset:6144
v_mfma_f32_16x16x32_bf16 v[212:215], a[32:35], v[132:135], v[212:215]
ds_read_b128 v[164:167], v30 offset:15360
v_mfma_f32_16x16x32_bf16 v[208:211], a[36:39], v[136:139], v[208:211]
ds_read_b128 v[168:171], v30 offset:24576
v_mfma_f32_16x16x32_bf16 v[212:215], a[36:39], v[140:143], v[212:215]
ds_read_b128 v[172:175], v30 offset:33792
v_mfma_f32_16x16x32_bf16 v[216:219], a[80:83], v[80:83], v[216:219]
s_waitcnt lgkmcnt(4)
v_mfma_f32_16x16x32_bf16 v[208:211], a[40:43], v[144:147], v[208:211]
ds_read_b128 v[176:179], v30 offset:7168
v_mfma_f32_16x16x32_bf16 v[212:215], a[40:43], v[148:151], v[212:215]
ds_read_b128 v[180:183], v30 offset:16384
v_mfma_f32_16x16x32_bf16 v[208:211], a[44:47], v[152:155], v[208:211]
ds_read_b128 v[184:187], v30 offset:25600
v_mfma_f32_16x16x32_bf16 v[212:215], a[44:47], v[156:159], v[212:215]
ds_read_b128 v[188:191], v30 offset:34816
v_mfma_f32_16x16x32_bf16 v[220:223], a[80:83], v[84:87], v[220:223]
s_waitcnt lgkmcnt(4)
v_mfma_f32_16x16x32_bf16 v[208:211], a[48:51], v[160:163], v[208:211]
ds_read_b128 v[192:195], v30 offset:8192
v_mfma_f32_16x16x32_bf16 v[212:215], a[48:51], v[164:167], v[212:215]
ds_read_b128 v[196:199], v30 offset:17408
s_waitcnt vmcnt(4)
ds_write_b32 v18, v24
v_mfma_f32_16x16x32_bf16 v[208:211], a[52:55], v[168:171], v[208:211]
ds_read_b128 v[200:203], v30 offset:26624
v_mfma_f32_16x16x32_bf16 v[212:215], a[52:55], v[172:175], v[212:215]
ds_read_b128 v[204:207], v30 offset:35840
v_mfma_f32_16x16x32_bf16 v[216:219], a[84:87], v[88:91], v[216:219]
s_waitcnt lgkmcnt(2)
s_barrier
v_mfma_f32_16x16x32_bf16 v[208:211], a[56:59], v[176:179], v[208:211]
ds_read_b32 v33, v32
v_mfma_f32_16x16x32_bf16 v[212:215], a[56:59], v[180:183], v[212:215]
v_mfma_f32_16x16x32_bf16 v[208:211], a[60:63], v[184:187], v[208:211]
v_mfma_f32_16x16x32_bf16 v[212:215], a[60:63], v[188:191], v[212:215]
s_waitcnt lgkmcnt(0)
v_cmp_gt_u32 vcc, s52, v33
v_mfma_f32_16x16x32_bf16 v[220:223], a[84:87], v[92:95], v[220:223]
v_cmp_gt_u32 s[58:59], s54, v33
v_mfma_f32_16x16x32_bf16 v[208:211], a[64:67], v[192:195], v[208:211]
s_and_b32 vcc_lo, vcc_lo, s56
s_cselect_b32 s70, 0, 1
v_mfma_f32_16x16x32_bf16 v[212:215], a[64:67], v[196:199], v[212:215]
s_and_b32 s59, s59, s56
s_cselect_b32 s71, 0, s89
v_mfma_f32_16x16x32_bf16 v[208:211], a[68:71], v[200:203], v[208:211]
s_or_b32 s94, s70, s71
s_cselect_b32 s10, 268435456, 0
v_mfma_f32_16x16x32_bf16 v[212:215], a[68:71], v[204:207], v[212:215]
s_cmp_lg_u32 s70, 0
s_cselect_b64 s[90:91], s[52:53], s[54:55]
s_cselect_b64 s[58:59], s[44:45], s[46:47]
v_mfma_f32_16x16x32_bf16 v[216:219], a[88:91], v[96:99], v[216:219]
s_mul_i32 s92, s90, s20
s_add_u32 s92, s92, s58
v_mfma_f32_16x16x32_bf16 v[220:223], a[88:91], v[100:103], v[220:223]
s_add_u32 m0, s51, 0
s_mul_i32 s93, s90, s21
s_add_u32 s93, s93, s59
v_mfma_f32_16x16x32_bf16 v[216:219], a[92:95], v[104:107], v[216:219]
buffer_load_dwordx4 v8, s[8:11], s92 offen offset:0 sc1 lds
v_mfma_f32_16x16x32_bf16 v[220:223], a[92:95], v[108:111], v[220:223]
s_andn2_b32 s71, s71, s70
s_add_u32 s52, s52, s70
s_add_u32 s54, s54, s71
v_mfma_f32_16x16x32_bf16 v[216:219], a[96:99], v[112:115], v[216:219]
s_mov_b32 s95, s94
v_mfma_f32_16x16x32_bf16 v[220:223], a[96:99], v[116:119], v[220:223]
buffer_load_dwordx4 v9, s[8:11], s92 offen offset:1024 sc1 lds
v_mfma_f32_16x16x32_bf16 v[216:219], a[100:103], v[120:123], v[216:219]
v_permlane32_swap_b32 v208, v212
v_mfma_f32_16x16x32_bf16 v[220:223], a[100:103], v[124:127], v[220:223]
v_permlane32_swap_b32 v209, v213
v_mfma_f32_16x16x32_bf16 v[216:219], a[104:107], v[128:131], v[216:219]
buffer_load_dwordx4 v10, s[8:11], s92 offen offset:2048 sc1 lds
v_mfma_f32_16x16x32_bf16 v[220:223], a[104:107], v[132:135], v[220:223]
v_permlane32_swap_b32 v210, v214
v_mfma_f32_16x16x32_bf16 v[216:219], a[108:111], v[136:139], v[216:219]
v_permlane32_swap_b32 v211, v215
v_mfma_f32_16x16x32_bf16 v[220:223], a[108:111], v[140:143], v[220:223]
buffer_load_dwordx4 v11, s[8:11], s92 offen offset:3072 sc1 lds
v_mfma_f32_16x16x32_bf16 v[216:219], a[112:115], v[144:147], v[216:219]
v_mul_f32 v232, s57, v208
v_mul_f32 v233, s57, v209
v_mfma_f32_16x16x32_bf16 v[220:223], a[112:115], v[148:151], v[220:223]
s_add_u32 m0, s51, 4096
v_mul_f32 v234, s57, v210
v_mfma_f32_16x16x32_bf16 v[216:219], a[116:119], v[152:155], v[216:219]
buffer_load_dwordx4 v12, s[8:11], s92 offen offset:0 sc1 lds
v_mfma_f32_16x16x32_bf16 v[220:223], a[116:119], v[156:159], v[220:223]
v_mul_f32 v235, s57, v211
v_mfma_f32_16x16x32_bf16 v[216:219], a[120:123], v[160:163], v[216:219]
v_exp_f32 v232, v232
v_mfma_f32_16x16x32_bf16 v[220:223], a[120:123], v[164:167], v[220:223]
buffer_load_dwordx4 v13, s[8:11], s92 offen offset:1024 sc1 lds
v_mfma_f32_16x16x32_bf16 v[216:219], a[124:127], v[168:171], v[216:219]
v_exp_f32 v233, v233
v_mfma_f32_16x16x32_bf16 v[220:223], a[124:127], v[172:175], v[220:223]
v_exp_f32 v234, v234
v_mfma_f32_16x16x32_bf16 v[216:219], a[128:131], v[176:179], v[216:219]
buffer_load_dwordx4 v14, s[8:11], s92 offen offset:2048 sc1 lds
v_mfma_f32_16x16x32_bf16 v[220:223], a[128:131], v[180:183], v[220:223]
v_exp_f32 v235, v235
v_mfma_f32_16x16x32_bf16 v[216:219], a[132:135], v[184:187], v[216:219]
v_add_f32 v232, 1.0, v232
v_add_f32 v233, 1.0, v233
v_mfma_f32_16x16x32_bf16 v[220:223], a[132:135], v[188:191], v[220:223]
buffer_load_dwordx4 v15, s[8:11], s92 offen offset:3072 sc1 lds
v_mfma_f32_16x16x32_bf16 v[216:219], a[136:139], v[192:195], v[216:219]
v_add_f32 v234, 1.0, v234
v_add_f32 v235, 1.0, v235
v_mfma_f32_16x16x32_bf16 v[220:223], a[136:139], v[196:199], v[220:223]
s_add_u32 m0, s51, 8192
v_mfma_f32_16x16x32_bf16 v[216:219], a[140:143], v[200:203], v[216:219]
buffer_load_dwordx4 v16, s[8:11], s92 offen offset:0 sc1 lds
v_mfma_f32_16x16x32_bf16 v[220:223], a[140:143], v[204:207], v[220:223]
v_rcp_f32 v232, v232
v_mfma_f32_16x16x32_bf16 v[224:227], a[144:147], v[64:67], 0
v_rcp_f32 v233, v233
v_mfma_f32_16x16x32_bf16 v[228:231], a[144:147], v[68:71], 0
v_rcp_f32 v234, v234
v_mfma_f32_16x16x32_bf16 v[224:227], a[148:151], v[72:75], v[224:227]
v_rcp_f32 v235, v235
v_mfma_f32_16x16x32_bf16 v[228:231], a[148:151], v[76:79], v[228:231]
v_mul_f32 v212, v208, v212
v_mul_f32 v213, v209, v213
v_mfma_f32_16x16x32_bf16 v[224:227], a[152:155], v[80:83], v[224:227]
buffer_load_dword v24, v22, s[4:7], 0 offen sc1
v_mfma_f32_16x16x32_bf16 v[228:231], a[152:155], v[84:87], v[228:231]
v_mul_f32 v214, v210, v214
v_mul_f32 v215, v211, v215
v_mul_f32 v236, s57, v216
v_mul_f32 v237, s57, v217
v_mul_f32 v238, s57, v218
v_mul_f32 v239, s57, v219
v_exp_f32 v236, v236
v_exp_f32 v237, v237
v_exp_f32 v238, v238
v_exp_f32 v239, v239
v_add_f32 v236, 1.0, v236
v_add_f32 v237, 1.0, v237
v_add_f32 v238, 1.0, v238
v_add_f32 v239, 1.0, v239
v_rcp_f32 v236, v236
v_rcp_f32 v237, v237
v_mfma_f32_16x16x32_bf16 v[224:227], a[156:159], v[88:91], v[224:227]
s_waitcnt vmcnt(10)
s_barrier
v_mfma_f32_16x16x32_bf16 v[228:231], a[156:159], v[92:95], v[228:231]
buffer_store_dword v27, v45, s[4:7], s79 offen
v_mfma_f32_16x16x32_bf16 v[224:227], a[160:163], v[96:99], v[224:227]
buffer_store_dword v27, v44, s[4:7], s79 offen sc1
v_mfma_f32_16x16x32_bf16 v[228:231], a[160:163], v[100:103], v[228:231]
v_mul_f32 v212, v212, v232
v_mul_f32 v213, v213, v233
v_mfma_f32_16x16x32_bf16 v[224:227], a[164:167], v[104:107], v[224:227]
v_mul_f32 v214, v214, v234
v_mul_f32 v215, v215, v235
v_mfma_f32_16x16x32_bf16 v[228:231], a[164:167], v[108:111], v[228:231]
v_cvt_pk_bf16_f32 v48, v212, v213
v_cvt_pk_bf16_f32 v49, v214, v215
v_mfma_f32_16x16x32_bf16 v[224:227], a[168:171], v[112:115], v[224:227]
buffer_store_dwordx2 v[48:49], v19, s[4:7], s87 offen sc1
v_mfma_f32_16x16x32_bf16 v[228:231], a[168:171], v[116:119], v[228:231]
v_rcp_f32 v238, v238
v_mfma_f32_16x16x32_bf16 v[224:227], a[172:175], v[120:123], v[224:227]
v_rcp_f32 v239, v239
v_mfma_f32_16x16x32_bf16 v[228:231], a[172:175], v[124:127], v[228:231]
v_mul_f32 v240, s57, v220
v_mul_f32 v241, s57, v221
v_mfma_f32_16x16x32_bf16 v[224:227], a[176:179], v[128:131], v[224:227]
v_mul_f32 v242, s57, v222
v_mul_f32 v243, s57, v223
v_mfma_f32_16x16x32_bf16 v[228:231], a[176:179], v[132:135], v[228:231]
v_mul_f32 v236, v216, v236
v_mul_f32 v237, v217, v237
v_mfma_f32_16x16x32_bf16 v[224:227], a[180:183], v[136:139], v[224:227]
v_mul_f32 v238, v218, v238
v_mul_f32 v239, v219, v239
v_mfma_f32_16x16x32_bf16 v[228:231], a[180:183], v[140:143], v[228:231]
v_exp_f32 v240, v240
v_mfma_f32_16x16x32_bf16 v[224:227], a[184:187], v[144:147], v[224:227]
v_exp_f32 v241, v241
v_mfma_f32_16x16x32_bf16 v[228:231], a[184:187], v[148:151], v[228:231]
v_exp_f32 v242, v242
v_mfma_f32_16x16x32_bf16 v[224:227], a[188:191], v[152:155], v[224:227]
v_exp_f32 v243, v243
v_mfma_f32_16x16x32_bf16 v[228:231], a[188:191], v[156:159], v[228:231]
v_add_f32 v240, 1.0, v240
v_add_f32 v241, 1.0, v241
v_mfma_f32_16x16x32_bf16 v[224:227], a[192:195], v[160:163], v[224:227]
s_waitcnt vmcnt(11)
s_barrier
v_mfma_f32_16x16x32_bf16 v[228:231], a[192:195], v[164:167], v[228:231]
v_add_f32 v242, 1.0, v242
v_add_f32 v243, 1.0, v243
v_mfma_f32_16x16x32_bf16 v[224:227], a[196:199], v[168:171], v[224:227]
s_cmp_eq_u32 s94, 0
s_cbranch_scc1 g_slow_161
v_mfma_f32_16x16x32_bf16 v[228:231], a[196:199], v[172:175], v[228:231]
v_rcp_f32 v240, v240
ds_read_b128 v[64:67], v31 offset:0
v_mfma_f32_16x16x32_bf16 v[224:227], a[200:203], v[176:179], v[224:227]
v_rcp_f32 v241, v241
ds_read_b128 v[68:71], v31 offset:9216
v_mfma_f32_16x16x32_bf16 v[228:231], a[200:203], v[180:183], v[228:231]
v_rcp_f32 v242, v242
ds_read_b128 v[72:75], v31 offset:18432
v_mfma_f32_16x16x32_bf16 v[224:227], a[204:207], v[184:187], v[224:227]
v_rcp_f32 v243, v243
ds_read_b128 v[76:79], v31 offset:27648
v_mfma_f32_16x16x32_bf16 v[228:231], a[204:207], v[188:191], v[228:231]
v_mul_f32 v240, v220, v240
ds_read_b128 v[80:83], v31 offset:1024
v_mfma_f32_16x16x32_bf16 v[224:227], a[208:211], v[192:195], v[224:227]
v_mul_f32 v241, v221, v241
ds_read_b128 v[84:87], v31 offset:10240
v_mfma_f32_16x16x32_bf16 v[228:231], a[208:211], v[196:199], v[228:231]
v_mul_f32 v242, v222, v242
ds_read_b128 v[88:91], v31 offset:19456
v_mfma_f32_16x16x32_bf16 v[224:227], a[212:215], v[200:203], v[224:227]
v_mul_f32 v243, v223, v243
ds_read_b128 v[92:95], v31 offset:28672
v_mfma_f32_16x16x32_bf16 v[228:231], a[212:215], v[204:207], v[228:231]
s_waitcnt vmcnt(8)
s_barrier
g_body_150:
s_waitcnt lgkmcnt(4)
v_mfma_f32_16x16x32_bf16 v[208:211], a[0:3], v[64:67], 0
ds_read_b128 v[96:99], v31 offset:2048
v_mfma_f32_16x16x32_bf16 v[212:215], a[0:3], v[68:71], 0
ds_read_b128 v[100:103], v31 offset:11264
v_mfma_f32_16x16x32_bf16 v[208:211], a[4:7], v[72:75], v[208:211]
ds_read_b128 v[104:107], v31 offset:20480
v_mfma_f32_16x16x32_bf16 v[212:215], a[4:7], v[76:79], v[212:215]
ds_read_b128 v[108:111], v31 offset:29696
v_mul_f32 v224, v224, v236
v_mul_f32 v225, v225, v237
v_mul_f32 v226, v226, v238
v_mul_f32 v227, v227, v239
v_mul_f32 v228, v228, v240
v_mfma_f32_16x16x32_bf16 v[216:219], a[72:75], v[64:67], 0
v_mul_f32 v229, v229, v241
s_waitcnt lgkmcnt(4)
v_mfma_f32_16x16x32_bf16 v[208:211], a[8:11], v[80:83], v[208:211]
ds_read_b128 v[112:115], v31 offset:3072
v_mul_f32 v230, v230, v242
v_mfma_f32_16x16x32_bf16 v[212:215], a[8:11], v[84:87], v[212:215]
ds_read_b128 v[116:119], v31 offset:12288
v_mul_f32 v231, v231, v243
v_mfma_f32_16x16x32_bf16 v[208:211], a[12:15], v[88:91], v[208:211]
ds_read_b128 v[120:123], v31 offset:21504
v_cvt_pk_bf16_f32 v52, v224, v225
v_mfma_f32_16x16x32_bf16 v[212:215], a[12:15], v[92:95], v[212:215]
ds_read_b128 v[124:127], v31 offset:30720
v_cvt_pk_bf16_f32 v53, v226, v227
v_mfma_f32_16x16x32_bf16 v[220:223], a[72:75], v[68:71], 0
v_cvt_pk_bf16_f32 v54, v228, v229
s_waitcnt lgkmcnt(4)
v_mfma_f32_16x16x32_bf16 v[208:211], a[16:19], v[96:99], v[208:211]
ds_read_b128 v[128:131], v31 offset:4096
v_cvt_pk_bf16_f32 v55, v230, v231
v_mfma_f32_16x16x32_bf16 v[212:215], a[16:19], v[100:103], v[212:215]
ds_read_b128 v[132:135], v31 offset:13312
v_permlane16_swap_b32 v52, v54
v_mfma_f32_16x16x32_bf16 v[208:211], a[20:23], v[104:107], v[208:211]
ds_read_b128 v[136:139], v31 offset:22528
v_permlane16_swap_b32 v53, v55
v_mfma_f32_16x16x32_bf16 v[212:215], a[20:23], v[108:111], v[212:215]
ds_read_b128 v[140:143], v31 offset:31744
buffer_store_dwordx4 v[52:55], v20, s[4:7], s87 offen sc1
v_mfma_f32_16x16x32_bf16 v[216:219], a[76:79], v[72:75], v[216:219]
s_waitcnt vmcnt(5)
s_barrier
s_waitcnt lgkmcnt(4)
v_mfma_f32_16x16x32_bf16 v[208:211], a[24:27], v[112:115], v[208:211]
ds_read_b128 v[144:147], v31 offset:5120
v_mov_b32 v27, s84
v_mfma_f32_16x16x32_bf16 v[212:215], a[24:27], v[116:119], v[212:215]
ds_read_b128 v[148:151], v31 offset:14336
v_mfma_f32_16x16x32_bf16 v[208:211], a[28:31], v[120:123], v[208:211]
ds_read_b128 v[152:155], v31 offset:23552
v_mfma_f32_16x16x32_bf16 v[212:215], a[28:31], v[124:127], v[212:215]
ds_read_b128 v[156:159], v31 offset:32768
v_mfma_f32_16x16x32_bf16 v[220:223], a[76:79], v[76:79], v[220:223]
s_waitcnt lgkmcnt(4)
v_mfma_f32_16x16x32_bf16 v[208:211], a[32:35], v[128:131], v[208:211]
ds_read_b128 v[160:163], v31 offset:6144
v_mfma_f32_16x16x32_bf16 v[212:215], a[32:35], v[132:135], v[212:215]
ds_read_b128 v[164:167], v31 offset:15360
v_mfma_f32_16x16x32_bf16 v[208:211], a[36:39], v[136:139], v[208:211]
ds_read_b128 v[168:171], v31 offset:24576
v_mfma_f32_16x16x32_bf16 v[212:215], a[36:39], v[140:143], v[212:215]
ds_read_b128 v[172:175], v31 offset:33792
v_mfma_f32_16x16x32_bf16 v[216:219], a[80:83], v[80:83], v[216:219]
s_waitcnt lgkmcnt(4)
v_mfma_f32_16x16x32_bf16 v[208:211], a[40:43], v[144:147], v[208:211]
ds_read_b128 v[176:179], v31 offset:7168
v_mfma_f32_16x16x32_bf16 v[212:215], a[40:43], v[148:151], v[212:215]
ds_read_b128 v[180:183], v31 offset:16384
v_mfma_f32_16x16x32_bf16 v[208:211], a[44:47], v[152:155], v[208:211]
ds_read_b128 v[184:187], v31 offset:25600
v_mfma_f32_16x16x32_bf16 v[212:215], a[44:47], v[156:159], v[212:215]
ds_read_b128 v[188:191], v31 offset:34816
v_mfma_f32_16x16x32_bf16 v[220:223], a[80:83], v[84:87], v[220:223]
s_waitcnt lgkmcnt(4)
v_mfma_f32_16x16x32_bf16 v[208:211], a[48:51], v[160:163], v[208:211]
ds_read_b128 v[192:195], v31 offset:8192
v_mfma_f32_16x16x32_bf16 v[212:215], a[48:51], v[164:167], v[212:215]
ds_read_b128 v[196:199], v31 offset:17408
s_waitcnt vmcnt(4)
ds_write_b32 v18, v24
v_mfma_f32_16x16x32_bf16 v[208:211], a[52:55], v[168:171], v[208:211]
ds_read_b128 v[200:203], v31 offset:26624
v_mfma_f32_16x16x32_bf16 v[212:215], a[52:55], v[172:175], v[212:215]
ds_read_b128 v[204:207], v31 offset:35840
v_mfma_f32_16x16x32_bf16 v[216:219], a[84:87], v[88:91], v[216:219]
s_waitcnt lgkmcnt(2)
s_barrier
v_mfma_f32_16x16x32_bf16 v[208:211], a[56:59], v[176:179], v[208:211]
ds_read_b32 v33, v32
v_mfma_f32_16x16x32_bf16 v[212:215], a[56:59], v[180:183], v[212:215]
v_mfma_f32_16x16x32_bf16 v[208:211], a[60:63], v[184:187], v[208:211]
v_mfma_f32_16x16x32_bf16 v[212:215], a[60:63], v[188:191], v[212:215]
s_waitcnt lgkmcnt(0)
v_cmp_gt_u32 vcc, s52, v33
v_mfma_f32_16x16x32_bf16 v[220:223], a[84:87], v[92:95], v[220:223]
v_cmp_gt_u32 s[58:59], s54, v33
v_mfma_f32_16x16x32_bf16 v[208:211], a[64:67], v[192:195], v[208:211]
s_and_b32 vcc_lo, vcc_lo, s56
s_cselect_b32 s70, 0, 1
v_mfma_f32_16x16x32_bf16 v[212:215], a[64:67], v[196:199], v[212:215]
s_and_b32 s59, s59, s56
s_cselect_b32 s71, 0, s95
v_mfma_f32_16x16x32_bf16 v[208:211], a[68:71], v[200:203], v[208:211]
s_or_b32 s76, s70, s71
s_cselect_b32 s10, 268435456, 0
v_mfma_f32_16x16x32_bf16 v[212:215], a[68:71], v[204:207], v[212:215]
s_cmp_lg_u32 s70, 0
s_cselect_b64 s[72:73], s[52:53], s[54:55]
s_cselect_b64 s[58:59], s[44:45], s[46:47]
v_mfma_f32_16x16x32_bf16 v[216:219], a[88:91], v[96:99], v[216:219]
s_mul_i32 s74, s72, s20
s_add_u32 s74, s74, s58
v_mfma_f32_16x16x32_bf16 v[220:223], a[88:91], v[100:103], v[220:223]
s_add_u32 m0, s48, 0
s_mul_i32 s75, s72, s21
s_add_u32 s75, s75, s59
v_mfma_f32_16x16x32_bf16 v[216:219], a[92:95], v[104:107], v[216:219]
buffer_load_dwordx4 v8, s[8:11], s74 offen offset:0 sc1 lds
v_mfma_f32_16x16x32_bf16 v[220:223], a[92:95], v[108:111], v[220:223]
s_andn2_b32 s71, s71, s70
s_add_u32 s52, s52, s70
s_add_u32 s54, s54, s71
v_mfma_f32_16x16x32_bf16 v[216:219], a[96:99], v[112:115], v[216:219]
s_mov_b32 s77, s76
v_mfma_f32_16x16x32_bf16 v[220:223], a[96:99], v[116:119], v[220:223]
buffer_load_dwordx4 v9, s[8:11], s74 offen offset:1024 sc1 lds
v_mfma_f32_16x16x32_bf16 v[216:219], a[100:103], v[120:123], v[216:219]
v_permlane32_swap_b32 v208, v212
v_mfma_f32_16x16x32_bf16 v[220:223], a[100:103], v[124:127], v[220:223]
v_permlane32_swap_b32 v209, v213
v_mfma_f32_16x16x32_bf16 v[216:219], a[104:107], v[128:131], v[216:219]
buffer_load_dwordx4 v10, s[8:11], s74 offen offset:2048 sc1 lds
v_mfma_f32_16x16x32_bf16 v[220:223], a[104:107], v[132:135], v[220:223]
v_permlane32_swap_b32 v210, v214
v_mfma_f32_16x16x32_bf16 v[216:219], a[108:111], v[136:139], v[216:219]
v_permlane32_swap_b32 v211, v215
v_mfma_f32_16x16x32_bf16 v[220:223], a[108:111], v[140:143], v[220:223]
buffer_load_dwordx4 v11, s[8:11], s74 offen offset:3072 sc1 lds
v_mfma_f32_16x16x32_bf16 v[216:219], a[112:115], v[144:147], v[216:219]
v_mul_f32 v232, s57, v208
v_mul_f32 v233, s57, v209
v_mfma_f32_16x16x32_bf16 v[220:223], a[112:115], v[148:151], v[220:223]
s_add_u32 m0, s48, 4096
v_mul_f32 v234, s57, v210
v_mfma_f32_16x16x32_bf16 v[216:219], a[116:119], v[152:155], v[216:219]
buffer_load_dwordx4 v12, s[8:11], s74 offen offset:0 sc1 lds
v_mfma_f32_16x16x32_bf16 v[220:223], a[116:119], v[156:159], v[220:223]
v_mul_f32 v235, s57, v211
v_mfma_f32_16x16x32_bf16 v[216:219], a[120:123], v[160:163], v[216:219]
v_exp_f32 v232, v232
v_mfma_f32_16x16x32_bf16 v[220:223], a[120:123], v[164:167], v[220:223]
buffer_load_dwordx4 v13, s[8:11], s74 offen offset:1024 sc1 lds
v_mfma_f32_16x16x32_bf16 v[216:219], a[124:127], v[168:171], v[216:219]
v_exp_f32 v233, v233
v_mfma_f32_16x16x32_bf16 v[220:223], a[124:127], v[172:175], v[220:223]
v_exp_f32 v234, v234
v_mfma_f32_16x16x32_bf16 v[216:219], a[128:131], v[176:179], v[216:219]
buffer_load_dwordx4 v14, s[8:11], s74 offen offset:2048 sc1 lds
v_mfma_f32_16x16x32_bf16 v[220:223], a[128:131], v[180:183], v[220:223]
v_exp_f32 v235, v235
v_mfma_f32_16x16x32_bf16 v[216:219], a[132:135], v[184:187], v[216:219]
v_add_f32 v232, 1.0, v232
v_add_f32 v233, 1.0, v233
v_mfma_f32_16x16x32_bf16 v[220:223], a[132:135], v[188:191], v[220:223]
buffer_load_dwordx4 v15, s[8:11], s74 offen offset:3072 sc1 lds
v_mfma_f32_16x16x32_bf16 v[216:219], a[136:139], v[192:195], v[216:219]
v_add_f32 v234, 1.0, v234
v_add_f32 v235, 1.0, v235
v_mfma_f32_16x16x32_bf16 v[220:223], a[136:139], v[196:199], v[220:223]
s_add_u32 m0, s48, 8192
v_mfma_f32_16x16x32_bf16 v[216:219], a[140:143], v[200:203], v[216:219]
buffer_load_dwordx4 v16, s[8:11], s74 offen offset:0 sc1 lds
v_mfma_f32_16x16x32_bf16 v[220:223], a[140:143], v[204:207], v[220:223]
v_rcp_f32 v232, v232
v_mfma_f32_16x16x32_bf16 v[224:227], a[144:147], v[64:67], 0
v_rcp_f32 v233, v233
v_mfma_f32_16x16x32_bf16 v[228:231], a[144:147], v[68:71], 0
v_rcp_f32 v234, v234
v_mfma_f32_16x16x32_bf16 v[224:227], a[148:151], v[72:75], v[224:227]
v_rcp_f32 v235, v235
v_mfma_f32_16x16x32_bf16 v[228:231], a[148:151], v[76:79], v[228:231]
v_mul_f32 v212, v208, v212
v_mul_f32 v213, v209, v213
v_mfma_f32_16x16x32_bf16 v[224:227], a[152:155], v[80:83], v[224:227]
buffer_load_dword v24, v22, s[4:7], 0 offen sc1
v_mfma_f32_16x16x32_bf16 v[228:231], a[152:155], v[84:87], v[228:231]
v_mul_f32 v214, v210, v214
v_mul_f32 v215, v211, v215
v_mul_f32 v236, s57, v216
v_mul_f32 v237, s57, v217
v_mul_f32 v238, s57, v218
v_mul_f32 v239, s57, v219
v_exp_f32 v236, v236
v_exp_f32 v237, v237
v_exp_f32 v238, v238
v_exp_f32 v239, v239
v_add_f32 v236, 1.0, v236
v_add_f32 v237, 1.0, v237
v_add_f32 v238, 1.0, v238
v_add_f32 v239, 1.0, v239
v_rcp_f32 v236, v236
v_rcp_f32 v237, v237
v_mfma_f32_16x16x32_bf16 v[224:227], a[156:159], v[88:91], v[224:227]
s_waitcnt vmcnt(10)
s_barrier
v_mfma_f32_16x16x32_bf16 v[228:231], a[156:159], v[92:95], v[228:231]
buffer_store_dword v27, v45, s[4:7], s85 offen
v_mfma_f32_16x16x32_bf16 v[224:227], a[160:163], v[96:99], v[224:227]
buffer_store_dword v27, v44, s[4:7], s85 offen sc1
v_mfma_f32_16x16x32_bf16 v[228:231], a[160:163], v[100:103], v[228:231]
v_mul_f32 v212, v212, v232
v_mul_f32 v213, v213, v233
v_mfma_f32_16x16x32_bf16 v[224:227], a[164:167], v[104:107], v[224:227]
v_mul_f32 v214, v214, v234
v_mul_f32 v215, v215, v235
v_mfma_f32_16x16x32_bf16 v[228:231], a[164:167], v[108:111], v[228:231]
v_cvt_pk_bf16_f32 v48, v212, v213
v_cvt_pk_bf16_f32 v49, v214, v215
v_mfma_f32_16x16x32_bf16 v[224:227], a[168:171], v[112:115], v[224:227]
buffer_store_dwordx2 v[48:49], v19, s[4:7], s93 offen sc1
v_mfma_f32_16x16x32_bf16 v[228:231], a[168:171], v[116:119], v[228:231]
v_rcp_f32 v238, v238
v_mfma_f32_16x16x32_bf16 v[224:227], a[172:175], v[120:123], v[224:227]
v_rcp_f32 v239, v239
v_mfma_f32_16x16x32_bf16 v[228:231], a[172:175], v[124:127], v[228:231]
v_mul_f32 v240, s57, v220
v_mul_f32 v241, s57, v221
v_mfma_f32_16x16x32_bf16 v[224:227], a[176:179], v[128:131], v[224:227]
v_mul_f32 v242, s57, v222
v_mul_f32 v243, s57, v223
v_mfma_f32_16x16x32_bf16 v[228:231], a[176:179], v[132:135], v[228:231]
v_mul_f32 v236, v216, v236
v_mul_f32 v237, v217, v237
v_mfma_f32_16x16x32_bf16 v[224:227], a[180:183], v[136:139], v[224:227]
v_mul_f32 v238, v218, v238
v_mul_f32 v239, v219, v239
v_mfma_f32_16x16x32_bf16 v[228:231], a[180:183], v[140:143], v[228:231]
v_exp_f32 v240, v240
v_mfma_f32_16x16x32_bf16 v[224:227], a[184:187], v[144:147], v[224:227]
v_exp_f32 v241, v241
v_mfma_f32_16x16x32_bf16 v[228:231], a[184:187], v[148:151], v[228:231]
v_exp_f32 v242, v242
v_mfma_f32_16x16x32_bf16 v[224:227], a[188:191], v[152:155], v[224:227]
v_exp_f32 v243, v243
v_mfma_f32_16x16x32_bf16 v[228:231], a[188:191], v[156:159], v[228:231]
v_add_f32 v240, 1.0, v240
v_add_f32 v241, 1.0, v241
v_mfma_f32_16x16x32_bf16 v[224:227], a[192:195], v[160:163], v[224:227]
s_waitcnt vmcnt(11)
s_barrier
v_mfma_f32_16x16x32_bf16 v[228:231], a[192:195], v[164:167], v[228:231]
v_add_f32 v242, 1.0, v242
v_add_f32 v243, 1.0, v243
v_mfma_f32_16x16x32_bf16 v[224:227], a[196:199], v[168:171], v[224:227]
s_cmp_eq_u32 s76, 0
s_cbranch_scc1 g_slow_162
v_mfma_f32_16x16x32_bf16 v[228:231], a[196:199], v[172:175], v[228:231]
v_rcp_f32 v240, v240
ds_read_b128 v[64:67], v28 offset:0
v_mfma_f32_16x16x32_bf16 v[224:227], a[200:203], v[176:179], v[224:227]
v_rcp_f32 v241, v241
ds_read_b128 v[68:71], v28 offset:9216
v_mfma_f32_16x16x32_bf16 v[228:231], a[200:203], v[180:183], v[228:231]
v_rcp_f32 v242, v242
ds_read_b128 v[72:75], v28 offset:18432
v_mfma_f32_16x16x32_bf16 v[224:227], a[204:207], v[184:187], v[224:227]
v_rcp_f32 v243, v243
ds_read_b128 v[76:79], v28 offset:27648
v_mfma_f32_16x16x32_bf16 v[228:231], a[204:207], v[188:191], v[228:231]
v_mul_f32 v240, v220, v240
ds_read_b128 v[80:83], v28 offset:1024
v_mfma_f32_16x16x32_bf16 v[224:227], a[208:211], v[192:195], v[224:227]
v_mul_f32 v241, v221, v241
ds_read_b128 v[84:87], v28 offset:10240
v_mfma_f32_16x16x32_bf16 v[228:231], a[208:211], v[196:199], v[228:231]
v_mul_f32 v242, v222, v242
ds_read_b128 v[88:91], v28 offset:19456
v_mfma_f32_16x16x32_bf16 v[224:227], a[212:215], v[200:203], v[224:227]
v_mul_f32 v243, v223, v243
ds_read_b128 v[92:95], v28 offset:28672
v_mfma_f32_16x16x32_bf16 v[228:231], a[212:215], v[204:207], v[228:231]
s_waitcnt vmcnt(8)
s_barrier
s_branch g_body_147
g_slow_159:
v_mfma_f32_16x16x32_bf16 v[228:231], a[196:199], v[172:175], v[228:231]
v_rcp_f32 v240, v240
v_mfma_f32_16x16x32_bf16 v[224:227], a[200:203], v[176:179], v[224:227]
v_rcp_f32 v241, v241
v_mfma_f32_16x16x32_bf16 v[228:231], a[200:203], v[180:183], v[228:231]
v_rcp_f32 v242, v242
v_mfma_f32_16x16x32_bf16 v[224:227], a[204:207], v[184:187], v[224:227]
v_rcp_f32 v243, v243
v_mfma_f32_16x16x32_bf16 v[228:231], a[204:207], v[188:191], v[228:231]
v_mul_f32 v240, v220, v240
v_mfma_f32_16x16x32_bf16 v[224:227], a[208:211], v[192:195], v[224:227]
v_mul_f32 v241, v221, v241
v_mfma_f32_16x16x32_bf16 v[228:231], a[208:211], v[196:199], v[228:231]
v_mul_f32 v242, v222, v242
v_mfma_f32_16x16x32_bf16 v[224:227], a[212:215], v[200:203], v[224:227]
v_mul_f32 v243, v223, v243
v_mfma_f32_16x16x32_bf16 v[228:231], a[212:215], v[204:207], v[228:231]
s_nop 5
v_mul_f32 v224, v224, v236
v_mul_f32 v225, v225, v237
v_mul_f32 v226, v226, v238
v_mul_f32 v227, v227, v239
v_mul_f32 v228, v228, v240
v_mul_f32 v229, v229, v241
v_mul_f32 v230, v230, v242
v_mul_f32 v231, v231, v243
v_cvt_pk_bf16_f32 v52, v224, v225
v_cvt_pk_bf16_f32 v53, v226, v227
v_cvt_pk_bf16_f32 v54, v228, v229
v_cvt_pk_bf16_f32 v55, v230, v231
s_nop 0
v_permlane16_swap_b32 v52, v54
v_permlane16_swap_b32 v53, v55
buffer_store_dwordx4 v[52:55], v20, s[4:7], s75 offen sc1
s_mov_b32 s75, 1879048192
s_waitcnt vmcnt(4)
ds_write_b32 v18, v24
s_waitcnt lgkmcnt(0)
s_barrier
ds_read_b32 v33, v32
s_waitcnt lgkmcnt(0)
v_cmp_gt_u32 vcc, s52, v33
v_cmp_gt_u32 s[58:59], s54, v33
s_and_b32 vcc_lo, vcc_lo, s56
s_cselect_b32 s70, 0, 1
s_and_b32 s59, s59, s56
s_cselect_b32 s71, 0, s77
s_or_b32 s82, s70, s71
s_cselect_b32 s10, 268435456, 0
s_cmp_lg_u32 s70, 0
s_cselect_b64 s[78:79], s[52:53], s[54:55]
s_cselect_b64 s[58:59], s[44:45], s[46:47]
s_mul_i32 s80, s78, s20
s_add_u32 s80, s80, s58
s_mul_i32 s81, s78, s21
s_add_u32 s81, s81, s59
s_andn2_b32 s71, s71, s70
s_add_u32 s52, s52, s70
s_add_u32 s54, s54, s71
s_mov_b32 s83, s82
s_cmp_lg_u32 s82, 0
s_cbranch_scc1 g_go_163
v_mov_b32 v27, s72
s_waitcnt vmcnt(0)
s_barrier
s_add_u32 s70, s52, s54
s_cmp_eq_u32 s70, 130
s_cbranch_scc1 g_fin_151
s_cmp_lg_u32 s3, 0
s_cbranch_scc1 sp_ok_165_j
s_mov_b32 s23, 0
buffer_load_dword v33, v22, s[4:7], 0 offen sc1
buffer_store_dword v27, v45, s[4:7], s73 offen
buffer_store_dword v27, v44, s[4:7], s73 offen sc1
s_waitcnt vmcnt(2)
s_branch sp_loop_164_e
sp_loop_164:
buffer_load_dword v33, v22, s[4:7], 0 offen sc1
s_add_u32 s23, s23, 1
s_cmp_gt_u32 s23, 150000
s_cbranch_scc1 sp_bad_166
s_waitcnt vmcnt(0)
sp_loop_164_e:
v_cmp_gt_u32 vcc, s52, v33
v_cmp_gt_u32 s[58:59], s54, v33
s_and_b32 vcc_lo, vcc_lo, s56
s_cbranch_scc0 sp_ok_165
s_cmp_gt_u32 s23, 4
s_cselect_b32 s70, 0, s56
s_cmp_lg_u32 s77, 0
s_cselect_b32 s70, 0, s70
s_or_b32 s59, s59, s70
s_and_b32 s59, s59, s56
s_cbranch_scc0 sp_ok_165
s_sleep 1
s_branch sp_loop_164
sp_bad_166:
s_mov_b32 s98, 1028
s_branch L_fail
sp_ok_165:
ds_write_b32 v18, v33
s_waitcnt lgkmcnt(0)
sp_ok_165_j:
s_barrier
ds_read_b32 v33, v32
s_waitcnt lgkmcnt(0)
s_mov_b32 s73, 1879048192
v_cmp_gt_u32 vcc, s52, v33
v_cmp_gt_u32 s[58:59], s54, v33
s_and_b32 vcc_lo, vcc_lo, s56
s_cselect_b32 s70, 0, 1
s_and_b32 s59, s59, s56
s_cselect_b32 s71, 0, 1
s_or_b32 s82, s70, s71
s_cselect_b32 s10, 268435456, 0
s_cmp_lg_u32 s70, 0
s_cselect_b64 s[78:79], s[52:53], s[54:55]
s_cselect_b64 s[58:59], s[44:45], s[46:47]
s_mul_i32 s80, s78, s20
s_add_u32 s80, s80, s58
s_mul_i32 s81, s78, s21
s_add_u32 s81, s81, s59
s_andn2_b32 s71, s71, s70
s_add_u32 s52, s52, s70
s_add_u32 s54, s54, s71
s_mov_b32 s83, s82
g_go_163:
s_add_u32 m0, s49, 0
s_nop 0
buffer_load_dwordx4 v8, s[4:7], s80 offen offset:0 sc1 lds
buffer_load_dwordx4 v9, s[4:7], s80 offen offset:1024 sc1 lds
buffer_load_dwordx4 v10, s[4:7], s80 offen offset:2048 sc1 lds
buffer_load_dwordx4 v11, s[4:7], s80 offen offset:3072 sc1 lds
s_add_u32 m0, s49, 4096
s_nop 0
buffer_load_dwordx4 v12, s[4:7], s80 offen offset:0 sc1 lds
buffer_load_dwordx4 v13, s[4:7], s80 offen offset:1024 sc1 lds
buffer_load_dwordx4 v14, s[4:7], s80 offen offset:2048 sc1 lds
buffer_load_dwordx4 v15, s[4:7], s80 offen offset:3072 sc1 lds
s_add_u32 m0, s49, 8192
s_nop 0
buffer_load_dwordx4 v16, s[4:7], s80 offen offset:0 sc1 lds
buffer_load_dword v24, v22, s[4:7], 0 offen sc1
buffer_store_dword v27, v34, s[4:7], 0 offen
v_mov_b32 v27, s72
s_waitcnt vmcnt(9)
s_barrier
buffer_store_dword v27, v45, s[4:7], s73 offen
buffer_store_dword v27, v44, s[4:7], s73 offen sc1
s_mov_b32 s73, 1879048192
ds_read_b128 v[64:67], v29 offset:0
ds_read_b128 v[68:71], v29 offset:9216
ds_read_b128 v[72:75], v29 offset:18432
ds_read_b128 v[76:79], v29 offset:27648
ds_read_b128 v[80:83], v29 offset:1024
ds_read_b128 v[84:87], v29 offset:10240
ds_read_b128 v[88:91], v29 offset:19456
ds_read_b128 v[92:95], v29 offset:28672
s_waitcnt vmcnt(8)
s_barrier
s_branch g_body_148
g_slow_160:
v_mfma_f32_16x16x32_bf16 v[228:231], a[196:199], v[172:175], v[228:231]
v_rcp_f32 v240, v240
v_mfma_f32_16x16x32_bf16 v[224:227], a[200:203], v[176:179], v[224:227]
v_rcp_f32 v241, v241
v_mfma_f32_16x16x32_bf16 v[228:231], a[200:203], v[180:183], v[228:231]
v_rcp_f32 v242, v242
v_mfma_f32_16x16x32_bf16 v[224:227], a[204:207], v[184:187], v[224:227]
v_rcp_f32 v243, v243
v_mfma_f32_16x16x32_bf16 v[228:231], a[204:207], v[188:191], v[228:231]
v_mul_f32 v240, v220, v240
v_mfma_f32_16x16x32_bf16 v[224:227], a[208:211], v[192:195], v[224:227]
v_mul_f32 v241, v221, v241
v_mfma_f32_16x16x32_bf16 v[228:231], a[208:211], v[196:199], v[228:231]
v_mul_f32 v242, v222, v242
v_mfma_f32_16x16x32_bf16 v[224:227], a[212:215], v[200:203], v[224:227]
v_mul_f32 v243, v223, v243
v_mfma_f32_16x16x32_bf16 v[228:231], a[212:215], v[204:207], v[228:231]
s_nop 5
v_mul_f32 v224, v224, v236
v_mul_f32 v225, v225, v237
v_mul_f32 v226, v226, v238
v_mul_f32 v227, v227, v239
v_mul_f32 v228, v228, v240
v_mul_f32 v229, v229, v241
v_mul_f32 v230, v230, v242
v_mul_f32 v231, v231, v243
v_cvt_pk_bf16_f32 v52, v224, v225
v_cvt_pk_bf16_f32 v53, v226, v227
v_cvt_pk_bf16_f32 v54, v228, v229
v_cvt_pk_bf16_f32 v55, v230, v231
s_nop 0
v_permlane16_swap_b32 v52, v54
v_permlane16_swap_b32 v53, v55
buffer_store_dwordx4 v[52:55], v20, s[4:7], s81 offen sc1
s_mov_b32 s81, 1879048192
s_waitcnt vmcnt(4)
ds_write_b32 v18, v24
s_waitcnt lgkmcnt(0)
s_barrier
ds_read_b32 v33, v32
s_waitcnt lgkmcnt(0)
v_cmp_gt_u32 vcc, s52, v33
v_cmp_gt_u32 s[58:59], s54, v33
s_and_b32 vcc_lo, vcc_lo, s56
s_cselect_b32 s70, 0, 1
s_and_b32 s59, s59, s56
s_cselect_b32 s71, 0, s83
s_or_b32 s88, s70, s71
s_cselect_b32 s10, 268435456, 0
s_cmp_lg_u32 s70, 0
s_cselect_b64 s[84:85], s[52:53], s[54:55]
s_cselect_b64 s[58:59], s[44:45], s[46:47]
s_mul_i32 s86, s84, s20
s_add_u32 s86, s86, s58
s_mul_i32 s87, s84, s21
s_add_u32 s87, s87, s59
s_andn2_b32 s71, s71, s70
s_add_u32 s52, s52, s70
s_add_u32 s54, s54, s71
s_mov_b32 s89, s88
s_cmp_lg_u32 s88, 0
s_cbranch_scc1 g_go_167
v_mov_b32 v27, s78
s_waitcnt vmcnt(0)
s_barrier
s_add_u32 s70, s52, s54
s_cmp_eq_u32 s70, 130
s_cbranch_scc1 g_fin_151
s_cmp_lg_u32 s3, 0
s_cbranch_scc1 sp_ok_169_j
s_mov_b32 s23, 0
buffer_load_dword v33, v22, s[4:7], 0 offen sc1
buffer_store_dword v27, v45, s[4:7], s79 offen
buffer_store_dword v27, v44, s[4:7], s79 offen sc1
s_waitcnt vmcnt(2)
s_branch sp_loop_168_e
sp_loop_168:
buffer_load_dword v33, v22, s[4:7], 0 offen sc1
s_add_u32 s23, s23, 1
s_cmp_gt_u32 s23, 150000
s_cbranch_scc1 sp_bad_170
s_waitcnt vmcnt(0)
sp_loop_168_e:
v_cmp_gt_u32 vcc, s52, v33
v_cmp_gt_u32 s[58:59], s54, v33
s_and_b32 vcc_lo, vcc_lo, s56
s_cbranch_scc0 sp_ok_169
s_cmp_gt_u32 s23, 4
s_cselect_b32 s70, 0, s56
s_cmp_lg_u32 s83, 0
s_cselect_b32 s70, 0, s70
s_or_b32 s59, s59, s70
s_and_b32 s59, s59, s56
s_cbranch_scc0 sp_ok_169
s_sleep 1
s_branch sp_loop_168
sp_bad_170:
s_mov_b32 s98, 1028
s_branch L_fail
sp_ok_169:
ds_write_b32 v18, v33
s_waitcnt lgkmcnt(0)
sp_ok_169_j:
s_barrier
ds_read_b32 v33, v32
s_waitcnt lgkmcnt(0)
s_mov_b32 s79, 1879048192
v_cmp_gt_u32 vcc, s52, v33
v_cmp_gt_u32 s[58:59], s54, v33
s_and_b32 vcc_lo, vcc_lo, s56
s_cselect_b32 s70, 0, 1
s_and_b32 s59, s59, s56
s_cselect_b32 s71, 0, 1
s_or_b32 s88, s70, s71
s_cselect_b32 s10, 268435456, 0
s_cmp_lg_u32 s70, 0
s_cselect_b64 s[84:85], s[52:53], s[54:55]
s_cselect_b64 s[58:59], s[44:45], s[46:47]
s_mul_i32 s86, s84, s20
s_add_u32 s86, s86, s58
s_mul_i32 s87, s84, s21
s_add_u32 s87, s87, s59
s_andn2_b32 s71, s71, s70
s_add_u32 s52, s52, s70
s_add_u32 s54, s54, s71
s_mov_b32 s89, s88
g_go_167:
s_add_u32 m0, s50, 0
s_nop 0
buffer_load_dwordx4 v8, s[4:7], s86 offen offset:0 sc1 lds
buffer_load_dwordx4 v9, s[4:7], s86 offen offset:1024 sc1 lds
buffer_load_dwordx4 v10, s[4:7], s86 offen offset:2048 sc1 lds
buffer_load_dwordx4 v11, s[4:7], s86 offen offset:3072 sc1 lds
s_add_u32 m0, s50, 4096
s_nop 0
buffer_load_dwordx4 v12, s[4:7], s86 offen offset:0 sc1 lds
buffer_load_dwordx4 v13, s[4:7], s86 offen offset:1024 sc1 lds
buffer_load_dwordx4 v14, s[4:7], s86 offen offset:2048 sc1 lds
buffer_load_dwordx4 v15, s[4:7], s86 offen offset:3072 sc1 lds
s_add_u32 m0, s50, 8192
s_nop 0
buffer_load_dwordx4 v16, s[4:7], s86 offen offset:0 sc1 lds
buffer_load_dword v24, v22, s[4:7], 0 offen sc1
buffer_store_dword v27, v34, s[4:7], 0 offen
v_mov_b32 v27, s78
s_waitcnt vmcnt(9)
s_barrier
buffer_store_dword v27, v45, s[4:7], s79 offen
buffer_store_dword v27, v44, s[4:7], s79 offen sc1
s_mov_b32 s79, 1879048192
ds_read_b128 v[64:67], v30 offset:0
ds_read_b128 v[68:71], v30 offset:9216
ds_read_b128 v[72:75], v30 offset:18432
ds_read_b128 v[76:79], v30 offset:27648
ds_read_b128 v[80:83], v30 offset:1024
ds_read_b128 v[84:87], v30 offset:10240
ds_read_b128 v[88:91], v30 offset:19456
ds_read_b128 v[92:95], v30 offset:28672
s_waitcnt vmcnt(8)
s_barrier
s_branch g_body_149
g_slow_161:
v_mfma_f32_16x16x32_bf16 v[228:231], a[196:199], v[172:175], v[228:231]
v_rcp_f32 v240, v240
v_mfma_f32_16x16x32_bf16 v[224:227], a[200:203], v[176:179], v[224:227]
v_rcp_f32 v241, v241
v_mfma_f32_16x16x32_bf16 v[228:231], a[200:203], v[180:183], v[228:231]
v_rcp_f32 v242, v242
v_mfma_f32_16x16x32_bf16 v[224:227], a[204:207], v[184:187], v[224:227]
v_rcp_f32 v243, v243
v_mfma_f32_16x16x32_bf16 v[228:231], a[204:207], v[188:191], v[228:231]
v_mul_f32 v240, v220, v240
v_mfma_f32_16x16x32_bf16 v[224:227], a[208:211], v[192:195], v[224:227]
v_mul_f32 v241, v221, v241
v_mfma_f32_16x16x32_bf16 v[228:231], a[208:211], v[196:199], v[228:231]
v_mul_f32 v242, v222, v242
v_mfma_f32_16x16x32_bf16 v[224:227], a[212:215], v[200:203], v[224:227]
v_mul_f32 v243, v223, v243
v_mfma_f32_16x16x32_bf16 v[228:231], a[212:215], v[204:207], v[228:231]
s_nop 5
v_mul_f32 v224, v224, v236
v_mul_f32 v225, v225, v237
v_mul_f32 v226, v226, v238
v_mul_f32 v227, v227, v239
v_mul_f32 v228, v228, v240
v_mul_f32 v229, v229, v241
v_mul_f32 v230, v230, v242
v_mul_f32 v231, v231, v243
v_cvt_pk_bf16_f32 v52, v224, v225
v_cvt_pk_bf16_f32 v53, v226, v227
v_cvt_pk_bf16_f32 v54, v228, v229
v_cvt_pk_bf16_f32 v55, v230, v231
s_nop 0
v_permlane16_swap_b32 v52, v54
v_permlane16_swap_b32 v53, v55
buffer_store_dwordx4 v[52:55], v20, s[4:7], s87 offen sc1
s_mov_b32 s87, 1879048192
s_waitcnt vmcnt(4)
ds_write_b32 v18, v24
s_waitcnt lgkmcnt(0)
s_barrier
ds_read_b32 v33, v32
s_waitcnt lgkmcnt(0)
v_cmp_gt_u32 vcc, s52, v33
v_cmp_gt_u32 s[58:59], s54, v33
s_and_b32 vcc_lo, vcc_lo, s56
s_cselect_b32 s70, 0, 1
s_and_b32 s59, s59, s56
s_cselect_b32 s71, 0, s89
s_or_b32 s94, s70, s71
s_cselect_b32 s10, 268435456, 0
s_cmp_lg_u32 s70, 0
s_cselect_b64 s[90:91], s[52:53], s[54:55]
s_cselect_b64 s[58:59], s[44:45], s[46:47]
s_mul_i32 s92, s90, s20
s_add_u32 s92, s92, s58
s_mul_i32 s93, s90, s21
s_add_u32 s93, s93, s59
s_andn2_b32 s71, s71, s70
s_add_u32 s52, s52, s70
s_add_u32 s54, s54, s71
s_mov_b32 s95, s94
s_cmp_lg_u32 s94, 0
s_cbranch_scc1 g_go_171
v_mov_b32 v27, s84
s_waitcnt vmcnt(0)
s_barrier
s_add_u32 s70, s52, s54
s_cmp_eq_u32 s70, 130
s_cbranch_scc1 g_fin_151
s_cmp_lg_u32 s3, 0
s_cbranch_scc1 sp_ok_173_j
s_mov_b32 s23, 0
buffer_load_dword v33, v22, s[4:7], 0 offen sc1
buffer_store_dword v27, v45, s[4:7], s85 offen
buffer_store_dword v27, v44, s[4:7], s85 offen sc1
s_waitcnt vmcnt(2)
s_branch sp_loop_172_e
sp_loop_172:
buffer_load_dword v33, v22, s[4:7], 0 offen sc1
s_add_u32 s23, s23, 1
s_cmp_gt_u32 s23, 150000
s_cbranch_scc1 sp_bad_174
s_waitcnt vmcnt(0)
sp_loop_172_e:
v_cmp_gt_u32 vcc, s52, v33
v_cmp_gt_u32 s[58:59], s54, v33
s_and_b32 vcc_lo, vcc_lo, s56
s_cbranch_scc0 sp_ok_173
s_cmp_gt_u32 s23, 4
s_cselect_b32 s70, 0, s56
s_cmp_lg_u32 s89, 0
s_cselect_b32 s70, 0, s70
s_or_b32 s59, s59, s70
s_and_b32 s59, s59, s56
s_cbranch_scc0 sp_ok_173
s_sleep 1
s_branch sp_loop_172
sp_bad_174:
s_mov_b32 s98, 1028
s_branch L_fail
sp_ok_173:
ds_write_b32 v18, v33
s_waitcnt lgkmcnt(0)
sp_ok_173_j:
s_barrier
ds_read_b32 v33, v32
s_waitcnt lgkmcnt(0)
s_mov_b32 s85, 1879048192
v_cmp_gt_u32 vcc, s52, v33
v_cmp_gt_u32 s[58:59], s54, v33
s_and_b32 vcc_lo, vcc_lo, s56
s_cselect_b32 s70, 0, 1
s_and_b32 s59, s59, s56
s_cselect_b32 s71, 0, 1
s_or_b32 s94, s70, s71
s_cselect_b32 s10, 268435456, 0
s_cmp_lg_u32 s70, 0
s_cselect_b64 s[90:91], s[52:53], s[54:55]
s_cselect_b64 s[58:59], s[44:45], s[46:47]
s_mul_i32 s92, s90, s20
s_add_u32 s92, s92, s58
s_mul_i32 s93, s90, s21
s_add_u32 s93, s93, s59
s_andn2_b32 s71, s71, s70
s_add_u32 s52, s52, s70
s_add_u32 s54, s54, s71
s_mov_b32 s95, s94
g_go_171:
s_add_u32 m0, s51, 0
s_nop 0
buffer_load_dwordx4 v8, s[4:7], s92 offen offset:0 sc1 lds
buffer_load_dwordx4 v9, s[4:7], s92 offen offset:1024 sc1 lds
buffer_load_dwordx4 v10, s[4:7], s92 offen offset:2048 sc1 lds
buffer_load_dwordx4 v11, s[4:7], s92 offen offset:3072 sc1 lds
s_add_u32 m0, s51, 4096
s_nop 0
buffer_load_dwordx4 v12, s[4:7], s92 offen offset:0 sc1 lds
buffer_load_dwordx4 v13, s[4:7], s92 offen offset:1024 sc1 lds
buffer_load_dwordx4 v14, s[4:7], s92 offen offset:2048 sc1 lds
buffer_load_dwordx4 v15, s[4:7], s92 offen offset:3072 sc1 lds
s_add_u32 m0, s51, 8192
s_nop 0
buffer_load_dwordx4 v16, s[4:7], s92 offen offset:0 sc1 lds
buffer_load_dword v24, v22, s[4:7], 0 offen sc1
buffer_store_dword v27, v34, s[4:7], 0 offen
v_mov_b32 v27, s84
s_waitcnt vmcnt(9)
s_barrier
buffer_store_dword v27, v45, s[4:7], s85 offen
buffer_store_dword v27, v44, s[4:7], s85 offen sc1
s_mov_b32 s85, 1879048192
ds_read_b128 v[64:67], v31 offset:0
ds_read_b128 v[68:71], v31 offset:9216
ds_read_b128 v[72:75], v31 offset:18432
ds_read_b128 v[76:79], v31 offset:27648
ds_read_b128 v[80:83], v31 offset:1024
ds_read_b128 v[84:87], v31 offset:10240
ds_read_b128 v[88:91], v31 offset:19456
ds_read_b128 v[92:95], v31 offset:28672
s_waitcnt vmcnt(8)
s_barrier
s_branch g_body_150
g_slow_162:
v_mfma_f32_16x16x32_bf16 v[228:231], a[196:199], v[172:175], v[228:231]
v_rcp_f32 v240, v240
v_mfma_f32_16x16x32_bf16 v[224:227], a[200:203], v[176:179], v[224:227]
v_rcp_f32 v241, v241
v_mfma_f32_16x16x32_bf16 v[228:231], a[200:203], v[180:183], v[228:231]
v_rcp_f32 v242, v242
v_mfma_f32_16x16x32_bf16 v[224:227], a[204:207], v[184:187], v[224:227]
v_rcp_f32 v243, v243
v_mfma_f32_16x16x32_bf16 v[228:231], a[204:207], v[188:191], v[228:231]
v_mul_f32 v240, v220, v240
v_mfma_f32_16x16x32_bf16 v[224:227], a[208:211], v[192:195], v[224:227]
v_mul_f32 v241, v221, v241
v_mfma_f32_16x16x32_bf16 v[228:231], a[208:211], v[196:199], v[228:231]
v_mul_f32 v242, v222, v242
v_mfma_f32_16x16x32_bf16 v[224:227], a[212:215], v[200:203], v[224:227]
v_mul_f32 v243, v223, v243
v_mfma_f32_16x16x32_bf16 v[228:231], a[212:215], v[204:207], v[228:231]
s_nop 5
v_mul_f32 v224, v224, v236
v_mul_f32 v225, v225, v237
v_mul_f32 v226, v226, v238
v_mul_f32 v227, v227, v239
v_mul_f32 v228, v228, v240
v_mul_f32 v229, v229, v241
v_mul_f32 v230, v230, v242
v_mul_f32 v231, v231, v243
v_cvt_pk_bf16_f32 v52, v224, v225
v_cvt_pk_bf16_f32 v53, v226, v227
v_cvt_pk_bf16_f32 v54, v228, v229
v_cvt_pk_bf16_f32 v55, v230, v231
s_nop 0
v_permlane16_swap_b32 v52, v54
v_permlane16_swap_b32 v53, v55
buffer_store_dwordx4 v[52:55], v20, s[4:7], s93 offen sc1
s_mov_b32 s93, 1879048192
s_waitcnt vmcnt(4)
ds_write_b32 v18, v24
s_waitcnt lgkmcnt(0)
s_barrier
ds_read_b32 v33, v32
s_waitcnt lgkmcnt(0)
v_cmp_gt_u32 vcc, s52, v33
v_cmp_gt_u32 s[58:59], s54, v33
s_and_b32 vcc_lo, vcc_lo, s56
s_cselect_b32 s70, 0, 1
s_and_b32 s59, s59, s56
s_cselect_b32 s71, 0, s95
s_or_b32 s76, s70, s71
s_cselect_b32 s10, 268435456, 0
s_cmp_lg_u32 s70, 0
s_cselect_b64 s[72:73], s[52:53], s[54:55]
s_cselect_b64 s[58:59], s[44:45], s[46:47]
s_mul_i32 s74, s72, s20
s_add_u32 s74, s74, s58
s_mul_i32 s75, s72, s21
s_add_u32 s75, s75, s59
s_andn2_b32 s71, s71, s70
s_add_u32 s52, s52, s70
s_add_u32 s54, s54, s71
s_mov_b32 s77, s76
s_cmp_lg_u32 s76, 0
s_cbranch_scc1 g_go_175
v_mov_b32 v27, s90
s_waitcnt vmcnt(0)
s_barrier
s_add_u32 s70, s52, s54
s_cmp_eq_u32 s70, 130
s_cbranch_scc1 g_fin_151
s_cmp_lg_u32 s3, 0
s_cbranch_scc1 sp_ok_177_j
s_mov_b32 s23, 0
buffer_load_dword v33, v22, s[4:7], 0 offen sc1
buffer_store_dword v27, v45, s[4:7], s91 offen
buffer_store_dword v27, v44, s[4:7], s91 offen sc1
s_waitcnt vmcnt(2)
s_branch sp_loop_176_e
sp_loop_176:
buffer_load_dword v33, v22, s[4:7], 0 offen sc1
s_add_u32 s23, s23, 1
s_cmp_gt_u32 s23, 150000
s_cbranch_scc1 sp_bad_178
s_waitcnt vmcnt(0)
sp_loop_176_e:
v_cmp_gt_u32 vcc, s52, v33
v_cmp_gt_u32 s[58:59], s54, v33
s_and_b32 vcc_lo, vcc_lo, s56
s_cbranch_scc0 sp_ok_177
s_cmp_gt_u32 s23, 4
s_cselect_b32 s70, 0, s56
s_cmp_lg_u32 s95, 0
s_cselect_b32 s70, 0, s70
s_or_b32 s59, s59, s70
s_and_b32 s59, s59, s56
s_cbranch_scc0 sp_ok_177
s_sleep 1
s_branch sp_loop_176
sp_bad_178:
s_mov_b32 s98, 1028
s_branch L_fail
sp_ok_177:
ds_write_b32 v18, v33
s_waitcnt lgkmcnt(0)
sp_ok_177_j:
s_barrier
ds_read_b32 v33, v32
s_waitcnt lgkmcnt(0)
s_mov_b32 s91, 1879048192
v_cmp_gt_u32 vcc, s52, v33
v_cmp_gt_u32 s[58:59], s54, v33
s_and_b32 vcc_lo, vcc_lo, s56
s_cselect_b32 s70, 0, 1
s_and_b32 s59, s59, s56
s_cselect_b32 s71, 0, 1
s_or_b32 s76, s70, s71
s_cselect_b32 s10, 268435456, 0
s_cmp_lg_u32 s70, 0
s_cselect_b64 s[72:73], s[52:53], s[54:55]
s_cselect_b64 s[58:59], s[44:45], s[46:47]
s_mul_i32 s74, s72, s20
s_add_u32 s74, s74, s58
s_mul_i32 s75, s72, s21
s_add_u32 s75, s75, s59
s_andn2_b32 s71, s71, s70
s_add_u32 s52, s52, s70
s_add_u32 s54, s54, s71
s_mov_b32 s77, s76
g_go_175:
s_add_u32 m0, s48, 0
s_nop 0
buffer_load_dwordx4 v8, s[4:7], s74 offen offset:0 sc1 lds
buffer_load_dwordx4 v9, s[4:7], s74 offen offset:1024 sc1 lds
buffer_load_dwordx4 v10, s[4:7], s74 offen offset:2048 sc1 lds
buffer_load_dwordx4 v11, s[4:7], s74 offen offset:3072 sc1 lds
s_add_u32 m0, s48, 4096
s_nop 0
buffer_load_dwordx4 v12, s[4:7], s74 offen offset:0 sc1 lds
buffer_load_dwordx4 v13, s[4:7], s74 offen offset:1024 sc1 lds
buffer_load_dwordx4 v14, s[4:7], s74 offen offset:2048 sc1 lds
buffer_load_dwordx4 v15, s[4:7], s74 offen offset:3072 sc1 lds
s_add_u32 m0, s48, 8192
s_nop 0
buffer_load_dwordx4 v16, s[4:7], s74 offen offset:0 sc1 lds
buffer_load_dword v24, v22, s[4:7], 0 offen sc1
buffer_store_dword v27, v34, s[4:7], 0 offen
v_mov_b32 v27, s90
s_waitcnt vmcnt(9)
s_barrier
buffer_store_dword v27, v45, s[4:7], s91 offen
buffer_store_dword v27, v44, s[4:7], s91 offen sc1
s_mov_b32 s91, 1879048192
ds_read_b128 v[64:67], v28 offset:0
ds_read_b128 v[68:71], v28 offset:9216
ds_read_b128 v[72:75], v28 offset:18432
ds_read_b128 v[76:79], v28 offset:27648
ds_read_b128 v[80:83], v28 offset:1024
ds_read_b128 v[84:87], v28 offset:10240
ds_read_b128 v[88:91], v28 offset:19456
ds_read_b128 v[92:95], v28 offset:28672
s_waitcnt vmcnt(8)
s_barrier
s_branch g_body_147
g_fin_151:
buffer_store_dword v27, v45, s[4:7], s91 offen
buffer_store_dword v27, v44, s[4:7], s91 offen sc1
s_endpgm
H_att:
s_lshr_b32 s75, s74, 1
s_and_b32 s76, s74, 1
s_lshl_b32 s44, s75, 2
s_add_u32 s44, s44, s3
s_mul_i32 s52, s76, 32768
s_mul_i32 s46, s76, 50331648
s_add_u32 s46, s46, 10821632
s_mul_i32 s49, s44, 24576
s_add_u32 s46, s46, s49
s_mul_i32 s47, s76, 8388608
s_add_u32 s47, s47, 111484928
s_mul_i32 s49, s44, 4096
s_add_u32 s47, s47, s49
s_mul_i32 s48, s76, 16777216
s_add_u32 s48, s48, 128262144
s_mul_i32 s49, s44, 8192
s_add_u32 s48, s48, s49
s_mov_b32 s64, s47
s_mov_b32 s50, 0x3e0293ee
v_lshlrev_b32 v8, 4, v0
v_lshlrev_b32 v10, 3, v0
v_add_u32 v10, 2048, v10
v_bfe_u32 v1, v0, 2, 2
v_and_b32 v2, 1, v0
v_lshl_add_u32 v1, v1, 1, v2
v_lshlrev_b32 v1, 4, v1
v_lshrrev_b32 v2, 4, v0
v_lshl_add_u32 v9, v2, 7, v1
v_and_b32 v1, 15, v0
v_lshlrev_b32 v2, 2, v2
v_sub_u32 v1, v1, v2
v_cmp_le_i32 s[56:57], 0, v1
v_cmp_le_i32 s[58:59], 1, v1
v_cmp_le_i32 s[60:61], 2, v1
v_cmp_le_i32 s[62:63], 3, v1
v_mov_b32 v16, 0xff800000
v_mov_b64 v[50:51], 0
v_mov_b32 v57, 0
v_mov_b32 v58, 0
v_mov_b32 v61, 0
v_mov_b32 v62, 0
v_min_u32 v1, 5, v0
v_lshrrev_b32 v2, 1, v1
v_lshlrev_b32 v2, 8, v2
v_and_b32 v1, 1, v1
v_mul_u32_u24 v1, 7, v1
v_add_u32 v1, v1, v2
s_lshl_b32 s49, s44, 3
v_add_u32 v1, s49, v1
v_mul_u32_u24 v1, 43691, v1
v_lshrrev_b32 v1, 19, v1
v_mul_u32_u24 v1, 128, v1
v_add_u32 v1, 2048, v1
v_mov_b32 v7, 2147483632
v_cmp_gt_u32 vcc, 6, v0
s_nop 1
v_cndmask_b32 v11, v7, v1, vcc
s_mul_i32 s49, s44, 128
s_add_u32 s49, s49, 10240
v_mov_b32 v1, s49
v_mov_b32 v7, 2147483632
v_cmp_gt_u32 vcc, 1, v0
s_nop 1
v_cndmask_b32 v124, v7, v1, vcc
v_mov_b64 v[120:121], 0
v_mov_b64 v[122:123], 0
s_mul_i32 s49, s44, 128
s_add_u32 s49, s49, 14336
v_mov_b32 v1, s49
v_mov_b32 v2, 2147483632
v_cmp_eq_u32 vcc, 0, v0
s_nop 1
v_cndmask_b32 v22, v2, v1, vcc
v_add_u32 v23, 65536, v22
s_mov_b32 s45, 0
s_getpc_b64 s[96:97]
pc_179:
s_add_u32 s96, s96, L_writers-pc_179
s_addc_u32 s97, s97, 0
v_subrev_u32 v2, 0, v11
v_lshrrev_b32 v2, 7, v2
v_cmp_gt_u32 vcc, 0x200, v2
s_nop 1
v_cndmask_b32 v2, 0, v2, vcc
global_load_ubyte v2, v2, s[96:97]
s_mov_b32 s12, s40
s_and_b32 s13, s41, 0xffff
s_mov_b32 s14, 256
s_mov_b32 s15, 0x20000
v_lshlrev_b32 v14, 2, v0
v_add_u32 v15, 128, v14
v_cmp_le_u32 vcc, 2, v0
s_nop 1
v_cndmask_b32 v14, v14, v15, vcc
v_mov_b32 v15, 192
v_cmp_eq_u32 vcc, 8, v0
s_nop 1
v_cndmask_b32 v14, v14, v15, vcc
v_mov_b32 v15, 2147483632
v_cmp_lt_u32 vcc, 8, v0
s_nop 1
v_cndmask_b32 v14, v14, v15, vcc
s_mov_b32 s98, 0
wi_loop_180:
buffer_load_dword v15, v14, s[12:15], 0 offen sc1
s_add_u32 s98, s98, 1
s_cmp_gt_u32 s98, 150000
s_cbranch_scc1 wi_bad_182
s_waitcnt vmcnt(0)
v_cmp_eq_u32 vcc, 32, v15
s_nop 0
s_and_b32 s97, vcc_lo, 0x1ff
s_cmp_eq_u32 s97, 0x1ff
s_cbranch_scc1 wi_ok_181
v_cmp_lt_u32 vcc, 32, v15
s_nop 0
s_and_b32 s96, vcc_lo, 0xff
s_cselect_b32 s96, 0x100, 0
s_and_b32 s96, s96, s97
s_cbranch_scc1 wi_over_183
s_sleep 8
s_branch wi_loop_180
wi_bad_182:
s_mov_b32 s98, 512
s_branch L_fail
wi_over_183:
s_mov_b32 s100, 255
wi_ok_181:
v_add_u32 v3, 65536, v11
v_cmp_eq_u32 vcc, s100, v2
s_nop 1
v_cndmask_b32 v11, v11, v3, vcc
v_mov_b32 v3, 2147483632
s_cmp_lg_u32 s100, 255
s_cselect_b64 vcc, -1, 0
v_cndmask_b32 v22, v22, v3, vcc
s_mov_b32 s8, s42
s_and_b32 s9, s43, 0xffff
s_mov_b32 s10, 0
s_mov_b32 s11, 0x20000
s_add_u32 s49, s47, 0
buffer_store_dwordx4 v[120:123], v8, s[4:7], s49 offen offset:0 sc1
buffer_store_dwordx4 v[120:123], v8, s[4:7], s49 offen offset:1024 sc1
buffer_store_dwordx4 v[120:123], v8, s[4:7], s49 offen offset:2048 sc1
buffer_store_dwordx4 v[120:123], v8, s[4:7], s49 offen offset:3072 sc1
s_add_u32 s49, s47, 131072
buffer_store_dwordx4 v[120:123], v8, s[4:7], s49 offen offset:0 sc1
buffer_store_dwordx4 v[120:123], v8, s[4:7], s49 offen offset:1024 sc1
buffer_store_dwordx4 v[120:123], v8, s[4:7], s49 offen offset:2048 sc1
buffer_store_dwordx4 v[120:123], v8, s[4:7], s49 offen offset:3072 sc1
s_add_u32 s49, s47, 262144
buffer_store_dwordx4 v[120:123], v8, s[4:7], s49 offen offset:0 sc1
buffer_store_dwordx4 v[120:123], v8, s[4:7], s49 offen offset:1024 sc1
buffer_store_dwordx4 v[120:123], v8, s[4:7], s49 offen offset:2048 sc1
buffer_store_dwordx4 v[120:123], v8, s[4:7], s49 offen offset:3072 sc1
s_add_u32 s49, s47, 393216
buffer_store_dwordx4 v[120:123], v8, s[4:7], s49 offen offset:0 sc1
buffer_store_dwordx4 v[120:123], v8, s[4:7], s49 offen offset:1024 sc1
buffer_store_dwordx4 v[120:123], v8, s[4:7], s49 offen offset:2048 sc1
buffer_store_dwordx4 v[120:123], v8, s[4:7], s49 offen offset:3072 sc1
s_add_u32 s49, s47, 524288
buffer_store_dwordx4 v[120:123], v8, s[4:7], s49 offen offset:0 sc1
buffer_store_dwordx4 v[120:123], v8, s[4:7], s49 offen offset:1024 sc1
buffer_store_dwordx4 v[120:123], v8, s[4:7], s49 offen offset:2048 sc1
buffer_store_dwordx4 v[120:123], v8, s[4:7], s49 offen offset:3072 sc1
s_add_u32 s49, s47, 655360
buffer_store_dwordx4 v[120:123], v8, s[4:7], s49 offen offset:0 sc1
buffer_store_dwordx4 v[120:123], v8, s[4:7], s49 offen offset:1024 sc1
buffer_store_dwordx4 v[120:123], v8, s[4:7], s49 offen offset:2048 sc1
buffer_store_dwordx4 v[120:123], v8, s[4:7], s49 offen offset:3072 sc1
s_add_u32 s49, s47, 786432
buffer_store_dwordx4 v[120:123], v8, s[4:7], s49 offen offset:0 sc1
buffer_store_dwordx4 v[120:123], v8, s[4:7], s49 offen offset:1024 sc1
buffer_store_dwordx4 v[120:123], v8, s[4:7], s49 offen offset:2048 sc1
buffer_store_dwordx4 v[120:123], v8, s[4:7], s49 offen offset:3072 sc1
s_add_u32 s49, s47, 917504
buffer_store_dwordx4 v[120:123], v8, s[4:7], s49 offen offset:0 sc1
buffer_store_dwordx4 v[120:123], v8, s[4:7], s49 offen offset:1024 sc1
buffer_store_dwordx4 v[120:123], v8, s[4:7], s49 offen offset:2048 sc1
buffer_store_dwordx4 v[120:123], v8, s[4:7], s49 offen offset:3072 sc1
s_waitcnt vmcnt(0)
v_mov_b32 v125, 8
buffer_store_dword v125, v124, s[4:7], s52 offen sc1
s_mov_b32 s98, 0
sp_loop_186:
buffer_load_dword v24, v11, s[4:7], s52 offen sc1
s_add_u32 s98, s98, 1
s_cmp_gt_u32 s98, 150000
s_cbranch_scc1 sp_bad_188
s_waitcnt vmcnt(0)
v_cmp_gt_u32 vcc, 1, v24
s_nop 0
s_and_b32 vcc_lo, vcc_lo, 0x3f
s_cbranch_scc0 sp_ok_187
s_sleep 2
s_branch sp_loop_186
sp_bad_188:
s_mov_b32 s98, 1536
s_branch L_fail
sp_ok_187:
s_add_u32 s54, s46, 0
buffer_load_dwordx4 a[0:3], v8, s[4:7], s54 offen offset:0 sc1
buffer_load_dwordx4 a[4:7], v8, s[4:7], s54 offen offset:1024 sc1
buffer_load_dwordx4 a[8:11], v8, s[4:7], s54 offen offset:2048 sc1
buffer_load_dwordx4 a[12:15], v8, s[4:7], s54 offen offset:3072 sc1
s_add_u32 s54, s46, 4096
buffer_load_dwordx4 a[16:19], v8, s[4:7], s54 offen offset:0 sc1
buffer_load_dwordx4 a[20:23], v8, s[4:7], s54 offen offset:1024 sc1
buffer_load_dwordx4 a[24:27], v8, s[4:7], s54 offen offset:2048 sc1
buffer_load_dwordx4 a[28:31], v8, s[4:7], s54 offen offset:3072 sc1
s_add_u32 s54, s46, 8192
buffer_load_dwordx4 a[32:35], v8, s[4:7], s54 offen offset:0 sc1
buffer_load_dwordx4 a[36:39], v8, s[4:7], s54 offen offset:1024 sc1
buffer_load_dwordx4 a[40:43], v8, s[4:7], s54 offen offset:2048 sc1
buffer_load_dwordx4 a[44:47], v8, s[4:7], s54 offen offset:3072 sc1
s_add_u32 s54, s46, 12288
buffer_load_dwordx4 a[48:51], v8, s[4:7], s54 offen offset:0 sc1
buffer_load_dwordx4 a[52:55], v8, s[4:7], s54 offen offset:1024 sc1
buffer_load_dwordx4 a[56:59], v8, s[4:7], s54 offen offset:2048 sc1
buffer_load_dwordx4 a[60:63], v8, s[4:7], s54 offen offset:3072 sc1
s_add_u32 s54, s46, 16384
buffer_load_dwordx4 a[64:67], v8, s[4:7], s54 offen offset:0 sc1
buffer_load_dwordx4 a[68:71], v8, s[4:7], s54 offen offset:1024 sc1
buffer_load_dwordx4 a[72:75], v8, s[4:7], s54 offen offset:2048 sc1
buffer_load_dwordx4 a[76:79], v8, s[4:7], s54 offen offset:3072 sc1
s_add_u32 s54, s46, 20480
buffer_load_dwordx4 a[80:83], v8, s[4:7], s54 offen offset:0 sc1
buffer_load_dwordx4 a[84:87], v8, s[4:7], s54 offen offset:1024 sc1
buffer_load_dwordx4 a[88:91], v8, s[4:7], s54 offen offset:2048 sc1
buffer_load_dwordx4 a[92:95], v8, s[4:7], s54 offen offset:3072 sc1
s_waitcnt vmcnt(0)
buffer_load_dwordx4 v[64:67], v9, s[4:7], s47 offen offset:0 sc1
buffer_load_dwordx4 v[68:71], v9, s[4:7], s47 offen offset:512 sc1
buffer_load_dwordx4 v[72:75], v9, s[4:7], s47 offen offset:1024 sc1
buffer_load_dwordx4 v[76:79], v9, s[4:7], s47 offen offset:1536 sc1
buffer_load_dwordx2 v[80:81], v10, s[4:7], s47 offen offset:0 sc1
buffer_load_dwordx2 v[82:83], v10, s[4:7], s47 offen offset:512 sc1
buffer_load_dwordx2 v[84:85], v10, s[4:7], s47 offen offset:1024 sc1
buffer_load_dwordx2 v[86:87], v10, s[4:7], s47 offen offset:1536 sc1
v_mfma_f32_16x16x32_bf16 v[28:31], a[32:35], a[0:3], 0
v_mfma_f32_16x16x32_bf16 v[32:35], a[32:35], a[4:7], 0
v_mfma_f32_16x16x32_bf16 v[36:39], a[36:39], a[4:7], 0
v_mfma_f32_16x16x32_bf16 v[28:31], a[40:43], a[8:11], v[28:31]
v_mfma_f32_16x16x32_bf16 v[32:35], a[40:43], a[12:15], v[32:35]
v_mfma_f32_16x16x32_bf16 v[36:39], a[44:47], a[12:15], v[36:39]
v_mfma_f32_16x16x32_bf16 v[28:31], a[48:51], a[16:19], v[28:31]
v_mfma_f32_16x16x32_bf16 v[32:35], a[48:51], a[20:23], v[32:35]
v_mfma_f32_16x16x32_bf16 v[36:39], a[52:55], a[20:23], v[36:39]
v_mfma_f32_16x16x32_bf16 v[28:31], a[56:59], a[24:27], v[28:31]
v_mfma_f32_16x16x32_bf16 v[32:35], a[56:59], a[28:31], v[32:35]
v_mfma_f32_16x16x32_bf16 v[36:39], a[60:63], a[28:31], v[36:39]
s_add_u32 s53, s45, 1
s_nop 4
v_cndmask_b32 v28, v16, v28, s[56:57]
v_cndmask_b32 v29, v16, v29, s[58:59]
v_cndmask_b32 v30, v16, v30, s[60:61]
v_cndmask_b32 v31, v16, v31, s[62:63]
v_cndmask_b32 v36, v16, v36, s[56:57]
v_cndmask_b32 v37, v16, v37, s[58:59]
v_cndmask_b32 v38, v16, v38, s[60:61]
v_cndmask_b32 v39, v16, v39, s[62:63]
v_max3_f32 v18, v32, v33, v34
v_max3_f32 v17, v28, v29, v30
v_max3_f32 v18, v18, v35, v36
v_max_f32 v17, v17, v31
v_max3_f32 v18, v18, v37, v38
v_max_f32 v18, v18, v39
s_waitcnt vmcnt(0)
att_loop_184:
s_mov_b32 s98, 0
s_bfe_u32 s55, s45, 0x10003
s_xor_b32 s55, s55, 1
att_sp_189:
v_xor_b32 v14, s55, v64
v_xor_b32 v19, s55, v80
v_bitop3_b32 v14, v14, v68, s55 bitop3:0xf6
v_bitop3_b32 v19, v19, v82, s55 bitop3:0xf6
v_bitop3_b32 v14, v14, v72, s55 bitop3:0xf6
v_bitop3_b32 v19, v19, v84, s55 bitop3:0xf6
v_bitop3_b32 v14, v14, v76, s55 bitop3:0xf6
v_bitop3_b32 v19, v19, v86, s55 bitop3:0xf6
v_or_b32 v14, v14, v19
v_and_b32 v14, 1, v14
v_cmp_ne_u32 vcc, 0, v14
s_nop 0
s_cbranch_vccz att_ok_190
s_sleep 2
buffer_load_dwordx4 v[64:67], v9, s[4:7], s47 offen offset:0 sc1
buffer_load_dwordx4 v[68:71], v9, s[4:7], s47 offen offset:512 sc1
buffer_load_dwordx4 v[72:75], v9, s[4:7], s47 offen offset:1024 sc1
buffer_load_dwordx4 v[76:79], v9, s[4:7], s47 offen offset:1536 sc1
buffer_load_dwordx2 v[80:81], v10, s[4:7], s47 offen offset:0 sc1
buffer_load_dwordx2 v[82:83], v10, s[4:7], s47 offen offset:512 sc1
buffer_load_dwordx2 v[84:85], v10, s[4:7], s47 offen offset:1024 sc1
buffer_load_dwordx2 v[86:87], v10, s[4:7], s47 offen offset:1536 sc1
buffer_load_dword v24, v11, s[4:7], s52 offen sc1
s_add_u32 s98, s98, 1
s_cmp_gt_u32 s98, 150000
s_cbranch_scc1 att_bad_191
s_waitcnt vmcnt(0)
s_branch att_sp_189
att_bad_191:
s_mov_b32 s98, 1537
s_branch L_fail
att_ok_190:
s_add_u32 s49, s53, 1
v_cmp_gt_u32 vcc, s49, v24
s_nop 0
s_and_b32 vcc_lo, vcc_lo, 0x3f
s_cselect_b32 s51, 0, 1
s_cselect_b32 s10, 0, 268435456
s_add_u32 s46, s46, 786432
s_and_b32 s49, s53, 7
s_mul_i32 s49, s49, 131072
s_add_u32 s47, s64, s49
v_mfma_f32_16x16x32_bf16 v[40:43], v[64:67], a[0:3], 0
v_mfma_f32_16x16x32_bf16 v[44:47], v[64:67], a[4:7], 0
s_add_u32 s54, s46, 0
buffer_load_dwordx4 a[96:99], v8, s[8:11], s54 offen offset:0 sc1
v_mfma_f32_16x16x32_bf16 v[40:43], v[68:71], a[8:11], v[40:43]
v_mfma_f32_16x16x32_bf16 v[44:47], v[68:71], a[12:15], v[44:47]
buffer_load_dwordx4 a[100:103], v8, s[8:11], s54 offen offset:1024 sc1
v_mfma_f32_16x16x32_bf16 v[40:43], v[72:75], a[16:19], v[40:43]
v_mfma_f32_16x16x32_bf16 v[44:47], v[72:75], a[20:23], v[44:47]
buffer_load_dwordx4 a[104:107], v8, s[8:11], s54 offen offset:2048 sc1
v_mfma_f32_16x16x32_bf16 v[40:43], v[76:79], a[24:27], v[40:43]
v_mfma_f32_16x16x32_bf16 v[44:47], v[76:79], a[28:31], v[44:47]
buffer_load_dwordx4 a[108:111], v8, s[8:11], s54 offen offset:3072 sc1
s_add_u32 s54, s46, 4096
buffer_load_dwordx4 a[112:115], v8, s[8:11], s54 offen offset:0 sc1
buffer_load_dwordx4 a[116:119], v8, s[8:11], s54 offen offset:1024 sc1
s_nop 2
v_max3_f32 v17, v17, v40, v41
v_max3_f32 v18, v18, v44, v45
s_nop 1
v_permlane32_swap_b32 v17, v18
v_max_f32 v17, v17, v18
v_mov_b32 v19, v17
s_nop 1
v_permlane16_swap_b32 v17, v19
v_max_f32 v17, v17, v19
v_mul_f32 v17, s50, v17
v_mov_b32 v18, v17
buffer_load_dwordx4 a[120:123], v8, s[8:11], s54 offen offset:2048 sc1
s_nop 0
v_permlane32_swap_b32 v17, v18
v_fma_f32 v28, v28, s50, -v17
v_fma_f32 v29, v29, s50, -v17
v_fma_f32 v30, v30, s50, -v17
v_fma_f32 v31, v31, s50, -v17
v_fma_f32 v40, v40, s50, -v17
v_fma_f32 v41, v41, s50, -v17
v_fma_f32 v32, v32, s50, -v18
v_fma_f32 v33, v33, s50, -v18
v_fma_f32 v34, v34, s50, -v18
v_fma_f32 v35, v35, s50, -v18
v_fma_f32 v36, v36, s50, -v18
v_fma_f32 v37, v37, s50, -v18
v_fma_f32 v38, v38, s50, -v18
v_fma_f32 v39, v39, s50, -v18
v_fma_f32 v44, v44, s50, -v18
v_fma_f32 v45, v45, s50, -v18
buffer_load_dwordx4 a[124:127], v8, s[8:11], s54 offen offset:3072 sc1
v_exp_f32 v28, v28
v_exp_f32 v29, v29
v_exp_f32 v30, v30
v_exp_f32 v31, v31
v_exp_f32 v40, v40
v_exp_f32 v41, v41
s_add_u32 s54, s46, 8192
buffer_load_dwordx4 a[128:131], v8, s[8:11], s54 offen offset:0 sc1
v_exp_f32 v32, v32
v_exp_f32 v33, v33
v_exp_f32 v34, v34
v_exp_f32 v35, v35
v_exp_f32 v36, v36
v_exp_f32 v37, v37
v_exp_f32 v38, v38
v_exp_f32 v39, v39
v_exp_f32 v44, v44
v_exp_f32 v45, v45
buffer_load_dwordx4 a[132:135], v8, s[8:11], s54 offen offset:1024 sc1
v_add_f32 v17, v28, v29
v_add_f32 v18, v32, v33
v_add_f32 v17, v17, v30
v_add_f32 v18, v18, v34
v_add_f32 v17, v17, v31
v_add_f32 v18, v18, v35
v_add_f32 v17, v17, v40
v_add_f32 v18, v18, v36
v_add_f32 v17, v17, v41
v_add_f32 v18, v18, v37
v_add_f32 v18, v18, v38
v_add_f32 v18, v18, v39
v_add_f32 v18, v18, v44
v_add_f32 v18, v18, v45
buffer_load_dwordx4 a[136:139], v8, s[8:11], s54 offen offset:2048 sc1
s_nop 0
v_permlane32_swap_b32 v17, v18
v_add_f32 v17, v17, v18
v_mov_b32 v19, v17
s_nop 1
v_permlane16_swap_b32 v17, v19
v_add_f32 v17, v17, v19
v_rcp_f32 v17, v17
buffer_load_dwordx4 a[140:143], v8, s[8:11], s54 offen offset:3072 sc1
v_mov_b32 v18, v17
s_add_u32 s54, s46, 12288
buffer_load_dwordx4 a[144:147], v8, s[8:11], s54 offen offset:0 sc1
v_permlane32_swap_b32 v17, v18
v_mul_f32 v28, v28, v17
v_mul_f32 v29, v29, v17
v_mul_f32 v30, v30, v17
v_mul_f32 v31, v31, v17
v_mul_f32 v40, v40, v17
v_mul_f32 v41, v41, v17
v_cvt_pk_bf16_f32 v48, v28, v29
v_cvt_pk_bf16_f32 v49, v30, v31
v_cvt_pk_bf16_f32 v56, v40, v41
v_cvt_pk_bf16_f32 v59, v40, v41
buffer_load_dwordx4 a[148:151], v8, s[8:11], s54 offen offset:1024 sc1
v_mul_f32 v32, v32, v18
v_mul_f32 v33, v33, v18
v_mul_f32 v34, v34, v18
v_mul_f32 v35, v35, v18
v_mul_f32 v36, v36, v18
v_mul_f32 v37, v37, v18
v_mul_f32 v38, v38, v18
v_mul_f32 v39, v39, v18
v_mul_f32 v44, v44, v18
v_mul_f32 v45, v45, v18
v_cvt_pk_bf16_f32 v52, v32, v33
v_cvt_pk_bf16_f32 v53, v34, v35
v_cvt_pk_bf16_f32 v54, v36, v37
v_cvt_pk_bf16_f32 v55, v38, v39
v_cvt_pk_bf16_f32 v60, v44, v45
v_cvt_pk_bf16_f32 v63, v44, v45
buffer_load_dwordx4 a[152:155], v8, s[8:11], s54 offen offset:2048 sc1
s_add_u32 s49, s48, 4096
buffer_load_dword v24, v11, s[4:7], s52 offen sc1
v_mfma_f32_16x16x32_bf16 v[128:131], a[64:67], v[48:51], 0
v_mfma_f32_16x16x32_bf16 v[132:135], a[68:71], v[48:51], 0
v_mfma_f32_16x16x16_bf16 v[128:131], v[80:81], v[56:57], v[128:131]
v_mfma_f32_16x16x16_bf16 v[132:135], v[80:81], v[58:59], v[132:135]
v_mfma_f32_16x16x32_bf16 v[136:139], a[72:75], v[48:51], 0
v_mfma_f32_16x16x32_bf16 v[140:143], a[76:79], v[48:51], 0
v_mfma_f32_16x16x16_bf16 v[136:139], v[82:83], v[56:57], v[136:139]
v_mfma_f32_16x16x16_bf16 v[140:143], v[82:83], v[58:59], v[140:143]
v_mfma_f32_16x16x32_bf16 v[144:147], a[80:83], v[48:51], 0
s_nop 1
v_cvt_pk_bf16_f32 v88, v128, v129
v_mfma_f32_16x16x32_bf16 v[148:151], a[84:87], v[48:51], 0
v_cvt_pk_bf16_f32 v89, v130, v131
v_mfma_f32_16x16x16_bf16 v[144:147], v[84:85], v[56:57], v[144:147]
v_cvt_pk_bf16_f32 v90, v132, v133
v_mfma_f32_16x16x16_bf16 v[148:151], v[84:85], v[58:59], v[148:151]
v_cvt_pk_bf16_f32 v91, v134, v135
buffer_store_dwordx4 v[88:91], v8, s[4:7], s48 offen offset:0 sc1
v_mfma_f32_16x16x32_bf16 v[152:155], a[88:91], v[48:51], 0
v_cvt_pk_bf16_f32 v92, v136, v137
v_mfma_f32_16x16x32_bf16 v[156:159], a[92:95], v[48:51], 0
v_cvt_pk_bf16_f32 v93, v138, v139
v_mfma_f32_16x16x16_bf16 v[152:155], v[86:87], v[56:57], v[152:155]
v_cvt_pk_bf16_f32 v94, v140, v141
v_mfma_f32_16x16x16_bf16 v[156:159], v[86:87], v[58:59], v[156:159]
v_cvt_pk_bf16_f32 v95, v142, v143
buffer_store_dwordx4 v[92:95], v8, s[4:7], s48 offen offset:2048 sc1
v_mfma_f32_16x16x32_bf16 v[160:163], a[64:67], v[52:55], 0
v_cvt_pk_bf16_f32 v96, v144, v145
v_mfma_f32_16x16x32_bf16 v[164:167], a[68:71], v[52:55], 0
v_cvt_pk_bf16_f32 v97, v146, v147
v_mfma_f32_16x16x16_bf16 v[160:163], v[80:81], v[60:61], v[160:163]
v_cvt_pk_bf16_f32 v98, v148, v149
v_mfma_f32_16x16x16_bf16 v[164:167], v[80:81], v[62:63], v[164:167]
v_cvt_pk_bf16_f32 v99, v150, v151
buffer_store_dwordx4 v[96:99], v8, s[4:7], s49 offen offset:0 sc1
v_mfma_f32_16x16x32_bf16 v[168:171], a[72:75], v[52:55], 0
v_cvt_pk_bf16_f32 v100, v152, v153
v_mfma_f32_16x16x32_bf16 v[172:175], a[76:79], v[52:55], 0
v_cvt_pk_bf16_f32 v101, v154, v155
v_mfma_f32_16x16x16_bf16 v[168:171], v[82:83], v[60:61], v[168:171]
v_cvt_pk_bf16_f32 v102, v156, v157
v_mfma_f32_16x16x16_bf16 v[172:175], v[82:83], v[62:63], v[172:175]
v_cvt_pk_bf16_f32 v103, v158, v159
buffer_store_dwordx4 v[100:103], v8, s[4:7], s49 offen offset:2048 sc1
v_mfma_f32_16x16x32_bf16 v[176:179], a[80:83], v[52:55], 0
v_cvt_pk_bf16_f32 v104, v160, v161
v_mfma_f32_16x16x32_bf16 v[180:183], a[84:87], v[52:55], 0
v_cvt_pk_bf16_f32 v105, v162, v163
v_mfma_f32_16x16x16_bf16 v[176:179], v[84:85], v[60:61], v[176:179]
v_cvt_pk_bf16_f32 v106, v164, v165
v_mfma_f32_16x16x16_bf16 v[180:183], v[84:85], v[62:63], v[180:183]
v_cvt_pk_bf16_f32 v107, v166, v167
buffer_store_dwordx4 v[104:107], v8, s[4:7], s48 offen offset:1024 sc1
v_mfma_f32_16x16x32_bf16 v[184:187], a[88:91], v[52:55], 0
v_cvt_pk_bf16_f32 v108, v168, v169
v_mfma_f32_16x16x32_bf16 v[188:191], a[92:95], v[52:55], 0
v_cvt_pk_bf16_f32 v109, v170, v171
v_mfma_f32_16x16x16_bf16 v[184:187], v[86:87], v[60:61], v[184:187]
v_cvt_pk_bf16_f32 v110, v172, v173
v_mfma_f32_16x16x16_bf16 v[188:191], v[86:87], v[62:63], v[188:191]
v_cvt_pk_bf16_f32 v111, v174, v175
buffer_store_dwordx4 v[108:111], v8, s[4:7], s48 offen offset:3072 sc1
v_cvt_pk_bf16_f32 v112, v176, v177
v_cvt_pk_bf16_f32 v113, v178, v179
v_cvt_pk_bf16_f32 v114, v180, v181
v_cvt_pk_bf16_f32 v115, v182, v183
buffer_store_dwordx4 v[112:115], v8, s[4:7], s49 offen offset:1024 sc1
v_cvt_pk_bf16_f32 v116, v184, v185
v_cvt_pk_bf16_f32 v117, v186, v187
v_cvt_pk_bf16_f32 v118, v188, v189
v_cvt_pk_bf16_f32 v119, v190, v191
buffer_store_dwordx4 v[116:119], v8, s[4:7], s49 offen offset:3072 sc1
buffer_load_dwordx4 a[156:159], v8, s[8:11], s54 offen offset:3072 sc1
s_add_u32 s54, s46, 16384
buffer_load_dwordx4 a[160:163], v8, s[8:11], s54 offen offset:0 sc1
buffer_load_dwordx4 a[164:167], v8, s[8:11], s54 offen offset:1024 sc1
buffer_load_dwordx4 a[168:171], v8, s[8:11], s54 offen offset:2048 sc1
buffer_load_dwordx4 a[172:175], v8, s[8:11], s54 offen offset:3072 sc1
s_add_u32 s54, s46, 20480
buffer_load_dwordx4 a[176:179], v8, s[8:11], s54 offen offset:0 sc1
buffer_load_dwordx4 a[180:183], v8, s[8:11], s54 offen offset:1024 sc1
buffer_load_dwordx4 a[184:187], v8, s[8:11], s54 offen offset:2048 sc1
buffer_load_dwordx4 a[188:191], v8, s[8:11], s54 offen offset:3072 sc1
s_add_u32 s48, s48, 262144
v_mov_b32 v15, s53
s_mov_b32 s45, s53
s_cmp_eq_u32 s51, 0
s_cbranch_scc1 att_nopre_192
s_waitcnt vmcnt(9)
buffer_store_dword v15, v23, s[4:7], s52 offen
buffer_store_dword v15, v22, s[4:7], s52 offen sc1
buffer_load_dwordx4 v[64:67], v9, s[4:7], s47 offen offset:0 sc1
buffer_load_dwordx4 v[68:71], v9, s[4:7], s47 offen offset:512 sc1
buffer_load_dwordx4 v[72:75], v9, s[4:7], s47 offen offset:1024 sc1
buffer_load_dwordx4 v[76:79], v9, s[4:7], s47 offen offset:1536 sc1
buffer_load_dwordx2 v[80:81], v10, s[4:7], s47 offen offset:0 sc1
buffer_load_dwordx2 v[82:83], v10, s[4:7], s47 offen offset:512 sc1
buffer_load_dwordx2 v[84:85], v10, s[4:7], s47 offen offset:1024 sc1
buffer_load_dwordx2 v[86:87], v10, s[4:7], s47 offen offset:1536 sc1
s_add_u32 s49, s45, 8
v_mov_b32 v125, s49
buffer_store_dword v125, v124, s[4:7], s52 offen sc1
s_waitcnt vmcnt(11)
v_mfma_f32_16x16x32_bf16 v[28:31], a[128:131], a[96:99], 0
v_mfma_f32_16x16x32_bf16 v[32:35], a[128:131], a[100:103], 0
v_mfma_f32_16x16x32_bf16 v[36:39], a[132:135], a[100:103], 0
v_mfma_f32_16x16x32_bf16 v[28:31], a[136:139], a[104:107], v[28:31]
v_mfma_f32_16x16x32_bf16 v[32:35], a[136:139], a[108:111], v[32:35]
v_mfma_f32_16x16x32_bf16 v[36:39], a[140:143], a[108:111], v[36:39]
v_mfma_f32_16x16x32_bf16 v[28:31], a[144:147], a[112:115], v[28:31]
v_mfma_f32_16x16x32_bf16 v[32:35], a[144:147], a[116:119], v[32:35]
v_mfma_f32_16x16x32_bf16 v[36:39], a[148:151], a[116:119], v[36:39]
v_mfma_f32_16x16x32_bf16 v[28:31], a[152:155], a[120:123], v[28:31]
v_mfma_f32_16x16x32_bf16 v[32:35], a[152:155], a[124:127], v[32:35]
v_mfma_f32_16x16x32_bf16 v[36:39], a[156:159], a[124:127], v[36:39]
s_add_u32 s53, s45, 1
s_nop 4
v_cndmask_b32 v28, v16, v28, s[56:57]
v_cndmask_b32 v29, v16, v29, s[58:59]
v_cndmask_b32 v30, v16, v30, s[60:61]
v_cndmask_b32 v31, v16, v31, s[62:63]
v_cndmask_b32 v36, v16, v36, s[56:57]
v_cndmask_b32 v37, v16, v37, s[58:59]
v_cndmask_b32 v38, v16, v38, s[60:61]
v_cndmask_b32 v39, v16, v39, s[62:63]
v_max3_f32 v18, v32, v33, v34
v_max3_f32 v17, v28, v29, v30
v_max3_f32 v18, v18, v35, v36
v_max_f32 v17, v17, v31
v_max3_f32 v18, v18, v37, v38
v_max_f32 v18, v18, v39
s_waitcnt vmcnt(1)
att_j2_193:
s_mov_b32 s98, 0
s_bfe_u32 s55, s45, 0x10003
s_xor_b32 s55, s55, 1
att_sp_194:
v_xor_b32 v14, s55, v64
v_xor_b32 v19, s55, v80
v_bitop3_b32 v14, v14, v68, s55 bitop3:0xf6
v_bitop3_b32 v19, v19, v82, s55 bitop3:0xf6
v_bitop3_b32 v14, v14, v72, s55 bitop3:0xf6
v_bitop3_b32 v19, v19, v84, s55 bitop3:0xf6
v_bitop3_b32 v14, v14, v76, s55 bitop3:0xf6
v_bitop3_b32 v19, v19, v86, s55 bitop3:0xf6
v_or_b32 v14, v14, v19
v_and_b32 v14, 1, v14
v_cmp_ne_u32 vcc, 0, v14
s_nop 0
s_cbranch_vccz att_ok_195
s_sleep 2
buffer_load_dwordx4 v[64:67], v9, s[4:7], s47 offen offset:0 sc1
buffer_load_dwordx4 v[68:71], v9, s[4:7], s47 offen offset:512 sc1
buffer_load_dwordx4 v[72:75], v9, s[4:7], s47 offen offset:1024 sc1
buffer_load_dwordx4 v[76:79], v9, s[4:7], s47 offen offset:1536 sc1
buffer_load_dwordx2 v[80:81], v10, s[4:7], s47 offen offset:0 sc1
buffer_load_dwordx2 v[82:83], v10, s[4:7], s47 offen offset:512 sc1
buffer_load_dwordx2 v[84:85], v10, s[4:7], s47 offen offset:1024 sc1
buffer_load_dwordx2 v[86:87], v10, s[4:7], s47 offen offset:1536 sc1
buffer_load_dword v24, v11, s[4:7], s52 offen sc1
s_add_u32 s98, s98, 1
s_cmp_gt_u32 s98, 150000
s_cbranch_scc1 att_bad_196
s_waitcnt vmcnt(0)
s_branch att_sp_194
att_bad_196:
s_mov_b32 s98, 1537
s_branch L_fail
att_ok_195:
s_add_u32 s49, s53, 1
v_cmp_gt_u32 vcc, s49, v24
s_nop 0
s_and_b32 vcc_lo, vcc_lo, 0x3f
s_cselect_b32 s51, 0, 1
s_cselect_b32 s10, 0, 268435456
s_add_u32 s46, s46, 786432
s_and_b32 s49, s53, 7
s_mul_i32 s49, s49, 131072
s_add_u32 s47, s64, s49
v_mfma_f32_16x16x32_bf16 v[40:43], v[64:67], a[96:99], 0
v_mfma_f32_16x16x32_bf16 v[44:47], v[64:67], a[100:103], 0
s_add_u32 s54, s46, 0
buffer_load_dwordx4 a[0:3], v8, s[8:11], s54 offen offset:0 sc1
v_mfma_f32_16x16x32_bf16 v[40:43], v[68:71], a[104:107], v[40:43]
v_mfma_f32_16x16x32_bf16 v[44:47], v[68:71], a[108:111], v[44:47]
buffer_load_dwordx4 a[4:7], v8, s[8:11], s54 offen offset:1024 sc1
v_mfma_f32_16x16x32_bf16 v[40:43], v[72:75], a[112:115], v[40:43]
v_mfma_f32_16x16x32_bf16 v[44:47], v[72:75], a[116:119], v[44:47]
buffer_load_dwordx4 a[8:11], v8, s[8:11], s54 offen offset:2048 sc1
v_mfma_f32_16x16x32_bf16 v[40:43], v[76:79], a[120:123], v[40:43]
v_mfma_f32_16x16x32_bf16 v[44:47], v[76:79], a[124:127], v[44:47]
buffer_load_dwordx4 a[12:15], v8, s[8:11], s54 offen offset:3072 sc1
s_add_u32 s54, s46, 4096
buffer_load_dwordx4 a[16:19], v8, s[8:11], s54 offen offset:0 sc1
buffer_load_dwordx4 a[20:23], v8, s[8:11], s54 offen offset:1024 sc1
s_nop 2
v_max3_f32 v17, v17, v40, v41
v_max3_f32 v18, v18, v44, v45
s_nop 1
v_permlane32_swap_b32 v17, v18
v_max_f32 v17, v17, v18
v_mov_b32 v19, v17
s_nop 1
v_permlane16_swap_b32 v17, v19
v_max_f32 v17, v17, v19
v_mul_f32 v17, s50, v17
v_mov_b32 v18, v17
buffer_load_dwordx4 a[24:27], v8, s[8:11], s54 offen offset:2048 sc1
s_nop 0
v_permlane32_swap_b32 v17, v18
v_fma_f32 v28, v28, s50, -v17
v_fma_f32 v29, v29, s50, -v17
v_fma_f32 v30, v30, s50, -v17
v_fma_f32 v31, v31, s50, -v17
v_fma_f32 v40, v40, s50, -v17
v_fma_f32 v41, v41, s50, -v17
v_fma_f32 v32, v32, s50, -v18
v_fma_f32 v33, v33, s50, -v18
v_fma_f32 v34, v34, s50, -v18
v_fma_f32 v35, v35, s50, -v18
v_fma_f32 v36, v36, s50, -v18
v_fma_f32 v37, v37, s50, -v18
v_fma_f32 v38, v38, s50, -v18
v_fma_f32 v39, v39, s50, -v18
v_fma_f32 v44, v44, s50, -v18
v_fma_f32 v45, v45, s50, -v18
buffer_load_dwordx4 a[28:31], v8, s[8:11], s54 offen offset:3072 sc1
v_exp_f32 v28, v28
v_exp_f32 v29, v29
v_exp_f32 v30, v30
v_exp_f32 v31, v31
v_exp_f32 v40, v40
v_exp_f32 v41, v41
s_add_u32 s54, s46, 8192
buffer_load_dwordx4 a[32:35], v8, s[8:11], s54 offen offset:0 sc1
v_exp_f32 v32, v32
v_exp_f32 v33, v33
v_exp_f32 v34, v34
v_exp_f32 v35, v35
v_exp_f32 v36, v36
v_exp_f32 v37, v37
v_exp_f32 v38, v38
v_exp_f32 v39, v39
v_exp_f32 v44, v44
v_exp_f32 v45, v45
buffer_load_dwordx4 a[36:39], v8, s[8:11], s54 offen offset:1024 sc1
v_add_f32 v17, v28, v29
v_add_f32 v18, v32, v33
v_add_f32 v17, v17, v30
v_add_f32 v18, v18, v34
v_add_f32 v17, v17, v31
v_add_f32 v18, v18, v35
v_add_f32 v17, v17, v40
v_add_f32 v18, v18, v36
v_add_f32 v17, v17, v41
v_add_f32 v18, v18, v37
v_add_f32 v18, v18, v38
v_add_f32 v18, v18, v39
v_add_f32 v18, v18, v44
v_add_f32 v18, v18, v45
buffer_load_dwordx4 a[40:43], v8, s[8:11], s54 offen offset:2048 sc1
s_nop 0
v_permlane32_swap_b32 v17, v18
v_add_f32 v17, v17, v18
v_mov_b32 v19, v17
s_nop 1
v_permlane16_swap_b32 v17, v19
v_add_f32 v17, v17, v19
v_rcp_f32 v17, v17
buffer_load_dwordx4 a[44:47], v8, s[8:11], s54 offen offset:3072 sc1
v_mov_b32 v18, v17
s_add_u32 s54, s46, 12288
buffer_load_dwordx4 a[48:51], v8, s[8:11], s54 offen offset:0 sc1
v_permlane32_swap_b32 v17, v18
v_mul_f32 v28, v28, v17
v_mul_f32 v29, v29, v17
v_mul_f32 v30, v30, v17
v_mul_f32 v31, v31, v17
v_mul_f32 v40, v40, v17
v_mul_f32 v41, v41, v17
v_cvt_pk_bf16_f32 v48, v28, v29
v_cvt_pk_bf16_f32 v49, v30, v31
v_cvt_pk_bf16_f32 v56, v40, v41
v_cvt_pk_bf16_f32 v59, v40, v41
buffer_load_dwordx4 a[52:55], v8, s[8:11], s54 offen offset:1024 sc1
v_mul_f32 v32, v32, v18
v_mul_f32 v33, v33, v18
v_mul_f32 v34, v34, v18
v_mul_f32 v35, v35, v18
v_mul_f32 v36, v36, v18
v_mul_f32 v37, v37, v18
v_mul_f32 v38, v38, v18
v_mul_f32 v39, v39, v18
v_mul_f32 v44, v44, v18
v_mul_f32 v45, v45, v18
v_cvt_pk_bf16_f32 v52, v32, v33
v_cvt_pk_bf16_f32 v53, v34, v35
v_cvt_pk_bf16_f32 v54, v36, v37
v_cvt_pk_bf16_f32 v55, v38, v39
v_cvt_pk_bf16_f32 v60, v44, v45
v_cvt_pk_bf16_f32 v63, v44, v45
buffer_load_dwordx4 a[56:59], v8, s[8:11], s54 offen offset:2048 sc1
s_add_u32 s49, s48, 4096
buffer_load_dword v24, v11, s[4:7], s52 offen sc1
v_mfma_f32_16x16x32_bf16 v[128:131], a[160:163], v[48:51], 0
v_mfma_f32_16x16x32_bf16 v[132:135], a[164:167], v[48:51], 0
v_mfma_f32_16x16x16_bf16 v[128:131], v[80:81], v[56:57], v[128:131]
v_mfma_f32_16x16x16_bf16 v[132:135], v[80:81], v[58:59], v[132:135]
v_mfma_f32_16x16x32_bf16 v[136:139], a[168:171], v[48:51], 0
v_mfma_f32_16x16x32_bf16 v[140:143], a[172:175], v[48:51], 0
v_mfma_f32_16x16x16_bf16 v[136:139], v[82:83], v[56:57], v[136:139]
v_mfma_f32_16x16x16_bf16 v[140:143], v[82:83], v[58:59], v[140:143]
v_mfma_f32_16x16x32_bf16 v[144:147], a[176:179], v[48:51], 0
s_nop 1
v_cvt_pk_bf16_f32 v88, v128, v129
v_mfma_f32_16x16x32_bf16 v[148:151], a[180:183], v[48:51], 0
v_cvt_pk_bf16_f32 v89, v130, v131
v_mfma_f32_16x16x16_bf16 v[144:147], v[84:85], v[56:57], v[144:147]
v_cvt_pk_bf16_f32 v90, v132, v133
v_mfma_f32_16x16x16_bf16 v[148:151], v[84:85], v[58:59], v[148:151]
v_cvt_pk_bf16_f32 v91, v134, v135
buffer_store_dwordx4 v[88:91], v8, s[4:7], s48 offen offset:0 sc1
v_mfma_f32_16x16x32_bf16 v[152:155], a[184:187], v[48:51], 0
v_cvt_pk_bf16_f32 v92, v136, v137
v_mfma_f32_16x16x32_bf16 v[156:159], a[188:191], v[48:51], 0
v_cvt_pk_bf16_f32 v93, v138, v139
v_mfma_f32_16x16x16_bf16 v[152:155], v[86:87], v[56:57], v[152:155]
v_cvt_pk_bf16_f32 v94, v140, v141
v_mfma_f32_16x16x16_bf16 v[156:159], v[86:87], v[58:59], v[156:159]
v_cvt_pk_bf16_f32 v95, v142, v143
buffer_store_dwordx4 v[92:95], v8, s[4:7], s48 offen offset:2048 sc1
v_mfma_f32_16x16x32_bf16 v[160:163], a[160:163], v[52:55], 0
v_cvt_pk_bf16_f32 v96, v144, v145
v_mfma_f32_16x16x32_bf16 v[164:167], a[164:167], v[52:55], 0
v_cvt_pk_bf16_f32 v97, v146, v147
v_mfma_f32_16x16x16_bf16 v[160:163], v[80:81], v[60:61], v[160:163]
v_cvt_pk_bf16_f32 v98, v148, v149
v_mfma_f32_16x16x16_bf16 v[164:167], v[80:81], v[62:63], v[164:167]
v_cvt_pk_bf16_f32 v99, v150, v151
buffer_store_dwordx4 v[96:99], v8, s[4:7], s49 offen offset:0 sc1
v_mfma_f32_16x16x32_bf16 v[168:171], a[168:171], v[52:55], 0
v_cvt_pk_bf16_f32 v100, v152, v153
v_mfma_f32_16x16x32_bf16 v[172:175], a[172:175], v[52:55], 0
v_cvt_pk_bf16_f32 v101, v154, v155
v_mfma_f32_16x16x16_bf16 v[168:171], v[82:83], v[60:61], v[168:171]
v_cvt_pk_bf16_f32 v102, v156, v157
v_mfma_f32_16x16x16_bf16 v[172:175], v[82:83], v[62:63], v[172:175]
v_cvt_pk_bf16_f32 v103, v158, v159
buffer_store_dwordx4 v[100:103], v8, s[4:7], s49 offen offset:2048 sc1
v_mfma_f32_16x16x32_bf16 v[176:179], a[176:179], v[52:55], 0
v_cvt_pk_bf16_f32 v104, v160, v161
v_mfma_f32_16x16x32_bf16 v[180:183], a[180:183], v[52:55], 0
v_cvt_pk_bf16_f32 v105, v162, v163
v_mfma_f32_16x16x16_bf16 v[176:179], v[84:85], v[60:61], v[176:179]
v_cvt_pk_bf16_f32 v106, v164, v165
v_mfma_f32_16x16x16_bf16 v[180:183], v[84:85], v[62:63], v[180:183]
v_cvt_pk_bf16_f32 v107, v166, v167
buffer_store_dwordx4 v[104:107], v8, s[4:7], s48 offen offset:1024 sc1
v_mfma_f32_16x16x32_bf16 v[184:187], a[184:187], v[52:55], 0
v_cvt_pk_bf16_f32 v108, v168, v169
v_mfma_f32_16x16x32_bf16 v[188:191], a[188:191], v[52:55], 0
v_cvt_pk_bf16_f32 v109, v170, v171
v_mfma_f32_16x16x16_bf16 v[184:187], v[86:87], v[60:61], v[184:187]
v_cvt_pk_bf16_f32 v110, v172, v173
v_mfma_f32_16x16x16_bf16 v[188:191], v[86:87], v[62:63], v[188:191]
v_cvt_pk_bf16_f32 v111, v174, v175
buffer_store_dwordx4 v[108:111], v8, s[4:7], s48 offen offset:3072 sc1
v_cvt_pk_bf16_f32 v112, v176, v177
v_cvt_pk_bf16_f32 v113, v178, v179
v_cvt_pk_bf16_f32 v114, v180, v181
v_cvt_pk_bf16_f32 v115, v182, v183
buffer_store_dwordx4 v[112:115], v8, s[4:7], s49 offen offset:1024 sc1
v_cvt_pk_bf16_f32 v116, v184, v185
v_cvt_pk_bf16_f32 v117, v186, v187
v_cvt_pk_bf16_f32 v118, v188, v189
v_cvt_pk_bf16_f32 v119, v190, v191
buffer_store_dwordx4 v[116:119], v8, s[4:7], s49 offen offset:3072 sc1
buffer_load_dwordx4 a[60:63], v8, s[8:11], s54 offen offset:3072 sc1
s_add_u32 s54, s46, 16384
buffer_load_dwordx4 a[64:67], v8, s[8:11], s54 offen offset:0 sc1
buffer_load_dwordx4 a[68:71], v8, s[8:11], s54 offen offset:1024 sc1
buffer_load_dwordx4 a[72:75], v8, s[8:11], s54 offen offset:2048 sc1
buffer_load_dwordx4 a[76:79], v8, s[8:11], s54 offen offset:3072 sc1
s_add_u32 s54, s46, 20480
buffer_load_dwordx4 a[80:83], v8, s[8:11], s54 offen offset:0 sc1
buffer_load_dwordx4 a[84:87], v8, s[8:11], s54 offen offset:1024 sc1
buffer_load_dwordx4 a[88:91], v8, s[8:11], s54 offen offset:2048 sc1
buffer_load_dwordx4 a[92:95], v8, s[8:11], s54 offen offset:3072 sc1
s_add_u32 s48, s48, 262144
v_mov_b32 v15, s53
s_mov_b32 s45, s53
s_cmp_eq_u32 s51, 0
s_cbranch_scc1 att_nopre_197
s_waitcnt vmcnt(9)
buffer_store_dword v15, v23, s[4:7], s52 offen
buffer_store_dword v15, v22, s[4:7], s52 offen sc1
buffer_load_dwordx4 v[64:67], v9, s[4:7], s47 offen offset:0 sc1
buffer_load_dwordx4 v[68:71], v9, s[4:7], s47 offen offset:512 sc1
buffer_load_dwordx4 v[72:75], v9, s[4:7], s47 offen offset:1024 sc1
buffer_load_dwordx4 v[76:79], v9, s[4:7], s47 offen offset:1536 sc1
buffer_load_dwordx2 v[80:81], v10, s[4:7], s47 offen offset:0 sc1
buffer_load_dwordx2 v[82:83], v10, s[4:7], s47 offen offset:512 sc1
buffer_load_dwordx2 v[84:85], v10, s[4:7], s47 offen offset:1024 sc1
buffer_load_dwordx2 v[86:87], v10, s[4:7], s47 offen offset:1536 sc1
s_add_u32 s49, s45, 8
v_mov_b32 v125, s49
buffer_store_dword v125, v124, s[4:7], s52 offen sc1
s_waitcnt vmcnt(11)
v_mfma_f32_16x16x32_bf16 v[28:31], a[32:35], a[0:3], 0
v_mfma_f32_16x16x32_bf16 v[32:35], a[32:35], a[4:7], 0
v_mfma_f32_16x16x32_bf16 v[36:39], a[36:39], a[4:7], 0
v_mfma_f32_16x16x32_bf16 v[28:31], a[40:43], a[8:11], v[28:31]
v_mfma_f32_16x16x32_bf16 v[32:35], a[40:43], a[12:15], v[32:35]
v_mfma_f32_16x16x32_bf16 v[36:39], a[44:47], a[12:15], v[36:39]
v_mfma_f32_16x16x32_bf16 v[28:31], a[48:51], a[16:19], v[28:31]
v_mfma_f32_16x16x32_bf16 v[32:35], a[48:51], a[20:23], v[32:35]
v_mfma_f32_16x16x32_bf16 v[36:39], a[52:55], a[20:23], v[36:39]
v_mfma_f32_16x16x32_bf16 v[28:31], a[56:59], a[24:27], v[28:31]
v_mfma_f32_16x16x32_bf16 v[32:35], a[56:59], a[28:31], v[32:35]
v_mfma_f32_16x16x32_bf16 v[36:39], a[60:63], a[28:31], v[36:39]
s_add_u32 s53, s45, 1
s_nop 4
v_cndmask_b32 v28, v16, v28, s[56:57]
v_cndmask_b32 v29, v16, v29, s[58:59]
v_cndmask_b32 v30, v16, v30, s[60:61]
v_cndmask_b32 v31, v16, v31, s[62:63]
v_cndmask_b32 v36, v16, v36, s[56:57]
v_cndmask_b32 v37, v16, v37, s[58:59]
v_cndmask_b32 v38, v16, v38, s[60:61]
v_cndmask_b32 v39, v16, v39, s[62:63]
v_max3_f32 v18, v32, v33, v34
v_max3_f32 v17, v28, v29, v30
v_max3_f32 v18, v18, v35, v36
v_max_f32 v17, v17, v31
v_max3_f32 v18, v18, v37, v38
v_max_f32 v18, v18, v39
s_waitcnt vmcnt(1)
att_j2_198:
s_branch att_loop_184
att_nopre_192:
s_waitcnt vmcnt(17)
s_add_u32 s49, s45, 1
v_cmp_gt_u32 vcc, s49, v24
s_nop 0
s_and_b32 vcc_lo, vcc_lo, 0x3f
s_cbranch_scc1 att_still_199
s_add_u32 s54, s46, 0
buffer_load_dwordx4 a[96:99], v8, s[4:7], s54 offen offset:0 sc1
buffer_load_dwordx4 a[100:103], v8, s[4:7], s54 offen offset:1024 sc1
buffer_load_dwordx4 a[104:107], v8, s[4:7], s54 offen offset:2048 sc1
buffer_load_dwordx4 a[108:111], v8, s[4:7], s54 offen offset:3072 sc1
s_add_u32 s54, s46, 4096
buffer_load_dwordx4 a[112:115], v8, s[4:7], s54 offen offset:0 sc1
buffer_load_dwordx4 a[116:119], v8, s[4:7], s54 offen offset:1024 sc1
buffer_load_dwordx4 a[120:123], v8, s[4:7], s54 offen offset:2048 sc1
buffer_load_dwordx4 a[124:127], v8, s[4:7], s54 offen offset:3072 sc1
s_add_u32 s54, s46, 8192
buffer_load_dwordx4 a[128:131], v8, s[4:7], s54 offen offset:0 sc1
buffer_load_dwordx4 a[132:135], v8, s[4:7], s54 offen offset:1024 sc1
buffer_load_dwordx4 a[136:139], v8, s[4:7], s54 offen offset:2048 sc1
buffer_load_dwordx4 a[140:143], v8, s[4:7], s54 offen offset:3072 sc1
s_waitcnt vmcnt(21)
buffer_store_dword v15, v23, s[4:7], s52 offen
buffer_store_dword v15, v22, s[4:7], s52 offen sc1
s_add_u32 s54, s46, 12288
buffer_load_dwordx4 a[144:147], v8, s[4:7], s54 offen offset:0 sc1
buffer_load_dwordx4 a[148:151], v8, s[4:7], s54 offen offset:1024 sc1
buffer_load_dwordx4 a[152:155], v8, s[4:7], s54 offen offset:2048 sc1
buffer_load_dwordx4 a[156:159], v8, s[4:7], s54 offen offset:3072 sc1
buffer_load_dwordx4 v[64:67], v9, s[4:7], s47 offen offset:0 sc1
buffer_load_dwordx4 v[68:71], v9, s[4:7], s47 offen offset:512 sc1
buffer_load_dwordx4 v[72:75], v9, s[4:7], s47 offen offset:1024 sc1
buffer_load_dwordx4 v[76:79], v9, s[4:7], s47 offen offset:1536 sc1
buffer_load_dwordx2 v[80:81], v10, s[4:7], s47 offen offset:0 sc1
buffer_load_dwordx2 v[82:83], v10, s[4:7], s47 offen offset:512 sc1
buffer_load_dwordx2 v[84:85], v10, s[4:7], s47 offen offset:1024 sc1
buffer_load_dwordx2 v[86:87], v10, s[4:7], s47 offen offset:1536 sc1
s_add_u32 s54, s46, 16384
buffer_load_dwordx4 a[160:163], v8, s[4:7], s54 offen offset:0 sc1
buffer_load_dwordx4 a[164:167], v8, s[4:7], s54 offen offset:1024 sc1
buffer_load_dwordx4 a[168:171], v8, s[4:7], s54 offen offset:2048 sc1
buffer_load_dwordx4 a[172:175], v8, s[4:7], s54 offen offset:3072 sc1
s_add_u32 s54, s46, 20480
buffer_load_dwordx4 a[176:179], v8, s[4:7], s54 offen offset:0 sc1
buffer_load_dwordx4 a[180:183], v8, s[4:7], s54 offen offset:1024 sc1
buffer_load_dwordx4 a[184:187], v8, s[4:7], s54 offen offset:2048 sc1
buffer_load_dwordx4 a[188:191], v8, s[4:7], s54 offen offset:3072 sc1
s_add_u32 s49, s45, 8
v_mov_b32 v125, s49
buffer_store_dword v125, v124, s[4:7], s52 offen sc1
s_waitcnt vmcnt(17)
v_mfma_f32_16x16x32_bf16 v[28:31], a[128:131], a[96:99], 0
v_mfma_f32_16x16x32_bf16 v[32:35], a[128:131], a[100:103], 0
v_mfma_f32_16x16x32_bf16 v[36:39], a[132:135], a[100:103], 0
v_mfma_f32_16x16x32_bf16 v[28:31], a[136:139], a[104:107], v[28:31]
v_mfma_f32_16x16x32_bf16 v[32:35], a[136:139], a[108:111], v[32:35]
v_mfma_f32_16x16x32_bf16 v[36:39], a[140:143], a[108:111], v[36:39]
v_mfma_f32_16x16x32_bf16 v[28:31], a[144:147], a[112:115], v[28:31]
v_mfma_f32_16x16x32_bf16 v[32:35], a[144:147], a[116:119], v[32:35]
v_mfma_f32_16x16x32_bf16 v[36:39], a[148:151], a[116:119], v[36:39]
v_mfma_f32_16x16x32_bf16 v[28:31], a[152:155], a[120:123], v[28:31]
v_mfma_f32_16x16x32_bf16 v[32:35], a[152:155], a[124:127], v[32:35]
v_mfma_f32_16x16x32_bf16 v[36:39], a[156:159], a[124:127], v[36:39]
s_add_u32 s53, s45, 1
s_nop 4
v_cndmask_b32 v28, v16, v28, s[56:57]
v_cndmask_b32 v29, v16, v29, s[58:59]
v_cndmask_b32 v30, v16, v30, s[60:61]
v_cndmask_b32 v31, v16, v31, s[62:63]
v_cndmask_b32 v36, v16, v36, s[56:57]
v_cndmask_b32 v37, v16, v37, s[58:59]
v_cndmask_b32 v38, v16, v38, s[60:61]
v_cndmask_b32 v39, v16, v39, s[62:63]
v_max3_f32 v18, v32, v33, v34
v_max3_f32 v17, v28, v29, v30
v_max3_f32 v18, v18, v35, v36
v_max_f32 v17, v17, v31
v_max3_f32 v18, v18, v37, v38
v_max_f32 v18, v18, v39
s_waitcnt vmcnt(1)
s_branch att_j2_193
att_still_199:
s_waitcnt vmcnt(0)
buffer_store_dword v15, v23, s[4:7], s52 offen
buffer_store_dword v15, v22, s[4:7], s52 offen sc1
s_cmp_ge_u32 s45, 64
s_cbranch_scc1 att_done_185
s_add_u32 s49, s45, 8
v_mov_b32 v125, s49
buffer_store_dword v125, v124, s[4:7], s52 offen sc1
s_add_u32 s49, s45, 1
s_mov_b32 s98, 0
sp_loop_200:
buffer_load_dword v24, v11, s[4:7], s52 offen sc1
s_add_u32 s98, s98, 1
s_cmp_gt_u32 s98, 150000
s_cbranch_scc1 sp_bad_202
s_waitcnt vmcnt(0)
v_cmp_gt_u32 vcc, s49, v24
s_nop 0
s_and_b32 vcc_lo, vcc_lo, 0x3f
s_cbranch_scc0 sp_ok_201
s_sleep 2
s_branch sp_loop_200
sp_bad_202:
s_mov_b32 s98, 1536
s_branch L_fail
sp_ok_201:
s_add_u32 s54, s46, 0
buffer_load_dwordx4 a[96:99], v8, s[4:7], s54 offen offset:0 sc1
buffer_load_dwordx4 a[100:103], v8, s[4:7], s54 offen offset:1024 sc1
buffer_load_dwordx4 a[104:107], v8, s[4:7], s54 offen offset:2048 sc1
buffer_load_dwordx4 a[108:111], v8, s[4:7], s54 offen offset:3072 sc1
s_add_u32 s54, s46, 4096
buffer_load_dwordx4 a[112:115], v8, s[4:7], s54 offen offset:0 sc1
buffer_load_dwordx4 a[116:119], v8, s[4:7], s54 offen offset:1024 sc1
buffer_load_dwordx4 a[120:123], v8, s[4:7], s54 offen offset:2048 sc1
buffer_load_dwordx4 a[124:127], v8, s[4:7], s54 offen offset:3072 sc1
s_add_u32 s54, s46, 8192
buffer_load_dwordx4 a[128:131], v8, s[4:7], s54 offen offset:0 sc1
buffer_load_dwordx4 a[132:135], v8, s[4:7], s54 offen offset:1024 sc1
buffer_load_dwordx4 a[136:139], v8, s[4:7], s54 offen offset:2048 sc1
buffer_load_dwordx4 a[140:143], v8, s[4:7], s54 offen offset:3072 sc1
s_add_u32 s54, s46, 12288
buffer_load_dwordx4 a[144:147], v8, s[4:7], s54 offen offset:0 sc1
buffer_load_dwordx4 a[148:151], v8, s[4:7], s54 offen offset:1024 sc1
buffer_load_dwordx4 a[152:155], v8, s[4:7], s54 offen offset:2048 sc1
buffer_load_dwordx4 a[156:159], v8, s[4:7], s54 offen offset:3072 sc1
buffer_load_dwordx4 v[64:67], v9, s[4:7], s47 offen offset:0 sc1
buffer_load_dwordx4 v[68:71], v9, s[4:7], s47 offen offset:512 sc1
buffer_load_dwordx4 v[72:75], v9, s[4:7], s47 offen offset:1024 sc1
buffer_load_dwordx4 v[76:79], v9, s[4:7], s47 offen offset:1536 sc1
buffer_load_dwordx2 v[80:81], v10, s[4:7], s47 offen offset:0 sc1
buffer_load_dwordx2 v[82:83], v10, s[4:7], s47 offen offset:512 sc1
buffer_load_dwordx2 v[84:85], v10, s[4:7], s47 offen offset:1024 sc1
buffer_load_dwordx2 v[86:87], v10, s[4:7], s47 offen offset:1536 sc1
s_add_u32 s54, s46, 16384
buffer_load_dwordx4 a[160:163], v8, s[4:7], s54 offen offset:0 sc1
buffer_load_dwordx4 a[164:167], v8, s[4:7], s54 offen offset:1024 sc1
buffer_load_dwordx4 a[168:171], v8, s[4:7], s54 offen offset:2048 sc1
buffer_load_dwordx4 a[172:175], v8, s[4:7], s54 offen offset:3072 sc1
s_add_u32 s54, s46, 20480
buffer_load_dwordx4 a[176:179], v8, s[4:7], s54 offen offset:0 sc1
buffer_load_dwordx4 a[180:183], v8, s[4:7], s54 offen offset:1024 sc1
buffer_load_dwordx4 a[184:187], v8, s[4:7], s54 offen offset:2048 sc1
buffer_load_dwordx4 a[188:191], v8, s[4:7], s54 offen offset:3072 sc1
s_waitcnt vmcnt(16)
v_mfma_f32_16x16x32_bf16 v[28:31], a[128:131], a[96:99], 0
v_mfma_f32_16x16x32_bf16 v[32:35], a[128:131], a[100:103], 0
v_mfma_f32_16x16x32_bf16 v[36:39], a[132:135], a[100:103], 0
v_mfma_f32_16x16x32_bf16 v[28:31], a[136:139], a[104:107], v[28:31]
v_mfma_f32_16x16x32_bf16 v[32:35], a[136:139], a[108:111], v[32:35]
v_mfma_f32_16x16x32_bf16 v[36:39], a[140:143], a[108:111], v[36:39]
v_mfma_f32_16x16x32_bf16 v[28:31], a[144:147], a[112:115], v[28:31]
v_mfma_f32_16x16x32_bf16 v[32:35], a[144:147], a[116:119], v[32:35]
v_mfma_f32_16x16x32_bf16 v[36:39], a[148:151], a[116:119], v[36:39]
v_mfma_f32_16x16x32_bf16 v[28:31], a[152:155], a[120:123], v[28:31]
v_mfma_f32_16x16x32_bf16 v[32:35], a[152:155], a[124:127], v[32:35]
v_mfma_f32_16x16x32_bf16 v[36:39], a[156:159], a[124:127], v[36:39]
s_add_u32 s53, s45, 1
s_nop 4
v_cndmask_b32 v28, v16, v28, s[56:57]
v_cndmask_b32 v29, v16, v29, s[58:59]
v_cndmask_b32 v30, v16, v30, s[60:61]
v_cndmask_b32 v31, v16, v31, s[62:63]
v_cndmask_b32 v36, v16, v36, s[56:57]
v_cndmask_b32 v37, v16, v37, s[58:59]
v_cndmask_b32 v38, v16, v38, s[60:61]
v_cndmask_b32 v39, v16, v39, s[62:63]
v_max3_f32 v18, v32, v33, v34
v_max3_f32 v17, v28, v29, v30
v_max3_f32 v18, v18, v35, v36
v_max_f32 v17, v17, v31
v_max3_f32 v18, v18, v37, v38
v_max_f32 v18, v18, v39
s_waitcnt vmcnt(0)
s_branch att_j2_193
att_nopre_197:
s_waitcnt vmcnt(17)
s_add_u32 s49, s45, 1
v_cmp_gt_u32 vcc, s49, v24
s_nop 0
s_and_b32 vcc_lo, vcc_lo, 0x3f
s_cbranch_scc1 att_still_203
s_add_u32 s54, s46, 0
buffer_load_dwordx4 a[0:3], v8, s[4:7], s54 offen offset:0 sc1
buffer_load_dwordx4 a[4:7], v8, s[4:7], s54 offen offset:1024 sc1
buffer_load_dwordx4 a[8:11], v8, s[4:7], s54 offen offset:2048 sc1
buffer_load_dwordx4 a[12:15], v8, s[4:7], s54 offen offset:3072 sc1
s_add_u32 s54, s46, 4096
buffer_load_dwordx4 a[16:19], v8, s[4:7], s54 offen offset:0 sc1
buffer_load_dwordx4 a[20:23], v8, s[4:7], s54 offen offset:1024 sc1
buffer_load_dwordx4 a[24:27], v8, s[4:7], s54 offen offset:2048 sc1
buffer_load_dwordx4 a[28:31], v8, s[4:7], s54 offen offset:3072 sc1
s_add_u32 s54, s46, 8192
buffer_load_dwordx4 a[32:35], v8, s[4:7], s54 offen offset:0 sc1
buffer_load_dwordx4 a[36:39], v8, s[4:7], s54 offen offset:1024 sc1
buffer_load_dwordx4 a[40:43], v8, s[4:7], s54 offen offset:2048 sc1
buffer_load_dwordx4 a[44:47], v8, s[4:7], s54 offen offset:3072 sc1
s_waitcnt vmcnt(21)
buffer_store_dword v15, v23, s[4:7], s52 offen
buffer_store_dword v15, v22, s[4:7], s52 offen sc1
s_add_u32 s54, s46, 12288
buffer_load_dwordx4 a[48:51], v8, s[4:7], s54 offen offset:0 sc1
buffer_load_dwordx4 a[52:55], v8, s[4:7], s54 offen offset:1024 sc1
buffer_load_dwordx4 a[56:59], v8, s[4:7], s54 offen offset:2048 sc1
buffer_load_dwordx4 a[60:63], v8, s[4:7], s54 offen offset:3072 sc1
buffer_load_dwordx4 v[64:67], v9, s[4:7], s47 offen offset:0 sc1
buffer_load_dwordx4 v[68:71], v9, s[4:7], s47 offen offset:512 sc1
buffer_load_dwordx4 v[72:75], v9, s[4:7], s47 offen offset:1024 sc1
buffer_load_dwordx4 v[76:79], v9, s[4:7], s47 offen offset:1536 sc1
buffer_load_dwordx2 v[80:81], v10, s[4:7], s47 offen offset:0 sc1
buffer_load_dwordx2 v[82:83], v10, s[4:7], s47 offen offset:512 sc1
buffer_load_dwordx2 v[84:85], v10, s[4:7], s47 offen offset:1024 sc1
buffer_load_dwordx2 v[86:87], v10, s[4:7], s47 offen offset:1536 sc1
s_add_u32 s54, s46, 16384
buffer_load_dwordx4 a[64:67], v8, s[4:7], s54 offen offset:0 sc1
buffer_load_dwordx4 a[68:71], v8, s[4:7], s54 offen offset:1024 sc1
buffer_load_dwordx4 a[72:75], v8, s[4:7], s54 offen offset:2048 sc1
buffer_load_dwordx4 a[76:79], v8, s[4:7], s54 offen offset:3072 sc1
s_add_u32 s54, s46, 20480
buffer_load_dwordx4 a[80:83], v8, s[4:7], s54 offen offset:0 sc1
buffer_load_dwordx4 a[84:87], v8, s[4:7], s54 offen offset:1024 sc1
buffer_load_dwordx4 a[88:91], v8, s[4:7], s54 offen offset:2048 sc1
buffer_load_dwordx4 a[92:95], v8, s[4:7], s54 offen offset:3072 sc1
s_add_u32 s49, s45, 8
v_mov_b32 v125, s49
buffer_store_dword v125, v124, s[4:7], s52 offen sc1
s_waitcnt vmcnt(17)
v_mfma_f32_16x16x32_bf16 v[28:31], a[32:35], a[0:3], 0
v_mfma_f32_16x16x32_bf16 v[32:35], a[32:35], a[4:7], 0
v_mfma_f32_16x16x32_bf16 v[36:39], a[36:39], a[4:7], 0
v_mfma_f32_16x16x32_bf16 v[28:31], a[40:43], a[8:11], v[28:31]
v_mfma_f32_16x16x32_bf16 v[32:35], a[40:43], a[12:15], v[32:35]
v_mfma_f32_16x16x32_bf16 v[36:39], a[44:47], a[12:15], v[36:39]
v_mfma_f32_16x16x32_bf16 v[28:31], a[48:51], a[16:19], v[28:31]
v_mfma_f32_16x16x32_bf16 v[32:35], a[48:51], a[20:23], v[32:35]
v_mfma_f32_16x16x32_bf16 v[36:39], a[52:55], a[20:23], v[36:39]
v_mfma_f32_16x16x32_bf16 v[28:31], a[56:59], a[24:27], v[28:31]
v_mfma_f32_16x16x32_bf16 v[32:35], a[56:59], a[28:31], v[32:35]
v_mfma_f32_16x16x32_bf16 v[36:39], a[60:63], a[28:31], v[36:39]
s_add_u32 s53, s45, 1
s_nop 4
v_cndmask_b32 v28, v16, v28, s[56:57]
v_cndmask_b32 v29, v16, v29, s[58:59]
v_cndmask_b32 v30, v16, v30, s[60:61]
v_cndmask_b32 v31, v16, v31, s[62:63]
v_cndmask_b32 v36, v16, v36, s[56:57]
v_cndmask_b32 v37, v16, v37, s[58:59]
v_cndmask_b32 v38, v16, v38, s[60:61]
v_cndmask_b32 v39, v16, v39, s[62:63]
v_max3_f32 v18, v32, v33, v34
v_max3_f32 v17, v28, v29, v30
v_max3_f32 v18, v18, v35, v36
v_max_f32 v17, v17, v31
v_max3_f32 v18, v18, v37, v38
v_max_f32 v18, v18, v39
s_waitcnt vmcnt(1)
s_branch att_j2_198
att_still_203:
s_waitcnt vmcnt(0)
buffer_store_dword v15, v23, s[4:7], s52 offen
buffer_store_dword v15, v22, s[4:7], s52 offen sc1
s_cmp_ge_u32 s45, 64
s_cbranch_scc1 att_done_185
s_add_u32 s49, s45, 8
v_mov_b32 v125, s49
buffer_store_dword v125, v124, s[4:7], s52 offen sc1
s_add_u32 s49, s45, 1
s_mov_b32 s98, 0
sp_loop_204:
buffer_load_dword v24, v11, s[4:7], s52 offen sc1
s_add_u32 s98, s98, 1
s_cmp_gt_u32 s98, 150000
s_cbranch_scc1 sp_bad_206
s_waitcnt vmcnt(0)
v_cmp_gt_u32 vcc, s49, v24
s_nop 0
s_and_b32 vcc_lo, vcc_lo, 0x3f
s_cbranch_scc0 sp_ok_205
s_sleep 2
s_branch sp_loop_204
sp_bad_206:
s_mov_b32 s98, 1536
s_branch L_fail
sp_ok_205:
s_add_u32 s54, s46, 0
buffer_load_dwordx4 a[0:3], v8, s[4:7], s54 offen offset:0 sc1
buffer_load_dwordx4 a[4:7], v8, s[4:7], s54 offen offset:1024 sc1
buffer_load_dwordx4 a[8:11], v8, s[4:7], s54 offen offset:2048 sc1
buffer_load_dwordx4 a[12:15], v8, s[4:7], s54 offen offset:3072 sc1
s_add_u32 s54, s46, 4096
buffer_load_dwordx4 a[16:19], v8, s[4:7], s54 offen offset:0 sc1
buffer_load_dwordx4 a[20:23], v8, s[4:7], s54 offen offset:1024 sc1
buffer_load_dwordx4 a[24:27], v8, s[4:7], s54 offen offset:2048 sc1
buffer_load_dwordx4 a[28:31], v8, s[4:7], s54 offen offset:3072 sc1
s_add_u32 s54, s46, 8192
buffer_load_dwordx4 a[32:35], v8, s[4:7], s54 offen offset:0 sc1
buffer_load_dwordx4 a[36:39], v8, s[4:7], s54 offen offset:1024 sc1
buffer_load_dwordx4 a[40:43], v8, s[4:7], s54 offen offset:2048 sc1
buffer_load_dwordx4 a[44:47], v8, s[4:7], s54 offen offset:3072 sc1
s_add_u32 s54, s46, 12288
buffer_load_dwordx4 a[48:51], v8, s[4:7], s54 offen offset:0 sc1
buffer_load_dwordx4 a[52:55], v8, s[4:7], s54 offen offset:1024 sc1
buffer_load_dwordx4 a[56:59], v8, s[4:7], s54 offen offset:2048 sc1
buffer_load_dwordx4 a[60:63], v8, s[4:7], s54 offen offset:3072 sc1
buffer_load_dwordx4 v[64:67], v9, s[4:7], s47 offen offset:0 sc1
buffer_load_dwordx4 v[68:71], v9, s[4:7], s47 offen offset:512 sc1
buffer_load_dwordx4 v[72:75], v9, s[4:7], s47 offen offset:1024 sc1
buffer_load_dwordx4 v[76:79], v9, s[4:7], s47 offen offset:1536 sc1
buffer_load_dwordx2 v[80:81], v10, s[4:7], s47 offen offset:0 sc1
buffer_load_dwordx2 v[82:83], v10, s[4:7], s47 offen offset:512 sc1
buffer_load_dwordx2 v[84:85], v10, s[4:7], s47 offen offset:1024 sc1
buffer_load_dwordx2 v[86:87], v10, s[4:7], s47 offen offset:1536 sc1
s_add_u32 s54, s46, 16384
buffer_load_dwordx4 a[64:67], v8, s[4:7], s54 offen offset:0 sc1
buffer_load_dwordx4 a[68:71], v8, s[4:7], s54 offen offset:1024 sc1
buffer_load_dwordx4 a[72:75], v8, s[4:7], s54 offen offset:2048 sc1
buffer_load_dwordx4 a[76:79], v8, s[4:7], s54 offen offset:3072 sc1
s_add_u32 s54, s46, 20480
buffer_load_dwordx4 a[80:83], v8, s[4:7], s54 offen offset:0 sc1
buffer_load_dwordx4 a[84:87], v8, s[4:7], s54 offen offset:1024 sc1
buffer_load_dwordx4 a[88:91], v8, s[4:7], s54 offen offset:2048 sc1
buffer_load_dwordx4 a[92:95], v8, s[4:7], s54 offen offset:3072 sc1
s_waitcnt vmcnt(16)
v_mfma_f32_16x16x32_bf16 v[28:31], a[32:35], a[0:3], 0
v_mfma_f32_16x16x32_bf16 v[32:35], a[32:35], a[4:7], 0
v_mfma_f32_16x16x32_bf16 v[36:39], a[36:39], a[4:7], 0
v_mfma_f32_16x16x32_bf16 v[28:31], a[40:43], a[8:11], v[28:31]
v_mfma_f32_16x16x32_bf16 v[32:35], a[40:43], a[12:15], v[32:35]
v_mfma_f32_16x16x32_bf16 v[36:39], a[44:47], a[12:15], v[36:39]
v_mfma_f32_16x16x32_bf16 v[28:31], a[48:51], a[16:19], v[28:31]
v_mfma_f32_16x16x32_bf16 v[32:35], a[48:51], a[20:23], v[32:35]
v_mfma_f32_16x16x32_bf16 v[36:39], a[52:55], a[20:23], v[36:39]
v_mfma_f32_16x16x32_bf16 v[28:31], a[56:59], a[24:27], v[28:31]
v_mfma_f32_16x16x32_bf16 v[32:35], a[56:59], a[28:31], v[32:35]
v_mfma_f32_16x16x32_bf16 v[36:39], a[60:63], a[28:31], v[36:39]
s_add_u32 s53, s45, 1
s_nop 4
v_cndmask_b32 v28, v16, v28, s[56:57]
v_cndmask_b32 v29, v16, v29, s[58:59]
v_cndmask_b32 v30, v16, v30, s[60:61]
v_cndmask_b32 v31, v16, v31, s[62:63]
v_cndmask_b32 v36, v16, v36, s[56:57]
v_cndmask_b32 v37, v16, v37, s[58:59]
v_cndmask_b32 v38, v16, v38, s[60:61]
v_cndmask_b32 v39, v16, v39, s[62:63]
v_max3_f32 v18, v32, v33, v34
v_max3_f32 v17, v28, v29, v30
v_max3_f32 v18, v18, v35, v36
v_max_f32 v17, v17, v31
v_max3_f32 v18, v18, v37, v38
v_max_f32 v18, v18, v39
s_waitcnt vmcnt(0)
s_branch att_j2_198
att_done_185:
s_endpgm
H_red:
s_mov_b32 s44, s74
s_cmp_lg_u32 s44, 0
s_cbranch_scc1 nozero_207
s_lshl_b32 s46, s3, 15
s_add_u32 s46, s46, 0
v_lshlrev_b32 v2, 4, v0
v_mov_b64 v[4:5], 0
v_mov_b64 v[6:7], 0
buffer_store_dwordx4 v[4:7], v2, s[4:7], s46 offen offset:0 sc1
buffer_store_dwordx4 v[4:7], v2, s[4:7], s46 offen offset:1024 sc1
buffer_store_dwordx4 v[4:7], v2, s[4:7], s46 offen offset:2048 sc1
buffer_store_dwordx4 v[4:7], v2, s[4:7], s46 offen offset:3072 sc1
s_add_u32 s46, s46, 4096
buffer_store_dwordx4 v[4:7], v2, s[4:7], s46 offen offset:0 sc1
buffer_store_dwordx4 v[4:7], v2, s[4:7], s46 offen offset:1024 sc1
buffer_store_dwordx4 v[4:7], v2, s[4:7], s46 offen offset:2048 sc1
buffer_store_dwordx4 v[4:7], v2, s[4:7], s46 offen offset:3072 sc1
s_add_u32 s46, s46, 4096
buffer_store_dwordx4 v[4:7], v2, s[4:7], s46 offen offset:0 sc1
buffer_store_dwordx4 v[4:7], v2, s[4:7], s46 offen offset:1024 sc1
buffer_store_dwordx4 v[4:7], v2, s[4:7], s46 offen offset:2048 sc1
buffer_store_dwordx4 v[4:7], v2, s[4:7], s46 offen offset:3072 sc1
s_add_u32 s46, s46, 4096
buffer_store_dwordx4 v[4:7], v2, s[4:7], s46 offen offset:0 sc1
buffer_store_dwordx4 v[4:7], v2, s[4:7], s46 offen offset:1024 sc1
buffer_store_dwordx4 v[4:7], v2, s[4:7], s46 offen offset:2048 sc1
buffer_store_dwordx4 v[4:7], v2, s[4:7], s46 offen offset:3072 sc1
s_add_u32 s46, s46, 4096
buffer_store_dwordx4 v[4:7], v2, s[4:7], s46 offen offset:0 sc1
buffer_store_dwordx4 v[4:7], v2, s[4:7], s46 offen offset:1024 sc1
buffer_store_dwordx4 v[4:7], v2, s[4:7], s46 offen offset:2048 sc1
buffer_store_dwordx4 v[4:7], v2, s[4:7], s46 offen offset:3072 sc1
s_add_u32 s46, s46, 4096
buffer_store_dwordx4 v[4:7], v2, s[4:7], s46 offen offset:0 sc1
buffer_store_dwordx4 v[4:7], v2, s[4:7], s46 offen offset:1024 sc1
buffer_store_dwordx4 v[4:7], v2, s[4:7], s46 offen offset:2048 sc1
buffer_store_dwordx4 v[4:7], v2, s[4:7], s46 offen offset:3072 sc1
s_add_u32 s46, s46, 4096
buffer_store_dwordx4 v[4:7], v2, s[4:7], s46 offen offset:0 sc1
buffer_store_dwordx4 v[4:7], v2, s[4:7], s46 offen offset:1024 sc1
buffer_store_dwordx4 v[4:7], v2, s[4:7], s46 offen offset:2048 sc1
buffer_store_dwordx4 v[4:7], v2, s[4:7], s46 offen offset:3072 sc1
s_add_u32 s46, s46, 4096
buffer_store_dwordx4 v[4:7], v2, s[4:7], s46 offen offset:0 sc1
buffer_store_dwordx4 v[4:7], v2, s[4:7], s46 offen offset:1024 sc1
buffer_store_dwordx4 v[4:7], v2, s[4:7], s46 offen offset:2048 sc1
buffer_store_dwordx4 v[4:7], v2, s[4:7], s46 offen offset:3072 sc1
s_add_u32 s46, s46, 4096
s_waitcnt vmcnt(0)
s_barrier
s_cmp_lg_u32 s3, 0
s_cbranch_scc1 nozero_207
s_mov_b32 s12, s40
s_and_b32 s13, s41, 0xffff
s_mov_b32 s14, 256
s_mov_b32 s15, 0x20000
v_mov_b32 v2, 32
v_mov_b32 v3, 192
s_mov_b64 exec, 1
buffer_store_dword v2, v3, s[12:15], 0 offen sc1
s_mov_b64 exec, -1
nozero_207:
v_and_b32 v1, 15, v0
v_lshrrev_b32 v2, 4, v0
v_and_b32 v3, 1, v0
v_bfe_u32 v4, v0, 1, 3
v_bfe_u32 v5, v0, 4, 1
v_lshrrev_b32 v6, 5, v0
s_mul_i32 s46, s44, 2304
v_mul_u32_u24 v7, 36864, v2
v_lshl_add_u32 v7, v1, 4, v7
v_add_u32 v8, s46, v7
v_lshlrev_b32 v7, 9, v5
v_lshl_add_u32 v7, v6, 8, v7
v_lshl_add_u32 v7, v1, 4, v7
v_add_u32 v10, s46, v7
v_lshlrev_b32 v7, 4, v1
v_lshl_add_u32 v7, v5, 3, v7
v_add_u32 v11, s46, v7
v_mul_u32_u24 v7, 1152, v3
v_lshl_add_u32 v7, v4, 4, v7
v_add_u32 v7, s46, v7
v_lshl_add_u32 v13, v5, 3, v7
v_lshl_add_u32 v9, v6, 7, v13
v_lshl_add_u32 v7, v6, 7, v7
v_lshl_add_u32 v12, v5, 8, v7
v_lshlrev_b32 v7, 4, v3
v_mov_b32 v22, 0x3f80
v_lshlrev_b32 v7, v7, v22
v_cmp_eq_u32 vcc, 0, v4
s_nop 1
v_cndmask_b32 v28, 0, v7, vcc
v_cmp_eq_u32 vcc, 1, v4
s_nop 1
v_cndmask_b32 v29, 0, v7, vcc
v_cmp_eq_u32 vcc, 2, v4
s_nop 1
v_cndmask_b32 v30, 0, v7, vcc
v_cmp_eq_u32 vcc, 3, v4
s_nop 1
v_cndmask_b32 v31, 0, v7, vcc
v_cmp_eq_u32 vcc, 4, v4
s_nop 1
v_cndmask_b32 v32, 0, v7, vcc
v_cmp_eq_u32 vcc, 5, v4
s_nop 1
v_cndmask_b32 v33, 0, v7, vcc
v_cmp_eq_u32 vcc, 6, v4
s_nop 1
v_cndmask_b32 v34, 0, v7, vcc
v_cmp_eq_u32 vcc, 7, v4
s_nop 1
v_cndmask_b32 v35, 0, v7, vcc
s_mul_i32 s46, s44, 128
v_mov_b32 v1, s46
v_mov_b32 v22, 2147483632
v_cmp_eq_u32 vcc, 0, v0
s_nop 1
v_cndmask_b32 v36, v22, v1, vcc
v_add_u32 v37, 65536, v36
v_lshlrev_b32 v1, 2, v0
v_add_u32 v1, 147456, v1
v_mov_b32 v2, 0
ds_write_b32 v1, v2
v_mov_b32 v14, 147460
s_mov_b32 s8, s20
s_and_b32 s9, s21, 0xffff
s_mov_b32 s10, 2359296
s_mov_b32 s11, 0x20000
s_mov_b32 s16, s38
s_and_b32 s17, s39, 0xffff
s_mov_b32 s18, 2359296
s_mov_b32 s19, 0x20000
s_mov_b32 s45, s3
s_mov_b32 s52, 1384448
s_mov_b32 s50, 0
s_mul_i32 s47, s45, 36864
buffer_load_dwordx2 v[60:61], v9, s[8:11], s47 offen offset:0
buffer_load_dwordx2 v[62:63], v9, s[8:11], s47 offen offset:256
buffer_load_dwordx2 v[64:65], v9, s[8:11], s47 offen offset:512
buffer_load_dwordx2 v[66:67], v9, s[8:11], s47 offen offset:768
v_mov_b64 v[68:69], 0
s_mov_b64 exec, 0xffffffff
buffer_load_dwordx2 v[68:69], v9, s[8:11], s47 offen offset:1024
s_mov_b64 exec, -1
s_waitcnt lgkmcnt(0)
s_barrier
s_mov_b32 s12, s40
s_and_b32 s13, s41, 0xffff
s_mov_b32 s14, 256
s_mov_b32 s15, 0x20000
v_lshlrev_b32 v17, 2, v0
v_add_u32 v18, 128, v17
v_cmp_le_u32 vcc, 2, v0
s_nop 1
v_cndmask_b32 v17, v17, v18, vcc
v_mov_b32 v18, 192
v_cmp_eq_u32 vcc, 8, v0
s_nop 1
v_cndmask_b32 v17, v17, v18, vcc
v_mov_b32 v18, 2147483632
v_cmp_lt_u32 vcc, 8, v0
s_nop 1
v_cndmask_b32 v17, v17, v18, vcc
s_mov_b32 s98, 0
wi_loop_208:
buffer_load_dword v18, v17, s[12:15], 0 offen sc1
s_add_u32 s98, s98, 1
s_cmp_gt_u32 s98, 150000
s_cbranch_scc1 wi_bad_210
s_waitcnt vmcnt(0)
v_cmp_eq_u32 vcc, 32, v18
s_nop 0
s_and_b32 s97, vcc_lo, 0x1ff
s_cmp_eq_u32 s97, 0x1ff
s_cbranch_scc1 wi_ok_209
v_cmp_lt_u32 vcc, 32, v18
s_nop 0
s_and_b32 s96, vcc_lo, 0xff
s_cselect_b32 s96, 0x100, 0
s_and_b32 s96, s96, s97
s_cbranch_scc1 wi_over_211
s_sleep 8
s_branch wi_loop_208
wi_bad_210:
s_mov_b32 s98, 512
s_branch L_fail
wi_over_211:
s_mov_b32 s100, 255
wi_ok_209:
ln0_212:
v_lshlrev_b32 v40, 16, v60
v_and_b32 v41, 0xffff0000, v60
v_lshlrev_b32 v42, 16, v61
v_and_b32 v43, 0xffff0000, v61
v_lshlrev_b32 v44, 16, v62
v_and_b32 v45, 0xffff0000, v62
v_lshlrev_b32 v46, 16, v63
v_and_b32 v47, 0xffff0000, v63
v_lshlrev_b32 v48, 16, v64
v_and_b32 v49, 0xffff0000, v64
v_lshlrev_b32 v50, 16, v65
v_and_b32 v51, 0xffff0000, v65
v_lshlrev_b32 v52, 16, v66
v_and_b32 v53, 0xffff0000, v66
v_lshlrev_b32 v54, 16, v67
v_and_b32 v55, 0xffff0000, v67
v_lshlrev_b32 v56, 16, v68
v_and_b32 v57, 0xffff0000, v68
v_lshlrev_b32 v58, 16, v69
v_and_b32 v59, 0xffff0000, v69
v_mul_f32 v20, v40, v40
v_add_f32 v19, v40, v41
v_fmac_f32 v20, v41, v41
v_add_f32 v19, v19, v42
v_fmac_f32 v20, v42, v42
v_add_f32 v19, v19, v43
v_fmac_f32 v20, v43, v43
v_add_f32 v19, v19, v44
v_fmac_f32 v20, v44, v44
v_add_f32 v19, v19, v45
v_fmac_f32 v20, v45, v45
v_add_f32 v19, v19, v46
v_fmac_f32 v20, v46, v46
v_add_f32 v19, v19, v47
v_fmac_f32 v20, v47, v47
v_add_f32 v19, v19, v48
v_fmac_f32 v20, v48, v48
v_add_f32 v19, v19, v49
v_fmac_f32 v20, v49, v49
v_add_f32 v19, v19, v50
v_fmac_f32 v20, v50, v50
v_add_f32 v19, v19, v51
v_fmac_f32 v20, v51, v51
v_add_f32 v19, v19, v52
v_fmac_f32 v20, v52, v52
v_add_f32 v19, v19, v53
v_fmac_f32 v20, v53, v53
v_add_f32 v19, v19, v54
v_fmac_f32 v20, v54, v54
v_add_f32 v19, v19, v55
v_fmac_f32 v20, v55, v55
v_add_f32 v19, v19, v56
v_fmac_f32 v20, v56, v56
v_add_f32 v19, v19, v57
v_fmac_f32 v20, v57, v57
v_add_f32 v19, v19, v58
v_fmac_f32 v20, v58, v58
v_add_f32 v19, v19, v59
v_fmac_f32 v20, v59, v59
s_mul_i32 s47, s45, 36864
s_add_u32 s47, s47, s52
v_permlane32_swap_b32 v19, v20
v_add_f32 v19, v19, v20
v_mov_b32 v21, v19
s_nop 1
v_permlane16_swap_b32 v19, v21
v_add_f32 v19, v19, v21
s_nop 1
v_add_f32_dpp v19, v19, v19 quad_perm:[2,3,0,1] row_mask:0xf bank_mask:0xf
s_nop 1
v_add_f32_dpp v19, v19, v19 row_ror:4 row_mask:0xf bank_mask:0xf
s_nop 1
v_add_f32_dpp v19, v19, v19 row_ror:8 row_mask:0xf bank_mask:0xf
v_mul_f32 v19, 0x3ae38e39, v19
v_mov_b32 v20, v19
s_nop 1
v_permlane32_swap_b32 v19, v20
v_fma_f32 v20, -v19, v19, v20
v_max_f32 v20, 0, v20
v_add_f32 v20, 0x3727c5ac, v20
v_rsq_f32 v20, v20
s_nop 0
v_mul_f32 v19, v19, v20
v_fma_f32 v40, v40, v20, -v19
v_fma_f32 v41, v41, v20, -v19
v_fma_f32 v42, v42, v20, -v19
v_fma_f32 v43, v43, v20, -v19
v_fma_f32 v44, v44, v20, -v19
v_fma_f32 v45, v45, v20, -v19
v_fma_f32 v46, v46, v20, -v19
v_fma_f32 v47, v47, v20, -v19
v_fma_f32 v48, v48, v20, -v19
v_fma_f32 v49, v49, v20, -v19
v_fma_f32 v50, v50, v20, -v19
v_fma_f32 v51, v51, v20, -v19
v_fma_f32 v52, v52, v20, -v19
v_fma_f32 v53, v53, v20, -v19
v_fma_f32 v54, v54, v20, -v19
v_fma_f32 v55, v55, v20, -v19
v_fma_f32 v56, v56, v20, -v19
v_fma_f32 v57, v57, v20, -v19
v_fma_f32 v58, v58, v20, -v19
v_fma_f32 v59, v59, v20, -v19
v_cvt_pk_bf16_f32 v72, v40, v41
v_cvt_pk_bf16_f32 v74, v44, v45
v_cvt_pk_bf16_f32 v73, v42, v43
v_cvt_pk_bf16_f32 v75, v46, v47
v_permlane16_swap_b32 v72, v74
s_nop 0
v_permlane16_swap_b32 v73, v75
buffer_store_dwordx4 v[72:75], v10, s[4:7], s47 offen offset:0 sc1
v_cvt_pk_bf16_f32 v76, v48, v49
v_cvt_pk_bf16_f32 v78, v52, v53
v_cvt_pk_bf16_f32 v77, v50, v51
v_cvt_pk_bf16_f32 v79, v54, v55
v_permlane16_swap_b32 v76, v78
s_nop 0
v_permlane16_swap_b32 v77, v79
buffer_store_dwordx4 v[76:79], v10, s[4:7], s47 offen offset:1024 sc1
v_cvt_pk_bf16_f32 v80, v56, v57
v_cvt_pk_bf16_f32 v81, v58, v59
s_mov_b64 exec, 0xffffffff
buffer_store_dwordx2 v[80:81], v11, s[4:7], s47 offen offset:2048 sc1
s_mov_b64 exec, -1
s_add_u32 s45, s45, 4
s_cmp_ge_u32 s45, 64
s_cbranch_scc1 ln0_done_213
s_mul_i32 s47, s45, 36864
buffer_load_dwordx2 v[60:61], v9, s[8:11], s47 offen offset:0
buffer_load_dwordx2 v[62:63], v9, s[8:11], s47 offen offset:256
buffer_load_dwordx2 v[64:65], v9, s[8:11], s47 offen offset:512
buffer_load_dwordx2 v[66:67], v9, s[8:11], s47 offen offset:768
v_mov_b64 v[68:69], 0
s_mov_b64 exec, 0xffffffff
buffer_load_dwordx2 v[68:69], v9, s[8:11], s47 offen offset:1024
s_mov_b64 exec, -1
s_waitcnt vmcnt(0)
v_mov_b32 v17, 1
s_mov_b64 exec, 1
ds_add_rtn_u32 v17, v14, v17
s_mov_b64 exec, -1
s_andn2_b32 s48, s45, 3
s_waitcnt lgkmcnt(0)
v_readfirstlane_b32 s47, v17
v_mov_b32 v18, s48
s_and_b32 s47, s47, 3
s_cmp_lg_u32 s47, 3
s_cbranch_scc1 nolast_214
buffer_store_dword v18, v36, s[4:7], s50 offen sc1
buffer_store_dword v18, v37, s[4:7], s50 offen
nolast_214:
v_add_u32 v14, 4, v14
s_branch ln0_212
ln0_done_213:
s_waitcnt vmcnt(0)
v_mov_b32 v17, 1
s_mov_b64 exec, 1
ds_add_rtn_u32 v17, v14, v17
s_mov_b64 exec, -1
s_andn2_b32 s48, s45, 3
s_waitcnt lgkmcnt(0)
v_readfirstlane_b32 s47, v17
v_mov_b32 v18, s48
s_and_b32 s47, s47, 3
s_cmp_lg_u32 s47, 3
s_cbranch_scc1 nolast_215
buffer_store_dword v18, v36, s[4:7], s50 offen sc1
buffer_store_dword v18, v37, s[4:7], s50 offen
nolast_215:
v_add_u32 v14, 4, v14
s_mov_b32 s99, 100
s_and_b32 s47, s3, 1
s_mul_i32 s51, s47, 18874368
s_add_u32 s51, s51, 199565312
s_mul_i32 s47, s47, 11264
s_add_u32 s47, s47, 18432
v_mul_u32_u24 v1, 128, v0
v_add_u32 v1, s47, v1
v_mov_b32 v7, 2147483632
v_cmp_gt_u32 vcc, 24, v0
s_nop 1
v_cndmask_b32 v15, v7, v1, vcc
s_getpc_b64 s[96:97]
pc_216:
s_add_u32 s96, s96, L_writers-pc_216
s_addc_u32 s97, s97, 0
v_subrev_u32 v2, 0, v15
v_lshrrev_b32 v2, 7, v2
v_cmp_gt_u32 vcc, 0x200, v2
s_nop 1
v_cndmask_b32 v2, 0, v2, vcc
global_load_ubyte v2, v2, s[96:97]
s_waitcnt vmcnt(0)
v_add_u32 v3, 65536, v15
v_cmp_eq_u32 vcc, s100, v2
s_nop 1
v_cndmask_b32 v15, v15, v3, vcc
s_lshr_b32 s47, s3, 1
s_mul_i32 s49, s47, 32768
s_mov_b32 s52, 6103040
s_mov_b32 s50, 21504
s_cmp_eq_u32 s3, 1
s_cselect_b32 s52, 3743744, s52
s_cselect_b32 s50, 32768, s50
s_cmp_eq_u32 s3, 2
s_cselect_b32 s52, 8462336, s52
s_cselect_b32 s50, 54272, s50
s_mov_b32 s45, 0
v_mov_b32 v16, 2147483632
s_cmp_eq_u32 s3, 3
s_cbranch_scc1 red_fin_218
s_cmp_lg_u32 s3, 0
s_cbranch_scc1 red_mid_217
red_loop_219:
s_add_u32 s48, s45, 1
s_mov_b32 s98, 0
grd_222:
v_mov_b32 v1, 147456
ds_read_b32 v2, v1
s_waitcnt lgkmcnt(0)
v_readfirstlane_b32 s47, v2
s_nop 0
s_add_u32 s47, s47, 32
s_cmp_gt_u32 s47, s45
s_cbranch_scc1 grd_ok_223
s_add_u32 s98, s98, 1
s_cmp_gt_u32 s98, 600000
s_cbranch_scc1 grd_bad_224
s_sleep 2
s_branch grd_222
grd_bad_224:
s_mov_b32 s98, 1280
s_branch L_fail
grd_ok_223:
s_mov_b32 s98, 0
sp_loop_225:
buffer_load_dword v24, v15, s[4:7], s49 offen sc1
s_add_u32 s98, s98, 1
s_cmp_gt_u32 s98, 150000
s_cbranch_scc1 sp_bad_227
s_waitcnt vmcnt(0)
v_cmp_gt_u32 vcc, s48, v24
s_nop 0
s_and_b32 vcc_lo, vcc_lo, 0xffffff
s_cbranch_scc0 sp_ok_226
s_sleep 2
s_branch sp_loop_225
sp_bad_227:
s_mov_b32 s98, 1281
s_branch L_fail
sp_ok_226:
s_mul_i32 s47, s45, 36864
buffer_load_dwordx2 v[60:61], v9, s[8:11], s47 offen offset:0
buffer_load_dwordx2 v[62:63], v9, s[8:11], s47 offen offset:256
buffer_load_dwordx2 v[64:65], v9, s[8:11], s47 offen offset:512
buffer_load_dwordx2 v[66:67], v9, s[8:11], s47 offen offset:768
v_mov_b64 v[68:69], 0
s_mov_b64 exec, 0xffffffff
buffer_load_dwordx2 v[68:69], v9, s[8:11], s47 offen offset:1024
s_mov_b64 exec, -1
s_mul_i32 s47, s45, 294912
s_add_u32 s47, s47, s51
s_add_u32 s46, s47, 147456
buffer_load_dwordx4 v[96:99], v8, s[4:7], s47 offen offset:0 sc1
buffer_load_dwordx4 v[100:103], v8, s[4:7], s46 offen offset:0 sc1
buffer_load_dwordx4 v[104:107], v8, s[4:7], s47 offen offset:256 sc1
buffer_load_dwordx4 v[108:111], v8, s[4:7], s46 offen offset:256 sc1
buffer_load_dwordx4 v[112:115], v8, s[4:7], s47 offen offset:512 sc1
buffer_load_dwordx4 v[116:119], v8, s[4:7], s46 offen offset:512 sc1
buffer_load_dwordx4 v[120:123], v8, s[4:7], s47 offen offset:768 sc1
buffer_load_dwordx4 v[124:127], v8, s[4:7], s46 offen offset:768 sc1
buffer_load_dwordx4 v[128:131], v8, s[4:7], s47 offen offset:1024 sc1
buffer_load_dwordx4 v[132:135], v8, s[4:7], s46 offen offset:1024 sc1
buffer_load_dwordx4 v[136:139], v8, s[4:7], s47 offen offset:1280 sc1
buffer_load_dwordx4 v[140:143], v8, s[4:7], s46 offen offset:1280 sc1
buffer_load_dwordx4 v[144:147], v8, s[4:7], s47 offen offset:1536 sc1
buffer_load_dwordx4 v[148:151], v8, s[4:7], s46 offen offset:1536 sc1
buffer_load_dwordx4 v[152:155], v8, s[4:7], s47 offen offset:1792 sc1
buffer_load_dwordx4 v[156:159], v8, s[4:7], s46 offen offset:1792 sc1
buffer_load_dwordx4 v[160:163], v8, s[4:7], s47 offen offset:2048 sc1
buffer_load_dwordx4 v[164:167], v8, s[4:7], s46 offen offset:2048 sc1
buffer_store_dword v18, v16, s[4:7], 0 offen
buffer_store_dword v18, v16, s[4:7], 0 offen
red_have_220:
buffer_load_dword v24, v15, s[4:7], s49 offen sc1
s_and_b32 s47, s45, 31
s_mul_i32 s47, s47, 4608
v_lshlrev_b32 v14, 4, v0
v_add_u32 v14, s47, v14
s_waitcnt vmcnt(21)
v_lshlrev_b32 v40, 16, v60
v_and_b32 v41, 0xffff0000, v60
v_lshlrev_b32 v42, 16, v61
v_and_b32 v43, 0xffff0000, v61
v_lshlrev_b32 v44, 16, v62
v_and_b32 v45, 0xffff0000, v62
v_lshlrev_b32 v46, 16, v63
v_and_b32 v47, 0xffff0000, v63
v_lshlrev_b32 v48, 16, v64
v_and_b32 v49, 0xffff0000, v64
v_lshlrev_b32 v50, 16, v65
v_and_b32 v51, 0xffff0000, v65
v_lshlrev_b32 v52, 16, v66
v_and_b32 v53, 0xffff0000, v66
v_lshlrev_b32 v54, 16, v67
v_and_b32 v55, 0xffff0000, v67
v_lshlrev_b32 v56, 16, v68
v_and_b32 v57, 0xffff0000, v68
v_lshlrev_b32 v58, 16, v69
v_and_b32 v59, 0xffff0000, v69
s_waitcnt vmcnt(20)
v_mfma_f32_16x16x32_bf16 v[40:43], v[28:31], v[96:99], v[40:43]
s_waitcnt vmcnt(19)
v_mfma_f32_16x16x32_bf16 v[40:43], v[28:31], v[100:103], v[40:43]
s_waitcnt vmcnt(18)
v_mfma_f32_16x16x32_bf16 v[40:43], v[32:35], v[104:107], v[40:43]
s_waitcnt vmcnt(17)
v_mfma_f32_16x16x32_bf16 v[40:43], v[32:35], v[108:111], v[40:43]
s_waitcnt vmcnt(16)
v_mfma_f32_16x16x32_bf16 v[44:47], v[28:31], v[112:115], v[44:47]
s_waitcnt vmcnt(15)
v_mfma_f32_16x16x32_bf16 v[44:47], v[28:31], v[116:119], v[44:47]
s_nop 3
ds_write_b128 v14, v[40:43] offset:0
v_mul_f32 v20, v40, v40
v_add_f32 v19, v40, v41
v_fmac_f32 v20, v41, v41
v_add_f32 v19, v19, v42
v_fmac_f32 v20, v42, v42
v_add_f32 v19, v19, v43
v_fmac_f32 v20, v43, v43
s_waitcnt vmcnt(14)
v_mfma_f32_16x16x32_bf16 v[44:47], v[32:35], v[120:123], v[44:47]
s_waitcnt vmcnt(13)
v_mfma_f32_16x16x32_bf16 v[44:47], v[32:35], v[124:127], v[44:47]
s_waitcnt vmcnt(12)
v_mfma_f32_16x16x32_bf16 v[48:51], v[28:31], v[128:131], v[48:51]
s_waitcnt vmcnt(11)
v_mfma_f32_16x16x32_bf16 v[48:51], v[28:31], v[132:135], v[48:51]
s_nop 3
ds_write_b128 v14, v[44:47] offset:1024
v_add_f32 v19, v19, v44
v_fmac_f32 v20, v44, v44
v_add_f32 v19, v19, v45
v_fmac_f32 v20, v45, v45
v_add_f32 v19, v19, v46
v_fmac_f32 v20, v46, v46
v_add_f32 v19, v19, v47
v_fmac_f32 v20, v47, v47
s_waitcnt vmcnt(10)
v_mfma_f32_16x16x32_bf16 v[48:51], v[32:35], v[136:139], v[48:51]
s_waitcnt vmcnt(9)
v_mfma_f32_16x16x32_bf16 v[48:51], v[32:35], v[140:143], v[48:51]
s_waitcnt vmcnt(8)
v_mfma_f32_16x16x32_bf16 v[52:55], v[28:31], v[144:147], v[52:55]
s_waitcnt vmcnt(7)
v_mfma_f32_16x16x32_bf16 v[52:55], v[28:31], v[148:151], v[52:55]
s_nop 3
ds_write_b128 v14, v[48:51] offset:2048
v_add_f32 v19, v19, v48
v_fmac_f32 v20, v48, v48
v_add_f32 v19, v19, v49
v_fmac_f32 v20, v49, v49
v_add_f32 v19, v19, v50
v_fmac_f32 v20, v50, v50
v_add_f32 v19, v19, v51
v_fmac_f32 v20, v51, v51
s_waitcnt vmcnt(6)
v_mfma_f32_16x16x32_bf16 v[52:55], v[32:35], v[152:155], v[52:55]
s_waitcnt vmcnt(5)
v_mfma_f32_16x16x32_bf16 v[52:55], v[32:35], v[156:159], v[52:55]
s_waitcnt vmcnt(4)
v_mfma_f32_16x16x32_bf16 v[56:59], v[28:31], v[160:163], v[56:59]
s_waitcnt vmcnt(3)
v_mfma_f32_16x16x32_bf16 v[56:59], v[28:31], v[164:167], v[56:59]
s_nop 3
ds_write_b128 v14, v[52:55] offset:3072
v_add_f32 v19, v19, v52
v_fmac_f32 v20, v52, v52
v_add_f32 v19, v19, v53
v_fmac_f32 v20, v53, v53
v_add_f32 v19, v19, v54
v_fmac_f32 v20, v54, v54
v_add_f32 v19, v19, v55
v_fmac_f32 v20, v55, v55
s_mov_b64 exec, 0xffffffff
ds_write_b128 v14, v[56:59] offset:4096
s_mov_b64 exec, -1
v_add_f32 v19, v19, v56
v_fmac_f32 v20, v56, v56
v_add_f32 v19, v19, v57
v_fmac_f32 v20, v57, v57
v_add_f32 v19, v19, v58
v_fmac_f32 v20, v58, v58
v_add_f32 v19, v19, v59
v_fmac_f32 v20, v59, v59
s_mul_i32 s47, s45, 36864
s_add_u32 s47, s47, s52
v_permlane32_swap_b32 v19, v20
v_add_f32 v19, v19, v20
v_mov_b32 v21, v19
s_nop 1
v_permlane16_swap_b32 v19, v21
v_add_f32 v19, v19, v21
s_nop 1
v_add_f32_dpp v19, v19, v19 quad_perm:[2,3,0,1] row_mask:0xf bank_mask:0xf
s_nop 1
v_add_f32_dpp v19, v19, v19 row_ror:4 row_mask:0xf bank_mask:0xf
s_nop 1
v_add_f32_dpp v19, v19, v19 row_ror:8 row_mask:0xf bank_mask:0xf
v_mul_f32 v19, 0x3ae38e39, v19
v_mov_b32 v20, v19
s_nop 1
v_permlane32_swap_b32 v19, v20
v_fma_f32 v20, -v19, v19, v20
v_max_f32 v20, 0, v20
v_add_f32 v20, 0x3727c5ac, v20
v_rsq_f32 v20, v20
s_nop 0
v_mul_f32 v19, v19, v20
v_fma_f32 v40, v40, v20, -v19
v_fma_f32 v41, v41, v20, -v19
v_fma_f32 v42, v42, v20, -v19
v_fma_f32 v43, v43, v20, -v19
v_fma_f32 v44, v44, v20, -v19
v_fma_f32 v45, v45, v20, -v19
v_fma_f32 v46, v46, v20, -v19
v_fma_f32 v47, v47, v20, -v19
v_fma_f32 v48, v48, v20, -v19
v_fma_f32 v49, v49, v20, -v19
v_fma_f32 v50, v50, v20, -v19
v_fma_f32 v51, v51, v20, -v19
v_fma_f32 v52, v52, v20, -v19
v_fma_f32 v53, v53, v20, -v19
v_fma_f32 v54, v54, v20, -v19
v_fma_f32 v55, v55, v20, -v19
v_fma_f32 v56, v56, v20, -v19
v_fma_f32 v57, v57, v20, -v19
v_fma_f32 v58, v58, v20, -v19
v_fma_f32 v59, v59, v20, -v19
v_cvt_pk_bf16_f32 v72, v40, v41
v_cvt_pk_bf16_f32 v74, v44, v45
v_cvt_pk_bf16_f32 v73, v42, v43
v_cvt_pk_bf16_f32 v75, v46, v47
v_permlane16_swap_b32 v72, v74
s_nop 0
v_permlane16_swap_b32 v73, v75
buffer_store_dwordx4 v[72:75], v10, s[4:7], s47 offen offset:0 sc1
v_cvt_pk_bf16_f32 v76, v48, v49
v_cvt_pk_bf16_f32 v78, v52, v53
v_cvt_pk_bf16_f32 v77, v50, v51
v_cvt_pk_bf16_f32 v79, v54, v55
v_permlane16_swap_b32 v76, v78
s_nop 0
v_permlane16_swap_b32 v77, v79
buffer_store_dwordx4 v[76:79], v10, s[4:7], s47 offen offset:1024 sc1
v_cvt_pk_bf16_f32 v80, v56, v57
v_cvt_pk_bf16_f32 v81, v58, v59
s_mov_b64 exec, 0xffffffff
buffer_store_dwordx2 v[80:81], v11, s[4:7], s47 offen offset:2048 sc1
s_mov_b64 exec, -1
v_mov_b32 v18, s48
s_mov_b32 s45, s48
s_add_u32 s48, s48, 1
s_waitcnt vmcnt(3)
v_cmp_gt_u32 vcc, s48, v24
s_nop 0
s_and_b32 vcc_lo, vcc_lo, 0xffffff
s_cbranch_scc1 red_late_221
v_mov_b32 v1, 147456
ds_read_b32 v2, v1
s_waitcnt lgkmcnt(0)
v_readfirstlane_b32 s47, v2
s_nop 0
s_add_u32 s47, s47, 32
s_cmp_gt_u32 s47, s45
s_cbranch_scc0 red_late_221
s_mul_i32 s47, s45, 36864
buffer_load_dwordx2 v[60:61], v9, s[8:11], s47 offen offset:0
buffer_load_dwordx2 v[62:63], v9, s[8:11], s47 offen offset:256
buffer_load_dwordx2 v[64:65], v9, s[8:11], s47 offen offset:512
buffer_load_dwordx2 v[66:67], v9, s[8:11], s47 offen offset:768
v_mov_b64 v[68:69], 0
s_mov_b64 exec, 0xffffffff
buffer_load_dwordx2 v[68:69], v9, s[8:11], s47 offen offset:1024
s_mov_b64 exec, -1
s_mul_i32 s47, s45, 294912
s_add_u32 s47, s47, s51
s_add_u32 s46, s47, 147456
buffer_load_dwordx4 v[96:99], v8, s[4:7], s47 offen offset:0 sc1
buffer_load_dwordx4 v[100:103], v8, s[4:7], s46 offen offset:0 sc1
buffer_load_dwordx4 v[104:107], v8, s[4:7], s47 offen offset:256 sc1
buffer_load_dwordx4 v[108:111], v8, s[4:7], s46 offen offset:256 sc1
buffer_load_dwordx4 v[112:115], v8, s[4:7], s47 offen offset:512 sc1
buffer_load_dwordx4 v[116:119], v8, s[4:7], s46 offen offset:512 sc1
buffer_load_dwordx4 v[120:123], v8, s[4:7], s47 offen offset:768 sc1
buffer_load_dwordx4 v[124:127], v8, s[4:7], s46 offen offset:768 sc1
buffer_load_dwordx4 v[128:131], v8, s[4:7], s47 offen offset:1024 sc1
buffer_load_dwordx4 v[132:135], v8, s[4:7], s46 offen offset:1024 sc1
buffer_load_dwordx4 v[136:139], v8, s[4:7], s47 offen offset:1280 sc1
buffer_load_dwordx4 v[140:143], v8, s[4:7], s46 offen offset:1280 sc1
buffer_load_dwordx4 v[144:147], v8, s[4:7], s47 offen offset:1536 sc1
buffer_load_dwordx4 v[148:151], v8, s[4:7], s46 offen offset:1536 sc1
buffer_load_dwordx4 v[152:155], v8, s[4:7], s47 offen offset:1792 sc1
buffer_load_dwordx4 v[156:159], v8, s[4:7], s46 offen offset:1792 sc1
buffer_load_dwordx4 v[160:163], v8, s[4:7], s47 offen offset:2048 sc1
buffer_load_dwordx4 v[164:167], v8, s[4:7], s46 offen offset:2048 sc1
s_waitcnt vmcnt(23) lgkmcnt(0)
buffer_store_dword v18, v36, s[4:7], s50 offen sc1
buffer_store_dword v18, v37, s[4:7], s50 offen
s_branch red_have_220
red_late_221:
s_waitcnt vmcnt(0) lgkmcnt(0)
buffer_store_dword v18, v36, s[4:7], s50 offen sc1
buffer_store_dword v18, v37, s[4:7], s50 offen
s_cmp_lt_u32 s45, 64
s_cbranch_scc1 red_loop_219
s_endpgm
red_mid_217:
red_loop_228:
s_add_u32 s48, s45, 1
s_mov_b32 s98, 0
sp_loop_231:
buffer_load_dword v24, v15, s[4:7], s49 offen sc1
s_add_u32 s98, s98, 1
s_cmp_gt_u32 s98, 150000
s_cbranch_scc1 sp_bad_233
s_waitcnt vmcnt(0)
v_cmp_gt_u32 vcc, s48, v24
s_nop 0
s_and_b32 vcc_lo, vcc_lo, 0xffffff
s_cbranch_scc0 sp_ok_232
s_sleep 2
s_branch sp_loop_231
sp_bad_233:
s_mov_b32 s98, 1281
s_branch L_fail
sp_ok_232:
s_mul_i32 s47, s45, 294912
s_add_u32 s47, s47, s51
s_add_u32 s46, s47, 147456
buffer_load_dwordx4 v[96:99], v8, s[4:7], s47 offen offset:0 sc1
buffer_load_dwordx4 v[100:103], v8, s[4:7], s46 offen offset:0 sc1
buffer_load_dwordx4 v[104:107], v8, s[4:7], s47 offen offset:256 sc1
buffer_load_dwordx4 v[108:111], v8, s[4:7], s46 offen offset:256 sc1
buffer_load_dwordx4 v[112:115], v8, s[4:7], s47 offen offset:512 sc1
buffer_load_dwordx4 v[116:119], v8, s[4:7], s46 offen offset:512 sc1
buffer_load_dwordx4 v[120:123], v8, s[4:7], s47 offen offset:768 sc1
buffer_load_dwordx4 v[124:127], v8, s[4:7], s46 offen offset:768 sc1
buffer_load_dwordx4 v[128:131], v8, s[4:7], s47 offen offset:1024 sc1
buffer_load_dwordx4 v[132:135], v8, s[4:7], s46 offen offset:1024 sc1
buffer_load_dwordx4 v[136:139], v8, s[4:7], s47 offen offset:1280 sc1
buffer_load_dwordx4 v[140:143], v8, s[4:7], s46 offen offset:1280 sc1
buffer_load_dwordx4 v[144:147], v8, s[4:7], s47 offen offset:1536 sc1
buffer_load_dwordx4 v[148:151], v8, s[4:7], s46 offen offset:1536 sc1
buffer_load_dwordx4 v[152:155], v8, s[4:7], s47 offen offset:1792 sc1
buffer_load_dwordx4 v[156:159], v8, s[4:7], s46 offen offset:1792 sc1
buffer_load_dwordx4 v[160:163], v8, s[4:7], s47 offen offset:2048 sc1
buffer_load_dwordx4 v[164:167], v8, s[4:7], s46 offen offset:2048 sc1
buffer_store_dword v18, v16, s[4:7], 0 offen
buffer_store_dword v18, v16, s[4:7], 0 offen
red_have_229:
buffer_load_dword v24, v15, s[4:7], s49 offen sc1
s_and_b32 s47, s45, 31
s_mul_i32 s47, s47, 4608
v_lshlrev_b32 v14, 4, v0
v_add_u32 v14, s47, v14
ds_read_b128 v[40:43], v14 offset:0
ds_read_b128 v[44:47], v14 offset:1024
ds_read_b128 v[48:51], v14 offset:2048
ds_read_b128 v[52:55], v14 offset:3072
v_mov_b64 v[56:57], 0
v_mov_b64 v[58:59], 0
s_mov_b64 exec, 0xffffffff
ds_read_b128 v[56:59], v14 offset:4096
s_mov_b64 exec, -1
s_waitcnt lgkmcnt(0)
s_waitcnt vmcnt(20)
v_mfma_f32_16x16x32_bf16 v[40:43], v[28:31], v[96:99], v[40:43]
s_waitcnt vmcnt(19)
v_mfma_f32_16x16x32_bf16 v[40:43], v[28:31], v[100:103], v[40:43]
s_waitcnt vmcnt(18)
v_mfma_f32_16x16x32_bf16 v[40:43], v[32:35], v[104:107], v[40:43]
s_waitcnt vmcnt(17)
v_mfma_f32_16x16x32_bf16 v[40:43], v[32:35], v[108:111], v[40:43]
s_waitcnt vmcnt(16)
v_mfma_f32_16x16x32_bf16 v[44:47], v[28:31], v[112:115], v[44:47]
s_waitcnt vmcnt(15)
v_mfma_f32_16x16x32_bf16 v[44:47], v[28:31], v[116:119], v[44:47]
s_nop 3
ds_write_b128 v14, v[40:43] offset:0
v_mul_f32 v20, v40, v40
v_add_f32 v19, v40, v41
v_fmac_f32 v20, v41, v41
v_add_f32 v19, v19, v42
v_fmac_f32 v20, v42, v42
v_add_f32 v19, v19, v43
v_fmac_f32 v20, v43, v43
s_waitcnt vmcnt(14)
v_mfma_f32_16x16x32_bf16 v[44:47], v[32:35], v[120:123], v[44:47]
s_waitcnt vmcnt(13)
v_mfma_f32_16x16x32_bf16 v[44:47], v[32:35], v[124:127], v[44:47]
s_waitcnt vmcnt(12)
v_mfma_f32_16x16x32_bf16 v[48:51], v[28:31], v[128:131], v[48:51]
s_waitcnt vmcnt(11)
v_mfma_f32_16x16x32_bf16 v[48:51], v[28:31], v[132:135], v[48:51]
s_nop 3
ds_write_b128 v14, v[44:47] offset:1024
v_add_f32 v19, v19, v44
v_fmac_f32 v20, v44, v44
v_add_f32 v19, v19, v45
v_fmac_f32 v20, v45, v45
v_add_f32 v19, v19, v46
v_fmac_f32 v20, v46, v46
v_add_f32 v19, v19, v47
v_fmac_f32 v20, v47, v47
s_waitcnt vmcnt(10)
v_mfma_f32_16x16x32_bf16 v[48:51], v[32:35], v[136:139], v[48:51]
s_waitcnt vmcnt(9)
v_mfma_f32_16x16x32_bf16 v[48:51], v[32:35], v[140:143], v[48:51]
s_waitcnt vmcnt(8)
v_mfma_f32_16x16x32_bf16 v[52:55], v[28:31], v[144:147], v[52:55]
s_waitcnt vmcnt(7)
v_mfma_f32_16x16x32_bf16 v[52:55], v[28:31], v[148:151], v[52:55]
s_nop 3
ds_write_b128 v14, v[48:51] offset:2048
v_add_f32 v19, v19, v48
v_fmac_f32 v20, v48, v48
v_add_f32 v19, v19, v49
v_fmac_f32 v20, v49, v49
v_add_f32 v19, v19, v50
v_fmac_f32 v20, v50, v50
v_add_f32 v19, v19, v51
v_fmac_f32 v20, v51, v51
s_waitcnt vmcnt(6)
v_mfma_f32_16x16x32_bf16 v[52:55], v[32:35], v[152:155], v[52:55]
s_waitcnt vmcnt(5)
v_mfma_f32_16x16x32_bf16 v[52:55], v[32:35], v[156:159], v[52:55]
s_waitcnt vmcnt(4)
v_mfma_f32_16x16x32_bf16 v[56:59], v[28:31], v[160:163], v[56:59]
s_waitcnt vmcnt(3)
v_mfma_f32_16x16x32_bf16 v[56:59], v[28:31], v[164:167], v[56:59]
s_nop 3
ds_write_b128 v14, v[52:55] offset:3072
v_add_f32 v19, v19, v52
v_fmac_f32 v20, v52, v52
v_add_f32 v19, v19, v53
v_fmac_f32 v20, v53, v53
v_add_f32 v19, v19, v54
v_fmac_f32 v20, v54, v54
v_add_f32 v19, v19, v55
v_fmac_f32 v20, v55, v55
s_mov_b64 exec, 0xffffffff
ds_write_b128 v14, v[56:59] offset:4096
s_mov_b64 exec, -1
v_add_f32 v19, v19, v56
v_fmac_f32 v20, v56, v56
v_add_f32 v19, v19, v57
v_fmac_f32 v20, v57, v57
v_add_f32 v19, v19, v58
v_fmac_f32 v20, v58, v58
v_add_f32 v19, v19, v59
v_fmac_f32 v20, v59, v59
s_mul_i32 s47, s45, 36864
s_add_u32 s47, s47, s52
v_permlane32_swap_b32 v19, v20
v_add_f32 v19, v19, v20
v_mov_b32 v21, v19
s_nop 1
v_permlane16_swap_b32 v19, v21
v_add_f32 v19, v19, v21
s_nop 1
v_add_f32_dpp v19, v19, v19 quad_perm:[2,3,0,1] row_mask:0xf bank_mask:0xf
s_nop 1
v_add_f32_dpp v19, v19, v19 row_ror:4 row_mask:0xf bank_mask:0xf
s_nop 1
v_add_f32_dpp v19, v19, v19 row_ror:8 row_mask:0xf bank_mask:0xf
v_mul_f32 v19, 0x3ae38e39, v19
v_mov_b32 v20, v19
s_nop 1
v_permlane32_swap_b32 v19, v20
v_fma_f32 v20, -v19, v19, v20
v_max_f32 v20, 0, v20
v_add_f32 v20, 0x3727c5ac, v20
v_rsq_f32 v20, v20
s_nop 0
v_mul_f32 v19, v19, v20
v_fma_f32 v40, v40, v20, -v19
v_fma_f32 v41, v41, v20, -v19
v_fma_f32 v42, v42, v20, -v19
v_fma_f32 v43, v43, v20, -v19
v_fma_f32 v44, v44, v20, -v19
v_fma_f32 v45, v45, v20, -v19
v_fma_f32 v46, v46, v20, -v19
v_fma_f32 v47, v47, v20, -v19
v_fma_f32 v48, v48, v20, -v19
v_fma_f32 v49, v49, v20, -v19
v_fma_f32 v50, v50, v20, -v19
v_fma_f32 v51, v51, v20, -v19
v_fma_f32 v52, v52, v20, -v19
v_fma_f32 v53, v53, v20, -v19
v_fma_f32 v54, v54, v20, -v19
v_fma_f32 v55, v55, v20, -v19
v_fma_f32 v56, v56, v20, -v19
v_fma_f32 v57, v57, v20, -v19
v_fma_f32 v58, v58, v20, -v19
v_fma_f32 v59, v59, v20, -v19
v_cvt_pk_bf16_f32 v72, v40, v41
v_cvt_pk_bf16_f32 v74, v44, v45
v_cvt_pk_bf16_f32 v73, v42, v43
v_cvt_pk_bf16_f32 v75, v46, v47
v_permlane16_swap_b32 v72, v74
s_nop 0
v_permlane16_swap_b32 v73, v75
buffer_store_dwordx4 v[72:75], v10, s[4:7], s47 offen offset:0 sc1
v_cvt_pk_bf16_f32 v76, v48, v49
v_cvt_pk_bf16_f32 v78, v52, v53
v_cvt_pk_bf16_f32 v77, v50, v51
v_cvt_pk_bf16_f32 v79, v54, v55
v_permlane16_swap_b32 v76, v78
s_nop 0
v_permlane16_swap_b32 v77, v79
buffer_store_dwordx4 v[76:79], v10, s[4:7], s47 offen offset:1024 sc1
v_cvt_pk_bf16_f32 v80, v56, v57
v_cvt_pk_bf16_f32 v81, v58, v59
s_mov_b64 exec, 0xffffffff
buffer_store_dwordx2 v[80:81], v11, s[4:7], s47 offen offset:2048 sc1
s_mov_b64 exec, -1
v_mov_b32 v18, s48
s_mov_b32 s45, s48
s_add_u32 s48, s48, 1
s_waitcnt vmcnt(3)
v_cmp_gt_u32 vcc, s48, v24
s_nop 0
s_and_b32 vcc_lo, vcc_lo, 0xffffff
s_cbranch_scc1 red_late_230
s_mul_i32 s47, s45, 294912
s_add_u32 s47, s47, s51
s_add_u32 s46, s47, 147456
buffer_load_dwordx4 v[96:99], v8, s[4:7], s47 offen offset:0 sc1
buffer_load_dwordx4 v[100:103], v8, s[4:7], s46 offen offset:0 sc1
buffer_load_dwordx4 v[104:107], v8, s[4:7], s47 offen offset:256 sc1
buffer_load_dwordx4 v[108:111], v8, s[4:7], s46 offen offset:256 sc1
buffer_load_dwordx4 v[112:115], v8, s[4:7], s47 offen offset:512 sc1
buffer_load_dwordx4 v[116:119], v8, s[4:7], s46 offen offset:512 sc1
buffer_load_dwordx4 v[120:123], v8, s[4:7], s47 offen offset:768 sc1
buffer_load_dwordx4 v[124:127], v8, s[4:7], s46 offen offset:768 sc1
buffer_load_dwordx4 v[128:131], v8, s[4:7], s47 offen offset:1024 sc1
buffer_load_dwordx4 v[132:135], v8, s[4:7], s46 offen offset:1024 sc1
buffer_load_dwordx4 v[136:139], v8, s[4:7], s47 offen offset:1280 sc1
buffer_load_dwordx4 v[140:143], v8, s[4:7], s46 offen offset:1280 sc1
buffer_load_dwordx4 v[144:147], v8, s[4:7], s47 offen offset:1536 sc1
buffer_load_dwordx4 v[148:151], v8, s[4:7], s46 offen offset:1536 sc1
buffer_load_dwordx4 v[152:155], v8, s[4:7], s47 offen offset:1792 sc1
buffer_load_dwordx4 v[156:159], v8, s[4:7], s46 offen offset:1792 sc1
buffer_load_dwordx4 v[160:163], v8, s[4:7], s47 offen offset:2048 sc1
buffer_load_dwordx4 v[164:167], v8, s[4:7], s46 offen offset:2048 sc1
s_waitcnt vmcnt(18) lgkmcnt(0)
buffer_store_dword v18, v36, s[4:7], s50 offen sc1
buffer_store_dword v18, v37, s[4:7], s50 offen
s_branch red_have_229
red_late_230:
s_waitcnt vmcnt(0) lgkmcnt(0)
buffer_store_dword v18, v36, s[4:7], s50 offen sc1
buffer_store_dword v18, v37, s[4:7], s50 offen
s_cmp_lt_u32 s45, 64
s_cbranch_scc1 red_loop_228
s_endpgm
red_fin_218:
red_loop_234:
s_add_u32 s48, s45, 1
s_mov_b32 s98, 0
sp_loop_237:
buffer_load_dword v24, v15, s[4:7], s49 offen sc1
s_add_u32 s98, s98, 1
s_cmp_gt_u32 s98, 150000
s_cbranch_scc1 sp_bad_239
s_waitcnt vmcnt(0)
v_cmp_gt_u32 vcc, s48, v24
s_nop 0
s_and_b32 vcc_lo, vcc_lo, 0xffffff
s_cbranch_scc0 sp_ok_238
s_sleep 2
s_branch sp_loop_237
sp_bad_239:
s_mov_b32 s98, 1281
s_branch L_fail
sp_ok_238:
s_mul_i32 s47, s45, 294912
s_add_u32 s47, s47, s51
s_add_u32 s46, s47, 147456
buffer_load_dwordx4 v[96:99], v8, s[4:7], s47 offen offset:0 sc1
buffer_load_dwordx4 v[100:103], v8, s[4:7], s46 offen offset:0 sc1
buffer_load_dwordx4 v[104:107], v8, s[4:7], s47 offen offset:256 sc1
buffer_load_dwordx4 v[108:111], v8, s[4:7], s46 offen offset:256 sc1
buffer_load_dwordx4 v[112:115], v8, s[4:7], s47 offen offset:512 sc1
buffer_load_dwordx4 v[116:119], v8, s[4:7], s46 offen offset:512 sc1
buffer_load_dwordx4 v[120:123], v8, s[4:7], s47 offen offset:768 sc1
buffer_load_dwordx4 v[124:127], v8, s[4:7], s46 offen offset:768 sc1
buffer_load_dwordx4 v[128:131], v8, s[4:7], s47 offen offset:1024 sc1
buffer_load_dwordx4 v[132:135], v8, s[4:7], s46 offen offset:1024 sc1
buffer_load_dwordx4 v[136:139], v8, s[4:7], s47 offen offset:1280 sc1
buffer_load_dwordx4 v[140:143], v8, s[4:7], s46 offen offset:1280 sc1
buffer_load_dwordx4 v[144:147], v8, s[4:7], s47 offen offset:1536 sc1
buffer_load_dwordx4 v[148:151], v8, s[4:7], s46 offen offset:1536 sc1
buffer_load_dwordx4 v[152:155], v8, s[4:7], s47 offen offset:1792 sc1
buffer_load_dwordx4 v[156:159], v8, s[4:7], s46 offen offset:1792 sc1
buffer_load_dwordx4 v[160:163], v8, s[4:7], s47 offen offset:2048 sc1
buffer_load_dwordx4 v[164:167], v8, s[4:7], s46 offen offset:2048 sc1
red_have_235:
buffer_load_dword v24, v15, s[4:7], s49 offen sc1
s_and_b32 s47, s45, 31
s_mul_i32 s47, s47, 4608
v_lshlrev_b32 v14, 4, v0
v_add_u32 v14, s47, v14
ds_read_b128 v[40:43], v14 offset:0
ds_read_b128 v[44:47], v14 offset:1024
ds_read_b128 v[48:51], v14 offset:2048
ds_read_b128 v[52:55], v14 offset:3072
v_mov_b64 v[56:57], 0
v_mov_b64 v[58:59], 0
s_mov_b64 exec, 0xffffffff
ds_read_b128 v[56:59], v14 offset:4096
s_mov_b64 exec, -1
s_waitcnt lgkmcnt(0)
v_mov_b32 v1, 147456
v_mov_b32 v2, s48
ds_write_b32 v1, v2
s_waitcnt vmcnt(18)
v_mfma_f32_16x16x32_bf16 v[40:43], v[28:31], v[96:99], v[40:43]
s_waitcnt vmcnt(17)
v_mfma_f32_16x16x32_bf16 v[40:43], v[28:31], v[100:103], v[40:43]
s_waitcnt vmcnt(16)
v_mfma_f32_16x16x32_bf16 v[40:43], v[32:35], v[104:107], v[40:43]
s_waitcnt vmcnt(15)
v_mfma_f32_16x16x32_bf16 v[40:43], v[32:35], v[108:111], v[40:43]
s_waitcnt vmcnt(14)
v_mfma_f32_16x16x32_bf16 v[44:47], v[28:31], v[112:115], v[44:47]
s_waitcnt vmcnt(13)
v_mfma_f32_16x16x32_bf16 v[44:47], v[28:31], v[116:119], v[44:47]
s_waitcnt vmcnt(12)
v_mfma_f32_16x16x32_bf16 v[44:47], v[32:35], v[120:123], v[44:47]
s_waitcnt vmcnt(11)
v_mfma_f32_16x16x32_bf16 v[44:47], v[32:35], v[124:127], v[44:47]
s_waitcnt vmcnt(10)
v_mfma_f32_16x16x32_bf16 v[48:51], v[28:31], v[128:131], v[48:51]
s_waitcnt vmcnt(9)
v_mfma_f32_16x16x32_bf16 v[48:51], v[28:31], v[132:135], v[48:51]
s_waitcnt vmcnt(8)
v_mfma_f32_16x16x32_bf16 v[48:51], v[32:35], v[136:139], v[48:51]
s_waitcnt vmcnt(7)
v_mfma_f32_16x16x32_bf16 v[48:51], v[32:35], v[140:143], v[48:51]
s_waitcnt vmcnt(6)
v_mfma_f32_16x16x32_bf16 v[52:55], v[28:31], v[144:147], v[52:55]
s_waitcnt vmcnt(5)
v_mfma_f32_16x16x32_bf16 v[52:55], v[28:31], v[148:151], v[52:55]
s_waitcnt vmcnt(4)
v_mfma_f32_16x16x32_bf16 v[52:55], v[32:35], v[152:155], v[52:55]
s_waitcnt vmcnt(3)
v_mfma_f32_16x16x32_bf16 v[52:55], v[32:35], v[156:159], v[52:55]
s_waitcnt vmcnt(2)
v_mfma_f32_16x16x32_bf16 v[56:59], v[28:31], v[160:163], v[56:59]
s_waitcnt vmcnt(1)
v_mfma_f32_16x16x32_bf16 v[56:59], v[28:31], v[164:167], v[56:59]
s_mul_i32 s47, s45, 36864
v_cvt_pk_bf16_f32 v72, v40, v41
v_cvt_pk_bf16_f32 v74, v44, v45
v_cvt_pk_bf16_f32 v73, v42, v43
v_cvt_pk_bf16_f32 v75, v46, v47
v_permlane16_swap_b32 v72, v74
s_nop 0
v_permlane16_swap_b32 v73, v75
buffer_store_dwordx4 v[72:75], v12, s[16:19], s47 offen offset:0
v_cvt_pk_bf16_f32 v76, v48, v49
v_cvt_pk_bf16_f32 v78, v52, v53
v_cvt_pk_bf16_f32 v77, v50, v51
v_cvt_pk_bf16_f32 v79, v54, v55
v_permlane16_swap_b32 v76, v78
s_nop 0
v_permlane16_swap_b32 v77, v79
buffer_store_dwordx4 v[76:79], v12, s[16:19], s47 offen offset:512
v_cvt_pk_bf16_f32 v80, v56, v57
v_cvt_pk_bf16_f32 v81, v58, v59
s_mov_b64 exec, 0xffffffff
buffer_store_dwordx2 v[80:81], v13, s[16:19], s47 offen offset:1024
s_mov_b64 exec, -1
v_mov_b32 v18, s48
s_mov_b32 s45, s48
s_add_u32 s48, s48, 1
s_waitcnt vmcnt(3)
v_cmp_gt_u32 vcc, s48, v24
s_nop 0
s_and_b32 vcc_lo, vcc_lo, 0xffffff
s_cbranch_scc1 red_late_236
s_mul_i32 s47, s45, 294912
s_add_u32 s47, s47, s51
s_add_u32 s46, s47, 147456
buffer_load_dwordx4 v[96:99], v8, s[4:7], s47 offen offset:0 sc1
buffer_load_dwordx4 v[100:103], v8, s[4:7], s46 offen offset:0 sc1
buffer_load_dwordx4 v[104:107], v8, s[4:7], s47 offen offset:256 sc1
buffer_load_dwordx4 v[108:111], v8, s[4:7], s46 offen offset:256 sc1
buffer_load_dwordx4 v[112:115], v8, s[4:7], s47 offen offset:512 sc1
buffer_load_dwordx4 v[116:119], v8, s[4:7], s46 offen offset:512 sc1
buffer_load_dwordx4 v[120:123], v8, s[4:7], s47 offen offset:768 sc1
buffer_load_dwordx4 v[124:127], v8, s[4:7], s46 offen offset:768 sc1
buffer_load_dwordx4 v[128:131], v8, s[4:7], s47 offen offset:1024 sc1
buffer_load_dwordx4 v[132:135], v8, s[4:7], s46 offen offset:1024 sc1
buffer_load_dwordx4 v[136:139], v8, s[4:7], s47 offen offset:1280 sc1
buffer_load_dwordx4 v[140:143], v8, s[4:7], s46 offen offset:1280 sc1
buffer_load_dwordx4 v[144:147], v8, s[4:7], s47 offen offset:1536 sc1
buffer_load_dwordx4 v[148:151], v8, s[4:7], s46 offen offset:1536 sc1
buffer_load_dwordx4 v[152:155], v8, s[4:7], s47 offen offset:1792 sc1
buffer_load_dwordx4 v[156:159], v8, s[4:7], s46 offen offset:1792 sc1
buffer_load_dwordx4 v[160:163], v8, s[4:7], s47 offen offset:2048 sc1
buffer_load_dwordx4 v[164:167], v8, s[4:7], s46 offen offset:2048 sc1
s_branch red_have_235
red_late_236:
s_cmp_lt_u32 s45, 64
s_cbranch_scc1 red_loop_234
s_endpgm
L_fail:
s_mov_b64 exec, -1
v_mov_b32 v2, s98
v_mov_b32 v3, 252
s_mov_b32 s12, s40
s_and_b32 s13, s41, 0xffff
s_mov_b32 s14, 256
s_mov_b32 s15, 0x20000
buffer_store_dword v2, v3, s[12:15], 0 offen
s_waitcnt vmcnt(0)
s_endpgm
L_chain:
s_mul_i32 s53, s50, 50331648
s_add_u32 s53, s53, 10821632
s_mul_i32 s54, s50, 8388608
s_add_u32 s54, s54, 111484928
s_mul_i32 s55, s50, 589824
s_add_u32 s55, s55, 131072
s_mul_i32 s56, s50, 36864
s_add_u32 s56, s56, 1310720
s_mul_i32 s57, s50, 4
s_add_u32 s57, s57, 48
s_mul_i32 s58, s50, 32768
s_add_u32 s58, s58, 0
v_lshlrev_b32 v1, 4, v0
v_lshlrev_b32 v15, 3, v0
v_add_u32 v2, 139264, v15
v_and_b32 v24, 1, v0
v_mov_b32 v25, 0x88888888
v_mov_b32 v26, 0xdddddddd
v_cmp_eq_u32 vcc, 1, v24
s_nop 1
v_cndmask_b32 v3, v25, v26, vcc
v_lshrrev_b32 v24, 5, v0
v_bfe_u32 v25, v0, 4, 1
v_and_b32 v26, 15, v0
v_lshrrev_b32 v27, 4, v0
s_lshl_b32 s60, s3, 5
v_bfe_u32 v28, v0, 2, 1
v_lshlrev_b32 v28, 3, v28
v_bfe_u32 v29, v0, 3, 1
v_lshl_add_u32 v28, v29, 2, v28
v_and_b32 v29, 3, v0
v_add3_u32 v28, v28, v29, s60
v_lshlrev_b32 v28, 5, v28
v_lshl_add_u32 v28, v27, 3, v28
v_add_u32 v4, 148480, v28
v_bfe_u32 v28, v0, 1, 3
v_lshlrev_b32 v28, 5, v28
v_and_b32 v29, 1, v0
v_lshl_add_u32 v28, v29, 9, v28
v_lshl_add_u32 v28, v27, 3, v28
s_mul_i32 s60, s3, 2304
s_add_u32 s60, s60, 139264
v_add_u32 v11, s60, v28
s_add_u32 s68, s60, 2048
s_lshl_b32 s78, s3, 9
s_sub_u32 s78, s78, 137216
v_lshrrev_b32 v28, 3, v0
v_lshlrev_b32 v28, 12, v28
v_and_b32 v29, 7, v0
v_lshl_add_u32 v9, v29, 4, v28
v_lshlrev_b32 v28, 9, v24
v_lshl_add_u32 v28, v25, 7, v28
v_lshl_add_u32 v28, v26, 3, v28
v_add_u32 v5, 148480, v28
v_bfe_u32 v28, v0, 2, 2
v_lshlrev_b32 v28, 1, v28
v_and_b32 v30, 1, v0
v_add_u32 v30, v28, v30
v_lshlrev_b32 v28, 8, v24
v_lshl_add_u32 v28, v25, 7, v28
v_lshl_add_u32 v12, v30, 4, v28
v_mov_b32 v31, v30
v_min_u32 v28, 3, v0
v_lshrrev_b32 v29, 1, v28
v_lshlrev_b32 v29, 8, v29
v_and_b32 v28, 1, v28
v_mul_u32_u24 v28, 7, v28
s_lshl_b32 s60, s51, 3
s_add_u32 s60, s60, 256
v_add3_u32 v28, v28, v29, s60
v_mul_u32_u24 v28, 43691, v28
v_lshrrev_b32 v28, 19, v28
v_mul_u32_u24 v28, 128, v28
v_add_u32 v28, 2048, v28
s_mul_i32 s60, s51, 128
s_add_u32 s60, s60, 10240
v_mov_b32 v29, s60
v_cmp_eq_u32 vcc, 4, v0
s_nop 1
v_cndmask_b32 v28, v28, v29, vcc
v_mov_b32 v29, 2147483632
s_cmp_eq_u32 s3, 3
s_cselect_b32 s61, 5, 0
v_cmp_gt_u32 vcc, s61, v0
s_nop 1
v_cndmask_b32 v7, v29, v28, vcc
s_lshr_b32 s60, s3, 1
s_lshl_b32 s60, s60, 10
s_and_b32 s61, s3, 1
s_lshl_b32 s61, s61, 9
s_add_u32 s60, s60, s61
s_add_u32 s60, s60, 152576
v_lshrrev_b32 v28, 4, v0
v_lshlrev_b32 v28, 2, v28
v_lshl_add_u32 v28, v31, 5, v28
v_add_u32 v6, s60, v28
v_lshlrev_b32 v29, 6, v25
v_lshl_add_u32 v29, v24, 5, v29
v_lshl_add_u32 v10, v26, 2, v29
v_mov_b32 v29, 2147483632
v_cmp_gt_u32 vcc, 8, v26
s_nop 1
v_cndmask_b32 v10, v29, v10, vcc
s_mov_b32 s66, 0x3e0293ee
s_mov_b32 s70, 0xfffffffe
s_mov_b32 s98, 0xff800000
s_mov_b32 s99, 0xff800000
s_mul_i32 s60, s3, 65536
s_lshl_b32 s61, s51, 7
s_add_u32 s74, s60, s61
s_add_u32 s74, s74, s55
s_lshl_b32 s69, s51, 1
s_add_u32 s69, s69, s3
s_add_u32 s60, s51, 64
s_cmp_lt_u32 s3, 2
s_cselect_b32 s69, s69, s60
s_cselect_b32 s48, 1, 0
s_cmp_eq_u32 s3, 2
s_cselect_b32 s60, 1, 0
s_cmp_lt_u32 s51, 8
s_cselect_b32 s60, s60, 0
s_or_b32 s48, s48, s60
s_lshl_b32 s60, s3, 13
s_lshl_b32 s49, s51, 7
s_add_u32 s49, s49, s60
s_add_u32 s49, s49, s55
s_add_u32 s49, s49, 262144
s_lshl_b32 s75, s69, 12
s_add_u32 s75, s75, s55
s_lshl_b32 s76, s69, 7
s_cmp_eq_u32 s48, 0
s_cselect_b32 s76, 0x70000000, s76
s_add_u32 s79, s56, 9216
s_add_u32 s71, s56, 18432
s_mov_b32 s73, s56
s_mov_b32 s72, 0x00ff00ff
s_cmp_eq_u32 s48, 0
s_cbranch_scc1 z2_242
v_mov_b64 v[24:25], 0
v_mov_b64 v[26:27], 0
buffer_store_dwordx4 v[24:27], v1, s[4:7], s75 offen offset:0 sc1
buffer_store_dwordx4 v[24:27], v1, s[4:7], s75 offen offset:1024 sc1
buffer_store_dwordx4 v[24:27], v1, s[4:7], s75 offen offset:2048 sc1
buffer_store_dwordx4 v[24:27], v1, s[4:7], s75 offen offset:3072 sc1
v_mov_b32 v28, -1
s_mov_b32 exec_lo, s72
s_mov_b32 exec_hi, s72
s_add_u32 s60, s76, s56
s_add_u32 s60, s60, 0
buffer_store_dword v28, v10, s[4:7], s60 offen sc1
s_add_u32 s60, s76, s56
s_add_u32 s60, s60, 9216
buffer_store_dword v28, v10, s[4:7], s60 offen sc1
s_add_u32 s60, s76, s56
s_add_u32 s60, s60, 18432
buffer_store_dword v28, v10, s[4:7], s60 offen sc1
s_mov_b64 exec, -1
z2_242:
s_mov_b32 s8, s22
s_and_b32 s9, s23, 0xffff
s_mov_b32 s10, 9216
s_mov_b32 s11, 0x20000
s_lshl_b32 s60, s3, 6
v_add_u32 v24, s60, v0
v_lshrrev_b32 v26, 3, v24
v_lshlrev_b32 v26, 2, v26
v_and_b32 v27, 7, v24
v_mul_u32_u24 v27, 1152, v27
v_add_u32 v26, v26, v27
buffer_load_dword v16, v26, s[8:11], 0 offen offset:0
buffer_load_dword v17, v26, s[8:11], 0 offen offset:128
buffer_load_dword v18, v26, s[8:11], 0 offen offset:256
buffer_load_dword v19, v26, s[8:11], 0 offen offset:384
buffer_load_dword v20, v26, s[8:11], 0 offen offset:512
buffer_load_dword v21, v26, s[8:11], 0 offen offset:640
buffer_load_dword v22, v26, s[8:11], 0 offen offset:768
buffer_load_dword v23, v26, s[8:11], 0 offen offset:896
buffer_load_dword v14, v26, s[8:11], 0 offen offset:1024
v_lshrrev_b32 v28, 4, v0
v_lshlrev_b32 v29, 1, v28
v_and_b32 v30, 15, v0
v_xor_b32 v30, v30, v29
v_lshlrev_b32 v30, 4, v30
v_lshlrev_b32 v28, 13, v28
v_add_u32 v30, v28, v30
v_xor_b32 v31, 128, v30
s_cmp_eq_u32 s58, 0
s_cbranch_scc1 now_243
s_cmp_lg_u32 s3, 3
s_cbranch_scc1 now2_244
s_mov_b32 s12, s40
s_and_b32 s13, s41, 0xffff
s_mov_b32 s14, 256
s_mov_b32 s15, 0x20000
v_lshlrev_b32 v24, 2, v0
v_add_u32 v25, 128, v24
v_cmp_le_u32 vcc, 2, v0
s_nop 1
v_cndmask_b32 v24, v24, v25, vcc
v_mov_b32 v25, 192
v_cmp_eq_u32 vcc, 8, v0
s_nop 1
v_cndmask_b32 v24, v24, v25, vcc
v_mov_b32 v25, 2147483632
v_cmp_lt_u32 vcc, 8, v0
s_nop 1
v_cndmask_b32 v24, v24, v25, vcc
s_mov_b32 s98, 0
wi_loop_245:
buffer_load_dword v25, v24, s[12:15], 0 offen sc1
s_add_u32 s98, s98, 1
s_cmp_gt_u32 s98, 150000
s_cbranch_scc1 wi_bad_247
s_waitcnt vmcnt(0)
v_cmp_eq_u32 vcc, 32, v25
s_nop 0
s_and_b32 s97, vcc_lo, 0x1ff
s_cmp_eq_u32 s97, 0x1ff
s_cbranch_scc1 wi_ok_246
v_cmp_lt_u32 vcc, 32, v25
s_nop 0
s_and_b32 s96, vcc_lo, 0xff
s_cselect_b32 s96, 0x100, 0
s_and_b32 s96, s96, s97
s_cbranch_scc1 wi_over_248
s_sleep 8
s_branch wi_loop_245
wi_bad_247:
s_mov_b32 s98, 512
s_branch L_fail
wi_over_248:
s_mov_b32 s100, 255
wi_ok_246:
s_mov_b32 s67, 0
sp_loop_249:
buffer_load_dword v24, v7, s[4:7], 0 offen sc1
s_add_u32 s67, s67, 1
s_cmp_gt_u32 s67, 150000
s_cbranch_scc1 sp_bad_251
s_waitcnt vmcnt(0)
v_cmp_gt_u32 vcc, 1, v24
s_nop 0
s_and_b32 vcc_lo, vcc_lo, 15
s_cbranch_scc0 sp_ok_250
s_sleep 8
s_branch sp_loop_249
sp_bad_251:
s_mov_b32 s98, 1793
s_branch L_fail
sp_ok_250:
now2_244:
s_barrier
now_243:
s_mov_b32 s8, s24
s_and_b32 s9, s25, 0xffff
s_mov_b32 s10, 4718592
s_mov_b32 s11, 0x20000
s_lshl_b32 s61, s51, 8
s_mul_i32 s60, s3, 393216
s_add_u32 s61, s61, s60
s_add_u32 s61, s61, 0
s_mul_i32 s60, s3, 12288
s_add_u32 m0, s60, 0
s_mul_i32 s62, s3, 48
s_bitcmp1_b32 s62, 5
s_cbranch_scc1 sq_252
buffer_load_dwordx4 v30, s[8:11], s61 offen lds
s_branch sq_253
sq_252:
buffer_load_dwordx4 v31, s[8:11], s61 offen lds
sq_253:
s_add_u32 s62, s62, 4
s_add_u32 s61, s61, 32768
s_add_u32 m0, m0, 1024
s_bitcmp1_b32 s62, 5
s_cbranch_scc1 sq_254
buffer_load_dwordx4 v30, s[8:11], s61 offen lds
s_branch sq_255
sq_254:
buffer_load_dwordx4 v31, s[8:11], s61 offen lds
sq_255:
s_add_u32 s62, s62, 4
s_add_u32 s61, s61, 32768
s_add_u32 m0, m0, 1024
s_bitcmp1_b32 s62, 5
s_cbranch_scc1 sq_256
buffer_load_dwordx4 v30, s[8:11], s61 offen lds
s_branch sq_257
sq_256:
buffer_load_dwordx4 v31, s[8:11], s61 offen lds
sq_257:
s_add_u32 s62, s62, 4
s_add_u32 s61, s61, 32768
s_add_u32 m0, m0, 1024
s_bitcmp1_b32 s62, 5
s_cbranch_scc1 sq_258
buffer_load_dwordx4 v30, s[8:11], s61 offen lds
s_branch sq_259
sq_258:
buffer_load_dwordx4 v31, s[8:11], s61 offen lds
sq_259:
s_add_u32 s62, s62, 4
s_add_u32 s61, s61, 32768
s_add_u32 m0, m0, 1024
s_bitcmp1_b32 s62, 5
s_cbranch_scc1 sq_260
buffer_load_dwordx4 v30, s[8:11], s61 offen lds
s_branch sq_261
sq_260:
buffer_load_dwordx4 v31, s[8:11], s61 offen lds
sq_261:
s_add_u32 s62, s62, 4
s_add_u32 s61, s61, 32768
s_add_u32 m0, m0, 1024
s_bitcmp1_b32 s62, 5
s_cbranch_scc1 sq_262
buffer_load_dwordx4 v30, s[8:11], s61 offen lds
s_branch sq_263
sq_262:
buffer_load_dwordx4 v31, s[8:11], s61 offen lds
sq_263:
s_add_u32 s62, s62, 4
s_add_u32 s61, s61, 32768
s_add_u32 m0, m0, 1024
s_bitcmp1_b32 s62, 5
s_cbranch_scc1 sq_264
buffer_load_dwordx4 v30, s[8:11], s61 offen lds
s_branch sq_265
sq_264:
buffer_load_dwordx4 v31, s[8:11], s61 offen lds
sq_265:
s_add_u32 s62, s62, 4
s_add_u32 s61, s61, 32768
s_add_u32 m0, m0, 1024
s_bitcmp1_b32 s62, 5
s_cbranch_scc1 sq_266
buffer_load_dwordx4 v30, s[8:11], s61 offen lds
s_branch sq_267
sq_266:
buffer_load_dwordx4 v31, s[8:11], s61 offen lds
sq_267:
s_add_u32 s62, s62, 4
s_add_u32 s61, s61, 32768
s_add_u32 m0, m0, 1024
s_bitcmp1_b32 s62, 5
s_cbranch_scc1 sq_268
buffer_load_dwordx4 v30, s[8:11], s61 offen lds
s_branch sq_269
sq_268:
buffer_load_dwordx4 v31, s[8:11], s61 offen lds
sq_269:
s_add_u32 s62, s62, 4
s_add_u32 s61, s61, 32768
s_add_u32 m0, m0, 1024
s_bitcmp1_b32 s62, 5
s_cbranch_scc1 sq_270
buffer_load_dwordx4 v30, s[8:11], s61 offen lds
s_branch sq_271
sq_270:
buffer_load_dwordx4 v31, s[8:11], s61 offen lds
sq_271:
s_add_u32 s62, s62, 4
s_add_u32 s61, s61, 32768
s_add_u32 m0, m0, 1024
s_bitcmp1_b32 s62, 5
s_cbranch_scc1 sq_272
buffer_load_dwordx4 v30, s[8:11], s61 offen lds
s_branch sq_273
sq_272:
buffer_load_dwordx4 v31, s[8:11], s61 offen lds
sq_273:
s_add_u32 s62, s62, 4
s_add_u32 s61, s61, 32768
s_add_u32 m0, m0, 1024
s_bitcmp1_b32 s62, 5
s_cbranch_scc1 sq_274
buffer_load_dwordx4 v30, s[8:11], s61 offen lds
s_branch sq_275
sq_274:
buffer_load_dwordx4 v31, s[8:11], s61 offen lds
sq_275:
s_add_u32 s62, s62, 4
s_add_u32 s61, s61, 32768
s_add_u32 m0, m0, 1024
s_mov_b32 s8, s24
s_and_b32 s9, s25, 0xffff
s_mov_b32 s10, 4718592
s_mov_b32 s11, 0x20000
s_lshl_b32 s61, s51, 8
s_mul_i32 s60, s3, 393216
s_add_u32 s61, s61, s60
s_add_u32 s61, s61, 1572864
s_mul_i32 s60, s3, 12288
s_add_u32 m0, s60, 49152
s_mul_i32 s62, s3, 48
s_bitcmp1_b32 s62, 5
s_cbranch_scc1 sq_276
buffer_load_dwordx4 v30, s[8:11], s61 offen lds
s_branch sq_277
sq_276:
buffer_load_dwordx4 v31, s[8:11], s61 offen lds
sq_277:
s_add_u32 s62, s62, 4
s_add_u32 s61, s61, 32768
s_add_u32 m0, m0, 1024
s_bitcmp1_b32 s62, 5
s_cbranch_scc1 sq_278
buffer_load_dwordx4 v30, s[8:11], s61 offen lds
s_branch sq_279
sq_278:
buffer_load_dwordx4 v31, s[8:11], s61 offen lds
sq_279:
s_add_u32 s62, s62, 4
s_add_u32 s61, s61, 32768
s_add_u32 m0, m0, 1024
s_bitcmp1_b32 s62, 5
s_cbranch_scc1 sq_280
buffer_load_dwordx4 v30, s[8:11], s61 offen lds
s_branch sq_281
sq_280:
buffer_load_dwordx4 v31, s[8:11], s61 offen lds
sq_281:
s_add_u32 s62, s62, 4
s_add_u32 s61, s61, 32768
s_add_u32 m0, m0, 1024
s_bitcmp1_b32 s62, 5
s_cbranch_scc1 sq_282
buffer_load_dwordx4 v30, s[8:11], s61 offen lds
s_branch sq_283
sq_282:
buffer_load_dwordx4 v31, s[8:11], s61 offen lds
sq_283:
s_add_u32 s62, s62, 4
s_add_u32 s61, s61, 32768
s_add_u32 m0, m0, 1024
s_bitcmp1_b32 s62, 5
s_cbranch_scc1 sq_284
buffer_load_dwordx4 v30, s[8:11], s61 offen lds
s_branch sq_285
sq_284:
buffer_load_dwordx4 v31, s[8:11], s61 offen lds
sq_285:
s_add_u32 s62, s62, 4
s_add_u32 s61, s61, 32768
s_add_u32 m0, m0, 1024
s_bitcmp1_b32 s62, 5
s_cbranch_scc1 sq_286
buffer_load_dwordx4 v30, s[8:11], s61 offen lds
s_branch sq_287
sq_286:
buffer_load_dwordx4 v31, s[8:11], s61 offen lds
sq_287:
s_add_u32 s62, s62, 4
s_add_u32 s61, s61, 32768
s_add_u32 m0, m0, 1024
s_bitcmp1_b32 s62, 5
s_cbranch_scc1 sq_288
buffer_load_dwordx4 v30, s[8:11], s61 offen lds
s_branch sq_289
sq_288:
buffer_load_dwordx4 v31, s[8:11], s61 offen lds
sq_289:
s_add_u32 s62, s62, 4
s_add_u32 s61, s61, 32768
s_add_u32 m0, m0, 1024
s_bitcmp1_b32 s62, 5
s_cbranch_scc1 sq_290
buffer_load_dwordx4 v30, s[8:11], s61 offen lds
s_branch sq_291
sq_290:
buffer_load_dwordx4 v31, s[8:11], s61 offen lds
sq_291:
s_add_u32 s62, s62, 4
s_add_u32 s61, s61, 32768
s_add_u32 m0, m0, 1024
s_bitcmp1_b32 s62, 5
s_cbranch_scc1 sq_292
buffer_load_dwordx4 v30, s[8:11], s61 offen lds
s_branch sq_293
sq_292:
buffer_load_dwordx4 v31, s[8:11], s61 offen lds
sq_293:
s_add_u32 s62, s62, 4
s_add_u32 s61, s61, 32768
s_add_u32 m0, m0, 1024
s_bitcmp1_b32 s62, 5
s_cbranch_scc1 sq_294
buffer_load_dwordx4 v30, s[8:11], s61 offen lds
s_branch sq_295
sq_294:
buffer_load_dwordx4 v31, s[8:11], s61 offen lds
sq_295:
s_add_u32 s62, s62, 4
s_add_u32 s61, s61, 32768
s_add_u32 m0, m0, 1024
s_bitcmp1_b32 s62, 5
s_cbranch_scc1 sq_296
buffer_load_dwordx4 v30, s[8:11], s61 offen lds
s_branch sq_297
sq_296:
buffer_load_dwordx4 v31, s[8:11], s61 offen lds
sq_297:
s_add_u32 s62, s62, 4
s_add_u32 s61, s61, 32768
s_add_u32 m0, m0, 1024
s_bitcmp1_b32 s62, 5
s_cbranch_scc1 sq_298
buffer_load_dwordx4 v30, s[8:11], s61 offen lds
s_branch sq_299
sq_298:
buffer_load_dwordx4 v31, s[8:11], s61 offen lds
sq_299:
s_add_u32 s62, s62, 4
s_add_u32 s61, s61, 32768
s_add_u32 m0, m0, 1024
s_mov_b32 s8, s24
s_and_b32 s9, s25, 0xffff
s_mov_b32 s10, 4718592
s_mov_b32 s11, 0x20000
s_lshl_b32 s61, s51, 8
s_mul_i32 s60, s3, 393216
s_add_u32 s61, s61, s60
s_add_u32 s61, s61, 3145728
s_mul_i32 s60, s3, 12288
s_add_u32 m0, s60, 98304
s_mul_i32 s62, s3, 48
s_bitcmp1_b32 s62, 5
s_cbranch_scc1 sq_300
buffer_load_dwordx4 v30, s[8:11], s61 offen lds
s_branch sq_301
sq_300:
buffer_load_dwordx4 v31, s[8:11], s61 offen lds
sq_301:
s_add_u32 s62, s62, 4
s_add_u32 s61, s61, 32768
s_add_u32 m0, m0, 1024
s_bitcmp1_b32 s62, 5
s_cbranch_scc1 sq_302
buffer_load_dwordx4 v30, s[8:11], s61 offen lds
s_branch sq_303
sq_302:
buffer_load_dwordx4 v31, s[8:11], s61 offen lds
sq_303:
s_add_u32 s62, s62, 4
s_add_u32 s61, s61, 32768
s_add_u32 m0, m0, 1024
s_bitcmp1_b32 s62, 5
s_cbranch_scc1 sq_304
buffer_load_dwordx4 v30, s[8:11], s61 offen lds
s_branch sq_305
sq_304:
buffer_load_dwordx4 v31, s[8:11], s61 offen lds
sq_305:
s_add_u32 s62, s62, 4
s_add_u32 s61, s61, 32768
s_add_u32 m0, m0, 1024
s_bitcmp1_b32 s62, 5
s_cbranch_scc1 sq_306
buffer_load_dwordx4 v30, s[8:11], s61 offen lds
s_branch sq_307
sq_306:
buffer_load_dwordx4 v31, s[8:11], s61 offen lds
sq_307:
s_add_u32 s62, s62, 4
s_add_u32 s61, s61, 32768
s_add_u32 m0, m0, 1024
s_bitcmp1_b32 s62, 5
s_cbranch_scc1 sq_308
buffer_load_dwordx4 v30, s[8:11], s61 offen lds
s_branch sq_309
sq_308:
buffer_load_dwordx4 v31, s[8:11], s61 offen lds
sq_309:
s_add_u32 s62, s62, 4
s_add_u32 s61, s61, 32768
s_add_u32 m0, m0, 1024
s_bitcmp1_b32 s62, 5
s_cbranch_scc1 sq_310
buffer_load_dwordx4 v30, s[8:11], s61 offen lds
s_branch sq_311
sq_310:
buffer_load_dwordx4 v31, s[8:11], s61 offen lds
sq_311:
s_add_u32 s62, s62, 4
s_add_u32 s61, s61, 32768
s_add_u32 m0, m0, 1024
s_bitcmp1_b32 s62, 5
s_cbranch_scc1 sq_312
buffer_load_dwordx4 v30, s[8:11], s61 offen lds
s_branch sq_313
sq_312:
buffer_load_dwordx4 v31, s[8:11], s61 offen lds
sq_313:
s_add_u32 s62, s62, 4
s_add_u32 s61, s61, 32768
s_add_u32 m0, m0, 1024
s_bitcmp1_b32 s62, 5
s_cbranch_scc1 sq_314
buffer_load_dwordx4 v30, s[8:11], s61 offen lds
s_branch sq_315
sq_314:
buffer_load_dwordx4 v31, s[8:11], s61 offen lds
sq_315:
s_add_u32 s62, s62, 4
s_add_u32 s61, s61, 32768
s_add_u32 m0, m0, 1024
s_bitcmp1_b32 s62, 5
s_cbranch_scc1 sq_316
buffer_load_dwordx4 v30, s[8:11], s61 offen lds
s_branch sq_317
sq_316:
buffer_load_dwordx4 v31, s[8:11], s61 offen lds
sq_317:
s_add_u32 s62, s62, 4
s_add_u32 s61, s61, 32768
s_add_u32 m0, m0, 1024
s_bitcmp1_b32 s62, 5
s_cbranch_scc1 sq_318
buffer_load_dwordx4 v30, s[8:11], s61 offen lds
s_branch sq_319
sq_318:
buffer_load_dwordx4 v31, s[8:11], s61 offen lds
sq_319:
s_add_u32 s62, s62, 4
s_add_u32 s61, s61, 32768
s_add_u32 m0, m0, 1024
s_bitcmp1_b32 s62, 5
s_cbranch_scc1 sq_320
buffer_load_dwordx4 v30, s[8:11], s61 offen lds
s_branch sq_321
sq_320:
buffer_load_dwordx4 v31, s[8:11], s61 offen lds
sq_321:
s_add_u32 s62, s62, 4
s_add_u32 s61, s61, 32768
s_add_u32 m0, m0, 1024
s_bitcmp1_b32 s62, 5
s_cbranch_scc1 sq_322
buffer_load_dwordx4 v30, s[8:11], s61 offen lds
s_branch sq_323
sq_322:
buffer_load_dwordx4 v31, s[8:11], s61 offen lds
sq_323:
s_add_u32 s62, s62, 4
s_add_u32 s61, s61, 32768
s_add_u32 m0, m0, 1024
s_waitcnt vmcnt(24)
s_barrier
s_cmp_lg_u32 s3, 0
s_cbranch_scc1 cb_324
v_mov_b32 v24, s52
v_mov_b32 v25, s57
s_mov_b64 exec, 1
buffer_atomic_add v24, v25, s[12:15], 0 offen
s_mov_b64 exec, -1
cb_324:
v_bfe_u32 v24, v0, 4, 1
v_lshrrev_b32 v25, 5, v0
v_bfe_u32 v26, v0, 2, 2
v_lshlrev_b32 v27, 5, v24
v_lshl_add_u32 v27, v25, 3, v27
v_add_u32 v27, v27, v26
v_lshlrev_b32 v27, 8, v27
v_lshl_add_u32 v26, v24, 2, v26
s_lshl_b32 s60, s3, 1
s_add_u32 s60, s60, 0
v_xor_b32 v26, s60, v26
v_lshl_add_u32 v27, v26, 5, v27
v_and_b32 v26, 3, v0
v_lshl_add_u32 v28, v26, 3, v27
v_bfe_u32 v24, v0, 4, 1
v_lshrrev_b32 v25, 5, v0
v_bfe_u32 v26, v0, 2, 2
v_lshlrev_b32 v27, 5, v24
v_lshl_add_u32 v27, v25, 3, v27
v_add_u32 v27, v27, v26
v_lshlrev_b32 v27, 8, v27
v_lshl_add_u32 v26, v24, 2, v26
s_lshl_b32 s60, s3, 1
s_add_u32 s60, s60, 1
v_xor_b32 v26, s60, v26
v_lshl_add_u32 v27, v26, 5, v27
v_and_b32 v26, 3, v0
v_lshl_add_u32 v29, v26, 3, v27
ds_read_b64_tr_b16 a[0:1], v28 offset:0
ds_read_b64_tr_b16 a[2:3], v28 offset:1024
ds_read_b64_tr_b16 a[4:5], v28 offset:4096
ds_read_b64_tr_b16 a[6:7], v28 offset:5120
ds_read_b64_tr_b16 a[72:73], v29 offset:0
ds_read_b64_tr_b16 a[74:75], v29 offset:1024
ds_read_b64_tr_b16 a[76:77], v29 offset:4096
ds_read_b64_tr_b16 a[78:79], v29 offset:5120
s_waitcnt lgkmcnt(0)
ds_read_b64_tr_b16 a[8:9], v28 offset:16384
ds_read_b64_tr_b16 a[10:11], v28 offset:17408
ds_read_b64_tr_b16 a[12:13], v28 offset:20480
ds_read_b64_tr_b16 a[14:15], v28 offset:21504
ds_read_b64_tr_b16 a[80:81], v29 offset:16384
ds_read_b64_tr_b16 a[82:83], v29 offset:17408
ds_read_b64_tr_b16 a[84:85], v29 offset:20480
ds_read_b64_tr_b16 a[86:87], v29 offset:21504
s_waitcnt lgkmcnt(0)
ds_read_b64_tr_b16 a[16:17], v28 offset:32768
ds_read_b64_tr_b16 a[18:19], v28 offset:33792
ds_read_b64_tr_b16 a[20:21], v28 offset:36864
ds_read_b64_tr_b16 a[22:23], v28 offset:37888
ds_read_b64_tr_b16 a[88:89], v29 offset:32768
ds_read_b64_tr_b16 a[90:91], v29 offset:33792
ds_read_b64_tr_b16 a[92:93], v29 offset:36864
ds_read_b64_tr_b16 a[94:95], v29 offset:37888
s_waitcnt lgkmcnt(0)
s_barrier
s_mov_b32 s8, s26
s_and_b32 s9, s27, 0xffff
s_mov_b32 s10, 4718592
s_mov_b32 s11, 0x20000
s_lshl_b32 s61, s51, 8
s_mul_i32 s60, s3, 393216
s_add_u32 s61, s61, s60
s_add_u32 s61, s61, 0
s_mul_i32 s60, s3, 12288
s_add_u32 m0, s60, 0
s_mul_i32 s62, s3, 48
s_bitcmp1_b32 s62, 5
s_cbranch_scc1 sq_325
buffer_load_dwordx4 v30, s[8:11], s61 offen lds
s_branch sq_326
sq_325:
buffer_load_dwordx4 v31, s[8:11], s61 offen lds
sq_326:
s_add_u32 s62, s62, 4
s_add_u32 s61, s61, 32768
s_add_u32 m0, m0, 1024
s_bitcmp1_b32 s62, 5
s_cbranch_scc1 sq_327
buffer_load_dwordx4 v30, s[8:11], s61 offen lds
s_branch sq_328
sq_327:
buffer_load_dwordx4 v31, s[8:11], s61 offen lds
sq_328:
s_add_u32 s62, s62, 4
s_add_u32 s61, s61, 32768
s_add_u32 m0, m0, 1024
s_bitcmp1_b32 s62, 5
s_cbranch_scc1 sq_329
buffer_load_dwordx4 v30, s[8:11], s61 offen lds
s_branch sq_330
sq_329:
buffer_load_dwordx4 v31, s[8:11], s61 offen lds
sq_330:
s_add_u32 s62, s62, 4
s_add_u32 s61, s61, 32768
s_add_u32 m0, m0, 1024
s_bitcmp1_b32 s62, 5
s_cbranch_scc1 sq_331
buffer_load_dwordx4 v30, s[8:11], s61 offen lds
s_branch sq_332
sq_331:
buffer_load_dwordx4 v31, s[8:11], s61 offen lds
sq_332:
s_add_u32 s62, s62, 4
s_add_u32 s61, s61, 32768
s_add_u32 m0, m0, 1024
s_bitcmp1_b32 s62, 5
s_cbranch_scc1 sq_333
buffer_load_dwordx4 v30, s[8:11], s61 offen lds
s_branch sq_334
sq_333:
buffer_load_dwordx4 v31, s[8:11], s61 offen lds
sq_334:
s_add_u32 s62, s62, 4
s_add_u32 s61, s61, 32768
s_add_u32 m0, m0, 1024
s_bitcmp1_b32 s62, 5
s_cbranch_scc1 sq_335
buffer_load_dwordx4 v30, s[8:11], s61 offen lds
s_branch sq_336
sq_335:
buffer_load_dwordx4 v31, s[8:11], s61 offen lds
sq_336:
s_add_u32 s62, s62, 4
s_add_u32 s61, s61, 32768
s_add_u32 m0, m0, 1024
s_bitcmp1_b32 s62, 5
s_cbranch_scc1 sq_337
buffer_load_dwordx4 v30, s[8:11], s61 offen lds
s_branch sq_338
sq_337:
buffer_load_dwordx4 v31, s[8:11], s61 offen lds
sq_338:
s_add_u32 s62, s62, 4
s_add_u32 s61, s61, 32768
s_add_u32 m0, m0, 1024
s_bitcmp1_b32 s62, 5
s_cbranch_scc1 sq_339
buffer_load_dwordx4 v30, s[8:11], s61 offen lds
s_branch sq_340
sq_339:
buffer_load_dwordx4 v31, s[8:11], s61 offen lds
sq_340:
s_add_u32 s62, s62, 4
s_add_u32 s61, s61, 32768
s_add_u32 m0, m0, 1024
s_bitcmp1_b32 s62, 5
s_cbranch_scc1 sq_341
buffer_load_dwordx4 v30, s[8:11], s61 offen lds
s_branch sq_342
sq_341:
buffer_load_dwordx4 v31, s[8:11], s61 offen lds
sq_342:
s_add_u32 s62, s62, 4
s_add_u32 s61, s61, 32768
s_add_u32 m0, m0, 1024
s_bitcmp1_b32 s62, 5
s_cbranch_scc1 sq_343
buffer_load_dwordx4 v30, s[8:11], s61 offen lds
s_branch sq_344
sq_343:
buffer_load_dwordx4 v31, s[8:11], s61 offen lds
sq_344:
s_add_u32 s62, s62, 4
s_add_u32 s61, s61, 32768
s_add_u32 m0, m0, 1024
s_bitcmp1_b32 s62, 5
s_cbranch_scc1 sq_345
buffer_load_dwordx4 v30, s[8:11], s61 offen lds
s_branch sq_346
sq_345:
buffer_load_dwordx4 v31, s[8:11], s61 offen lds
sq_346:
s_add_u32 s62, s62, 4
s_add_u32 s61, s61, 32768
s_add_u32 m0, m0, 1024
s_bitcmp1_b32 s62, 5
s_cbranch_scc1 sq_347
buffer_load_dwordx4 v30, s[8:11], s61 offen lds
s_branch sq_348
sq_347:
buffer_load_dwordx4 v31, s[8:11], s61 offen lds
sq_348:
s_add_u32 s62, s62, 4
s_add_u32 s61, s61, 32768
s_add_u32 m0, m0, 1024
s_waitcnt vmcnt(24)
s_barrier
v_bfe_u32 v24, v0, 4, 1
v_lshrrev_b32 v25, 5, v0
v_bfe_u32 v26, v0, 2, 2
v_lshlrev_b32 v27, 5, v24
v_lshl_add_u32 v27, v25, 3, v27
v_add_u32 v27, v27, v26
v_lshlrev_b32 v27, 8, v27
v_lshl_add_u32 v26, v24, 2, v26
s_lshl_b32 s60, s3, 1
s_add_u32 s60, s60, 0
v_xor_b32 v26, s60, v26
v_lshl_add_u32 v27, v26, 5, v27
v_and_b32 v26, 3, v0
v_lshl_add_u32 v28, v26, 3, v27
v_add_u32 v28, 49152, v28
v_bfe_u32 v24, v0, 4, 1
v_lshrrev_b32 v25, 5, v0
v_bfe_u32 v26, v0, 2, 2
v_lshlrev_b32 v27, 5, v24
v_lshl_add_u32 v27, v25, 3, v27
v_add_u32 v27, v27, v26
v_lshlrev_b32 v27, 8, v27
v_lshl_add_u32 v26, v24, 2, v26
s_lshl_b32 s60, s3, 1
s_add_u32 s60, s60, 1
v_xor_b32 v26, s60, v26
v_lshl_add_u32 v27, v26, 5, v27
v_and_b32 v26, 3, v0
v_lshl_add_u32 v29, v26, 3, v27
v_add_u32 v29, 49152, v29
ds_read_b64_tr_b16 a[24:25], v28 offset:0
ds_read_b64_tr_b16 a[26:27], v28 offset:1024
ds_read_b64_tr_b16 a[28:29], v28 offset:4096
ds_read_b64_tr_b16 a[30:31], v28 offset:5120
ds_read_b64_tr_b16 a[96:97], v29 offset:0
ds_read_b64_tr_b16 a[98:99], v29 offset:1024
ds_read_b64_tr_b16 a[100:101], v29 offset:4096
ds_read_b64_tr_b16 a[102:103], v29 offset:5120
s_waitcnt lgkmcnt(0)
ds_read_b64_tr_b16 a[32:33], v28 offset:16384
ds_read_b64_tr_b16 a[34:35], v28 offset:17408
ds_read_b64_tr_b16 a[36:37], v28 offset:20480
ds_read_b64_tr_b16 a[38:39], v28 offset:21504
ds_read_b64_tr_b16 a[104:105], v29 offset:16384
ds_read_b64_tr_b16 a[106:107], v29 offset:17408
ds_read_b64_tr_b16 a[108:109], v29 offset:20480
ds_read_b64_tr_b16 a[110:111], v29 offset:21504
s_waitcnt lgkmcnt(0)
ds_read_b64_tr_b16 a[40:41], v28 offset:32768
ds_read_b64_tr_b16 a[42:43], v28 offset:33792
ds_read_b64_tr_b16 a[44:45], v28 offset:36864
ds_read_b64_tr_b16 a[46:47], v28 offset:37888
ds_read_b64_tr_b16 a[112:113], v29 offset:32768
ds_read_b64_tr_b16 a[114:115], v29 offset:33792
ds_read_b64_tr_b16 a[116:117], v29 offset:36864
ds_read_b64_tr_b16 a[118:119], v29 offset:37888
s_waitcnt lgkmcnt(0)
s_barrier
s_mov_b32 s8, s26
s_and_b32 s9, s27, 0xffff
s_mov_b32 s10, 4718592
s_mov_b32 s11, 0x20000
s_lshl_b32 s61, s51, 8
s_mul_i32 s60, s3, 393216
s_add_u32 s61, s61, s60
s_add_u32 s61, s61, 1572864
s_mul_i32 s60, s3, 12288
s_add_u32 m0, s60, 49152
s_mul_i32 s62, s3, 48
s_bitcmp1_b32 s62, 5
s_cbranch_scc1 sq_349
buffer_load_dwordx4 v30, s[8:11], s61 offen lds
s_branch sq_350
sq_349:
buffer_load_dwordx4 v31, s[8:11], s61 offen lds
sq_350:
s_add_u32 s62, s62, 4
s_add_u32 s61, s61, 32768
s_add_u32 m0, m0, 1024
s_bitcmp1_b32 s62, 5
s_cbranch_scc1 sq_351
buffer_load_dwordx4 v30, s[8:11], s61 offen lds
s_branch sq_352
sq_351:
buffer_load_dwordx4 v31, s[8:11], s61 offen lds
sq_352:
s_add_u32 s62, s62, 4
s_add_u32 s61, s61, 32768
s_add_u32 m0, m0, 1024
s_bitcmp1_b32 s62, 5
s_cbranch_scc1 sq_353
buffer_load_dwordx4 v30, s[8:11], s61 offen lds
s_branch sq_354
sq_353:
buffer_load_dwordx4 v31, s[8:11], s61 offen lds
sq_354:
s_add_u32 s62, s62, 4
s_add_u32 s61, s61, 32768
s_add_u32 m0, m0, 1024
s_bitcmp1_b32 s62, 5
s_cbranch_scc1 sq_355
buffer_load_dwordx4 v30, s[8:11], s61 offen lds
s_branch sq_356
sq_355:
buffer_load_dwordx4 v31, s[8:11], s61 offen lds
sq_356:
s_add_u32 s62, s62, 4
s_add_u32 s61, s61, 32768
s_add_u32 m0, m0, 1024
s_bitcmp1_b32 s62, 5
s_cbranch_scc1 sq_357
buffer_load_dwordx4 v30, s[8:11], s61 offen lds
s_branch sq_358
sq_357:
buffer_load_dwordx4 v31, s[8:11], s61 offen lds
sq_358:
s_add_u32 s62, s62, 4
s_add_u32 s61, s61, 32768
s_add_u32 m0, m0, 1024
s_bitcmp1_b32 s62, 5
s_cbranch_scc1 sq_359
buffer_load_dwordx4 v30, s[8:11], s61 offen lds
s_branch sq_360
sq_359:
buffer_load_dwordx4 v31, s[8:11], s61 offen lds
sq_360:
s_add_u32 s62, s62, 4
s_add_u32 s61, s61, 32768
s_add_u32 m0, m0, 1024
s_bitcmp1_b32 s62, 5
s_cbranch_scc1 sq_361
buffer_load_dwordx4 v30, s[8:11], s61 offen lds
s_branch sq_362
sq_361:
buffer_load_dwordx4 v31, s[8:11], s61 offen lds
sq_362:
s_add_u32 s62, s62, 4
s_add_u32 s61, s61, 32768
s_add_u32 m0, m0, 1024
s_bitcmp1_b32 s62, 5
s_cbranch_scc1 sq_363
buffer_load_dwordx4 v30, s[8:11], s61 offen lds
s_branch sq_364
sq_363:
buffer_load_dwordx4 v31, s[8:11], s61 offen lds
sq_364:
s_add_u32 s62, s62, 4
s_add_u32 s61, s61, 32768
s_add_u32 m0, m0, 1024
s_bitcmp1_b32 s62, 5
s_cbranch_scc1 sq_365
buffer_load_dwordx4 v30, s[8:11], s61 offen lds
s_branch sq_366
sq_365:
buffer_load_dwordx4 v31, s[8:11], s61 offen lds
sq_366:
s_add_u32 s62, s62, 4
s_add_u32 s61, s61, 32768
s_add_u32 m0, m0, 1024
s_bitcmp1_b32 s62, 5
s_cbranch_scc1 sq_367
buffer_load_dwordx4 v30, s[8:11], s61 offen lds
s_branch sq_368
sq_367:
buffer_load_dwordx4 v31, s[8:11], s61 offen lds
sq_368:
s_add_u32 s62, s62, 4
s_add_u32 s61, s61, 32768
s_add_u32 m0, m0, 1024
s_bitcmp1_b32 s62, 5
s_cbranch_scc1 sq_369
buffer_load_dwordx4 v30, s[8:11], s61 offen lds
s_branch sq_370
sq_369:
buffer_load_dwordx4 v31, s[8:11], s61 offen lds
sq_370:
s_add_u32 s62, s62, 4
s_add_u32 s61, s61, 32768
s_add_u32 m0, m0, 1024
s_bitcmp1_b32 s62, 5
s_cbranch_scc1 sq_371
buffer_load_dwordx4 v30, s[8:11], s61 offen lds
s_branch sq_372
sq_371:
buffer_load_dwordx4 v31, s[8:11], s61 offen lds
sq_372:
s_add_u32 s62, s62, 4
s_add_u32 s61, s61, 32768
s_add_u32 m0, m0, 1024
s_waitcnt vmcnt(24)
s_barrier
v_bfe_u32 v24, v0, 4, 1
v_lshrrev_b32 v25, 5, v0
v_bfe_u32 v26, v0, 2, 2
v_lshlrev_b32 v27, 5, v24
v_lshl_add_u32 v27, v25, 3, v27
v_add_u32 v27, v27, v26
v_lshlrev_b32 v27, 8, v27
v_lshl_add_u32 v26, v24, 2, v26
s_lshl_b32 s60, s3, 1
s_add_u32 s60, s60, 0
v_xor_b32 v26, s60, v26
v_lshl_add_u32 v27, v26, 5, v27
v_and_b32 v26, 3, v0
v_lshl_add_u32 v28, v26, 3, v27
v_add_u32 v28, 98304, v28
v_bfe_u32 v24, v0, 4, 1
v_lshrrev_b32 v25, 5, v0
v_bfe_u32 v26, v0, 2, 2
v_lshlrev_b32 v27, 5, v24
v_lshl_add_u32 v27, v25, 3, v27
v_add_u32 v27, v27, v26
v_lshlrev_b32 v27, 8, v27
v_lshl_add_u32 v26, v24, 2, v26
s_lshl_b32 s60, s3, 1
s_add_u32 s60, s60, 1
v_xor_b32 v26, s60, v26
v_lshl_add_u32 v27, v26, 5, v27
v_and_b32 v26, 3, v0
v_lshl_add_u32 v29, v26, 3, v27
v_add_u32 v29, 98304, v29
ds_read_b64_tr_b16 a[48:49], v28 offset:0
ds_read_b64_tr_b16 a[50:51], v28 offset:1024
ds_read_b64_tr_b16 a[52:53], v28 offset:4096
ds_read_b64_tr_b16 a[54:55], v28 offset:5120
ds_read_b64_tr_b16 a[120:121], v29 offset:0
ds_read_b64_tr_b16 a[122:123], v29 offset:1024
ds_read_b64_tr_b16 a[124:125], v29 offset:4096
ds_read_b64_tr_b16 a[126:127], v29 offset:5120
s_waitcnt lgkmcnt(0)
ds_read_b64_tr_b16 a[56:57], v28 offset:16384
ds_read_b64_tr_b16 a[58:59], v28 offset:17408
ds_read_b64_tr_b16 a[60:61], v28 offset:20480
ds_read_b64_tr_b16 a[62:63], v28 offset:21504
ds_read_b64_tr_b16 a[128:129], v29 offset:16384
ds_read_b64_tr_b16 a[130:131], v29 offset:17408
ds_read_b64_tr_b16 a[132:133], v29 offset:20480
ds_read_b64_tr_b16 a[134:135], v29 offset:21504
s_waitcnt lgkmcnt(0)
ds_read_b64_tr_b16 a[64:65], v28 offset:32768
ds_read_b64_tr_b16 a[66:67], v28 offset:33792
ds_read_b64_tr_b16 a[68:69], v28 offset:36864
ds_read_b64_tr_b16 a[70:71], v28 offset:37888
ds_read_b64_tr_b16 a[136:137], v29 offset:32768
ds_read_b64_tr_b16 a[138:139], v29 offset:33792
ds_read_b64_tr_b16 a[140:141], v29 offset:36864
ds_read_b64_tr_b16 a[142:143], v29 offset:37888
s_waitcnt lgkmcnt(0)
s_barrier
s_mov_b32 s8, s26
s_and_b32 s9, s27, 0xffff
s_mov_b32 s10, 4718592
s_mov_b32 s11, 0x20000
s_lshl_b32 s61, s51, 8
s_mul_i32 s60, s3, 393216
s_add_u32 s61, s61, s60
s_add_u32 s61, s61, 3145728
s_mul_i32 s60, s3, 12288
s_add_u32 m0, s60, 98304
s_mul_i32 s62, s3, 48
s_bitcmp1_b32 s62, 5
s_cbranch_scc1 sq_373
buffer_load_dwordx4 v30, s[8:11], s61 offen lds
s_branch sq_374
sq_373:
buffer_load_dwordx4 v31, s[8:11], s61 offen lds
sq_374:
s_add_u32 s62, s62, 4
s_add_u32 s61, s61, 32768
s_add_u32 m0, m0, 1024
s_bitcmp1_b32 s62, 5
s_cbranch_scc1 sq_375
buffer_load_dwordx4 v30, s[8:11], s61 offen lds
s_branch sq_376
sq_375:
buffer_load_dwordx4 v31, s[8:11], s61 offen lds
sq_376:
s_add_u32 s62, s62, 4
s_add_u32 s61, s61, 32768
s_add_u32 m0, m0, 1024
s_bitcmp1_b32 s62, 5
s_cbranch_scc1 sq_377
buffer_load_dwordx4 v30, s[8:11], s61 offen lds
s_branch sq_378
sq_377:
buffer_load_dwordx4 v31, s[8:11], s61 offen lds
sq_378:
s_add_u32 s62, s62, 4
s_add_u32 s61, s61, 32768
s_add_u32 m0, m0, 1024
s_bitcmp1_b32 s62, 5
s_cbranch_scc1 sq_379
buffer_load_dwordx4 v30, s[8:11], s61 offen lds
s_branch sq_380
sq_379:
buffer_load_dwordx4 v31, s[8:11], s61 offen lds
sq_380:
s_add_u32 s62, s62, 4
s_add_u32 s61, s61, 32768
s_add_u32 m0, m0, 1024
s_bitcmp1_b32 s62, 5
s_cbranch_scc1 sq_381
buffer_load_dwordx4 v30, s[8:11], s61 offen lds
s_branch sq_382
sq_381:
buffer_load_dwordx4 v31, s[8:11], s61 offen lds
sq_382:
s_add_u32 s62, s62, 4
s_add_u32 s61, s61, 32768
s_add_u32 m0, m0, 1024
s_bitcmp1_b32 s62, 5
s_cbranch_scc1 sq_383
buffer_load_dwordx4 v30, s[8:11], s61 offen lds
s_branch sq_384
sq_383:
buffer_load_dwordx4 v31, s[8:11], s61 offen lds
sq_384:
s_add_u32 s62, s62, 4
s_add_u32 s61, s61, 32768
s_add_u32 m0, m0, 1024
s_bitcmp1_b32 s62, 5
s_cbranch_scc1 sq_385
buffer_load_dwordx4 v30, s[8:11], s61 offen lds
s_branch sq_386
sq_385:
buffer_load_dwordx4 v31, s[8:11], s61 offen lds
sq_386:
s_add_u32 s62, s62, 4
s_add_u32 s61, s61, 32768
s_add_u32 m0, m0, 1024
s_bitcmp1_b32 s62, 5
s_cbranch_scc1 sq_387
buffer_load_dwordx4 v30, s[8:11], s61 offen lds
s_branch sq_388
sq_387:
buffer_load_dwordx4 v31, s[8:11], s61 offen lds
sq_388:
s_add_u32 s62, s62, 4
s_add_u32 s61, s61, 32768
s_add_u32 m0, m0, 1024
s_bitcmp1_b32 s62, 5
s_cbranch_scc1 sq_389
buffer_load_dwordx4 v30, s[8:11], s61 offen lds
s_branch sq_390
sq_389:
buffer_load_dwordx4 v31, s[8:11], s61 offen lds
sq_390:
s_add_u32 s62, s62, 4
s_add_u32 s61, s61, 32768
s_add_u32 m0, m0, 1024
s_bitcmp1_b32 s62, 5
s_cbranch_scc1 sq_391
buffer_load_dwordx4 v30, s[8:11], s61 offen lds
s_branch sq_392
sq_391:
buffer_load_dwordx4 v31, s[8:11], s61 offen lds
sq_392:
s_add_u32 s62, s62, 4
s_add_u32 s61, s61, 32768
s_add_u32 m0, m0, 1024
s_bitcmp1_b32 s62, 5
s_cbranch_scc1 sq_393
buffer_load_dwordx4 v30, s[8:11], s61 offen lds
s_branch sq_394
sq_393:
buffer_load_dwordx4 v31, s[8:11], s61 offen lds
sq_394:
s_add_u32 s62, s62, 4
s_add_u32 s61, s61, 32768
s_add_u32 m0, m0, 1024
s_bitcmp1_b32 s62, 5
s_cbranch_scc1 sq_395
buffer_load_dwordx4 v30, s[8:11], s61 offen lds
s_branch sq_396
sq_395:
buffer_load_dwordx4 v31, s[8:11], s61 offen lds
sq_396:
s_add_u32 s62, s62, 4
s_add_u32 s61, s61, 32768
s_add_u32 m0, m0, 1024
s_waitcnt vmcnt(24)
s_barrier
v_bfe_u32 v24, v0, 4, 1
v_lshrrev_b32 v25, 5, v0
v_bfe_u32 v26, v0, 2, 2
v_lshlrev_b32 v27, 5, v24
v_lshl_add_u32 v27, v25, 3, v27
v_add_u32 v27, v27, v26
v_lshlrev_b32 v27, 8, v27
v_lshl_add_u32 v26, v24, 2, v26
s_lshl_b32 s60, s3, 1
s_add_u32 s60, s60, 0
v_xor_b32 v26, s60, v26
v_lshl_add_u32 v27, v26, 5, v27
v_and_b32 v26, 3, v0
v_lshl_add_u32 v28, v26, 3, v27
v_bfe_u32 v24, v0, 4, 1
v_lshrrev_b32 v25, 5, v0
v_bfe_u32 v26, v0, 2, 2
v_lshlrev_b32 v27, 5, v24
v_lshl_add_u32 v27, v25, 3, v27
v_add_u32 v27, v27, v26
v_lshlrev_b32 v27, 8, v27
v_lshl_add_u32 v26, v24, 2, v26
s_lshl_b32 s60, s3, 1
s_add_u32 s60, s60, 1
v_xor_b32 v26, s60, v26
v_lshl_add_u32 v27, v26, 5, v27
v_and_b32 v26, 3, v0
v_lshl_add_u32 v29, v26, 3, v27
ds_read_b64_tr_b16 a[144:145], v28 offset:0
ds_read_b64_tr_b16 a[146:147], v28 offset:1024
ds_read_b64_tr_b16 a[148:149], v28 offset:4096
ds_read_b64_tr_b16 a[150:151], v28 offset:5120
ds_read_b64_tr_b16 a[216:217], v29 offset:0
ds_read_b64_tr_b16 a[218:219], v29 offset:1024
ds_read_b64_tr_b16 a[220:221], v29 offset:4096
ds_read_b64_tr_b16 a[222:223], v29 offset:5120
s_waitcnt lgkmcnt(0)
ds_read_b64_tr_b16 a[152:153], v28 offset:16384
ds_read_b64_tr_b16 a[154:155], v28 offset:17408
ds_read_b64_tr_b16 a[156:157], v28 offset:20480
ds_read_b64_tr_b16 a[158:159], v28 offset:21504
ds_read_b64_tr_b16 a[224:225], v29 offset:16384
ds_read_b64_tr_b16 a[226:227], v29 offset:17408
ds_read_b64_tr_b16 a[228:229], v29 offset:20480
ds_read_b64_tr_b16 a[230:231], v29 offset:21504
s_waitcnt lgkmcnt(0)
ds_read_b64_tr_b16 a[160:161], v28 offset:32768
ds_read_b64_tr_b16 a[162:163], v28 offset:33792
ds_read_b64_tr_b16 a[164:165], v28 offset:36864
ds_read_b64_tr_b16 a[166:167], v28 offset:37888
ds_read_b64_tr_b16 a[232:233], v29 offset:32768
ds_read_b64_tr_b16 a[234:235], v29 offset:33792
ds_read_b64_tr_b16 a[236:237], v29 offset:36864
ds_read_b64_tr_b16 a[238:239], v29 offset:37888
s_waitcnt lgkmcnt(0)
s_barrier
s_mov_b32 s8, s30
s_and_b32 s9, s31, 0xffff
s_mov_b32 s10, 4718592
s_mov_b32 s11, 0x20000
s_mul_i32 s61, s51, 147456
s_mul_i32 s60, s3, 9216
s_add_u32 s61, s61, s60
s_add_u32 s61, s61, 0
s_add_u32 m0, s60, 0
s_nop 0
buffer_load_dwordx4 v1, s[8:11], s61 offen lds
s_add_u32 s61, s61, 1024
s_add_u32 m0, m0, 1024
s_nop 0
buffer_load_dwordx4 v1, s[8:11], s61 offen lds
s_add_u32 s61, s61, 1024
s_add_u32 m0, m0, 1024
s_nop 0
buffer_load_dwordx4 v1, s[8:11], s61 offen lds
s_add_u32 s61, s61, 1024
s_add_u32 m0, m0, 1024
s_nop 0
buffer_load_dwordx4 v1, s[8:11], s61 offen lds
s_add_u32 s61, s61, 1024
s_add_u32 m0, m0, 1024
s_nop 0
buffer_load_dwordx4 v1, s[8:11], s61 offen lds
s_add_u32 s61, s61, 1024
s_add_u32 m0, m0, 1024
s_nop 0
buffer_load_dwordx4 v1, s[8:11], s61 offen lds
s_add_u32 s61, s61, 1024
s_add_u32 m0, m0, 1024
s_nop 0
buffer_load_dwordx4 v1, s[8:11], s61 offen lds
s_add_u32 s61, s61, 1024
s_add_u32 m0, m0, 1024
s_nop 0
buffer_load_dwordx4 v1, s[8:11], s61 offen lds
s_add_u32 s61, s61, 1024
s_add_u32 m0, m0, 1024
s_nop 0
buffer_load_dwordx4 v1, s[8:11], s61 offen lds
s_add_u32 s61, s61, 1024
s_add_u32 m0, m0, 1024
s_waitcnt vmcnt(21)
s_barrier
v_bfe_u32 v24, v0, 4, 1
v_lshrrev_b32 v25, 5, v0
v_bfe_u32 v26, v0, 2, 2
v_lshlrev_b32 v27, 5, v24
v_lshl_add_u32 v27, v25, 3, v27
v_add_u32 v27, v27, v26
v_lshlrev_b32 v27, 8, v27
v_lshl_add_u32 v26, v24, 2, v26
s_lshl_b32 s60, s3, 1
s_add_u32 s60, s60, 0
v_xor_b32 v26, s60, v26
v_lshl_add_u32 v27, v26, 5, v27
v_and_b32 v26, 3, v0
v_lshl_add_u32 v28, v26, 3, v27
v_add_u32 v28, 49152, v28
v_bfe_u32 v24, v0, 4, 1
v_lshrrev_b32 v25, 5, v0
v_bfe_u32 v26, v0, 2, 2
v_lshlrev_b32 v27, 5, v24
v_lshl_add_u32 v27, v25, 3, v27
v_add_u32 v27, v27, v26
v_lshlrev_b32 v27, 8, v27
v_lshl_add_u32 v26, v24, 2, v26
s_lshl_b32 s60, s3, 1
s_add_u32 s60, s60, 1
v_xor_b32 v26, s60, v26
v_lshl_add_u32 v27, v26, 5, v27
v_and_b32 v26, 3, v0
v_lshl_add_u32 v29, v26, 3, v27
v_add_u32 v29, 49152, v29
ds_read_b64_tr_b16 a[168:169], v28 offset:0
ds_read_b64_tr_b16 a[170:171], v28 offset:1024
ds_read_b64_tr_b16 a[172:173], v28 offset:4096
ds_read_b64_tr_b16 a[174:175], v28 offset:5120
ds_read_b64_tr_b16 a[240:241], v29 offset:0
ds_read_b64_tr_b16 a[242:243], v29 offset:1024
ds_read_b64_tr_b16 a[244:245], v29 offset:4096
ds_read_b64_tr_b16 a[246:247], v29 offset:5120
s_waitcnt lgkmcnt(0)
ds_read_b64_tr_b16 a[176:177], v28 offset:16384
ds_read_b64_tr_b16 a[178:179], v28 offset:17408
ds_read_b64_tr_b16 a[180:181], v28 offset:20480
ds_read_b64_tr_b16 a[182:183], v28 offset:21504
ds_read_b64_tr_b16 a[248:249], v29 offset:16384
ds_read_b64_tr_b16 a[250:251], v29 offset:17408
ds_read_b64_tr_b16 a[252:253], v29 offset:20480
ds_read_b64_tr_b16 a[254:255], v29 offset:21504
s_waitcnt lgkmcnt(0)
ds_read_b64_tr_b16 a[184:185], v28 offset:32768
ds_read_b64_tr_b16 a[186:187], v28 offset:33792
ds_read_b64_tr_b16 a[188:189], v28 offset:36864
ds_read_b64_tr_b16 a[190:191], v28 offset:37888
ds_read_b64_tr_b16 v[72:73], v29 offset:32768
ds_read_b64_tr_b16 v[74:75], v29 offset:33792
ds_read_b64_tr_b16 v[76:77], v29 offset:36864
ds_read_b64_tr_b16 v[78:79], v29 offset:37888
s_waitcnt lgkmcnt(0)
s_barrier
s_mov_b32 s8, s30
s_and_b32 s9, s31, 0xffff
s_mov_b32 s10, 4718592
s_mov_b32 s11, 0x20000
s_mul_i32 s61, s51, 147456
s_mul_i32 s60, s3, 9216
s_add_u32 s61, s61, s60
s_add_u32 s61, s61, 36864
s_add_u32 m0, s60, 49152
s_nop 0
buffer_load_dwordx4 v1, s[8:11], s61 offen lds
s_add_u32 s61, s61, 1024
s_add_u32 m0, m0, 1024
s_nop 0
buffer_load_dwordx4 v1, s[8:11], s61 offen lds
s_add_u32 s61, s61, 1024
s_add_u32 m0, m0, 1024
s_nop 0
buffer_load_dwordx4 v1, s[8:11], s61 offen lds
s_add_u32 s61, s61, 1024
s_add_u32 m0, m0, 1024
s_nop 0
buffer_load_dwordx4 v1, s[8:11], s61 offen lds
s_add_u32 s61, s61, 1024
s_add_u32 m0, m0, 1024
s_nop 0
buffer_load_dwordx4 v1, s[8:11], s61 offen lds
s_add_u32 s61, s61, 1024
s_add_u32 m0, m0, 1024
s_nop 0
buffer_load_dwordx4 v1, s[8:11], s61 offen lds
s_add_u32 s61, s61, 1024
s_add_u32 m0, m0, 1024
s_nop 0
buffer_load_dwordx4 v1, s[8:11], s61 offen lds
s_add_u32 s61, s61, 1024
s_add_u32 m0, m0, 1024
s_nop 0
buffer_load_dwordx4 v1, s[8:11], s61 offen lds
s_add_u32 s61, s61, 1024
s_add_u32 m0, m0, 1024
s_nop 0
buffer_load_dwordx4 v1, s[8:11], s61 offen lds
s_add_u32 s61, s61, 1024
s_add_u32 m0, m0, 1024
s_waitcnt vmcnt(18)
s_barrier
v_bfe_u32 v24, v0, 4, 1
v_lshrrev_b32 v25, 5, v0
v_bfe_u32 v26, v0, 2, 2
v_lshlrev_b32 v27, 5, v24
v_lshl_add_u32 v27, v25, 3, v27
v_add_u32 v27, v27, v26
v_lshlrev_b32 v27, 8, v27
v_lshl_add_u32 v26, v24, 2, v26
s_lshl_b32 s60, s3, 1
s_add_u32 s60, s60, 0
v_xor_b32 v26, s60, v26
v_lshl_add_u32 v27, v26, 5, v27
v_and_b32 v26, 3, v0
v_lshl_add_u32 v28, v26, 3, v27
v_add_u32 v28, 98304, v28
v_bfe_u32 v24, v0, 4, 1
v_lshrrev_b32 v25, 5, v0
v_bfe_u32 v26, v0, 2, 2
v_lshlrev_b32 v27, 5, v24
v_lshl_add_u32 v27, v25, 3, v27
v_add_u32 v27, v27, v26
v_lshlrev_b32 v27, 8, v27
v_lshl_add_u32 v26, v24, 2, v26
s_lshl_b32 s60, s3, 1
s_add_u32 s60, s60, 1
v_xor_b32 v26, s60, v26
v_lshl_add_u32 v27, v26, 5, v27
v_and_b32 v26, 3, v0
v_lshl_add_u32 v29, v26, 3, v27
v_add_u32 v29, 98304, v29
ds_read_b64_tr_b16 a[192:193], v28 offset:0
ds_read_b64_tr_b16 a[194:195], v28 offset:1024
ds_read_b64_tr_b16 a[196:197], v28 offset:4096
ds_read_b64_tr_b16 a[198:199], v28 offset:5120
ds_read_b64_tr_b16 v[80:81], v29 offset:0
ds_read_b64_tr_b16 v[82:83], v29 offset:1024
ds_read_b64_tr_b16 v[84:85], v29 offset:4096
ds_read_b64_tr_b16 v[86:87], v29 offset:5120
s_waitcnt lgkmcnt(0)
ds_read_b64_tr_b16 a[200:201], v28 offset:16384
ds_read_b64_tr_b16 a[202:203], v28 offset:17408
ds_read_b64_tr_b16 a[204:205], v28 offset:20480
ds_read_b64_tr_b16 a[206:207], v28 offset:21504
ds_read_b64_tr_b16 v[88:89], v29 offset:16384
ds_read_b64_tr_b16 v[90:91], v29 offset:17408
ds_read_b64_tr_b16 v[92:93], v29 offset:20480
ds_read_b64_tr_b16 v[94:95], v29 offset:21504
s_waitcnt lgkmcnt(0)
ds_read_b64_tr_b16 a[208:209], v28 offset:32768
ds_read_b64_tr_b16 a[210:211], v28 offset:33792
ds_read_b64_tr_b16 a[212:213], v28 offset:36864
ds_read_b64_tr_b16 a[214:215], v28 offset:37888
ds_read_b64_tr_b16 v[96:97], v29 offset:32768
ds_read_b64_tr_b16 v[98:99], v29 offset:33792
ds_read_b64_tr_b16 v[100:101], v29 offset:36864
ds_read_b64_tr_b16 v[102:103], v29 offset:37888
s_waitcnt lgkmcnt(0)
s_barrier
s_mov_b32 s8, s30
s_and_b32 s9, s31, 0xffff
s_mov_b32 s10, 4718592
s_mov_b32 s11, 0x20000
s_mul_i32 s61, s51, 147456
s_mul_i32 s60, s3, 9216
s_add_u32 s61, s61, s60
s_add_u32 s61, s61, 73728
s_add_u32 m0, s60, 98304
s_nop 0
buffer_load_dwordx4 v1, s[8:11], s61 offen lds
s_add_u32 s61, s61, 1024
s_add_u32 m0, m0, 1024
s_nop 0
buffer_load_dwordx4 v1, s[8:11], s61 offen lds
s_add_u32 s61, s61, 1024
s_add_u32 m0, m0, 1024
s_nop 0
buffer_load_dwordx4 v1, s[8:11], s61 offen lds
s_add_u32 s61, s61, 1024
s_add_u32 m0, m0, 1024
s_nop 0
buffer_load_dwordx4 v1, s[8:11], s61 offen lds
s_add_u32 s61, s61, 1024
s_add_u32 m0, m0, 1024
s_nop 0
buffer_load_dwordx4 v1, s[8:11], s61 offen lds
s_add_u32 s61, s61, 1024
s_add_u32 m0, m0, 1024
s_nop 0
buffer_load_dwordx4 v1, s[8:11], s61 offen lds
s_add_u32 s61, s61, 1024
s_add_u32 m0, m0, 1024
s_nop 0
buffer_load_dwordx4 v1, s[8:11], s61 offen lds
s_add_u32 s61, s61, 1024
s_add_u32 m0, m0, 1024
s_nop 0
buffer_load_dwordx4 v1, s[8:11], s61 offen lds
s_add_u32 s61, s61, 1024
s_add_u32 m0, m0, 1024
s_nop 0
buffer_load_dwordx4 v1, s[8:11], s61 offen lds
s_add_u32 s61, s61, 1024
s_add_u32 m0, m0, 1024
s_waitcnt vmcnt(18)
s_barrier
v_lshrrev_b32 v24, 4, v0
v_lshlrev_b32 v24, 3, v24
v_bfe_u32 v25, v0, 2, 2
v_add_u32 v24, v24, v25
v_mul_u32_u24 v24, 1152, v24
v_and_b32 v25, 3, v0
v_lshl_add_u32 v24, v25, 3, v24
s_mul_i32 s60, s3, 288
s_add_u32 s60, s60, 0
v_add_u32 v28, s60, v24
ds_read_b64_tr_b16 v[104:105], v28 offset:0
ds_read_b64_tr_b16 v[106:107], v28 offset:4608
ds_read_b64_tr_b16 v[120:121], v28 offset:32
ds_read_b64_tr_b16 v[122:123], v28 offset:4640
ds_read_b64_tr_b16 v[136:137], v28 offset:64
ds_read_b64_tr_b16 v[138:139], v28 offset:4672
s_waitcnt lgkmcnt(0)
ds_read_b64_tr_b16 v[152:153], v28 offset:96
ds_read_b64_tr_b16 v[154:155], v28 offset:4704
ds_read_b64_tr_b16 v[168:169], v28 offset:128
ds_read_b64_tr_b16 v[170:171], v28 offset:4736
ds_read_b64_tr_b16 v[184:185], v28 offset:160
ds_read_b64_tr_b16 v[186:187], v28 offset:4768
s_waitcnt lgkmcnt(0)
ds_read_b64_tr_b16 v[200:201], v28 offset:192
ds_read_b64_tr_b16 v[202:203], v28 offset:4800
ds_read_b64_tr_b16 v[216:217], v28 offset:224
ds_read_b64_tr_b16 v[218:219], v28 offset:4832
ds_read_b64_tr_b16 v[232:233], v28 offset:256
ds_read_b64_tr_b16 v[234:235], v28 offset:4864
s_waitcnt lgkmcnt(0)
s_barrier
s_mov_b32 s8, s30
s_and_b32 s9, s31, 0xffff
s_mov_b32 s10, 4718592
s_mov_b32 s11, 0x20000
s_mul_i32 s61, s51, 147456
s_mul_i32 s60, s3, 9216
s_add_u32 s61, s61, s60
s_add_u32 s61, s61, 110592
s_add_u32 m0, s60, 0
s_nop 0
buffer_load_dwordx4 v1, s[8:11], s61 offen lds
s_add_u32 s61, s61, 1024
s_add_u32 m0, m0, 1024
s_nop 0
buffer_load_dwordx4 v1, s[8:11], s61 offen lds
s_add_u32 s61, s61, 1024
s_add_u32 m0, m0, 1024
s_nop 0
buffer_load_dwordx4 v1, s[8:11], s61 offen lds
s_add_u32 s61, s61, 1024
s_add_u32 m0, m0, 1024
s_nop 0
buffer_load_dwordx4 v1, s[8:11], s61 offen lds
s_add_u32 s61, s61, 1024
s_add_u32 m0, m0, 1024
s_nop 0
buffer_load_dwordx4 v1, s[8:11], s61 offen lds
s_add_u32 s61, s61, 1024
s_add_u32 m0, m0, 1024
s_nop 0
buffer_load_dwordx4 v1, s[8:11], s61 offen lds
s_add_u32 s61, s61, 1024
s_add_u32 m0, m0, 1024
s_nop 0
buffer_load_dwordx4 v1, s[8:11], s61 offen lds
s_add_u32 s61, s61, 1024
s_add_u32 m0, m0, 1024
s_nop 0
buffer_load_dwordx4 v1, s[8:11], s61 offen lds
s_add_u32 s61, s61, 1024
s_add_u32 m0, m0, 1024
s_nop 0
buffer_load_dwordx4 v1, s[8:11], s61 offen lds
s_add_u32 s61, s61, 1024
s_add_u32 m0, m0, 1024
s_waitcnt vmcnt(18)
s_barrier
s_or_b32 s60, s3, s58
s_cbranch_scc1 pri_397
v_mov_b32 v24, 1
v_mov_b32 v25, 224
s_mov_b64 exec, 1
buffer_atomic_add v24, v25, s[12:15], 0 offen
s_mov_b64 exec, -1
pri_397:
v_lshrrev_b32 v24, 4, v0
v_lshlrev_b32 v24, 3, v24
v_bfe_u32 v25, v0, 2, 2
v_add_u32 v24, v24, v25
v_mul_u32_u24 v24, 1152, v24
v_and_b32 v25, 3, v0
v_lshl_add_u32 v24, v25, 3, v24
s_mul_i32 s60, s3, 288
s_add_u32 s60, s60, 49152
v_add_u32 v28, s60, v24
ds_read_b64_tr_b16 v[108:109], v28 offset:0
ds_read_b64_tr_b16 v[110:111], v28 offset:4608
ds_read_b64_tr_b16 v[124:125], v28 offset:32
ds_read_b64_tr_b16 v[126:127], v28 offset:4640
ds_read_b64_tr_b16 v[140:141], v28 offset:64
ds_read_b64_tr_b16 v[142:143], v28 offset:4672
s_waitcnt lgkmcnt(0)
ds_read_b64_tr_b16 v[156:157], v28 offset:96
ds_read_b64_tr_b16 v[158:159], v28 offset:4704
ds_read_b64_tr_b16 v[172:173], v28 offset:128
ds_read_b64_tr_b16 v[174:175], v28 offset:4736
ds_read_b64_tr_b16 v[188:189], v28 offset:160
ds_read_b64_tr_b16 v[190:191], v28 offset:4768
s_waitcnt lgkmcnt(0)
ds_read_b64_tr_b16 v[204:205], v28 offset:192
ds_read_b64_tr_b16 v[206:207], v28 offset:4800
ds_read_b64_tr_b16 v[220:221], v28 offset:224
ds_read_b64_tr_b16 v[222:223], v28 offset:4832
ds_read_b64_tr_b16 v[236:237], v28 offset:256
ds_read_b64_tr_b16 v[238:239], v28 offset:4864
s_waitcnt lgkmcnt(0)
s_barrier
s_mov_b32 s8, s28
s_and_b32 s9, s29, 0xffff
s_mov_b32 s10, 4718592
s_mov_b32 s11, 0x20000
s_lshl_b32 s61, s51, 8
s_mul_i32 s60, s3, 393216
s_add_u32 s61, s61, s60
s_add_u32 s61, s61, 1572864
s_mul_i32 s60, s3, 12288
s_add_u32 m0, s60, 49152
s_mul_i32 s62, s3, 48
s_bitcmp1_b32 s62, 5
s_cbranch_scc1 sq_398
buffer_load_dwordx4 v30, s[8:11], s61 offen lds
s_branch sq_399
sq_398:
buffer_load_dwordx4 v31, s[8:11], s61 offen lds
sq_399:
s_add_u32 s62, s62, 4
s_add_u32 s61, s61, 32768
s_add_u32 m0, m0, 1024
s_bitcmp1_b32 s62, 5
s_cbranch_scc1 sq_400
buffer_load_dwordx4 v30, s[8:11], s61 offen lds
s_branch sq_401
sq_400:
buffer_load_dwordx4 v31, s[8:11], s61 offen lds
sq_401:
s_add_u32 s62, s62, 4
s_add_u32 s61, s61, 32768
s_add_u32 m0, m0, 1024
s_bitcmp1_b32 s62, 5
s_cbranch_scc1 sq_402
buffer_load_dwordx4 v30, s[8:11], s61 offen lds
s_branch sq_403
sq_402:
buffer_load_dwordx4 v31, s[8:11], s61 offen lds
sq_403:
s_add_u32 s62, s62, 4
s_add_u32 s61, s61, 32768
s_add_u32 m0, m0, 1024
s_bitcmp1_b32 s62, 5
s_cbranch_scc1 sq_404
buffer_load_dwordx4 v30, s[8:11], s61 offen lds
s_branch sq_405
sq_404:
buffer_load_dwordx4 v31, s[8:11], s61 offen lds
sq_405:
s_add_u32 s62, s62, 4
s_add_u32 s61, s61, 32768
s_add_u32 m0, m0, 1024
s_bitcmp1_b32 s62, 5
s_cbranch_scc1 sq_406
buffer_load_dwordx4 v30, s[8:11], s61 offen lds
s_branch sq_407
sq_406:
buffer_load_dwordx4 v31, s[8:11], s61 offen lds
sq_407:
s_add_u32 s62, s62, 4
s_add_u32 s61, s61, 32768
s_add_u32 m0, m0, 1024
s_bitcmp1_b32 s62, 5
s_cbranch_scc1 sq_408
buffer_load_dwordx4 v30, s[8:11], s61 offen lds
s_branch sq_409
sq_408:
buffer_load_dwordx4 v31, s[8:11], s61 offen lds
sq_409:
s_add_u32 s62, s62, 4
s_add_u32 s61, s61, 32768
s_add_u32 m0, m0, 1024
s_bitcmp1_b32 s62, 5
s_cbranch_scc1 sq_410
buffer_load_dwordx4 v30, s[8:11], s61 offen lds
s_branch sq_411
sq_410:
buffer_load_dwordx4 v31, s[8:11], s61 offen lds
sq_411:
s_add_u32 s62, s62, 4
s_add_u32 s61, s61, 32768
s_add_u32 m0, m0, 1024
s_bitcmp1_b32 s62, 5
s_cbranch_scc1 sq_412
buffer_load_dwordx4 v30, s[8:11], s61 offen lds
s_branch sq_413
sq_412:
buffer_load_dwordx4 v31, s[8:11], s61 offen lds
sq_413:
s_add_u32 s62, s62, 4
s_add_u32 s61, s61, 32768
s_add_u32 m0, m0, 1024
s_bitcmp1_b32 s62, 5
s_cbranch_scc1 sq_414
buffer_load_dwordx4 v30, s[8:11], s61 offen lds
s_branch sq_415
sq_414:
buffer_load_dwordx4 v31, s[8:11], s61 offen lds
sq_415:
s_add_u32 s62, s62, 4
s_add_u32 s61, s61, 32768
s_add_u32 m0, m0, 1024
s_bitcmp1_b32 s62, 5
s_cbranch_scc1 sq_416
buffer_load_dwordx4 v30, s[8:11], s61 offen lds
s_branch sq_417
sq_416:
buffer_load_dwordx4 v31, s[8:11], s61 offen lds
sq_417:
s_add_u32 s62, s62, 4
s_add_u32 s61, s61, 32768
s_add_u32 m0, m0, 1024
s_bitcmp1_b32 s62, 5
s_cbranch_scc1 sq_418
buffer_load_dwordx4 v30, s[8:11], s61 offen lds
s_branch sq_419
sq_418:
buffer_load_dwordx4 v31, s[8:11], s61 offen lds
sq_419:
s_add_u32 s62, s62, 4
s_add_u32 s61, s61, 32768
s_add_u32 m0, m0, 1024
s_bitcmp1_b32 s62, 5
s_cbranch_scc1 sq_420
buffer_load_dwordx4 v30, s[8:11], s61 offen lds
s_branch sq_421
sq_420:
buffer_load_dwordx4 v31, s[8:11], s61 offen lds
sq_421:
s_add_u32 s62, s62, 4
s_add_u32 s61, s61, 32768
s_add_u32 m0, m0, 1024
s_waitcnt vmcnt(21)
s_barrier
v_lshrrev_b32 v24, 4, v0
v_lshlrev_b32 v24, 3, v24
v_bfe_u32 v25, v0, 2, 2
v_add_u32 v24, v24, v25
v_mul_u32_u24 v24, 1152, v24
v_and_b32 v25, 3, v0
v_lshl_add_u32 v24, v25, 3, v24
s_mul_i32 s60, s3, 288
s_add_u32 s60, s60, 98304
v_add_u32 v28, s60, v24
ds_read_b64_tr_b16 v[112:113], v28 offset:0
ds_read_b64_tr_b16 v[114:115], v28 offset:4608
ds_read_b64_tr_b16 v[128:129], v28 offset:32
ds_read_b64_tr_b16 v[130:131], v28 offset:4640
ds_read_b64_tr_b16 v[144:145], v28 offset:64
ds_read_b64_tr_b16 v[146:147], v28 offset:4672
s_waitcnt lgkmcnt(0)
ds_read_b64_tr_b16 v[160:161], v28 offset:96
ds_read_b64_tr_b16 v[162:163], v28 offset:4704
ds_read_b64_tr_b16 v[176:177], v28 offset:128
ds_read_b64_tr_b16 v[178:179], v28 offset:4736
ds_read_b64_tr_b16 v[192:193], v28 offset:160
ds_read_b64_tr_b16 v[194:195], v28 offset:4768
s_waitcnt lgkmcnt(0)
ds_read_b64_tr_b16 v[208:209], v28 offset:192
ds_read_b64_tr_b16 v[210:211], v28 offset:4800
ds_read_b64_tr_b16 v[224:225], v28 offset:224
ds_read_b64_tr_b16 v[226:227], v28 offset:4832
ds_read_b64_tr_b16 v[240:241], v28 offset:256
ds_read_b64_tr_b16 v[242:243], v28 offset:4864
s_waitcnt lgkmcnt(0)
s_barrier
s_mov_b32 s8, s28
s_and_b32 s9, s29, 0xffff
s_mov_b32 s10, 4718592
s_mov_b32 s11, 0x20000
s_lshl_b32 s61, s51, 8
s_mul_i32 s60, s3, 393216
s_add_u32 s61, s61, s60
s_add_u32 s61, s61, 3145728
s_mul_i32 s60, s3, 12288
s_add_u32 m0, s60, 98304
s_mul_i32 s62, s3, 48
s_bitcmp1_b32 s62, 5
s_cbranch_scc1 sq_422
buffer_load_dwordx4 v30, s[8:11], s61 offen lds
s_branch sq_423
sq_422:
buffer_load_dwordx4 v31, s[8:11], s61 offen lds
sq_423:
s_add_u32 s62, s62, 4
s_add_u32 s61, s61, 32768
s_add_u32 m0, m0, 1024
s_bitcmp1_b32 s62, 5
s_cbranch_scc1 sq_424
buffer_load_dwordx4 v30, s[8:11], s61 offen lds
s_branch sq_425
sq_424:
buffer_load_dwordx4 v31, s[8:11], s61 offen lds
sq_425:
s_add_u32 s62, s62, 4
s_add_u32 s61, s61, 32768
s_add_u32 m0, m0, 1024
s_bitcmp1_b32 s62, 5
s_cbranch_scc1 sq_426
buffer_load_dwordx4 v30, s[8:11], s61 offen lds
s_branch sq_427
sq_426:
buffer_load_dwordx4 v31, s[8:11], s61 offen lds
sq_427:
s_add_u32 s62, s62, 4
s_add_u32 s61, s61, 32768
s_add_u32 m0, m0, 1024
s_bitcmp1_b32 s62, 5
s_cbranch_scc1 sq_428
buffer_load_dwordx4 v30, s[8:11], s61 offen lds
s_branch sq_429
sq_428:
buffer_load_dwordx4 v31, s[8:11], s61 offen lds
sq_429:
s_add_u32 s62, s62, 4
s_add_u32 s61, s61, 32768
s_add_u32 m0, m0, 1024
s_bitcmp1_b32 s62, 5
s_cbranch_scc1 sq_430
buffer_load_dwordx4 v30, s[8:11], s61 offen lds
s_branch sq_431
sq_430:
buffer_load_dwordx4 v31, s[8:11], s61 offen lds
sq_431:
s_add_u32 s62, s62, 4
s_add_u32 s61, s61, 32768
s_add_u32 m0, m0, 1024
s_bitcmp1_b32 s62, 5
s_cbranch_scc1 sq_432
buffer_load_dwordx4 v30, s[8:11], s61 offen lds
s_branch sq_433
sq_432:
buffer_load_dwordx4 v31, s[8:11], s61 offen lds
sq_433:
s_add_u32 s62, s62, 4
s_add_u32 s61, s61, 32768
s_add_u32 m0, m0, 1024
s_bitcmp1_b32 s62, 5
s_cbranch_scc1 sq_434
buffer_load_dwordx4 v30, s[8:11], s61 offen lds
s_branch sq_435
sq_434:
buffer_load_dwordx4 v31, s[8:11], s61 offen lds
sq_435:
s_add_u32 s62, s62, 4
s_add_u32 s61, s61, 32768
s_add_u32 m0, m0, 1024
s_bitcmp1_b32 s62, 5
s_cbranch_scc1 sq_436
buffer_load_dwordx4 v30, s[8:11], s61 offen lds
s_branch sq_437
sq_436:
buffer_load_dwordx4 v31, s[8:11], s61 offen lds
sq_437:
s_add_u32 s62, s62, 4
s_add_u32 s61, s61, 32768
s_add_u32 m0, m0, 1024
s_bitcmp1_b32 s62, 5
s_cbranch_scc1 sq_438
buffer_load_dwordx4 v30, s[8:11], s61 offen lds
s_branch sq_439
sq_438:
buffer_load_dwordx4 v31, s[8:11], s61 offen lds
sq_439:
s_add_u32 s62, s62, 4
s_add_u32 s61, s61, 32768
s_add_u32 m0, m0, 1024
s_bitcmp1_b32 s62, 5
s_cbranch_scc1 sq_440
buffer_load_dwordx4 v30, s[8:11], s61 offen lds
s_branch sq_441
sq_440:
buffer_load_dwordx4 v31, s[8:11], s61 offen lds
sq_441:
s_add_u32 s62, s62, 4
s_add_u32 s61, s61, 32768
s_add_u32 m0, m0, 1024
s_bitcmp1_b32 s62, 5
s_cbranch_scc1 sq_442
buffer_load_dwordx4 v30, s[8:11], s61 offen lds
s_branch sq_443
sq_442:
buffer_load_dwordx4 v31, s[8:11], s61 offen lds
sq_443:
s_add_u32 s62, s62, 4
s_add_u32 s61, s61, 32768
s_add_u32 m0, m0, 1024
s_bitcmp1_b32 s62, 5
s_cbranch_scc1 sq_444
buffer_load_dwordx4 v30, s[8:11], s61 offen lds
s_branch sq_445
sq_444:
buffer_load_dwordx4 v31, s[8:11], s61 offen lds
sq_445:
s_add_u32 s62, s62, 4
s_add_u32 s61, s61, 32768
s_add_u32 m0, m0, 1024
s_waitcnt vmcnt(24)
s_barrier
v_lshrrev_b32 v24, 4, v0
v_lshlrev_b32 v24, 3, v24
v_bfe_u32 v25, v0, 2, 2
v_add_u32 v24, v24, v25
v_mul_u32_u24 v24, 1152, v24
v_and_b32 v25, 3, v0
v_lshl_add_u32 v24, v25, 3, v24
s_mul_i32 s60, s3, 288
s_add_u32 s60, s60, 0
v_add_u32 v28, s60, v24
ds_read_b64_tr_b16 v[116:117], v28 offset:0
ds_read_b64_tr_b16 v[118:119], v28 offset:4608
ds_read_b64_tr_b16 v[132:133], v28 offset:32
ds_read_b64_tr_b16 v[134:135], v28 offset:4640
ds_read_b64_tr_b16 v[148:149], v28 offset:64
ds_read_b64_tr_b16 v[150:151], v28 offset:4672
s_waitcnt lgkmcnt(0)
ds_read_b64_tr_b16 v[164:165], v28 offset:96
ds_read_b64_tr_b16 v[166:167], v28 offset:4704
ds_read_b64_tr_b16 v[180:181], v28 offset:128
ds_read_b64_tr_b16 v[182:183], v28 offset:4736
ds_read_b64_tr_b16 v[196:197], v28 offset:160
ds_read_b64_tr_b16 v[198:199], v28 offset:4768
s_waitcnt lgkmcnt(0)
ds_read_b64_tr_b16 v[212:213], v28 offset:192
ds_read_b64_tr_b16 v[214:215], v28 offset:4800
ds_read_b64_tr_b16 v[228:229], v28 offset:224
ds_read_b64_tr_b16 v[230:231], v28 offset:4832
ds_read_b64_tr_b16 v[244:245], v28 offset:256
ds_read_b64_tr_b16 v[246:247], v28 offset:4864
s_waitcnt lgkmcnt(0)
s_barrier
s_mov_b32 s8, s28
s_and_b32 s9, s29, 0xffff
s_mov_b32 s10, 4718592
s_mov_b32 s11, 0x20000
s_lshl_b32 s61, s51, 8
s_mul_i32 s60, s3, 393216
s_add_u32 s61, s61, s60
s_add_u32 s61, s61, 0
s_mul_i32 s60, s3, 12288
s_add_u32 m0, s60, 0
s_mul_i32 s62, s3, 48
s_bitcmp1_b32 s62, 5
s_cbranch_scc1 sq_446
buffer_load_dwordx4 v30, s[8:11], s61 offen lds
s_branch sq_447
sq_446:
buffer_load_dwordx4 v31, s[8:11], s61 offen lds
sq_447:
s_add_u32 s62, s62, 4
s_add_u32 s61, s61, 32768
s_add_u32 m0, m0, 1024
s_bitcmp1_b32 s62, 5
s_cbranch_scc1 sq_448
buffer_load_dwordx4 v30, s[8:11], s61 offen lds
s_branch sq_449
sq_448:
buffer_load_dwordx4 v31, s[8:11], s61 offen lds
sq_449:
s_add_u32 s62, s62, 4
s_add_u32 s61, s61, 32768
s_add_u32 m0, m0, 1024
s_bitcmp1_b32 s62, 5
s_cbranch_scc1 sq_450
buffer_load_dwordx4 v30, s[8:11], s61 offen lds
s_branch sq_451
sq_450:
buffer_load_dwordx4 v31, s[8:11], s61 offen lds
sq_451:
s_add_u32 s62, s62, 4
s_add_u32 s61, s61, 32768
s_add_u32 m0, m0, 1024
s_bitcmp1_b32 s62, 5
s_cbranch_scc1 sq_452
buffer_load_dwordx4 v30, s[8:11], s61 offen lds
s_branch sq_453
sq_452:
buffer_load_dwordx4 v31, s[8:11], s61 offen lds
sq_453:
s_add_u32 s62, s62, 4
s_add_u32 s61, s61, 32768
s_add_u32 m0, m0, 1024
s_bitcmp1_b32 s62, 5
s_cbranch_scc1 sq_454
buffer_load_dwordx4 v30, s[8:11], s61 offen lds
s_branch sq_455
sq_454:
buffer_load_dwordx4 v31, s[8:11], s61 offen lds
sq_455:
s_add_u32 s62, s62, 4
s_add_u32 s61, s61, 32768
s_add_u32 m0, m0, 1024
s_bitcmp1_b32 s62, 5
s_cbranch_scc1 sq_456
buffer_load_dwordx4 v30, s[8:11], s61 offen lds
s_branch sq_457
sq_456:
buffer_load_dwordx4 v31, s[8:11], s61 offen lds
sq_457:
s_add_u32 s62, s62, 4
s_add_u32 s61, s61, 32768
s_add_u32 m0, m0, 1024
s_bitcmp1_b32 s62, 5
s_cbranch_scc1 sq_458
buffer_load_dwordx4 v30, s[8:11], s61 offen lds
s_branch sq_459
sq_458:
buffer_load_dwordx4 v31, s[8:11], s61 offen lds
sq_459:
s_add_u32 s62, s62, 4
s_add_u32 s61, s61, 32768
s_add_u32 m0, m0, 1024
s_bitcmp1_b32 s62, 5
s_cbranch_scc1 sq_460
buffer_load_dwordx4 v30, s[8:11], s61 offen lds
s_branch sq_461
sq_460:
buffer_load_dwordx4 v31, s[8:11], s61 offen lds
sq_461:
s_add_u32 s62, s62, 4
s_add_u32 s61, s61, 32768
s_add_u32 m0, m0, 1024
s_bitcmp1_b32 s62, 5
s_cbranch_scc1 sq_462
buffer_load_dwordx4 v30, s[8:11], s61 offen lds
s_branch sq_463
sq_462:
buffer_load_dwordx4 v31, s[8:11], s61 offen lds
sq_463:
s_add_u32 s62, s62, 4
s_add_u32 s61, s61, 32768
s_add_u32 m0, m0, 1024
s_bitcmp1_b32 s62, 5
s_cbranch_scc1 sq_464
buffer_load_dwordx4 v30, s[8:11], s61 offen lds
s_branch sq_465
sq_464:
buffer_load_dwordx4 v31, s[8:11], s61 offen lds
sq_465:
s_add_u32 s62, s62, 4
s_add_u32 s61, s61, 32768
s_add_u32 m0, m0, 1024
s_bitcmp1_b32 s62, 5
s_cbranch_scc1 sq_466
buffer_load_dwordx4 v30, s[8:11], s61 offen lds
s_branch sq_467
sq_466:
buffer_load_dwordx4 v31, s[8:11], s61 offen lds
sq_467:
s_add_u32 s62, s62, 4
s_add_u32 s61, s61, 32768
s_add_u32 m0, m0, 1024
s_bitcmp1_b32 s62, 5
s_cbranch_scc1 sq_468
buffer_load_dwordx4 v30, s[8:11], s61 offen lds
s_branch sq_469
sq_468:
buffer_load_dwordx4 v31, s[8:11], s61 offen lds
sq_469:
s_add_u32 s62, s62, 4
s_add_u32 s61, s61, 32768
s_add_u32 m0, m0, 1024
s_waitcnt vmcnt(24)
s_barrier
v_bfe_u32 v24, v0, 4, 1
v_lshrrev_b32 v25, 5, v0
v_bfe_u32 v26, v0, 2, 2
v_lshlrev_b32 v27, 5, v24
v_lshl_add_u32 v27, v25, 3, v27
v_add_u32 v27, v27, v26
v_lshlrev_b32 v27, 8, v27
v_lshl_add_u32 v26, v24, 2, v26
s_lshl_b32 s60, s3, 1
s_add_u32 s60, s60, 0
v_xor_b32 v26, s60, v26
v_lshl_add_u32 v27, v26, 5, v27
v_and_b32 v26, 3, v0
v_lshl_add_u32 v28, v26, 3, v27
v_add_u32 v28, 49152, v28
v_bfe_u32 v24, v0, 4, 1
v_lshrrev_b32 v25, 5, v0
v_bfe_u32 v26, v0, 2, 2
v_lshlrev_b32 v27, 5, v24
v_lshl_add_u32 v27, v25, 3, v27
v_add_u32 v27, v27, v26
v_lshlrev_b32 v27, 8, v27
v_lshl_add_u32 v26, v24, 2, v26
s_lshl_b32 s60, s3, 1
s_add_u32 s60, s60, 1
v_xor_b32 v26, s60, v26
v_lshl_add_u32 v27, v26, 5, v27
v_and_b32 v26, 3, v0
v_lshl_add_u32 v29, v26, 3, v27
v_add_u32 v29, 49152, v29
ds_read_b64_tr_b16 v[32:33], v28 offset:0
ds_read_b64_tr_b16 v[34:35], v28 offset:1024
ds_read_b64_tr_b16 v[36:37], v28 offset:4096
ds_read_b64_tr_b16 v[38:39], v28 offset:5120
ds_read_b64_tr_b16 v[40:41], v29 offset:0
ds_read_b64_tr_b16 v[42:43], v29 offset:1024
ds_read_b64_tr_b16 v[44:45], v29 offset:4096
ds_read_b64_tr_b16 v[46:47], v29 offset:5120
s_waitcnt lgkmcnt(0)
ds_read_b64_tr_b16 v[48:49], v28 offset:16384
ds_read_b64_tr_b16 v[50:51], v28 offset:17408
ds_read_b64_tr_b16 v[52:53], v28 offset:20480
ds_read_b64_tr_b16 v[54:55], v28 offset:21504
ds_read_b64_tr_b16 v[56:57], v29 offset:16384
ds_read_b64_tr_b16 v[58:59], v29 offset:17408
ds_read_b64_tr_b16 v[60:61], v29 offset:20480
ds_read_b64_tr_b16 v[62:63], v29 offset:21504
s_waitcnt lgkmcnt(0)
ds_read_b64_tr_b16 v[64:65], v28 offset:32768
ds_read_b64_tr_b16 v[66:67], v28 offset:33792
ds_read_b64_tr_b16 v[68:69], v28 offset:36864
ds_read_b64_tr_b16 v[70:71], v28 offset:37888
ds_read_b64_tr_b16 v[248:249], v29 offset:32768
ds_read_b64_tr_b16 v[250:251], v29 offset:33792
ds_read_b64_tr_b16 v[252:253], v29 offset:36864
ds_read_b64_tr_b16 v[254:255], v29 offset:37888
s_waitcnt lgkmcnt(0)
s_barrier
s_lshl_b32 s60, s3, 12
s_add_u32 s60, s60, 49152
v_add_u32 v28, s60, v1
ds_write_b128 v28, v[32:35] offset:0
ds_write_b128 v28, v[36:39] offset:1024
ds_write_b128 v28, v[40:43] offset:2048
ds_write_b128 v28, v[44:47] offset:3072
ds_write_b128 v28, v[48:51] offset:16384
ds_write_b128 v28, v[52:55] offset:17408
ds_write_b128 v28, v[56:59] offset:18432
ds_write_b128 v28, v[60:63] offset:19456
ds_write_b128 v28, v[64:67] offset:32768
ds_write_b128 v28, v[68:71] offset:33792
ds_write_b128 v28, v[248:251] offset:34816
ds_write_b128 v28, v[252:255] offset:35840
s_waitcnt lgkmcnt(0)
s_barrier
s_waitcnt vmcnt(0)
s_barrier
v_bfe_u32 v24, v0, 4, 1
v_lshrrev_b32 v25, 5, v0
v_bfe_u32 v26, v0, 2, 2
v_lshlrev_b32 v27, 5, v24
v_lshl_add_u32 v27, v25, 3, v27
v_add_u32 v27, v27, v26
v_lshlrev_b32 v27, 8, v27
v_lshl_add_u32 v26, v24, 2, v26
s_lshl_b32 s60, s3, 1
s_add_u32 s60, s60, 0
v_xor_b32 v26, s60, v26
v_lshl_add_u32 v27, v26, 5, v27
v_and_b32 v26, 3, v0
v_lshl_add_u32 v28, v26, 3, v27
v_bfe_u32 v24, v0, 4, 1
v_lshrrev_b32 v25, 5, v0
v_bfe_u32 v26, v0, 2, 2
v_lshlrev_b32 v27, 5, v24
v_lshl_add_u32 v27, v25, 3, v27
v_add_u32 v27, v27, v26
v_lshlrev_b32 v27, 8, v27
v_lshl_add_u32 v26, v24, 2, v26
s_lshl_b32 s60, s3, 1
s_add_u32 s60, s60, 1
v_xor_b32 v26, s60, v26
v_lshl_add_u32 v27, v26, 5, v27
v_and_b32 v26, 3, v0
v_lshl_add_u32 v29, v26, 3, v27
ds_read_b64_tr_b16 v[32:33], v28 offset:0
ds_read_b64_tr_b16 v[34:35], v28 offset:1024
ds_read_b64_tr_b16 v[36:37], v28 offset:4096
ds_read_b64_tr_b16 v[38:39], v28 offset:5120
ds_read_b64_tr_b16 v[40:41], v29 offset:0
ds_read_b64_tr_b16 v[42:43], v29 offset:1024
ds_read_b64_tr_b16 v[44:45], v29 offset:4096
ds_read_b64_tr_b16 v[46:47], v29 offset:5120
s_waitcnt lgkmcnt(0)
ds_read_b64_tr_b16 v[48:49], v28 offset:16384
ds_read_b64_tr_b16 v[50:51], v28 offset:17408
ds_read_b64_tr_b16 v[52:53], v28 offset:20480
ds_read_b64_tr_b16 v[54:55], v28 offset:21504
ds_read_b64_tr_b16 v[56:57], v29 offset:16384
ds_read_b64_tr_b16 v[58:59], v29 offset:17408
ds_read_b64_tr_b16 v[60:61], v29 offset:20480
ds_read_b64_tr_b16 v[62:63], v29 offset:21504
s_waitcnt lgkmcnt(0)
ds_read_b64_tr_b16 v[64:65], v28 offset:32768
ds_read_b64_tr_b16 v[66:67], v28 offset:33792
ds_read_b64_tr_b16 v[68:69], v28 offset:36864
ds_read_b64_tr_b16 v[70:71], v28 offset:37888
ds_read_b64_tr_b16 v[248:249], v29 offset:32768
ds_read_b64_tr_b16 v[250:251], v29 offset:33792
ds_read_b64_tr_b16 v[252:253], v29 offset:36864
ds_read_b64_tr_b16 v[254:255], v29 offset:37888
s_waitcnt lgkmcnt(0)
s_barrier
s_lshl_b32 s60, s3, 12
s_add_u32 s60, s60, 0
v_add_u32 v28, s60, v1
ds_write_b128 v28, v[32:35] offset:0
ds_write_b128 v28, v[36:39] offset:1024
ds_write_b128 v28, v[40:43] offset:2048
ds_write_b128 v28, v[44:47] offset:3072
ds_write_b128 v28, v[48:51] offset:16384
ds_write_b128 v28, v[52:55] offset:17408
ds_write_b128 v28, v[56:59] offset:18432
ds_write_b128 v28, v[60:63] offset:19456
ds_write_b128 v28, v[64:67] offset:32768
ds_write_b128 v28, v[68:71] offset:33792
ds_write_b128 v28, v[248:251] offset:34816
ds_write_b128 v28, v[252:255] offset:35840
s_waitcnt lgkmcnt(0)
s_barrier
s_waitcnt vmcnt(12)
s_barrier
v_bfe_u32 v24, v0, 4, 1
v_lshrrev_b32 v25, 5, v0
v_bfe_u32 v26, v0, 2, 2
v_lshlrev_b32 v27, 5, v24
v_lshl_add_u32 v27, v25, 3, v27
v_add_u32 v27, v27, v26
v_lshlrev_b32 v27, 8, v27
v_lshl_add_u32 v26, v24, 2, v26
s_lshl_b32 s60, s3, 1
s_add_u32 s60, s60, 0
v_xor_b32 v26, s60, v26
v_lshl_add_u32 v27, v26, 5, v27
v_and_b32 v26, 3, v0
v_lshl_add_u32 v28, v26, 3, v27
v_add_u32 v28, 98304, v28
v_bfe_u32 v24, v0, 4, 1
v_lshrrev_b32 v25, 5, v0
v_bfe_u32 v26, v0, 2, 2
v_lshlrev_b32 v27, 5, v24
v_lshl_add_u32 v27, v25, 3, v27
v_add_u32 v27, v27, v26
v_lshlrev_b32 v27, 8, v27
v_lshl_add_u32 v26, v24, 2, v26
s_lshl_b32 s60, s3, 1
s_add_u32 s60, s60, 1
v_xor_b32 v26, s60, v26
v_lshl_add_u32 v27, v26, 5, v27
v_and_b32 v26, 3, v0
v_lshl_add_u32 v29, v26, 3, v27
v_add_u32 v29, 98304, v29
ds_read_b64_tr_b16 v[32:33], v28 offset:0
ds_read_b64_tr_b16 v[34:35], v28 offset:1024
ds_read_b64_tr_b16 v[36:37], v28 offset:4096
ds_read_b64_tr_b16 v[38:39], v28 offset:5120
ds_read_b64_tr_b16 v[40:41], v29 offset:0
ds_read_b64_tr_b16 v[42:43], v29 offset:1024
ds_read_b64_tr_b16 v[44:45], v29 offset:4096
ds_read_b64_tr_b16 v[46:47], v29 offset:5120
s_waitcnt lgkmcnt(0)
ds_read_b64_tr_b16 v[48:49], v28 offset:16384
ds_read_b64_tr_b16 v[50:51], v28 offset:17408
ds_read_b64_tr_b16 v[52:53], v28 offset:20480
ds_read_b64_tr_b16 v[54:55], v28 offset:21504
ds_read_b64_tr_b16 v[56:57], v29 offset:16384
ds_read_b64_tr_b16 v[58:59], v29 offset:17408
ds_read_b64_tr_b16 v[60:61], v29 offset:20480
ds_read_b64_tr_b16 v[62:63], v29 offset:21504
s_waitcnt lgkmcnt(0)
ds_read_b64_tr_b16 v[64:65], v28 offset:32768
ds_read_b64_tr_b16 v[66:67], v28 offset:33792
ds_read_b64_tr_b16 v[68:69], v28 offset:36864
ds_read_b64_tr_b16 v[70:71], v28 offset:37888
ds_read_b64_tr_b16 v[248:249], v29 offset:32768
ds_read_b64_tr_b16 v[250:251], v29 offset:33792
ds_read_b64_tr_b16 v[252:253], v29 offset:36864
ds_read_b64_tr_b16 v[254:255], v29 offset:37888
s_waitcnt lgkmcnt(0)
s_barrier
s_lshl_b32 s60, s3, 12
s_add_u32 s60, s60, 98304
v_add_u32 v28, s60, v1
ds_write_b128 v28, v[32:35] offset:0
ds_write_b128 v28, v[36:39] offset:1024
ds_write_b128 v28, v[40:43] offset:2048
ds_write_b128 v28, v[44:47] offset:3072
ds_write_b128 v28, v[48:51] offset:16384
ds_write_b128 v28, v[52:55] offset:17408
ds_write_b128 v28, v[56:59] offset:18432
ds_write_b128 v28, v[60:63] offset:19456
s_lshl_b32 s60, s3, 11
s_add_u32 s60, s60, 131072
v_add_u32 v29, s60, v1
ds_write_b128 v29, v[64:67] offset:0
ds_write_b128 v29, v[68:71] offset:1024
s_waitcnt lgkmcnt(0)
s_barrier
s_lshl_b32 s60, s3, 6
v_add_u32 v24, s60, v0
v_lshlrev_b32 v25, 2, v24
v_add_u32 v25, 139264, v25
ds_write_b32 v25, v16 offset:0
ds_write_b32 v25, v17 offset:1024
ds_write_b32 v25, v18 offset:2048
ds_write_b32 v25, v19 offset:3072
ds_write_b32 v25, v20 offset:4096
ds_write_b32 v25, v21 offset:5120
ds_write_b32 v25, v22 offset:6144
ds_write_b32 v25, v23 offset:7168
ds_write_b32 v25, v14 offset:8192
s_waitcnt lgkmcnt(0)
s_mov_b32 s67, 0
v_mov_b32 v25, s57
cbp_470:
buffer_load_dword v24, v25, s[12:15], 0 offen sc1
s_add_u32 s67, s67, 1
s_cmp_gt_u32 s67, 400000
s_cbranch_scc1 chain_fail_240
s_waitcnt vmcnt(0)
v_readfirstlane_b32 s61, v24
s_nop 0
s_and_b32 s60, s61, 0xffff
s_cmp_lt_u32 s60, 32
s_cbranch_scc1 cbp_470
s_lshr_b32 s47, s61, 16
s_mov_b32 s12, s40
s_and_b32 s13, s41, 0xffff
s_mov_b32 s14, 256
s_mov_b32 s15, 0x20000
v_lshlrev_b32 v24, 2, v0
v_add_u32 v25, 128, v24
v_cmp_le_u32 vcc, 2, v0
s_nop 1
v_cndmask_b32 v24, v24, v25, vcc
v_mov_b32 v25, 192
v_cmp_eq_u32 vcc, 8, v0
s_nop 1
v_cndmask_b32 v24, v24, v25, vcc
v_mov_b32 v25, 2147483632
v_cmp_lt_u32 vcc, 8, v0
s_nop 1
v_cndmask_b32 v24, v24, v25, vcc
s_mov_b32 s98, 0
wi_loop_471:
buffer_load_dword v25, v24, s[12:15], 0 offen sc1
s_add_u32 s98, s98, 1
s_cmp_gt_u32 s98, 150000
s_cbranch_scc1 wi_bad_473
s_waitcnt vmcnt(0)
v_cmp_eq_u32 vcc, 32, v25
s_nop 0
s_and_b32 s97, vcc_lo, 0x1ff
s_cmp_eq_u32 s97, 0x1ff
s_cbranch_scc1 wi_ok_472
v_cmp_lt_u32 vcc, 32, v25
s_nop 0
s_and_b32 s96, vcc_lo, 0xff
s_cselect_b32 s96, 0x100, 0
s_and_b32 s96, s96, s97
s_cbranch_scc1 wi_over_474
s_sleep 8
s_branch wi_loop_471
wi_bad_473:
s_mov_b32 s98, 512
s_branch L_fail
wi_over_474:
s_mov_b32 s100, 255
wi_ok_472:
s_mov_b32 s98, 0xff800000
s_mov_b32 s99, 0xff800000
s_cmp_lg_u32 s47, 0
s_cbranch_scc1 chain_foreign_475
s_mov_b32 s62, 0
s_lshl_b32 s65, s3, 11
s_add_u32 s65, s65, 16384
s_mul_i32 s63, s51, 24576
s_add_u32 s63, s63, s53
s_mul_i32 s77, s51, 4096
s_add_u32 s77, s77, s54
s_mov_b32 s59, s77
v_mov_b32 v8, 1
v_mov_b64 v[48:49], 0
v_mov_b64 v[50:51], 0
v_mov_b64 v[52:53], 0
v_mov_b64 v[54:55], 0
v_mov_b64 v[56:57], 0
v_mov_b64 v[58:59], 0
v_mov_b64 v[60:61], 0
v_mov_b64 v[62:63], 0
v_mov_b64 v[64:65], 0
v_mov_b64 v[66:67], 0
v_mov_b64 v[68:69], 0
v_mov_b64 v[70:71], 0
s_lshl_b32 s60, s3, 12
v_add_u32 v15, s60, v1
s_lshl_b32 s60, s3, 11
s_add_u32 s60, s60, 131072
v_add_u32 v14, s60, v1
s_cmp_lg_u32 s3, 3
s_cbranch_scc1 kx0_476
s_add_u32 s61, s62, 1
s_mov_b32 s67, 0
sp_loop_477:
buffer_load_dword v32, v7, s[4:7], s58 offen sc1
s_add_u32 s67, s67, 1
s_cmp_gt_u32 s67, 150000
s_cbranch_scc1 sp_bad_479
s_waitcnt vmcnt(0)
v_cmp_gt_u32 vcc, s61, v32
s_nop 0
s_and_b32 vcc_lo, vcc_lo, 31
s_cbranch_scc0 sp_ok_478
s_sleep 1
s_branch sp_loop_477
sp_bad_479:
s_mov_b32 s98, 1792
s_branch L_fail
sp_ok_478:
kx0_476:
s_barrier
chain_loop_480:
ds_read_b64_tr_b16 v[24:25], v2 offset:0
ds_read_b64_tr_b16 v[26:27], v2 offset:512
ds_read_b128 v[32:35], v15 offset:0
ds_read_b128 v[36:39], v15 offset:1024
ds_read_b64_tr_b16 v[28:29], v2 offset:1024
ds_read_b64_tr_b16 v[30:31], v2 offset:1536
s_sub_u32 s60, s65, 8192
s_add_u32 m0, s60, 146432
s_add_u32 s60, s60, s63
v_lshlrev_b32 v13, 7, v0
s_add_u32 s61, s63, s65
buffer_load_dwordx4 v1, s[4:7], s60 offen offset:0 sc1 lds
buffer_load_dwordx4 v1, s[4:7], s60 offen offset:1024 sc1 lds
s_mov_b64 exec, 0xffff
buffer_load_dword v13, v13, s[4:7], s61 offen sc1
s_mov_b64 exec, -1
s_waitcnt lgkmcnt(4)
v_smfmac_f32_16x16x64_bf16 v[48:51], v[24:27], a[0:7], v3
ds_read_b128 v[40:43], v15 offset:2048
v_smfmac_f32_16x16x64_bf16 v[52:55], v[24:27], a[72:79], v3
ds_read_b128 v[44:47], v15 offset:3072
v_smfmac_f32_16x16x64_bf16 v[56:59], v[24:27], a[144:151], v3
ds_read_b128 v[16:19], v15 offset:16384
v_smfmac_f32_16x16x64_bf16 v[60:63], v[24:27], a[216:223], v3
ds_read_b128 v[20:23], v15 offset:17408
s_waitcnt lgkmcnt(6)
v_smfmac_f32_16x16x64_bf16 v[64:67], v[24:27], v[32:39], v3
ds_read_b128 v[32:35], v15 offset:18432
s_waitcnt lgkmcnt(3)
v_smfmac_f32_16x16x64_bf16 v[68:71], v[24:27], v[40:47], v3
ds_read_b128 v[36:39], v15 offset:19456
v_smfmac_f32_16x16x64_bf16 v[48:51], v[28:31], a[8:15], v3
ds_read_b64_tr_b16 v[24:25], v2 offset:2048
v_smfmac_f32_16x16x64_bf16 v[52:55], v[28:31], a[80:87], v3
ds_read_b64_tr_b16 v[26:27], v2 offset:2560
v_smfmac_f32_16x16x64_bf16 v[56:59], v[28:31], a[152:159], v3
ds_read_b128 v[40:43], v15 offset:32768
v_smfmac_f32_16x16x64_bf16 v[60:63], v[28:31], a[224:231], v3
ds_read_b128 v[44:47], v15 offset:33792
s_waitcnt lgkmcnt(6)
v_smfmac_f32_16x16x64_bf16 v[64:67], v[28:31], v[16:23], v3
ds_read_b128 v[16:19], v15 offset:34816
s_waitcnt lgkmcnt(5)
v_smfmac_f32_16x16x64_bf16 v[68:71], v[28:31], v[32:39], v3
ds_read_b128 v[20:23], v15 offset:35840
s_waitcnt lgkmcnt(4)
v_smfmac_f32_16x16x64_bf16 v[48:51], v[24:27], a[16:23], v3
ds_read_b64_tr_b16 v[28:29], v2 offset:3072
v_smfmac_f32_16x16x64_bf16 v[52:55], v[24:27], a[88:95], v3
ds_read_b64_tr_b16 v[30:31], v2 offset:3584
v_smfmac_f32_16x16x64_bf16 v[56:59], v[24:27], a[160:167], v3
ds_read_b128 v[32:35], v15 offset:49152
v_smfmac_f32_16x16x64_bf16 v[60:63], v[24:27], a[232:239], v3
ds_read_b128 v[36:39], v15 offset:50176
s_waitcnt lgkmcnt(6)
v_smfmac_f32_16x16x64_bf16 v[64:67], v[24:27], v[40:47], v3
ds_read_b128 v[40:43], v15 offset:51200
s_waitcnt lgkmcnt(5)
v_smfmac_f32_16x16x64_bf16 v[68:71], v[24:27], v[16:23], v3
ds_read_b128 v[44:47], v15 offset:52224
s_waitcnt lgkmcnt(4)
v_smfmac_f32_16x16x64_bf16 v[48:51], v[28:31], a[24:31], v3
ds_read_b64_tr_b16 v[24:25], v2 offset:4096
v_smfmac_f32_16x16x64_bf16 v[52:55], v[28:31], a[96:103], v3
ds_read_b64_tr_b16 v[26:27], v2 offset:4608
v_smfmac_f32_16x16x64_bf16 v[56:59], v[28:31], a[168:175], v3
v_add_u32 v15, 65536, v15
ds_read_b128 v[16:19], v15 offset:0
v_smfmac_f32_16x16x64_bf16 v[60:63], v[28:31], a[240:247], v3
ds_read_b128 v[20:23], v15 offset:1024
s_waitcnt lgkmcnt(6)
v_smfmac_f32_16x16x64_bf16 v[64:67], v[28:31], v[32:39], v3
ds_read_b128 v[32:35], v15 offset:2048
s_waitcnt lgkmcnt(5)
v_smfmac_f32_16x16x64_bf16 v[68:71], v[28:31], v[40:47], v3
ds_read_b128 v[36:39], v15 offset:3072
s_waitcnt lgkmcnt(4)
v_smfmac_f32_16x16x64_bf16 v[48:51], v[24:27], a[32:39], v3
ds_read_b64_tr_b16 v[28:29], v2 offset:5120
v_smfmac_f32_16x16x64_bf16 v[52:55], v[24:27], a[104:111], v3
ds_read_b64_tr_b16 v[30:31], v2 offset:5632
v_smfmac_f32_16x16x64_bf16 v[56:59], v[24:27], a[176:183], v3
ds_read_b128 v[40:43], v15 offset:16384
v_smfmac_f32_16x16x64_bf16 v[60:63], v[24:27], a[248:255], v3
ds_read_b128 v[44:47], v15 offset:17408
s_waitcnt lgkmcnt(6)
v_smfmac_f32_16x16x64_bf16 v[64:67], v[24:27], v[16:23], v3
ds_read_b128 v[16:19], v15 offset:18432
s_waitcnt lgkmcnt(5)
v_smfmac_f32_16x16x64_bf16 v[68:71], v[24:27], v[32:39], v3
ds_read_b128 v[20:23], v15 offset:19456
s_waitcnt lgkmcnt(4)
v_smfmac_f32_16x16x64_bf16 v[48:51], v[28:31], a[40:47], v3
ds_read_b64_tr_b16 v[24:25], v2 offset:6144
v_smfmac_f32_16x16x64_bf16 v[52:55], v[28:31], a[112:119], v3
ds_read_b64_tr_b16 v[26:27], v2 offset:6656
v_smfmac_f32_16x16x64_bf16 v[56:59], v[28:31], a[184:191], v3
ds_read_b128 v[32:35], v15 offset:32768
v_smfmac_f32_16x16x64_bf16 v[60:63], v[28:31], v[72:79], v3
ds_read_b128 v[36:39], v15 offset:33792
s_waitcnt lgkmcnt(6)
v_smfmac_f32_16x16x64_bf16 v[64:67], v[28:31], v[40:47], v3
ds_read_b128 v[40:43], v15 offset:34816
s_waitcnt lgkmcnt(5)
v_smfmac_f32_16x16x64_bf16 v[68:71], v[28:31], v[16:23], v3
ds_read_b128 v[44:47], v15 offset:35840
s_waitcnt lgkmcnt(4)
v_smfmac_f32_16x16x64_bf16 v[48:51], v[24:27], a[48:55], v3
ds_read_b64_tr_b16 v[28:29], v2 offset:7168
v_smfmac_f32_16x16x64_bf16 v[52:55], v[24:27], a[120:127], v3
ds_read_b64_tr_b16 v[30:31], v2 offset:7680
v_smfmac_f32_16x16x64_bf16 v[56:59], v[24:27], a[192:199], v3
ds_read_b128 v[16:19], v15 offset:49152
v_smfmac_f32_16x16x64_bf16 v[60:63], v[24:27], v[80:87], v3
ds_read_b128 v[20:23], v15 offset:50176
s_waitcnt lgkmcnt(6)
v_smfmac_f32_16x16x64_bf16 v[64:67], v[24:27], v[32:39], v3
ds_read_b128 v[32:35], v15 offset:51200
s_waitcnt lgkmcnt(5)
v_smfmac_f32_16x16x64_bf16 v[68:71], v[24:27], v[40:47], v3
ds_read_b128 v[36:39], v15 offset:52224
s_waitcnt lgkmcnt(4)
v_smfmac_f32_16x16x64_bf16 v[48:51], v[28:31], a[56:63], v3
ds_read_b64_tr_b16 v[24:25], v2 offset:8192
v_smfmac_f32_16x16x64_bf16 v[52:55], v[28:31], a[128:135], v3
ds_read_b64_tr_b16 v[26:27], v2 offset:8704
v_smfmac_f32_16x16x64_bf16 v[56:59], v[28:31], a[200:207], v3
ds_read_b128 v[40:43], v14 offset:0
v_smfmac_f32_16x16x64_bf16 v[60:63], v[28:31], v[88:95], v3
ds_read_b128 v[44:47], v14 offset:1024
v_add_u32 v15, 152576, v1
s_waitcnt lgkmcnt(2)
v_smfmac_f32_16x16x64_bf16 v[48:51], v[24:27], a[64:71], v3
v_smfmac_f32_16x16x64_bf16 v[52:55], v[24:27], a[136:143], v3
v_smfmac_f32_16x16x64_bf16 v[56:59], v[24:27], a[208:215], v3
v_smfmac_f32_16x16x64_bf16 v[60:63], v[24:27], v[96:103], v3
s_add_u32 s61, s63, s65
v_smfmac_f32_16x16x64_bf16 v[64:67], v[28:31], v[16:23], v3
v_smfmac_f32_16x16x64_bf16 v[68:71], v[28:31], v[32:39], v3
s_nop 1
v_add_f32 v48, v48, v49
v_add_f32 v50, v50, v51
v_cvt_pk_bf16_f32 v49, v48, v50
s_waitcnt lgkmcnt(0)
v_smfmac_f32_16x16x64_bf16 v[64:67], v[24:27], v[40:47], v3
v_add_f32 v52, v52, v53
v_add_f32 v54, v54, v55
v_cvt_pk_bf16_f32 v53, v52, v54
v_smfmac_f32_16x16x64_bf16 v[68:71], v[24:27], v[248:255], v3
v_add_f32 v56, v56, v57
v_add_f32 v58, v58, v59
v_cvt_pk_bf16_f32 v48, v56, v58
ds_write_b64 v4, v[48:49] offset:0
v_add_f32 v60, v60, v61
v_add_f32 v62, v62, v63
v_cvt_pk_bf16_f32 v52, v60, v62
ds_write_b64 v4, v[52:53] offset:512
buffer_load_dwordx4 v[16:19], v1, s[4:7], s61 offen sc1
buffer_load_dwordx4 v[20:23], v1, s[4:7], s61 offen offset:1024 sc1
v_add_f32 v64, v64, v65
v_add_f32 v66, v66, v67
v_cvt_pk_bf16_f32 v28, v64, v66
v_add_f32 v68, v68, v69
v_add_f32 v70, v70, v71
v_cvt_pk_bf16_f32 v29, v68, v70
s_waitcnt vmcnt(3) lgkmcnt(0)
s_barrier
ds_read_b64_tr_b16 v[48:49], v5 offset:0
ds_read_b64_tr_b16 v[50:51], v5 offset:256
ds_read_b128 v[32:35], v15 offset:2048
ds_read_b128 v[36:39], v15 offset:3072
ds_read_b64_tr_b16 v[52:53], v5 offset:1024
ds_read_b64_tr_b16 v[54:55], v5 offset:1280
ds_read_b128 v[40:43], v15 offset:4096
ds_read_b128 v[44:47], v15 offset:5120
ds_read_b64_tr_b16 v[64:65], v5 offset:2048
ds_read_b64_tr_b16 v[66:67], v5 offset:2304
ds_read_b64_tr_b16 v[68:69], v5 offset:3072
ds_read_b64_tr_b16 v[70:71], v5 offset:3328
s_add_u32 s61, s77, s78
v_and_or_b32 v28, v28, s70, v8
buffer_store_dwordx2 v[28:29], v2, s[4:7], s61 offen sc1
v_mov_b64 v[24:25], 0
v_mov_b64 v[26:27], s[98:99]
s_waitcnt lgkmcnt(10)
s_nop 0
v_mfma_f32_16x16x32_bf16 v[24:27], v[48:51], v[48:51], v[24:27]
s_waitcnt lgkmcnt(8)
v_mfma_f32_16x16x32_bf16 v[56:59], v[32:35], v[48:51], 0
v_mfma_f32_16x16x32_bf16 v[60:63], v[36:39], v[48:51], 0
ds_read_b128 v[32:35], v15 offset:6144
ds_read_b128 v[36:39], v15 offset:7168
s_waitcnt lgkmcnt(8)
v_mfma_f32_16x16x32_bf16 v[24:27], v[52:55], v[52:55], v[24:27]
s_waitcnt lgkmcnt(6)
v_mfma_f32_16x16x32_bf16 v[56:59], v[40:43], v[52:55], v[56:59]
v_mfma_f32_16x16x32_bf16 v[60:63], v[44:47], v[52:55], v[60:63]
ds_read_b128 v[40:43], v15 offset:8192
ds_read_b128 v[44:47], v15 offset:9216
s_waitcnt lgkmcnt(6)
v_mfma_f32_16x16x32_bf16 v[24:27], v[64:67], v[64:67], v[24:27]
s_waitcnt lgkmcnt(2)
v_mfma_f32_16x16x32_bf16 v[56:59], v[32:35], v[64:67], v[56:59]
v_mfma_f32_16x16x32_bf16 v[60:63], v[36:39], v[64:67], v[60:63]
v_mfma_f32_16x16x32_bf16 v[24:27], v[68:71], v[68:71], v[24:27]
s_waitcnt lgkmcnt(0)
v_mfma_f32_16x16x32_bf16 v[56:59], v[40:43], v[68:71], v[56:59]
v_mfma_f32_16x16x32_bf16 v[60:63], v[44:47], v[68:71], v[60:63]
s_mov_b32 exec_lo, 0x33333333
s_mov_b32 exec_hi, 0x33333333
s_cmp_ge_u32 s3, 2
s_cbranch_scc1 km23_482
s_bitcmp1_b32 s3, 0
s_cbranch_scc1 km_483
v_and_or_b32 v48, v48, s70, v8
buffer_store_dwordx4 v[48:51], v12, s[4:7], s77 offen offset:0 sc1
s_branch kmd_481
km_483:
v_and_or_b32 v52, v52, s70, v8
buffer_store_dwordx4 v[52:55], v12, s[4:7], s77 offen offset:512 sc1
s_branch kmd_481
km23_482:
s_bitcmp1_b32 s3, 0
s_cbranch_scc1 km_484
v_and_or_b32 v64, v64, s70, v8
buffer_store_dwordx4 v[64:67], v12, s[4:7], s77 offen offset:1024 sc1
s_branch kmd_481
km_484:
v_and_or_b32 v68, v68, s70, v8
buffer_store_dwordx4 v[68:71], v12, s[4:7], s77 offen offset:1536 sc1
kmd_481:
s_mov_b64 exec, -1
s_cmp_eq_u32 s62, 63
s_cbranch_scc1 chain_done_241
v_mov_b32 v36, 0x3f803f80
v_mov_b32 v37, 0x3f803f80
v_mov_b32 v45, 0
v_mov_b32 v46, 0
v_mov_b64 v[38:39], v[36:37]
v_max3_f32 v32, v24, v25, v56
v_max3_f32 v32, v32, v57, v58
v_max3_f32 v32, v32, v59, v60
v_max3_f32 v32, v32, v61, v62
v_max_f32 v32, v32, v63
v_mov_b32 v33, v32
s_add_u32 s63, s63, 786432
s_add_u32 s62, s62, 1
v_permlane16_swap_b32 v33, v32
v_max_f32 v32, v32, v33
v_mov_b32 v33, v32
s_and_b32 s64, s62, 1
s_nop 0
v_permlane32_swap_b32 v33, v32
v_max_f32 v32, v32, v33
v_mul_f32 v32, s66, v32
v_pk_fma_f32 v[24:25], v[24:25], s[66:67], v[32:33] op_sel_hi:[1,0,0] neg_lo:[0,0,1] neg_hi:[0,0,1]
v_pk_fma_f32 v[56:57], v[56:57], s[66:67], v[32:33] op_sel_hi:[1,0,0] neg_lo:[0,0,1] neg_hi:[0,0,1]
v_pk_fma_f32 v[58:59], v[58:59], s[66:67], v[32:33] op_sel_hi:[1,0,0] neg_lo:[0,0,1] neg_hi:[0,0,1]
v_pk_fma_f32 v[60:61], v[60:61], s[66:67], v[32:33] op_sel_hi:[1,0,0] neg_lo:[0,0,1] neg_hi:[0,0,1]
v_pk_fma_f32 v[62:63], v[62:63], s[66:67], v[32:33] op_sel_hi:[1,0,0] neg_lo:[0,0,1] neg_hi:[0,0,1]
v_exp_f32 v24, v24
v_exp_f32 v25, v25
v_exp_f32 v56, v56
v_exp_f32 v57, v57
v_cvt_pk_bf16_f32 v44, v24, v25
v_cvt_pk_bf16_f32 v47, v24, v25
v_exp_f32 v58, v58
v_exp_f32 v59, v59
v_mfma_f32_16x16x16_bf16 v[48:51], v[36:37], v[44:45], 0
v_exp_f32 v60, v60
v_mfma_f32_16x16x16_bf16 v[68:71], v[28:29], v[46:47], 0
v_exp_f32 v61, v61
v_mfma_f32_16x16x16_bf16 v[64:67], v[28:29], v[44:45], 0
v_exp_f32 v62, v62
v_exp_f32 v63, v63
v_cvt_pk_bf16_f32 v40, v56, v57
v_cvt_pk_bf16_f32 v41, v58, v59
v_cvt_pk_bf16_f32 v42, v60, v61
v_cvt_pk_bf16_f32 v43, v62, v63
s_waitcnt vmcnt(2)
s_nop 0
v_mfma_f32_16x16x32_bf16 v[48:51], v[36:39], v[40:43], v[48:51]
v_mfma_f32_16x16x32_bf16 v[68:71], v[20:23], v[40:43], v[68:71]
v_mfma_f32_16x16x32_bf16 v[64:67], v[16:19], v[40:43], v[64:67]
v_mov_b32 v13, s64
v_mov_b64 v[24:25], 0
v_mov_b64 v[26:27], 0
v_mov_b64 v[56:57], 0
v_mov_b64 v[58:59], 0
v_mov_b64 v[60:61], 0
v_mov_b64 v[62:63], 0
v_rcp_f32 v52, v48
s_nop 0
v_pk_mul_f32 v[68:69], v[68:69], v[52:53] op_sel_hi:[1,0]
v_pk_mul_f32 v[70:71], v[70:71], v[52:53] op_sel_hi:[1,0]
s_nop 0
v_cvt_pk_bf16_f32 v50, v68, v70
v_cvt_pk_bf16_f32 v51, v69, v71
v_pk_mul_f32 v[64:65], v[64:65], v[52:53] op_sel_hi:[1,0]
v_pk_mul_f32 v[66:67], v[66:67], v[52:53] op_sel_hi:[1,0]
s_mov_b32 exec_lo, 0xcccccccc
s_mov_b32 exec_hi, 0xcccccccc
ds_write_b32 v6, v50 offset:256
ds_write_b32 v6, v51 offset:272
s_mov_b64 exec, -1
v_cvt_pk_bf16_f32 v48, v64, v66
v_cvt_pk_bf16_f32 v49, v65, v67
s_mov_b32 exec_lo, 0xcccccccc
s_mov_b32 exec_hi, 0xcccccccc
ds_write_b32 v6, v48
ds_write_b32 v6, v49 offset:16
s_mov_b64 exec, -1
v_mov_b64 v[32:33], 0
v_mov_b64 v[34:35], 0
v_mov_b64 v[36:37], 0
v_mov_b64 v[38:39], 0
v_mov_b64 v[40:41], 0
v_mov_b64 v[42:43], 0
v_mov_b64 v[44:45], 0
v_mov_b64 v[46:47], 0
v_add_u32 v20, 152576, v1
s_waitcnt lgkmcnt(0)
s_barrier
ds_read_b128 v[48:51], v20 offset:0
ds_read_b128 v[52:55], v20 offset:1024
v_mov_b64 v[64:65], 0
v_mov_b64 v[66:67], 0
v_mov_b64 v[68:69], 0
v_mov_b64 v[70:71], 0
s_mov_b64 exec, 31
buffer_load_dword v23, v7, s[4:7], s58 offen sc1
s_mov_b64 exec, -1
s_add_u32 s45, s74, 32768
s_waitcnt lgkmcnt(0)
v_smfmac_f32_16x16x64_bf16 v[24:27], v[48:51], v[232:239], v3
v_smfmac_f32_16x16x64_bf16 v[24:27], v[52:55], v[240:247], v3
v_smfmac_f32_16x16x64_bf16 v[32:35], v[48:51], v[104:111], v3
v_smfmac_f32_16x16x64_bf16 v[36:39], v[48:51], v[120:127], v3
v_smfmac_f32_16x16x64_bf16 v[40:43], v[48:51], v[136:143], v3
v_smfmac_f32_16x16x64_bf16 v[44:47], v[48:51], v[152:159], v3
s_nop 3
v_add_f32 v24, v24, v25
v_add_f32 v26, v26, v27
v_smfmac_f32_16x16x64_bf16 v[32:35], v[52:55], v[112:119], v3
v_cvt_pk_bf16_f32 v24, v24, v26
v_smfmac_f32_16x16x64_bf16 v[36:39], v[52:55], v[128:135], v3
s_nop 0
v_permlane32_swap_b32 v24, v26
v_smfmac_f32_16x16x64_bf16 v[40:43], v[52:55], v[144:151], v3
s_nop 0
v_permlane16_swap_b32 v24, v25
v_permlane16_swap_b32 v26, v27
v_smfmac_f32_16x16x64_bf16 v[44:47], v[52:55], v[160:167], v3
v_and_or_b32 v24, v24, s70, v13
v_smfmac_f32_16x16x64_bf16 v[56:59], v[48:51], v[168:175], v3
s_mov_b64 exec, 0xffff
buffer_store_dwordx4 v[24:27], v9, s[4:7], s49 offen
s_mov_b64 exec, -1
v_smfmac_f32_16x16x64_bf16 v[60:63], v[48:51], v[184:191], v3
v_add_f32 v32, v32, v33
v_add_f32 v34, v34, v35
v_smfmac_f32_16x16x64_bf16 v[64:67], v[48:51], v[200:207], v3
v_cvt_pk_bf16_f32 v28, v32, v34
v_add_f32 v36, v36, v37
v_smfmac_f32_16x16x64_bf16 v[68:71], v[48:51], v[216:223], v3
v_add_f32 v38, v38, v39
v_cvt_pk_bf16_f32 v29, v36, v38
v_smfmac_f32_16x16x64_bf16 v[56:59], v[52:55], v[176:183], v3
v_add_f32 v40, v40, v41
v_add_f32 v42, v42, v43
v_smfmac_f32_16x16x64_bf16 v[60:63], v[52:55], v[192:199], v3
v_cvt_pk_bf16_f32 v30, v40, v42
v_add_f32 v44, v44, v45
v_smfmac_f32_16x16x64_bf16 v[64:67], v[52:55], v[208:215], v3
v_add_f32 v46, v46, v47
v_cvt_pk_bf16_f32 v31, v44, v46
v_smfmac_f32_16x16x64_bf16 v[68:71], v[52:55], v[224:231], v3
v_and_or_b32 v28, v28, s70, v13
buffer_store_dwordx4 v[28:31], v9, s[4:7], s74 offen
v_add_f32 v56, v56, v57
v_add_f32 v58, v58, v59
v_cvt_pk_bf16_f32 v32, v56, v58
v_add_f32 v60, v60, v61
v_add_f32 v62, v62, v63
v_cvt_pk_bf16_f32 v33, v60, v62
v_add_f32 v64, v64, v65
v_add_f32 v66, v66, v67
v_cvt_pk_bf16_f32 v34, v64, v66
v_add_f32 v68, v68, v69
v_add_f32 v70, v70, v71
v_cvt_pk_bf16_f32 v35, v68, v70
v_and_or_b32 v32, v32, s70, v13
buffer_store_dwordx4 v[32:35], v9, s[4:7], s45 offen
s_and_b32 s60, s62, 7
s_mul_i32 s60, s60, 131072
s_add_u32 s77, s59, s60
s_bfe_u32 s60, s62, 0x10003
s_xor_b32 s60, s60, 1
v_mov_b32 v8, s60
v_mov_b64 v[48:49], 0
v_mov_b64 v[50:51], 0
v_mov_b64 v[52:53], 0
v_mov_b64 v[54:55], 0
v_mov_b64 v[56:57], 0
v_mov_b64 v[58:59], 0
v_mov_b64 v[60:61], 0
v_mov_b64 v[62:63], 0
v_mov_b64 v[64:65], 0
v_mov_b64 v[66:67], 0
v_mov_b64 v[68:69], 0
v_mov_b64 v[70:71], 0
s_lshl_b32 s60, s3, 12
v_add_u32 v15, s60, v1
s_cmp_eq_u32 s48, 0
s_cbranch_scc1 noown_485
v_and_b32 v20, 15, v0
v_and_b32 v21, 1, v0
v_lshlrev_b32 v21, 4, v21
v_mov_b32 v22, 0x3f80
v_lshlrev_b32 v21, v21, v22
v_lshrrev_b32 v22, 1, v20
v_cmp_eq_u32 vcc, 0, v22
s_nop 1
v_cndmask_b32 v16, 0, v21, vcc
v_cmp_eq_u32 vcc, 1, v22
s_nop 1
v_cndmask_b32 v17, 0, v21, vcc
v_cmp_eq_u32 vcc, 2, v22
s_nop 1
v_cndmask_b32 v18, 0, v21, vcc
v_cmp_eq_u32 vcc, 3, v22
s_nop 1
v_cndmask_b32 v19, 0, v21, vcc
s_sleep 2
s_mov_b32 s67, 0
s_mov_b32 s97, 15
h1_488:
buffer_load_dwordx4 v[32:35], v1, s[4:7], s75 offen offset:0 sc1
buffer_load_dwordx4 v[36:39], v1, s[4:7], s75 offen offset:1024 sc1
buffer_load_dwordx4 v[40:43], v1, s[4:7], s75 offen offset:2048 sc1
buffer_load_dwordx4 v[44:47], v1, s[4:7], s75 offen offset:3072 sc1
s_add_u32 s67, s67, 1
s_cmp_gt_u32 s67, 400000
s_cbranch_scc1 chain_fail_240
s_waitcnt vmcnt(3)
v_mfma_f32_16x16x32_bf16 v[24:27], v[32:35], v[16:19], 0
v_xor_b32 v28, v32, v13
s_waitcnt vmcnt(2)
v_mfma_f32_16x16x32_bf16 v[24:27], v[36:39], v[16:19], v[24:27]
v_bitop3_b32 v28, v28, v36, v13 bitop3:0xf6
s_waitcnt vmcnt(1)
v_mfma_f32_16x16x32_bf16 v[24:27], v[40:43], v[16:19], v[24:27]
v_bitop3_b32 v28, v28, v40, v13 bitop3:0xf6
s_waitcnt vmcnt(0)
v_mfma_f32_16x16x32_bf16 v[24:27], v[44:47], v[16:19], v[24:27]
v_bitop3_b32 v28, v28, v44, v13 bitop3:0xf6
v_and_b32 v28, 1, v28
v_cmp_ne_u32 vcc, 0, v28
s_nop 0
s_cbranch_vccnz h1_488
s_add_u32 s60, s79, s76
s_nop 1
v_permlane32_swap_b32 v24, v26
v_permlane32_swap_b32 v25, v27
v_add_f32 v24, v24, v26
v_add_f32 v25, v25, v27
v_cvt_pk_bf16_f32 v30, v24, v25
v_min_u32 v30, s70, v30
buffer_store_dword v30, v10, s[4:7], s60 offen
noown_485:
s_lshl_b32 s45, s3, 11
s_add_u32 s45, s45, s79
s_lshl_b32 s46, s3, 8
s_add_u32 s46, s46, 8192
s_add_u32 s46, s46, s79
v_and_b32 v20, 0xf0, v1
v_add_u32 v21, s68, v20
s_barrier
s_sleep 1
s_mov_b32 s67, 0
h2_489:
buffer_load_dwordx4 v[24:27], v1, s[4:7], s45 offen offset:0 sc1
buffer_load_dwordx4 v[28:31], v1, s[4:7], s45 offen offset:1024 sc1
buffer_load_dwordx4 v[32:35], v20, s[4:7], s46 offen sc1
s_add_u32 s67, s67, 1
s_cmp_gt_u32 s67, 400000
s_cbranch_scc1 chain_fail_240
s_waitcnt vmcnt(2)
ds_write2_b64 v11, v[24:25], v[26:27] offset1:32
v_max3_u32 v40, v24, v25, v26
v_max3_u32 v40, v40, v26, v27
s_waitcnt vmcnt(1)
ds_write2_b64 v11, v[28:29], v[30:31] offset0:128 offset1:160
v_max3_u32 v40, v28, v29, v40
v_max3_u32 v40, v40, v30, v31
s_waitcnt vmcnt(0)
ds_write_b128 v21, v[32:35]
v_max3_u32 v40, v32, v33, v40
v_max3_u32 v40, v40, v34, v35
v_cmp_eq_u32 vcc, -1, v40
s_nop 0
s_cbranch_vccnz h2_489
v_mov_b32 v41, -1
s_add_u32 s60, s73, s76
buffer_store_dword v41, v10, s[4:7], s60 offen
s_cmp_eq_u32 s3, 3
s_cbranch_scc1 io_486
io_end_487:
s_mov_b32 s60, s79
s_mov_b32 s79, s71
s_mov_b32 s71, s73
s_mov_b32 s73, s60
s_waitcnt lgkmcnt(0)
s_barrier
s_branch chain_loop_480
io_486:
s_sub_u32 s62, s62, 1
s_add_u32 s62, s62, 1
s_add_u32 s61, s62, 1
v_cmp_gt_u32 vcc, s61, v23
s_nop 0
s_and_b32 vcc_lo, vcc_lo, 31
s_cbranch_scc0 io_end_487
s_add_u32 s61, s62, 1
s_mov_b32 s67, 0
sp_loop_490:
buffer_load_dword v32, v7, s[4:7], s58 offen sc1
s_add_u32 s67, s67, 1
s_cmp_gt_u32 s67, 150000
s_cbranch_scc1 sp_bad_492
s_waitcnt vmcnt(0)
v_cmp_gt_u32 vcc, s61, v32
s_nop 0
s_and_b32 vcc_lo, vcc_lo, 31
s_cbranch_scc0 sp_ok_491
s_sleep 1
s_branch sp_loop_490
sp_bad_492:
s_mov_b32 s98, 1792
s_branch L_fail
sp_ok_491:
s_branch io_end_487
chain_foreign_475:
s_mov_b32 s62, 0
s_lshl_b32 s65, s3, 11
s_add_u32 s65, s65, 16384
s_mul_i32 s63, s51, 24576
s_add_u32 s63, s63, s53
s_mul_i32 s77, s51, 4096
s_add_u32 s77, s77, s54
s_mov_b32 s59, s77
v_mov_b32 v8, 1
v_mov_b64 v[48:49], 0
v_mov_b64 v[50:51], 0
v_mov_b64 v[52:53], 0
v_mov_b64 v[54:55], 0
v_mov_b64 v[56:57], 0
v_mov_b64 v[58:59], 0
v_mov_b64 v[60:61], 0
v_mov_b64 v[62:63], 0
v_mov_b64 v[64:65], 0
v_mov_b64 v[66:67], 0
v_mov_b64 v[68:69], 0
v_mov_b64 v[70:71], 0
s_lshl_b32 s60, s3, 12
v_add_u32 v15, s60, v1
s_lshl_b32 s60, s3, 11
s_add_u32 s60, s60, 131072
v_add_u32 v14, s60, v1
s_cmp_lg_u32 s3, 3
s_cbranch_scc1 kx0_493
s_add_u32 s61, s62, 1
s_mov_b32 s67, 0
sp_loop_494:
buffer_load_dword v32, v7, s[4:7], s58 offen sc1
s_add_u32 s67, s67, 1
s_cmp_gt_u32 s67, 150000
s_cbranch_scc1 sp_bad_496
s_waitcnt vmcnt(0)
v_cmp_gt_u32 vcc, s61, v32
s_nop 0
s_and_b32 vcc_lo, vcc_lo, 31
s_cbranch_scc0 sp_ok_495
s_sleep 1
s_branch sp_loop_494
sp_bad_496:
s_mov_b32 s98, 1792
s_branch L_fail
sp_ok_495:
kx0_493:
s_barrier
chain_loop_497:
ds_read_b64_tr_b16 v[24:25], v2 offset:0
ds_read_b64_tr_b16 v[26:27], v2 offset:512
ds_read_b128 v[32:35], v15 offset:0
ds_read_b128 v[36:39], v15 offset:1024
ds_read_b64_tr_b16 v[28:29], v2 offset:1024
ds_read_b64_tr_b16 v[30:31], v2 offset:1536
s_sub_u32 s60, s65, 8192
s_add_u32 m0, s60, 146432
s_add_u32 s60, s60, s63
v_lshlrev_b32 v13, 7, v0
s_add_u32 s61, s63, s65
buffer_load_dwordx4 v1, s[4:7], s60 offen offset:0 sc1 lds
buffer_load_dwordx4 v1, s[4:7], s60 offen offset:1024 sc1 lds
s_mov_b64 exec, 0xffff
buffer_load_dword v13, v13, s[4:7], s61 offen sc1
s_mov_b64 exec, -1
s_waitcnt lgkmcnt(4)
v_smfmac_f32_16x16x64_bf16 v[48:51], v[24:27], a[0:7], v3
ds_read_b128 v[40:43], v15 offset:2048
v_smfmac_f32_16x16x64_bf16 v[52:55], v[24:27], a[72:79], v3
ds_read_b128 v[44:47], v15 offset:3072
v_smfmac_f32_16x16x64_bf16 v[56:59], v[24:27], a[144:151], v3
ds_read_b128 v[16:19], v15 offset:16384
v_smfmac_f32_16x16x64_bf16 v[60:63], v[24:27], a[216:223], v3
ds_read_b128 v[20:23], v15 offset:17408
s_waitcnt lgkmcnt(6)
v_smfmac_f32_16x16x64_bf16 v[64:67], v[24:27], v[32:39], v3
ds_read_b128 v[32:35], v15 offset:18432
s_waitcnt lgkmcnt(3)
v_smfmac_f32_16x16x64_bf16 v[68:71], v[24:27], v[40:47], v3
ds_read_b128 v[36:39], v15 offset:19456
v_smfmac_f32_16x16x64_bf16 v[48:51], v[28:31], a[8:15], v3
ds_read_b64_tr_b16 v[24:25], v2 offset:2048
v_smfmac_f32_16x16x64_bf16 v[52:55], v[28:31], a[80:87], v3
ds_read_b64_tr_b16 v[26:27], v2 offset:2560
v_smfmac_f32_16x16x64_bf16 v[56:59], v[28:31], a[152:159], v3
ds_read_b128 v[40:43], v15 offset:32768
v_smfmac_f32_16x16x64_bf16 v[60:63], v[28:31], a[224:231], v3
ds_read_b128 v[44:47], v15 offset:33792
s_waitcnt lgkmcnt(6)
v_smfmac_f32_16x16x64_bf16 v[64:67], v[28:31], v[16:23], v3
ds_read_b128 v[16:19], v15 offset:34816
s_waitcnt lgkmcnt(5)
v_smfmac_f32_16x16x64_bf16 v[68:71], v[28:31], v[32:39], v3
ds_read_b128 v[20:23], v15 offset:35840
s_waitcnt lgkmcnt(4)
v_smfmac_f32_16x16x64_bf16 v[48:51], v[24:27], a[16:23], v3
ds_read_b64_tr_b16 v[28:29], v2 offset:3072
v_smfmac_f32_16x16x64_bf16 v[52:55], v[24:27], a[88:95], v3
ds_read_b64_tr_b16 v[30:31], v2 offset:3584
v_smfmac_f32_16x16x64_bf16 v[56:59], v[24:27], a[160:167], v3
ds_read_b128 v[32:35], v15 offset:49152
v_smfmac_f32_16x16x64_bf16 v[60:63], v[24:27], a[232:239], v3
ds_read_b128 v[36:39], v15 offset:50176
s_waitcnt lgkmcnt(6)
v_smfmac_f32_16x16x64_bf16 v[64:67], v[24:27], v[40:47], v3
ds_read_b128 v[40:43], v15 offset:51200
s_waitcnt lgkmcnt(5)
v_smfmac_f32_16x16x64_bf16 v[68:71], v[24:27], v[16:23], v3
ds_read_b128 v[44:47], v15 offset:52224
s_waitcnt lgkmcnt(4)
v_smfmac_f32_16x16x64_bf16 v[48:51], v[28:31], a[24:31], v3
ds_read_b64_tr_b16 v[24:25], v2 offset:4096
v_smfmac_f32_16x16x64_bf16 v[52:55], v[28:31], a[96:103], v3
ds_read_b64_tr_b16 v[26:27], v2 offset:4608
v_smfmac_f32_16x16x64_bf16 v[56:59], v[28:31], a[168:175], v3
v_add_u32 v15, 65536, v15
ds_read_b128 v[16:19], v15 offset:0
v_smfmac_f32_16x16x64_bf16 v[60:63], v[28:31], a[240:247], v3
ds_read_b128 v[20:23], v15 offset:1024
s_waitcnt lgkmcnt(6)
v_smfmac_f32_16x16x64_bf16 v[64:67], v[28:31], v[32:39], v3
ds_read_b128 v[32:35], v15 offset:2048
s_waitcnt lgkmcnt(5)
v_smfmac_f32_16x16x64_bf16 v[68:71], v[28:31], v[40:47], v3
ds_read_b128 v[36:39], v15 offset:3072
s_waitcnt lgkmcnt(4)
v_smfmac_f32_16x16x64_bf16 v[48:51], v[24:27], a[32:39], v3
ds_read_b64_tr_b16 v[28:29], v2 offset:5120
v_smfmac_f32_16x16x64_bf16 v[52:55], v[24:27], a[104:111], v3
ds_read_b64_tr_b16 v[30:31], v2 offset:5632
v_smfmac_f32_16x16x64_bf16 v[56:59], v[24:27], a[176:183], v3
ds_read_b128 v[40:43], v15 offset:16384
v_smfmac_f32_16x16x64_bf16 v[60:63], v[24:27], a[248:255], v3
ds_read_b128 v[44:47], v15 offset:17408
s_waitcnt lgkmcnt(6)
v_smfmac_f32_16x16x64_bf16 v[64:67], v[24:27], v[16:23], v3
ds_read_b128 v[16:19], v15 offset:18432
s_waitcnt lgkmcnt(5)
v_smfmac_f32_16x16x64_bf16 v[68:71], v[24:27], v[32:39], v3
ds_read_b128 v[20:23], v15 offset:19456
s_waitcnt lgkmcnt(4)
v_smfmac_f32_16x16x64_bf16 v[48:51], v[28:31], a[40:47], v3
ds_read_b64_tr_b16 v[24:25], v2 offset:6144
v_smfmac_f32_16x16x64_bf16 v[52:55], v[28:31], a[112:119], v3
ds_read_b64_tr_b16 v[26:27], v2 offset:6656
v_smfmac_f32_16x16x64_bf16 v[56:59], v[28:31], a[184:191], v3
ds_read_b128 v[32:35], v15 offset:32768
v_smfmac_f32_16x16x64_bf16 v[60:63], v[28:31], v[72:79], v3
ds_read_b128 v[36:39], v15 offset:33792
s_waitcnt lgkmcnt(6)
v_smfmac_f32_16x16x64_bf16 v[64:67], v[28:31], v[40:47], v3
ds_read_b128 v[40:43], v15 offset:34816
s_waitcnt lgkmcnt(5)
v_smfmac_f32_16x16x64_bf16 v[68:71], v[28:31], v[16:23], v3
ds_read_b128 v[44:47], v15 offset:35840
s_waitcnt lgkmcnt(4)
v_smfmac_f32_16x16x64_bf16 v[48:51], v[24:27], a[48:55], v3
ds_read_b64_tr_b16 v[28:29], v2 offset:7168
v_smfmac_f32_16x16x64_bf16 v[52:55], v[24:27], a[120:127], v3
ds_read_b64_tr_b16 v[30:31], v2 offset:7680
v_smfmac_f32_16x16x64_bf16 v[56:59], v[24:27], a[192:199], v3
ds_read_b128 v[16:19], v15 offset:49152
v_smfmac_f32_16x16x64_bf16 v[60:63], v[24:27], v[80:87], v3
ds_read_b128 v[20:23], v15 offset:50176
s_waitcnt lgkmcnt(6)
v_smfmac_f32_16x16x64_bf16 v[64:67], v[24:27], v[32:39], v3
ds_read_b128 v[32:35], v15 offset:51200
s_waitcnt lgkmcnt(5)
v_smfmac_f32_16x16x64_bf16 v[68:71], v[24:27], v[40:47], v3
ds_read_b128 v[36:39], v15 offset:52224
s_waitcnt lgkmcnt(4)
v_smfmac_f32_16x16x64_bf16 v[48:51], v[28:31], a[56:63], v3
ds_read_b64_tr_b16 v[24:25], v2 offset:8192
v_smfmac_f32_16x16x64_bf16 v[52:55], v[28:31], a[128:135], v3
ds_read_b64_tr_b16 v[26:27], v2 offset:8704
v_smfmac_f32_16x16x64_bf16 v[56:59], v[28:31], a[200:207], v3
ds_read_b128 v[40:43], v14 offset:0
v_smfmac_f32_16x16x64_bf16 v[60:63], v[28:31], v[88:95], v3
ds_read_b128 v[44:47], v14 offset:1024
v_add_u32 v15, 152576, v1
s_waitcnt lgkmcnt(2)
v_smfmac_f32_16x16x64_bf16 v[48:51], v[24:27], a[64:71], v3
v_smfmac_f32_16x16x64_bf16 v[52:55], v[24:27], a[136:143], v3
v_smfmac_f32_16x16x64_bf16 v[56:59], v[24:27], a[208:215], v3
v_smfmac_f32_16x16x64_bf16 v[60:63], v[24:27], v[96:103], v3
s_add_u32 s61, s63, s65
v_smfmac_f32_16x16x64_bf16 v[64:67], v[28:31], v[16:23], v3
v_smfmac_f32_16x16x64_bf16 v[68:71], v[28:31], v[32:39], v3
s_nop 1
v_add_f32 v48, v48, v49
v_add_f32 v50, v50, v51
v_cvt_pk_bf16_f32 v49, v48, v50
s_waitcnt lgkmcnt(0)
v_smfmac_f32_16x16x64_bf16 v[64:67], v[24:27], v[40:47], v3
v_add_f32 v52, v52, v53
v_add_f32 v54, v54, v55
v_cvt_pk_bf16_f32 v53, v52, v54
v_smfmac_f32_16x16x64_bf16 v[68:71], v[24:27], v[248:255], v3
v_add_f32 v56, v56, v57
v_add_f32 v58, v58, v59
v_cvt_pk_bf16_f32 v48, v56, v58
ds_write_b64 v4, v[48:49] offset:0
v_add_f32 v60, v60, v61
v_add_f32 v62, v62, v63
v_cvt_pk_bf16_f32 v52, v60, v62
ds_write_b64 v4, v[52:53] offset:512
buffer_load_dwordx4 v[16:19], v1, s[4:7], s61 offen sc1
buffer_load_dwordx4 v[20:23], v1, s[4:7], s61 offen offset:1024 sc1
v_add_f32 v64, v64, v65
v_add_f32 v66, v66, v67
v_cvt_pk_bf16_f32 v28, v64, v66
v_add_f32 v68, v68, v69
v_add_f32 v70, v70, v71
v_cvt_pk_bf16_f32 v29, v68, v70
s_waitcnt vmcnt(3) lgkmcnt(0)
s_barrier
ds_read_b64_tr_b16 v[48:49], v5 offset:0
ds_read_b64_tr_b16 v[50:51], v5 offset:256
ds_read_b128 v[32:35], v15 offset:2048
ds_read_b128 v[36:39], v15 offset:3072
ds_read_b64_tr_b16 v[52:53], v5 offset:1024
ds_read_b64_tr_b16 v[54:55], v5 offset:1280
ds_read_b128 v[40:43], v15 offset:4096
ds_read_b128 v[44:47], v15 offset:5120
ds_read_b64_tr_b16 v[64:65], v5 offset:2048
ds_read_b64_tr_b16 v[66:67], v5 offset:2304
ds_read_b64_tr_b16 v[68:69], v5 offset:3072
ds_read_b64_tr_b16 v[70:71], v5 offset:3328
s_add_u32 s61, s77, s78
v_and_or_b32 v28, v28, s70, v8
buffer_store_dwordx2 v[28:29], v2, s[4:7], s61 offen sc1
v_mov_b64 v[24:25], 0
v_mov_b64 v[26:27], s[98:99]
s_waitcnt lgkmcnt(10)
s_nop 0
v_mfma_f32_16x16x32_bf16 v[24:27], v[48:51], v[48:51], v[24:27]
s_waitcnt lgkmcnt(8)
v_mfma_f32_16x16x32_bf16 v[56:59], v[32:35], v[48:51], 0
v_mfma_f32_16x16x32_bf16 v[60:63], v[36:39], v[48:51], 0
ds_read_b128 v[32:35], v15 offset:6144
ds_read_b128 v[36:39], v15 offset:7168
s_waitcnt lgkmcnt(8)
v_mfma_f32_16x16x32_bf16 v[24:27], v[52:55], v[52:55], v[24:27]
s_waitcnt lgkmcnt(6)
v_mfma_f32_16x16x32_bf16 v[56:59], v[40:43], v[52:55], v[56:59]
v_mfma_f32_16x16x32_bf16 v[60:63], v[44:47], v[52:55], v[60:63]
ds_read_b128 v[40:43], v15 offset:8192
ds_read_b128 v[44:47], v15 offset:9216
s_waitcnt lgkmcnt(6)
v_mfma_f32_16x16x32_bf16 v[24:27], v[64:67], v[64:67], v[24:27]
s_waitcnt lgkmcnt(2)
v_mfma_f32_16x16x32_bf16 v[56:59], v[32:35], v[64:67], v[56:59]
v_mfma_f32_16x16x32_bf16 v[60:63], v[36:39], v[64:67], v[60:63]
v_mfma_f32_16x16x32_bf16 v[24:27], v[68:71], v[68:71], v[24:27]
s_waitcnt lgkmcnt(0)
v_mfma_f32_16x16x32_bf16 v[56:59], v[40:43], v[68:71], v[56:59]
v_mfma_f32_16x16x32_bf16 v[60:63], v[44:47], v[68:71], v[60:63]
s_mov_b32 exec_lo, 0x33333333
s_mov_b32 exec_hi, 0x33333333
s_cmp_ge_u32 s3, 2
s_cbranch_scc1 km23_499
s_bitcmp1_b32 s3, 0
s_cbranch_scc1 km_500
v_and_or_b32 v48, v48, s70, v8
buffer_store_dwordx4 v[48:51], v12, s[4:7], s77 offen offset:0 sc1
s_branch kmd_498
km_500:
v_and_or_b32 v52, v52, s70, v8
buffer_store_dwordx4 v[52:55], v12, s[4:7], s77 offen offset:512 sc1
s_branch kmd_498
km23_499:
s_bitcmp1_b32 s3, 0
s_cbranch_scc1 km_501
v_and_or_b32 v64, v64, s70, v8
buffer_store_dwordx4 v[64:67], v12, s[4:7], s77 offen offset:1024 sc1
s_branch kmd_498
km_501:
v_and_or_b32 v68, v68, s70, v8
buffer_store_dwordx4 v[68:71], v12, s[4:7], s77 offen offset:1536 sc1
kmd_498:
s_mov_b64 exec, -1
s_cmp_eq_u32 s62, 63
s_cbranch_scc1 chain_done_241
v_mov_b32 v36, 0x3f803f80
v_mov_b32 v37, 0x3f803f80
v_mov_b32 v45, 0
v_mov_b32 v46, 0
v_mov_b64 v[38:39], v[36:37]
v_max3_f32 v32, v24, v25, v56
v_max3_f32 v32, v32, v57, v58
v_max3_f32 v32, v32, v59, v60
v_max3_f32 v32, v32, v61, v62
v_max_f32 v32, v32, v63
v_mov_b32 v33, v32
s_add_u32 s63, s63, 786432
s_add_u32 s62, s62, 1
v_permlane16_swap_b32 v33, v32
v_max_f32 v32, v32, v33
v_mov_b32 v33, v32
s_and_b32 s64, s62, 1
s_nop 0
v_permlane32_swap_b32 v33, v32
v_max_f32 v32, v32, v33
v_mul_f32 v32, s66, v32
v_pk_fma_f32 v[24:25], v[24:25], s[66:67], v[32:33] op_sel_hi:[1,0,0] neg_lo:[0,0,1] neg_hi:[0,0,1]
v_pk_fma_f32 v[56:57], v[56:57], s[66:67], v[32:33] op_sel_hi:[1,0,0] neg_lo:[0,0,1] neg_hi:[0,0,1]
v_pk_fma_f32 v[58:59], v[58:59], s[66:67], v[32:33] op_sel_hi:[1,0,0] neg_lo:[0,0,1] neg_hi:[0,0,1]
v_pk_fma_f32 v[60:61], v[60:61], s[66:67], v[32:33] op_sel_hi:[1,0,0] neg_lo:[0,0,1] neg_hi:[0,0,1]
v_pk_fma_f32 v[62:63], v[62:63], s[66:67], v[32:33] op_sel_hi:[1,0,0] neg_lo:[0,0,1] neg_hi:[0,0,1]
v_exp_f32 v24, v24
v_exp_f32 v25, v25
v_exp_f32 v56, v56
v_exp_f32 v57, v57
v_cvt_pk_bf16_f32 v44, v24, v25
v_cvt_pk_bf16_f32 v47, v24, v25
v_exp_f32 v58, v58
v_exp_f32 v59, v59
v_mfma_f32_16x16x16_bf16 v[48:51], v[36:37], v[44:45], 0
v_exp_f32 v60, v60
v_mfma_f32_16x16x16_bf16 v[68:71], v[28:29], v[46:47], 0
v_exp_f32 v61, v61
v_mfma_f32_16x16x16_bf16 v[64:67], v[28:29], v[44:45], 0
v_exp_f32 v62, v62
v_exp_f32 v63, v63
v_cvt_pk_bf16_f32 v40, v56, v57
v_cvt_pk_bf16_f32 v41, v58, v59
v_cvt_pk_bf16_f32 v42, v60, v61
v_cvt_pk_bf16_f32 v43, v62, v63
s_waitcnt vmcnt(2)
s_nop 0
v_mfma_f32_16x16x32_bf16 v[48:51], v[36:39], v[40:43], v[48:51]
v_mfma_f32_16x16x32_bf16 v[68:71], v[20:23], v[40:43], v[68:71]
v_mfma_f32_16x16x32_bf16 v[64:67], v[16:19], v[40:43], v[64:67]
v_mov_b32 v13, s64
v_mov_b64 v[24:25], 0
v_mov_b64 v[26:27], 0
v_mov_b64 v[56:57], 0
v_mov_b64 v[58:59], 0
v_mov_b64 v[60:61], 0
v_mov_b64 v[62:63], 0
v_rcp_f32 v52, v48
s_nop 0
v_pk_mul_f32 v[68:69], v[68:69], v[52:53] op_sel_hi:[1,0]
v_pk_mul_f32 v[70:71], v[70:71], v[52:53] op_sel_hi:[1,0]
s_nop 0
v_cvt_pk_bf16_f32 v50, v68, v70
v_cvt_pk_bf16_f32 v51, v69, v71
v_pk_mul_f32 v[64:65], v[64:65], v[52:53] op_sel_hi:[1,0]
v_pk_mul_f32 v[66:67], v[66:67], v[52:53] op_sel_hi:[1,0]
s_mov_b32 exec_lo, 0xcccccccc
s_mov_b32 exec_hi, 0xcccccccc
ds_write_b32 v6, v50 offset:256
ds_write_b32 v6, v51 offset:272
s_mov_b64 exec, -1
v_cvt_pk_bf16_f32 v48, v64, v66
v_cvt_pk_bf16_f32 v49, v65, v67
s_mov_b32 exec_lo, 0xcccccccc
s_mov_b32 exec_hi, 0xcccccccc
ds_write_b32 v6, v48
ds_write_b32 v6, v49 offset:16
s_mov_b64 exec, -1
v_mov_b64 v[32:33], 0
v_mov_b64 v[34:35], 0
v_mov_b64 v[36:37], 0
v_mov_b64 v[38:39], 0
v_mov_b64 v[40:41], 0
v_mov_b64 v[42:43], 0
v_mov_b64 v[44:45], 0
v_mov_b64 v[46:47], 0
v_add_u32 v20, 152576, v1
s_waitcnt lgkmcnt(0)
s_barrier
ds_read_b128 v[48:51], v20 offset:0
ds_read_b128 v[52:55], v20 offset:1024
v_mov_b64 v[64:65], 0
v_mov_b64 v[66:67], 0
v_mov_b64 v[68:69], 0
v_mov_b64 v[70:71], 0
s_mov_b64 exec, 31
buffer_load_dword v23, v7, s[4:7], s58 offen sc1
s_mov_b64 exec, -1
s_add_u32 s45, s74, 32768
s_waitcnt lgkmcnt(0)
v_smfmac_f32_16x16x64_bf16 v[24:27], v[48:51], v[232:239], v3
v_smfmac_f32_16x16x64_bf16 v[24:27], v[52:55], v[240:247], v3
v_smfmac_f32_16x16x64_bf16 v[32:35], v[48:51], v[104:111], v3
v_smfmac_f32_16x16x64_bf16 v[36:39], v[48:51], v[120:127], v3
v_smfmac_f32_16x16x64_bf16 v[40:43], v[48:51], v[136:143], v3
v_smfmac_f32_16x16x64_bf16 v[44:47], v[48:51], v[152:159], v3
s_nop 3
v_add_f32 v24, v24, v25
v_add_f32 v26, v26, v27
v_smfmac_f32_16x16x64_bf16 v[32:35], v[52:55], v[112:119], v3
v_cvt_pk_bf16_f32 v24, v24, v26
v_smfmac_f32_16x16x64_bf16 v[36:39], v[52:55], v[128:135], v3
s_nop 0
v_permlane32_swap_b32 v24, v26
v_smfmac_f32_16x16x64_bf16 v[40:43], v[52:55], v[144:151], v3
s_nop 0
v_permlane16_swap_b32 v24, v25
v_permlane16_swap_b32 v26, v27
v_smfmac_f32_16x16x64_bf16 v[44:47], v[52:55], v[160:167], v3
v_and_or_b32 v24, v24, s70, v13
v_smfmac_f32_16x16x64_bf16 v[56:59], v[48:51], v[168:175], v3
s_mov_b64 exec, 0xffff
buffer_store_dwordx4 v[24:27], v9, s[4:7], s49 offen sc1
s_mov_b64 exec, -1
v_smfmac_f32_16x16x64_bf16 v[60:63], v[48:51], v[184:191], v3
v_add_f32 v32, v32, v33
v_add_f32 v34, v34, v35
v_smfmac_f32_16x16x64_bf16 v[64:67], v[48:51], v[200:207], v3
v_cvt_pk_bf16_f32 v28, v32, v34
v_add_f32 v36, v36, v37
v_smfmac_f32_16x16x64_bf16 v[68:71], v[48:51], v[216:223], v3
v_add_f32 v38, v38, v39
v_cvt_pk_bf16_f32 v29, v36, v38
v_smfmac_f32_16x16x64_bf16 v[56:59], v[52:55], v[176:183], v3
v_add_f32 v40, v40, v41
v_add_f32 v42, v42, v43
v_smfmac_f32_16x16x64_bf16 v[60:63], v[52:55], v[192:199], v3
v_cvt_pk_bf16_f32 v30, v40, v42
v_add_f32 v44, v44, v45
v_smfmac_f32_16x16x64_bf16 v[64:67], v[52:55], v[208:215], v3
v_add_f32 v46, v46, v47
v_cvt_pk_bf16_f32 v31, v44, v46
v_smfmac_f32_16x16x64_bf16 v[68:71], v[52:55], v[224:231], v3
v_and_or_b32 v28, v28, s70, v13
buffer_store_dwordx4 v[28:31], v9, s[4:7], s74 offen sc1
v_add_f32 v56, v56, v57
v_add_f32 v58, v58, v59
v_cvt_pk_bf16_f32 v32, v56, v58
v_add_f32 v60, v60, v61
v_add_f32 v62, v62, v63
v_cvt_pk_bf16_f32 v33, v60, v62
v_add_f32 v64, v64, v65
v_add_f32 v66, v66, v67
v_cvt_pk_bf16_f32 v34, v64, v66
v_add_f32 v68, v68, v69
v_add_f32 v70, v70, v71
v_cvt_pk_bf16_f32 v35, v68, v70
v_and_or_b32 v32, v32, s70, v13
buffer_store_dwordx4 v[32:35], v9, s[4:7], s45 offen sc1
s_and_b32 s60, s62, 7
s_mul_i32 s60, s60, 131072
s_add_u32 s77, s59, s60
s_bfe_u32 s60, s62, 0x10003
s_xor_b32 s60, s60, 1
v_mov_b32 v8, s60
v_mov_b64 v[48:49], 0
v_mov_b64 v[50:51], 0
v_mov_b64 v[52:53], 0
v_mov_b64 v[54:55], 0
v_mov_b64 v[56:57], 0
v_mov_b64 v[58:59], 0
v_mov_b64 v[60:61], 0
v_mov_b64 v[62:63], 0
v_mov_b64 v[64:65], 0
v_mov_b64 v[66:67], 0
v_mov_b64 v[68:69], 0
v_mov_b64 v[70:71], 0
s_lshl_b32 s60, s3, 12
v_add_u32 v15, s60, v1
s_cmp_eq_u32 s48, 0
s_cbranch_scc1 noown_502
v_and_b32 v20, 15, v0
v_and_b32 v21, 1, v0
v_lshlrev_b32 v21, 4, v21
v_mov_b32 v22, 0x3f80
v_lshlrev_b32 v21, v21, v22
v_lshrrev_b32 v22, 1, v20
v_cmp_eq_u32 vcc, 0, v22
s_nop 1
v_cndmask_b32 v16, 0, v21, vcc
v_cmp_eq_u32 vcc, 1, v22
s_nop 1
v_cndmask_b32 v17, 0, v21, vcc
v_cmp_eq_u32 vcc, 2, v22
s_nop 1
v_cndmask_b32 v18, 0, v21, vcc
v_cmp_eq_u32 vcc, 3, v22
s_nop 1
v_cndmask_b32 v19, 0, v21, vcc
s_sleep 2
s_mov_b32 s67, 0
s_mov_b32 s97, 15
h1_505:
buffer_load_dwordx4 v[32:35], v1, s[4:7], s75 offen offset:0 sc1
buffer_load_dwordx4 v[36:39], v1, s[4:7], s75 offen offset:1024 sc1
buffer_load_dwordx4 v[40:43], v1, s[4:7], s75 offen offset:2048 sc1
buffer_load_dwordx4 v[44:47], v1, s[4:7], s75 offen offset:3072 sc1
s_add_u32 s67, s67, 1
s_cmp_gt_u32 s67, 400000
s_cbranch_scc1 chain_fail_240
s_waitcnt vmcnt(3)
v_mfma_f32_16x16x32_bf16 v[24:27], v[32:35], v[16:19], 0
v_xor_b32 v28, v32, v13
s_waitcnt vmcnt(2)
v_mfma_f32_16x16x32_bf16 v[24:27], v[36:39], v[16:19], v[24:27]
v_bitop3_b32 v28, v28, v36, v13 bitop3:0xf6
s_waitcnt vmcnt(1)
v_mfma_f32_16x16x32_bf16 v[24:27], v[40:43], v[16:19], v[24:27]
v_bitop3_b32 v28, v28, v40, v13 bitop3:0xf6
s_waitcnt vmcnt(0)
v_mfma_f32_16x16x32_bf16 v[24:27], v[44:47], v[16:19], v[24:27]
v_bitop3_b32 v28, v28, v44, v13 bitop3:0xf6
v_and_b32 v28, 1, v28
v_cmp_ne_u32 vcc, 0, v28
s_nop 0
s_cbranch_vccnz h1_505
s_add_u32 s60, s79, s76
s_nop 1
v_permlane32_swap_b32 v24, v26
v_permlane32_swap_b32 v25, v27
v_add_f32 v24, v24, v26
v_add_f32 v25, v25, v27
v_cvt_pk_bf16_f32 v30, v24, v25
v_min_u32 v30, s70, v30
buffer_store_dword v30, v10, s[4:7], s60 offen sc1
noown_502:
s_lshl_b32 s45, s3, 11
s_add_u32 s45, s45, s79
s_lshl_b32 s46, s3, 8
s_add_u32 s46, s46, 8192
s_add_u32 s46, s46, s79
v_and_b32 v20, 0xf0, v1
v_add_u32 v21, s68, v20
s_barrier
s_sleep 1
s_mov_b32 s67, 0
h2_506:
buffer_load_dwordx4 v[24:27], v1, s[4:7], s45 offen offset:0 sc1
buffer_load_dwordx4 v[28:31], v1, s[4:7], s45 offen offset:1024 sc1
buffer_load_dwordx4 v[32:35], v20, s[4:7], s46 offen sc1
s_add_u32 s67, s67, 1
s_cmp_gt_u32 s67, 400000
s_cbranch_scc1 chain_fail_240
s_waitcnt vmcnt(2)
ds_write2_b64 v11, v[24:25], v[26:27] offset1:32
v_max3_u32 v40, v24, v25, v26
v_max3_u32 v40, v40, v26, v27
s_waitcnt vmcnt(1)
ds_write2_b64 v11, v[28:29], v[30:31] offset0:128 offset1:160
v_max3_u32 v40, v28, v29, v40
v_max3_u32 v40, v40, v30, v31
s_waitcnt vmcnt(0)
ds_write_b128 v21, v[32:35]
v_max3_u32 v40, v32, v33, v40
v_max3_u32 v40, v40, v34, v35
v_cmp_eq_u32 vcc, -1, v40
s_nop 0
s_cbranch_vccnz h2_506
v_mov_b32 v41, -1
s_add_u32 s60, s73, s76
buffer_store_dword v41, v10, s[4:7], s60 offen sc1
s_cmp_eq_u32 s3, 3
s_cbranch_scc1 io_503
io_end_504:
s_mov_b32 s60, s79
s_mov_b32 s79, s71
s_mov_b32 s71, s73
s_mov_b32 s73, s60
s_waitcnt lgkmcnt(0)
s_barrier
s_branch chain_loop_497
io_503:
s_sub_u32 s62, s62, 1
s_add_u32 s62, s62, 1
s_add_u32 s61, s62, 1
v_cmp_gt_u32 vcc, s61, v23
s_nop 0
s_and_b32 vcc_lo, vcc_lo, 31
s_cbranch_scc0 io_end_504
s_add_u32 s61, s62, 1
s_mov_b32 s67, 0
sp_loop_507:
buffer_load_dword v32, v7, s[4:7], s58 offen sc1
s_add_u32 s67, s67, 1
s_cmp_gt_u32 s67, 150000
s_cbranch_scc1 sp_bad_509
s_waitcnt vmcnt(0)
v_cmp_gt_u32 vcc, s61, v32
s_nop 0
s_and_b32 vcc_lo, vcc_lo, 31
s_cbranch_scc0 sp_ok_508
s_sleep 1
s_branch sp_loop_507
sp_bad_509:
s_mov_b32 s98, 1792
s_branch L_fail
sp_ok_508:
s_branch io_end_504
chain_fail_240:
v_mov_b32 v24, 0xdead
v_mov_b32 v25, 252
buffer_store_dword v24, v25, s[12:15], 0 offen
s_waitcnt vmcnt(0)
s_endpgm
chain_done_241:
s_endpgm
.p2align 2
L_roles:
.short 0,0,0,0,0,0,0,0,0,0,0,0,0,0,0,0,0,0,0,0,0,0,0,0,0,0,0,0,0,0,0,0
.short 0,0,0,0,0,0,0,0,0,0,0,0,0,0,0,0,0,0,0,0,0,0,0,0,0,0,0,0,0,0,0,0
.short 0,1,2,3,4,5,256,257,258,6,7,8,9,10,11,259,260,261,512,513,514,768,769,1024,1025,1280,1281,1282,1283,1284,1285,1286
.short 12,13,14,15,16,17,262,263,264,18,19,20,21,22,23,265,266,267,515,516,517,770,771,1026,1027,1287,1288,1289,1290,1291,1292,1293
.short 24,25,26,27,28,29,268,269,270,518,519,520,772,773,521,522,523,774,775,1028,1029,1294,1295,1296,1297,1298,1299,1300,1301,1302,1303,1304
.short 30,31,32,33,34,35,271,272,273,524,525,526,776,777,527,528,529,778,779,1030,1031,1305,1306,1307,1308,1309,1310,1311,1312,1313,1314,1315
.short 36,37,38,39,40,41,274,275,276,530,531,532,780,781,1032,1033,1034,1035,1316,1317,1318,1319,1320,1321,1322,1323,1324,1325,1326,1327,1328,1329
.short 42,43,44,45,46,47,277,278,279,533,534,535,782,783,1036,1037,1038,1039,1330,1331,1332,1333,1334,1335,1336,1337,1338,1339,1340,1341,1342,1343
L_writers:
.byte 2,2,3,3,4,4,5,5,6,6,6,6,7,7,7,7,2,2,2,2,2,2,2,3,3,3,3,3,3,3,4,4,4,4,4,4,4,4,4,4,4,5,5,5,5,5,5,5,5,5,5,5,6,6,6,6,6,6,6,6,6,6,6,6
.byte 6,6,7,7,7,7,7,7,7,7,7,7,7,7,7,7,0,0,0,0,0,0,0,0,0,0,0,0,0,0,0,0,0,0,0,0,0,0,0,0,0,0,0,0,0,0,0,0,2,2,2,2,3,3,3,3,4,4,4,4,4,4,4,4
.byte 5,5,5,5,5,5,5,5,6,6,6,6,7,7,7,7,2,2,2,3,3,3,4,4,4,4,4,4,5,5,5,5,5,5,6,6,6,7,7,7,2,2,3,3,4,4,5,5,6,6,6,6,7,7,7,7,2,2,2,2,2,2,2,2
.byte 2,2,2,2,3,3,3,3,3,3,3,3,3,3,3,3,4,4,4,4,4,4,5,5,5,5,5,5,6,6,6,6,6,6,7,7,7,7,7,7,2,2,2,2,2,2,3,3,3,3,3,3,4,4,4,5,5,5,6,6,6,7,7,7
.byte 2,2,3,3,4,4,5,5,6,6,6,6,7,7,7,7,2,2,2,2,2,2,2,3,3,3,3,3,3,3,4,4,4,4,4,4,4,4,4,4,4,5,5,5,5,5,5,5,5,5,5,5,6,6,6,6,6,6,6,6,6,6,6,6
.byte 6,6,7,7,7,7,7,7,7,7,7,7,7,7,7,7,1,1,1,1,1,1,1,1,1,1,1,1,1,1,1,1,1,1,1,1,1,1,1,1,1,1,1,1,1,1,1,1,2,2,2,2,3,3,3,3,4,4,4,4,4,4,4,4
.byte 5,5,5,5,5,5,5,5,6,6,6,6,7,7,7,7,2,2,2,3,3,3,4,4,4,4,4,4,5,5,5,5,5,5,6,6,6,7,7,7,2,2,3,3,4,4,5,5,6,6,6,6,7,7,7,7,2,2,2,2,2,2,2,2
.byte 2,2,2,2,3,3,3,3,3,3,3,3,3,3,3,3,4,4,4,4,4,4,5,5,5,5,5,5,6,6,6,6,6,6,7,7,7,7,7,7,2,2,2,2,2,2,3,3,3,3,3,3,4,4,4,5,5,5,6,6,6,7,7,7
L_code_end:
.section .rodata,"a"
.p2align 6
.amdhsa_kernel interleave_layers__memory_aug_recurrent_mem_tr__glu_gated_swiglu__prompt_kernel
  .amdhsa_next_free_vgpr 512
  .amdhsa_next_free_sgpr 102
  .amdhsa_accum_offset 256
  .amdhsa_group_segment_fixed_size 0
  .amdhsa_kernarg_size 112
  .amdhsa_user_sgpr_count 2
  .amdhsa_user_sgpr_kernarg_segment_ptr 1
  .amdhsa_system_sgpr_workgroup_id_x 1
  .amdhsa_float_denorm_mode_32 3
.end_amdhsa_kernel
```

```asm
; @launch grid=(256,1,1) block=(256,1,1) lds=163840
.amdgcn_target "amdgcn-amd-amdhsa--gfx950"
.text
.globl interleave_layers__memory_aug_recurrent_mem_tr__glu_gated_swiglu__prompt_kernel
.p2align 8
.type interleave_layers__memory_aug_recurrent_mem_tr__glu_gated_swiglu__prompt_kernel,@function
interleave_layers__memory_aug_recurrent_mem_tr__glu_gated_swiglu__prompt_kernel:
s_cmp_lt_u32 s2, 256
s_cbranch_scc1 L_go
L_end:
s_endpgm
L_go:
s_getpc_b64 s[56:57]
L_pc0:
s_sub_u32 s56, s56, L_pc0-interleave_layers__memory_aug_recurrent_mem_tr__glu_gated_swiglu__prompt_kernel
s_subb_u32 s57, s57, 0
s_lshr_b32 s58, s2, 3
s_and_b32 s58, s58, 31
s_mul_i32 s58, s58, (L_code_end-interleave_layers__memory_aug_recurrent_mem_tr__glu_gated_swiglu__prompt_kernel+32*4096-1)/(32*4096)*4096
v_lshlrev_b32 v2, 4, v0
v_add_u32 v2, s58, v2
v_add_u32 v3, 0, v2
v_min_u32 v3, L_code_end-interleave_layers__memory_aug_recurrent_mem_tr__glu_gated_swiglu__prompt_kernel-16, v3
global_load_dwordx4 v[200:203], v3, s[56:57]
v_add_u32 v3, 4096, v2
v_min_u32 v3, L_code_end-interleave_layers__memory_aug_recurrent_mem_tr__glu_gated_swiglu__prompt_kernel-16, v3
global_load_dwordx4 v[204:207], v3, s[56:57]
s_load_dwordx4 s[20:23], s[0:1], 0
s_load_dwordx4 s[24:27], s[0:1], 16
s_load_dwordx4 s[28:31], s[0:1], 32
s_load_dwordx4 s[32:35], s[0:1], 64
s_load_dwordx4 s[36:39], s[0:1], 80
s_load_dwordx4 s[40:43], s[0:1], 96
v_lshrrev_b32 v1, 6, v0
v_and_b32 v0, 63, v0
v_readfirstlane_b32 s3, v1
s_waitcnt lgkmcnt(0)
s_mov_b32 s4, s42
s_and_b32 s5, s43, 0xffff
s_mov_b32 s6, 268435456
s_mov_b32 s7, 0x20000
s_mov_b32 s12, s40
s_and_b32 s13, s41, 0xffff
s_mov_b32 s14, 256
s_mov_b32 s15, 0x20000
s_getreg_b32 s50, hwreg(HW_REG_XCC_ID, 0, 4)
s_and_b32 s50, s50, 7
s_cmp_lg_u32 s3, 0
s_cbranch_scc1 tk_1
v_mov_b32 v2, 1
s_lshl_b32 s51, s50, 2
s_cmp_ge_u32 s50, 2
s_cselect_b32 s52, 128, 0
s_add_u32 s51, s51, s52
v_mov_b32 v3, s51
s_mov_b64 exec, 1
buffer_atomic_add v2, v3, s[12:15], 0 offen sc0
s_waitcnt vmcnt(0)
v_readfirstlane_b32 s51, v2
s_mov_b32 s52, 1
s_cmp_lt_u32 s51, 32
s_cbranch_scc1 native_2
v_mov_b32 v2, 1
v_mov_b32 v3, 32
buffer_atomic_add v2, v3, s[12:15], 0 offen sc0
s_waitcnt vmcnt(0)
v_readfirstlane_b32 s53, v2
s_mov_b64 exec, 0xff
v_lshlrev_b32 v3, 2, v0
v_add_u32 v5, 128, v3
v_cmp_le_u32 vcc, 2, v0
s_nop 1
v_cndmask_b32 v3, v3, v5, vcc
s_mov_b32 s98, 0
olp_3:
buffer_load_dword v4, v3, s[12:15], 0 offen sc1
s_add_u32 s98, s98, 1
s_cmp_gt_u32 s98, 150000
s_cbranch_scc1 obad_4
s_waitcnt vmcnt(0)
s_mov_b32 s54, 0
v_readlane_b32 s55, v4, 0
s_nop 0
s_add_u32 s54, s54, s55
v_readlane_b32 s55, v4, 1
s_nop 0
s_add_u32 s54, s54, s55
v_readlane_b32 s55, v4, 2
s_nop 0
s_add_u32 s54, s54, s55
v_readlane_b32 s55, v4, 3
s_nop 0
s_add_u32 s54, s54, s55
v_readlane_b32 s55, v4, 4
s_nop 0
s_add_u32 s54, s54, s55
v_readlane_b32 s55, v4, 5
s_nop 0
s_add_u32 s54, s54, s55
v_readlane_b32 s55, v4, 6
s_nop 0
s_add_u32 s54, s54, s55
v_readlane_b32 s55, v4, 7
s_nop 0
s_add_u32 s54, s54, s55
s_cmp_lt_u32 s54, 256
s_cbranch_scc1 olp_3
v_readlane_b32 s55, v4, 0
s_nop 0
s_min_u32 s55, s55, 32
s_sub_u32 s54, 32, s55
s_cmp_ge_u32 s53, s54
s_cbranch_scc1 onx_6
s_mov_b32 s50, 0
s_add_u32 s51, s55, s53
s_branch ofin_5
onx_6:
s_sub_u32 s53, s53, s54
v_readlane_b32 s55, v4, 1
s_nop 0
s_min_u32 s55, s55, 32
s_sub_u32 s54, 32, s55
s_cmp_ge_u32 s53, s54
s_cbranch_scc1 onx_7
s_mov_b32 s50, 1
s_add_u32 s51, s55, s53
s_branch ofin_5
onx_7:
s_sub_u32 s53, s53, s54
v_readlane_b32 s55, v4, 2
s_nop 0
s_min_u32 s55, s55, 32
s_sub_u32 s54, 32, s55
s_cmp_ge_u32 s53, s54
s_cbranch_scc1 onx_8
s_mov_b32 s50, 2
s_add_u32 s51, s55, s53
s_branch ofin_5
onx_8:
s_sub_u32 s53, s53, s54
v_readlane_b32 s55, v4, 3
s_nop 0
s_min_u32 s55, s55, 32
s_sub_u32 s54, 32, s55
s_cmp_ge_u32 s53, s54
s_cbranch_scc1 onx_9
s_mov_b32 s50, 3
s_add_u32 s51, s55, s53
s_branch ofin_5
onx_9:
s_sub_u32 s53, s53, s54
v_readlane_b32 s55, v4, 4
s_nop 0
s_min_u32 s55, s55, 32
s_sub_u32 s54, 32, s55
s_cmp_ge_u32 s53, s54
s_cbranch_scc1 onx_10
s_mov_b32 s50, 4
s_add_u32 s51, s55, s53
s_branch ofin_5
onx_10:
s_sub_u32 s53, s53, s54
v_readlane_b32 s55, v4, 5
s_nop 0
s_min_u32 s55, s55, 32
s_sub_u32 s54, 32, s55
s_cmp_ge_u32 s53, s54
s_cbranch_scc1 onx_11
s_mov_b32 s50, 5
s_add_u32 s51, s55, s53
s_branch ofin_5
onx_11:
s_sub_u32 s53, s53, s54
v_readlane_b32 s55, v4, 6
s_nop 0
s_min_u32 s55, s55, 32
s_sub_u32 s54, 32, s55
s_cmp_ge_u32 s53, s54
s_cbranch_scc1 onx_12
s_mov_b32 s50, 6
s_add_u32 s51, s55, s53
s_branch ofin_5
onx_12:
s_sub_u32 s53, s53, s54
v_readlane_b32 s55, v4, 7
s_nop 0
s_min_u32 s55, s55, 32
s_sub_u32 s54, 32, s55
s_cmp_ge_u32 s53, s54
s_cbranch_scc1 onx_13
s_mov_b32 s50, 7
s_add_u32 s51, s55, s53
s_branch ofin_5
onx_13:
s_sub_u32 s53, s53, s54
obad_4:
s_mov_b32 s50, 8
ofin_5:
s_mov_b32 s52, 0x10001
native_2:
s_mov_b64 exec, 1
v_mov_b32 v3, 0
v_mov_b32 v4, s50
v_mov_b32 v5, s51
v_mov_b32 v6, s52
v_mov_b32 v7, 0
ds_write_b128 v3, v[4:7]
s_mov_b64 exec, -1
s_waitcnt lgkmcnt(0)
tk_1:
s_barrier
v_mov_b32 v3, 0
ds_read_b128 v[4:7], v3
s_waitcnt lgkmcnt(0)
v_readfirstlane_b32 s50, v4
v_readfirstlane_b32 s51, v5
v_readfirstlane_b32 s52, v6
s_barrier
s_cmp_ge_u32 s50, 8
s_cbranch_scc1 L_end
s_cmp_ge_u32 s51, 32
s_cbranch_scc1 L_end
s_mov_b32 s100, s50
s_cmp_lt_u32 s50, 2
s_cbranch_scc1 L_chain
s_getpc_b64 s[96:97]
pc_14:
s_add_u32 s96, s96, L_roles-pc_14
s_addc_u32 s97, s97, 0
s_lshl_b32 s53, s50, 5
s_add_u32 s53, s53, s51
s_lshl_b32 s53, s53, 1
v_mov_b32 v1, s53
global_load_ushort v1, v1, s[96:97]
s_waitcnt vmcnt(0)
v_readfirstlane_b32 s53, v1
s_nop 0
s_and_b32 s74, s53, 0xff
s_lshr_b32 s53, s53, 8
s_cmp_eq_u32 s53, 0
s_cbranch_scc1 H_up
s_cmp_eq_u32 s53, 1
s_cbranch_scc1 H_dn
s_cmp_eq_u32 s53, 2
s_cbranch_scc1 H_wo
s_cmp_eq_u32 s53, 3
s_cbranch_scc1 H_att
s_cmp_eq_u32 s53, 4
s_cbranch_scc1 H_red
H_qkv:
s_lshl_b32 s75, s74, 2
s_add_u32 s75, s75, s3
s_mul_i32 s76, s75, 3
v_bfe_u32 v1, v0, 4, 1
v_lshlrev_b32 v1, 10, v1
v_lshrrev_b32 v2, 5, v0
v_lshl_add_u32 v1, v2, 8, v1
v_and_b32 v2, 15, v0
v_lshl_add_u32 v5, v2, 4, v1
v_lshlrev_b32 v6, 4, v0
s_add_u32 s77, s76, 0
s_lshr_b32 s78, s77, 8
s_and_b32 s77, s77, 255
s_lshl_b32 s48, s77, 5
s_cmp_eq_u32 s78, 0
s_cselect_b32 s80, s24, s26
s_cselect_b32 s81, s25, s27
s_cmp_eq_u32 s78, 2
s_cselect_b32 s80, s28, s80
s_cselect_b32 s81, s29, s81
s_mov_b32 s8, s80
s_and_b32 s9, s81, 0xffff
s_mov_b32 s10, 4718592
s_mov_b32 s11, 0x20000
s_lshr_b32 s79, s77, 3
s_mul_i32 s79, s79, 24576
s_lshl_b32 s82, s78, 13
s_add_u32 s79, s79, s82
s_and_b32 s82, s77, 7
s_lshl_b32 s83, s82, 10
s_and_b32 s84, s82, 1
s_lshl_b32 s84, s84, 9
s_andn2_b32 s82, s83, 1024
s_add_u32 s82, s82, s84
s_cmp_eq_u32 s78, 2
s_cselect_b32 s82, s83, s82
s_cselect_b64 vcc, -1, 0
s_add_u32 s79, s79, s82
v_cndmask_b32 v7, v5, v6, vcc
v_add_u32 v19, s79, v7
s_add_u32 s77, s76, 1
s_lshr_b32 s78, s77, 8
s_and_b32 s77, s77, 255
s_lshl_b32 s49, s77, 5
s_cmp_eq_u32 s78, 0
s_cselect_b32 s80, s24, s26
s_cselect_b32 s81, s25, s27
s_cmp_eq_u32 s78, 2
s_cselect_b32 s80, s28, s80
s_cselect_b32 s81, s29, s81
s_mov_b32 s12, s80
s_and_b32 s13, s81, 0xffff
s_mov_b32 s14, 4718592
s_mov_b32 s15, 0x20000
s_lshr_b32 s79, s77, 3
s_mul_i32 s79, s79, 24576
s_lshl_b32 s82, s78, 13
s_add_u32 s79, s79, s82
s_and_b32 s82, s77, 7
s_lshl_b32 s83, s82, 10
s_and_b32 s84, s82, 1
s_lshl_b32 s84, s84, 9
s_andn2_b32 s82, s83, 1024
s_add_u32 s82, s82, s84
s_cmp_eq_u32 s78, 2
s_cselect_b32 s82, s83, s82
s_cselect_b64 vcc, -1, 0
s_add_u32 s79, s79, s82
v_cndmask_b32 v7, v5, v6, vcc
v_add_u32 v20, s79, v7
s_add_u32 s77, s76, 2
s_lshr_b32 s78, s77, 8
s_and_b32 s77, s77, 255
s_lshl_b32 s50, s77, 5
s_cmp_eq_u32 s78, 0
s_cselect_b32 s80, s24, s26
s_cselect_b32 s81, s25, s27
s_cmp_eq_u32 s78, 2
s_cselect_b32 s80, s28, s80
s_cselect_b32 s81, s29, s81
s_mov_b32 s16, s80
s_and_b32 s17, s81, 0xffff
s_mov_b32 s18, 4718592
s_mov_b32 s19, 0x20000
s_lshr_b32 s79, s77, 3
s_mul_i32 s79, s79, 24576
s_lshl_b32 s82, s78, 13
s_add_u32 s79, s79, s82
s_and_b32 s82, s77, 7
s_lshl_b32 s83, s82, 10
s_and_b32 s84, s82, 1
s_lshl_b32 s84, s84, 9
s_andn2_b32 s82, s83, 1024
s_add_u32 s82, s82, s84
s_cmp_eq_u32 s78, 2
s_cselect_b32 s82, s83, s82
s_cselect_b64 vcc, -1, 0
s_add_u32 s79, s79, s82
v_cndmask_b32 v7, v5, v6, vcc
v_add_u32 v21, s79, v7
v_lshrrev_b32 v1, 5, v0
v_bfe_u32 v2, v0, 3, 1
v_lshl_add_u32 v1, v1, 1, v2
v_bfe_u32 v2, v0, 4, 1
v_bfe_u32 v3, v0, 1, 2
v_lshlrev_b32 v1, 3, v1
v_lshl_add_u32 v1, v2, 2, v1
v_add_u32 v1, v1, v3
v_mul_u32_u24 v1, 8192, v1
v_and_b32 v2, 1, v0
v_lshl_add_u32 v63, v2, 4, v1
s_mul_i32 s70, s3, 40960
v_lshrrev_b32 v1, 5, v0
v_lshlrev_b32 v1, 9, v1
v_bfe_u32 v2, v0, 4, 1
v_lshl_add_u32 v1, v2, 7, v1
v_add_u32 v1, s70, v1
v_and_b32 v2, 15, v0
v_lshl_add_u32 v2, v2, 3, v1
v_add_u32 v60, 0, v2
v_add_u32 v61, 1024, v2
v_add_u32 v62, 2048, v2
s_add_u32 m0, s70, 0
s_add_u32 s71, s48, 0
buffer_load_dwordx4 v63, s[8:11], s71 offen lds
s_add_u32 m0, s70, 1024
s_add_u32 s71, s49, 0
buffer_load_dwordx4 v63, s[12:15], s71 offen lds
s_add_u32 m0, s70, 2048
s_add_u32 s71, s50, 0
buffer_load_dwordx4 v63, s[16:19], s71 offen lds
s_add_u32 m0, s70, 3072
s_add_u32 s71, s48, 262144
buffer_load_dwordx4 v63, s[8:11], s71 offen lds
s_add_u32 m0, s70, 4096
s_add_u32 s71, s49, 262144
buffer_load_dwordx4 v63, s[12:15], s71 offen lds
s_add_u32 m0, s70, 5120
s_add_u32 s71, s50, 262144
buffer_load_dwordx4 v63, s[16:19], s71 offen lds
s_add_u32 m0, s70, 6144
s_add_u32 s71, s48, 524288
buffer_load_dwordx4 v63, s[8:11], s71 offen lds
s_add_u32 m0, s70, 7168
s_add_u32 s71, s49, 524288
buffer_load_dwordx4 v63, s[12:15], s71 offen lds
s_add_u32 m0, s70, 8192
s_add_u32 s71, s50, 524288
buffer_load_dwordx4 v63, s[16:19], s71 offen lds
s_add_u32 m0, s70, 9216
s_add_u32 s71, s48, 786432
buffer_load_dwordx4 v63, s[8:11], s71 offen lds
s_add_u32 m0, s70, 10240
s_add_u32 s71, s49, 786432
buffer_load_dwordx4 v63, s[12:15], s71 offen lds
s_add_u32 m0, s70, 11264
s_add_u32 s71, s50, 786432
buffer_load_dwordx4 v63, s[16:19], s71 offen lds
s_add_u32 m0, s70, 12288
s_add_u32 s71, s48, 1048576
buffer_load_dwordx4 v63, s[8:11], s71 offen lds
s_add_u32 m0, s70, 13312
s_add_u32 s71, s49, 1048576
buffer_load_dwordx4 v63, s[12:15], s71 offen lds
s_add_u32 m0, s70, 14336
s_add_u32 s71, s50, 1048576
buffer_load_dwordx4 v63, s[16:19], s71 offen lds
s_add_u32 m0, s70, 15360
s_add_u32 s71, s48, 1310720
buffer_load_dwordx4 v63, s[8:11], s71 offen lds
s_add_u32 m0, s70, 16384
s_add_u32 s71, s49, 1310720
buffer_load_dwordx4 v63, s[12:15], s71 offen lds
s_add_u32 m0, s70, 17408
s_add_u32 s71, s50, 1310720
buffer_load_dwordx4 v63, s[16:19], s71 offen lds
s_add_u32 m0, s70, 18432
s_add_u32 s71, s48, 1572864
buffer_load_dwordx4 v63, s[8:11], s71 offen lds
s_add_u32 m0, s70, 19456
s_add_u32 s71, s49, 1572864
buffer_load_dwordx4 v63, s[12:15], s71 offen lds
s_add_u32 m0, s70, 20480
s_add_u32 s71, s50, 1572864
buffer_load_dwordx4 v63, s[16:19], s71 offen lds
s_add_u32 m0, s70, 21504
s_add_u32 s71, s48, 1835008
buffer_load_dwordx4 v63, s[8:11], s71 offen lds
s_add_u32 m0, s70, 22528
s_add_u32 s71, s49, 1835008
buffer_load_dwordx4 v63, s[12:15], s71 offen lds
s_add_u32 m0, s70, 23552
s_add_u32 s71, s50, 1835008
buffer_load_dwordx4 v63, s[16:19], s71 offen lds
s_add_u32 m0, s70, 24576
s_add_u32 s71, s48, 2097152
buffer_load_dwordx4 v63, s[8:11], s71 offen lds
s_add_u32 m0, s70, 25600
s_add_u32 s71, s49, 2097152
buffer_load_dwordx4 v63, s[12:15], s71 offen lds
s_add_u32 m0, s70, 26624
s_add_u32 s71, s50, 2097152
buffer_load_dwordx4 v63, s[16:19], s71 offen lds
s_add_u32 m0, s70, 27648
s_add_u32 s71, s48, 2359296
buffer_load_dwordx4 v63, s[8:11], s71 offen lds
s_add_u32 m0, s70, 28672
s_add_u32 s71, s49, 2359296
buffer_load_dwordx4 v63, s[12:15], s71 offen lds
s_add_u32 m0, s70, 29696
s_add_u32 s71, s50, 2359296
buffer_load_dwordx4 v63, s[16:19], s71 offen lds
s_add_u32 m0, s70, 30720
s_add_u32 s71, s48, 2621440
buffer_load_dwordx4 v63, s[8:11], s71 offen lds
s_add_u32 m0, s70, 31744
s_add_u32 s71, s49, 2621440
buffer_load_dwordx4 v63, s[12:15], s71 offen lds
s_add_u32 m0, s70, 32768
s_add_u32 s71, s50, 2621440
buffer_load_dwordx4 v63, s[16:19], s71 offen lds
s_add_u32 m0, s70, 33792
s_add_u32 s71, s48, 2883584
buffer_load_dwordx4 v63, s[8:11], s71 offen lds
s_add_u32 m0, s70, 34816
s_add_u32 s71, s49, 2883584
buffer_load_dwordx4 v63, s[12:15], s71 offen lds
s_add_u32 m0, s70, 35840
s_add_u32 s71, s50, 2883584
buffer_load_dwordx4 v63, s[16:19], s71 offen lds
s_add_u32 m0, s70, 36864
s_add_u32 s71, s48, 3145728
buffer_load_dwordx4 v63, s[8:11], s71 offen lds
s_add_u32 m0, s70, 37888
s_add_u32 s71, s49, 3145728
buffer_load_dwordx4 v63, s[12:15], s71 offen lds
s_add_u32 m0, s70, 38912
s_add_u32 s71, s50, 3145728
buffer_load_dwordx4 v63, s[16:19], s71 offen lds
s_waitcnt vmcnt(36)
ds_read_b64_tr_b16 a[0:1], v60 offset:0
ds_read_b64_tr_b16 a[2:3], v60 offset:256
ds_read_b64_tr_b16 a[72:73], v61 offset:0
ds_read_b64_tr_b16 a[74:75], v61 offset:256
ds_read_b64_tr_b16 a[144:145], v62 offset:0
ds_read_b64_tr_b16 a[146:147], v62 offset:256
s_waitcnt lgkmcnt(0)
s_add_u32 m0, s70, 0
s_add_u32 s71, s48, 3407872
buffer_load_dwordx4 v63, s[8:11], s71 offen lds
s_add_u32 m0, s70, 1024
s_add_u32 s71, s49, 3407872
buffer_load_dwordx4 v63, s[12:15], s71 offen lds
s_add_u32 m0, s70, 2048
s_add_u32 s71, s50, 3407872
buffer_load_dwordx4 v63, s[16:19], s71 offen lds
s_waitcnt vmcnt(36)
ds_read_b64_tr_b16 a[4:5], v60 offset:3072
ds_read_b64_tr_b16 a[6:7], v60 offset:3328
ds_read_b64_tr_b16 a[76:77], v61 offset:3072
ds_read_b64_tr_b16 a[78:79], v61 offset:3328
ds_read_b64_tr_b16 a[148:149], v62 offset:3072
ds_read_b64_tr_b16 a[150:151], v62 offset:3328
s_waitcnt lgkmcnt(0)
s_add_u32 m0, s70, 3072
s_add_u32 s71, s48, 3670016
buffer_load_dwordx4 v63, s[8:11], s71 offen lds
s_add_u32 m0, s70, 4096
s_add_u32 s71, s49, 3670016
buffer_load_dwordx4 v63, s[12:15], s71 offen lds
s_add_u32 m0, s70, 5120
s_add_u32 s71, s50, 3670016
buffer_load_dwordx4 v63, s[16:19], s71 offen lds
s_waitcnt vmcnt(36)
ds_read_b64_tr_b16 a[8:9], v60 offset:6144
ds_read_b64_tr_b16 a[10:11], v60 offset:6400
ds_read_b64_tr_b16 a[80:81], v61 offset:6144
ds_read_b64_tr_b16 a[82:83], v61 offset:6400
ds_read_b64_tr_b16 a[152:153], v62 offset:6144
ds_read_b64_tr_b16 a[154:155], v62 offset:6400
s_waitcnt lgkmcnt(0)
s_add_u32 m0, s70, 6144
s_add_u32 s71, s48, 3932160
buffer_load_dwordx4 v63, s[8:11], s71 offen lds
s_add_u32 m0, s70, 7168
s_add_u32 s71, s49, 3932160
buffer_load_dwordx4 v63, s[12:15], s71 offen lds
s_add_u32 m0, s70, 8192
s_add_u32 s71, s50, 3932160
buffer_load_dwordx4 v63, s[16:19], s71 offen lds
s_waitcnt vmcnt(36)
ds_read_b64_tr_b16 a[12:13], v60 offset:9216
ds_read_b64_tr_b16 a[14:15], v60 offset:9472
ds_read_b64_tr_b16 a[84:85], v61 offset:9216
ds_read_b64_tr_b16 a[86:87], v61 offset:9472
ds_read_b64_tr_b16 a[156:157], v62 offset:9216
ds_read_b64_tr_b16 a[158:159], v62 offset:9472
s_waitcnt lgkmcnt(0)
s_add_u32 m0, s70, 9216
s_add_u32 s71, s48, 4194304
buffer_load_dwordx4 v63, s[8:11], s71 offen lds
s_add_u32 m0, s70, 10240
s_add_u32 s71, s49, 4194304
buffer_load_dwordx4 v63, s[12:15], s71 offen lds
s_add_u32 m0, s70, 11264
s_add_u32 s71, s50, 4194304
buffer_load_dwordx4 v63, s[16:19], s71 offen lds
s_waitcnt vmcnt(36)
ds_read_b64_tr_b16 a[16:17], v60 offset:12288
ds_read_b64_tr_b16 a[18:19], v60 offset:12544
ds_read_b64_tr_b16 a[88:89], v61 offset:12288
ds_read_b64_tr_b16 a[90:91], v61 offset:12544
ds_read_b64_tr_b16 a[160:161], v62 offset:12288
ds_read_b64_tr_b16 a[162:163], v62 offset:12544
s_waitcnt lgkmcnt(0)
s_add_u32 m0, s70, 12288
s_add_u32 s71, s48, 4456448
buffer_load_dwordx4 v63, s[8:11], s71 offen lds
s_add_u32 m0, s70, 13312
s_add_u32 s71, s49, 4456448
buffer_load_dwordx4 v63, s[12:15], s71 offen lds
s_add_u32 m0, s70, 14336
s_add_u32 s71, s50, 4456448
buffer_load_dwordx4 v63, s[16:19], s71 offen lds
s_waitcnt vmcnt(36)
ds_read_b64_tr_b16 a[20:21], v60 offset:15360
ds_read_b64_tr_b16 a[22:23], v60 offset:15616
ds_read_b64_tr_b16 a[92:93], v61 offset:15360
ds_read_b64_tr_b16 a[94:95], v61 offset:15616
ds_read_b64_tr_b16 a[164:165], v62 offset:15360
ds_read_b64_tr_b16 a[166:167], v62 offset:15616
s_waitcnt vmcnt(33)
ds_read_b64_tr_b16 a[24:25], v60 offset:18432
ds_read_b64_tr_b16 a[26:27], v60 offset:18688
ds_read_b64_tr_b16 a[96:97], v61 offset:18432
ds_read_b64_tr_b16 a[98:99], v61 offset:18688
ds_read_b64_tr_b16 a[168:169], v62 offset:18432
ds_read_b64_tr_b16 a[170:171], v62 offset:18688
s_waitcnt vmcnt(30)
ds_read_b64_tr_b16 a[28:29], v60 offset:21504
ds_read_b64_tr_b16 a[30:31], v60 offset:21760
ds_read_b64_tr_b16 a[100:101], v61 offset:21504
ds_read_b64_tr_b16 a[102:103], v61 offset:21760
ds_read_b64_tr_b16 a[172:173], v62 offset:21504
ds_read_b64_tr_b16 a[174:175], v62 offset:21760
s_waitcnt vmcnt(27)
ds_read_b64_tr_b16 a[32:33], v60 offset:24576
ds_read_b64_tr_b16 a[34:35], v60 offset:24832
ds_read_b64_tr_b16 a[104:105], v61 offset:24576
ds_read_b64_tr_b16 a[106:107], v61 offset:24832
ds_read_b64_tr_b16 a[176:177], v62 offset:24576
ds_read_b64_tr_b16 a[178:179], v62 offset:24832
s_waitcnt vmcnt(24)
ds_read_b64_tr_b16 a[36:37], v60 offset:27648
ds_read_b64_tr_b16 a[38:39], v60 offset:27904
ds_read_b64_tr_b16 a[108:109], v61 offset:27648
ds_read_b64_tr_b16 a[110:111], v61 offset:27904
ds_read_b64_tr_b16 a[180:181], v62 offset:27648
ds_read_b64_tr_b16 a[182:183], v62 offset:27904
s_waitcnt vmcnt(21)
ds_read_b64_tr_b16 a[40:41], v60 offset:30720
ds_read_b64_tr_b16 a[42:43], v60 offset:30976
ds_read_b64_tr_b16 a[112:113], v61 offset:30720
ds_read_b64_tr_b16 a[114:115], v61 offset:30976
ds_read_b64_tr_b16 a[184:185], v62 offset:30720
ds_read_b64_tr_b16 a[186:187], v62 offset:30976
s_waitcnt vmcnt(18)
ds_read_b64_tr_b16 a[44:45], v60 offset:33792
ds_read_b64_tr_b16 a[46:47], v60 offset:34048
ds_read_b64_tr_b16 a[116:117], v61 offset:33792
ds_read_b64_tr_b16 a[118:119], v61 offset:34048
ds_read_b64_tr_b16 a[188:189], v62 offset:33792
ds_read_b64_tr_b16 a[190:191], v62 offset:34048
s_waitcnt vmcnt(15)
ds_read_b64_tr_b16 a[48:49], v60 offset:36864
ds_read_b64_tr_b16 a[50:51], v60 offset:37120
ds_read_b64_tr_b16 a[120:121], v61 offset:36864
ds_read_b64_tr_b16 a[122:123], v61 offset:37120
ds_read_b64_tr_b16 a[192:193], v62 offset:36864
ds_read_b64_tr_b16 a[194:195], v62 offset:37120
s_waitcnt vmcnt(12)
ds_read_b64_tr_b16 a[52:53], v60 offset:0
ds_read_b64_tr_b16 a[54:55], v60 offset:256
ds_read_b64_tr_b16 a[124:125], v61 offset:0
ds_read_b64_tr_b16 a[126:127], v61 offset:256
ds_read_b64_tr_b16 a[196:197], v62 offset:0
ds_read_b64_tr_b16 a[198:199], v62 offset:256
s_waitcnt vmcnt(9)
ds_read_b64_tr_b16 a[56:57], v60 offset:3072
ds_read_b64_tr_b16 a[58:59], v60 offset:3328
ds_read_b64_tr_b16 a[128:129], v61 offset:3072
ds_read_b64_tr_b16 a[130:131], v61 offset:3328
ds_read_b64_tr_b16 a[200:201], v62 offset:3072
ds_read_b64_tr_b16 a[202:203], v62 offset:3328
s_waitcnt vmcnt(6)
ds_read_b64_tr_b16 a[60:61], v60 offset:6144
ds_read_b64_tr_b16 a[62:63], v60 offset:6400
ds_read_b64_tr_b16 a[132:133], v61 offset:6144
ds_read_b64_tr_b16 a[134:135], v61 offset:6400
ds_read_b64_tr_b16 a[204:205], v62 offset:6144
ds_read_b64_tr_b16 a[206:207], v62 offset:6400
s_waitcnt vmcnt(3)
ds_read_b64_tr_b16 a[64:65], v60 offset:9216
ds_read_b64_tr_b16 a[66:67], v60 offset:9472
ds_read_b64_tr_b16 a[136:137], v61 offset:9216
ds_read_b64_tr_b16 a[138:139], v61 offset:9472
ds_read_b64_tr_b16 a[208:209], v62 offset:9216
ds_read_b64_tr_b16 a[210:211], v62 offset:9472
s_waitcnt vmcnt(0)
ds_read_b64_tr_b16 a[68:69], v60 offset:12288
ds_read_b64_tr_b16 a[70:71], v60 offset:12544
ds_read_b64_tr_b16 a[140:141], v61 offset:12288
ds_read_b64_tr_b16 a[142:143], v61 offset:12544
ds_read_b64_tr_b16 a[212:213], v62 offset:12288
ds_read_b64_tr_b16 a[214:215], v62 offset:12544
s_waitcnt lgkmcnt(0)
v_lshrrev_b32 v1, 3, v0
v_bfe_u32 v2, v0, 1, 2
v_lshrrev_b32 v3, 5, v0
v_lshlrev_b32 v3, 1, v3
v_xor_b32 v2, v2, v3
v_mul_u32_u24 v1, 2304, v1
v_lshl_add_u32 v1, v2, 5, v1
v_and_b32 v2, 1, v0
v_lshl_add_u32 v1, v2, 4, v1
s_and_b32 s70, s3, 1
s_mul_i32 s70, s70, 18432
s_lshr_b32 s71, s3, 1
s_lshl_b32 s71, s71, 7
s_add_u32 s70, s70, s71
v_add_u32 v1, s70, v1
v_add_u32 v8, 4096, v1
v_add_u32 v9, 3328, v1
v_add_u32 v10, 2560, v1
v_add_u32 v11, 1792, v1
v_add_u32 v12, 5120, v1
v_add_u32 v13, 4352, v1
v_add_u32 v14, 3584, v1
v_add_u32 v15, 2816, v1
v_add_u32 v16, 6144, v1
v_bfe_u32 v1, v0, 1, 3
v_lshlrev_b32 v1, 7, v1
v_lshrrev_b32 v2, 4, v0
v_bfe_u32 v3, v0, 3, 1
v_lshlrev_b32 v3, 1, v3
v_xor_b32 v2, v2, v3
v_lshl_add_u32 v1, v2, 5, v1
v_and_b32 v2, 1, v0
v_lshl_add_u32 v17, v2, 4, v1
v_and_b32 v2, 31, v0
v_add_u32 v1, 0, v2
v_mul_u32_u24 v1, 128, v1
v_lshrrev_b32 v3, 5, v0
v_xor_b32 v3, 1, v3
v_mul_u32_u24 v3, 32768, v3
v_add_u32 v1, 0, v1
v_add_u32 v1, v1, v3
v_mov_b32 v3, 2147483632
s_cmp_eq_u32 s3, 0
s_cselect_b32 s71, 16, 0
v_cmp_gt_u32 vcc, s71, v2
s_nop 1
v_cndmask_b32 v22, v3, v1, vcc
s_mov_b32 s56, 0xffff
s_mul_i32 s70, s74, 128
s_add_u32 s70, s70, 2048
v_mov_b32 v1, s70
s_min_u32 s71, s71, 1
v_cmp_gt_u32 vcc, s71, v0
s_nop 1
v_cndmask_b32 v44, v3, v1, vcc
v_add_u32 v45, 65536, v44
s_getpc_b64 s[96:97]
pc_15:
s_add_u32 s96, s96, L_writers-pc_15
s_addc_u32 s97, s97, 0
v_subrev_u32 v23, 0, v22
v_lshrrev_b32 v23, 7, v23
v_cmp_gt_u32 vcc, 0x200, v23
s_nop 1
v_cndmask_b32 v23, 0, v23, vcc
global_load_ubyte v23, v23, s[96:97]
s_mov_b32 s44, 3702784
s_mov_b32 s45, 60366848
s_mov_b32 s52, 1
s_mov_b32 s53, 32768
s_mov_b32 s46, 1343488
s_mov_b32 s47, 10035200
s_mov_b32 s54, 1
s_mov_b32 s55, 0
s_mov_b32 s25, 64
s_mov_b32 s20, 36864
s_mov_b32 s21, 786432
s_cmp_lt_u32 s75, 170
s_cbranch_scc1 G_sss18
s_cmp_eq_u32 s75, 170
s_cbranch_scc1 G_ssv18
s_mov_b32 s8, s42
s_and_b32 s9, s43, 0xffff
s_mov_b32 s10, 0
s_mov_b32 s11, 0x20000
s_mov_b32 s22, 0
s_mul_i32 s48, s3, 9216
s_add_u32 s49, s48, 36864
s_add_u32 s50, s48, 73728
s_add_u32 s51, s48, 110592
s_mov_b32 s57, 0xbfb8aa3b
v_add_u32 v28, 0, v17
v_add_u32 v29, 36864, v17
v_add_u32 v30, 73728, v17
v_add_u32 v31, 110592, v17
v_lshlrev_b32 v1, 2, v0
v_add_u32 v32, 147456, v1
s_lshl_b32 s70, s3, 8
v_add_u32 v18, s70, v32
v_mov_b64 v[224:225], 0
v_mov_b64 v[236:237], 0
v_mov_b64 v[226:227], 0
v_mov_b64 v[238:239], 0
v_mov_b64 v[228:229], 0
v_mov_b64 v[240:241], 0
v_mov_b64 v[230:231], 0
v_mov_b64 v[242:243], 0
s_mov_b32 s12, s40
s_and_b32 s13, s41, 0xffff
s_mov_b32 s14, 256
s_mov_b32 s15, 0x20000
v_lshlrev_b32 v26, 2, v0
v_add_u32 v27, 128, v26
v_cmp_le_u32 vcc, 2, v0
s_nop 1
v_cndmask_b32 v26, v26, v27, vcc
v_mov_b32 v27, 192
v_cmp_eq_u32 vcc, 8, v0
s_nop 1
v_cndmask_b32 v26, v26, v27, vcc
v_mov_b32 v27, 2147483632
v_cmp_lt_u32 vcc, 8, v0
s_nop 1
v_cndmask_b32 v26, v26, v27, vcc
s_mov_b32 s98, 0
wi_loop_21:
buffer_load_dword v27, v26, s[12:15], 0 offen sc1
s_add_u32 s98, s98, 1
s_cmp_gt_u32 s98, 150000
s_cbranch_scc1 wi_bad_23
s_waitcnt vmcnt(0)
v_cmp_eq_u32 vcc, 32, v27
s_nop 0
s_and_b32 s97, vcc_lo, 0x1ff
s_cmp_eq_u32 s97, 0x1ff
s_cbranch_scc1 wi_ok_22
v_cmp_lt_u32 vcc, 32, v27
s_nop 0
s_and_b32 s96, vcc_lo, 0xff
s_cselect_b32 s96, 0x100, 0
s_and_b32 s96, s96, s97
s_cbranch_scc1 wi_over_24
s_sleep 8
s_branch wi_loop_21
wi_bad_23:
s_mov_b32 s98, 512
s_branch L_fail
wi_over_24:
s_mov_b32 s100, 255
wi_ok_22:
v_add_u32 v26, 65536, v22
v_cmp_eq_u32 vcc, s100, v23
s_nop 1
v_cndmask_b32 v22, v22, v26, vcc
s_mov_b32 s90, 0
s_mov_b32 s91, 1879048192
s_mov_b32 s93, 1879048192
v_mov_b32 v34, 2147483632
s_barrier
s_mov_b32 s95, 1
s_cmp_lg_u32 s3, 0
s_cbranch_scc1 sp_ok_26_j
s_mov_b32 s23, 0
sp_loop_25:
buffer_load_dword v33, v22, s[4:7], 0 offen sc1
s_add_u32 s23, s23, 1
s_cmp_gt_u32 s23, 150000
s_cbranch_scc1 sp_bad_27
s_waitcnt vmcnt(0)
sp_loop_25_e:
v_cmp_gt_u32 vcc, s52, v33
v_cmp_gt_u32 s[58:59], s54, v33
s_and_b32 vcc_lo, vcc_lo, s56
s_cbranch_scc0 sp_ok_26
s_cmp_gt_u32 s23, 4
s_cselect_b32 s70, 0, s56
s_cmp_lg_u32 s95, 0
s_cselect_b32 s70, 0, s70
s_or_b32 s59, s59, s70
s_and_b32 s59, s59, s56
s_cbranch_scc0 sp_ok_26
s_sleep 1
s_branch sp_loop_25
sp_bad_27:
s_mov_b32 s98, 1025
s_branch L_fail
sp_ok_26:
ds_write_b32 v18, v33
s_waitcnt lgkmcnt(0)
sp_ok_26_j:
s_barrier
ds_read_b32 v33, v32
s_waitcnt lgkmcnt(0)
v_cmp_gt_u32 vcc, s52, v33
v_cmp_gt_u32 s[58:59], s54, v33
s_and_b32 vcc_lo, vcc_lo, s56
s_cselect_b32 s70, 0, 1
s_and_b32 s59, s59, s56
s_cselect_b32 s71, 0, 1
s_or_b32 s76, s70, s71
s_cselect_b32 s10, 268435456, 0
s_cmp_lg_u32 s70, 0
s_cselect_b64 s[72:73], s[52:53], s[54:55]
s_cselect_b64 s[58:59], s[44:45], s[46:47]
s_mul_i32 s74, s72, s20
s_add_u32 s74, s74, s58
s_mul_i32 s75, s72, s21
s_add_u32 s75, s75, s59
s_andn2_b32 s71, s71, s70
s_add_u32 s52, s52, s70
s_add_u32 s54, s54, s71
s_mov_b32 s77, s76
s_add_u32 m0, s48, 0
s_nop 0
buffer_load_dwordx4 v8, s[4:7], s74 offen offset:0 sc1 lds
buffer_load_dwordx4 v9, s[4:7], s74 offen offset:1024 sc1 lds
buffer_load_dwordx4 v10, s[4:7], s74 offen offset:2048 sc1 lds
buffer_load_dwordx4 v11, s[4:7], s74 offen offset:3072 sc1 lds
s_add_u32 m0, s48, 4096
s_nop 0
buffer_load_dwordx4 v12, s[4:7], s74 offen offset:0 sc1 lds
buffer_load_dwordx4 v13, s[4:7], s74 offen offset:1024 sc1 lds
buffer_load_dwordx4 v14, s[4:7], s74 offen offset:2048 sc1 lds
buffer_load_dwordx4 v15, s[4:7], s74 offen offset:3072 sc1 lds
s_add_u32 m0, s48, 8192
s_nop 0
buffer_load_dwordx4 v16, s[4:7], s74 offen offset:0 sc1 lds
buffer_load_dword v24, v22, s[4:7], 0 offen sc1
buffer_store_dword v27, v34, s[4:7], 0 offen
v_mov_b32 v27, s90
s_waitcnt vmcnt(9)
s_barrier
buffer_store_dword v27, v45, s[4:7], s91 offen
buffer_store_dword v27, v44, s[4:7], s91 offen sc1
s_mov_b32 s91, 1879048192
ds_read_b128 v[64:67], v28 offset:0
ds_read_b128 v[68:71], v28 offset:9216
ds_read_b128 v[72:75], v28 offset:18432
ds_read_b128 v[76:79], v28 offset:27648
ds_read_b128 v[80:83], v28 offset:1024
ds_read_b128 v[84:87], v28 offset:10240
ds_read_b128 v[88:91], v28 offset:19456
ds_read_b128 v[92:95], v28 offset:28672
s_waitcnt vmcnt(8)
s_barrier
s_branch g_body_16
g_body_16:
s_waitcnt lgkmcnt(4)
v_mfma_f32_16x16x32_bf16 v[208:211], v[64:67], a[0:3], 0
ds_read_b128 v[96:99], v28 offset:2048
v_mfma_f32_16x16x32_bf16 v[212:215], v[68:71], a[0:3], 0
ds_read_b128 v[100:103], v28 offset:11264
v_mfma_f32_16x16x32_bf16 v[216:219], v[64:67], a[72:75], 0
v_mfma_f32_16x16x32_bf16 v[208:211], v[72:75], a[4:7], v[208:211]
ds_read_b128 v[104:107], v28 offset:20480
v_cvt_pk_bf16_f32 v56, v224, v225
v_mfma_f32_16x16x32_bf16 v[212:215], v[76:79], a[4:7], v[212:215]
ds_read_b128 v[108:111], v28 offset:29696
v_cvt_pk_bf16_f32 v57, v226, v227
v_mfma_f32_16x16x32_bf16 v[220:223], v[68:71], a[72:75], 0
v_cvt_pk_bf16_f32 v58, v228, v229
s_waitcnt lgkmcnt(4)
v_mfma_f32_16x16x32_bf16 v[208:211], v[80:83], a[8:11], v[208:211]
ds_read_b128 v[112:115], v28 offset:3072
v_cvt_pk_bf16_f32 v59, v230, v231
v_mfma_f32_16x16x32_bf16 v[212:215], v[84:87], a[8:11], v[212:215]
ds_read_b128 v[116:119], v28 offset:12288
v_mfma_f32_16x16x32_bf16 v[216:219], v[72:75], a[76:79], v[216:219]
buffer_store_dwordx4 v[56:59], v21, s[4:7], s93 offen sc1
v_mfma_f32_16x16x32_bf16 v[208:211], v[88:91], a[12:15], v[208:211]
ds_read_b128 v[120:123], v28 offset:21504
v_mfma_f32_16x16x32_bf16 v[212:215], v[92:95], a[12:15], v[212:215]
ds_read_b128 v[124:127], v28 offset:30720
v_mfma_f32_16x16x32_bf16 v[220:223], v[76:79], a[76:79], v[220:223]
s_waitcnt lgkmcnt(4)
v_mfma_f32_16x16x32_bf16 v[208:211], v[96:99], a[16:19], v[208:211]
ds_read_b128 v[128:131], v28 offset:4096
v_mfma_f32_16x16x32_bf16 v[212:215], v[100:103], a[16:19], v[212:215]
ds_read_b128 v[132:135], v28 offset:13312
v_mfma_f32_16x16x32_bf16 v[216:219], v[80:83], a[80:83], v[216:219]
v_mfma_f32_16x16x32_bf16 v[208:211], v[104:107], a[20:23], v[208:211]
ds_read_b128 v[136:139], v28 offset:22528
v_mfma_f32_16x16x32_bf16 v[212:215], v[108:111], a[20:23], v[212:215]
ds_read_b128 v[140:143], v28 offset:31744
v_mfma_f32_16x16x32_bf16 v[220:223], v[84:87], a[80:83], v[220:223]
s_waitcnt vmcnt(5)
s_barrier
s_waitcnt lgkmcnt(4)
v_mfma_f32_16x16x32_bf16 v[208:211], v[112:115], a[24:27], v[208:211]
ds_read_b128 v[144:147], v28 offset:5120
v_mov_b32 v27, s90
v_mfma_f32_16x16x32_bf16 v[212:215], v[116:119], a[24:27], v[212:215]
ds_read_b128 v[148:151], v28 offset:14336
v_mfma_f32_16x16x32_bf16 v[216:219], v[88:91], a[84:87], v[216:219]
v_mfma_f32_16x16x32_bf16 v[208:211], v[120:123], a[28:31], v[208:211]
ds_read_b128 v[152:155], v28 offset:23552
v_mfma_f32_16x16x32_bf16 v[212:215], v[124:127], a[28:31], v[212:215]
ds_read_b128 v[156:159], v28 offset:32768
v_mfma_f32_16x16x32_bf16 v[220:223], v[92:95], a[84:87], v[220:223]
s_waitcnt lgkmcnt(4)
v_mfma_f32_16x16x32_bf16 v[208:211], v[128:131], a[32:35], v[208:211]
ds_read_b128 v[160:163], v28 offset:6144
v_mfma_f32_16x16x32_bf16 v[212:215], v[132:135], a[32:35], v[212:215]
ds_read_b128 v[164:167], v28 offset:15360
v_mfma_f32_16x16x32_bf16 v[216:219], v[96:99], a[88:91], v[216:219]
v_mfma_f32_16x16x32_bf16 v[208:211], v[136:139], a[36:39], v[208:211]
ds_read_b128 v[168:171], v28 offset:24576
v_mfma_f32_16x16x32_bf16 v[212:215], v[140:143], a[36:39], v[212:215]
ds_read_b128 v[172:175], v28 offset:33792
v_mfma_f32_16x16x32_bf16 v[220:223], v[100:103], a[88:91], v[220:223]
s_waitcnt lgkmcnt(4)
v_mfma_f32_16x16x32_bf16 v[208:211], v[144:147], a[40:43], v[208:211]
ds_read_b128 v[176:179], v28 offset:7168
v_mfma_f32_16x16x32_bf16 v[212:215], v[148:151], a[40:43], v[212:215]
ds_read_b128 v[180:183], v28 offset:16384
s_waitcnt vmcnt(4)
ds_write_b32 v18, v24
v_mfma_f32_16x16x32_bf16 v[216:219], v[104:107], a[92:95], v[216:219]
v_mfma_f32_16x16x32_bf16 v[208:211], v[152:155], a[44:47], v[208:211]
ds_read_b128 v[184:187], v28 offset:25600
v_mfma_f32_16x16x32_bf16 v[212:215], v[156:159], a[44:47], v[212:215]
ds_read_b128 v[188:191], v28 offset:34816
s_waitcnt lgkmcnt(2)
s_barrier
v_mfma_f32_16x16x32_bf16 v[220:223], v[108:111], a[92:95], v[220:223]
ds_read_b32 v33, v32
v_mfma_f32_16x16x32_bf16 v[208:211], v[160:163], a[48:51], v[208:211]
ds_read_b128 v[192:195], v28 offset:8192
v_mfma_f32_16x16x32_bf16 v[212:215], v[164:167], a[48:51], v[212:215]
ds_read_b128 v[196:199], v28 offset:17408
v_mfma_f32_16x16x32_bf16 v[216:219], v[112:115], a[96:99], v[216:219]
s_waitcnt lgkmcnt(2)
v_cmp_gt_u32 vcc, s52, v33
v_mfma_f32_16x16x32_bf16 v[208:211], v[168:171], a[52:55], v[208:211]
ds_read_b128 v[200:203], v28 offset:26624
v_cmp_gt_u32 s[58:59], s54, v33
v_mfma_f32_16x16x32_bf16 v[212:215], v[172:175], a[52:55], v[212:215]
ds_read_b128 v[204:207], v28 offset:35840
s_and_b32 vcc_lo, vcc_lo, s56
s_cselect_b32 s70, 0, 1
v_mfma_f32_16x16x32_bf16 v[220:223], v[116:119], a[96:99], v[220:223]
v_mfma_f32_16x16x32_bf16 v[208:211], v[176:179], a[56:59], v[208:211]
s_and_b32 s59, s59, s56
s_cselect_b32 s71, 0, s77
v_mfma_f32_16x16x32_bf16 v[212:215], v[180:183], a[56:59], v[212:215]
s_or_b32 s82, s70, s71
s_cselect_b32 s10, 268435456, 0
v_mfma_f32_16x16x32_bf16 v[216:219], v[120:123], a[100:103], v[216:219]
s_cmp_lg_u32 s70, 0
s_cselect_b64 s[78:79], s[52:53], s[54:55]
s_cselect_b64 s[58:59], s[44:45], s[46:47]
v_mfma_f32_16x16x32_bf16 v[208:211], v[184:187], a[60:63], v[208:211]
s_mul_i32 s80, s78, s20
s_add_u32 s80, s80, s58
v_mfma_f32_16x16x32_bf16 v[212:215], v[188:191], a[60:63], v[212:215]
s_add_u32 m0, s49, 0
s_mul_i32 s81, s78, s21
s_add_u32 s81, s81, s59
v_mfma_f32_16x16x32_bf16 v[220:223], v[124:127], a[100:103], v[220:223]
buffer_load_dwordx4 v8, s[8:11], s80 offen offset:0 sc1 lds
s_waitcnt lgkmcnt(0)
v_mfma_f32_16x16x32_bf16 v[208:211], v[192:195], a[64:67], v[208:211]
s_andn2_b32 s71, s71, s70
s_add_u32 s52, s52, s70
s_add_u32 s54, s54, s71
v_mfma_f32_16x16x32_bf16 v[212:215], v[196:199], a[64:67], v[212:215]
s_mov_b32 s83, s82
v_mfma_f32_16x16x32_bf16 v[216:219], v[128:131], a[104:107], v[216:219]
buffer_load_dwordx4 v9, s[8:11], s80 offen offset:1024 sc1 lds
v_mfma_f32_16x16x32_bf16 v[208:211], v[200:203], a[68:71], v[208:211]
v_mfma_f32_16x16x32_bf16 v[212:215], v[204:207], a[68:71], v[212:215]
v_mfma_f32_16x16x32_bf16 v[220:223], v[132:135], a[104:107], v[220:223]
buffer_load_dwordx4 v10, s[8:11], s80 offen offset:2048 sc1 lds
v_mfma_f32_16x16x32_bf16 v[216:219], v[136:139], a[108:111], v[216:219]
v_mfma_f32_16x16x32_bf16 v[220:223], v[140:143], a[108:111], v[220:223]
v_mfma_f32_16x16x32_bf16 v[216:219], v[144:147], a[112:115], v[216:219]
buffer_load_dwordx4 v11, s[8:11], s80 offen offset:3072 sc1 lds
v_mfma_f32_16x16x32_bf16 v[220:223], v[148:151], a[112:115], v[220:223]
v_mfma_f32_16x16x32_bf16 v[216:219], v[152:155], a[116:119], v[216:219]
s_add_u32 m0, s49, 4096
v_cvt_pk_bf16_f32 v48, v208, v209
v_mfma_f32_16x16x32_bf16 v[220:223], v[156:159], a[116:119], v[220:223]
buffer_load_dwordx4 v12, s[8:11], s80 offen offset:0 sc1 lds
v_mfma_f32_16x16x32_bf16 v[216:219], v[160:163], a[120:123], v[216:219]
v_cvt_pk_bf16_f32 v49, v210, v211
v_cvt_pk_bf16_f32 v50, v212, v213
v_mfma_f32_16x16x32_bf16 v[220:223], v[164:167], a[120:123], v[220:223]
v_cvt_pk_bf16_f32 v51, v214, v215
v_mfma_f32_16x16x32_bf16 v[216:219], v[168:171], a[124:127], v[216:219]
buffer_load_dwordx4 v13, s[8:11], s80 offen offset:1024 sc1 lds
v_mfma_f32_16x16x32_bf16 v[220:223], v[172:175], a[124:127], v[220:223]
buffer_store_dwordx4 v[48:51], v19, s[4:7], s75 offen sc1
v_mfma_f32_16x16x32_bf16 v[216:219], v[176:179], a[128:131], v[216:219]
v_mfma_f32_16x16x32_bf16 v[220:223], v[180:183], a[128:131], v[220:223]
buffer_load_dwordx4 v14, s[8:11], s80 offen offset:2048 sc1 lds
v_mfma_f32_16x16x32_bf16 v[216:219], v[184:187], a[132:135], v[216:219]
v_mfma_f32_16x16x32_bf16 v[220:223], v[188:191], a[132:135], v[220:223]
v_mfma_f32_16x16x32_bf16 v[216:219], v[192:195], a[136:139], v[216:219]
buffer_load_dwordx4 v15, s[8:11], s80 offen offset:3072 sc1 lds
v_mfma_f32_16x16x32_bf16 v[220:223], v[196:199], a[136:139], v[220:223]
v_mfma_f32_16x16x32_bf16 v[216:219], v[200:203], a[140:143], v[216:219]
s_add_u32 m0, s49, 8192
v_mfma_f32_16x16x32_bf16 v[220:223], v[204:207], a[140:143], v[220:223]
buffer_load_dwordx4 v16, s[8:11], s80 offen offset:0 sc1 lds
v_mfma_f32_16x16x32_bf16 v[224:227], v[64:67], a[144:147], 0
v_mfma_f32_16x16x32_bf16 v[228:231], v[68:71], a[144:147], 0
v_mfma_f32_16x16x32_bf16 v[224:227], v[72:75], a[148:151], v[224:227]
v_mfma_f32_16x16x32_bf16 v[228:231], v[76:79], a[148:151], v[228:231]
v_mfma_f32_16x16x32_bf16 v[224:227], v[80:83], a[152:155], v[224:227]
buffer_load_dword v24, v22, s[4:7], 0 offen sc1
v_mfma_f32_16x16x32_bf16 v[228:231], v[84:87], a[152:155], v[228:231]
v_cvt_pk_bf16_f32 v52, v216, v217
v_cvt_pk_bf16_f32 v53, v218, v219
v_mfma_f32_16x16x32_bf16 v[224:227], v[88:91], a[156:159], v[224:227]
s_waitcnt vmcnt(11)
s_barrier
v_mfma_f32_16x16x32_bf16 v[228:231], v[92:95], a[156:159], v[228:231]
buffer_store_dword v27, v45, s[4:7], s91 offen
v_mfma_f32_16x16x32_bf16 v[224:227], v[96:99], a[160:163], v[224:227]
buffer_store_dword v27, v44, s[4:7], s91 offen sc1
v_mfma_f32_16x16x32_bf16 v[228:231], v[100:103], a[160:163], v[228:231]
v_cvt_pk_bf16_f32 v54, v220, v221
v_cvt_pk_bf16_f32 v55, v222, v223
v_mfma_f32_16x16x32_bf16 v[224:227], v[104:107], a[164:167], v[224:227]
buffer_store_dwordx4 v[52:55], v20, s[4:7], s75 offen sc1
v_mfma_f32_16x16x32_bf16 v[228:231], v[108:111], a[164:167], v[228:231]
v_mfma_f32_16x16x32_bf16 v[224:227], v[112:115], a[168:171], v[224:227]
v_mfma_f32_16x16x32_bf16 v[228:231], v[116:119], a[168:171], v[228:231]
v_mfma_f32_16x16x32_bf16 v[224:227], v[120:123], a[172:175], v[224:227]
v_mfma_f32_16x16x32_bf16 v[228:231], v[124:127], a[172:175], v[228:231]
v_mfma_f32_16x16x32_bf16 v[224:227], v[128:131], a[176:179], v[224:227]
v_mfma_f32_16x16x32_bf16 v[228:231], v[132:135], a[176:179], v[228:231]
v_mfma_f32_16x16x32_bf16 v[224:227], v[136:139], a[180:183], v[224:227]
v_mfma_f32_16x16x32_bf16 v[228:231], v[140:143], a[180:183], v[228:231]
v_mfma_f32_16x16x32_bf16 v[224:227], v[144:147], a[184:187], v[224:227]
v_mfma_f32_16x16x32_bf16 v[228:231], v[148:151], a[184:187], v[228:231]
v_mfma_f32_16x16x32_bf16 v[224:227], v[152:155], a[188:191], v[224:227]
v_mfma_f32_16x16x32_bf16 v[228:231], v[156:159], a[188:191], v[228:231]
v_mfma_f32_16x16x32_bf16 v[224:227], v[160:163], a[192:195], v[224:227]
s_waitcnt vmcnt(12)
s_barrier
v_mfma_f32_16x16x32_bf16 v[228:231], v[164:167], a[192:195], v[228:231]
v_mfma_f32_16x16x32_bf16 v[224:227], v[168:171], a[196:199], v[224:227]
s_cmp_eq_u32 s82, 0
s_cbranch_scc1 g_slow_28
v_mfma_f32_16x16x32_bf16 v[228:231], v[172:175], a[196:199], v[228:231]
ds_read_b128 v[64:67], v29 offset:0
v_mfma_f32_16x16x32_bf16 v[224:227], v[176:179], a[200:203], v[224:227]
ds_read_b128 v[68:71], v29 offset:9216
v_mfma_f32_16x16x32_bf16 v[228:231], v[180:183], a[200:203], v[228:231]
ds_read_b128 v[72:75], v29 offset:18432
v_mfma_f32_16x16x32_bf16 v[224:227], v[184:187], a[204:207], v[224:227]
ds_read_b128 v[76:79], v29 offset:27648
v_mfma_f32_16x16x32_bf16 v[228:231], v[188:191], a[204:207], v[228:231]
ds_read_b128 v[80:83], v29 offset:1024
v_mfma_f32_16x16x32_bf16 v[224:227], v[192:195], a[208:211], v[224:227]
ds_read_b128 v[84:87], v29 offset:10240
v_mfma_f32_16x16x32_bf16 v[228:231], v[196:199], a[208:211], v[228:231]
ds_read_b128 v[88:91], v29 offset:19456
v_mfma_f32_16x16x32_bf16 v[224:227], v[200:203], a[212:215], v[224:227]
ds_read_b128 v[92:95], v29 offset:28672
v_mfma_f32_16x16x32_bf16 v[228:231], v[204:207], a[212:215], v[228:231]
s_waitcnt vmcnt(9)
s_barrier
g_body_17:
s_waitcnt lgkmcnt(4)
v_mfma_f32_16x16x32_bf16 v[208:211], v[64:67], a[0:3], 0
ds_read_b128 v[96:99], v29 offset:2048
v_mfma_f32_16x16x32_bf16 v[212:215], v[68:71], a[0:3], 0
ds_read_b128 v[100:103], v29 offset:11264
v_mfma_f32_16x16x32_bf16 v[216:219], v[64:67], a[72:75], 0
v_mfma_f32_16x16x32_bf16 v[208:211], v[72:75], a[4:7], v[208:211]
ds_read_b128 v[104:107], v29 offset:20480
v_cvt_pk_bf16_f32 v56, v224, v225
v_mfma_f32_16x16x32_bf16 v[212:215], v[76:79], a[4:7], v[212:215]
ds_read_b128 v[108:111], v29 offset:29696
v_cvt_pk_bf16_f32 v57, v226, v227
v_mfma_f32_16x16x32_bf16 v[220:223], v[68:71], a[72:75], 0
v_cvt_pk_bf16_f32 v58, v228, v229
s_waitcnt lgkmcnt(4)
v_mfma_f32_16x16x32_bf16 v[208:211], v[80:83], a[8:11], v[208:211]
ds_read_b128 v[112:115], v29 offset:3072
v_cvt_pk_bf16_f32 v59, v230, v231
v_mfma_f32_16x16x32_bf16 v[212:215], v[84:87], a[8:11], v[212:215]
ds_read_b128 v[116:119], v29 offset:12288
v_mfma_f32_16x16x32_bf16 v[216:219], v[72:75], a[76:79], v[216:219]
buffer_store_dwordx4 v[56:59], v21, s[4:7], s75 offen sc1
v_mfma_f32_16x16x32_bf16 v[208:211], v[88:91], a[12:15], v[208:211]
ds_read_b128 v[120:123], v29 offset:21504
v_mfma_f32_16x16x32_bf16 v[212:215], v[92:95], a[12:15], v[212:215]
ds_read_b128 v[124:127], v29 offset:30720
v_mfma_f32_16x16x32_bf16 v[220:223], v[76:79], a[76:79], v[220:223]
s_waitcnt lgkmcnt(4)
v_mfma_f32_16x16x32_bf16 v[208:211], v[96:99], a[16:19], v[208:211]
ds_read_b128 v[128:131], v29 offset:4096
v_mfma_f32_16x16x32_bf16 v[212:215], v[100:103], a[16:19], v[212:215]
ds_read_b128 v[132:135], v29 offset:13312
v_mfma_f32_16x16x32_bf16 v[216:219], v[80:83], a[80:83], v[216:219]
v_mfma_f32_16x16x32_bf16 v[208:211], v[104:107], a[20:23], v[208:211]
ds_read_b128 v[136:139], v29 offset:22528
v_mfma_f32_16x16x32_bf16 v[212:215], v[108:111], a[20:23], v[212:215]
ds_read_b128 v[140:143], v29 offset:31744
v_mfma_f32_16x16x32_bf16 v[220:223], v[84:87], a[80:83], v[220:223]
s_waitcnt vmcnt(5)
s_barrier
s_waitcnt lgkmcnt(4)
v_mfma_f32_16x16x32_bf16 v[208:211], v[112:115], a[24:27], v[208:211]
ds_read_b128 v[144:147], v29 offset:5120
v_mov_b32 v27, s72
v_mfma_f32_16x16x32_bf16 v[212:215], v[116:119], a[24:27], v[212:215]
ds_read_b128 v[148:151], v29 offset:14336
v_mfma_f32_16x16x32_bf16 v[216:219], v[88:91], a[84:87], v[216:219]
v_mfma_f32_16x16x32_bf16 v[208:211], v[120:123], a[28:31], v[208:211]
ds_read_b128 v[152:155], v29 offset:23552
v_mfma_f32_16x16x32_bf16 v[212:215], v[124:127], a[28:31], v[212:215]
ds_read_b128 v[156:159], v29 offset:32768
v_mfma_f32_16x16x32_bf16 v[220:223], v[92:95], a[84:87], v[220:223]
s_waitcnt lgkmcnt(4)
v_mfma_f32_16x16x32_bf16 v[208:211], v[128:131], a[32:35], v[208:211]
ds_read_b128 v[160:163], v29 offset:6144
v_mfma_f32_16x16x32_bf16 v[212:215], v[132:135], a[32:35], v[212:215]
ds_read_b128 v[164:167], v29 offset:15360
v_mfma_f32_16x16x32_bf16 v[216:219], v[96:99], a[88:91], v[216:219]
v_mfma_f32_16x16x32_bf16 v[208:211], v[136:139], a[36:39], v[208:211]
ds_read_b128 v[168:171], v29 offset:24576
v_mfma_f32_16x16x32_bf16 v[212:215], v[140:143], a[36:39], v[212:215]
ds_read_b128 v[172:175], v29 offset:33792
v_mfma_f32_16x16x32_bf16 v[220:223], v[100:103], a[88:91], v[220:223]
s_waitcnt lgkmcnt(4)
v_mfma_f32_16x16x32_bf16 v[208:211], v[144:147], a[40:43], v[208:211]
ds_read_b128 v[176:179], v29 offset:7168
v_mfma_f32_16x16x32_bf16 v[212:215], v[148:151], a[40:43], v[212:215]
ds_read_b128 v[180:183], v29 offset:16384
s_waitcnt vmcnt(4)
ds_write_b32 v18, v24
v_mfma_f32_16x16x32_bf16 v[216:219], v[104:107], a[92:95], v[216:219]
v_mfma_f32_16x16x32_bf16 v[208:211], v[152:155], a[44:47], v[208:211]
ds_read_b128 v[184:187], v29 offset:25600
v_mfma_f32_16x16x32_bf16 v[212:215], v[156:159], a[44:47], v[212:215]
ds_read_b128 v[188:191], v29 offset:34816
s_waitcnt lgkmcnt(2)
s_barrier
v_mfma_f32_16x16x32_bf16 v[220:223], v[108:111], a[92:95], v[220:223]
ds_read_b32 v33, v32
v_mfma_f32_16x16x32_bf16 v[208:211], v[160:163], a[48:51], v[208:211]
ds_read_b128 v[192:195], v29 offset:8192
v_mfma_f32_16x16x32_bf16 v[212:215], v[164:167], a[48:51], v[212:215]
ds_read_b128 v[196:199], v29 offset:17408
v_mfma_f32_16x16x32_bf16 v[216:219], v[112:115], a[96:99], v[216:219]
s_waitcnt lgkmcnt(2)
v_cmp_gt_u32 vcc, s52, v33
v_mfma_f32_16x16x32_bf16 v[208:211], v[168:171], a[52:55], v[208:211]
ds_read_b128 v[200:203], v29 offset:26624
v_cmp_gt_u32 s[58:59], s54, v33
v_mfma_f32_16x16x32_bf16 v[212:215], v[172:175], a[52:55], v[212:215]
ds_read_b128 v[204:207], v29 offset:35840
s_and_b32 vcc_lo, vcc_lo, s56
s_cselect_b32 s70, 0, 1
v_mfma_f32_16x16x32_bf16 v[220:223], v[116:119], a[96:99], v[220:223]
v_mfma_f32_16x16x32_bf16 v[208:211], v[176:179], a[56:59], v[208:211]
s_and_b32 s59, s59, s56
s_cselect_b32 s71, 0, s83
v_mfma_f32_16x16x32_bf16 v[212:215], v[180:183], a[56:59], v[212:215]
s_or_b32 s88, s70, s71
s_cselect_b32 s10, 268435456, 0
v_mfma_f32_16x16x32_bf16 v[216:219], v[120:123], a[100:103], v[216:219]
s_cmp_lg_u32 s70, 0
s_cselect_b64 s[84:85], s[52:53], s[54:55]
s_cselect_b64 s[58:59], s[44:45], s[46:47]
v_mfma_f32_16x16x32_bf16 v[208:211], v[184:187], a[60:63], v[208:211]
s_mul_i32 s86, s84, s20
s_add_u32 s86, s86, s58
v_mfma_f32_16x16x32_bf16 v[212:215], v[188:191], a[60:63], v[212:215]
s_add_u32 m0, s50, 0
s_mul_i32 s87, s84, s21
s_add_u32 s87, s87, s59
v_mfma_f32_16x16x32_bf16 v[220:223], v[124:127], a[100:103], v[220:223]
buffer_load_dwordx4 v8, s[8:11], s86 offen offset:0 sc1 lds
s_waitcnt lgkmcnt(0)
v_mfma_f32_16x16x32_bf16 v[208:211], v[192:195], a[64:67], v[208:211]
s_andn2_b32 s71, s71, s70
s_add_u32 s52, s52, s70
s_add_u32 s54, s54, s71
v_mfma_f32_16x16x32_bf16 v[212:215], v[196:199], a[64:67], v[212:215]
s_mov_b32 s89, s88
v_mfma_f32_16x16x32_bf16 v[216:219], v[128:131], a[104:107], v[216:219]
buffer_load_dwordx4 v9, s[8:11], s86 offen offset:1024 sc1 lds
v_mfma_f32_16x16x32_bf16 v[208:211], v[200:203], a[68:71], v[208:211]
v_mfma_f32_16x16x32_bf16 v[212:215], v[204:207], a[68:71], v[212:215]
v_mfma_f32_16x16x32_bf16 v[220:223], v[132:135], a[104:107], v[220:223]
buffer_load_dwordx4 v10, s[8:11], s86 offen offset:2048 sc1 lds
v_mfma_f32_16x16x32_bf16 v[216:219], v[136:139], a[108:111], v[216:219]
v_mfma_f32_16x16x32_bf16 v[220:223], v[140:143], a[108:111], v[220:223]
v_mfma_f32_16x16x32_bf16 v[216:219], v[144:147], a[112:115], v[216:219]
buffer_load_dwordx4 v11, s[8:11], s86 offen offset:3072 sc1 lds
v_mfma_f32_16x16x32_bf16 v[220:223], v[148:151], a[112:115], v[220:223]
v_mfma_f32_16x16x32_bf16 v[216:219], v[152:155], a[116:119], v[216:219]
s_add_u32 m0, s50, 4096
v_cvt_pk_bf16_f32 v48, v208, v209
v_mfma_f32_16x16x32_bf16 v[220:223], v[156:159], a[116:119], v[220:223]
buffer_load_dwordx4 v12, s[8:11], s86 offen offset:0 sc1 lds
v_mfma_f32_16x16x32_bf16 v[216:219], v[160:163], a[120:123], v[216:219]
v_cvt_pk_bf16_f32 v49, v210, v211
v_cvt_pk_bf16_f32 v50, v212, v213
v_mfma_f32_16x16x32_bf16 v[220:223], v[164:167], a[120:123], v[220:223]
v_cvt_pk_bf16_f32 v51, v214, v215
v_mfma_f32_16x16x32_bf16 v[216:219], v[168:171], a[124:127], v[216:219]
buffer_load_dwordx4 v13, s[8:11], s86 offen offset:1024 sc1 lds
v_mfma_f32_16x16x32_bf16 v[220:223], v[172:175], a[124:127], v[220:223]
buffer_store_dwordx4 v[48:51], v19, s[4:7], s81 offen sc1
v_mfma_f32_16x16x32_bf16 v[216:219], v[176:179], a[128:131], v[216:219]
v_mfma_f32_16x16x32_bf16 v[220:223], v[180:183], a[128:131], v[220:223]
buffer_load_dwordx4 v14, s[8:11], s86 offen offset:2048 sc1 lds
v_mfma_f32_16x16x32_bf16 v[216:219], v[184:187], a[132:135], v[216:219]
v_mfma_f32_16x16x32_bf16 v[220:223], v[188:191], a[132:135], v[220:223]
v_mfma_f32_16x16x32_bf16 v[216:219], v[192:195], a[136:139], v[216:219]
buffer_load_dwordx4 v15, s[8:11], s86 offen offset:3072 sc1 lds
v_mfma_f32_16x16x32_bf16 v[220:223], v[196:199], a[136:139], v[220:223]
v_mfma_f32_16x16x32_bf16 v[216:219], v[200:203], a[140:143], v[216:219]
s_add_u32 m0, s50, 8192
v_mfma_f32_16x16x32_bf16 v[220:223], v[204:207], a[140:143], v[220:223]
buffer_load_dwordx4 v16, s[8:11], s86 offen offset:0 sc1 lds
v_mfma_f32_16x16x32_bf16 v[224:227], v[64:67], a[144:147], 0
v_mfma_f32_16x16x32_bf16 v[228:231], v[68:71], a[144:147], 0
v_mfma_f32_16x16x32_bf16 v[224:227], v[72:75], a[148:151], v[224:227]
v_mfma_f32_16x16x32_bf16 v[228:231], v[76:79], a[148:151], v[228:231]
v_mfma_f32_16x16x32_bf16 v[224:227], v[80:83], a[152:155], v[224:227]
buffer_load_dword v24, v22, s[4:7], 0 offen sc1
v_mfma_f32_16x16x32_bf16 v[228:231], v[84:87], a[152:155], v[228:231]
v_cvt_pk_bf16_f32 v52, v216, v217
v_cvt_pk_bf16_f32 v53, v218, v219
v_mfma_f32_16x16x32_bf16 v[224:227], v[88:91], a[156:159], v[224:227]
s_waitcnt vmcnt(11)
s_barrier
v_mfma_f32_16x16x32_bf16 v[228:231], v[92:95], a[156:159], v[228:231]
buffer_store_dword v27, v45, s[4:7], s73 offen
v_mfma_f32_16x16x32_bf16 v[224:227], v[96:99], a[160:163], v[224:227]
buffer_store_dword v27, v44, s[4:7], s73 offen sc1
v_mfma_f32_16x16x32_bf16 v[228:231], v[100:103], a[160:163], v[228:231]
v_cvt_pk_bf16_f32 v54, v220, v221
v_cvt_pk_bf16_f32 v55, v222, v223
v_mfma_f32_16x16x32_bf16 v[224:227], v[104:107], a[164:167], v[224:227]
buffer_store_dwordx4 v[52:55], v20, s[4:7], s81 offen sc1
v_mfma_f32_16x16x32_bf16 v[228:231], v[108:111], a[164:167], v[228:231]
v_mfma_f32_16x16x32_bf16 v[224:227], v[112:115], a[168:171], v[224:227]
v_mfma_f32_16x16x32_bf16 v[228:231], v[116:119], a[168:171], v[228:231]
v_mfma_f32_16x16x32_bf16 v[224:227], v[120:123], a[172:175], v[224:227]
v_mfma_f32_16x16x32_bf16 v[228:231], v[124:127], a[172:175], v[228:231]
v_mfma_f32_16x16x32_bf16 v[224:227], v[128:131], a[176:179], v[224:227]
v_mfma_f32_16x16x32_bf16 v[228:231], v[132:135], a[176:179], v[228:231]
v_mfma_f32_16x16x32_bf16 v[224:227], v[136:139], a[180:183], v[224:227]
v_mfma_f32_16x16x32_bf16 v[228:231], v[140:143], a[180:183], v[228:231]
v_mfma_f32_16x16x32_bf16 v[224:227], v[144:147], a[184:187], v[224:227]
v_mfma_f32_16x16x32_bf16 v[228:231], v[148:151], a[184:187], v[228:231]
v_mfma_f32_16x16x32_bf16 v[224:227], v[152:155], a[188:191], v[224:227]
v_mfma_f32_16x16x32_bf16 v[228:231], v[156:159], a[188:191], v[228:231]
v_mfma_f32_16x16x32_bf16 v[224:227], v[160:163], a[192:195], v[224:227]
s_waitcnt vmcnt(12)
s_barrier
v_mfma_f32_16x16x32_bf16 v[228:231], v[164:167], a[192:195], v[228:231]
v_mfma_f32_16x16x32_bf16 v[224:227], v[168:171], a[196:199], v[224:227]
s_cmp_eq_u32 s88, 0
s_cbranch_scc1 g_slow_29
v_mfma_f32_16x16x32_bf16 v[228:231], v[172:175], a[196:199], v[228:231]
ds_read_b128 v[64:67], v30 offset:0
v_mfma_f32_16x16x32_bf16 v[224:227], v[176:179], a[200:203], v[224:227]
ds_read_b128 v[68:71], v30 offset:9216
v_mfma_f32_16x16x32_bf16 v[228:231], v[180:183], a[200:203], v[228:231]
ds_read_b128 v[72:75], v30 offset:18432
v_mfma_f32_16x16x32_bf16 v[224:227], v[184:187], a[204:207], v[224:227]
ds_read_b128 v[76:79], v30 offset:27648
v_mfma_f32_16x16x32_bf16 v[228:231], v[188:191], a[204:207], v[228:231]
ds_read_b128 v[80:83], v30 offset:1024
v_mfma_f32_16x16x32_bf16 v[224:227], v[192:195], a[208:211], v[224:227]
ds_read_b128 v[84:87], v30 offset:10240
v_mfma_f32_16x16x32_bf16 v[228:231], v[196:199], a[208:211], v[228:231]
ds_read_b128 v[88:91], v30 offset:19456
v_mfma_f32_16x16x32_bf16 v[224:227], v[200:203], a[212:215], v[224:227]
ds_read_b128 v[92:95], v30 offset:28672
v_mfma_f32_16x16x32_bf16 v[228:231], v[204:207], a[212:215], v[228:231]
s_waitcnt vmcnt(9)
s_barrier
g_body_18:
s_waitcnt lgkmcnt(4)
v_mfma_f32_16x16x32_bf16 v[208:211], v[64:67], a[0:3], 0
ds_read_b128 v[96:99], v30 offset:2048
v_mfma_f32_16x16x32_bf16 v[212:215], v[68:71], a[0:3], 0
ds_read_b128 v[100:103], v30 offset:11264
v_mfma_f32_16x16x32_bf16 v[216:219], v[64:67], a[72:75], 0
v_mfma_f32_16x16x32_bf16 v[208:211], v[72:75], a[4:7], v[208:211]
ds_read_b128 v[104:107], v30 offset:20480
v_cvt_pk_bf16_f32 v56, v224, v225
v_mfma_f32_16x16x32_bf16 v[212:215], v[76:79], a[4:7], v[212:215]
ds_read_b128 v[108:111], v30 offset:29696
v_cvt_pk_bf16_f32 v57, v226, v227
v_mfma_f32_16x16x32_bf16 v[220:223], v[68:71], a[72:75], 0
v_cvt_pk_bf16_f32 v58, v228, v229
s_waitcnt lgkmcnt(4)
v_mfma_f32_16x16x32_bf16 v[208:211], v[80:83], a[8:11], v[208:211]
ds_read_b128 v[112:115], v30 offset:3072
v_cvt_pk_bf16_f32 v59, v230, v231
v_mfma_f32_16x16x32_bf16 v[212:215], v[84:87], a[8:11], v[212:215]
ds_read_b128 v[116:119], v30 offset:12288
v_mfma_f32_16x16x32_bf16 v[216:219], v[72:75], a[76:79], v[216:219]
buffer_store_dwordx4 v[56:59], v21, s[4:7], s81 offen sc1
v_mfma_f32_16x16x32_bf16 v[208:211], v[88:91], a[12:15], v[208:211]
ds_read_b128 v[120:123], v30 offset:21504
v_mfma_f32_16x16x32_bf16 v[212:215], v[92:95], a[12:15], v[212:215]
ds_read_b128 v[124:127], v30 offset:30720
v_mfma_f32_16x16x32_bf16 v[220:223], v[76:79], a[76:79], v[220:223]
s_waitcnt lgkmcnt(4)
v_mfma_f32_16x16x32_bf16 v[208:211], v[96:99], a[16:19], v[208:211]
ds_read_b128 v[128:131], v30 offset:4096
v_mfma_f32_16x16x32_bf16 v[212:215], v[100:103], a[16:19], v[212:215]
ds_read_b128 v[132:135], v30 offset:13312
v_mfma_f32_16x16x32_bf16 v[216:219], v[80:83], a[80:83], v[216:219]
v_mfma_f32_16x16x32_bf16 v[208:211], v[104:107], a[20:23], v[208:211]
ds_read_b128 v[136:139], v30 offset:22528
v_mfma_f32_16x16x32_bf16 v[212:215], v[108:111], a[20:23], v[212:215]
ds_read_b128 v[140:143], v30 offset:31744
v_mfma_f32_16x16x32_bf16 v[220:223], v[84:87], a[80:83], v[220:223]
s_waitcnt vmcnt(5)
s_barrier
s_waitcnt lgkmcnt(4)
v_mfma_f32_16x16x32_bf16 v[208:211], v[112:115], a[24:27], v[208:211]
ds_read_b128 v[144:147], v30 offset:5120
v_mov_b32 v27, s78
v_mfma_f32_16x16x32_bf16 v[212:215], v[116:119], a[24:27], v[212:215]
ds_read_b128 v[148:151], v30 offset:14336
v_mfma_f32_16x16x32_bf16 v[216:219], v[88:91], a[84:87], v[216:219]
v_mfma_f32_16x16x32_bf16 v[208:211], v[120:123], a[28:31], v[208:211]
ds_read_b128 v[152:155], v30 offset:23552
v_mfma_f32_16x16x32_bf16 v[212:215], v[124:127], a[28:31], v[212:215]
ds_read_b128 v[156:159], v30 offset:32768
v_mfma_f32_16x16x32_bf16 v[220:223], v[92:95], a[84:87], v[220:223]
s_waitcnt lgkmcnt(4)
v_mfma_f32_16x16x32_bf16 v[208:211], v[128:131], a[32:35], v[208:211]
ds_read_b128 v[160:163], v30 offset:6144
v_mfma_f32_16x16x32_bf16 v[212:215], v[132:135], a[32:35], v[212:215]
ds_read_b128 v[164:167], v30 offset:15360
v_mfma_f32_16x16x32_bf16 v[216:219], v[96:99], a[88:91], v[216:219]
v_mfma_f32_16x16x32_bf16 v[208:211], v[136:139], a[36:39], v[208:211]
ds_read_b128 v[168:171], v30 offset:24576
v_mfma_f32_16x16x32_bf16 v[212:215], v[140:143], a[36:39], v[212:215]
ds_read_b128 v[172:175], v30 offset:33792
v_mfma_f32_16x16x32_bf16 v[220:223], v[100:103], a[88:91], v[220:223]
s_waitcnt lgkmcnt(4)
v_mfma_f32_16x16x32_bf16 v[208:211], v[144:147], a[40:43], v[208:211]
ds_read_b128 v[176:179], v30 offset:7168
v_mfma_f32_16x16x32_bf16 v[212:215], v[148:151], a[40:43], v[212:215]
ds_read_b128 v[180:183], v30 offset:16384
s_waitcnt vmcnt(4)
ds_write_b32 v18, v24
v_mfma_f32_16x16x32_bf16 v[216:219], v[104:107], a[92:95], v[216:219]
v_mfma_f32_16x16x32_bf16 v[208:211], v[152:155], a[44:47], v[208:211]
ds_read_b128 v[184:187], v30 offset:25600
v_mfma_f32_16x16x32_bf16 v[212:215], v[156:159], a[44:47], v[212:215]
ds_read_b128 v[188:191], v30 offset:34816
s_waitcnt lgkmcnt(2)
s_barrier
v_mfma_f32_16x16x32_bf16 v[220:223], v[108:111], a[92:95], v[220:223]
ds_read_b32 v33, v32
v_mfma_f32_16x16x32_bf16 v[208:211], v[160:163], a[48:51], v[208:211]
ds_read_b128 v[192:195], v30 offset:8192
v_mfma_f32_16x16x32_bf16 v[212:215], v[164:167], a[48:51], v[212:215]
ds_read_b128 v[196:199], v30 offset:17408
v_mfma_f32_16x16x32_bf16 v[216:219], v[112:115], a[96:99], v[216:219]
s_waitcnt lgkmcnt(2)
v_cmp_gt_u32 vcc, s52, v33
v_mfma_f32_16x16x32_bf16 v[208:211], v[168:171], a[52:55], v[208:211]
ds_read_b128 v[200:203], v30 offset:26624
v_cmp_gt_u32 s[58:59], s54, v33
v_mfma_f32_16x16x32_bf16 v[212:215], v[172:175], a[52:55], v[212:215]
ds_read_b128 v[204:207], v30 offset:35840
s_and_b32 vcc_lo, vcc_lo, s56
s_cselect_b32 s70, 0, 1
v_mfma_f32_16x16x32_bf16 v[220:223], v[116:119], a[96:99], v[220:223]
v_mfma_f32_16x16x32_bf16 v[208:211], v[176:179], a[56:59], v[208:211]
s_and_b32 s59, s59, s56
s_cselect_b32 s71, 0, s89
v_mfma_f32_16x16x32_bf16 v[212:215], v[180:183], a[56:59], v[212:215]
s_or_b32 s94, s70, s71
s_cselect_b32 s10, 268435456, 0
v_mfma_f32_16x16x32_bf16 v[216:219], v[120:123], a[100:103], v[216:219]
s_cmp_lg_u32 s70, 0
s_cselect_b64 s[90:91], s[52:53], s[54:55]
s_cselect_b64 s[58:59], s[44:45], s[46:47]
v_mfma_f32_16x16x32_bf16 v[208:211], v[184:187], a[60:63], v[208:211]
s_mul_i32 s92, s90, s20
s_add_u32 s92, s92, s58
v_mfma_f32_16x16x32_bf16 v[212:215], v[188:191], a[60:63], v[212:215]
s_add_u32 m0, s51, 0
s_mul_i32 s93, s90, s21
s_add_u32 s93, s93, s59
v_mfma_f32_16x16x32_bf16 v[220:223], v[124:127], a[100:103], v[220:223]
buffer_load_dwordx4 v8, s[8:11], s92 offen offset:0 sc1 lds
s_waitcnt lgkmcnt(0)
v_mfma_f32_16x16x32_bf16 v[208:211], v[192:195], a[64:67], v[208:211]
s_andn2_b32 s71, s71, s70
s_add_u32 s52, s52, s70
s_add_u32 s54, s54, s71
v_mfma_f32_16x16x32_bf16 v[212:215], v[196:199], a[64:67], v[212:215]
s_mov_b32 s95, s94
v_mfma_f32_16x16x32_bf16 v[216:219], v[128:131], a[104:107], v[216:219]
buffer_load_dwordx4 v9, s[8:11], s92 offen offset:1024 sc1 lds
v_mfma_f32_16x16x32_bf16 v[208:211], v[200:203], a[68:71], v[208:211]
v_mfma_f32_16x16x32_bf16 v[212:215], v[204:207], a[68:71], v[212:215]
v_mfma_f32_16x16x32_bf16 v[220:223], v[132:135], a[104:107], v[220:223]
buffer_load_dwordx4 v10, s[8:11], s92 offen offset:2048 sc1 lds
v_mfma_f32_16x16x32_bf16 v[216:219], v[136:139], a[108:111], v[216:219]
v_mfma_f32_16x16x32_bf16 v[220:223], v[140:143], a[108:111], v[220:223]
v_mfma_f32_16x16x32_bf16 v[216:219], v[144:147], a[112:115], v[216:219]
buffer_load_dwordx4 v11, s[8:11], s92 offen offset:3072 sc1 lds
v_mfma_f32_16x16x32_bf16 v[220:223], v[148:151], a[112:115], v[220:223]
v_mfma_f32_16x16x32_bf16 v[216:219], v[152:155], a[116:119], v[216:219]
s_add_u32 m0, s51, 4096
v_cvt_pk_bf16_f32 v48, v208, v209
v_mfma_f32_16x16x32_bf16 v[220:223], v[156:159], a[116:119], v[220:223]
buffer_load_dwordx4 v12, s[8:11], s92 offen offset:0 sc1 lds
v_mfma_f32_16x16x32_bf16 v[216:219], v[160:163], a[120:123], v[216:219]
v_cvt_pk_bf16_f32 v49, v210, v211
v_cvt_pk_bf16_f32 v50, v212, v213
v_mfma_f32_16x16x32_bf16 v[220:223], v[164:167], a[120:123], v[220:223]
v_cvt_pk_bf16_f32 v51, v214, v215
v_mfma_f32_16x16x32_bf16 v[216:219], v[168:171], a[124:127], v[216:219]
buffer_load_dwordx4 v13, s[8:11], s92 offen offset:1024 sc1 lds
v_mfma_f32_16x16x32_bf16 v[220:223], v[172:175], a[124:127], v[220:223]
buffer_store_dwordx4 v[48:51], v19, s[4:7], s87 offen sc1
v_mfma_f32_16x16x32_bf16 v[216:219], v[176:179], a[128:131], v[216:219]
v_mfma_f32_16x16x32_bf16 v[220:223], v[180:183], a[128:131], v[220:223]
buffer_load_dwordx4 v14, s[8:11], s92 offen offset:2048 sc1 lds
v_mfma_f32_16x16x32_bf16 v[216:219], v[184:187], a[132:135], v[216:219]
v_mfma_f32_16x16x32_bf16 v[220:223], v[188:191], a[132:135], v[220:223]
v_mfma_f32_16x16x32_bf16 v[216:219], v[192:195], a[136:139], v[216:219]
buffer_load_dwordx4 v15, s[8:11], s92 offen offset:3072 sc1 lds
v_mfma_f32_16x16x32_bf16 v[220:223], v[196:199], a[136:139], v[220:223]
v_mfma_f32_16x16x32_bf16 v[216:219], v[200:203], a[140:143], v[216:219]
s_add_u32 m0, s51, 8192
v_mfma_f32_16x16x32_bf16 v[220:223], v[204:207], a[140:143], v[220:223]
buffer_load_dwordx4 v16, s[8:11], s92 offen offset:0 sc1 lds
v_mfma_f32_16x16x32_bf16 v[224:227], v[64:67], a[144:147], 0
v_mfma_f32_16x16x32_bf16 v[228:231], v[68:71], a[144:147], 0
v_mfma_f32_16x16x32_bf16 v[224:227], v[72:75], a[148:151], v[224:227]
v_mfma_f32_16x16x32_bf16 v[228:231], v[76:79], a[148:151], v[228:231]
v_mfma_f32_16x16x32_bf16 v[224:227], v[80:83], a[152:155], v[224:227]
buffer_load_dword v24, v22, s[4:7], 0 offen sc1
v_mfma_f32_16x16x32_bf16 v[228:231], v[84:87], a[152:155], v[228:231]
v_cvt_pk_bf16_f32 v52, v216, v217
v_cvt_pk_bf16_f32 v53, v218, v219
v_mfma_f32_16x16x32_bf16 v[224:227], v[88:91], a[156:159], v[224:227]
s_waitcnt vmcnt(11)
s_barrier
v_mfma_f32_16x16x32_bf16 v[228:231], v[92:95], a[156:159], v[228:231]
buffer_store_dword v27, v45, s[4:7], s79 offen
v_mfma_f32_16x16x32_bf16 v[224:227], v[96:99], a[160:163], v[224:227]
buffer_store_dword v27, v44, s[4:7], s79 offen sc1
v_mfma_f32_16x16x32_bf16 v[228:231], v[100:103], a[160:163], v[228:231]
v_cvt_pk_bf16_f32 v54, v220, v221
v_cvt_pk_bf16_f32 v55, v222, v223
v_mfma_f32_16x16x32_bf16 v[224:227], v[104:107], a[164:167], v[224:227]
buffer_store_dwordx4 v[52:55], v20, s[4:7], s87 offen sc1
v_mfma_f32_16x16x32_bf16 v[228:231], v[108:111], a[164:167], v[228:231]
v_mfma_f32_16x16x32_bf16 v[224:227], v[112:115], a[168:171], v[224:227]
v_mfma_f32_16x16x32_bf16 v[228:231], v[116:119], a[168:171], v[228:231]
v_mfma_f32_16x16x32_bf16 v[224:227], v[120:123], a[172:175], v[224:227]
v_mfma_f32_16x16x32_bf16 v[228:231], v[124:127], a[172:175], v[228:231]
v_mfma_f32_16x16x32_bf16 v[224:227], v[128:131], a[176:179], v[224:227]
v_mfma_f32_16x16x32_bf16 v[228:231], v[132:135], a[176:179], v[228:231]
v_mfma_f32_16x16x32_bf16 v[224:227], v[136:139], a[180:183], v[224:227]
v_mfma_f32_16x16x32_bf16 v[228:231], v[140:143], a[180:183], v[228:231]
v_mfma_f32_16x16x32_bf16 v[224:227], v[144:147], a[184:187], v[224:227]
v_mfma_f32_16x16x32_bf16 v[228:231], v[148:151], a[184:187], v[228:231]
v_mfma_f32_16x16x32_bf16 v[224:227], v[152:155], a[188:191], v[224:227]
v_mfma_f32_16x16x32_bf16 v[228:231], v[156:159], a[188:191], v[228:231]
v_mfma_f32_16x16x32_bf16 v[224:227], v[160:163], a[192:195], v[224:227]
s_waitcnt vmcnt(12)
s_barrier
v_mfma_f32_16x16x32_bf16 v[228:231], v[164:167], a[192:195], v[228:231]
v_mfma_f32_16x16x32_bf16 v[224:227], v[168:171], a[196:199], v[224:227]
s_cmp_eq_u32 s94, 0
s_cbranch_scc1 g_slow_30
v_mfma_f32_16x16x32_bf16 v[228:231], v[172:175], a[196:199], v[228:231]
ds_read_b128 v[64:67], v31 offset:0
v_mfma_f32_16x16x32_bf16 v[224:227], v[176:179], a[200:203], v[224:227]
ds_read_b128 v[68:71], v31 offset:9216
v_mfma_f32_16x16x32_bf16 v[228:231], v[180:183], a[200:203], v[228:231]
ds_read_b128 v[72:75], v31 offset:18432
v_mfma_f32_16x16x32_bf16 v[224:227], v[184:187], a[204:207], v[224:227]
ds_read_b128 v[76:79], v31 offset:27648
v_mfma_f32_16x16x32_bf16 v[228:231], v[188:191], a[204:207], v[228:231]
ds_read_b128 v[80:83], v31 offset:1024
v_mfma_f32_16x16x32_bf16 v[224:227], v[192:195], a[208:211], v[224:227]
ds_read_b128 v[84:87], v31 offset:10240
v_mfma_f32_16x16x32_bf16 v[228:231], v[196:199], a[208:211], v[228:231]
ds_read_b128 v[88:91], v31 offset:19456
v_mfma_f32_16x16x32_bf16 v[224:227], v[200:203], a[212:215], v[224:227]
ds_read_b128 v[92:95], v31 offset:28672
v_mfma_f32_16x16x32_bf16 v[228:231], v[204:207], a[212:215], v[228:231]
s_waitcnt vmcnt(9)
s_barrier
g_body_19:
s_waitcnt lgkmcnt(4)
v_mfma_f32_16x16x32_bf16 v[208:211], v[64:67], a[0:3], 0
ds_read_b128 v[96:99], v31 offset:2048
v_mfma_f32_16x16x32_bf16 v[212:215], v[68:71], a[0:3], 0
ds_read_b128 v[100:103], v31 offset:11264
v_mfma_f32_16x16x32_bf16 v[216:219], v[64:67], a[72:75], 0
v_mfma_f32_16x16x32_bf16 v[208:211], v[72:75], a[4:7], v[208:211]
ds_read_b128 v[104:107], v31 offset:20480
v_cvt_pk_bf16_f32 v56, v224, v225
v_mfma_f32_16x16x32_bf16 v[212:215], v[76:79], a[4:7], v[212:215]
ds_read_b128 v[108:111], v31 offset:29696
v_cvt_pk_bf16_f32 v57, v226, v227
v_mfma_f32_16x16x32_bf16 v[220:223], v[68:71], a[72:75], 0
v_cvt_pk_bf16_f32 v58, v228, v229
s_waitcnt lgkmcnt(4)
v_mfma_f32_16x16x32_bf16 v[208:211], v[80:83], a[8:11], v[208:211]
ds_read_b128 v[112:115], v31 offset:3072
v_cvt_pk_bf16_f32 v59, v230, v231
v_mfma_f32_16x16x32_bf16 v[212:215], v[84:87], a[8:11], v[212:215]
ds_read_b128 v[116:119], v31 offset:12288
v_mfma_f32_16x16x32_bf16 v[216:219], v[72:75], a[76:79], v[216:219]
buffer_store_dwordx4 v[56:59], v21, s[4:7], s87 offen sc1
v_mfma_f32_16x16x32_bf16 v[208:211], v[88:91], a[12:15], v[208:211]
ds_read_b128 v[120:123], v31 offset:21504
v_mfma_f32_16x16x32_bf16 v[212:215], v[92:95], a[12:15], v[212:215]
ds_read_b128 v[124:127], v31 offset:30720
v_mfma_f32_16x16x32_bf16 v[220:223], v[76:79], a[76:79], v[220:223]
s_waitcnt lgkmcnt(4)
v_mfma_f32_16x16x32_bf16 v[208:211], v[96:99], a[16:19], v[208:211]
ds_read_b128 v[128:131], v31 offset:4096
v_mfma_f32_16x16x32_bf16 v[212:215], v[100:103], a[16:19], v[212:215]
ds_read_b128 v[132:135], v31 offset:13312
v_mfma_f32_16x16x32_bf16 v[216:219], v[80:83], a[80:83], v[216:219]
v_mfma_f32_16x16x32_bf16 v[208:211], v[104:107], a[20:23], v[208:211]
ds_read_b128 v[136:139], v31 offset:22528
v_mfma_f32_16x16x32_bf16 v[212:215], v[108:111], a[20:23], v[212:215]
ds_read_b128 v[140:143], v31 offset:31744
v_mfma_f32_16x16x32_bf16 v[220:223], v[84:87], a[80:83], v[220:223]
s_waitcnt vmcnt(5)
s_barrier
s_waitcnt lgkmcnt(4)
v_mfma_f32_16x16x32_bf16 v[208:211], v[112:115], a[24:27], v[208:211]
ds_read_b128 v[144:147], v31 offset:5120
v_mov_b32 v27, s84
v_mfma_f32_16x16x32_bf16 v[212:215], v[116:119], a[24:27], v[212:215]
ds_read_b128 v[148:151], v31 offset:14336
v_mfma_f32_16x16x32_bf16 v[216:219], v[88:91], a[84:87], v[216:219]
v_mfma_f32_16x16x32_bf16 v[208:211], v[120:123], a[28:31], v[208:211]
ds_read_b128 v[152:155], v31 offset:23552
v_mfma_f32_16x16x32_bf16 v[212:215], v[124:127], a[28:31], v[212:215]
ds_read_b128 v[156:159], v31 offset:32768
v_mfma_f32_16x16x32_bf16 v[220:223], v[92:95], a[84:87], v[220:223]
s_waitcnt lgkmcnt(4)
v_mfma_f32_16x16x32_bf16 v[208:211], v[128:131], a[32:35], v[208:211]
ds_read_b128 v[160:163], v31 offset:6144
v_mfma_f32_16x16x32_bf16 v[212:215], v[132:135], a[32:35], v[212:215]
ds_read_b128 v[164:167], v31 offset:15360
v_mfma_f32_16x16x32_bf16 v[216:219], v[96:99], a[88:91], v[216:219]
v_mfma_f32_16x16x32_bf16 v[208:211], v[136:139], a[36:39], v[208:211]
ds_read_b128 v[168:171], v31 offset:24576
v_mfma_f32_16x16x32_bf16 v[212:215], v[140:143], a[36:39], v[212:215]
ds_read_b128 v[172:175], v31 offset:33792
v_mfma_f32_16x16x32_bf16 v[220:223], v[100:103], a[88:91], v[220:223]
s_waitcnt lgkmcnt(4)
v_mfma_f32_16x16x32_bf16 v[208:211], v[144:147], a[40:43], v[208:211]
ds_read_b128 v[176:179], v31 offset:7168
v_mfma_f32_16x16x32_bf16 v[212:215], v[148:151], a[40:43], v[212:215]
ds_read_b128 v[180:183], v31 offset:16384
s_waitcnt vmcnt(4)
ds_write_b32 v18, v24
v_mfma_f32_16x16x32_bf16 v[216:219], v[104:107], a[92:95], v[216:219]
v_mfma_f32_16x16x32_bf16 v[208:211], v[152:155], a[44:47], v[208:211]
ds_read_b128 v[184:187], v31 offset:25600
v_mfma_f32_16x16x32_bf16 v[212:215], v[156:159], a[44:47], v[212:215]
ds_read_b128 v[188:191], v31 offset:34816
s_waitcnt lgkmcnt(2)
s_barrier
v_mfma_f32_16x16x32_bf16 v[220:223], v[108:111], a[92:95], v[220:223]
ds_read_b32 v33, v32
v_mfma_f32_16x16x32_bf16 v[208:211], v[160:163], a[48:51], v[208:211]
ds_read_b128 v[192:195], v31 offset:8192
v_mfma_f32_16x16x32_bf16 v[212:215], v[164:167], a[48:51], v[212:215]
ds_read_b128 v[196:199], v31 offset:17408
v_mfma_f32_16x16x32_bf16 v[216:219], v[112:115], a[96:99], v[216:219]
s_waitcnt lgkmcnt(2)
v_cmp_gt_u32 vcc, s52, v33
v_mfma_f32_16x16x32_bf16 v[208:211], v[168:171], a[52:55], v[208:211]
ds_read_b128 v[200:203], v31 offset:26624
v_cmp_gt_u32 s[58:59], s54, v33
v_mfma_f32_16x16x32_bf16 v[212:215], v[172:175], a[52:55], v[212:215]
ds_read_b128 v[204:207], v31 offset:35840
s_and_b32 vcc_lo, vcc_lo, s56
s_cselect_b32 s70, 0, 1
v_mfma_f32_16x16x32_bf16 v[220:223], v[116:119], a[96:99], v[220:223]
v_mfma_f32_16x16x32_bf16 v[208:211], v[176:179], a[56:59], v[208:211]
s_and_b32 s59, s59, s56
s_cselect_b32 s71, 0, s95
v_mfma_f32_16x16x32_bf16 v[212:215], v[180:183], a[56:59], v[212:215]
s_or_b32 s76, s70, s71
s_cselect_b32 s10, 268435456, 0
v_mfma_f32_16x16x32_bf16 v[216:219], v[120:123], a[100:103], v[216:219]
s_cmp_lg_u32 s70, 0
s_cselect_b64 s[72:73], s[52:53], s[54:55]
s_cselect_b64 s[58:59], s[44:45], s[46:47]
v_mfma_f32_16x16x32_bf16 v[208:211], v[184:187], a[60:63], v[208:211]
s_mul_i32 s74, s72, s20
s_add_u32 s74, s74, s58
v_mfma_f32_16x16x32_bf16 v[212:215], v[188:191], a[60:63], v[212:215]
s_add_u32 m0, s48, 0
s_mul_i32 s75, s72, s21
s_add_u32 s75, s75, s59
v_mfma_f32_16x16x32_bf16 v[220:223], v[124:127], a[100:103], v[220:223]
buffer_load_dwordx4 v8, s[8:11], s74 offen offset:0 sc1 lds
s_waitcnt lgkmcnt(0)
v_mfma_f32_16x16x32_bf16 v[208:211], v[192:195], a[64:67], v[208:211]
s_andn2_b32 s71, s71, s70
s_add_u32 s52, s52, s70
s_add_u32 s54, s54, s71
v_mfma_f32_16x16x32_bf16 v[212:215], v[196:199], a[64:67], v[212:215]
s_mov_b32 s77, s76
v_mfma_f32_16x16x32_bf16 v[216:219], v[128:131], a[104:107], v[216:219]
buffer_load_dwordx4 v9, s[8:11], s74 offen offset:1024 sc1 lds
v_mfma_f32_16x16x32_bf16 v[208:211], v[200:203], a[68:71], v[208:211]
v_mfma_f32_16x16x32_bf16 v[212:215], v[204:207], a[68:71], v[212:215]
v_mfma_f32_16x16x32_bf16 v[220:223], v[132:135], a[104:107], v[220:223]
buffer_load_dwordx4 v10, s[8:11], s74 offen offset:2048 sc1 lds
v_mfma_f32_16x16x32_bf16 v[216:219], v[136:139], a[108:111], v[216:219]
v_mfma_f32_16x16x32_bf16 v[220:223], v[140:143], a[108:111], v[220:223]
v_mfma_f32_16x16x32_bf16 v[216:219], v[144:147], a[112:115], v[216:219]
buffer_load_dwordx4 v11, s[8:11], s74 offen offset:3072 sc1 lds
v_mfma_f32_16x16x32_bf16 v[220:223], v[148:151], a[112:115], v[220:223]
v_mfma_f32_16x16x32_bf16 v[216:219], v[152:155], a[116:119], v[216:219]
s_add_u32 m0, s48, 4096
v_cvt_pk_bf16_f32 v48, v208, v209
v_mfma_f32_16x16x32_bf16 v[220:223], v[156:159], a[116:119], v[220:223]
buffer_load_dwordx4 v12, s[8:11], s74 offen offset:0 sc1 lds
v_mfma_f32_16x16x32_bf16 v[216:219], v[160:163], a[120:123], v[216:219]
v_cvt_pk_bf16_f32 v49, v210, v211
v_cvt_pk_bf16_f32 v50, v212, v213
v_mfma_f32_16x16x32_bf16 v[220:223], v[164:167], a[120:123], v[220:223]
v_cvt_pk_bf16_f32 v51, v214, v215
v_mfma_f32_16x16x32_bf16 v[216:219], v[168:171], a[124:127], v[216:219]
buffer_load_dwordx4 v13, s[8:11], s74 offen offset:1024 sc1 lds
v_mfma_f32_16x16x32_bf16 v[220:223], v[172:175], a[124:127], v[220:223]
buffer_store_dwordx4 v[48:51], v19, s[4:7], s93 offen sc1
v_mfma_f32_16x16x32_bf16 v[216:219], v[176:179], a[128:131], v[216:219]
v_mfma_f32_16x16x32_bf16 v[220:223], v[180:183], a[128:131], v[220:223]
buffer_load_dwordx4 v14, s[8:11], s74 offen offset:2048 sc1 lds
v_mfma_f32_16x16x32_bf16 v[216:219], v[184:187], a[132:135], v[216:219]
v_mfma_f32_16x16x32_bf16 v[220:223], v[188:191], a[132:135], v[220:223]
v_mfma_f32_16x16x32_bf16 v[216:219], v[192:195], a[136:139], v[216:219]
buffer_load_dwordx4 v15, s[8:11], s74 offen offset:3072 sc1 lds
v_mfma_f32_16x16x32_bf16 v[220:223], v[196:199], a[136:139], v[220:223]
v_mfma_f32_16x16x32_bf16 v[216:219], v[200:203], a[140:143], v[216:219]
s_add_u32 m0, s48, 8192
v_mfma_f32_16x16x32_bf16 v[220:223], v[204:207], a[140:143], v[220:223]
buffer_load_dwordx4 v16, s[8:11], s74 offen offset:0 sc1 lds
v_mfma_f32_16x16x32_bf16 v[224:227], v[64:67], a[144:147], 0
v_mfma_f32_16x16x32_bf16 v[228:231], v[68:71], a[144:147], 0
v_mfma_f32_16x16x32_bf16 v[224:227], v[72:75], a[148:151], v[224:227]
v_mfma_f32_16x16x32_bf16 v[228:231], v[76:79], a[148:151], v[228:231]
v_mfma_f32_16x16x32_bf16 v[224:227], v[80:83], a[152:155], v[224:227]
buffer_load_dword v24, v22, s[4:7], 0 offen sc1
v_mfma_f32_16x16x32_bf16 v[228:231], v[84:87], a[152:155], v[228:231]
v_cvt_pk_bf16_f32 v52, v216, v217
v_cvt_pk_bf16_f32 v53, v218, v219
v_mfma_f32_16x16x32_bf16 v[224:227], v[88:91], a[156:159], v[224:227]
s_waitcnt vmcnt(11)
s_barrier
v_mfma_f32_16x16x32_bf16 v[228:231], v[92:95], a[156:159], v[228:231]
buffer_store_dword v27, v45, s[4:7], s85 offen
v_mfma_f32_16x16x32_bf16 v[224:227], v[96:99], a[160:163], v[224:227]
buffer_store_dword v27, v44, s[4:7], s85 offen sc1
v_mfma_f32_16x16x32_bf16 v[228:231], v[100:103], a[160:163], v[228:231]
v_cvt_pk_bf16_f32 v54, v220, v221
v_cvt_pk_bf16_f32 v55, v222, v223
v_mfma_f32_16x16x32_bf16 v[224:227], v[104:107], a[164:167], v[224:227]
buffer_store_dwordx4 v[52:55], v20, s[4:7], s93 offen sc1
v_mfma_f32_16x16x32_bf16 v[228:231], v[108:111], a[164:167], v[228:231]
v_mfma_f32_16x16x32_bf16 v[224:227], v[112:115], a[168:171], v[224:227]
v_mfma_f32_16x16x32_bf16 v[228:231], v[116:119], a[168:171], v[228:231]
v_mfma_f32_16x16x32_bf16 v[224:227], v[120:123], a[172:175], v[224:227]
v_mfma_f32_16x16x32_bf16 v[228:231], v[124:127], a[172:175], v[228:231]
v_mfma_f32_16x16x32_bf16 v[224:227], v[128:131], a[176:179], v[224:227]
v_mfma_f32_16x16x32_bf16 v[228:231], v[132:135], a[176:179], v[228:231]
v_mfma_f32_16x16x32_bf16 v[224:227], v[136:139], a[180:183], v[224:227]
v_mfma_f32_16x16x32_bf16 v[228:231], v[140:143], a[180:183], v[228:231]
v_mfma_f32_16x16x32_bf16 v[224:227], v[144:147], a[184:187], v[224:227]
v_mfma_f32_16x16x32_bf16 v[228:231], v[148:151], a[184:187], v[228:231]
v_mfma_f32_16x16x32_bf16 v[224:227], v[152:155], a[188:191], v[224:227]
v_mfma_f32_16x16x32_bf16 v[228:231], v[156:159], a[188:191], v[228:231]
v_mfma_f32_16x16x32_bf16 v[224:227], v[160:163], a[192:195], v[224:227]
s_waitcnt vmcnt(12)
s_barrier
v_mfma_f32_16x16x32_bf16 v[228:231], v[164:167], a[192:195], v[228:231]
v_mfma_f32_16x16x32_bf16 v[224:227], v[168:171], a[196:199], v[224:227]
s_cmp_eq_u32 s76, 0
s_cbranch_scc1 g_slow_31
v_mfma_f32_16x16x32_bf16 v[228:231], v[172:175], a[196:199], v[228:231]
ds_read_b128 v[64:67], v28 offset:0
v_mfma_f32_16x16x32_bf16 v[224:227], v[176:179], a[200:203], v[224:227]
ds_read_b128 v[68:71], v28 offset:9216
v_mfma_f32_16x16x32_bf16 v[228:231], v[180:183], a[200:203], v[228:231]
ds_read_b128 v[72:75], v28 offset:18432
v_mfma_f32_16x16x32_bf16 v[224:227], v[184:187], a[204:207], v[224:227]
ds_read_b128 v[76:79], v28 offset:27648
v_mfma_f32_16x16x32_bf16 v[228:231], v[188:191], a[204:207], v[228:231]
ds_read_b128 v[80:83], v28 offset:1024
v_mfma_f32_16x16x32_bf16 v[224:227], v[192:195], a[208:211], v[224:227]
ds_read_b128 v[84:87], v28 offset:10240
v_mfma_f32_16x16x32_bf16 v[228:231], v[196:199], a[208:211], v[228:231]
ds_read_b128 v[88:91], v28 offset:19456
v_mfma_f32_16x16x32_bf16 v[224:227], v[200:203], a[212:215], v[224:227]
ds_read_b128 v[92:95], v28 offset:28672
v_mfma_f32_16x16x32_bf16 v[228:231], v[204:207], a[212:215], v[228:231]
s_waitcnt vmcnt(9)
s_barrier
s_branch g_body_16
g_slow_28:
v_mfma_f32_16x16x32_bf16 v[228:231], v[172:175], a[196:199], v[228:231]
v_mfma_f32_16x16x32_bf16 v[224:227], v[176:179], a[200:203], v[224:227]
v_mfma_f32_16x16x32_bf16 v[228:231], v[180:183], a[200:203], v[228:231]
v_mfma_f32_16x16x32_bf16 v[224:227], v[184:187], a[204:207], v[224:227]
v_mfma_f32_16x16x32_bf16 v[228:231], v[188:191], a[204:207], v[228:231]
v_mfma_f32_16x16x32_bf16 v[224:227], v[192:195], a[208:211], v[224:227]
v_mfma_f32_16x16x32_bf16 v[228:231], v[196:199], a[208:211], v[228:231]
v_mfma_f32_16x16x32_bf16 v[224:227], v[200:203], a[212:215], v[224:227]
v_mfma_f32_16x16x32_bf16 v[228:231], v[204:207], a[212:215], v[228:231]
s_nop 6
v_cvt_pk_bf16_f32 v56, v224, v225
v_cvt_pk_bf16_f32 v57, v226, v227
v_cvt_pk_bf16_f32 v58, v228, v229
v_cvt_pk_bf16_f32 v59, v230, v231
buffer_store_dwordx4 v[56:59], v21, s[4:7], s75 offen sc1
s_mov_b32 s75, 1879048192
s_waitcnt vmcnt(4)
ds_write_b32 v18, v24
s_waitcnt lgkmcnt(0)
s_barrier
ds_read_b32 v33, v32
s_waitcnt lgkmcnt(0)
v_cmp_gt_u32 vcc, s52, v33
v_cmp_gt_u32 s[58:59], s54, v33
s_and_b32 vcc_lo, vcc_lo, s56
s_cselect_b32 s70, 0, 1
s_and_b32 s59, s59, s56
s_cselect_b32 s71, 0, s77
s_or_b32 s82, s70, s71
s_cselect_b32 s10, 268435456, 0
s_cmp_lg_u32 s70, 0
s_cselect_b64 s[78:79], s[52:53], s[54:55]
s_cselect_b64 s[58:59], s[44:45], s[46:47]
s_mul_i32 s80, s78, s20
s_add_u32 s80, s80, s58
s_mul_i32 s81, s78, s21
s_add_u32 s81, s81, s59
s_andn2_b32 s71, s71, s70
s_add_u32 s52, s52, s70
s_add_u32 s54, s54, s71
s_mov_b32 s83, s82
s_cmp_lg_u32 s82, 0
s_cbranch_scc1 g_go_32
v_mov_b32 v27, s72
s_waitcnt vmcnt(0)
s_barrier
s_add_u32 s70, s52, s54
s_cmp_eq_u32 s70, 130
s_cbranch_scc1 g_fin_20
s_cmp_lg_u32 s3, 0
s_cbranch_scc1 sp_ok_34_j
s_mov_b32 s23, 0
buffer_load_dword v33, v22, s[4:7], 0 offen sc1
buffer_store_dword v27, v45, s[4:7], s73 offen
buffer_store_dword v27, v44, s[4:7], s73 offen sc1
s_waitcnt vmcnt(2)
s_branch sp_loop_33_e
sp_loop_33:
buffer_load_dword v33, v22, s[4:7], 0 offen sc1
s_add_u32 s23, s23, 1
s_cmp_gt_u32 s23, 150000
s_cbranch_scc1 sp_bad_35
s_waitcnt vmcnt(0)
sp_loop_33_e:
v_cmp_gt_u32 vcc, s52, v33
v_cmp_gt_u32 s[58:59], s54, v33
s_and_b32 vcc_lo, vcc_lo, s56
s_cbranch_scc0 sp_ok_34
s_cmp_gt_u32 s23, 4
s_cselect_b32 s70, 0, s56
s_cmp_lg_u32 s77, 0
s_cselect_b32 s70, 0, s70
s_or_b32 s59, s59, s70
s_and_b32 s59, s59, s56
s_cbranch_scc0 sp_ok_34
s_sleep 1
s_branch sp_loop_33
sp_bad_35:
s_mov_b32 s98, 1025
s_branch L_fail
sp_ok_34:
ds_write_b32 v18, v33
s_waitcnt lgkmcnt(0)
sp_ok_34_j:
s_barrier
ds_read_b32 v33, v32
s_waitcnt lgkmcnt(0)
s_mov_b32 s73, 1879048192
v_cmp_gt_u32 vcc, s52, v33
v_cmp_gt_u32 s[58:59], s54, v33
s_and_b32 vcc_lo, vcc_lo, s56
s_cselect_b32 s70, 0, 1
s_and_b32 s59, s59, s56
s_cselect_b32 s71, 0, 1
s_or_b32 s82, s70, s71
s_cselect_b32 s10, 268435456, 0
s_cmp_lg_u32 s70, 0
s_cselect_b64 s[78:79], s[52:53], s[54:55]
s_cselect_b64 s[58:59], s[44:45], s[46:47]
s_mul_i32 s80, s78, s20
s_add_u32 s80, s80, s58
s_mul_i32 s81, s78, s21
s_add_u32 s81, s81, s59
s_andn2_b32 s71, s71, s70
s_add_u32 s52, s52, s70
s_add_u32 s54, s54, s71
s_mov_b32 s83, s82
g_go_32:
s_add_u32 m0, s49, 0
s_nop 0
buffer_load_dwordx4 v8, s[4:7], s80 offen offset:0 sc1 lds
buffer_load_dwordx4 v9, s[4:7], s80 offen offset:1024 sc1 lds
buffer_load_dwordx4 v10, s[4:7], s80 offen offset:2048 sc1 lds
buffer_load_dwordx4 v11, s[4:7], s80 offen offset:3072 sc1 lds
s_add_u32 m0, s49, 4096
s_nop 0
buffer_load_dwordx4 v12, s[4:7], s80 offen offset:0 sc1 lds
buffer_load_dwordx4 v13, s[4:7], s80 offen offset:1024 sc1 lds
buffer_load_dwordx4 v14, s[4:7], s80 offen offset:2048 sc1 lds
buffer_load_dwordx4 v15, s[4:7], s80 offen offset:3072 sc1 lds
s_add_u32 m0, s49, 8192
s_nop 0
buffer_load_dwordx4 v16, s[4:7], s80 offen offset:0 sc1 lds
buffer_load_dword v24, v22, s[4:7], 0 offen sc1
buffer_store_dword v27, v34, s[4:7], 0 offen
v_mov_b32 v27, s72
s_waitcnt vmcnt(9)
s_barrier
buffer_store_dword v27, v45, s[4:7], s73 offen
buffer_store_dword v27, v44, s[4:7], s73 offen sc1
s_mov_b32 s73, 1879048192
ds_read_b128 v[64:67], v29 offset:0
ds_read_b128 v[68:71], v29 offset:9216
ds_read_b128 v[72:75], v29 offset:18432
ds_read_b128 v[76:79], v29 offset:27648
ds_read_b128 v[80:83], v29 offset:1024
ds_read_b128 v[84:87], v29 offset:10240
ds_read_b128 v[88:91], v29 offset:19456
ds_read_b128 v[92:95], v29 offset:28672
s_waitcnt vmcnt(8)
s_barrier
s_branch g_body_17
g_slow_29:
v_mfma_f32_16x16x32_bf16 v[228:231], v[172:175], a[196:199], v[228:231]
v_mfma_f32_16x16x32_bf16 v[224:227], v[176:179], a[200:203], v[224:227]
v_mfma_f32_16x16x32_bf16 v[228:231], v[180:183], a[200:203], v[228:231]
v_mfma_f32_16x16x32_bf16 v[224:227], v[184:187], a[204:207], v[224:227]
v_mfma_f32_16x16x32_bf16 v[228:231], v[188:191], a[204:207], v[228:231]
v_mfma_f32_16x16x32_bf16 v[224:227], v[192:195], a[208:211], v[224:227]
v_mfma_f32_16x16x32_bf16 v[228:231], v[196:199], a[208:211], v[228:231]
v_mfma_f32_16x16x32_bf16 v[224:227], v[200:203], a[212:215], v[224:227]
v_mfma_f32_16x16x32_bf16 v[228:231], v[204:207], a[212:215], v[228:231]
s_nop 6
v_cvt_pk_bf16_f32 v56, v224, v225
v_cvt_pk_bf16_f32 v57, v226, v227
v_cvt_pk_bf16_f32 v58, v228, v229
v_cvt_pk_bf16_f32 v59, v230, v231
buffer_store_dwordx4 v[56:59], v21, s[4:7], s81 offen sc1
s_mov_b32 s81, 1879048192
s_waitcnt vmcnt(4)
ds_write_b32 v18, v24
s_waitcnt lgkmcnt(0)
s_barrier
ds_read_b32 v33, v32
s_waitcnt lgkmcnt(0)
v_cmp_gt_u32 vcc, s52, v33
v_cmp_gt_u32 s[58:59], s54, v33
s_and_b32 vcc_lo, vcc_lo, s56
s_cselect_b32 s70, 0, 1
s_and_b32 s59, s59, s56
s_cselect_b32 s71, 0, s83
s_or_b32 s88, s70, s71
s_cselect_b32 s10, 268435456, 0
s_cmp_lg_u32 s70, 0
s_cselect_b64 s[84:85], s[52:53], s[54:55]
s_cselect_b64 s[58:59], s[44:45], s[46:47]
s_mul_i32 s86, s84, s20
s_add_u32 s86, s86, s58
s_mul_i32 s87, s84, s21
s_add_u32 s87, s87, s59
s_andn2_b32 s71, s71, s70
s_add_u32 s52, s52, s70
s_add_u32 s54, s54, s71
s_mov_b32 s89, s88
s_cmp_lg_u32 s88, 0
s_cbranch_scc1 g_go_36
v_mov_b32 v27, s78
s_waitcnt vmcnt(0)
s_barrier
s_add_u32 s70, s52, s54
s_cmp_eq_u32 s70, 130
s_cbranch_scc1 g_fin_20
s_cmp_lg_u32 s3, 0
s_cbranch_scc1 sp_ok_38_j
s_mov_b32 s23, 0
buffer_load_dword v33, v22, s[4:7], 0 offen sc1
buffer_store_dword v27, v45, s[4:7], s79 offen
buffer_store_dword v27, v44, s[4:7], s79 offen sc1
s_waitcnt vmcnt(2)
s_branch sp_loop_37_e
sp_loop_37:
buffer_load_dword v33, v22, s[4:7], 0 offen sc1
s_add_u32 s23, s23, 1
s_cmp_gt_u32 s23, 150000
s_cbranch_scc1 sp_bad_39
s_waitcnt vmcnt(0)
sp_loop_37_e:
v_cmp_gt_u32 vcc, s52, v33
v_cmp_gt_u32 s[58:59], s54, v33
s_and_b32 vcc_lo, vcc_lo, s56
s_cbranch_scc0 sp_ok_38
s_cmp_gt_u32 s23, 4
s_cselect_b32 s70, 0, s56
s_cmp_lg_u32 s83, 0
s_cselect_b32 s70, 0, s70
s_or_b32 s59, s59, s70
s_and_b32 s59, s59, s56
s_cbranch_scc0 sp_ok_38
s_sleep 1
s_branch sp_loop_37
sp_bad_39:
s_mov_b32 s98, 1025
s_branch L_fail
sp_ok_38:
ds_write_b32 v18, v33
s_waitcnt lgkmcnt(0)
sp_ok_38_j:
s_barrier
ds_read_b32 v33, v32
s_waitcnt lgkmcnt(0)
s_mov_b32 s79, 1879048192
v_cmp_gt_u32 vcc, s52, v33
v_cmp_gt_u32 s[58:59], s54, v33
s_and_b32 vcc_lo, vcc_lo, s56
s_cselect_b32 s70, 0, 1
s_and_b32 s59, s59, s56
s_cselect_b32 s71, 0, 1
s_or_b32 s88, s70, s71
s_cselect_b32 s10, 268435456, 0
s_cmp_lg_u32 s70, 0
s_cselect_b64 s[84:85], s[52:53], s[54:55]
s_cselect_b64 s[58:59], s[44:45], s[46:47]
s_mul_i32 s86, s84, s20
s_add_u32 s86, s86, s58
s_mul_i32 s87, s84, s21
s_add_u32 s87, s87, s59
s_andn2_b32 s71, s71, s70
s_add_u32 s52, s52, s70
s_add_u32 s54, s54, s71
s_mov_b32 s89, s88
g_go_36:
s_add_u32 m0, s50, 0
s_nop 0
buffer_load_dwordx4 v8, s[4:7], s86 offen offset:0 sc1 lds
buffer_load_dwordx4 v9, s[4:7], s86 offen offset:1024 sc1 lds
buffer_load_dwordx4 v10, s[4:7], s86 offen offset:2048 sc1 lds
buffer_load_dwordx4 v11, s[4:7], s86 offen offset:3072 sc1 lds
s_add_u32 m0, s50, 4096
s_nop 0
buffer_load_dwordx4 v12, s[4:7], s86 offen offset:0 sc1 lds
buffer_load_dwordx4 v13, s[4:7], s86 offen offset:1024 sc1 lds
buffer_load_dwordx4 v14, s[4:7], s86 offen offset:2048 sc1 lds
buffer_load_dwordx4 v15, s[4:7], s86 offen offset:3072 sc1 lds
s_add_u32 m0, s50, 8192
s_nop 0
buffer_load_dwordx4 v16, s[4:7], s86 offen offset:0 sc1 lds
buffer_load_dword v24, v22, s[4:7], 0 offen sc1
buffer_store_dword v27, v34, s[4:7], 0 offen
v_mov_b32 v27, s78
s_waitcnt vmcnt(9)
s_barrier
buffer_store_dword v27, v45, s[4:7], s79 offen
buffer_store_dword v27, v44, s[4:7], s79 offen sc1
s_mov_b32 s79, 1879048192
ds_read_b128 v[64:67], v30 offset:0
ds_read_b128 v[68:71], v30 offset:9216
ds_read_b128 v[72:75], v30 offset:18432
ds_read_b128 v[76:79], v30 offset:27648
ds_read_b128 v[80:83], v30 offset:1024
ds_read_b128 v[84:87], v30 offset:10240
ds_read_b128 v[88:91], v30 offset:19456
ds_read_b128 v[92:95], v30 offset:28672
s_waitcnt vmcnt(8)
s_barrier
s_branch g_body_18
g_slow_30:
v_mfma_f32_16x16x32_bf16 v[228:231], v[172:175], a[196:199], v[228:231]
v_mfma_f32_16x16x32_bf16 v[224:227], v[176:179], a[200:203], v[224:227]
v_mfma_f32_16x16x32_bf16 v[228:231], v[180:183], a[200:203], v[228:231]
v_mfma_f32_16x16x32_bf16 v[224:227], v[184:187], a[204:207], v[224:227]
v_mfma_f32_16x16x32_bf16 v[228:231], v[188:191], a[204:207], v[228:231]
v_mfma_f32_16x16x32_bf16 v[224:227], v[192:195], a[208:211], v[224:227]
v_mfma_f32_16x16x32_bf16 v[228:231], v[196:199], a[208:211], v[228:231]
v_mfma_f32_16x16x32_bf16 v[224:227], v[200:203], a[212:215], v[224:227]
v_mfma_f32_16x16x32_bf16 v[228:231], v[204:207], a[212:215], v[228:231]
s_nop 6
v_cvt_pk_bf16_f32 v56, v224, v225
v_cvt_pk_bf16_f32 v57, v226, v227
v_cvt_pk_bf16_f32 v58, v228, v229
v_cvt_pk_bf16_f32 v59, v230, v231
buffer_store_dwordx4 v[56:59], v21, s[4:7], s87 offen sc1
s_mov_b32 s87, 1879048192
s_waitcnt vmcnt(4)
ds_write_b32 v18, v24
s_waitcnt lgkmcnt(0)
s_barrier
ds_read_b32 v33, v32
s_waitcnt lgkmcnt(0)
v_cmp_gt_u32 vcc, s52, v33
v_cmp_gt_u32 s[58:59], s54, v33
s_and_b32 vcc_lo, vcc_lo, s56
s_cselect_b32 s70, 0, 1
s_and_b32 s59, s59, s56
s_cselect_b32 s71, 0, s89
s_or_b32 s94, s70, s71
s_cselect_b32 s10, 268435456, 0
s_cmp_lg_u32 s70, 0
s_cselect_b64 s[90:91], s[52:53], s[54:55]
s_cselect_b64 s[58:59], s[44:45], s[46:47]
s_mul_i32 s92, s90, s20
s_add_u32 s92, s92, s58
s_mul_i32 s93, s90, s21
s_add_u32 s93, s93, s59
s_andn2_b32 s71, s71, s70
s_add_u32 s52, s52, s70
s_add_u32 s54, s54, s71
s_mov_b32 s95, s94
s_cmp_lg_u32 s94, 0
s_cbranch_scc1 g_go_40
v_mov_b32 v27, s84
s_waitcnt vmcnt(0)
s_barrier
s_add_u32 s70, s52, s54
s_cmp_eq_u32 s70, 130
s_cbranch_scc1 g_fin_20
s_cmp_lg_u32 s3, 0
s_cbranch_scc1 sp_ok_42_j
s_mov_b32 s23, 0
buffer_load_dword v33, v22, s[4:7], 0 offen sc1
buffer_store_dword v27, v45, s[4:7], s85 offen
buffer_store_dword v27, v44, s[4:7], s85 offen sc1
s_waitcnt vmcnt(2)
s_branch sp_loop_41_e
sp_loop_41:
buffer_load_dword v33, v22, s[4:7], 0 offen sc1
s_add_u32 s23, s23, 1
s_cmp_gt_u32 s23, 150000
s_cbranch_scc1 sp_bad_43
s_waitcnt vmcnt(0)
sp_loop_41_e:
v_cmp_gt_u32 vcc, s52, v33
v_cmp_gt_u32 s[58:59], s54, v33
s_and_b32 vcc_lo, vcc_lo, s56
s_cbranch_scc0 sp_ok_42
s_cmp_gt_u32 s23, 4
s_cselect_b32 s70, 0, s56
s_cmp_lg_u32 s89, 0
s_cselect_b32 s70, 0, s70
s_or_b32 s59, s59, s70
s_and_b32 s59, s59, s56
s_cbranch_scc0 sp_ok_42
s_sleep 1
s_branch sp_loop_41
sp_bad_43:
s_mov_b32 s98, 1025
s_branch L_fail
sp_ok_42:
ds_write_b32 v18, v33
s_waitcnt lgkmcnt(0)
sp_ok_42_j:
s_barrier
ds_read_b32 v33, v32
s_waitcnt lgkmcnt(0)
s_mov_b32 s85, 1879048192
v_cmp_gt_u32 vcc, s52, v33
v_cmp_gt_u32 s[58:59], s54, v33
s_and_b32 vcc_lo, vcc_lo, s56
s_cselect_b32 s70, 0, 1
s_and_b32 s59, s59, s56
s_cselect_b32 s71, 0, 1
s_or_b32 s94, s70, s71
s_cselect_b32 s10, 268435456, 0
s_cmp_lg_u32 s70, 0
s_cselect_b64 s[90:91], s[52:53], s[54:55]
s_cselect_b64 s[58:59], s[44:45], s[46:47]
s_mul_i32 s92, s90, s20
s_add_u32 s92, s92, s58
s_mul_i32 s93, s90, s21
s_add_u32 s93, s93, s59
s_andn2_b32 s71, s71, s70
s_add_u32 s52, s52, s70
s_add_u32 s54, s54, s71
s_mov_b32 s95, s94
g_go_40:
s_add_u32 m0, s51, 0
s_nop 0
buffer_load_dwordx4 v8, s[4:7], s92 offen offset:0 sc1 lds
buffer_load_dwordx4 v9, s[4:7], s92 offen offset:1024 sc1 lds
buffer_load_dwordx4 v10, s[4:7], s92 offen offset:2048 sc1 lds
buffer_load_dwordx4 v11, s[4:7], s92 offen offset:3072 sc1 lds
s_add_u32 m0, s51, 4096
s_nop 0
buffer_load_dwordx4 v12, s[4:7], s92 offen offset:0 sc1 lds
buffer_load_dwordx4 v13, s[4:7], s92 offen offset:1024 sc1 lds
buffer_load_dwordx4 v14, s[4:7], s92 offen offset:2048 sc1 lds
buffer_load_dwordx4 v15, s[4:7], s92 offen offset:3072 sc1 lds
s_add_u32 m0, s51, 8192
s_nop 0
buffer_load_dwordx4 v16, s[4:7], s92 offen offset:0 sc1 lds
buffer_load_dword v24, v22, s[4:7], 0 offen sc1
buffer_store_dword v27, v34, s[4:7], 0 offen
v_mov_b32 v27, s84
s_waitcnt vmcnt(9)
s_barrier
buffer_store_dword v27, v45, s[4:7], s85 offen
buffer_store_dword v27, v44, s[4:7], s85 offen sc1
s_mov_b32 s85, 1879048192
ds_read_b128 v[64:67], v31 offset:0
ds_read_b128 v[68:71], v31 offset:9216
ds_read_b128 v[72:75], v31 offset:18432
ds_read_b128 v[76:79], v31 offset:27648
ds_read_b128 v[80:83], v31 offset:1024
ds_read_b128 v[84:87], v31 offset:10240
ds_read_b128 v[88:91], v31 offset:19456
ds_read_b128 v[92:95], v31 offset:28672
s_waitcnt vmcnt(8)
s_barrier
s_branch g_body_19
g_slow_31:
v_mfma_f32_16x16x32_bf16 v[228:231], v[172:175], a[196:199], v[228:231]
v_mfma_f32_16x16x32_bf16 v[224:227], v[176:179], a[200:203], v[224:227]
v_mfma_f32_16x16x32_bf16 v[228:231], v[180:183], a[200:203], v[228:231]
v_mfma_f32_16x16x32_bf16 v[224:227], v[184:187], a[204:207], v[224:227]
v_mfma_f32_16x16x32_bf16 v[228:231], v[188:191], a[204:207], v[228:231]
v_mfma_f32_16x16x32_bf16 v[224:227], v[192:195], a[208:211], v[224:227]
v_mfma_f32_16x16x32_bf16 v[228:231], v[196:199], a[208:211], v[228:231]
v_mfma_f32_16x16x32_bf16 v[224:227], v[200:203], a[212:215], v[224:227]
v_mfma_f32_16x16x32_bf16 v[228:231], v[204:207], a[212:215], v[228:231]
s_nop 6
v_cvt_pk_bf16_f32 v56, v224, v225
v_cvt_pk_bf16_f32 v57, v226, v227
v_cvt_pk_bf16_f32 v58, v228, v229
v_cvt_pk_bf16_f32 v59, v230, v231
buffer_store_dwordx4 v[56:59], v21, s[4:7], s93 offen sc1
s_mov_b32 s93, 1879048192
s_waitcnt vmcnt(4)
ds_write_b32 v18, v24
s_waitcnt lgkmcnt(0)
s_barrier
ds_read_b32 v33, v32
s_waitcnt lgkmcnt(0)
v_cmp_gt_u32 vcc, s52, v33
v_cmp_gt_u32 s[58:59], s54, v33
s_and_b32 vcc_lo, vcc_lo, s56
s_cselect_b32 s70, 0, 1
s_and_b32 s59, s59, s56
s_cselect_b32 s71, 0, s95
s_or_b32 s76, s70, s71
s_cselect_b32 s10, 268435456, 0
s_cmp_lg_u32 s70, 0
s_cselect_b64 s[72:73], s[52:53], s[54:55]
s_cselect_b64 s[58:59], s[44:45], s[46:47]
s_mul_i32 s74, s72, s20
s_add_u32 s74, s74, s58
s_mul_i32 s75, s72, s21
s_add_u32 s75, s75, s59
s_andn2_b32 s71, s71, s70
s_add_u32 s52, s52, s70
s_add_u32 s54, s54, s71
s_mov_b32 s77, s76
s_cmp_lg_u32 s76, 0
s_cbranch_scc1 g_go_44
v_mov_b32 v27, s90
s_waitcnt vmcnt(0)
s_barrier
s_add_u32 s70, s52, s54
s_cmp_eq_u32 s70, 130
s_cbranch_scc1 g_fin_20
s_cmp_lg_u32 s3, 0
s_cbranch_scc1 sp_ok_46_j
s_mov_b32 s23, 0
buffer_load_dword v33, v22, s[4:7], 0 offen sc1
buffer_store_dword v27, v45, s[4:7], s91 offen
buffer_store_dword v27, v44, s[4:7], s91 offen sc1
s_waitcnt vmcnt(2)
s_branch sp_loop_45_e
sp_loop_45:
buffer_load_dword v33, v22, s[4:7], 0 offen sc1
s_add_u32 s23, s23, 1
s_cmp_gt_u32 s23, 150000
s_cbranch_scc1 sp_bad_47
s_waitcnt vmcnt(0)
sp_loop_45_e:
v_cmp_gt_u32 vcc, s52, v33
v_cmp_gt_u32 s[58:59], s54, v33
s_and_b32 vcc_lo, vcc_lo, s56
s_cbranch_scc0 sp_ok_46
s_cmp_gt_u32 s23, 4
s_cselect_b32 s70, 0, s56
s_cmp_lg_u32 s95, 0
s_cselect_b32 s70, 0, s70
s_or_b32 s59, s59, s70
s_and_b32 s59, s59, s56
s_cbranch_scc0 sp_ok_46
s_sleep 1
s_branch sp_loop_45
sp_bad_47:
s_mov_b32 s98, 1025
s_branch L_fail
sp_ok_46:
ds_write_b32 v18, v33
s_waitcnt lgkmcnt(0)
sp_ok_46_j:
s_barrier
ds_read_b32 v33, v32
s_waitcnt lgkmcnt(0)
s_mov_b32 s91, 1879048192
v_cmp_gt_u32 vcc, s52, v33
v_cmp_gt_u32 s[58:59], s54, v33
s_and_b32 vcc_lo, vcc_lo, s56
s_cselect_b32 s70, 0, 1
s_and_b32 s59, s59, s56
s_cselect_b32 s71, 0, 1
s_or_b32 s76, s70, s71
s_cselect_b32 s10, 268435456, 0
s_cmp_lg_u32 s70, 0
s_cselect_b64 s[72:73], s[52:53], s[54:55]
s_cselect_b64 s[58:59], s[44:45], s[46:47]
s_mul_i32 s74, s72, s20
s_add_u32 s74, s74, s58
s_mul_i32 s75, s72, s21
s_add_u32 s75, s75, s59
s_andn2_b32 s71, s71, s70
s_add_u32 s52, s52, s70
s_add_u32 s54, s54, s71
s_mov_b32 s77, s76
g_go_44:
s_add_u32 m0, s48, 0
s_nop 0
buffer_load_dwordx4 v8, s[4:7], s74 offen offset:0 sc1 lds
buffer_load_dwordx4 v9, s[4:7], s74 offen offset:1024 sc1 lds
buffer_load_dwordx4 v10, s[4:7], s74 offen offset:2048 sc1 lds
buffer_load_dwordx4 v11, s[4:7], s74 offen offset:3072 sc1 lds
s_add_u32 m0, s48, 4096
s_nop 0
buffer_load_dwordx4 v12, s[4:7], s74 offen offset:0 sc1 lds
buffer_load_dwordx4 v13, s[4:7], s74 offen offset:1024 sc1 lds
buffer_load_dwordx4 v14, s[4:7], s74 offen offset:2048 sc1 lds
buffer_load_dwordx4 v15, s[4:7], s74 offen offset:3072 sc1 lds
s_add_u32 m0, s48, 8192
s_nop 0
buffer_load_dwordx4 v16, s[4:7], s74 offen offset:0 sc1 lds
buffer_load_dword v24, v22, s[4:7], 0 offen sc1
buffer_store_dword v27, v34, s[4:7], 0 offen
v_mov_b32 v27, s90
s_waitcnt vmcnt(9)
s_barrier
buffer_store_dword v27, v45, s[4:7], s91 offen
buffer_store_dword v27, v44, s[4:7], s91 offen sc1
s_mov_b32 s91, 1879048192
ds_read_b128 v[64:67], v28 offset:0
ds_read_b128 v[68:71], v28 offset:9216
ds_read_b128 v[72:75], v28 offset:18432
ds_read_b128 v[76:79], v28 offset:27648
ds_read_b128 v[80:83], v28 offset:1024
ds_read_b128 v[84:87], v28 offset:10240
ds_read_b128 v[88:91], v28 offset:19456
ds_read_b128 v[92:95], v28 offset:28672
s_waitcnt vmcnt(8)
s_barrier
s_branch g_body_16
g_fin_20:
buffer_store_dword v27, v45, s[4:7], s91 offen
buffer_store_dword v27, v44, s[4:7], s91 offen sc1
s_endpgm
G_ssv18:
s_mov_b32 s8, s42
s_and_b32 s9, s43, 0xffff
s_mov_b32 s10, 0
s_mov_b32 s11, 0x20000
s_mov_b32 s22, 0
s_mul_i32 s48, s3, 9216
s_add_u32 s49, s48, 36864
s_add_u32 s50, s48, 73728
s_add_u32 s51, s48, 110592
s_mov_b32 s57, 0xbfb8aa3b
v_add_u32 v28, 0, v17
v_add_u32 v29, 36864, v17
v_add_u32 v30, 73728, v17
v_add_u32 v31, 110592, v17
v_lshlrev_b32 v1, 2, v0
v_add_u32 v32, 147456, v1
s_lshl_b32 s70, s3, 8
v_add_u32 v18, s70, v32
v_mov_b64 v[224:225], 0
v_mov_b64 v[236:237], 0
v_mov_b64 v[226:227], 0
v_mov_b64 v[238:239], 0
v_mov_b64 v[228:229], 0
v_mov_b64 v[240:241], 0
v_mov_b64 v[230:231], 0
v_mov_b64 v[242:243], 0
s_mov_b32 s12, s40
s_and_b32 s13, s41, 0xffff
s_mov_b32 s14, 256
s_mov_b32 s15, 0x20000
v_lshlrev_b32 v26, 2, v0
v_add_u32 v27, 128, v26
v_cmp_le_u32 vcc, 2, v0
s_nop 1
v_cndmask_b32 v26, v26, v27, vcc
v_mov_b32 v27, 192
v_cmp_eq_u32 vcc, 8, v0
s_nop 1
v_cndmask_b32 v26, v26, v27, vcc
v_mov_b32 v27, 2147483632
v_cmp_lt_u32 vcc, 8, v0
s_nop 1
v_cndmask_b32 v26, v26, v27, vcc
s_mov_b32 s98, 0
wi_loop_53:
buffer_load_dword v27, v26, s[12:15], 0 offen sc1
s_add_u32 s98, s98, 1
s_cmp_gt_u32 s98, 150000
s_cbranch_scc1 wi_bad_55
s_waitcnt vmcnt(0)
v_cmp_eq_u32 vcc, 32, v27
s_nop 0
s_and_b32 s97, vcc_lo, 0x1ff
s_cmp_eq_u32 s97, 0x1ff
s_cbranch_scc1 wi_ok_54
v_cmp_lt_u32 vcc, 32, v27
s_nop 0
s_and_b32 s96, vcc_lo, 0xff
s_cselect_b32 s96, 0x100, 0
s_and_b32 s96, s96, s97
s_cbranch_scc1 wi_over_56
s_sleep 8
s_branch wi_loop_53
wi_bad_55:
s_mov_b32 s98, 512
s_branch L_fail
wi_over_56:
s_mov_b32 s100, 255
wi_ok_54:
v_add_u32 v26, 65536, v22
v_cmp_eq_u32 vcc, s100, v23
s_nop 1
v_cndmask_b32 v22, v22, v26, vcc
s_mov_b32 s90, 0
s_mov_b32 s91, 1879048192
s_mov_b32 s93, 1879048192
v_mov_b32 v34, 2147483632
s_barrier
s_mov_b32 s95, 1
s_cmp_lg_u32 s3, 0
s_cbranch_scc1 sp_ok_58_j
s_mov_b32 s23, 0
sp_loop_57:
buffer_load_dword v33, v22, s[4:7], 0 offen sc1
s_add_u32 s23, s23, 1
s_cmp_gt_u32 s23, 150000
s_cbranch_scc1 sp_bad_59
s_waitcnt vmcnt(0)
sp_loop_57_e:
v_cmp_gt_u32 vcc, s52, v33
v_cmp_gt_u32 s[58:59], s54, v33
s_and_b32 vcc_lo, vcc_lo, s56
s_cbranch_scc0 sp_ok_58
s_cmp_gt_u32 s23, 4
s_cselect_b32 s70, 0, s56
s_cmp_lg_u32 s95, 0
s_cselect_b32 s70, 0, s70
s_or_b32 s59, s59, s70
s_and_b32 s59, s59, s56
s_cbranch_scc0 sp_ok_58
s_sleep 1
s_branch sp_loop_57
sp_bad_59:
s_mov_b32 s98, 1026
s_branch L_fail
sp_ok_58:
ds_write_b32 v18, v33
s_waitcnt lgkmcnt(0)
sp_ok_58_j:
s_barrier
ds_read_b32 v33, v32
s_waitcnt lgkmcnt(0)
v_cmp_gt_u32 vcc, s52, v33
v_cmp_gt_u32 s[58:59], s54, v33
s_and_b32 vcc_lo, vcc_lo, s56
s_cselect_b32 s70, 0, 1
s_and_b32 s59, s59, s56
s_cselect_b32 s71, 0, 1
s_or_b32 s76, s70, s71
s_cselect_b32 s10, 268435456, 0
s_cmp_lg_u32 s70, 0
s_cselect_b64 s[72:73], s[52:53], s[54:55]
s_cselect_b64 s[58:59], s[44:45], s[46:47]
s_mul_i32 s74, s72, s20
s_add_u32 s74, s74, s58
s_mul_i32 s75, s72, s21
s_add_u32 s75, s75, s59
s_andn2_b32 s71, s71, s70
s_add_u32 s52, s52, s70
s_add_u32 s54, s54, s71
s_mov_b32 s77, s76
s_add_u32 m0, s48, 0
s_nop 0
buffer_load_dwordx4 v8, s[4:7], s74 offen offset:0 sc1 lds
buffer_load_dwordx4 v9, s[4:7], s74 offen offset:1024 sc1 lds
buffer_load_dwordx4 v10, s[4:7], s74 offen offset:2048 sc1 lds
buffer_load_dwordx4 v11, s[4:7], s74 offen offset:3072 sc1 lds
s_add_u32 m0, s48, 4096
s_nop 0
buffer_load_dwordx4 v12, s[4:7], s74 offen offset:0 sc1 lds
buffer_load_dwordx4 v13, s[4:7], s74 offen offset:1024 sc1 lds
buffer_load_dwordx4 v14, s[4:7], s74 offen offset:2048 sc1 lds
buffer_load_dwordx4 v15, s[4:7], s74 offen offset:3072 sc1 lds
s_add_u32 m0, s48, 8192
s_nop 0
buffer_load_dwordx4 v16, s[4:7], s74 offen offset:0 sc1 lds
buffer_load_dword v24, v22, s[4:7], 0 offen sc1
buffer_store_dword v27, v34, s[4:7], 0 offen
v_mov_b32 v27, s90
s_waitcnt vmcnt(9)
s_barrier
buffer_store_dword v27, v45, s[4:7], s91 offen
buffer_store_dword v27, v44, s[4:7], s91 offen sc1
s_mov_b32 s91, 1879048192
ds_read_b128 v[64:67], v28 offset:0
ds_read_b128 v[68:71], v28 offset:9216
ds_read_b128 v[72:75], v28 offset:18432
ds_read_b128 v[76:79], v28 offset:27648
ds_read_b128 v[80:83], v28 offset:1024
ds_read_b128 v[84:87], v28 offset:10240
ds_read_b128 v[88:91], v28 offset:19456
ds_read_b128 v[92:95], v28 offset:28672
s_waitcnt vmcnt(8)
s_barrier
s_branch g_body_48
g_body_48:
s_waitcnt lgkmcnt(4)
v_mfma_f32_16x16x32_bf16 v[208:211], a[0:3], v[64:67], 0
ds_read_b128 v[96:99], v28 offset:2048
v_mfma_f32_16x16x32_bf16 v[212:215], a[0:3], v[68:71], 0
ds_read_b128 v[100:103], v28 offset:11264
v_mfma_f32_16x16x32_bf16 v[216:219], a[72:75], v[64:67], 0
v_mfma_f32_16x16x32_bf16 v[208:211], a[4:7], v[72:75], v[208:211]
ds_read_b128 v[104:107], v28 offset:20480
v_cvt_pk_bf16_f32 v56, v224, v225
v_mfma_f32_16x16x32_bf16 v[212:215], a[4:7], v[76:79], v[212:215]
ds_read_b128 v[108:111], v28 offset:29696
v_cvt_pk_bf16_f32 v57, v226, v227
v_mfma_f32_16x16x32_bf16 v[220:223], a[72:75], v[68:71], 0
v_cvt_pk_bf16_f32 v58, v228, v229
s_waitcnt lgkmcnt(4)
v_mfma_f32_16x16x32_bf16 v[208:211], a[8:11], v[80:83], v[208:211]
ds_read_b128 v[112:115], v28 offset:3072
v_cvt_pk_bf16_f32 v59, v230, v231
v_mfma_f32_16x16x32_bf16 v[212:215], a[8:11], v[84:87], v[212:215]
ds_read_b128 v[116:119], v28 offset:12288
v_mfma_f32_16x16x32_bf16 v[216:219], a[76:79], v[72:75], v[216:219]
buffer_store_dwordx4 v[56:59], v21, s[4:7], s93 offen sc1
v_mfma_f32_16x16x32_bf16 v[208:211], a[12:15], v[88:91], v[208:211]
ds_read_b128 v[120:123], v28 offset:21504
v_mfma_f32_16x16x32_bf16 v[212:215], a[12:15], v[92:95], v[212:215]
ds_read_b128 v[124:127], v28 offset:30720
v_mfma_f32_16x16x32_bf16 v[220:223], a[76:79], v[76:79], v[220:223]
s_waitcnt lgkmcnt(4)
v_mfma_f32_16x16x32_bf16 v[208:211], a[16:19], v[96:99], v[208:211]
ds_read_b128 v[128:131], v28 offset:4096
v_mfma_f32_16x16x32_bf16 v[212:215], a[16:19], v[100:103], v[212:215]
ds_read_b128 v[132:135], v28 offset:13312
v_mfma_f32_16x16x32_bf16 v[216:219], a[80:83], v[80:83], v[216:219]
v_mfma_f32_16x16x32_bf16 v[208:211], a[20:23], v[104:107], v[208:211]
ds_read_b128 v[136:139], v28 offset:22528
v_mfma_f32_16x16x32_bf16 v[212:215], a[20:23], v[108:111], v[212:215]
ds_read_b128 v[140:143], v28 offset:31744
v_mfma_f32_16x16x32_bf16 v[220:223], a[80:83], v[84:87], v[220:223]
s_waitcnt vmcnt(5)
s_barrier
s_waitcnt lgkmcnt(4)
v_mfma_f32_16x16x32_bf16 v[208:211], a[24:27], v[112:115], v[208:211]
ds_read_b128 v[144:147], v28 offset:5120
v_mov_b32 v27, s90
v_mfma_f32_16x16x32_bf16 v[212:215], a[24:27], v[116:119], v[212:215]
ds_read_b128 v[148:151], v28 offset:14336
v_mfma_f32_16x16x32_bf16 v[216:219], a[84:87], v[88:91], v[216:219]
v_mfma_f32_16x16x32_bf16 v[208:211], a[28:31], v[120:123], v[208:211]
ds_read_b128 v[152:155], v28 offset:23552
v_mfma_f32_16x16x32_bf16 v[212:215], a[28:31], v[124:127], v[212:215]
ds_read_b128 v[156:159], v28 offset:32768
v_mfma_f32_16x16x32_bf16 v[220:223], a[84:87], v[92:95], v[220:223]
s_waitcnt lgkmcnt(4)
v_mfma_f32_16x16x32_bf16 v[208:211], a[32:35], v[128:131], v[208:211]
ds_read_b128 v[160:163], v28 offset:6144
v_mfma_f32_16x16x32_bf16 v[212:215], a[32:35], v[132:135], v[212:215]
ds_read_b128 v[164:167], v28 offset:15360
v_mfma_f32_16x16x32_bf16 v[216:219], a[88:91], v[96:99], v[216:219]
v_mfma_f32_16x16x32_bf16 v[208:211], a[36:39], v[136:139], v[208:211]
ds_read_b128 v[168:171], v28 offset:24576
v_mfma_f32_16x16x32_bf16 v[212:215], a[36:39], v[140:143], v[212:215]
ds_read_b128 v[172:175], v28 offset:33792
v_mfma_f32_16x16x32_bf16 v[220:223], a[88:91], v[100:103], v[220:223]
s_waitcnt lgkmcnt(4)
v_mfma_f32_16x16x32_bf16 v[208:211], a[40:43], v[144:147], v[208:211]
ds_read_b128 v[176:179], v28 offset:7168
v_mfma_f32_16x16x32_bf16 v[212:215], a[40:43], v[148:151], v[212:215]
ds_read_b128 v[180:183], v28 offset:16384
s_waitcnt vmcnt(4)
ds_write_b32 v18, v24
v_mfma_f32_16x16x32_bf16 v[216:219], a[92:95], v[104:107], v[216:219]
v_mfma_f32_16x16x32_bf16 v[208:211], a[44:47], v[152:155], v[208:211]
ds_read_b128 v[184:187], v28 offset:25600
v_mfma_f32_16x16x32_bf16 v[212:215], a[44:47], v[156:159], v[212:215]
ds_read_b128 v[188:191], v28 offset:34816
s_waitcnt lgkmcnt(2)
s_barrier
v_mfma_f32_16x16x32_bf16 v[220:223], a[92:95], v[108:111], v[220:223]
ds_read_b32 v33, v32
v_mfma_f32_16x16x32_bf16 v[208:211], a[48:51], v[160:163], v[208:211]
ds_read_b128 v[192:195], v28 offset:8192
v_mfma_f32_16x16x32_bf16 v[212:215], a[48:51], v[164:167], v[212:215]
ds_read_b128 v[196:199], v28 offset:17408
v_mfma_f32_16x16x32_bf16 v[216:219], a[96:99], v[112:115], v[216:219]
s_waitcnt lgkmcnt(2)
v_cmp_gt_u32 vcc, s52, v33
v_mfma_f32_16x16x32_bf16 v[208:211], a[52:55], v[168:171], v[208:211]
ds_read_b128 v[200:203], v28 offset:26624
v_cmp_gt_u32 s[58:59], s54, v33
v_mfma_f32_16x16x32_bf16 v[212:215], a[52:55], v[172:175], v[212:215]
ds_read_b128 v[204:207], v28 offset:35840
s_and_b32 vcc_lo, vcc_lo, s56
s_cselect_b32 s70, 0, 1
v_mfma_f32_16x16x32_bf16 v[220:223], a[96:99], v[116:119], v[220:223]
v_mfma_f32_16x16x32_bf16 v[208:211], a[56:59], v[176:179], v[208:211]
s_and_b32 s59, s59, s56
s_cselect_b32 s71, 0, s77
v_mfma_f32_16x16x32_bf16 v[212:215], a[56:59], v[180:183], v[212:215]
s_or_b32 s82, s70, s71
s_cselect_b32 s10, 268435456, 0
v_mfma_f32_16x16x32_bf16 v[216:219], a[100:103], v[120:123], v[216:219]
s_cmp_lg_u32 s70, 0
s_cselect_b64 s[78:79], s[52:53], s[54:55]
s_cselect_b64 s[58:59], s[44:45], s[46:47]
v_mfma_f32_16x16x32_bf16 v[208:211], a[60:63], v[184:187], v[208:211]
s_mul_i32 s80, s78, s20
s_add_u32 s80, s80, s58
v_mfma_f32_16x16x32_bf16 v[212:215], a[60:63], v[188:191], v[212:215]
s_add_u32 m0, s49, 0
s_mul_i32 s81, s78, s21
s_add_u32 s81, s81, s59
v_mfma_f32_16x16x32_bf16 v[220:223], a[100:103], v[124:127], v[220:223]
buffer_load_dwordx4 v8, s[8:11], s80 offen offset:0 sc1 lds
s_waitcnt lgkmcnt(0)
v_mfma_f32_16x16x32_bf16 v[208:211], a[64:67], v[192:195], v[208:211]
s_andn2_b32 s71, s71, s70
s_add_u32 s52, s52, s70
s_add_u32 s54, s54, s71
v_mfma_f32_16x16x32_bf16 v[212:215], a[64:67], v[196:199], v[212:215]
s_mov_b32 s83, s82
v_mfma_f32_16x16x32_bf16 v[216:219], a[104:107], v[128:131], v[216:219]
buffer_load_dwordx4 v9, s[8:11], s80 offen offset:1024 sc1 lds
v_mfma_f32_16x16x32_bf16 v[208:211], a[68:71], v[200:203], v[208:211]
v_mfma_f32_16x16x32_bf16 v[212:215], a[68:71], v[204:207], v[212:215]
v_mfma_f32_16x16x32_bf16 v[220:223], a[104:107], v[132:135], v[220:223]
buffer_load_dwordx4 v10, s[8:11], s80 offen offset:2048 sc1 lds
v_mfma_f32_16x16x32_bf16 v[216:219], a[108:111], v[136:139], v[216:219]
v_mfma_f32_16x16x32_bf16 v[220:223], a[108:111], v[140:143], v[220:223]
v_mfma_f32_16x16x32_bf16 v[216:219], a[112:115], v[144:147], v[216:219]
buffer_load_dwordx4 v11, s[8:11], s80 offen offset:3072 sc1 lds
v_mfma_f32_16x16x32_bf16 v[220:223], a[112:115], v[148:151], v[220:223]
v_mfma_f32_16x16x32_bf16 v[216:219], a[116:119], v[152:155], v[216:219]
s_add_u32 m0, s49, 4096
v_cvt_pk_bf16_f32 v48, v208, v209
v_mfma_f32_16x16x32_bf16 v[220:223], a[116:119], v[156:159], v[220:223]
buffer_load_dwordx4 v12, s[8:11], s80 offen offset:0 sc1 lds
v_mfma_f32_16x16x32_bf16 v[216:219], a[120:123], v[160:163], v[216:219]
v_cvt_pk_bf16_f32 v49, v210, v211
v_cvt_pk_bf16_f32 v50, v212, v213
v_mfma_f32_16x16x32_bf16 v[220:223], a[120:123], v[164:167], v[220:223]
v_cvt_pk_bf16_f32 v51, v214, v215
v_mfma_f32_16x16x32_bf16 v[216:219], a[124:127], v[168:171], v[216:219]
buffer_load_dwordx4 v13, s[8:11], s80 offen offset:1024 sc1 lds
v_mfma_f32_16x16x32_bf16 v[220:223], a[124:127], v[172:175], v[220:223]
v_permlane16_swap_b32 v48, v50
v_mfma_f32_16x16x32_bf16 v[216:219], a[128:131], v[176:179], v[216:219]
v_permlane16_swap_b32 v49, v51
v_mfma_f32_16x16x32_bf16 v[220:223], a[128:131], v[180:183], v[220:223]
buffer_load_dwordx4 v14, s[8:11], s80 offen offset:2048 sc1 lds
v_mfma_f32_16x16x32_bf16 v[216:219], a[132:135], v[184:187], v[216:219]
buffer_store_dwordx4 v[48:51], v19, s[4:7], s75 offen sc1
v_mfma_f32_16x16x32_bf16 v[220:223], a[132:135], v[188:191], v[220:223]
v_mfma_f32_16x16x32_bf16 v[216:219], a[136:139], v[192:195], v[216:219]
buffer_load_dwordx4 v15, s[8:11], s80 offen offset:3072 sc1 lds
v_mfma_f32_16x16x32_bf16 v[220:223], a[136:139], v[196:199], v[220:223]
v_mfma_f32_16x16x32_bf16 v[216:219], a[140:143], v[200:203], v[216:219]
s_add_u32 m0, s49, 8192
v_mfma_f32_16x16x32_bf16 v[220:223], a[140:143], v[204:207], v[220:223]
buffer_load_dwordx4 v16, s[8:11], s80 offen offset:0 sc1 lds
v_mfma_f32_16x16x32_bf16 v[224:227], v[64:67], a[144:147], 0
v_mfma_f32_16x16x32_bf16 v[228:231], v[68:71], a[144:147], 0
v_mfma_f32_16x16x32_bf16 v[224:227], v[72:75], a[148:151], v[224:227]
v_mfma_f32_16x16x32_bf16 v[228:231], v[76:79], a[148:151], v[228:231]
v_mfma_f32_16x16x32_bf16 v[224:227], v[80:83], a[152:155], v[224:227]
buffer_load_dword v24, v22, s[4:7], 0 offen sc1
v_mfma_f32_16x16x32_bf16 v[228:231], v[84:87], a[152:155], v[228:231]
v_cvt_pk_bf16_f32 v52, v216, v217
v_cvt_pk_bf16_f32 v53, v218, v219
v_mfma_f32_16x16x32_bf16 v[224:227], v[88:91], a[156:159], v[224:227]
s_waitcnt vmcnt(11)
s_barrier
v_mfma_f32_16x16x32_bf16 v[228:231], v[92:95], a[156:159], v[228:231]
buffer_store_dword v27, v45, s[4:7], s91 offen
v_mfma_f32_16x16x32_bf16 v[224:227], v[96:99], a[160:163], v[224:227]
buffer_store_dword v27, v44, s[4:7], s91 offen sc1
v_mfma_f32_16x16x32_bf16 v[228:231], v[100:103], a[160:163], v[228:231]
v_cvt_pk_bf16_f32 v54, v220, v221
v_cvt_pk_bf16_f32 v55, v222, v223
v_mfma_f32_16x16x32_bf16 v[224:227], v[104:107], a[164:167], v[224:227]
v_permlane16_swap_b32 v52, v54
v_mfma_f32_16x16x32_bf16 v[228:231], v[108:111], a[164:167], v[228:231]
v_permlane16_swap_b32 v53, v55
v_mfma_f32_16x16x32_bf16 v[224:227], v[112:115], a[168:171], v[224:227]
buffer_store_dwordx4 v[52:55], v20, s[4:7], s75 offen sc1
v_mfma_f32_16x16x32_bf16 v[228:231], v[116:119], a[168:171], v[228:231]
v_mfma_f32_16x16x32_bf16 v[224:227], v[120:123], a[172:175], v[224:227]
v_mfma_f32_16x16x32_bf16 v[228:231], v[124:127], a[172:175], v[228:231]
v_mfma_f32_16x16x32_bf16 v[224:227], v[128:131], a[176:179], v[224:227]
v_mfma_f32_16x16x32_bf16 v[228:231], v[132:135], a[176:179], v[228:231]
v_mfma_f32_16x16x32_bf16 v[224:227], v[136:139], a[180:183], v[224:227]
v_mfma_f32_16x16x32_bf16 v[228:231], v[140:143], a[180:183], v[228:231]
v_mfma_f32_16x16x32_bf16 v[224:227], v[144:147], a[184:187], v[224:227]
v_mfma_f32_16x16x32_bf16 v[228:231], v[148:151], a[184:187], v[228:231]
v_mfma_f32_16x16x32_bf16 v[224:227], v[152:155], a[188:191], v[224:227]
v_mfma_f32_16x16x32_bf16 v[228:231], v[156:159], a[188:191], v[228:231]
v_mfma_f32_16x16x32_bf16 v[224:227], v[160:163], a[192:195], v[224:227]
s_waitcnt vmcnt(12)
s_barrier
v_mfma_f32_16x16x32_bf16 v[228:231], v[164:167], a[192:195], v[228:231]
v_mfma_f32_16x16x32_bf16 v[224:227], v[168:171], a[196:199], v[224:227]
s_cmp_eq_u32 s82, 0
s_cbranch_scc1 g_slow_60
v_mfma_f32_16x16x32_bf16 v[228:231], v[172:175], a[196:199], v[228:231]
ds_read_b128 v[64:67], v29 offset:0
v_mfma_f32_16x16x32_bf16 v[224:227], v[176:179], a[200:203], v[224:227]
ds_read_b128 v[68:71], v29 offset:9216
v_mfma_f32_16x16x32_bf16 v[228:231], v[180:183], a[200:203], v[228:231]
ds_read_b128 v[72:75], v29 offset:18432
v_mfma_f32_16x16x32_bf16 v[224:227], v[184:187], a[204:207], v[224:227]
ds_read_b128 v[76:79], v29 offset:27648
v_mfma_f32_16x16x32_bf16 v[228:231], v[188:191], a[204:207], v[228:231]
ds_read_b128 v[80:83], v29 offset:1024
v_mfma_f32_16x16x32_bf16 v[224:227], v[192:195], a[208:211], v[224:227]
ds_read_b128 v[84:87], v29 offset:10240
v_mfma_f32_16x16x32_bf16 v[228:231], v[196:199], a[208:211], v[228:231]
ds_read_b128 v[88:91], v29 offset:19456
v_mfma_f32_16x16x32_bf16 v[224:227], v[200:203], a[212:215], v[224:227]
ds_read_b128 v[92:95], v29 offset:28672
v_mfma_f32_16x16x32_bf16 v[228:231], v[204:207], a[212:215], v[228:231]
s_waitcnt vmcnt(9)
s_barrier
g_body_49:
s_waitcnt lgkmcnt(4)
v_mfma_f32_16x16x32_bf16 v[208:211], a[0:3], v[64:67], 0
ds_read_b128 v[96:99], v29 offset:2048
v_mfma_f32_16x16x32_bf16 v[212:215], a[0:3], v[68:71], 0
ds_read_b128 v[100:103], v29 offset:11264
v_mfma_f32_16x16x32_bf16 v[216:219], a[72:75], v[64:67], 0
v_mfma_f32_16x16x32_bf16 v[208:211], a[4:7], v[72:75], v[208:211]
ds_read_b128 v[104:107], v29 offset:20480
v_cvt_pk_bf16_f32 v56, v224, v225
v_mfma_f32_16x16x32_bf16 v[212:215], a[4:7], v[76:79], v[212:215]
ds_read_b128 v[108:111], v29 offset:29696
v_cvt_pk_bf16_f32 v57, v226, v227
v_mfma_f32_16x16x32_bf16 v[220:223], a[72:75], v[68:71], 0
v_cvt_pk_bf16_f32 v58, v228, v229
s_waitcnt lgkmcnt(4)
v_mfma_f32_16x16x32_bf16 v[208:211], a[8:11], v[80:83], v[208:211]
ds_read_b128 v[112:115], v29 offset:3072
v_cvt_pk_bf16_f32 v59, v230, v231
v_mfma_f32_16x16x32_bf16 v[212:215], a[8:11], v[84:87], v[212:215]
ds_read_b128 v[116:119], v29 offset:12288
v_mfma_f32_16x16x32_bf16 v[216:219], a[76:79], v[72:75], v[216:219]
buffer_store_dwordx4 v[56:59], v21, s[4:7], s75 offen sc1
v_mfma_f32_16x16x32_bf16 v[208:211], a[12:15], v[88:91], v[208:211]
ds_read_b128 v[120:123], v29 offset:21504
v_mfma_f32_16x16x32_bf16 v[212:215], a[12:15], v[92:95], v[212:215]
ds_read_b128 v[124:127], v29 offset:30720
v_mfma_f32_16x16x32_bf16 v[220:223], a[76:79], v[76:79], v[220:223]
s_waitcnt lgkmcnt(4)
v_mfma_f32_16x16x32_bf16 v[208:211], a[16:19], v[96:99], v[208:211]
ds_read_b128 v[128:131], v29 offset:4096
v_mfma_f32_16x16x32_bf16 v[212:215], a[16:19], v[100:103], v[212:215]
ds_read_b128 v[132:135], v29 offset:13312
v_mfma_f32_16x16x32_bf16 v[216:219], a[80:83], v[80:83], v[216:219]
v_mfma_f32_16x16x32_bf16 v[208:211], a[20:23], v[104:107], v[208:211]
ds_read_b128 v[136:139], v29 offset:22528
v_mfma_f32_16x16x32_bf16 v[212:215], a[20:23], v[108:111], v[212:215]
ds_read_b128 v[140:143], v29 offset:31744
v_mfma_f32_16x16x32_bf16 v[220:223], a[80:83], v[84:87], v[220:223]
s_waitcnt vmcnt(5)
s_barrier
s_waitcnt lgkmcnt(4)
v_mfma_f32_16x16x32_bf16 v[208:211], a[24:27], v[112:115], v[208:211]
ds_read_b128 v[144:147], v29 offset:5120
v_mov_b32 v27, s72
v_mfma_f32_16x16x32_bf16 v[212:215], a[24:27], v[116:119], v[212:215]
ds_read_b128 v[148:151], v29 offset:14336
v_mfma_f32_16x16x32_bf16 v[216:219], a[84:87], v[88:91], v[216:219]
v_mfma_f32_16x16x32_bf16 v[208:211], a[28:31], v[120:123], v[208:211]
ds_read_b128 v[152:155], v29 offset:23552
v_mfma_f32_16x16x32_bf16 v[212:215], a[28:31], v[124:127], v[212:215]
ds_read_b128 v[156:159], v29 offset:32768
v_mfma_f32_16x16x32_bf16 v[220:223], a[84:87], v[92:95], v[220:223]
s_waitcnt lgkmcnt(4)
v_mfma_f32_16x16x32_bf16 v[208:211], a[32:35], v[128:131], v[208:211]
ds_read_b128 v[160:163], v29 offset:6144
v_mfma_f32_16x16x32_bf16 v[212:215], a[32:35], v[132:135], v[212:215]
ds_read_b128 v[164:167], v29 offset:15360
v_mfma_f32_16x16x32_bf16 v[216:219], a[88:91], v[96:99], v[216:219]
v_mfma_f32_16x16x32_bf16 v[208:211], a[36:39], v[136:139], v[208:211]
ds_read_b128 v[168:171], v29 offset:24576
v_mfma_f32_16x16x32_bf16 v[212:215], a[36:39], v[140:143], v[212:215]
ds_read_b128 v[172:175], v29 offset:33792
v_mfma_f32_16x16x32_bf16 v[220:223], a[88:91], v[100:103], v[220:223]
s_waitcnt lgkmcnt(4)
v_mfma_f32_16x16x32_bf16 v[208:211], a[40:43], v[144:147], v[208:211]
ds_read_b128 v[176:179], v29 offset:7168
v_mfma_f32_16x16x32_bf16 v[212:215], a[40:43], v[148:151], v[212:215]
ds_read_b128 v[180:183], v29 offset:16384
s_waitcnt vmcnt(4)
ds_write_b32 v18, v24
v_mfma_f32_16x16x32_bf16 v[216:219], a[92:95], v[104:107], v[216:219]
v_mfma_f32_16x16x32_bf16 v[208:211], a[44:47], v[152:155], v[208:211]
ds_read_b128 v[184:187], v29 offset:25600
v_mfma_f32_16x16x32_bf16 v[212:215], a[44:47], v[156:159], v[212:215]
ds_read_b128 v[188:191], v29 offset:34816
s_waitcnt lgkmcnt(2)
s_barrier
v_mfma_f32_16x16x32_bf16 v[220:223], a[92:95], v[108:111], v[220:223]
ds_read_b32 v33, v32
v_mfma_f32_16x16x32_bf16 v[208:211], a[48:51], v[160:163], v[208:211]
ds_read_b128 v[192:195], v29 offset:8192
v_mfma_f32_16x16x32_bf16 v[212:215], a[48:51], v[164:167], v[212:215]
ds_read_b128 v[196:199], v29 offset:17408
v_mfma_f32_16x16x32_bf16 v[216:219], a[96:99], v[112:115], v[216:219]
s_waitcnt lgkmcnt(2)
v_cmp_gt_u32 vcc, s52, v33
v_mfma_f32_16x16x32_bf16 v[208:211], a[52:55], v[168:171], v[208:211]
ds_read_b128 v[200:203], v29 offset:26624
v_cmp_gt_u32 s[58:59], s54, v33
v_mfma_f32_16x16x32_bf16 v[212:215], a[52:55], v[172:175], v[212:215]
ds_read_b128 v[204:207], v29 offset:35840
s_and_b32 vcc_lo, vcc_lo, s56
s_cselect_b32 s70, 0, 1
v_mfma_f32_16x16x32_bf16 v[220:223], a[96:99], v[116:119], v[220:223]
v_mfma_f32_16x16x32_bf16 v[208:211], a[56:59], v[176:179], v[208:211]
s_and_b32 s59, s59, s56
s_cselect_b32 s71, 0, s83
v_mfma_f32_16x16x32_bf16 v[212:215], a[56:59], v[180:183], v[212:215]
s_or_b32 s88, s70, s71
s_cselect_b32 s10, 268435456, 0
v_mfma_f32_16x16x32_bf16 v[216:219], a[100:103], v[120:123], v[216:219]
s_cmp_lg_u32 s70, 0
s_cselect_b64 s[84:85], s[52:53], s[54:55]
s_cselect_b64 s[58:59], s[44:45], s[46:47]
v_mfma_f32_16x16x32_bf16 v[208:211], a[60:63], v[184:187], v[208:211]
s_mul_i32 s86, s84, s20
s_add_u32 s86, s86, s58
v_mfma_f32_16x16x32_bf16 v[212:215], a[60:63], v[188:191], v[212:215]
s_add_u32 m0, s50, 0
s_mul_i32 s87, s84, s21
s_add_u32 s87, s87, s59
v_mfma_f32_16x16x32_bf16 v[220:223], a[100:103], v[124:127], v[220:223]
buffer_load_dwordx4 v8, s[8:11], s86 offen offset:0 sc1 lds
s_waitcnt lgkmcnt(0)
v_mfma_f32_16x16x32_bf16 v[208:211], a[64:67], v[192:195], v[208:211]
s_andn2_b32 s71, s71, s70
s_add_u32 s52, s52, s70
s_add_u32 s54, s54, s71
v_mfma_f32_16x16x32_bf16 v[212:215], a[64:67], v[196:199], v[212:215]
s_mov_b32 s89, s88
v_mfma_f32_16x16x32_bf16 v[216:219], a[104:107], v[128:131], v[216:219]
buffer_load_dwordx4 v9, s[8:11], s86 offen offset:1024 sc1 lds
v_mfma_f32_16x16x32_bf16 v[208:211], a[68:71], v[200:203], v[208:211]
v_mfma_f32_16x16x32_bf16 v[212:215], a[68:71], v[204:207], v[212:215]
v_mfma_f32_16x16x32_bf16 v[220:223], a[104:107], v[132:135], v[220:223]
buffer_load_dwordx4 v10, s[8:11], s86 offen offset:2048 sc1 lds
v_mfma_f32_16x16x32_bf16 v[216:219], a[108:111], v[136:139], v[216:219]
v_mfma_f32_16x16x32_bf16 v[220:223], a[108:111], v[140:143], v[220:223]
v_mfma_f32_16x16x32_bf16 v[216:219], a[112:115], v[144:147], v[216:219]
buffer_load_dwordx4 v11, s[8:11], s86 offen offset:3072 sc1 lds
v_mfma_f32_16x16x32_bf16 v[220:223], a[112:115], v[148:151], v[220:223]
v_mfma_f32_16x16x32_bf16 v[216:219], a[116:119], v[152:155], v[216:219]
s_add_u32 m0, s50, 4096
v_cvt_pk_bf16_f32 v48, v208, v209
v_mfma_f32_16x16x32_bf16 v[220:223], a[116:119], v[156:159], v[220:223]
buffer_load_dwordx4 v12, s[8:11], s86 offen offset:0 sc1 lds
v_mfma_f32_16x16x32_bf16 v[216:219], a[120:123], v[160:163], v[216:219]
v_cvt_pk_bf16_f32 v49, v210, v211
v_cvt_pk_bf16_f32 v50, v212, v213
v_mfma_f32_16x16x32_bf16 v[220:223], a[120:123], v[164:167], v[220:223]
v_cvt_pk_bf16_f32 v51, v214, v215
v_mfma_f32_16x16x32_bf16 v[216:219], a[124:127], v[168:171], v[216:219]
buffer_load_dwordx4 v13, s[8:11], s86 offen offset:1024 sc1 lds
v_mfma_f32_16x16x32_bf16 v[220:223], a[124:127], v[172:175], v[220:223]
v_permlane16_swap_b32 v48, v50
v_mfma_f32_16x16x32_bf16 v[216:219], a[128:131], v[176:179], v[216:219]
v_permlane16_swap_b32 v49, v51
v_mfma_f32_16x16x32_bf16 v[220:223], a[128:131], v[180:183], v[220:223]
buffer_load_dwordx4 v14, s[8:11], s86 offen offset:2048 sc1 lds
v_mfma_f32_16x16x32_bf16 v[216:219], a[132:135], v[184:187], v[216:219]
buffer_store_dwordx4 v[48:51], v19, s[4:7], s81 offen sc1
v_mfma_f32_16x16x32_bf16 v[220:223], a[132:135], v[188:191], v[220:223]
v_mfma_f32_16x16x32_bf16 v[216:219], a[136:139], v[192:195], v[216:219]
buffer_load_dwordx4 v15, s[8:11], s86 offen offset:3072 sc1 lds
v_mfma_f32_16x16x32_bf16 v[220:223], a[136:139], v[196:199], v[220:223]
v_mfma_f32_16x16x32_bf16 v[216:219], a[140:143], v[200:203], v[216:219]
s_add_u32 m0, s50, 8192
v_mfma_f32_16x16x32_bf16 v[220:223], a[140:143], v[204:207], v[220:223]
buffer_load_dwordx4 v16, s[8:11], s86 offen offset:0 sc1 lds
v_mfma_f32_16x16x32_bf16 v[224:227], v[64:67], a[144:147], 0
v_mfma_f32_16x16x32_bf16 v[228:231], v[68:71], a[144:147], 0
v_mfma_f32_16x16x32_bf16 v[224:227], v[72:75], a[148:151], v[224:227]
v_mfma_f32_16x16x32_bf16 v[228:231], v[76:79], a[148:151], v[228:231]
v_mfma_f32_16x16x32_bf16 v[224:227], v[80:83], a[152:155], v[224:227]
buffer_load_dword v24, v22, s[4:7], 0 offen sc1
v_mfma_f32_16x16x32_bf16 v[228:231], v[84:87], a[152:155], v[228:231]
v_cvt_pk_bf16_f32 v52, v216, v217
v_cvt_pk_bf16_f32 v53, v218, v219
v_mfma_f32_16x16x32_bf16 v[224:227], v[88:91], a[156:159], v[224:227]
s_waitcnt vmcnt(11)
s_barrier
v_mfma_f32_16x16x32_bf16 v[228:231], v[92:95], a[156:159], v[228:231]
buffer_store_dword v27, v45, s[4:7], s73 offen
v_mfma_f32_16x16x32_bf16 v[224:227], v[96:99], a[160:163], v[224:227]
buffer_store_dword v27, v44, s[4:7], s73 offen sc1
v_mfma_f32_16x16x32_bf16 v[228:231], v[100:103], a[160:163], v[228:231]
v_cvt_pk_bf16_f32 v54, v220, v221
v_cvt_pk_bf16_f32 v55, v222, v223
v_mfma_f32_16x16x32_bf16 v[224:227], v[104:107], a[164:167], v[224:227]
v_permlane16_swap_b32 v52, v54
v_mfma_f32_16x16x32_bf16 v[228:231], v[108:111], a[164:167], v[228:231]
v_permlane16_swap_b32 v53, v55
v_mfma_f32_16x16x32_bf16 v[224:227], v[112:115], a[168:171], v[224:227]
buffer_store_dwordx4 v[52:55], v20, s[4:7], s81 offen sc1
v_mfma_f32_16x16x32_bf16 v[228:231], v[116:119], a[168:171], v[228:231]
v_mfma_f32_16x16x32_bf16 v[224:227], v[120:123], a[172:175], v[224:227]
v_mfma_f32_16x16x32_bf16 v[228:231], v[124:127], a[172:175], v[228:231]
v_mfma_f32_16x16x32_bf16 v[224:227], v[128:131], a[176:179], v[224:227]
v_mfma_f32_16x16x32_bf16 v[228:231], v[132:135], a[176:179], v[228:231]
v_mfma_f32_16x16x32_bf16 v[224:227], v[136:139], a[180:183], v[224:227]
v_mfma_f32_16x16x32_bf16 v[228:231], v[140:143], a[180:183], v[228:231]
v_mfma_f32_16x16x32_bf16 v[224:227], v[144:147], a[184:187], v[224:227]
v_mfma_f32_16x16x32_bf16 v[228:231], v[148:151], a[184:187], v[228:231]
v_mfma_f32_16x16x32_bf16 v[224:227], v[152:155], a[188:191], v[224:227]
v_mfma_f32_16x16x32_bf16 v[228:231], v[156:159], a[188:191], v[228:231]
v_mfma_f32_16x16x32_bf16 v[224:227], v[160:163], a[192:195], v[224:227]
s_waitcnt vmcnt(12)
s_barrier
v_mfma_f32_16x16x32_bf16 v[228:231], v[164:167], a[192:195], v[228:231]
v_mfma_f32_16x16x32_bf16 v[224:227], v[168:171], a[196:199], v[224:227]
s_cmp_eq_u32 s88, 0
s_cbranch_scc1 g_slow_61
v_mfma_f32_16x16x32_bf16 v[228:231], v[172:175], a[196:199], v[228:231]
ds_read_b128 v[64:67], v30 offset:0
v_mfma_f32_16x16x32_bf16 v[224:227], v[176:179], a[200:203], v[224:227]
ds_read_b128 v[68:71], v30 offset:9216
v_mfma_f32_16x16x32_bf16 v[228:231], v[180:183], a[200:203], v[228:231]
ds_read_b128 v[72:75], v30 offset:18432
v_mfma_f32_16x16x32_bf16 v[224:227], v[184:187], a[204:207], v[224:227]
ds_read_b128 v[76:79], v30 offset:27648
v_mfma_f32_16x16x32_bf16 v[228:231], v[188:191], a[204:207], v[228:231]
ds_read_b128 v[80:83], v30 offset:1024
v_mfma_f32_16x16x32_bf16 v[224:227], v[192:195], a[208:211], v[224:227]
ds_read_b128 v[84:87], v30 offset:10240
v_mfma_f32_16x16x32_bf16 v[228:231], v[196:199], a[208:211], v[228:231]
ds_read_b128 v[88:91], v30 offset:19456
v_mfma_f32_16x16x32_bf16 v[224:227], v[200:203], a[212:215], v[224:227]
ds_read_b128 v[92:95], v30 offset:28672
v_mfma_f32_16x16x32_bf16 v[228:231], v[204:207], a[212:215], v[228:231]
s_waitcnt vmcnt(9)
s_barrier
g_body_50:
s_waitcnt lgkmcnt(4)
v_mfma_f32_16x16x32_bf16 v[208:211], a[0:3], v[64:67], 0
ds_read_b128 v[96:99], v30 offset:2048
v_mfma_f32_16x16x32_bf16 v[212:215], a[0:3], v[68:71], 0
ds_read_b128 v[100:103], v30 offset:11264
v_mfma_f32_16x16x32_bf16 v[216:219], a[72:75], v[64:67], 0
v_mfma_f32_16x16x32_bf16 v[208:211], a[4:7], v[72:75], v[208:211]
ds_read_b128 v[104:107], v30 offset:20480
v_cvt_pk_bf16_f32 v56, v224, v225
v_mfma_f32_16x16x32_bf16 v[212:215], a[4:7], v[76:79], v[212:215]
ds_read_b128 v[108:111], v30 offset:29696
v_cvt_pk_bf16_f32 v57, v226, v227
v_mfma_f32_16x16x32_bf16 v[220:223], a[72:75], v[68:71], 0
v_cvt_pk_bf16_f32 v58, v228, v229
s_waitcnt lgkmcnt(4)
v_mfma_f32_16x16x32_bf16 v[208:211], a[8:11], v[80:83], v[208:211]
ds_read_b128 v[112:115], v30 offset:3072
v_cvt_pk_bf16_f32 v59, v230, v231
v_mfma_f32_16x16x32_bf16 v[212:215], a[8:11], v[84:87], v[212:215]
ds_read_b128 v[116:119], v30 offset:12288
v_mfma_f32_16x16x32_bf16 v[216:219], a[76:79], v[72:75], v[216:219]
buffer_store_dwordx4 v[56:59], v21, s[4:7], s81 offen sc1
v_mfma_f32_16x16x32_bf16 v[208:211], a[12:15], v[88:91], v[208:211]
ds_read_b128 v[120:123], v30 offset:21504
v_mfma_f32_16x16x32_bf16 v[212:215], a[12:15], v[92:95], v[212:215]
ds_read_b128 v[124:127], v30 offset:30720
v_mfma_f32_16x16x32_bf16 v[220:223], a[76:79], v[76:79], v[220:223]
s_waitcnt lgkmcnt(4)
v_mfma_f32_16x16x32_bf16 v[208:211], a[16:19], v[96:99], v[208:211]
ds_read_b128 v[128:131], v30 offset:4096
v_mfma_f32_16x16x32_bf16 v[212:215], a[16:19], v[100:103], v[212:215]
ds_read_b128 v[132:135], v30 offset:13312
v_mfma_f32_16x16x32_bf16 v[216:219], a[80:83], v[80:83], v[216:219]
v_mfma_f32_16x16x32_bf16 v[208:211], a[20:23], v[104:107], v[208:211]
ds_read_b128 v[136:139], v30 offset:22528
v_mfma_f32_16x16x32_bf16 v[212:215], a[20:23], v[108:111], v[212:215]
ds_read_b128 v[140:143], v30 offset:31744
v_mfma_f32_16x16x32_bf16 v[220:223], a[80:83], v[84:87], v[220:223]
s_waitcnt vmcnt(5)
s_barrier
s_waitcnt lgkmcnt(4)
v_mfma_f32_16x16x32_bf16 v[208:211], a[24:27], v[112:115], v[208:211]
ds_read_b128 v[144:147], v30 offset:5120
v_mov_b32 v27, s78
v_mfma_f32_16x16x32_bf16 v[212:215], a[24:27], v[116:119], v[212:215]
ds_read_b128 v[148:151], v30 offset:14336
v_mfma_f32_16x16x32_bf16 v[216:219], a[84:87], v[88:91], v[216:219]
v_mfma_f32_16x16x32_bf16 v[208:211], a[28:31], v[120:123], v[208:211]
ds_read_b128 v[152:155], v30 offset:23552
v_mfma_f32_16x16x32_bf16 v[212:215], a[28:31], v[124:127], v[212:215]
ds_read_b128 v[156:159], v30 offset:32768
v_mfma_f32_16x16x32_bf16 v[220:223], a[84:87], v[92:95], v[220:223]
s_waitcnt lgkmcnt(4)
v_mfma_f32_16x16x32_bf16 v[208:211], a[32:35], v[128:131], v[208:211]
ds_read_b128 v[160:163], v30 offset:6144
v_mfma_f32_16x16x32_bf16 v[212:215], a[32:35], v[132:135], v[212:215]
ds_read_b128 v[164:167], v30 offset:15360
v_mfma_f32_16x16x32_bf16 v[216:219], a[88:91], v[96:99], v[216:219]
v_mfma_f32_16x16x32_bf16 v[208:211], a[36:39], v[136:139], v[208:211]
ds_read_b128 v[168:171], v30 offset:24576
v_mfma_f32_16x16x32_bf16 v[212:215], a[36:39], v[140:143], v[212:215]
ds_read_b128 v[172:175], v30 offset:33792
v_mfma_f32_16x16x32_bf16 v[220:223], a[88:91], v[100:103], v[220:223]
s_waitcnt lgkmcnt(4)
v_mfma_f32_16x16x32_bf16 v[208:211], a[40:43], v[144:147], v[208:211]
ds_read_b128 v[176:179], v30 offset:7168
v_mfma_f32_16x16x32_bf16 v[212:215], a[40:43], v[148:151], v[212:215]
ds_read_b128 v[180:183], v30 offset:16384
s_waitcnt vmcnt(4)
ds_write_b32 v18, v24
v_mfma_f32_16x16x32_bf16 v[216:219], a[92:95], v[104:107], v[216:219]
v_mfma_f32_16x16x32_bf16 v[208:211], a[44:47], v[152:155], v[208:211]
ds_read_b128 v[184:187], v30 offset:25600
v_mfma_f32_16x16x32_bf16 v[212:215], a[44:47], v[156:159], v[212:215]
ds_read_b128 v[188:191], v30 offset:34816
s_waitcnt lgkmcnt(2)
s_barrier
v_mfma_f32_16x16x32_bf16 v[220:223], a[92:95], v[108:111], v[220:223]
ds_read_b32 v33, v32
v_mfma_f32_16x16x32_bf16 v[208:211], a[48:51], v[160:163], v[208:211]
ds_read_b128 v[192:195], v30 offset:8192
v_mfma_f32_16x16x32_bf16 v[212:215], a[48:51], v[164:167], v[212:215]
ds_read_b128 v[196:199], v30 offset:17408
v_mfma_f32_16x16x32_bf16 v[216:219], a[96:99], v[112:115], v[216:219]
s_waitcnt lgkmcnt(2)
v_cmp_gt_u32 vcc, s52, v33
v_mfma_f32_16x16x32_bf16 v[208:211], a[52:55], v[168:171], v[208:211]
ds_read_b128 v[200:203], v30 offset:26624
v_cmp_gt_u32 s[58:59], s54, v33
v_mfma_f32_16x16x32_bf16 v[212:215], a[52:55], v[172:175], v[212:215]
ds_read_b128 v[204:207], v30 offset:35840
s_and_b32 vcc_lo, vcc_lo, s56
s_cselect_b32 s70, 0, 1
v_mfma_f32_16x16x32_bf16 v[220:223], a[96:99], v[116:119], v[220:223]
v_mfma_f32_16x16x32_bf16 v[208:211], a[56:59], v[176:179], v[208:211]
s_and_b32 s59, s59, s56
s_cselect_b32 s71, 0, s89
v_mfma_f32_16x16x32_bf16 v[212:215], a[56:59], v[180:183], v[212:215]
s_or_b32 s94, s70, s71
s_cselect_b32 s10, 268435456, 0
v_mfma_f32_16x16x32_bf16 v[216:219], a[100:103], v[120:123], v[216:219]
s_cmp_lg_u32 s70, 0
s_cselect_b64 s[90:91], s[52:53], s[54:55]
s_cselect_b64 s[58:59], s[44:45], s[46:47]
v_mfma_f32_16x16x32_bf16 v[208:211], a[60:63], v[184:187], v[208:211]
s_mul_i32 s92, s90, s20
s_add_u32 s92, s92, s58
v_mfma_f32_16x16x32_bf16 v[212:215], a[60:63], v[188:191], v[212:215]
s_add_u32 m0, s51, 0
s_mul_i32 s93, s90, s21
s_add_u32 s93, s93, s59
v_mfma_f32_16x16x32_bf16 v[220:223], a[100:103], v[124:127], v[220:223]
buffer_load_dwordx4 v8, s[8:11], s92 offen offset:0 sc1 lds
s_waitcnt lgkmcnt(0)
v_mfma_f32_16x16x32_bf16 v[208:211], a[64:67], v[192:195], v[208:211]
s_andn2_b32 s71, s71, s70
s_add_u32 s52, s52, s70
s_add_u32 s54, s54, s71
v_mfma_f32_16x16x32_bf16 v[212:215], a[64:67], v[196:199], v[212:215]
s_mov_b32 s95, s94
v_mfma_f32_16x16x32_bf16 v[216:219], a[104:107], v[128:131], v[216:219]
buffer_load_dwordx4 v9, s[8:11], s92 offen offset:1024 sc1 lds
v_mfma_f32_16x16x32_bf16 v[208:211], a[68:71], v[200:203], v[208:211]
v_mfma_f32_16x16x32_bf16 v[212:215], a[68:71], v[204:207], v[212:215]
v_mfma_f32_16x16x32_bf16 v[220:223], a[104:107], v[132:135], v[220:223]
buffer_load_dwordx4 v10, s[8:11], s92 offen offset:2048 sc1 lds
v_mfma_f32_16x16x32_bf16 v[216:219], a[108:111], v[136:139], v[216:219]
v_mfma_f32_16x16x32_bf16 v[220:223], a[108:111], v[140:143], v[220:223]
v_mfma_f32_16x16x32_bf16 v[216:219], a[112:115], v[144:147], v[216:219]
buffer_load_dwordx4 v11, s[8:11], s92 offen offset:3072 sc1 lds
v_mfma_f32_16x16x32_bf16 v[220:223], a[112:115], v[148:151], v[220:223]
v_mfma_f32_16x16x32_bf16 v[216:219], a[116:119], v[152:155], v[216:219]
s_add_u32 m0, s51, 4096
v_cvt_pk_bf16_f32 v48, v208, v209
v_mfma_f32_16x16x32_bf16 v[220:223], a[116:119], v[156:159], v[220:223]
buffer_load_dwordx4 v12, s[8:11], s92 offen offset:0 sc1 lds
v_mfma_f32_16x16x32_bf16 v[216:219], a[120:123], v[160:163], v[216:219]
v_cvt_pk_bf16_f32 v49, v210, v211
v_cvt_pk_bf16_f32 v50, v212, v213
v_mfma_f32_16x16x32_bf16 v[220:223], a[120:123], v[164:167], v[220:223]
v_cvt_pk_bf16_f32 v51, v214, v215
v_mfma_f32_16x16x32_bf16 v[216:219], a[124:127], v[168:171], v[216:219]
buffer_load_dwordx4 v13, s[8:11], s92 offen offset:1024 sc1 lds
v_mfma_f32_16x16x32_bf16 v[220:223], a[124:127], v[172:175], v[220:223]
v_permlane16_swap_b32 v48, v50
v_mfma_f32_16x16x32_bf16 v[216:219], a[128:131], v[176:179], v[216:219]
v_permlane16_swap_b32 v49, v51
v_mfma_f32_16x16x32_bf16 v[220:223], a[128:131], v[180:183], v[220:223]
buffer_load_dwordx4 v14, s[8:11], s92 offen offset:2048 sc1 lds
v_mfma_f32_16x16x32_bf16 v[216:219], a[132:135], v[184:187], v[216:219]
buffer_store_dwordx4 v[48:51], v19, s[4:7], s87 offen sc1
v_mfma_f32_16x16x32_bf16 v[220:223], a[132:135], v[188:191], v[220:223]
v_mfma_f32_16x16x32_bf16 v[216:219], a[136:139], v[192:195], v[216:219]
buffer_load_dwordx4 v15, s[8:11], s92 offen offset:3072 sc1 lds
v_mfma_f32_16x16x32_bf16 v[220:223], a[136:139], v[196:199], v[220:223]
v_mfma_f32_16x16x32_bf16 v[216:219], a[140:143], v[200:203], v[216:219]
s_add_u32 m0, s51, 8192
v_mfma_f32_16x16x32_bf16 v[220:223], a[140:143], v[204:207], v[220:223]
buffer_load_dwordx4 v16, s[8:11], s92 offen offset:0 sc1 lds
v_mfma_f32_16x16x32_bf16 v[224:227], v[64:67], a[144:147], 0
v_mfma_f32_16x16x32_bf16 v[228:231], v[68:71], a[144:147], 0
v_mfma_f32_16x16x32_bf16 v[224:227], v[72:75], a[148:151], v[224:227]
v_mfma_f32_16x16x32_bf16 v[228:231], v[76:79], a[148:151], v[228:231]
v_mfma_f32_16x16x32_bf16 v[224:227], v[80:83], a[152:155], v[224:227]
buffer_load_dword v24, v22, s[4:7], 0 offen sc1
v_mfma_f32_16x16x32_bf16 v[228:231], v[84:87], a[152:155], v[228:231]
v_cvt_pk_bf16_f32 v52, v216, v217
v_cvt_pk_bf16_f32 v53, v218, v219
v_mfma_f32_16x16x32_bf16 v[224:227], v[88:91], a[156:159], v[224:227]
s_waitcnt vmcnt(11)
s_barrier
v_mfma_f32_16x16x32_bf16 v[228:231], v[92:95], a[156:159], v[228:231]
buffer_store_dword v27, v45, s[4:7], s79 offen
v_mfma_f32_16x16x32_bf16 v[224:227], v[96:99], a[160:163], v[224:227]
buffer_store_dword v27, v44, s[4:7], s79 offen sc1
v_mfma_f32_16x16x32_bf16 v[228:231], v[100:103], a[160:163], v[228:231]
v_cvt_pk_bf16_f32 v54, v220, v221
v_cvt_pk_bf16_f32 v55, v222, v223
v_mfma_f32_16x16x32_bf16 v[224:227], v[104:107], a[164:167], v[224:227]
v_permlane16_swap_b32 v52, v54
v_mfma_f32_16x16x32_bf16 v[228:231], v[108:111], a[164:167], v[228:231]
v_permlane16_swap_b32 v53, v55
v_mfma_f32_16x16x32_bf16 v[224:227], v[112:115], a[168:171], v[224:227]
buffer_store_dwordx4 v[52:55], v20, s[4:7], s87 offen sc1
v_mfma_f32_16x16x32_bf16 v[228:231], v[116:119], a[168:171], v[228:231]
v_mfma_f32_16x16x32_bf16 v[224:227], v[120:123], a[172:175], v[224:227]
v_mfma_f32_16x16x32_bf16 v[228:231], v[124:127], a[172:175], v[228:231]
v_mfma_f32_16x16x32_bf16 v[224:227], v[128:131], a[176:179], v[224:227]
v_mfma_f32_16x16x32_bf16 v[228:231], v[132:135], a[176:179], v[228:231]
v_mfma_f32_16x16x32_bf16 v[224:227], v[136:139], a[180:183], v[224:227]
v_mfma_f32_16x16x32_bf16 v[228:231], v[140:143], a[180:183], v[228:231]
v_mfma_f32_16x16x32_bf16 v[224:227], v[144:147], a[184:187], v[224:227]
v_mfma_f32_16x16x32_bf16 v[228:231], v[148:151], a[184:187], v[228:231]
v_mfma_f32_16x16x32_bf16 v[224:227], v[152:155], a[188:191], v[224:227]
v_mfma_f32_16x16x32_bf16 v[228:231], v[156:159], a[188:191], v[228:231]
v_mfma_f32_16x16x32_bf16 v[224:227], v[160:163], a[192:195], v[224:227]
s_waitcnt vmcnt(12)
s_barrier
v_mfma_f32_16x16x32_bf16 v[228:231], v[164:167], a[192:195], v[228:231]
v_mfma_f32_16x16x32_bf16 v[224:227], v[168:171], a[196:199], v[224:227]
s_cmp_eq_u32 s94, 0
s_cbranch_scc1 g_slow_62
v_mfma_f32_16x16x32_bf16 v[228:231], v[172:175], a[196:199], v[228:231]
ds_read_b128 v[64:67], v31 offset:0
v_mfma_f32_16x16x32_bf16 v[224:227], v[176:179], a[200:203], v[224:227]
ds_read_b128 v[68:71], v31 offset:9216
v_mfma_f32_16x16x32_bf16 v[228:231], v[180:183], a[200:203], v[228:231]
ds_read_b128 v[72:75], v31 offset:18432
v_mfma_f32_16x16x32_bf16 v[224:227], v[184:187], a[204:207], v[224:227]
ds_read_b128 v[76:79], v31 offset:27648
v_mfma_f32_16x16x32_bf16 v[228:231], v[188:191], a[204:207], v[228:231]
ds_read_b128 v[80:83], v31 offset:1024
v_mfma_f32_16x16x32_bf16 v[224:227], v[192:195], a[208:211], v[224:227]
ds_read_b128 v[84:87], v31 offset:10240
v_mfma_f32_16x16x32_bf16 v[228:231], v[196:199], a[208:211], v[228:231]
ds_read_b128 v[88:91], v31 offset:19456
v_mfma_f32_16x16x32_bf16 v[224:227], v[200:203], a[212:215], v[224:227]
ds_read_b128 v[92:95], v31 offset:28672
v_mfma_f32_16x16x32_bf16 v[228:231], v[204:207], a[212:215], v[228:231]
s_waitcnt vmcnt(9)
s_barrier
g_body_51:
s_waitcnt lgkmcnt(4)
v_mfma_f32_16x16x32_bf16 v[208:211], a[0:3], v[64:67], 0
ds_read_b128 v[96:99], v31 offset:2048
v_mfma_f32_16x16x32_bf16 v[212:215], a[0:3], v[68:71], 0
ds_read_b128 v[100:103], v31 offset:11264
v_mfma_f32_16x16x32_bf16 v[216:219], a[72:75], v[64:67], 0
v_mfma_f32_16x16x32_bf16 v[208:211], a[4:7], v[72:75], v[208:211]
ds_read_b128 v[104:107], v31 offset:20480
v_cvt_pk_bf16_f32 v56, v224, v225
v_mfma_f32_16x16x32_bf16 v[212:215], a[4:7], v[76:79], v[212:215]
ds_read_b128 v[108:111], v31 offset:29696
v_cvt_pk_bf16_f32 v57, v226, v227
v_mfma_f32_16x16x32_bf16 v[220:223], a[72:75], v[68:71], 0
v_cvt_pk_bf16_f32 v58, v228, v229
s_waitcnt lgkmcnt(4)
v_mfma_f32_16x16x32_bf16 v[208:211], a[8:11], v[80:83], v[208:211]
ds_read_b128 v[112:115], v31 offset:3072
v_cvt_pk_bf16_f32 v59, v230, v231
v_mfma_f32_16x16x32_bf16 v[212:215], a[8:11], v[84:87], v[212:215]
ds_read_b128 v[116:119], v31 offset:12288
v_mfma_f32_16x16x32_bf16 v[216:219], a[76:79], v[72:75], v[216:219]
buffer_store_dwordx4 v[56:59], v21, s[4:7], s87 offen sc1
v_mfma_f32_16x16x32_bf16 v[208:211], a[12:15], v[88:91], v[208:211]
ds_read_b128 v[120:123], v31 offset:21504
v_mfma_f32_16x16x32_bf16 v[212:215], a[12:15], v[92:95], v[212:215]
ds_read_b128 v[124:127], v31 offset:30720
v_mfma_f32_16x16x32_bf16 v[220:223], a[76:79], v[76:79], v[220:223]
s_waitcnt lgkmcnt(4)
v_mfma_f32_16x16x32_bf16 v[208:211], a[16:19], v[96:99], v[208:211]
ds_read_b128 v[128:131], v31 offset:4096
v_mfma_f32_16x16x32_bf16 v[212:215], a[16:19], v[100:103], v[212:215]
ds_read_b128 v[132:135], v31 offset:13312
v_mfma_f32_16x16x32_bf16 v[216:219], a[80:83], v[80:83], v[216:219]
v_mfma_f32_16x16x32_bf16 v[208:211], a[20:23], v[104:107], v[208:211]
ds_read_b128 v[136:139], v31 offset:22528
v_mfma_f32_16x16x32_bf16 v[212:215], a[20:23], v[108:111], v[212:215]
ds_read_b128 v[140:143], v31 offset:31744
v_mfma_f32_16x16x32_bf16 v[220:223], a[80:83], v[84:87], v[220:223]
s_waitcnt vmcnt(5)
s_barrier
s_waitcnt lgkmcnt(4)
v_mfma_f32_16x16x32_bf16 v[208:211], a[24:27], v[112:115], v[208:211]
ds_read_b128 v[144:147], v31 offset:5120
v_mov_b32 v27, s84
v_mfma_f32_16x16x32_bf16 v[212:215], a[24:27], v[116:119], v[212:215]
ds_read_b128 v[148:151], v31 offset:14336
v_mfma_f32_16x16x32_bf16 v[216:219], a[84:87], v[88:91], v[216:219]
v_mfma_f32_16x16x32_bf16 v[208:211], a[28:31], v[120:123], v[208:211]
ds_read_b128 v[152:155], v31 offset:23552
v_mfma_f32_16x16x32_bf16 v[212:215], a[28:31], v[124:127], v[212:215]
ds_read_b128 v[156:159], v31 offset:32768
v_mfma_f32_16x16x32_bf16 v[220:223], a[84:87], v[92:95], v[220:223]
s_waitcnt lgkmcnt(4)
v_mfma_f32_16x16x32_bf16 v[208:211], a[32:35], v[128:131], v[208:211]
ds_read_b128 v[160:163], v31 offset:6144
v_mfma_f32_16x16x32_bf16 v[212:215], a[32:35], v[132:135], v[212:215]
ds_read_b128 v[164:167], v31 offset:15360
v_mfma_f32_16x16x32_bf16 v[216:219], a[88:91], v[96:99], v[216:219]
v_mfma_f32_16x16x32_bf16 v[208:211], a[36:39], v[136:139], v[208:211]
ds_read_b128 v[168:171], v31 offset:24576
v_mfma_f32_16x16x32_bf16 v[212:215], a[36:39], v[140:143], v[212:215]
ds_read_b128 v[172:175], v31 offset:33792
v_mfma_f32_16x16x32_bf16 v[220:223], a[88:91], v[100:103], v[220:223]
s_waitcnt lgkmcnt(4)
v_mfma_f32_16x16x32_bf16 v[208:211], a[40:43], v[144:147], v[208:211]
ds_read_b128 v[176:179], v31 offset:7168
v_mfma_f32_16x16x32_bf16 v[212:215], a[40:43], v[148:151], v[212:215]
ds_read_b128 v[180:183], v31 offset:16384
s_waitcnt vmcnt(4)
ds_write_b32 v18, v24
v_mfma_f32_16x16x32_bf16 v[216:219], a[92:95], v[104:107], v[216:219]
v_mfma_f32_16x16x32_bf16 v[208:211], a[44:47], v[152:155], v[208:211]
ds_read_b128 v[184:187], v31 offset:25600
v_mfma_f32_16x16x32_bf16 v[212:215], a[44:47], v[156:159], v[212:215]
ds_read_b128 v[188:191], v31 offset:34816
s_waitcnt lgkmcnt(2)
s_barrier
v_mfma_f32_16x16x32_bf16 v[220:223], a[92:95], v[108:111], v[220:223]
ds_read_b32 v33, v32
v_mfma_f32_16x16x32_bf16 v[208:211], a[48:51], v[160:163], v[208:211]
ds_read_b128 v[192:195], v31 offset:8192
v_mfma_f32_16x16x32_bf16 v[212:215], a[48:51], v[164:167], v[212:215]
ds_read_b128 v[196:199], v31 offset:17408
v_mfma_f32_16x16x32_bf16 v[216:219], a[96:99], v[112:115], v[216:219]
s_waitcnt lgkmcnt(2)
v_cmp_gt_u32 vcc, s52, v33
v_mfma_f32_16x16x32_bf16 v[208:211], a[52:55], v[168:171], v[208:211]
ds_read_b128 v[200:203], v31 offset:26624
v_cmp_gt_u32 s[58:59], s54, v33
v_mfma_f32_16x16x32_bf16 v[212:215], a[52:55], v[172:175], v[212:215]
ds_read_b128 v[204:207], v31 offset:35840
s_and_b32 vcc_lo, vcc_lo, s56
s_cselect_b32 s70, 0, 1
v_mfma_f32_16x16x32_bf16 v[220:223], a[96:99], v[116:119], v[220:223]
v_mfma_f32_16x16x32_bf16 v[208:211], a[56:59], v[176:179], v[208:211]
s_and_b32 s59, s59, s56
s_cselect_b32 s71, 0, s95
v_mfma_f32_16x16x32_bf16 v[212:215], a[56:59], v[180:183], v[212:215]
s_or_b32 s76, s70, s71
s_cselect_b32 s10, 268435456, 0
v_mfma_f32_16x16x32_bf16 v[216:219], a[100:103], v[120:123], v[216:219]
s_cmp_lg_u32 s70, 0
s_cselect_b64 s[72:73], s[52:53], s[54:55]
s_cselect_b64 s[58:59], s[44:45], s[46:47]
v_mfma_f32_16x16x32_bf16 v[208:211], a[60:63], v[184:187], v[208:211]
s_mul_i32 s74, s72, s20
s_add_u32 s74, s74, s58
v_mfma_f32_16x16x32_bf16 v[212:215], a[60:63], v[188:191], v[212:215]
s_add_u32 m0, s48, 0
s_mul_i32 s75, s72, s21
s_add_u32 s75, s75, s59
v_mfma_f32_16x16x32_bf16 v[220:223], a[100:103], v[124:127], v[220:223]
buffer_load_dwordx4 v8, s[8:11], s74 offen offset:0 sc1 lds
s_waitcnt lgkmcnt(0)
v_mfma_f32_16x16x32_bf16 v[208:211], a[64:67], v[192:195], v[208:211]
s_andn2_b32 s71, s71, s70
s_add_u32 s52, s52, s70
s_add_u32 s54, s54, s71
v_mfma_f32_16x16x32_bf16 v[212:215], a[64:67], v[196:199], v[212:215]
s_mov_b32 s77, s76
v_mfma_f32_16x16x32_bf16 v[216:219], a[104:107], v[128:131], v[216:219]
buffer_load_dwordx4 v9, s[8:11], s74 offen offset:1024 sc1 lds
v_mfma_f32_16x16x32_bf16 v[208:211], a[68:71], v[200:203], v[208:211]
v_mfma_f32_16x16x32_bf16 v[212:215], a[68:71], v[204:207], v[212:215]
v_mfma_f32_16x16x32_bf16 v[220:223], a[104:107], v[132:135], v[220:223]
buffer_load_dwordx4 v10, s[8:11], s74 offen offset:2048 sc1 lds
v_mfma_f32_16x16x32_bf16 v[216:219], a[108:111], v[136:139], v[216:219]
v_mfma_f32_16x16x32_bf16 v[220:223], a[108:111], v[140:143], v[220:223]
v_mfma_f32_16x16x32_bf16 v[216:219], a[112:115], v[144:147], v[216:219]
buffer_load_dwordx4 v11, s[8:11], s74 offen offset:3072 sc1 lds
v_mfma_f32_16x16x32_bf16 v[220:223], a[112:115], v[148:151], v[220:223]
v_mfma_f32_16x16x32_bf16 v[216:219], a[116:119], v[152:155], v[216:219]
s_add_u32 m0, s48, 4096
v_cvt_pk_bf16_f32 v48, v208, v209
v_mfma_f32_16x16x32_bf16 v[220:223], a[116:119], v[156:159], v[220:223]
buffer_load_dwordx4 v12, s[8:11], s74 offen offset:0 sc1 lds
v_mfma_f32_16x16x32_bf16 v[216:219], a[120:123], v[160:163], v[216:219]
v_cvt_pk_bf16_f32 v49, v210, v211
v_cvt_pk_bf16_f32 v50, v212, v213
v_mfma_f32_16x16x32_bf16 v[220:223], a[120:123], v[164:167], v[220:223]
v_cvt_pk_bf16_f32 v51, v214, v215
v_mfma_f32_16x16x32_bf16 v[216:219], a[124:127], v[168:171], v[216:219]
buffer_load_dwordx4 v13, s[8:11], s74 offen offset:1024 sc1 lds
v_mfma_f32_16x16x32_bf16 v[220:223], a[124:127], v[172:175], v[220:223]
v_permlane16_swap_b32 v48, v50
v_mfma_f32_16x16x32_bf16 v[216:219], a[128:131], v[176:179], v[216:219]
v_permlane16_swap_b32 v49, v51
v_mfma_f32_16x16x32_bf16 v[220:223], a[128:131], v[180:183], v[220:223]
buffer_load_dwordx4 v14, s[8:11], s74 offen offset:2048 sc1 lds
v_mfma_f32_16x16x32_bf16 v[216:219], a[132:135], v[184:187], v[216:219]
buffer_store_dwordx4 v[48:51], v19, s[4:7], s93 offen sc1
v_mfma_f32_16x16x32_bf16 v[220:223], a[132:135], v[188:191], v[220:223]
v_mfma_f32_16x16x32_bf16 v[216:219], a[136:139], v[192:195], v[216:219]
buffer_load_dwordx4 v15, s[8:11], s74 offen offset:3072 sc1 lds
v_mfma_f32_16x16x32_bf16 v[220:223], a[136:139], v[196:199], v[220:223]
v_mfma_f32_16x16x32_bf16 v[216:219], a[140:143], v[200:203], v[216:219]
s_add_u32 m0, s48, 8192
v_mfma_f32_16x16x32_bf16 v[220:223], a[140:143], v[204:207], v[220:223]
buffer_load_dwordx4 v16, s[8:11], s74 offen offset:0 sc1 lds
v_mfma_f32_16x16x32_bf16 v[224:227], v[64:67], a[144:147], 0
v_mfma_f32_16x16x32_bf16 v[228:231], v[68:71], a[144:147], 0
v_mfma_f32_16x16x32_bf16 v[224:227], v[72:75], a[148:151], v[224:227]
v_mfma_f32_16x16x32_bf16 v[228:231], v[76:79], a[148:151], v[228:231]
v_mfma_f32_16x16x32_bf16 v[224:227], v[80:83], a[152:155], v[224:227]
buffer_load_dword v24, v22, s[4:7], 0 offen sc1
v_mfma_f32_16x16x32_bf16 v[228:231], v[84:87], a[152:155], v[228:231]
v_cvt_pk_bf16_f32 v52, v216, v217
v_cvt_pk_bf16_f32 v53, v218, v219
v_mfma_f32_16x16x32_bf16 v[224:227], v[88:91], a[156:159], v[224:227]
s_waitcnt vmcnt(11)
s_barrier
v_mfma_f32_16x16x32_bf16 v[228:231], v[92:95], a[156:159], v[228:231]
buffer_store_dword v27, v45, s[4:7], s85 offen
v_mfma_f32_16x16x32_bf16 v[224:227], v[96:99], a[160:163], v[224:227]
buffer_store_dword v27, v44, s[4:7], s85 offen sc1
v_mfma_f32_16x16x32_bf16 v[228:231], v[100:103], a[160:163], v[228:231]
v_cvt_pk_bf16_f32 v54, v220, v221
v_cvt_pk_bf16_f32 v55, v222, v223
v_mfma_f32_16x16x32_bf16 v[224:227], v[104:107], a[164:167], v[224:227]
v_permlane16_swap_b32 v52, v54
v_mfma_f32_16x16x32_bf16 v[228:231], v[108:111], a[164:167], v[228:231]
v_permlane16_swap_b32 v53, v55
v_mfma_f32_16x16x32_bf16 v[224:227], v[112:115], a[168:171], v[224:227]
buffer_store_dwordx4 v[52:55], v20, s[4:7], s93 offen sc1
v_mfma_f32_16x16x32_bf16 v[228:231], v[116:119], a[168:171], v[228:231]
v_mfma_f32_16x16x32_bf16 v[224:227], v[120:123], a[172:175], v[224:227]
v_mfma_f32_16x16x32_bf16 v[228:231], v[124:127], a[172:175], v[228:231]
v_mfma_f32_16x16x32_bf16 v[224:227], v[128:131], a[176:179], v[224:227]
v_mfma_f32_16x16x32_bf16 v[228:231], v[132:135], a[176:179], v[228:231]
v_mfma_f32_16x16x32_bf16 v[224:227], v[136:139], a[180:183], v[224:227]
v_mfma_f32_16x16x32_bf16 v[228:231], v[140:143], a[180:183], v[228:231]
v_mfma_f32_16x16x32_bf16 v[224:227], v[144:147], a[184:187], v[224:227]
v_mfma_f32_16x16x32_bf16 v[228:231], v[148:151], a[184:187], v[228:231]
v_mfma_f32_16x16x32_bf16 v[224:227], v[152:155], a[188:191], v[224:227]
v_mfma_f32_16x16x32_bf16 v[228:231], v[156:159], a[188:191], v[228:231]
v_mfma_f32_16x16x32_bf16 v[224:227], v[160:163], a[192:195], v[224:227]
s_waitcnt vmcnt(12)
s_barrier
v_mfma_f32_16x16x32_bf16 v[228:231], v[164:167], a[192:195], v[228:231]
v_mfma_f32_16x16x32_bf16 v[224:227], v[168:171], a[196:199], v[224:227]
s_cmp_eq_u32 s76, 0
s_cbranch_scc1 g_slow_63
v_mfma_f32_16x16x32_bf16 v[228:231], v[172:175], a[196:199], v[228:231]
ds_read_b128 v[64:67], v28 offset:0
v_mfma_f32_16x16x32_bf16 v[224:227], v[176:179], a[200:203], v[224:227]
ds_read_b128 v[68:71], v28 offset:9216
v_mfma_f32_16x16x32_bf16 v[228:231], v[180:183], a[200:203], v[228:231]
ds_read_b128 v[72:75], v28 offset:18432
v_mfma_f32_16x16x32_bf16 v[224:227], v[184:187], a[204:207], v[224:227]
ds_read_b128 v[76:79], v28 offset:27648
v_mfma_f32_16x16x32_bf16 v[228:231], v[188:191], a[204:207], v[228:231]
ds_read_b128 v[80:83], v28 offset:1024
v_mfma_f32_16x16x32_bf16 v[224:227], v[192:195], a[208:211], v[224:227]
ds_read_b128 v[84:87], v28 offset:10240
v_mfma_f32_16x16x32_bf16 v[228:231], v[196:199], a[208:211], v[228:231]
ds_read_b128 v[88:91], v28 offset:19456
v_mfma_f32_16x16x32_bf16 v[224:227], v[200:203], a[212:215], v[224:227]
ds_read_b128 v[92:95], v28 offset:28672
v_mfma_f32_16x16x32_bf16 v[228:231], v[204:207], a[212:215], v[228:231]
s_waitcnt vmcnt(9)
s_barrier
s_branch g_body_48
g_slow_60:
v_mfma_f32_16x16x32_bf16 v[228:231], v[172:175], a[196:199], v[228:231]
v_mfma_f32_16x16x32_bf16 v[224:227], v[176:179], a[200:203], v[224:227]
v_mfma_f32_16x16x32_bf16 v[228:231], v[180:183], a[200:203], v[228:231]
v_mfma_f32_16x16x32_bf16 v[224:227], v[184:187], a[204:207], v[224:227]
v_mfma_f32_16x16x32_bf16 v[228:231], v[188:191], a[204:207], v[228:231]
v_mfma_f32_16x16x32_bf16 v[224:227], v[192:195], a[208:211], v[224:227]
v_mfma_f32_16x16x32_bf16 v[228:231], v[196:199], a[208:211], v[228:231]
v_mfma_f32_16x16x32_bf16 v[224:227], v[200:203], a[212:215], v[224:227]
v_mfma_f32_16x16x32_bf16 v[228:231], v[204:207], a[212:215], v[228:231]
s_nop 6
v_cvt_pk_bf16_f32 v56, v224, v225
v_cvt_pk_bf16_f32 v57, v226, v227
v_cvt_pk_bf16_f32 v58, v228, v229
v_cvt_pk_bf16_f32 v59, v230, v231
buffer_store_dwordx4 v[56:59], v21, s[4:7], s75 offen sc1
s_mov_b32 s75, 1879048192
s_waitcnt vmcnt(4)
ds_write_b32 v18, v24
s_waitcnt lgkmcnt(0)
s_barrier
ds_read_b32 v33, v32
s_waitcnt lgkmcnt(0)
v_cmp_gt_u32 vcc, s52, v33
v_cmp_gt_u32 s[58:59], s54, v33
s_and_b32 vcc_lo, vcc_lo, s56
s_cselect_b32 s70, 0, 1
s_and_b32 s59, s59, s56
s_cselect_b32 s71, 0, s77
s_or_b32 s82, s70, s71
s_cselect_b32 s10, 268435456, 0
s_cmp_lg_u32 s70, 0
s_cselect_b64 s[78:79], s[52:53], s[54:55]
s_cselect_b64 s[58:59], s[44:45], s[46:47]
s_mul_i32 s80, s78, s20
s_add_u32 s80, s80, s58
s_mul_i32 s81, s78, s21
s_add_u32 s81, s81, s59
s_andn2_b32 s71, s71, s70
s_add_u32 s52, s52, s70
s_add_u32 s54, s54, s71
s_mov_b32 s83, s82
s_cmp_lg_u32 s82, 0
s_cbranch_scc1 g_go_64
v_mov_b32 v27, s72
s_waitcnt vmcnt(0)
s_barrier
s_add_u32 s70, s52, s54
s_cmp_eq_u32 s70, 130
s_cbranch_scc1 g_fin_52
s_cmp_lg_u32 s3, 0
s_cbranch_scc1 sp_ok_66_j
s_mov_b32 s23, 0
buffer_load_dword v33, v22, s[4:7], 0 offen sc1
buffer_store_dword v27, v45, s[4:7], s73 offen
buffer_store_dword v27, v44, s[4:7], s73 offen sc1
s_waitcnt vmcnt(2)
s_branch sp_loop_65_e
sp_loop_65:
buffer_load_dword v33, v22, s[4:7], 0 offen sc1
s_add_u32 s23, s23, 1
s_cmp_gt_u32 s23, 150000
s_cbranch_scc1 sp_bad_67
s_waitcnt vmcnt(0)
sp_loop_65_e:
v_cmp_gt_u32 vcc, s52, v33
v_cmp_gt_u32 s[58:59], s54, v33
s_and_b32 vcc_lo, vcc_lo, s56
s_cbranch_scc0 sp_ok_66
s_cmp_gt_u32 s23, 4
s_cselect_b32 s70, 0, s56
s_cmp_lg_u32 s77, 0
s_cselect_b32 s70, 0, s70
s_or_b32 s59, s59, s70
s_and_b32 s59, s59, s56
s_cbranch_scc0 sp_ok_66
s_sleep 1
s_branch sp_loop_65
sp_bad_67:
s_mov_b32 s98, 1026
s_branch L_fail
sp_ok_66:
ds_write_b32 v18, v33
s_waitcnt lgkmcnt(0)
sp_ok_66_j:
s_barrier
ds_read_b32 v33, v32
s_waitcnt lgkmcnt(0)
s_mov_b32 s73, 1879048192
v_cmp_gt_u32 vcc, s52, v33
v_cmp_gt_u32 s[58:59], s54, v33
s_and_b32 vcc_lo, vcc_lo, s56
s_cselect_b32 s70, 0, 1
s_and_b32 s59, s59, s56
s_cselect_b32 s71, 0, 1
s_or_b32 s82, s70, s71
s_cselect_b32 s10, 268435456, 0
s_cmp_lg_u32 s70, 0
s_cselect_b64 s[78:79], s[52:53], s[54:55]
s_cselect_b64 s[58:59], s[44:45], s[46:47]
s_mul_i32 s80, s78, s20
s_add_u32 s80, s80, s58
s_mul_i32 s81, s78, s21
s_add_u32 s81, s81, s59
s_andn2_b32 s71, s71, s70
s_add_u32 s52, s52, s70
s_add_u32 s54, s54, s71
s_mov_b32 s83, s82
g_go_64:
s_add_u32 m0, s49, 0
s_nop 0
buffer_load_dwordx4 v8, s[4:7], s80 offen offset:0 sc1 lds
buffer_load_dwordx4 v9, s[4:7], s80 offen offset:1024 sc1 lds
buffer_load_dwordx4 v10, s[4:7], s80 offen offset:2048 sc1 lds
buffer_load_dwordx4 v11, s[4:7], s80 offen offset:3072 sc1 lds
s_add_u32 m0, s49, 4096
s_nop 0
buffer_load_dwordx4 v12, s[4:7], s80 offen offset:0 sc1 lds
buffer_load_dwordx4 v13, s[4:7], s80 offen offset:1024 sc1 lds
buffer_load_dwordx4 v14, s[4:7], s80 offen offset:2048 sc1 lds
buffer_load_dwordx4 v15, s[4:7], s80 offen offset:3072 sc1 lds
s_add_u32 m0, s49, 8192
s_nop 0
buffer_load_dwordx4 v16, s[4:7], s80 offen offset:0 sc1 lds
buffer_load_dword v24, v22, s[4:7], 0 offen sc1
buffer_store_dword v27, v34, s[4:7], 0 offen
v_mov_b32 v27, s72
s_waitcnt vmcnt(9)
s_barrier
buffer_store_dword v27, v45, s[4:7], s73 offen
buffer_store_dword v27, v44, s[4:7], s73 offen sc1
s_mov_b32 s73, 1879048192
ds_read_b128 v[64:67], v29 offset:0
ds_read_b128 v[68:71], v29 offset:9216
ds_read_b128 v[72:75], v29 offset:18432
ds_read_b128 v[76:79], v29 offset:27648
ds_read_b128 v[80:83], v29 offset:1024
ds_read_b128 v[84:87], v29 offset:10240
ds_read_b128 v[88:91], v29 offset:19456
ds_read_b128 v[92:95], v29 offset:28672
s_waitcnt vmcnt(8)
s_barrier
s_branch g_body_49
g_slow_61:
v_mfma_f32_16x16x32_bf16 v[228:231], v[172:175], a[196:199], v[228:231]
v_mfma_f32_16x16x32_bf16 v[224:227], v[176:179], a[200:203], v[224:227]
v_mfma_f32_16x16x32_bf16 v[228:231], v[180:183], a[200:203], v[228:231]
v_mfma_f32_16x16x32_bf16 v[224:227], v[184:187], a[204:207], v[224:227]
v_mfma_f32_16x16x32_bf16 v[228:231], v[188:191], a[204:207], v[228:231]
v_mfma_f32_16x16x32_bf16 v[224:227], v[192:195], a[208:211], v[224:227]
v_mfma_f32_16x16x32_bf16 v[228:231], v[196:199], a[208:211], v[228:231]
v_mfma_f32_16x16x32_bf16 v[224:227], v[200:203], a[212:215], v[224:227]
v_mfma_f32_16x16x32_bf16 v[228:231], v[204:207], a[212:215], v[228:231]
s_nop 6
v_cvt_pk_bf16_f32 v56, v224, v225
v_cvt_pk_bf16_f32 v57, v226, v227
v_cvt_pk_bf16_f32 v58, v228, v229
v_cvt_pk_bf16_f32 v59, v230, v231
buffer_store_dwordx4 v[56:59], v21, s[4:7], s81 offen sc1
s_mov_b32 s81, 1879048192
s_waitcnt vmcnt(4)
ds_write_b32 v18, v24
s_waitcnt lgkmcnt(0)
s_barrier
ds_read_b32 v33, v32
s_waitcnt lgkmcnt(0)
v_cmp_gt_u32 vcc, s52, v33
v_cmp_gt_u32 s[58:59], s54, v33
s_and_b32 vcc_lo, vcc_lo, s56
s_cselect_b32 s70, 0, 1
s_and_b32 s59, s59, s56
s_cselect_b32 s71, 0, s83
s_or_b32 s88, s70, s71
s_cselect_b32 s10, 268435456, 0
s_cmp_lg_u32 s70, 0
s_cselect_b64 s[84:85], s[52:53], s[54:55]
s_cselect_b64 s[58:59], s[44:45], s[46:47]
s_mul_i32 s86, s84, s20
s_add_u32 s86, s86, s58
s_mul_i32 s87, s84, s21
s_add_u32 s87, s87, s59
s_andn2_b32 s71, s71, s70
s_add_u32 s52, s52, s70
s_add_u32 s54, s54, s71
s_mov_b32 s89, s88
s_cmp_lg_u32 s88, 0
s_cbranch_scc1 g_go_68
v_mov_b32 v27, s78
s_waitcnt vmcnt(0)
s_barrier
s_add_u32 s70, s52, s54
s_cmp_eq_u32 s70, 130
s_cbranch_scc1 g_fin_52
s_cmp_lg_u32 s3, 0
s_cbranch_scc1 sp_ok_70_j
s_mov_b32 s23, 0
buffer_load_dword v33, v22, s[4:7], 0 offen sc1
buffer_store_dword v27, v45, s[4:7], s79 offen
buffer_store_dword v27, v44, s[4:7], s79 offen sc1
s_waitcnt vmcnt(2)
s_branch sp_loop_69_e
sp_loop_69:
buffer_load_dword v33, v22, s[4:7], 0 offen sc1
s_add_u32 s23, s23, 1
s_cmp_gt_u32 s23, 150000
s_cbranch_scc1 sp_bad_71
s_waitcnt vmcnt(0)
sp_loop_69_e:
v_cmp_gt_u32 vcc, s52, v33
v_cmp_gt_u32 s[58:59], s54, v33
s_and_b32 vcc_lo, vcc_lo, s56
s_cbranch_scc0 sp_ok_70
s_cmp_gt_u32 s23, 4
s_cselect_b32 s70, 0, s56
s_cmp_lg_u32 s83, 0
s_cselect_b32 s70, 0, s70
s_or_b32 s59, s59, s70
s_and_b32 s59, s59, s56
s_cbranch_scc0 sp_ok_70
s_sleep 1
s_branch sp_loop_69
sp_bad_71:
s_mov_b32 s98, 1026
s_branch L_fail
sp_ok_70:
ds_write_b32 v18, v33
s_waitcnt lgkmcnt(0)
sp_ok_70_j:
s_barrier
ds_read_b32 v33, v32
s_waitcnt lgkmcnt(0)
s_mov_b32 s79, 1879048192
v_cmp_gt_u32 vcc, s52, v33
v_cmp_gt_u32 s[58:59], s54, v33
s_and_b32 vcc_lo, vcc_lo, s56
s_cselect_b32 s70, 0, 1
s_and_b32 s59, s59, s56
s_cselect_b32 s71, 0, 1
s_or_b32 s88, s70, s71
s_cselect_b32 s10, 268435456, 0
s_cmp_lg_u32 s70, 0
s_cselect_b64 s[84:85], s[52:53], s[54:55]
s_cselect_b64 s[58:59], s[44:45], s[46:47]
s_mul_i32 s86, s84, s20
s_add_u32 s86, s86, s58
s_mul_i32 s87, s84, s21
s_add_u32 s87, s87, s59
s_andn2_b32 s71, s71, s70
s_add_u32 s52, s52, s70
s_add_u32 s54, s54, s71
s_mov_b32 s89, s88
g_go_68:
s_add_u32 m0, s50, 0
s_nop 0
buffer_load_dwordx4 v8, s[4:7], s86 offen offset:0 sc1 lds
buffer_load_dwordx4 v9, s[4:7], s86 offen offset:1024 sc1 lds
buffer_load_dwordx4 v10, s[4:7], s86 offen offset:2048 sc1 lds
buffer_load_dwordx4 v11, s[4:7], s86 offen offset:3072 sc1 lds
s_add_u32 m0, s50, 4096
s_nop 0
buffer_load_dwordx4 v12, s[4:7], s86 offen offset:0 sc1 lds
buffer_load_dwordx4 v13, s[4:7], s86 offen offset:1024 sc1 lds
buffer_load_dwordx4 v14, s[4:7], s86 offen offset:2048 sc1 lds
buffer_load_dwordx4 v15, s[4:7], s86 offen offset:3072 sc1 lds
s_add_u32 m0, s50, 8192
s_nop 0
buffer_load_dwordx4 v16, s[4:7], s86 offen offset:0 sc1 lds
buffer_load_dword v24, v22, s[4:7], 0 offen sc1
buffer_store_dword v27, v34, s[4:7], 0 offen
v_mov_b32 v27, s78
s_waitcnt vmcnt(9)
s_barrier
buffer_store_dword v27, v45, s[4:7], s79 offen
buffer_store_dword v27, v44, s[4:7], s79 offen sc1
s_mov_b32 s79, 1879048192
ds_read_b128 v[64:67], v30 offset:0
ds_read_b128 v[68:71], v30 offset:9216
ds_read_b128 v[72:75], v30 offset:18432
ds_read_b128 v[76:79], v30 offset:27648
ds_read_b128 v[80:83], v30 offset:1024
ds_read_b128 v[84:87], v30 offset:10240
ds_read_b128 v[88:91], v30 offset:19456
ds_read_b128 v[92:95], v30 offset:28672
s_waitcnt vmcnt(8)
s_barrier
s_branch g_body_50
g_slow_62:
v_mfma_f32_16x16x32_bf16 v[228:231], v[172:175], a[196:199], v[228:231]
v_mfma_f32_16x16x32_bf16 v[224:227], v[176:179], a[200:203], v[224:227]
v_mfma_f32_16x16x32_bf16 v[228:231], v[180:183], a[200:203], v[228:231]
v_mfma_f32_16x16x32_bf16 v[224:227], v[184:187], a[204:207], v[224:227]
v_mfma_f32_16x16x32_bf16 v[228:231], v[188:191], a[204:207], v[228:231]
v_mfma_f32_16x16x32_bf16 v[224:227], v[192:195], a[208:211], v[224:227]
v_mfma_f32_16x16x32_bf16 v[228:231], v[196:199], a[208:211], v[228:231]
v_mfma_f32_16x16x32_bf16 v[224:227], v[200:203], a[212:215], v[224:227]
v_mfma_f32_16x16x32_bf16 v[228:231], v[204:207], a[212:215], v[228:231]
s_nop 6
v_cvt_pk_bf16_f32 v56, v224, v225
v_cvt_pk_bf16_f32 v57, v226, v227
v_cvt_pk_bf16_f32 v58, v228, v229
v_cvt_pk_bf16_f32 v59, v230, v231
buffer_store_dwordx4 v[56:59], v21, s[4:7], s87 offen sc1
s_mov_b32 s87, 1879048192
s_waitcnt vmcnt(4)
ds_write_b32 v18, v24
s_waitcnt lgkmcnt(0)
s_barrier
ds_read_b32 v33, v32
s_waitcnt lgkmcnt(0)
v_cmp_gt_u32 vcc, s52, v33
v_cmp_gt_u32 s[58:59], s54, v33
s_and_b32 vcc_lo, vcc_lo, s56
s_cselect_b32 s70, 0, 1
s_and_b32 s59, s59, s56
s_cselect_b32 s71, 0, s89
s_or_b32 s94, s70, s71
s_cselect_b32 s10, 268435456, 0
s_cmp_lg_u32 s70, 0
s_cselect_b64 s[90:91], s[52:53], s[54:55]
s_cselect_b64 s[58:59], s[44:45], s[46:47]
s_mul_i32 s92, s90, s20
s_add_u32 s92, s92, s58
s_mul_i32 s93, s90, s21
s_add_u32 s93, s93, s59
s_andn2_b32 s71, s71, s70
s_add_u32 s52, s52, s70
s_add_u32 s54, s54, s71
s_mov_b32 s95, s94
s_cmp_lg_u32 s94, 0
s_cbranch_scc1 g_go_72
v_mov_b32 v27, s84
s_waitcnt vmcnt(0)
s_barrier
s_add_u32 s70, s52, s54
s_cmp_eq_u32 s70, 130
s_cbranch_scc1 g_fin_52
s_cmp_lg_u32 s3, 0
s_cbranch_scc1 sp_ok_74_j
s_mov_b32 s23, 0
buffer_load_dword v33, v22, s[4:7], 0 offen sc1
buffer_store_dword v27, v45, s[4:7], s85 offen
buffer_store_dword v27, v44, s[4:7], s85 offen sc1
s_waitcnt vmcnt(2)
s_branch sp_loop_73_e
sp_loop_73:
buffer_load_dword v33, v22, s[4:7], 0 offen sc1
s_add_u32 s23, s23, 1
s_cmp_gt_u32 s23, 150000
s_cbranch_scc1 sp_bad_75
s_waitcnt vmcnt(0)
sp_loop_73_e:
v_cmp_gt_u32 vcc, s52, v33
v_cmp_gt_u32 s[58:59], s54, v33
s_and_b32 vcc_lo, vcc_lo, s56
s_cbranch_scc0 sp_ok_74
s_cmp_gt_u32 s23, 4
s_cselect_b32 s70, 0, s56
s_cmp_lg_u32 s89, 0
s_cselect_b32 s70, 0, s70
s_or_b32 s59, s59, s70
s_and_b32 s59, s59, s56
s_cbranch_scc0 sp_ok_74
s_sleep 1
s_branch sp_loop_73
sp_bad_75:
s_mov_b32 s98, 1026
s_branch L_fail
sp_ok_74:
ds_write_b32 v18, v33
s_waitcnt lgkmcnt(0)
sp_ok_74_j:
s_barrier
ds_read_b32 v33, v32
s_waitcnt lgkmcnt(0)
s_mov_b32 s85, 1879048192
v_cmp_gt_u32 vcc, s52, v33
v_cmp_gt_u32 s[58:59], s54, v33
s_and_b32 vcc_lo, vcc_lo, s56
s_cselect_b32 s70, 0, 1
s_and_b32 s59, s59, s56
s_cselect_b32 s71, 0, 1
s_or_b32 s94, s70, s71
s_cselect_b32 s10, 268435456, 0
s_cmp_lg_u32 s70, 0
s_cselect_b64 s[90:91], s[52:53], s[54:55]
s_cselect_b64 s[58:59], s[44:45], s[46:47]
s_mul_i32 s92, s90, s20
s_add_u32 s92, s92, s58
s_mul_i32 s93, s90, s21
s_add_u32 s93, s93, s59
s_andn2_b32 s71, s71, s70
s_add_u32 s52, s52, s70
s_add_u32 s54, s54, s71
s_mov_b32 s95, s94
g_go_72:
s_add_u32 m0, s51, 0
s_nop 0
buffer_load_dwordx4 v8, s[4:7], s92 offen offset:0 sc1 lds
buffer_load_dwordx4 v9, s[4:7], s92 offen offset:1024 sc1 lds
buffer_load_dwordx4 v10, s[4:7], s92 offen offset:2048 sc1 lds
buffer_load_dwordx4 v11, s[4:7], s92 offen offset:3072 sc1 lds
s_add_u32 m0, s51, 4096
s_nop 0
buffer_load_dwordx4 v12, s[4:7], s92 offen offset:0 sc1 lds
buffer_load_dwordx4 v13, s[4:7], s92 offen offset:1024 sc1 lds
buffer_load_dwordx4 v14, s[4:7], s92 offen offset:2048 sc1 lds
buffer_load_dwordx4 v15, s[4:7], s92 offen offset:3072 sc1 lds
s_add_u32 m0, s51, 8192
s_nop 0
buffer_load_dwordx4 v16, s[4:7], s92 offen offset:0 sc1 lds
buffer_load_dword v24, v22, s[4:7], 0 offen sc1
buffer_store_dword v27, v34, s[4:7], 0 offen
v_mov_b32 v27, s84
s_waitcnt vmcnt(9)
s_barrier
buffer_store_dword v27, v45, s[4:7], s85 offen
buffer_store_dword v27, v44, s[4:7], s85 offen sc1
s_mov_b32 s85, 1879048192
ds_read_b128 v[64:67], v31 offset:0
ds_read_b128 v[68:71], v31 offset:9216
ds_read_b128 v[72:75], v31 offset:18432
ds_read_b128 v[76:79], v31 offset:27648
ds_read_b128 v[80:83], v31 offset:1024
ds_read_b128 v[84:87], v31 offset:10240
ds_read_b128 v[88:91], v31 offset:19456
ds_read_b128 v[92:95], v31 offset:28672
s_waitcnt vmcnt(8)
s_barrier
s_branch g_body_51
g_slow_63:
v_mfma_f32_16x16x32_bf16 v[228:231], v[172:175], a[196:199], v[228:231]
v_mfma_f32_16x16x32_bf16 v[224:227], v[176:179], a[200:203], v[224:227]
v_mfma_f32_16x16x32_bf16 v[228:231], v[180:183], a[200:203], v[228:231]
v_mfma_f32_16x16x32_bf16 v[224:227], v[184:187], a[204:207], v[224:227]
v_mfma_f32_16x16x32_bf16 v[228:231], v[188:191], a[204:207], v[228:231]
v_mfma_f32_16x16x32_bf16 v[224:227], v[192:195], a[208:211], v[224:227]
v_mfma_f32_16x16x32_bf16 v[228:231], v[196:199], a[208:211], v[228:231]
v_mfma_f32_16x16x32_bf16 v[224:227], v[200:203], a[212:215], v[224:227]
v_mfma_f32_16x16x32_bf16 v[228:231], v[204:207], a[212:215], v[228:231]
s_nop 6
v_cvt_pk_bf16_f32 v56, v224, v225
v_cvt_pk_bf16_f32 v57, v226, v227
v_cvt_pk_bf16_f32 v58, v228, v229
v_cvt_pk_bf16_f32 v59, v230, v231
buffer_store_dwordx4 v[56:59], v21, s[4:7], s93 offen sc1
s_mov_b32 s93, 1879048192
s_waitcnt vmcnt(4)
ds_write_b32 v18, v24
s_waitcnt lgkmcnt(0)
s_barrier
ds_read_b32 v33, v32
s_waitcnt lgkmcnt(0)
v_cmp_gt_u32 vcc, s52, v33
v_cmp_gt_u32 s[58:59], s54, v33
s_and_b32 vcc_lo, vcc_lo, s56
s_cselect_b32 s70, 0, 1
s_and_b32 s59, s59, s56
s_cselect_b32 s71, 0, s95
s_or_b32 s76, s70, s71
s_cselect_b32 s10, 268435456, 0
s_cmp_lg_u32 s70, 0
s_cselect_b64 s[72:73], s[52:53], s[54:55]
s_cselect_b64 s[58:59], s[44:45], s[46:47]
s_mul_i32 s74, s72, s20
s_add_u32 s74, s74, s58
s_mul_i32 s75, s72, s21
s_add_u32 s75, s75, s59
s_andn2_b32 s71, s71, s70
s_add_u32 s52, s52, s70
s_add_u32 s54, s54, s71
s_mov_b32 s77, s76
s_cmp_lg_u32 s76, 0
s_cbranch_scc1 g_go_76
v_mov_b32 v27, s90
s_waitcnt vmcnt(0)
s_barrier
s_add_u32 s70, s52, s54
s_cmp_eq_u32 s70, 130
s_cbranch_scc1 g_fin_52
s_cmp_lg_u32 s3, 0
s_cbranch_scc1 sp_ok_78_j
s_mov_b32 s23, 0
buffer_load_dword v33, v22, s[4:7], 0 offen sc1
buffer_store_dword v27, v45, s[4:7], s91 offen
buffer_store_dword v27, v44, s[4:7], s91 offen sc1
s_waitcnt vmcnt(2)
s_branch sp_loop_77_e
sp_loop_77:
buffer_load_dword v33, v22, s[4:7], 0 offen sc1
s_add_u32 s23, s23, 1
s_cmp_gt_u32 s23, 150000
s_cbranch_scc1 sp_bad_79
s_waitcnt vmcnt(0)
sp_loop_77_e:
v_cmp_gt_u32 vcc, s52, v33
v_cmp_gt_u32 s[58:59], s54, v33
s_and_b32 vcc_lo, vcc_lo, s56
s_cbranch_scc0 sp_ok_78
s_cmp_gt_u32 s23, 4
s_cselect_b32 s70, 0, s56
s_cmp_lg_u32 s95, 0
s_cselect_b32 s70, 0, s70
s_or_b32 s59, s59, s70
s_and_b32 s59, s59, s56
s_cbranch_scc0 sp_ok_78
s_sleep 1
s_branch sp_loop_77
sp_bad_79:
s_mov_b32 s98, 1026
s_branch L_fail
sp_ok_78:
ds_write_b32 v18, v33
s_waitcnt lgkmcnt(0)
sp_ok_78_j:
s_barrier
ds_read_b32 v33, v32
s_waitcnt lgkmcnt(0)
s_mov_b32 s91, 1879048192
v_cmp_gt_u32 vcc, s52, v33
v_cmp_gt_u32 s[58:59], s54, v33
s_and_b32 vcc_lo, vcc_lo, s56
s_cselect_b32 s70, 0, 1
s_and_b32 s59, s59, s56
s_cselect_b32 s71, 0, 1
s_or_b32 s76, s70, s71
s_cselect_b32 s10, 268435456, 0
s_cmp_lg_u32 s70, 0
s_cselect_b64 s[72:73], s[52:53], s[54:55]
s_cselect_b64 s[58:59], s[44:45], s[46:47]
s_mul_i32 s74, s72, s20
s_add_u32 s74, s74, s58
s_mul_i32 s75, s72, s21
s_add_u32 s75, s75, s59
s_andn2_b32 s71, s71, s70
s_add_u32 s52, s52, s70
s_add_u32 s54, s54, s71
s_mov_b32 s77, s76
g_go_76:
s_add_u32 m0, s48, 0
s_nop 0
buffer_load_dwordx4 v8, s[4:7], s74 offen offset:0 sc1 lds
buffer_load_dwordx4 v9, s[4:7], s74 offen offset:1024 sc1 lds
buffer_load_dwordx4 v10, s[4:7], s74 offen offset:2048 sc1 lds
buffer_load_dwordx4 v11, s[4:7], s74 offen offset:3072 sc1 lds
s_add_u32 m0, s48, 4096
s_nop 0
buffer_load_dwordx4 v12, s[4:7], s74 offen offset:0 sc1 lds
buffer_load_dwordx4 v13, s[4:7], s74 offen offset:1024 sc1 lds
buffer_load_dwordx4 v14, s[4:7], s74 offen offset:2048 sc1 lds
buffer_load_dwordx4 v15, s[4:7], s74 offen offset:3072 sc1 lds
s_add_u32 m0, s48, 8192
s_nop 0
buffer_load_dwordx4 v16, s[4:7], s74 offen offset:0 sc1 lds
buffer_load_dword v24, v22, s[4:7], 0 offen sc1
buffer_store_dword v27, v34, s[4:7], 0 offen
v_mov_b32 v27, s90
s_waitcnt vmcnt(9)
s_barrier
buffer_store_dword v27, v45, s[4:7], s91 offen
buffer_store_dword v27, v44, s[4:7], s91 offen sc1
s_mov_b32 s91, 1879048192
ds_read_b128 v[64:67], v28 offset:0
ds_read_b128 v[68:71], v28 offset:9216
ds_read_b128 v[72:75], v28 offset:18432
ds_read_b128 v[76:79], v28 offset:27648
ds_read_b128 v[80:83], v28 offset:1024
ds_read_b128 v[84:87], v28 offset:10240
ds_read_b128 v[88:91], v28 offset:19456
ds_read_b128 v[92:95], v28 offset:28672
s_waitcnt vmcnt(8)
s_barrier
s_branch g_body_48
g_fin_52:
buffer_store_dword v27, v45, s[4:7], s91 offen
buffer_store_dword v27, v44, s[4:7], s91 offen sc1
s_endpgm
G_sss18:
s_mov_b32 s8, s42
s_and_b32 s9, s43, 0xffff
s_mov_b32 s10, 0
s_mov_b32 s11, 0x20000
s_mov_b32 s22, 0
s_mul_i32 s48, s3, 9216
s_add_u32 s49, s48, 36864
s_add_u32 s50, s48, 73728
s_add_u32 s51, s48, 110592
s_mov_b32 s57, 0xbfb8aa3b
v_add_u32 v28, 0, v17
v_add_u32 v29, 36864, v17
v_add_u32 v30, 73728, v17
v_add_u32 v31, 110592, v17
v_lshlrev_b32 v1, 2, v0
v_add_u32 v32, 147456, v1
s_lshl_b32 s70, s3, 8
v_add_u32 v18, s70, v32
v_mov_b64 v[224:225], 0
v_mov_b64 v[236:237], 0
v_mov_b64 v[226:227], 0
v_mov_b64 v[238:239], 0
v_mov_b64 v[228:229], 0
v_mov_b64 v[240:241], 0
v_mov_b64 v[230:231], 0
v_mov_b64 v[242:243], 0
s_mov_b32 s12, s40
s_and_b32 s13, s41, 0xffff
s_mov_b32 s14, 256
s_mov_b32 s15, 0x20000
v_lshlrev_b32 v26, 2, v0
v_add_u32 v27, 128, v26
v_cmp_le_u32 vcc, 2, v0
s_nop 1
v_cndmask_b32 v26, v26, v27, vcc
v_mov_b32 v27, 192
v_cmp_eq_u32 vcc, 8, v0
s_nop 1
v_cndmask_b32 v26, v26, v27, vcc
v_mov_b32 v27, 2147483632
v_cmp_lt_u32 vcc, 8, v0
s_nop 1
v_cndmask_b32 v26, v26, v27, vcc
s_mov_b32 s98, 0
wi_loop_85:
buffer_load_dword v27, v26, s[12:15], 0 offen sc1
s_add_u32 s98, s98, 1
s_cmp_gt_u32 s98, 150000
s_cbranch_scc1 wi_bad_87
s_waitcnt vmcnt(0)
v_cmp_eq_u32 vcc, 32, v27
s_nop 0
s_and_b32 s97, vcc_lo, 0x1ff
s_cmp_eq_u32 s97, 0x1ff
s_cbranch_scc1 wi_ok_86
v_cmp_lt_u32 vcc, 32, v27
s_nop 0
s_and_b32 s96, vcc_lo, 0xff
s_cselect_b32 s96, 0x100, 0
s_and_b32 s96, s96, s97
s_cbranch_scc1 wi_over_88
s_sleep 8
s_branch wi_loop_85
wi_bad_87:
s_mov_b32 s98, 512
s_branch L_fail
wi_over_88:
s_mov_b32 s100, 255
wi_ok_86:
v_add_u32 v26, 65536, v22
v_cmp_eq_u32 vcc, s100, v23
s_nop 1
v_cndmask_b32 v22, v22, v26, vcc
s_mov_b32 s90, 0
s_mov_b32 s91, 1879048192
s_mov_b32 s93, 1879048192
v_mov_b32 v34, 2147483632
s_barrier
s_mov_b32 s95, 1
s_cmp_lg_u32 s3, 0
s_cbranch_scc1 sp_ok_90_j
s_mov_b32 s23, 0
sp_loop_89:
buffer_load_dword v33, v22, s[4:7], 0 offen sc1
s_add_u32 s23, s23, 1
s_cmp_gt_u32 s23, 150000
s_cbranch_scc1 sp_bad_91
s_waitcnt vmcnt(0)
sp_loop_89_e:
v_cmp_gt_u32 vcc, s52, v33
v_cmp_gt_u32 s[58:59], s54, v33
s_and_b32 vcc_lo, vcc_lo, s56
s_cbranch_scc0 sp_ok_90
s_cmp_gt_u32 s23, 4
s_cselect_b32 s70, 0, s56
s_cmp_lg_u32 s95, 0
s_cselect_b32 s70, 0, s70
s_or_b32 s59, s59, s70
s_and_b32 s59, s59, s56
s_cbranch_scc0 sp_ok_90
s_sleep 1
s_branch sp_loop_89
sp_bad_91:
s_mov_b32 s98, 1027
s_branch L_fail
sp_ok_90:
ds_write_b32 v18, v33
s_waitcnt lgkmcnt(0)
sp_ok_90_j:
s_barrier
ds_read_b32 v33, v32
s_waitcnt lgkmcnt(0)
v_cmp_gt_u32 vcc, s52, v33
v_cmp_gt_u32 s[58:59], s54, v33
s_and_b32 vcc_lo, vcc_lo, s56
s_cselect_b32 s70, 0, 1
s_and_b32 s59, s59, s56
s_cselect_b32 s71, 0, 1
s_or_b32 s76, s70, s71
s_cselect_b32 s10, 268435456, 0
s_cmp_lg_u32 s70, 0
s_cselect_b64 s[72:73], s[52:53], s[54:55]
s_cselect_b64 s[58:59], s[44:45], s[46:47]
s_mul_i32 s74, s72, s20
s_add_u32 s74, s74, s58
s_mul_i32 s75, s72, s21
s_add_u32 s75, s75, s59
s_andn2_b32 s71, s71, s70
s_add_u32 s52, s52, s70
s_add_u32 s54, s54, s71
s_mov_b32 s77, s76
s_add_u32 m0, s48, 0
s_nop 0
buffer_load_dwordx4 v8, s[4:7], s74 offen offset:0 sc1 lds
buffer_load_dwordx4 v9, s[4:7], s74 offen offset:1024 sc1 lds
buffer_load_dwordx4 v10, s[4:7], s74 offen offset:2048 sc1 lds
buffer_load_dwordx4 v11, s[4:7], s74 offen offset:3072 sc1 lds
s_add_u32 m0, s48, 4096
s_nop 0
buffer_load_dwordx4 v12, s[4:7], s74 offen offset:0 sc1 lds
buffer_load_dwordx4 v13, s[4:7], s74 offen offset:1024 sc1 lds
buffer_load_dwordx4 v14, s[4:7], s74 offen offset:2048 sc1 lds
buffer_load_dwordx4 v15, s[4:7], s74 offen offset:3072 sc1 lds
s_add_u32 m0, s48, 8192
s_nop 0
buffer_load_dwordx4 v16, s[4:7], s74 offen offset:0 sc1 lds
buffer_load_dword v24, v22, s[4:7], 0 offen sc1
buffer_store_dword v27, v34, s[4:7], 0 offen
v_mov_b32 v27, s90
s_waitcnt vmcnt(9)
s_barrier
buffer_store_dword v27, v45, s[4:7], s91 offen
buffer_store_dword v27, v44, s[4:7], s91 offen sc1
s_mov_b32 s91, 1879048192
ds_read_b128 v[64:67], v28 offset:0
ds_read_b128 v[68:71], v28 offset:9216
ds_read_b128 v[72:75], v28 offset:18432
ds_read_b128 v[76:79], v28 offset:27648
ds_read_b128 v[80:83], v28 offset:1024
ds_read_b128 v[84:87], v28 offset:10240
ds_read_b128 v[88:91], v28 offset:19456
ds_read_b128 v[92:95], v28 offset:28672
s_waitcnt vmcnt(8)
s_barrier
s_branch g_body_80
g_body_80:
s_waitcnt lgkmcnt(4)
v_mfma_f32_16x16x32_bf16 v[208:211], a[0:3], v[64:67], 0
ds_read_b128 v[96:99], v28 offset:2048
v_mfma_f32_16x16x32_bf16 v[212:215], a[0:3], v[68:71], 0
ds_read_b128 v[100:103], v28 offset:11264
v_mfma_f32_16x16x32_bf16 v[216:219], a[72:75], v[64:67], 0
v_mfma_f32_16x16x32_bf16 v[208:211], a[4:7], v[72:75], v[208:211]
ds_read_b128 v[104:107], v28 offset:20480
v_cvt_pk_bf16_f32 v56, v224, v225
v_mfma_f32_16x16x32_bf16 v[212:215], a[4:7], v[76:79], v[212:215]
ds_read_b128 v[108:111], v28 offset:29696
v_cvt_pk_bf16_f32 v57, v226, v227
v_mfma_f32_16x16x32_bf16 v[220:223], a[72:75], v[68:71], 0
v_cvt_pk_bf16_f32 v58, v228, v229
s_waitcnt lgkmcnt(4)
v_mfma_f32_16x16x32_bf16 v[208:211], a[8:11], v[80:83], v[208:211]
ds_read_b128 v[112:115], v28 offset:3072
v_cvt_pk_bf16_f32 v59, v230, v231
v_mfma_f32_16x16x32_bf16 v[212:215], a[8:11], v[84:87], v[212:215]
ds_read_b128 v[116:119], v28 offset:12288
v_permlane16_swap_b32 v56, v58
v_mfma_f32_16x16x32_bf16 v[216:219], a[76:79], v[72:75], v[216:219]
v_permlane16_swap_b32 v57, v59
v_mfma_f32_16x16x32_bf16 v[208:211], a[12:15], v[88:91], v[208:211]
ds_read_b128 v[120:123], v28 offset:21504
v_mfma_f32_16x16x32_bf16 v[212:215], a[12:15], v[92:95], v[212:215]
ds_read_b128 v[124:127], v28 offset:30720
v_mfma_f32_16x16x32_bf16 v[220:223], a[76:79], v[76:79], v[220:223]
s_waitcnt lgkmcnt(4)
v_mfma_f32_16x16x32_bf16 v[208:211], a[16:19], v[96:99], v[208:211]
ds_read_b128 v[128:131], v28 offset:4096
v_mfma_f32_16x16x32_bf16 v[212:215], a[16:19], v[100:103], v[212:215]
ds_read_b128 v[132:135], v28 offset:13312
v_mfma_f32_16x16x32_bf16 v[216:219], a[80:83], v[80:83], v[216:219]
buffer_store_dwordx4 v[56:59], v21, s[4:7], s93 offen sc1
v_mfma_f32_16x16x32_bf16 v[208:211], a[20:23], v[104:107], v[208:211]
ds_read_b128 v[136:139], v28 offset:22528
v_mfma_f32_16x16x32_bf16 v[212:215], a[20:23], v[108:111], v[212:215]
ds_read_b128 v[140:143], v28 offset:31744
v_mfma_f32_16x16x32_bf16 v[220:223], a[80:83], v[84:87], v[220:223]
s_waitcnt vmcnt(5)
s_barrier
s_waitcnt lgkmcnt(4)
v_mfma_f32_16x16x32_bf16 v[208:211], a[24:27], v[112:115], v[208:211]
ds_read_b128 v[144:147], v28 offset:5120
v_mov_b32 v27, s90
v_mfma_f32_16x16x32_bf16 v[212:215], a[24:27], v[116:119], v[212:215]
ds_read_b128 v[148:151], v28 offset:14336
v_mfma_f32_16x16x32_bf16 v[216:219], a[84:87], v[88:91], v[216:219]
v_mfma_f32_16x16x32_bf16 v[208:211], a[28:31], v[120:123], v[208:211]
ds_read_b128 v[152:155], v28 offset:23552
v_mfma_f32_16x16x32_bf16 v[212:215], a[28:31], v[124:127], v[212:215]
ds_read_b128 v[156:159], v28 offset:32768
v_mfma_f32_16x16x32_bf16 v[220:223], a[84:87], v[92:95], v[220:223]
s_waitcnt lgkmcnt(4)
v_mfma_f32_16x16x32_bf16 v[208:211], a[32:35], v[128:131], v[208:211]
ds_read_b128 v[160:163], v28 offset:6144
v_mfma_f32_16x16x32_bf16 v[212:215], a[32:35], v[132:135], v[212:215]
ds_read_b128 v[164:167], v28 offset:15360
v_mfma_f32_16x16x32_bf16 v[216:219], a[88:91], v[96:99], v[216:219]
v_mfma_f32_16x16x32_bf16 v[208:211], a[36:39], v[136:139], v[208:211]
ds_read_b128 v[168:171], v28 offset:24576
v_mfma_f32_16x16x32_bf16 v[212:215], a[36:39], v[140:143], v[212:215]
ds_read_b128 v[172:175], v28 offset:33792
v_mfma_f32_16x16x32_bf16 v[220:223], a[88:91], v[100:103], v[220:223]
s_waitcnt lgkmcnt(4)
v_mfma_f32_16x16x32_bf16 v[208:211], a[40:43], v[144:147], v[208:211]
ds_read_b128 v[176:179], v28 offset:7168
v_mfma_f32_16x16x32_bf16 v[212:215], a[40:43], v[148:151], v[212:215]
ds_read_b128 v[180:183], v28 offset:16384
s_waitcnt vmcnt(4)
ds_write_b32 v18, v24
v_mfma_f32_16x16x32_bf16 v[216:219], a[92:95], v[104:107], v[216:219]
v_mfma_f32_16x16x32_bf16 v[208:211], a[44:47], v[152:155], v[208:211]
ds_read_b128 v[184:187], v28 offset:25600
v_mfma_f32_16x16x32_bf16 v[212:215], a[44:47], v[156:159], v[212:215]
ds_read_b128 v[188:191], v28 offset:34816
s_waitcnt lgkmcnt(2)
s_barrier
v_mfma_f32_16x16x32_bf16 v[220:223], a[92:95], v[108:111], v[220:223]
ds_read_b32 v33, v32
v_mfma_f32_16x16x32_bf16 v[208:211], a[48:51], v[160:163], v[208:211]
ds_read_b128 v[192:195], v28 offset:8192
v_mfma_f32_16x16x32_bf16 v[212:215], a[48:51], v[164:167], v[212:215]
ds_read_b128 v[196:199], v28 offset:17408
v_mfma_f32_16x16x32_bf16 v[216:219], a[96:99], v[112:115], v[216:219]
s_waitcnt lgkmcnt(2)
v_cmp_gt_u32 vcc, s52, v33
v_mfma_f32_16x16x32_bf16 v[208:211], a[52:55], v[168:171], v[208:211]
ds_read_b128 v[200:203], v28 offset:26624
v_cmp_gt_u32 s[58:59], s54, v33
v_mfma_f32_16x16x32_bf16 v[212:215], a[52:55], v[172:175], v[212:215]
ds_read_b128 v[204:207], v28 offset:35840
s_and_b32 vcc_lo, vcc_lo, s56
s_cselect_b32 s70, 0, 1
v_mfma_f32_16x16x32_bf16 v[220:223], a[96:99], v[116:119], v[220:223]
v_mfma_f32_16x16x32_bf16 v[208:211], a[56:59], v[176:179], v[208:211]
s_and_b32 s59, s59, s56
s_cselect_b32 s71, 0, s77
v_mfma_f32_16x16x32_bf16 v[212:215], a[56:59], v[180:183], v[212:215]
s_or_b32 s82, s70, s71
s_cselect_b32 s10, 268435456, 0
v_mfma_f32_16x16x32_bf16 v[216:219], a[100:103], v[120:123], v[216:219]
s_cmp_lg_u32 s70, 0
s_cselect_b64 s[78:79], s[52:53], s[54:55]
s_cselect_b64 s[58:59], s[44:45], s[46:47]
v_mfma_f32_16x16x32_bf16 v[208:211], a[60:63], v[184:187], v[208:211]
s_mul_i32 s80, s78, s20
s_add_u32 s80, s80, s58
v_mfma_f32_16x16x32_bf16 v[212:215], a[60:63], v[188:191], v[212:215]
s_add_u32 m0, s49, 0
s_mul_i32 s81, s78, s21
s_add_u32 s81, s81, s59
v_mfma_f32_16x16x32_bf16 v[220:223], a[100:103], v[124:127], v[220:223]
buffer_load_dwordx4 v8, s[8:11], s80 offen offset:0 sc1 lds
s_waitcnt lgkmcnt(0)
v_mfma_f32_16x16x32_bf16 v[208:211], a[64:67], v[192:195], v[208:211]
s_andn2_b32 s71, s71, s70
s_add_u32 s52, s52, s70
s_add_u32 s54, s54, s71
v_mfma_f32_16x16x32_bf16 v[212:215], a[64:67], v[196:199], v[212:215]
s_mov_b32 s83, s82
v_mfma_f32_16x16x32_bf16 v[216:219], a[104:107], v[128:131], v[216:219]
buffer_load_dwordx4 v9, s[8:11], s80 offen offset:1024 sc1 lds
v_mfma_f32_16x16x32_bf16 v[208:211], a[68:71], v[200:203], v[208:211]
v_mfma_f32_16x16x32_bf16 v[212:215], a[68:71], v[204:207], v[212:215]
v_mfma_f32_16x16x32_bf16 v[220:223], a[104:107], v[132:135], v[220:223]
buffer_load_dwordx4 v10, s[8:11], s80 offen offset:2048 sc1 lds
v_mfma_f32_16x16x32_bf16 v[216:219], a[108:111], v[136:139], v[216:219]
v_mfma_f32_16x16x32_bf16 v[220:223], a[108:111], v[140:143], v[220:223]
v_mfma_f32_16x16x32_bf16 v[216:219], a[112:115], v[144:147], v[216:219]
buffer_load_dwordx4 v11, s[8:11], s80 offen offset:3072 sc1 lds
v_mfma_f32_16x16x32_bf16 v[220:223], a[112:115], v[148:151], v[220:223]
v_mfma_f32_16x16x32_bf16 v[216:219], a[116:119], v[152:155], v[216:219]
s_add_u32 m0, s49, 4096
v_cvt_pk_bf16_f32 v48, v208, v209
v_mfma_f32_16x16x32_bf16 v[220:223], a[116:119], v[156:159], v[220:223]
buffer_load_dwordx4 v12, s[8:11], s80 offen offset:0 sc1 lds
v_mfma_f32_16x16x32_bf16 v[216:219], a[120:123], v[160:163], v[216:219]
v_cvt_pk_bf16_f32 v49, v210, v211
v_cvt_pk_bf16_f32 v50, v212, v213
v_mfma_f32_16x16x32_bf16 v[220:223], a[120:123], v[164:167], v[220:223]
v_cvt_pk_bf16_f32 v51, v214, v215
v_mfma_f32_16x16x32_bf16 v[216:219], a[124:127], v[168:171], v[216:219]
buffer_load_dwordx4 v13, s[8:11], s80 offen offset:1024 sc1 lds
v_mfma_f32_16x16x32_bf16 v[220:223], a[124:127], v[172:175], v[220:223]
v_permlane16_swap_b32 v48, v50
v_mfma_f32_16x16x32_bf16 v[216:219], a[128:131], v[176:179], v[216:219]
v_permlane16_swap_b32 v49, v51
v_mfma_f32_16x16x32_bf16 v[220:223], a[128:131], v[180:183], v[220:223]
buffer_load_dwordx4 v14, s[8:11], s80 offen offset:2048 sc1 lds
v_mfma_f32_16x16x32_bf16 v[216:219], a[132:135], v[184:187], v[216:219]
buffer_store_dwordx4 v[48:51], v19, s[4:7], s75 offen sc1
v_mfma_f32_16x16x32_bf16 v[220:223], a[132:135], v[188:191], v[220:223]
v_mfma_f32_16x16x32_bf16 v[216:219], a[136:139], v[192:195], v[216:219]
buffer_load_dwordx4 v15, s[8:11], s80 offen offset:3072 sc1 lds
v_mfma_f32_16x16x32_bf16 v[220:223], a[136:139], v[196:199], v[220:223]
v_mfma_f32_16x16x32_bf16 v[216:219], a[140:143], v[200:203], v[216:219]
s_add_u32 m0, s49, 8192
v_mfma_f32_16x16x32_bf16 v[220:223], a[140:143], v[204:207], v[220:223]
buffer_load_dwordx4 v16, s[8:11], s80 offen offset:0 sc1 lds
v_mfma_f32_16x16x32_bf16 v[224:227], a[144:147], v[64:67], 0
v_mfma_f32_16x16x32_bf16 v[228:231], a[144:147], v[68:71], 0
v_mfma_f32_16x16x32_bf16 v[224:227], a[148:151], v[72:75], v[224:227]
v_mfma_f32_16x16x32_bf16 v[228:231], a[148:151], v[76:79], v[228:231]
v_mfma_f32_16x16x32_bf16 v[224:227], a[152:155], v[80:83], v[224:227]
buffer_load_dword v24, v22, s[4:7], 0 offen sc1
v_mfma_f32_16x16x32_bf16 v[228:231], a[152:155], v[84:87], v[228:231]
v_cvt_pk_bf16_f32 v52, v216, v217
v_cvt_pk_bf16_f32 v53, v218, v219
v_mfma_f32_16x16x32_bf16 v[224:227], a[156:159], v[88:91], v[224:227]
s_waitcnt vmcnt(11)
s_barrier
v_mfma_f32_16x16x32_bf16 v[228:231], a[156:159], v[92:95], v[228:231]
buffer_store_dword v27, v45, s[4:7], s91 offen
v_mfma_f32_16x16x32_bf16 v[224:227], a[160:163], v[96:99], v[224:227]
buffer_store_dword v27, v44, s[4:7], s91 offen sc1
v_mfma_f32_16x16x32_bf16 v[228:231], a[160:163], v[100:103], v[228:231]
v_cvt_pk_bf16_f32 v54, v220, v221
v_cvt_pk_bf16_f32 v55, v222, v223
v_mfma_f32_16x16x32_bf16 v[224:227], a[164:167], v[104:107], v[224:227]
v_permlane16_swap_b32 v52, v54
v_mfma_f32_16x16x32_bf16 v[228:231], a[164:167], v[108:111], v[228:231]
v_permlane16_swap_b32 v53, v55
v_mfma_f32_16x16x32_bf16 v[224:227], a[168:171], v[112:115], v[224:227]
buffer_store_dwordx4 v[52:55], v20, s[4:7], s75 offen sc1
v_mfma_f32_16x16x32_bf16 v[228:231], a[168:171], v[116:119], v[228:231]
v_mfma_f32_16x16x32_bf16 v[224:227], a[172:175], v[120:123], v[224:227]
v_mfma_f32_16x16x32_bf16 v[228:231], a[172:175], v[124:127], v[228:231]
v_mfma_f32_16x16x32_bf16 v[224:227], a[176:179], v[128:131], v[224:227]
v_mfma_f32_16x16x32_bf16 v[228:231], a[176:179], v[132:135], v[228:231]
v_mfma_f32_16x16x32_bf16 v[224:227], a[180:183], v[136:139], v[224:227]
v_mfma_f32_16x16x32_bf16 v[228:231], a[180:183], v[140:143], v[228:231]
v_mfma_f32_16x16x32_bf16 v[224:227], a[184:187], v[144:147], v[224:227]
v_mfma_f32_16x16x32_bf16 v[228:231], a[184:187], v[148:151], v[228:231]
v_mfma_f32_16x16x32_bf16 v[224:227], a[188:191], v[152:155], v[224:227]
v_mfma_f32_16x16x32_bf16 v[228:231], a[188:191], v[156:159], v[228:231]
v_mfma_f32_16x16x32_bf16 v[224:227], a[192:195], v[160:163], v[224:227]
s_waitcnt vmcnt(12)
s_barrier
v_mfma_f32_16x16x32_bf16 v[228:231], a[192:195], v[164:167], v[228:231]
v_mfma_f32_16x16x32_bf16 v[224:227], a[196:199], v[168:171], v[224:227]
s_cmp_eq_u32 s82, 0
s_cbranch_scc1 g_slow_92
v_mfma_f32_16x16x32_bf16 v[228:231], a[196:199], v[172:175], v[228:231]
ds_read_b128 v[64:67], v29 offset:0
v_mfma_f32_16x16x32_bf16 v[224:227], a[200:203], v[176:179], v[224:227]
ds_read_b128 v[68:71], v29 offset:9216
v_mfma_f32_16x16x32_bf16 v[228:231], a[200:203], v[180:183], v[228:231]
ds_read_b128 v[72:75], v29 offset:18432
v_mfma_f32_16x16x32_bf16 v[224:227], a[204:207], v[184:187], v[224:227]
ds_read_b128 v[76:79], v29 offset:27648
v_mfma_f32_16x16x32_bf16 v[228:231], a[204:207], v[188:191], v[228:231]
ds_read_b128 v[80:83], v29 offset:1024
v_mfma_f32_16x16x32_bf16 v[224:227], a[208:211], v[192:195], v[224:227]
ds_read_b128 v[84:87], v29 offset:10240
v_mfma_f32_16x16x32_bf16 v[228:231], a[208:211], v[196:199], v[228:231]
ds_read_b128 v[88:91], v29 offset:19456
v_mfma_f32_16x16x32_bf16 v[224:227], a[212:215], v[200:203], v[224:227]
ds_read_b128 v[92:95], v29 offset:28672
v_mfma_f32_16x16x32_bf16 v[228:231], a[212:215], v[204:207], v[228:231]
s_waitcnt vmcnt(9)
s_barrier
g_body_81:
s_waitcnt lgkmcnt(4)
v_mfma_f32_16x16x32_bf16 v[208:211], a[0:3], v[64:67], 0
ds_read_b128 v[96:99], v29 offset:2048
v_mfma_f32_16x16x32_bf16 v[212:215], a[0:3], v[68:71], 0
ds_read_b128 v[100:103], v29 offset:11264
v_mfma_f32_16x16x32_bf16 v[216:219], a[72:75], v[64:67], 0
v_mfma_f32_16x16x32_bf16 v[208:211], a[4:7], v[72:75], v[208:211]
ds_read_b128 v[104:107], v29 offset:20480
v_cvt_pk_bf16_f32 v56, v224, v225
v_mfma_f32_16x16x32_bf16 v[212:215], a[4:7], v[76:79], v[212:215]
ds_read_b128 v[108:111], v29 offset:29696
v_cvt_pk_bf16_f32 v57, v226, v227
v_mfma_f32_16x16x32_bf16 v[220:223], a[72:75], v[68:71], 0
v_cvt_pk_bf16_f32 v58, v228, v229
s_waitcnt lgkmcnt(4)
v_mfma_f32_16x16x32_bf16 v[208:211], a[8:11], v[80:83], v[208:211]
ds_read_b128 v[112:115], v29 offset:3072
v_cvt_pk_bf16_f32 v59, v230, v231
v_mfma_f32_16x16x32_bf16 v[212:215], a[8:11], v[84:87], v[212:215]
ds_read_b128 v[116:119], v29 offset:12288
v_permlane16_swap_b32 v56, v58
v_mfma_f32_16x16x32_bf16 v[216:219], a[76:79], v[72:75], v[216:219]
v_permlane16_swap_b32 v57, v59
v_mfma_f32_16x16x32_bf16 v[208:211], a[12:15], v[88:91], v[208:211]
ds_read_b128 v[120:123], v29 offset:21504
v_mfma_f32_16x16x32_bf16 v[212:215], a[12:15], v[92:95], v[212:215]
ds_read_b128 v[124:127], v29 offset:30720
v_mfma_f32_16x16x32_bf16 v[220:223], a[76:79], v[76:79], v[220:223]
s_waitcnt lgkmcnt(4)
v_mfma_f32_16x16x32_bf16 v[208:211], a[16:19], v[96:99], v[208:211]
ds_read_b128 v[128:131], v29 offset:4096
v_mfma_f32_16x16x32_bf16 v[212:215], a[16:19], v[100:103], v[212:215]
ds_read_b128 v[132:135], v29 offset:13312
v_mfma_f32_16x16x32_bf16 v[216:219], a[80:83], v[80:83], v[216:219]
buffer_store_dwordx4 v[56:59], v21, s[4:7], s75 offen sc1
v_mfma_f32_16x16x32_bf16 v[208:211], a[20:23], v[104:107], v[208:211]
ds_read_b128 v[136:139], v29 offset:22528
v_mfma_f32_16x16x32_bf16 v[212:215], a[20:23], v[108:111], v[212:215]
ds_read_b128 v[140:143], v29 offset:31744
v_mfma_f32_16x16x32_bf16 v[220:223], a[80:83], v[84:87], v[220:223]
s_waitcnt vmcnt(5)
s_barrier
s_waitcnt lgkmcnt(4)
v_mfma_f32_16x16x32_bf16 v[208:211], a[24:27], v[112:115], v[208:211]
ds_read_b128 v[144:147], v29 offset:5120
v_mov_b32 v27, s72
v_mfma_f32_16x16x32_bf16 v[212:215], a[24:27], v[116:119], v[212:215]
ds_read_b128 v[148:151], v29 offset:14336
v_mfma_f32_16x16x32_bf16 v[216:219], a[84:87], v[88:91], v[216:219]
v_mfma_f32_16x16x32_bf16 v[208:211], a[28:31], v[120:123], v[208:211]
ds_read_b128 v[152:155], v29 offset:23552
v_mfma_f32_16x16x32_bf16 v[212:215], a[28:31], v[124:127], v[212:215]
ds_read_b128 v[156:159], v29 offset:32768
v_mfma_f32_16x16x32_bf16 v[220:223], a[84:87], v[92:95], v[220:223]
s_waitcnt lgkmcnt(4)
v_mfma_f32_16x16x32_bf16 v[208:211], a[32:35], v[128:131], v[208:211]
ds_read_b128 v[160:163], v29 offset:6144
v_mfma_f32_16x16x32_bf16 v[212:215], a[32:35], v[132:135], v[212:215]
ds_read_b128 v[164:167], v29 offset:15360
v_mfma_f32_16x16x32_bf16 v[216:219], a[88:91], v[96:99], v[216:219]
v_mfma_f32_16x16x32_bf16 v[208:211], a[36:39], v[136:139], v[208:211]
ds_read_b128 v[168:171], v29 offset:24576
v_mfma_f32_16x16x32_bf16 v[212:215], a[36:39], v[140:143], v[212:215]
ds_read_b128 v[172:175], v29 offset:33792
v_mfma_f32_16x16x32_bf16 v[220:223], a[88:91], v[100:103], v[220:223]
s_waitcnt lgkmcnt(4)
v_mfma_f32_16x16x32_bf16 v[208:211], a[40:43], v[144:147], v[208:211]
ds_read_b128 v[176:179], v29 offset:7168
v_mfma_f32_16x16x32_bf16 v[212:215], a[40:43], v[148:151], v[212:215]
ds_read_b128 v[180:183], v29 offset:16384
s_waitcnt vmcnt(4)
ds_write_b32 v18, v24
v_mfma_f32_16x16x32_bf16 v[216:219], a[92:95], v[104:107], v[216:219]
v_mfma_f32_16x16x32_bf16 v[208:211], a[44:47], v[152:155], v[208:211]
ds_read_b128 v[184:187], v29 offset:25600
v_mfma_f32_16x16x32_bf16 v[212:215], a[44:47], v[156:159], v[212:215]
ds_read_b128 v[188:191], v29 offset:34816
s_waitcnt lgkmcnt(2)
s_barrier
v_mfma_f32_16x16x32_bf16 v[220:223], a[92:95], v[108:111], v[220:223]
ds_read_b32 v33, v32
v_mfma_f32_16x16x32_bf16 v[208:211], a[48:51], v[160:163], v[208:211]
ds_read_b128 v[192:195], v29 offset:8192
v_mfma_f32_16x16x32_bf16 v[212:215], a[48:51], v[164:167], v[212:215]
ds_read_b128 v[196:199], v29 offset:17408
v_mfma_f32_16x16x32_bf16 v[216:219], a[96:99], v[112:115], v[216:219]
s_waitcnt lgkmcnt(2)
v_cmp_gt_u32 vcc, s52, v33
v_mfma_f32_16x16x32_bf16 v[208:211], a[52:55], v[168:171], v[208:211]
ds_read_b128 v[200:203], v29 offset:26624
v_cmp_gt_u32 s[58:59], s54, v33
v_mfma_f32_16x16x32_bf16 v[212:215], a[52:55], v[172:175], v[212:215]
ds_read_b128 v[204:207], v29 offset:35840
s_and_b32 vcc_lo, vcc_lo, s56
s_cselect_b32 s70, 0, 1
v_mfma_f32_16x16x32_bf16 v[220:223], a[96:99], v[116:119], v[220:223]
v_mfma_f32_16x16x32_bf16 v[208:211], a[56:59], v[176:179], v[208:211]
s_and_b32 s59, s59, s56
s_cselect_b32 s71, 0, s83
v_mfma_f32_16x16x32_bf16 v[212:215], a[56:59], v[180:183], v[212:215]
s_or_b32 s88, s70, s71
s_cselect_b32 s10, 268435456, 0
v_mfma_f32_16x16x32_bf16 v[216:219], a[100:103], v[120:123], v[216:219]
s_cmp_lg_u32 s70, 0
s_cselect_b64 s[84:85], s[52:53], s[54:55]
s_cselect_b64 s[58:59], s[44:45], s[46:47]
v_mfma_f32_16x16x32_bf16 v[208:211], a[60:63], v[184:187], v[208:211]
s_mul_i32 s86, s84, s20
s_add_u32 s86, s86, s58
v_mfma_f32_16x16x32_bf16 v[212:215], a[60:63], v[188:191], v[212:215]
s_add_u32 m0, s50, 0
s_mul_i32 s87, s84, s21
s_add_u32 s87, s87, s59
v_mfma_f32_16x16x32_bf16 v[220:223], a[100:103], v[124:127], v[220:223]
buffer_load_dwordx4 v8, s[8:11], s86 offen offset:0 sc1 lds
s_waitcnt lgkmcnt(0)
v_mfma_f32_16x16x32_bf16 v[208:211], a[64:67], v[192:195], v[208:211]
s_andn2_b32 s71, s71, s70
s_add_u32 s52, s52, s70
s_add_u32 s54, s54, s71
v_mfma_f32_16x16x32_bf16 v[212:215], a[64:67], v[196:199], v[212:215]
s_mov_b32 s89, s88
v_mfma_f32_16x16x32_bf16 v[216:219], a[104:107], v[128:131], v[216:219]
buffer_load_dwordx4 v9, s[8:11], s86 offen offset:1024 sc1 lds
v_mfma_f32_16x16x32_bf16 v[208:211], a[68:71], v[200:203], v[208:211]
v_mfma_f32_16x16x32_bf16 v[212:215], a[68:71], v[204:207], v[212:215]
v_mfma_f32_16x16x32_bf16 v[220:223], a[104:107], v[132:135], v[220:223]
buffer_load_dwordx4 v10, s[8:11], s86 offen offset:2048 sc1 lds
v_mfma_f32_16x16x32_bf16 v[216:219], a[108:111], v[136:139], v[216:219]
v_mfma_f32_16x16x32_bf16 v[220:223], a[108:111], v[140:143], v[220:223]
v_mfma_f32_16x16x32_bf16 v[216:219], a[112:115], v[144:147], v[216:219]
buffer_load_dwordx4 v11, s[8:11], s86 offen offset:3072 sc1 lds
v_mfma_f32_16x16x32_bf16 v[220:223], a[112:115], v[148:151], v[220:223]
v_mfma_f32_16x16x32_bf16 v[216:219], a[116:119], v[152:155], v[216:219]
s_add_u32 m0, s50, 4096
v_cvt_pk_bf16_f32 v48, v208, v209
v_mfma_f32_16x16x32_bf16 v[220:223], a[116:119], v[156:159], v[220:223]
buffer_load_dwordx4 v12, s[8:11], s86 offen offset:0 sc1 lds
v_mfma_f32_16x16x32_bf16 v[216:219], a[120:123], v[160:163], v[216:219]
v_cvt_pk_bf16_f32 v49, v210, v211
v_cvt_pk_bf16_f32 v50, v212, v213
v_mfma_f32_16x16x32_bf16 v[220:223], a[120:123], v[164:167], v[220:223]
v_cvt_pk_bf16_f32 v51, v214, v215
v_mfma_f32_16x16x32_bf16 v[216:219], a[124:127], v[168:171], v[216:219]
buffer_load_dwordx4 v13, s[8:11], s86 offen offset:1024 sc1 lds
v_mfma_f32_16x16x32_bf16 v[220:223], a[124:127], v[172:175], v[220:223]
v_permlane16_swap_b32 v48, v50
v_mfma_f32_16x16x32_bf16 v[216:219], a[128:131], v[176:179], v[216:219]
v_permlane16_swap_b32 v49, v51
v_mfma_f32_16x16x32_bf16 v[220:223], a[128:131], v[180:183], v[220:223]
buffer_load_dwordx4 v14, s[8:11], s86 offen offset:2048 sc1 lds
v_mfma_f32_16x16x32_bf16 v[216:219], a[132:135], v[184:187], v[216:219]
buffer_store_dwordx4 v[48:51], v19, s[4:7], s81 offen sc1
v_mfma_f32_16x16x32_bf16 v[220:223], a[132:135], v[188:191], v[220:223]
v_mfma_f32_16x16x32_bf16 v[216:219], a[136:139], v[192:195], v[216:219]
buffer_load_dwordx4 v15, s[8:11], s86 offen offset:3072 sc1 lds
v_mfma_f32_16x16x32_bf16 v[220:223], a[136:139], v[196:199], v[220:223]
v_mfma_f32_16x16x32_bf16 v[216:219], a[140:143], v[200:203], v[216:219]
s_add_u32 m0, s50, 8192
v_mfma_f32_16x16x32_bf16 v[220:223], a[140:143], v[204:207], v[220:223]
buffer_load_dwordx4 v16, s[8:11], s86 offen offset:0 sc1 lds
v_mfma_f32_16x16x32_bf16 v[224:227], a[144:147], v[64:67], 0
v_mfma_f32_16x16x32_bf16 v[228:231], a[144:147], v[68:71], 0
v_mfma_f32_16x16x32_bf16 v[224:227], a[148:151], v[72:75], v[224:227]
v_mfma_f32_16x16x32_bf16 v[228:231], a[148:151], v[76:79], v[228:231]
v_mfma_f32_16x16x32_bf16 v[224:227], a[152:155], v[80:83], v[224:227]
buffer_load_dword v24, v22, s[4:7], 0 offen sc1
v_mfma_f32_16x16x32_bf16 v[228:231], a[152:155], v[84:87], v[228:231]
v_cvt_pk_bf16_f32 v52, v216, v217
v_cvt_pk_bf16_f32 v53, v218, v219
v_mfma_f32_16x16x32_bf16 v[224:227], a[156:159], v[88:91], v[224:227]
s_waitcnt vmcnt(11)
s_barrier
v_mfma_f32_16x16x32_bf16 v[228:231], a[156:159], v[92:95], v[228:231]
buffer_store_dword v27, v45, s[4:7], s73 offen
v_mfma_f32_16x16x32_bf16 v[224:227], a[160:163], v[96:99], v[224:227]
buffer_store_dword v27, v44, s[4:7], s73 offen sc1
v_mfma_f32_16x16x32_bf16 v[228:231], a[160:163], v[100:103], v[228:231]
v_cvt_pk_bf16_f32 v54, v220, v221
v_cvt_pk_bf16_f32 v55, v222, v223
v_mfma_f32_16x16x32_bf16 v[224:227], a[164:167], v[104:107], v[224:227]
v_permlane16_swap_b32 v52, v54
v_mfma_f32_16x16x32_bf16 v[228:231], a[164:167], v[108:111], v[228:231]
v_permlane16_swap_b32 v53, v55
v_mfma_f32_16x16x32_bf16 v[224:227], a[168:171], v[112:115], v[224:227]
buffer_store_dwordx4 v[52:55], v20, s[4:7], s81 offen sc1
v_mfma_f32_16x16x32_bf16 v[228:231], a[168:171], v[116:119], v[228:231]
v_mfma_f32_16x16x32_bf16 v[224:227], a[172:175], v[120:123], v[224:227]
v_mfma_f32_16x16x32_bf16 v[228:231], a[172:175], v[124:127], v[228:231]
v_mfma_f32_16x16x32_bf16 v[224:227], a[176:179], v[128:131], v[224:227]
v_mfma_f32_16x16x32_bf16 v[228:231], a[176:179], v[132:135], v[228:231]
v_mfma_f32_16x16x32_bf16 v[224:227], a[180:183], v[136:139], v[224:227]
v_mfma_f32_16x16x32_bf16 v[228:231], a[180:183], v[140:143], v[228:231]
v_mfma_f32_16x16x32_bf16 v[224:227], a[184:187], v[144:147], v[224:227]
v_mfma_f32_16x16x32_bf16 v[228:231], a[184:187], v[148:151], v[228:231]
v_mfma_f32_16x16x32_bf16 v[224:227], a[188:191], v[152:155], v[224:227]
v_mfma_f32_16x16x32_bf16 v[228:231], a[188:191], v[156:159], v[228:231]
v_mfma_f32_16x16x32_bf16 v[224:227], a[192:195], v[160:163], v[224:227]
s_waitcnt vmcnt(12)
s_barrier
v_mfma_f32_16x16x32_bf16 v[228:231], a[192:195], v[164:167], v[228:231]
v_mfma_f32_16x16x32_bf16 v[224:227], a[196:199], v[168:171], v[224:227]
s_cmp_eq_u32 s88, 0
s_cbranch_scc1 g_slow_93
v_mfma_f32_16x16x32_bf16 v[228:231], a[196:199], v[172:175], v[228:231]
ds_read_b128 v[64:67], v30 offset:0
v_mfma_f32_16x16x32_bf16 v[224:227], a[200:203], v[176:179], v[224:227]
ds_read_b128 v[68:71], v30 offset:9216
v_mfma_f32_16x16x32_bf16 v[228:231], a[200:203], v[180:183], v[228:231]
ds_read_b128 v[72:75], v30 offset:18432
v_mfma_f32_16x16x32_bf16 v[224:227], a[204:207], v[184:187], v[224:227]
ds_read_b128 v[76:79], v30 offset:27648
v_mfma_f32_16x16x32_bf16 v[228:231], a[204:207], v[188:191], v[228:231]
ds_read_b128 v[80:83], v30 offset:1024
v_mfma_f32_16x16x32_bf16 v[224:227], a[208:211], v[192:195], v[224:227]
ds_read_b128 v[84:87], v30 offset:10240
v_mfma_f32_16x16x32_bf16 v[228:231], a[208:211], v[196:199], v[228:231]
ds_read_b128 v[88:91], v30 offset:19456
v_mfma_f32_16x16x32_bf16 v[224:227], a[212:215], v[200:203], v[224:227]
ds_read_b128 v[92:95], v30 offset:28672
v_mfma_f32_16x16x32_bf16 v[228:231], a[212:215], v[204:207], v[228:231]
s_waitcnt vmcnt(9)
s_barrier
g_body_82:
s_waitcnt lgkmcnt(4)
v_mfma_f32_16x16x32_bf16 v[208:211], a[0:3], v[64:67], 0
ds_read_b128 v[96:99], v30 offset:2048
v_mfma_f32_16x16x32_bf16 v[212:215], a[0:3], v[68:71], 0
ds_read_b128 v[100:103], v30 offset:11264
v_mfma_f32_16x16x32_bf16 v[216:219], a[72:75], v[64:67], 0
v_mfma_f32_16x16x32_bf16 v[208:211], a[4:7], v[72:75], v[208:211]
ds_read_b128 v[104:107], v30 offset:20480
v_cvt_pk_bf16_f32 v56, v224, v225
v_mfma_f32_16x16x32_bf16 v[212:215], a[4:7], v[76:79], v[212:215]
ds_read_b128 v[108:111], v30 offset:29696
v_cvt_pk_bf16_f32 v57, v226, v227
v_mfma_f32_16x16x32_bf16 v[220:223], a[72:75], v[68:71], 0
v_cvt_pk_bf16_f32 v58, v228, v229
s_waitcnt lgkmcnt(4)
v_mfma_f32_16x16x32_bf16 v[208:211], a[8:11], v[80:83], v[208:211]
ds_read_b128 v[112:115], v30 offset:3072
v_cvt_pk_bf16_f32 v59, v230, v231
v_mfma_f32_16x16x32_bf16 v[212:215], a[8:11], v[84:87], v[212:215]
ds_read_b128 v[116:119], v30 offset:12288
v_permlane16_swap_b32 v56, v58
v_mfma_f32_16x16x32_bf16 v[216:219], a[76:79], v[72:75], v[216:219]
v_permlane16_swap_b32 v57, v59
v_mfma_f32_16x16x32_bf16 v[208:211], a[12:15], v[88:91], v[208:211]
ds_read_b128 v[120:123], v30 offset:21504
v_mfma_f32_16x16x32_bf16 v[212:215], a[12:15], v[92:95], v[212:215]
ds_read_b128 v[124:127], v30 offset:30720
v_mfma_f32_16x16x32_bf16 v[220:223], a[76:79], v[76:79], v[220:223]
s_waitcnt lgkmcnt(4)
v_mfma_f32_16x16x32_bf16 v[208:211], a[16:19], v[96:99], v[208:211]
ds_read_b128 v[128:131], v30 offset:4096
v_mfma_f32_16x16x32_bf16 v[212:215], a[16:19], v[100:103], v[212:215]
ds_read_b128 v[132:135], v30 offset:13312
v_mfma_f32_16x16x32_bf16 v[216:219], a[80:83], v[80:83], v[216:219]
buffer_store_dwordx4 v[56:59], v21, s[4:7], s81 offen sc1
v_mfma_f32_16x16x32_bf16 v[208:211], a[20:23], v[104:107], v[208:211]
ds_read_b128 v[136:139], v30 offset:22528
v_mfma_f32_16x16x32_bf16 v[212:215], a[20:23], v[108:111], v[212:215]
ds_read_b128 v[140:143], v30 offset:31744
v_mfma_f32_16x16x32_bf16 v[220:223], a[80:83], v[84:87], v[220:223]
s_waitcnt vmcnt(5)
s_barrier
s_waitcnt lgkmcnt(4)
v_mfma_f32_16x16x32_bf16 v[208:211], a[24:27], v[112:115], v[208:211]
ds_read_b128 v[144:147], v30 offset:5120
v_mov_b32 v27, s78
v_mfma_f32_16x16x32_bf16 v[212:215], a[24:27], v[116:119], v[212:215]
ds_read_b128 v[148:151], v30 offset:14336
v_mfma_f32_16x16x32_bf16 v[216:219], a[84:87], v[88:91], v[216:219]
v_mfma_f32_16x16x32_bf16 v[208:211], a[28:31], v[120:123], v[208:211]
ds_read_b128 v[152:155], v30 offset:23552
v_mfma_f32_16x16x32_bf16 v[212:215], a[28:31], v[124:127], v[212:215]
ds_read_b128 v[156:159], v30 offset:32768
v_mfma_f32_16x16x32_bf16 v[220:223], a[84:87], v[92:95], v[220:223]
s_waitcnt lgkmcnt(4)
v_mfma_f32_16x16x32_bf16 v[208:211], a[32:35], v[128:131], v[208:211]
ds_read_b128 v[160:163], v30 offset:6144
v_mfma_f32_16x16x32_bf16 v[212:215], a[32:35], v[132:135], v[212:215]
ds_read_b128 v[164:167], v30 offset:15360
v_mfma_f32_16x16x32_bf16 v[216:219], a[88:91], v[96:99], v[216:219]
v_mfma_f32_16x16x32_bf16 v[208:211], a[36:39], v[136:139], v[208:211]
ds_read_b128 v[168:171], v30 offset:24576
v_mfma_f32_16x16x32_bf16 v[212:215], a[36:39], v[140:143], v[212:215]
ds_read_b128 v[172:175], v30 offset:33792
v_mfma_f32_16x16x32_bf16 v[220:223], a[88:91], v[100:103], v[220:223]
s_waitcnt lgkmcnt(4)
v_mfma_f32_16x16x32_bf16 v[208:211], a[40:43], v[144:147], v[208:211]
ds_read_b128 v[176:179], v30 offset:7168
v_mfma_f32_16x16x32_bf16 v[212:215], a[40:43], v[148:151], v[212:215]
ds_read_b128 v[180:183], v30 offset:16384
s_waitcnt vmcnt(4)
ds_write_b32 v18, v24
v_mfma_f32_16x16x32_bf16 v[216:219], a[92:95], v[104:107], v[216:219]
v_mfma_f32_16x16x32_bf16 v[208:211], a[44:47], v[152:155], v[208:211]
ds_read_b128 v[184:187], v30 offset:25600
v_mfma_f32_16x16x32_bf16 v[212:215], a[44:47], v[156:159], v[212:215]
ds_read_b128 v[188:191], v30 offset:34816
s_waitcnt lgkmcnt(2)
s_barrier
v_mfma_f32_16x16x32_bf16 v[220:223], a[92:95], v[108:111], v[220:223]
ds_read_b32 v33, v32
v_mfma_f32_16x16x32_bf16 v[208:211], a[48:51], v[160:163], v[208:211]
ds_read_b128 v[192:195], v30 offset:8192
v_mfma_f32_16x16x32_bf16 v[212:215], a[48:51], v[164:167], v[212:215]
ds_read_b128 v[196:199], v30 offset:17408
v_mfma_f32_16x16x32_bf16 v[216:219], a[96:99], v[112:115], v[216:219]
s_waitcnt lgkmcnt(2)
v_cmp_gt_u32 vcc, s52, v33
v_mfma_f32_16x16x32_bf16 v[208:211], a[52:55], v[168:171], v[208:211]
ds_read_b128 v[200:203], v30 offset:26624
v_cmp_gt_u32 s[58:59], s54, v33
v_mfma_f32_16x16x32_bf16 v[212:215], a[52:55], v[172:175], v[212:215]
ds_read_b128 v[204:207], v30 offset:35840
s_and_b32 vcc_lo, vcc_lo, s56
s_cselect_b32 s70, 0, 1
v_mfma_f32_16x16x32_bf16 v[220:223], a[96:99], v[116:119], v[220:223]
v_mfma_f32_16x16x32_bf16 v[208:211], a[56:59], v[176:179], v[208:211]
s_and_b32 s59, s59, s56
s_cselect_b32 s71, 0, s89
v_mfma_f32_16x16x32_bf16 v[212:215], a[56:59], v[180:183], v[212:215]
s_or_b32 s94, s70, s71
s_cselect_b32 s10, 268435456, 0
v_mfma_f32_16x16x32_bf16 v[216:219], a[100:103], v[120:123], v[216:219]
s_cmp_lg_u32 s70, 0
s_cselect_b64 s[90:91], s[52:53], s[54:55]
s_cselect_b64 s[58:59], s[44:45], s[46:47]
v_mfma_f32_16x16x32_bf16 v[208:211], a[60:63], v[184:187], v[208:211]
s_mul_i32 s92, s90, s20
s_add_u32 s92, s92, s58
v_mfma_f32_16x16x32_bf16 v[212:215], a[60:63], v[188:191], v[212:215]
s_add_u32 m0, s51, 0
s_mul_i32 s93, s90, s21
s_add_u32 s93, s93, s59
v_mfma_f32_16x16x32_bf16 v[220:223], a[100:103], v[124:127], v[220:223]
buffer_load_dwordx4 v8, s[8:11], s92 offen offset:0 sc1 lds
s_waitcnt lgkmcnt(0)
v_mfma_f32_16x16x32_bf16 v[208:211], a[64:67], v[192:195], v[208:211]
s_andn2_b32 s71, s71, s70
s_add_u32 s52, s52, s70
s_add_u32 s54, s54, s71
v_mfma_f32_16x16x32_bf16 v[212:215], a[64:67], v[196:199], v[212:215]
s_mov_b32 s95, s94
v_mfma_f32_16x16x32_bf16 v[216:219], a[104:107], v[128:131], v[216:219]
buffer_load_dwordx4 v9, s[8:11], s92 offen offset:1024 sc1 lds
v_mfma_f32_16x16x32_bf16 v[208:211], a[68:71], v[200:203], v[208:211]
v_mfma_f32_16x16x32_bf16 v[212:215], a[68:71], v[204:207], v[212:215]
v_mfma_f32_16x16x32_bf16 v[220:223], a[104:107], v[132:135], v[220:223]
buffer_load_dwordx4 v10, s[8:11], s92 offen offset:2048 sc1 lds
v_mfma_f32_16x16x32_bf16 v[216:219], a[108:111], v[136:139], v[216:219]
v_mfma_f32_16x16x32_bf16 v[220:223], a[108:111], v[140:143], v[220:223]
v_mfma_f32_16x16x32_bf16 v[216:219], a[112:115], v[144:147], v[216:219]
buffer_load_dwordx4 v11, s[8:11], s92 offen offset:3072 sc1 lds
v_mfma_f32_16x16x32_bf16 v[220:223], a[112:115], v[148:151], v[220:223]
v_mfma_f32_16x16x32_bf16 v[216:219], a[116:119], v[152:155], v[216:219]
s_add_u32 m0, s51, 4096
v_cvt_pk_bf16_f32 v48, v208, v209
v_mfma_f32_16x16x32_bf16 v[220:223], a[116:119], v[156:159], v[220:223]
buffer_load_dwordx4 v12, s[8:11], s92 offen offset:0 sc1 lds
v_mfma_f32_16x16x32_bf16 v[216:219], a[120:123], v[160:163], v[216:219]
v_cvt_pk_bf16_f32 v49, v210, v211
v_cvt_pk_bf16_f32 v50, v212, v213
v_mfma_f32_16x16x32_bf16 v[220:223], a[120:123], v[164:167], v[220:223]
v_cvt_pk_bf16_f32 v51, v214, v215
v_mfma_f32_16x16x32_bf16 v[216:219], a[124:127], v[168:171], v[216:219]
buffer_load_dwordx4 v13, s[8:11], s92 offen offset:1024 sc1 lds
v_mfma_f32_16x16x32_bf16 v[220:223], a[124:127], v[172:175], v[220:223]
v_permlane16_swap_b32 v48, v50
v_mfma_f32_16x16x32_bf16 v[216:219], a[128:131], v[176:179], v[216:219]
v_permlane16_swap_b32 v49, v51
v_mfma_f32_16x16x32_bf16 v[220:223], a[128:131], v[180:183], v[220:223]
buffer_load_dwordx4 v14, s[8:11], s92 offen offset:2048 sc1 lds
v_mfma_f32_16x16x32_bf16 v[216:219], a[132:135], v[184:187], v[216:219]
buffer_store_dwordx4 v[48:51], v19, s[4:7], s87 offen sc1
v_mfma_f32_16x16x32_bf16 v[220:223], a[132:135], v[188:191], v[220:223]
v_mfma_f32_16x16x32_bf16 v[216:219], a[136:139], v[192:195], v[216:219]
buffer_load_dwordx4 v15, s[8:11], s92 offen offset:3072 sc1 lds
v_mfma_f32_16x16x32_bf16 v[220:223], a[136:139], v[196:199], v[220:223]
v_mfma_f32_16x16x32_bf16 v[216:219], a[140:143], v[200:203], v[216:219]
s_add_u32 m0, s51, 8192
v_mfma_f32_16x16x32_bf16 v[220:223], a[140:143], v[204:207], v[220:223]
buffer_load_dwordx4 v16, s[8:11], s92 offen offset:0 sc1 lds
v_mfma_f32_16x16x32_bf16 v[224:227], a[144:147], v[64:67], 0
v_mfma_f32_16x16x32_bf16 v[228:231], a[144:147], v[68:71], 0
v_mfma_f32_16x16x32_bf16 v[224:227], a[148:151], v[72:75], v[224:227]
v_mfma_f32_16x16x32_bf16 v[228:231], a[148:151], v[76:79], v[228:231]
v_mfma_f32_16x16x32_bf16 v[224:227], a[152:155], v[80:83], v[224:227]
buffer_load_dword v24, v22, s[4:7], 0 offen sc1
v_mfma_f32_16x16x32_bf16 v[228:231], a[152:155], v[84:87], v[228:231]
v_cvt_pk_bf16_f32 v52, v216, v217
v_cvt_pk_bf16_f32 v53, v218, v219
v_mfma_f32_16x16x32_bf16 v[224:227], a[156:159], v[88:91], v[224:227]
s_waitcnt vmcnt(11)
s_barrier
v_mfma_f32_16x16x32_bf16 v[228:231], a[156:159], v[92:95], v[228:231]
buffer_store_dword v27, v45, s[4:7], s79 offen
v_mfma_f32_16x16x32_bf16 v[224:227], a[160:163], v[96:99], v[224:227]
buffer_store_dword v27, v44, s[4:7], s79 offen sc1
v_mfma_f32_16x16x32_bf16 v[228:231], a[160:163], v[100:103], v[228:231]
v_cvt_pk_bf16_f32 v54, v220, v221
v_cvt_pk_bf16_f32 v55, v222, v223
v_mfma_f32_16x16x32_bf16 v[224:227], a[164:167], v[104:107], v[224:227]
v_permlane16_swap_b32 v52, v54
v_mfma_f32_16x16x32_bf16 v[228:231], a[164:167], v[108:111], v[228:231]
v_permlane16_swap_b32 v53, v55
v_mfma_f32_16x16x32_bf16 v[224:227], a[168:171], v[112:115], v[224:227]
buffer_store_dwordx4 v[52:55], v20, s[4:7], s87 offen sc1
v_mfma_f32_16x16x32_bf16 v[228:231], a[168:171], v[116:119], v[228:231]
v_mfma_f32_16x16x32_bf16 v[224:227], a[172:175], v[120:123], v[224:227]
v_mfma_f32_16x16x32_bf16 v[228:231], a[172:175], v[124:127], v[228:231]
v_mfma_f32_16x16x32_bf16 v[224:227], a[176:179], v[128:131], v[224:227]
v_mfma_f32_16x16x32_bf16 v[228:231], a[176:179], v[132:135], v[228:231]
v_mfma_f32_16x16x32_bf16 v[224:227], a[180:183], v[136:139], v[224:227]
v_mfma_f32_16x16x32_bf16 v[228:231], a[180:183], v[140:143], v[228:231]
v_mfma_f32_16x16x32_bf16 v[224:227], a[184:187], v[144:147], v[224:227]
v_mfma_f32_16x16x32_bf16 v[228:231], a[184:187], v[148:151], v[228:231]
v_mfma_f32_16x16x32_bf16 v[224:227], a[188:191], v[152:155], v[224:227]
v_mfma_f32_16x16x32_bf16 v[228:231], a[188:191], v[156:159], v[228:231]
v_mfma_f32_16x16x32_bf16 v[224:227], a[192:195], v[160:163], v[224:227]
s_waitcnt vmcnt(12)
s_barrier
v_mfma_f32_16x16x32_bf16 v[228:231], a[192:195], v[164:167], v[228:231]
v_mfma_f32_16x16x32_bf16 v[224:227], a[196:199], v[168:171], v[224:227]
s_cmp_eq_u32 s94, 0
s_cbranch_scc1 g_slow_94
v_mfma_f32_16x16x32_bf16 v[228:231], a[196:199], v[172:175], v[228:231]
ds_read_b128 v[64:67], v31 offset:0
v_mfma_f32_16x16x32_bf16 v[224:227], a[200:203], v[176:179], v[224:227]
ds_read_b128 v[68:71], v31 offset:9216
v_mfma_f32_16x16x32_bf16 v[228:231], a[200:203], v[180:183], v[228:231]
ds_read_b128 v[72:75], v31 offset:18432
v_mfma_f32_16x16x32_bf16 v[224:227], a[204:207], v[184:187], v[224:227]
ds_read_b128 v[76:79], v31 offset:27648
v_mfma_f32_16x16x32_bf16 v[228:231], a[204:207], v[188:191], v[228:231]
ds_read_b128 v[80:83], v31 offset:1024
v_mfma_f32_16x16x32_bf16 v[224:227], a[208:211], v[192:195], v[224:227]
ds_read_b128 v[84:87], v31 offset:10240
v_mfma_f32_16x16x32_bf16 v[228:231], a[208:211], v[196:199], v[228:231]
ds_read_b128 v[88:91], v31 offset:19456
v_mfma_f32_16x16x32_bf16 v[224:227], a[212:215], v[200:203], v[224:227]
ds_read_b128 v[92:95], v31 offset:28672
v_mfma_f32_16x16x32_bf16 v[228:231], a[212:215], v[204:207], v[228:231]
s_waitcnt vmcnt(9)
s_barrier
g_body_83:
s_waitcnt lgkmcnt(4)
v_mfma_f32_16x16x32_bf16 v[208:211], a[0:3], v[64:67], 0
ds_read_b128 v[96:99], v31 offset:2048
v_mfma_f32_16x16x32_bf16 v[212:215], a[0:3], v[68:71], 0
ds_read_b128 v[100:103], v31 offset:11264
v_mfma_f32_16x16x32_bf16 v[216:219], a[72:75], v[64:67], 0
v_mfma_f32_16x16x32_bf16 v[208:211], a[4:7], v[72:75], v[208:211]
ds_read_b128 v[104:107], v31 offset:20480
v_cvt_pk_bf16_f32 v56, v224, v225
v_mfma_f32_16x16x32_bf16 v[212:215], a[4:7], v[76:79], v[212:215]
ds_read_b128 v[108:111], v31 offset:29696
v_cvt_pk_bf16_f32 v57, v226, v227
v_mfma_f32_16x16x32_bf16 v[220:223], a[72:75], v[68:71], 0
v_cvt_pk_bf16_f32 v58, v228, v229
s_waitcnt lgkmcnt(4)
v_mfma_f32_16x16x32_bf16 v[208:211], a[8:11], v[80:83], v[208:211]
ds_read_b128 v[112:115], v31 offset:3072
v_cvt_pk_bf16_f32 v59, v230, v231
v_mfma_f32_16x16x32_bf16 v[212:215], a[8:11], v[84:87], v[212:215]
ds_read_b128 v[116:119], v31 offset:12288
v_permlane16_swap_b32 v56, v58
v_mfma_f32_16x16x32_bf16 v[216:219], a[76:79], v[72:75], v[216:219]
v_permlane16_swap_b32 v57, v59
v_mfma_f32_16x16x32_bf16 v[208:211], a[12:15], v[88:91], v[208:211]
ds_read_b128 v[120:123], v31 offset:21504
v_mfma_f32_16x16x32_bf16 v[212:215], a[12:15], v[92:95], v[212:215]
ds_read_b128 v[124:127], v31 offset:30720
v_mfma_f32_16x16x32_bf16 v[220:223], a[76:79], v[76:79], v[220:223]
s_waitcnt lgkmcnt(4)
v_mfma_f32_16x16x32_bf16 v[208:211], a[16:19], v[96:99], v[208:211]
ds_read_b128 v[128:131], v31 offset:4096
v_mfma_f32_16x16x32_bf16 v[212:215], a[16:19], v[100:103], v[212:215]
ds_read_b128 v[132:135], v31 offset:13312
v_mfma_f32_16x16x32_bf16 v[216:219], a[80:83], v[80:83], v[216:219]
buffer_store_dwordx4 v[56:59], v21, s[4:7], s87 offen sc1
v_mfma_f32_16x16x32_bf16 v[208:211], a[20:23], v[104:107], v[208:211]
ds_read_b128 v[136:139], v31 offset:22528
v_mfma_f32_16x16x32_bf16 v[212:215], a[20:23], v[108:111], v[212:215]
ds_read_b128 v[140:143], v31 offset:31744
v_mfma_f32_16x16x32_bf16 v[220:223], a[80:83], v[84:87], v[220:223]
s_waitcnt vmcnt(5)
s_barrier
s_waitcnt lgkmcnt(4)
v_mfma_f32_16x16x32_bf16 v[208:211], a[24:27], v[112:115], v[208:211]
ds_read_b128 v[144:147], v31 offset:5120
v_mov_b32 v27, s84
v_mfma_f32_16x16x32_bf16 v[212:215], a[24:27], v[116:119], v[212:215]
ds_read_b128 v[148:151], v31 offset:14336
v_mfma_f32_16x16x32_bf16 v[216:219], a[84:87], v[88:91], v[216:219]
v_mfma_f32_16x16x32_bf16 v[208:211], a[28:31], v[120:123], v[208:211]
ds_read_b128 v[152:155], v31 offset:23552
v_mfma_f32_16x16x32_bf16 v[212:215], a[28:31], v[124:127], v[212:215]
ds_read_b128 v[156:159], v31 offset:32768
v_mfma_f32_16x16x32_bf16 v[220:223], a[84:87], v[92:95], v[220:223]
s_waitcnt lgkmcnt(4)
v_mfma_f32_16x16x32_bf16 v[208:211], a[32:35], v[128:131], v[208:211]
ds_read_b128 v[160:163], v31 offset:6144
v_mfma_f32_16x16x32_bf16 v[212:215], a[32:35], v[132:135], v[212:215]
ds_read_b128 v[164:167], v31 offset:15360
v_mfma_f32_16x16x32_bf16 v[216:219], a[88:91], v[96:99], v[216:219]
v_mfma_f32_16x16x32_bf16 v[208:211], a[36:39], v[136:139], v[208:211]
ds_read_b128 v[168:171], v31 offset:24576
v_mfma_f32_16x16x32_bf16 v[212:215], a[36:39], v[140:143], v[212:215]
ds_read_b128 v[172:175], v31 offset:33792
v_mfma_f32_16x16x32_bf16 v[220:223], a[88:91], v[100:103], v[220:223]
s_waitcnt lgkmcnt(4)
v_mfma_f32_16x16x32_bf16 v[208:211], a[40:43], v[144:147], v[208:211]
ds_read_b128 v[176:179], v31 offset:7168
v_mfma_f32_16x16x32_bf16 v[212:215], a[40:43], v[148:151], v[212:215]
ds_read_b128 v[180:183], v31 offset:16384
s_waitcnt vmcnt(4)
ds_write_b32 v18, v24
v_mfma_f32_16x16x32_bf16 v[216:219], a[92:95], v[104:107], v[216:219]
v_mfma_f32_16x16x32_bf16 v[208:211], a[44:47], v[152:155], v[208:211]
ds_read_b128 v[184:187], v31 offset:25600
v_mfma_f32_16x16x32_bf16 v[212:215], a[44:47], v[156:159], v[212:215]
ds_read_b128 v[188:191], v31 offset:34816
s_waitcnt lgkmcnt(2)
s_barrier
v_mfma_f32_16x16x32_bf16 v[220:223], a[92:95], v[108:111], v[220:223]
ds_read_b32 v33, v32
v_mfma_f32_16x16x32_bf16 v[208:211], a[48:51], v[160:163], v[208:211]
ds_read_b128 v[192:195], v31 offset:8192
v_mfma_f32_16x16x32_bf16 v[212:215], a[48:51], v[164:167], v[212:215]
ds_read_b128 v[196:199], v31 offset:17408
v_mfma_f32_16x16x32_bf16 v[216:219], a[96:99], v[112:115], v[216:219]
s_waitcnt lgkmcnt(2)
v_cmp_gt_u32 vcc, s52, v33
v_mfma_f32_16x16x32_bf16 v[208:211], a[52:55], v[168:171], v[208:211]
ds_read_b128 v[200:203], v31 offset:26624
v_cmp_gt_u32 s[58:59], s54, v33
v_mfma_f32_16x16x32_bf16 v[212:215], a[52:55], v[172:175], v[212:215]
ds_read_b128 v[204:207], v31 offset:35840
s_and_b32 vcc_lo, vcc_lo, s56
s_cselect_b32 s70, 0, 1
v_mfma_f32_16x16x32_bf16 v[220:223], a[96:99], v[116:119], v[220:223]
v_mfma_f32_16x16x32_bf16 v[208:211], a[56:59], v[176:179], v[208:211]
s_and_b32 s59, s59, s56
s_cselect_b32 s71, 0, s95
v_mfma_f32_16x16x32_bf16 v[212:215], a[56:59], v[180:183], v[212:215]
s_or_b32 s76, s70, s71
s_cselect_b32 s10, 268435456, 0
v_mfma_f32_16x16x32_bf16 v[216:219], a[100:103], v[120:123], v[216:219]
s_cmp_lg_u32 s70, 0
s_cselect_b64 s[72:73], s[52:53], s[54:55]
s_cselect_b64 s[58:59], s[44:45], s[46:47]
v_mfma_f32_16x16x32_bf16 v[208:211], a[60:63], v[184:187], v[208:211]
s_mul_i32 s74, s72, s20
s_add_u32 s74, s74, s58
v_mfma_f32_16x16x32_bf16 v[212:215], a[60:63], v[188:191], v[212:215]
s_add_u32 m0, s48, 0
s_mul_i32 s75, s72, s21
s_add_u32 s75, s75, s59
v_mfma_f32_16x16x32_bf16 v[220:223], a[100:103], v[124:127], v[220:223]
buffer_load_dwordx4 v8, s[8:11], s74 offen offset:0 sc1 lds
s_waitcnt lgkmcnt(0)
v_mfma_f32_16x16x32_bf16 v[208:211], a[64:67], v[192:195], v[208:211]
s_andn2_b32 s71, s71, s70
s_add_u32 s52, s52, s70
s_add_u32 s54, s54, s71
v_mfma_f32_16x16x32_bf16 v[212:215], a[64:67], v[196:199], v[212:215]
s_mov_b32 s77, s76
v_mfma_f32_16x16x32_bf16 v[216:219], a[104:107], v[128:131], v[216:219]
buffer_load_dwordx4 v9, s[8:11], s74 offen offset:1024 sc1 lds
v_mfma_f32_16x16x32_bf16 v[208:211], a[68:71], v[200:203], v[208:211]
v_mfma_f32_16x16x32_bf16 v[212:215], a[68:71], v[204:207], v[212:215]
v_mfma_f32_16x16x32_bf16 v[220:223], a[104:107], v[132:135], v[220:223]
buffer_load_dwordx4 v10, s[8:11], s74 offen offset:2048 sc1 lds
v_mfma_f32_16x16x32_bf16 v[216:219], a[108:111], v[136:139], v[216:219]
v_mfma_f32_16x16x32_bf16 v[220:223], a[108:111], v[140:143], v[220:223]
v_mfma_f32_16x16x32_bf16 v[216:219], a[112:115], v[144:147], v[216:219]
buffer_load_dwordx4 v11, s[8:11], s74 offen offset:3072 sc1 lds
v_mfma_f32_16x16x32_bf16 v[220:223], a[112:115], v[148:151], v[220:223]
v_mfma_f32_16x16x32_bf16 v[216:219], a[116:119], v[152:155], v[216:219]
s_add_u32 m0, s48, 4096
v_cvt_pk_bf16_f32 v48, v208, v209
v_mfma_f32_16x16x32_bf16 v[220:223], a[116:119], v[156:159], v[220:223]
buffer_load_dwordx4 v12, s[8:11], s74 offen offset:0 sc1 lds
v_mfma_f32_16x16x32_bf16 v[216:219], a[120:123], v[160:163], v[216:219]
v_cvt_pk_bf16_f32 v49, v210, v211
v_cvt_pk_bf16_f32 v50, v212, v213
v_mfma_f32_16x16x32_bf16 v[220:223], a[120:123], v[164:167], v[220:223]
v_cvt_pk_bf16_f32 v51, v214, v215
v_mfma_f32_16x16x32_bf16 v[216:219], a[124:127], v[168:171], v[216:219]
buffer_load_dwordx4 v13, s[8:11], s74 offen offset:1024 sc1 lds
v_mfma_f32_16x16x32_bf16 v[220:223], a[124:127], v[172:175], v[220:223]
v_permlane16_swap_b32 v48, v50
v_mfma_f32_16x16x32_bf16 v[216:219], a[128:131], v[176:179], v[216:219]
v_permlane16_swap_b32 v49, v51
v_mfma_f32_16x16x32_bf16 v[220:223], a[128:131], v[180:183], v[220:223]
buffer_load_dwordx4 v14, s[8:11], s74 offen offset:2048 sc1 lds
v_mfma_f32_16x16x32_bf16 v[216:219], a[132:135], v[184:187], v[216:219]
buffer_store_dwordx4 v[48:51], v19, s[4:7], s93 offen sc1
v_mfma_f32_16x16x32_bf16 v[220:223], a[132:135], v[188:191], v[220:223]
v_mfma_f32_16x16x32_bf16 v[216:219], a[136:139], v[192:195], v[216:219]
buffer_load_dwordx4 v15, s[8:11], s74 offen offset:3072 sc1 lds
v_mfma_f32_16x16x32_bf16 v[220:223], a[136:139], v[196:199], v[220:223]
v_mfma_f32_16x16x32_bf16 v[216:219], a[140:143], v[200:203], v[216:219]
s_add_u32 m0, s48, 8192
v_mfma_f32_16x16x32_bf16 v[220:223], a[140:143], v[204:207], v[220:223]
buffer_load_dwordx4 v16, s[8:11], s74 offen offset:0 sc1 lds
v_mfma_f32_16x16x32_bf16 v[224:227], a[144:147], v[64:67], 0
v_mfma_f32_16x16x32_bf16 v[228:231], a[144:147], v[68:71], 0
v_mfma_f32_16x16x32_bf16 v[224:227], a[148:151], v[72:75], v[224:227]
v_mfma_f32_16x16x32_bf16 v[228:231], a[148:151], v[76:79], v[228:231]
v_mfma_f32_16x16x32_bf16 v[224:227], a[152:155], v[80:83], v[224:227]
buffer_load_dword v24, v22, s[4:7], 0 offen sc1
v_mfma_f32_16x16x32_bf16 v[228:231], a[152:155], v[84:87], v[228:231]
v_cvt_pk_bf16_f32 v52, v216, v217
v_cvt_pk_bf16_f32 v53, v218, v219
v_mfma_f32_16x16x32_bf16 v[224:227], a[156:159], v[88:91], v[224:227]
s_waitcnt vmcnt(11)
s_barrier
v_mfma_f32_16x16x32_bf16 v[228:231], a[156:159], v[92:95], v[228:231]
buffer_store_dword v27, v45, s[4:7], s85 offen
v_mfma_f32_16x16x32_bf16 v[224:227], a[160:163], v[96:99], v[224:227]
buffer_store_dword v27, v44, s[4:7], s85 offen sc1
v_mfma_f32_16x16x32_bf16 v[228:231], a[160:163], v[100:103], v[228:231]
v_cvt_pk_bf16_f32 v54, v220, v221
v_cvt_pk_bf16_f32 v55, v222, v223
v_mfma_f32_16x16x32_bf16 v[224:227], a[164:167], v[104:107], v[224:227]
v_permlane16_swap_b32 v52, v54
v_mfma_f32_16x16x32_bf16 v[228:231], a[164:167], v[108:111], v[228:231]
v_permlane16_swap_b32 v53, v55
v_mfma_f32_16x16x32_bf16 v[224:227], a[168:171], v[112:115], v[224:227]
buffer_store_dwordx4 v[52:55], v20, s[4:7], s93 offen sc1
v_mfma_f32_16x16x32_bf16 v[228:231], a[168:171], v[116:119], v[228:231]
v_mfma_f32_16x16x32_bf16 v[224:227], a[172:175], v[120:123], v[224:227]
v_mfma_f32_16x16x32_bf16 v[228:231], a[172:175], v[124:127], v[228:231]
v_mfma_f32_16x16x32_bf16 v[224:227], a[176:179], v[128:131], v[224:227]
v_mfma_f32_16x16x32_bf16 v[228:231], a[176:179], v[132:135], v[228:231]
v_mfma_f32_16x16x32_bf16 v[224:227], a[180:183], v[136:139], v[224:227]
v_mfma_f32_16x16x32_bf16 v[228:231], a[180:183], v[140:143], v[228:231]
v_mfma_f32_16x16x32_bf16 v[224:227], a[184:187], v[144:147], v[224:227]
v_mfma_f32_16x16x32_bf16 v[228:231], a[184:187], v[148:151], v[228:231]
v_mfma_f32_16x16x32_bf16 v[224:227], a[188:191], v[152:155], v[224:227]
v_mfma_f32_16x16x32_bf16 v[228:231], a[188:191], v[156:159], v[228:231]
v_mfma_f32_16x16x32_bf16 v[224:227], a[192:195], v[160:163], v[224:227]
s_waitcnt vmcnt(12)
s_barrier
v_mfma_f32_16x16x32_bf16 v[228:231], a[192:195], v[164:167], v[228:231]
v_mfma_f32_16x16x32_bf16 v[224:227], a[196:199], v[168:171], v[224:227]
s_cmp_eq_u32 s76, 0
s_cbranch_scc1 g_slow_95
v_mfma_f32_16x16x32_bf16 v[228:231], a[196:199], v[172:175], v[228:231]
ds_read_b128 v[64:67], v28 offset:0
v_mfma_f32_16x16x32_bf16 v[224:227], a[200:203], v[176:179], v[224:227]
ds_read_b128 v[68:71], v28 offset:9216
v_mfma_f32_16x16x32_bf16 v[228:231], a[200:203], v[180:183], v[228:231]
ds_read_b128 v[72:75], v28 offset:18432
v_mfma_f32_16x16x32_bf16 v[224:227], a[204:207], v[184:187], v[224:227]
ds_read_b128 v[76:79], v28 offset:27648
v_mfma_f32_16x16x32_bf16 v[228:231], a[204:207], v[188:191], v[228:231]
ds_read_b128 v[80:83], v28 offset:1024
v_mfma_f32_16x16x32_bf16 v[224:227], a[208:211], v[192:195], v[224:227]
ds_read_b128 v[84:87], v28 offset:10240
v_mfma_f32_16x16x32_bf16 v[228:231], a[208:211], v[196:199], v[228:231]
ds_read_b128 v[88:91], v28 offset:19456
v_mfma_f32_16x16x32_bf16 v[224:227], a[212:215], v[200:203], v[224:227]
ds_read_b128 v[92:95], v28 offset:28672
v_mfma_f32_16x16x32_bf16 v[228:231], a[212:215], v[204:207], v[228:231]
s_waitcnt vmcnt(9)
s_barrier
s_branch g_body_80
g_slow_92:
v_mfma_f32_16x16x32_bf16 v[228:231], a[196:199], v[172:175], v[228:231]
v_mfma_f32_16x16x32_bf16 v[224:227], a[200:203], v[176:179], v[224:227]
v_mfma_f32_16x16x32_bf16 v[228:231], a[200:203], v[180:183], v[228:231]
v_mfma_f32_16x16x32_bf16 v[224:227], a[204:207], v[184:187], v[224:227]
v_mfma_f32_16x16x32_bf16 v[228:231], a[204:207], v[188:191], v[228:231]
v_mfma_f32_16x16x32_bf16 v[224:227], a[208:211], v[192:195], v[224:227]
v_mfma_f32_16x16x32_bf16 v[228:231], a[208:211], v[196:199], v[228:231]
v_mfma_f32_16x16x32_bf16 v[224:227], a[212:215], v[200:203], v[224:227]
v_mfma_f32_16x16x32_bf16 v[228:231], a[212:215], v[204:207], v[228:231]
s_nop 6
v_cvt_pk_bf16_f32 v56, v224, v225
v_cvt_pk_bf16_f32 v57, v226, v227
v_cvt_pk_bf16_f32 v58, v228, v229
v_cvt_pk_bf16_f32 v59, v230, v231
s_nop 0
v_permlane16_swap_b32 v56, v58
v_permlane16_swap_b32 v57, v59
buffer_store_dwordx4 v[56:59], v21, s[4:7], s75 offen sc1
s_mov_b32 s75, 1879048192
s_waitcnt vmcnt(4)
ds_write_b32 v18, v24
s_waitcnt lgkmcnt(0)
s_barrier
ds_read_b32 v33, v32
s_waitcnt lgkmcnt(0)
v_cmp_gt_u32 vcc, s52, v33
v_cmp_gt_u32 s[58:59], s54, v33
s_and_b32 vcc_lo, vcc_lo, s56
s_cselect_b32 s70, 0, 1
s_and_b32 s59, s59, s56
s_cselect_b32 s71, 0, s77
s_or_b32 s82, s70, s71
s_cselect_b32 s10, 268435456, 0
s_cmp_lg_u32 s70, 0
s_cselect_b64 s[78:79], s[52:53], s[54:55]
s_cselect_b64 s[58:59], s[44:45], s[46:47]
s_mul_i32 s80, s78, s20
s_add_u32 s80, s80, s58
s_mul_i32 s81, s78, s21
s_add_u32 s81, s81, s59
s_andn2_b32 s71, s71, s70
s_add_u32 s52, s52, s70
s_add_u32 s54, s54, s71
s_mov_b32 s83, s82
s_cmp_lg_u32 s82, 0
s_cbranch_scc1 g_go_96
v_mov_b32 v27, s72
s_waitcnt vmcnt(0)
s_barrier
s_add_u32 s70, s52, s54
s_cmp_eq_u32 s70, 130
s_cbranch_scc1 g_fin_84
s_cmp_lg_u32 s3, 0
s_cbranch_scc1 sp_ok_98_j
s_mov_b32 s23, 0
buffer_load_dword v33, v22, s[4:7], 0 offen sc1
buffer_store_dword v27, v45, s[4:7], s73 offen
buffer_store_dword v27, v44, s[4:7], s73 offen sc1
s_waitcnt vmcnt(2)
s_branch sp_loop_97_e
sp_loop_97:
buffer_load_dword v33, v22, s[4:7], 0 offen sc1
s_add_u32 s23, s23, 1
s_cmp_gt_u32 s23, 150000
s_cbranch_scc1 sp_bad_99
s_waitcnt vmcnt(0)
sp_loop_97_e:
v_cmp_gt_u32 vcc, s52, v33
v_cmp_gt_u32 s[58:59], s54, v33
s_and_b32 vcc_lo, vcc_lo, s56
s_cbranch_scc0 sp_ok_98
s_cmp_gt_u32 s23, 4
s_cselect_b32 s70, 0, s56
s_cmp_lg_u32 s77, 0
s_cselect_b32 s70, 0, s70
s_or_b32 s59, s59, s70
s_and_b32 s59, s59, s56
s_cbranch_scc0 sp_ok_98
s_sleep 1
s_branch sp_loop_97
sp_bad_99:
s_mov_b32 s98, 1027
s_branch L_fail
sp_ok_98:
ds_write_b32 v18, v33
s_waitcnt lgkmcnt(0)
sp_ok_98_j:
s_barrier
ds_read_b32 v33, v32
s_waitcnt lgkmcnt(0)
s_mov_b32 s73, 1879048192
v_cmp_gt_u32 vcc, s52, v33
v_cmp_gt_u32 s[58:59], s54, v33
s_and_b32 vcc_lo, vcc_lo, s56
s_cselect_b32 s70, 0, 1
s_and_b32 s59, s59, s56
s_cselect_b32 s71, 0, 1
s_or_b32 s82, s70, s71
s_cselect_b32 s10, 268435456, 0
s_cmp_lg_u32 s70, 0
s_cselect_b64 s[78:79], s[52:53], s[54:55]
s_cselect_b64 s[58:59], s[44:45], s[46:47]
s_mul_i32 s80, s78, s20
s_add_u32 s80, s80, s58
s_mul_i32 s81, s78, s21
s_add_u32 s81, s81, s59
s_andn2_b32 s71, s71, s70
s_add_u32 s52, s52, s70
s_add_u32 s54, s54, s71
s_mov_b32 s83, s82
g_go_96:
s_add_u32 m0, s49, 0
s_nop 0
buffer_load_dwordx4 v8, s[4:7], s80 offen offset:0 sc1 lds
buffer_load_dwordx4 v9, s[4:7], s80 offen offset:1024 sc1 lds
buffer_load_dwordx4 v10, s[4:7], s80 offen offset:2048 sc1 lds
buffer_load_dwordx4 v11, s[4:7], s80 offen offset:3072 sc1 lds
s_add_u32 m0, s49, 4096
s_nop 0
buffer_load_dwordx4 v12, s[4:7], s80 offen offset:0 sc1 lds
buffer_load_dwordx4 v13, s[4:7], s80 offen offset:1024 sc1 lds
buffer_load_dwordx4 v14, s[4:7], s80 offen offset:2048 sc1 lds
buffer_load_dwordx4 v15, s[4:7], s80 offen offset:3072 sc1 lds
s_add_u32 m0, s49, 8192
s_nop 0
buffer_load_dwordx4 v16, s[4:7], s80 offen offset:0 sc1 lds
buffer_load_dword v24, v22, s[4:7], 0 offen sc1
buffer_store_dword v27, v34, s[4:7], 0 offen
v_mov_b32 v27, s72
s_waitcnt vmcnt(9)
s_barrier
buffer_store_dword v27, v45, s[4:7], s73 offen
buffer_store_dword v27, v44, s[4:7], s73 offen sc1
s_mov_b32 s73, 1879048192
ds_read_b128 v[64:67], v29 offset:0
ds_read_b128 v[68:71], v29 offset:9216
ds_read_b128 v[72:75], v29 offset:18432
ds_read_b128 v[76:79], v29 offset:27648
ds_read_b128 v[80:83], v29 offset:1024
ds_read_b128 v[84:87], v29 offset:10240
ds_read_b128 v[88:91], v29 offset:19456
ds_read_b128 v[92:95], v29 offset:28672
s_waitcnt vmcnt(8)
s_barrier
s_branch g_body_81
g_slow_93:
v_mfma_f32_16x16x32_bf16 v[228:231], a[196:199], v[172:175], v[228:231]
v_mfma_f32_16x16x32_bf16 v[224:227], a[200:203], v[176:179], v[224:227]
v_mfma_f32_16x16x32_bf16 v[228:231], a[200:203], v[180:183], v[228:231]
v_mfma_f32_16x16x32_bf16 v[224:227], a[204:207], v[184:187], v[224:227]
v_mfma_f32_16x16x32_bf16 v[228:231], a[204:207], v[188:191], v[228:231]
v_mfma_f32_16x16x32_bf16 v[224:227], a[208:211], v[192:195], v[224:227]
v_mfma_f32_16x16x32_bf16 v[228:231], a[208:211], v[196:199], v[228:231]
v_mfma_f32_16x16x32_bf16 v[224:227], a[212:215], v[200:203], v[224:227]
v_mfma_f32_16x16x32_bf16 v[228:231], a[212:215], v[204:207], v[228:231]
s_nop 6
v_cvt_pk_bf16_f32 v56, v224, v225
v_cvt_pk_bf16_f32 v57, v226, v227
v_cvt_pk_bf16_f32 v58, v228, v229
v_cvt_pk_bf16_f32 v59, v230, v231
s_nop 0
v_permlane16_swap_b32 v56, v58
v_permlane16_swap_b32 v57, v59
buffer_store_dwordx4 v[56:59], v21, s[4:7], s81 offen sc1
s_mov_b32 s81, 1879048192
s_waitcnt vmcnt(4)
ds_write_b32 v18, v24
s_waitcnt lgkmcnt(0)
s_barrier
ds_read_b32 v33, v32
s_waitcnt lgkmcnt(0)
v_cmp_gt_u32 vcc, s52, v33
v_cmp_gt_u32 s[58:59], s54, v33
s_and_b32 vcc_lo, vcc_lo, s56
s_cselect_b32 s70, 0, 1
s_and_b32 s59, s59, s56
s_cselect_b32 s71, 0, s83
s_or_b32 s88, s70, s71
s_cselect_b32 s10, 268435456, 0
s_cmp_lg_u32 s70, 0
s_cselect_b64 s[84:85], s[52:53], s[54:55]
s_cselect_b64 s[58:59], s[44:45], s[46:47]
s_mul_i32 s86, s84, s20
s_add_u32 s86, s86, s58
s_mul_i32 s87, s84, s21
s_add_u32 s87, s87, s59
s_andn2_b32 s71, s71, s70
s_add_u32 s52, s52, s70
s_add_u32 s54, s54, s71
s_mov_b32 s89, s88
s_cmp_lg_u32 s88, 0
s_cbranch_scc1 g_go_100
v_mov_b32 v27, s78
s_waitcnt vmcnt(0)
s_barrier
s_add_u32 s70, s52, s54
s_cmp_eq_u32 s70, 130
s_cbranch_scc1 g_fin_84
s_cmp_lg_u32 s3, 0
s_cbranch_scc1 sp_ok_102_j
s_mov_b32 s23, 0
buffer_load_dword v33, v22, s[4:7], 0 offen sc1
buffer_store_dword v27, v45, s[4:7], s79 offen
buffer_store_dword v27, v44, s[4:7], s79 offen sc1
s_waitcnt vmcnt(2)
s_branch sp_loop_101_e
sp_loop_101:
buffer_load_dword v33, v22, s[4:7], 0 offen sc1
s_add_u32 s23, s23, 1
s_cmp_gt_u32 s23, 150000
s_cbranch_scc1 sp_bad_103
s_waitcnt vmcnt(0)
sp_loop_101_e:
v_cmp_gt_u32 vcc, s52, v33
v_cmp_gt_u32 s[58:59], s54, v33
s_and_b32 vcc_lo, vcc_lo, s56
s_cbranch_scc0 sp_ok_102
s_cmp_gt_u32 s23, 4
s_cselect_b32 s70, 0, s56
s_cmp_lg_u32 s83, 0
s_cselect_b32 s70, 0, s70
s_or_b32 s59, s59, s70
s_and_b32 s59, s59, s56
s_cbranch_scc0 sp_ok_102
s_sleep 1
s_branch sp_loop_101
sp_bad_103:
s_mov_b32 s98, 1027
s_branch L_fail
sp_ok_102:
ds_write_b32 v18, v33
s_waitcnt lgkmcnt(0)
sp_ok_102_j:
s_barrier
ds_read_b32 v33, v32
s_waitcnt lgkmcnt(0)
s_mov_b32 s79, 1879048192
v_cmp_gt_u32 vcc, s52, v33
v_cmp_gt_u32 s[58:59], s54, v33
s_and_b32 vcc_lo, vcc_lo, s56
s_cselect_b32 s70, 0, 1
s_and_b32 s59, s59, s56
s_cselect_b32 s71, 0, 1
s_or_b32 s88, s70, s71
s_cselect_b32 s10, 268435456, 0
s_cmp_lg_u32 s70, 0
s_cselect_b64 s[84:85], s[52:53], s[54:55]
s_cselect_b64 s[58:59], s[44:45], s[46:47]
s_mul_i32 s86, s84, s20
s_add_u32 s86, s86, s58
s_mul_i32 s87, s84, s21
s_add_u32 s87, s87, s59
s_andn2_b32 s71, s71, s70
s_add_u32 s52, s52, s70
s_add_u32 s54, s54, s71
s_mov_b32 s89, s88
g_go_100:
s_add_u32 m0, s50, 0
s_nop 0
buffer_load_dwordx4 v8, s[4:7], s86 offen offset:0 sc1 lds
buffer_load_dwordx4 v9, s[4:7], s86 offen offset:1024 sc1 lds
buffer_load_dwordx4 v10, s[4:7], s86 offen offset:2048 sc1 lds
buffer_load_dwordx4 v11, s[4:7], s86 offen offset:3072 sc1 lds
s_add_u32 m0, s50, 4096
s_nop 0
buffer_load_dwordx4 v12, s[4:7], s86 offen offset:0 sc1 lds
buffer_load_dwordx4 v13, s[4:7], s86 offen offset:1024 sc1 lds
buffer_load_dwordx4 v14, s[4:7], s86 offen offset:2048 sc1 lds
buffer_load_dwordx4 v15, s[4:7], s86 offen offset:3072 sc1 lds
s_add_u32 m0, s50, 8192
s_nop 0
buffer_load_dwordx4 v16, s[4:7], s86 offen offset:0 sc1 lds
buffer_load_dword v24, v22, s[4:7], 0 offen sc1
buffer_store_dword v27, v34, s[4:7], 0 offen
v_mov_b32 v27, s78
s_waitcnt vmcnt(9)
s_barrier
buffer_store_dword v27, v45, s[4:7], s79 offen
buffer_store_dword v27, v44, s[4:7], s79 offen sc1
s_mov_b32 s79, 1879048192
ds_read_b128 v[64:67], v30 offset:0
ds_read_b128 v[68:71], v30 offset:9216
ds_read_b128 v[72:75], v30 offset:18432
ds_read_b128 v[76:79], v30 offset:27648
ds_read_b128 v[80:83], v30 offset:1024
ds_read_b128 v[84:87], v30 offset:10240
ds_read_b128 v[88:91], v30 offset:19456
ds_read_b128 v[92:95], v30 offset:28672
s_waitcnt vmcnt(8)
s_barrier
s_branch g_body_82
g_slow_94:
v_mfma_f32_16x16x32_bf16 v[228:231], a[196:199], v[172:175], v[228:231]
v_mfma_f32_16x16x32_bf16 v[224:227], a[200:203], v[176:179], v[224:227]
v_mfma_f32_16x16x32_bf16 v[228:231], a[200:203], v[180:183], v[228:231]
v_mfma_f32_16x16x32_bf16 v[224:227], a[204:207], v[184:187], v[224:227]
v_mfma_f32_16x16x32_bf16 v[228:231], a[204:207], v[188:191], v[228:231]
v_mfma_f32_16x16x32_bf16 v[224:227], a[208:211], v[192:195], v[224:227]
v_mfma_f32_16x16x32_bf16 v[228:231], a[208:211], v[196:199], v[228:231]
v_mfma_f32_16x16x32_bf16 v[224:227], a[212:215], v[200:203], v[224:227]
v_mfma_f32_16x16x32_bf16 v[228:231], a[212:215], v[204:207], v[228:231]
s_nop 6
v_cvt_pk_bf16_f32 v56, v224, v225
v_cvt_pk_bf16_f32 v57, v226, v227
v_cvt_pk_bf16_f32 v58, v228, v229
v_cvt_pk_bf16_f32 v59, v230, v231
s_nop 0
v_permlane16_swap_b32 v56, v58
v_permlane16_swap_b32 v57, v59
buffer_store_dwordx4 v[56:59], v21, s[4:7], s87 offen sc1
s_mov_b32 s87, 1879048192
s_waitcnt vmcnt(4)
ds_write_b32 v18, v24
s_waitcnt lgkmcnt(0)
s_barrier
ds_read_b32 v33, v32
s_waitcnt lgkmcnt(0)
v_cmp_gt_u32 vcc, s52, v33
v_cmp_gt_u32 s[58:59], s54, v33
s_and_b32 vcc_lo, vcc_lo, s56
s_cselect_b32 s70, 0, 1
s_and_b32 s59, s59, s56
s_cselect_b32 s71, 0, s89
s_or_b32 s94, s70, s71
s_cselect_b32 s10, 268435456, 0
s_cmp_lg_u32 s70, 0
s_cselect_b64 s[90:91], s[52:53], s[54:55]
s_cselect_b64 s[58:59], s[44:45], s[46:47]
s_mul_i32 s92, s90, s20
s_add_u32 s92, s92, s58
s_mul_i32 s93, s90, s21
s_add_u32 s93, s93, s59
s_andn2_b32 s71, s71, s70
s_add_u32 s52, s52, s70
s_add_u32 s54, s54, s71
s_mov_b32 s95, s94
s_cmp_lg_u32 s94, 0
s_cbranch_scc1 g_go_104
v_mov_b32 v27, s84
s_waitcnt vmcnt(0)
s_barrier
s_add_u32 s70, s52, s54
s_cmp_eq_u32 s70, 130
s_cbranch_scc1 g_fin_84
s_cmp_lg_u32 s3, 0
s_cbranch_scc1 sp_ok_106_j
s_mov_b32 s23, 0
buffer_load_dword v33, v22, s[4:7], 0 offen sc1
buffer_store_dword v27, v45, s[4:7], s85 offen
buffer_store_dword v27, v44, s[4:7], s85 offen sc1
s_waitcnt vmcnt(2)
s_branch sp_loop_105_e
sp_loop_105:
buffer_load_dword v33, v22, s[4:7], 0 offen sc1
s_add_u32 s23, s23, 1
s_cmp_gt_u32 s23, 150000
s_cbranch_scc1 sp_bad_107
s_waitcnt vmcnt(0)
sp_loop_105_e:
v_cmp_gt_u32 vcc, s52, v33
v_cmp_gt_u32 s[58:59], s54, v33
s_and_b32 vcc_lo, vcc_lo, s56
s_cbranch_scc0 sp_ok_106
s_cmp_gt_u32 s23, 4
s_cselect_b32 s70, 0, s56
s_cmp_lg_u32 s89, 0
s_cselect_b32 s70, 0, s70
s_or_b32 s59, s59, s70
s_and_b32 s59, s59, s56
s_cbranch_scc0 sp_ok_106
s_sleep 1
s_branch sp_loop_105
sp_bad_107:
s_mov_b32 s98, 1027
s_branch L_fail
sp_ok_106:
ds_write_b32 v18, v33
s_waitcnt lgkmcnt(0)
sp_ok_106_j:
s_barrier
ds_read_b32 v33, v32
s_waitcnt lgkmcnt(0)
s_mov_b32 s85, 1879048192
v_cmp_gt_u32 vcc, s52, v33
v_cmp_gt_u32 s[58:59], s54, v33
s_and_b32 vcc_lo, vcc_lo, s56
s_cselect_b32 s70, 0, 1
s_and_b32 s59, s59, s56
s_cselect_b32 s71, 0, 1
s_or_b32 s94, s70, s71
s_cselect_b32 s10, 268435456, 0
s_cmp_lg_u32 s70, 0
s_cselect_b64 s[90:91], s[52:53], s[54:55]
s_cselect_b64 s[58:59], s[44:45], s[46:47]
s_mul_i32 s92, s90, s20
s_add_u32 s92, s92, s58
s_mul_i32 s93, s90, s21
s_add_u32 s93, s93, s59
s_andn2_b32 s71, s71, s70
s_add_u32 s52, s52, s70
s_add_u32 s54, s54, s71
s_mov_b32 s95, s94
g_go_104:
s_add_u32 m0, s51, 0
s_nop 0
buffer_load_dwordx4 v8, s[4:7], s92 offen offset:0 sc1 lds
buffer_load_dwordx4 v9, s[4:7], s92 offen offset:1024 sc1 lds
buffer_load_dwordx4 v10, s[4:7], s92 offen offset:2048 sc1 lds
buffer_load_dwordx4 v11, s[4:7], s92 offen offset:3072 sc1 lds
s_add_u32 m0, s51, 4096
s_nop 0
buffer_load_dwordx4 v12, s[4:7], s92 offen offset:0 sc1 lds
buffer_load_dwordx4 v13, s[4:7], s92 offen offset:1024 sc1 lds
buffer_load_dwordx4 v14, s[4:7], s92 offen offset:2048 sc1 lds
buffer_load_dwordx4 v15, s[4:7], s92 offen offset:3072 sc1 lds
s_add_u32 m0, s51, 8192
s_nop 0
buffer_load_dwordx4 v16, s[4:7], s92 offen offset:0 sc1 lds
buffer_load_dword v24, v22, s[4:7], 0 offen sc1
buffer_store_dword v27, v34, s[4:7], 0 offen
v_mov_b32 v27, s84
s_waitcnt vmcnt(9)
s_barrier
buffer_store_dword v27, v45, s[4:7], s85 offen
buffer_store_dword v27, v44, s[4:7], s85 offen sc1
s_mov_b32 s85, 1879048192
ds_read_b128 v[64:67], v31 offset:0
ds_read_b128 v[68:71], v31 offset:9216
ds_read_b128 v[72:75], v31 offset:18432
ds_read_b128 v[76:79], v31 offset:27648
ds_read_b128 v[80:83], v31 offset:1024
ds_read_b128 v[84:87], v31 offset:10240
ds_read_b128 v[88:91], v31 offset:19456
ds_read_b128 v[92:95], v31 offset:28672
s_waitcnt vmcnt(8)
s_barrier
s_branch g_body_83
g_slow_95:
v_mfma_f32_16x16x32_bf16 v[228:231], a[196:199], v[172:175], v[228:231]
v_mfma_f32_16x16x32_bf16 v[224:227], a[200:203], v[176:179], v[224:227]
v_mfma_f32_16x16x32_bf16 v[228:231], a[200:203], v[180:183], v[228:231]
v_mfma_f32_16x16x32_bf16 v[224:227], a[204:207], v[184:187], v[224:227]
v_mfma_f32_16x16x32_bf16 v[228:231], a[204:207], v[188:191], v[228:231]
v_mfma_f32_16x16x32_bf16 v[224:227], a[208:211], v[192:195], v[224:227]
v_mfma_f32_16x16x32_bf16 v[228:231], a[208:211], v[196:199], v[228:231]
v_mfma_f32_16x16x32_bf16 v[224:227], a[212:215], v[200:203], v[224:227]
v_mfma_f32_16x16x32_bf16 v[228:231], a[212:215], v[204:207], v[228:231]
s_nop 6
v_cvt_pk_bf16_f32 v56, v224, v225
v_cvt_pk_bf16_f32 v57, v226, v227
v_cvt_pk_bf16_f32 v58, v228, v229
v_cvt_pk_bf16_f32 v59, v230, v231
s_nop 0
v_permlane16_swap_b32 v56, v58
v_permlane16_swap_b32 v57, v59
buffer_store_dwordx4 v[56:59], v21, s[4:7], s93 offen sc1
s_mov_b32 s93, 1879048192
s_waitcnt vmcnt(4)
ds_write_b32 v18, v24
s_waitcnt lgkmcnt(0)
s_barrier
ds_read_b32 v33, v32
s_waitcnt lgkmcnt(0)
v_cmp_gt_u32 vcc, s52, v33
v_cmp_gt_u32 s[58:59], s54, v33
s_and_b32 vcc_lo, vcc_lo, s56
s_cselect_b32 s70, 0, 1
s_and_b32 s59, s59, s56
s_cselect_b32 s71, 0, s95
s_or_b32 s76, s70, s71
s_cselect_b32 s10, 268435456, 0
s_cmp_lg_u32 s70, 0
s_cselect_b64 s[72:73], s[52:53], s[54:55]
s_cselect_b64 s[58:59], s[44:45], s[46:47]
s_mul_i32 s74, s72, s20
s_add_u32 s74, s74, s58
s_mul_i32 s75, s72, s21
s_add_u32 s75, s75, s59
s_andn2_b32 s71, s71, s70
s_add_u32 s52, s52, s70
s_add_u32 s54, s54, s71
s_mov_b32 s77, s76
s_cmp_lg_u32 s76, 0
s_cbranch_scc1 g_go_108
v_mov_b32 v27, s90
s_waitcnt vmcnt(0)
s_barrier
s_add_u32 s70, s52, s54
s_cmp_eq_u32 s70, 130
s_cbranch_scc1 g_fin_84
s_cmp_lg_u32 s3, 0
s_cbranch_scc1 sp_ok_110_j
s_mov_b32 s23, 0
buffer_load_dword v33, v22, s[4:7], 0 offen sc1
buffer_store_dword v27, v45, s[4:7], s91 offen
buffer_store_dword v27, v44, s[4:7], s91 offen sc1
s_waitcnt vmcnt(2)
s_branch sp_loop_109_e
sp_loop_109:
buffer_load_dword v33, v22, s[4:7], 0 offen sc1
s_add_u32 s23, s23, 1
s_cmp_gt_u32 s23, 150000
s_cbranch_scc1 sp_bad_111
s_waitcnt vmcnt(0)
sp_loop_109_e:
v_cmp_gt_u32 vcc, s52, v33
v_cmp_gt_u32 s[58:59], s54, v33
s_and_b32 vcc_lo, vcc_lo, s56
s_cbranch_scc0 sp_ok_110
s_cmp_gt_u32 s23, 4
s_cselect_b32 s70, 0, s56
s_cmp_lg_u32 s95, 0
s_cselect_b32 s70, 0, s70
s_or_b32 s59, s59, s70
s_and_b32 s59, s59, s56
s_cbranch_scc0 sp_ok_110
s_sleep 1
s_branch sp_loop_109
sp_bad_111:
s_mov_b32 s98, 1027
s_branch L_fail
sp_ok_110:
ds_write_b32 v18, v33
s_waitcnt lgkmcnt(0)
sp_ok_110_j:
s_barrier
ds_read_b32 v33, v32
s_waitcnt lgkmcnt(0)
s_mov_b32 s91, 1879048192
v_cmp_gt_u32 vcc, s52, v33
v_cmp_gt_u32 s[58:59], s54, v33
s_and_b32 vcc_lo, vcc_lo, s56
s_cselect_b32 s70, 0, 1
s_and_b32 s59, s59, s56
s_cselect_b32 s71, 0, 1
s_or_b32 s76, s70, s71
s_cselect_b32 s10, 268435456, 0
s_cmp_lg_u32 s70, 0
s_cselect_b64 s[72:73], s[52:53], s[54:55]
s_cselect_b64 s[58:59], s[44:45], s[46:47]
s_mul_i32 s74, s72, s20
s_add_u32 s74, s74, s58
s_mul_i32 s75, s72, s21
s_add_u32 s75, s75, s59
s_andn2_b32 s71, s71, s70
s_add_u32 s52, s52, s70
s_add_u32 s54, s54, s71
s_mov_b32 s77, s76
g_go_108:
s_add_u32 m0, s48, 0
s_nop 0
buffer_load_dwordx4 v8, s[4:7], s74 offen offset:0 sc1 lds
buffer_load_dwordx4 v9, s[4:7], s74 offen offset:1024 sc1 lds
buffer_load_dwordx4 v10, s[4:7], s74 offen offset:2048 sc1 lds
buffer_load_dwordx4 v11, s[4:7], s74 offen offset:3072 sc1 lds
s_add_u32 m0, s48, 4096
s_nop 0
buffer_load_dwordx4 v12, s[4:7], s74 offen offset:0 sc1 lds
buffer_load_dwordx4 v13, s[4:7], s74 offen offset:1024 sc1 lds
buffer_load_dwordx4 v14, s[4:7], s74 offen offset:2048 sc1 lds
buffer_load_dwordx4 v15, s[4:7], s74 offen offset:3072 sc1 lds
s_add_u32 m0, s48, 8192
s_nop 0
buffer_load_dwordx4 v16, s[4:7], s74 offen offset:0 sc1 lds
buffer_load_dword v24, v22, s[4:7], 0 offen sc1
buffer_store_dword v27, v34, s[4:7], 0 offen
v_mov_b32 v27, s90
s_waitcnt vmcnt(9)
s_barrier
buffer_store_dword v27, v45, s[4:7], s91 offen
buffer_store_dword v27, v44, s[4:7], s91 offen sc1
s_mov_b32 s91, 1879048192
ds_read_b128 v[64:67], v28 offset:0
ds_read_b128 v[68:71], v28 offset:9216
ds_read_b128 v[72:75], v28 offset:18432
ds_read_b128 v[76:79], v28 offset:27648
ds_read_b128 v[80:83], v28 offset:1024
ds_read_b128 v[84:87], v28 offset:10240
ds_read_b128 v[88:91], v28 offset:19456
ds_read_b128 v[92:95], v28 offset:28672
s_waitcnt vmcnt(8)
s_barrier
s_branch g_body_80
g_fin_84:
buffer_store_dword v27, v45, s[4:7], s91 offen
buffer_store_dword v27, v44, s[4:7], s91 offen sc1
s_endpgm
H_dn:
s_mul_i32 s75, s74, 43
s_lshr_b32 s75, s75, 7
s_mul_i32 s76, s75, 3
s_sub_u32 s76, s74, s76
s_mov_b32 s8, s36
s_and_b32 s9, s37, 0xffff
s_mov_b32 s10, 5308416
s_mov_b32 s11, 0x20000
s_mul_i32 s77, s76, 12
s_mul_i32 s78, s3, 3
s_add_u32 s77, s77, s78
s_mul_i32 s78, s75, 663552
v_bfe_u32 v1, v0, 4, 1
v_bfe_u32 v2, v0, 1, 3
v_lshl_add_u32 v1, v1, 3, v2
v_mul_u32_u24 v1, 2304, v1
v_lshrrev_b32 v2, 5, v0
v_lshl_add_u32 v1, v2, 5, v1
v_and_b32 v2, 1, v0
v_lshl_add_u32 v5, v2, 4, v1
s_mul_i32 s79, s75, 36864
s_add_u32 s80, s77, 0
s_lshl_b32 s81, s80, 5
s_add_u32 s48, s81, s78
s_lshl_b32 s81, s80, 6
s_add_u32 s81, s81, s79
v_add_u32 v19, s81, v5
s_add_u32 s80, s77, 1
s_lshl_b32 s81, s80, 5
s_add_u32 s49, s81, s78
s_lshl_b32 s81, s80, 6
s_add_u32 s81, s81, s79
v_add_u32 v20, s81, v5
s_add_u32 s80, s77, 2
s_lshl_b32 s81, s80, 5
s_add_u32 s50, s81, s78
s_lshl_b32 s81, s80, 6
s_add_u32 s81, s81, s79
v_add_u32 v21, s81, v5
s_cmp_lg_u32 s3, 0
s_cbranch_scc1 wp_ok_113
s_mov_b32 s16, s40
s_and_b32 s17, s41, 0xffff
s_mov_b32 s18, 256
s_mov_b32 s19, 0x20000
v_mov_b32 v1, 224
s_mov_b32 s98, 0
s_mov_b64 exec, 1
wp_loop_112:
buffer_load_dword v2, v1, s[16:19], 0 offen sc1
s_add_u32 s98, s98, 1
s_cmp_gt_u32 s98, 150000
s_cbranch_scc1 wp_bad_114
s_waitcnt vmcnt(0)
v_readfirstlane_b32 s97, v2
s_nop 0
s_cmp_ge_u32 s97, 32
s_cbranch_scc1 wp_ok_113
s_sleep 8
s_branch wp_loop_112
wp_bad_114:
s_mov_b32 s98, 513
s_branch L_fail
wp_ok_113:
s_mov_b64 exec, -1
s_barrier
v_lshrrev_b32 v1, 5, v0
v_bfe_u32 v2, v0, 3, 1
v_lshl_add_u32 v1, v1, 1, v2
v_bfe_u32 v2, v0, 4, 1
v_bfe_u32 v3, v0, 1, 2
v_lshlrev_b32 v1, 3, v1
v_lshl_add_u32 v1, v2, 2, v1
v_add_u32 v1, v1, v3
v_mul_u32_u24 v1, 1152, v1
v_and_b32 v2, 1, v0
v_lshl_add_u32 v63, v2, 4, v1
s_mul_i32 s70, s3, 40960
v_lshrrev_b32 v1, 5, v0
v_lshlrev_b32 v1, 9, v1
v_bfe_u32 v2, v0, 4, 1
v_lshl_add_u32 v1, v2, 7, v1
v_add_u32 v1, s70, v1
v_and_b32 v2, 15, v0
v_lshl_add_u32 v2, v2, 3, v1
v_add_u32 v60, 0, v2
v_add_u32 v61, 1024, v2
v_add_u32 v62, 2048, v2
s_add_u32 m0, s70, 0
s_add_u32 s71, s48, 0
buffer_load_dwordx4 v63, s[8:11], s71 offen lds
s_add_u32 m0, s70, 1024
s_add_u32 s71, s49, 0
buffer_load_dwordx4 v63, s[8:11], s71 offen lds
s_add_u32 m0, s70, 2048
s_add_u32 s71, s50, 0
buffer_load_dwordx4 v63, s[8:11], s71 offen lds
s_add_u32 m0, s70, 3072
s_add_u32 s71, s48, 36864
buffer_load_dwordx4 v63, s[8:11], s71 offen lds
s_add_u32 m0, s70, 4096
s_add_u32 s71, s49, 36864
buffer_load_dwordx4 v63, s[8:11], s71 offen lds
s_add_u32 m0, s70, 5120
s_add_u32 s71, s50, 36864
buffer_load_dwordx4 v63, s[8:11], s71 offen lds
s_add_u32 m0, s70, 6144
s_add_u32 s71, s48, 73728
buffer_load_dwordx4 v63, s[8:11], s71 offen lds
s_add_u32 m0, s70, 7168
s_add_u32 s71, s49, 73728
buffer_load_dwordx4 v63, s[8:11], s71 offen lds
s_add_u32 m0, s70, 8192
s_add_u32 s71, s50, 73728
buffer_load_dwordx4 v63, s[8:11], s71 offen lds
s_add_u32 m0, s70, 9216
s_add_u32 s71, s48, 110592
buffer_load_dwordx4 v63, s[8:11], s71 offen lds
s_add_u32 m0, s70, 10240
s_add_u32 s71, s49, 110592
buffer_load_dwordx4 v63, s[8:11], s71 offen lds
s_add_u32 m0, s70, 11264
s_add_u32 s71, s50, 110592
buffer_load_dwordx4 v63, s[8:11], s71 offen lds
s_add_u32 m0, s70, 12288
s_add_u32 s71, s48, 147456
buffer_load_dwordx4 v63, s[8:11], s71 offen lds
s_add_u32 m0, s70, 13312
s_add_u32 s71, s49, 147456
buffer_load_dwordx4 v63, s[8:11], s71 offen lds
s_add_u32 m0, s70, 14336
s_add_u32 s71, s50, 147456
buffer_load_dwordx4 v63, s[8:11], s71 offen lds
s_add_u32 m0, s70, 15360
s_add_u32 s71, s48, 184320
buffer_load_dwordx4 v63, s[8:11], s71 offen lds
s_add_u32 m0, s70, 16384
s_add_u32 s71, s49, 184320
buffer_load_dwordx4 v63, s[8:11], s71 offen lds
s_add_u32 m0, s70, 17408
s_add_u32 s71, s50, 184320
buffer_load_dwordx4 v63, s[8:11], s71 offen lds
s_add_u32 m0, s70, 18432
s_add_u32 s71, s48, 221184
buffer_load_dwordx4 v63, s[8:11], s71 offen lds
s_add_u32 m0, s70, 19456
s_add_u32 s71, s49, 221184
buffer_load_dwordx4 v63, s[8:11], s71 offen lds
s_add_u32 m0, s70, 20480
s_add_u32 s71, s50, 221184
buffer_load_dwordx4 v63, s[8:11], s71 offen lds
s_add_u32 m0, s70, 21504
s_add_u32 s71, s48, 258048
buffer_load_dwordx4 v63, s[8:11], s71 offen lds
s_add_u32 m0, s70, 22528
s_add_u32 s71, s49, 258048
buffer_load_dwordx4 v63, s[8:11], s71 offen lds
s_add_u32 m0, s70, 23552
s_add_u32 s71, s50, 258048
buffer_load_dwordx4 v63, s[8:11], s71 offen lds
s_add_u32 m0, s70, 24576
s_add_u32 s71, s48, 294912
buffer_load_dwordx4 v63, s[8:11], s71 offen lds
s_add_u32 m0, s70, 25600
s_add_u32 s71, s49, 294912
buffer_load_dwordx4 v63, s[8:11], s71 offen lds
s_add_u32 m0, s70, 26624
s_add_u32 s71, s50, 294912
buffer_load_dwordx4 v63, s[8:11], s71 offen lds
s_add_u32 m0, s70, 27648
s_add_u32 s71, s48, 331776
buffer_load_dwordx4 v63, s[8:11], s71 offen lds
s_add_u32 m0, s70, 28672
s_add_u32 s71, s49, 331776
buffer_load_dwordx4 v63, s[8:11], s71 offen lds
s_add_u32 m0, s70, 29696
s_add_u32 s71, s50, 331776
buffer_load_dwordx4 v63, s[8:11], s71 offen lds
s_add_u32 m0, s70, 30720
s_add_u32 s71, s48, 368640
buffer_load_dwordx4 v63, s[8:11], s71 offen lds
s_add_u32 m0, s70, 31744
s_add_u32 s71, s49, 368640
buffer_load_dwordx4 v63, s[8:11], s71 offen lds
s_add_u32 m0, s70, 32768
s_add_u32 s71, s50, 368640
buffer_load_dwordx4 v63, s[8:11], s71 offen lds
s_add_u32 m0, s70, 33792
s_add_u32 s71, s48, 405504
buffer_load_dwordx4 v63, s[8:11], s71 offen lds
s_add_u32 m0, s70, 34816
s_add_u32 s71, s49, 405504
buffer_load_dwordx4 v63, s[8:11], s71 offen lds
s_add_u32 m0, s70, 35840
s_add_u32 s71, s50, 405504
buffer_load_dwordx4 v63, s[8:11], s71 offen lds
s_add_u32 m0, s70, 36864
s_add_u32 s71, s48, 442368
buffer_load_dwordx4 v63, s[8:11], s71 offen lds
s_add_u32 m0, s70, 37888
s_add_u32 s71, s49, 442368
buffer_load_dwordx4 v63, s[8:11], s71 offen lds
s_add_u32 m0, s70, 38912
s_add_u32 s71, s50, 442368
buffer_load_dwordx4 v63, s[8:11], s71 offen lds
s_waitcnt vmcnt(36)
ds_read_b64_tr_b16 a[0:1], v60 offset:0
ds_read_b64_tr_b16 a[2:3], v60 offset:256
ds_read_b64_tr_b16 a[72:73], v61 offset:0
ds_read_b64_tr_b16 a[74:75], v61 offset:256
ds_read_b64_tr_b16 a[144:145], v62 offset:0
ds_read_b64_tr_b16 a[146:147], v62 offset:256
s_waitcnt lgkmcnt(0)
s_add_u32 m0, s70, 0
s_add_u32 s71, s48, 479232
buffer_load_dwordx4 v63, s[8:11], s71 offen lds
s_add_u32 m0, s70, 1024
s_add_u32 s71, s49, 479232
buffer_load_dwordx4 v63, s[8:11], s71 offen lds
s_add_u32 m0, s70, 2048
s_add_u32 s71, s50, 479232
buffer_load_dwordx4 v63, s[8:11], s71 offen lds
s_waitcnt vmcnt(36)
ds_read_b64_tr_b16 a[4:5], v60 offset:3072
ds_read_b64_tr_b16 a[6:7], v60 offset:3328
ds_read_b64_tr_b16 a[76:77], v61 offset:3072
ds_read_b64_tr_b16 a[78:79], v61 offset:3328
ds_read_b64_tr_b16 a[148:149], v62 offset:3072
ds_read_b64_tr_b16 a[150:151], v62 offset:3328
s_waitcnt lgkmcnt(0)
s_add_u32 m0, s70, 3072
s_add_u32 s71, s48, 516096
buffer_load_dwordx4 v63, s[8:11], s71 offen lds
s_add_u32 m0, s70, 4096
s_add_u32 s71, s49, 516096
buffer_load_dwordx4 v63, s[8:11], s71 offen lds
s_add_u32 m0, s70, 5120
s_add_u32 s71, s50, 516096
buffer_load_dwordx4 v63, s[8:11], s71 offen lds
s_waitcnt vmcnt(36)
ds_read_b64_tr_b16 a[8:9], v60 offset:6144
ds_read_b64_tr_b16 a[10:11], v60 offset:6400
ds_read_b64_tr_b16 a[80:81], v61 offset:6144
ds_read_b64_tr_b16 a[82:83], v61 offset:6400
ds_read_b64_tr_b16 a[152:153], v62 offset:6144
ds_read_b64_tr_b16 a[154:155], v62 offset:6400
s_waitcnt lgkmcnt(0)
s_add_u32 m0, s70, 6144
s_add_u32 s71, s48, 552960
buffer_load_dwordx4 v63, s[8:11], s71 offen lds
s_add_u32 m0, s70, 7168
s_add_u32 s71, s49, 552960
buffer_load_dwordx4 v63, s[8:11], s71 offen lds
s_add_u32 m0, s70, 8192
s_add_u32 s71, s50, 552960
buffer_load_dwordx4 v63, s[8:11], s71 offen lds
s_waitcnt vmcnt(36)
ds_read_b64_tr_b16 a[12:13], v60 offset:9216
ds_read_b64_tr_b16 a[14:15], v60 offset:9472
ds_read_b64_tr_b16 a[84:85], v61 offset:9216
ds_read_b64_tr_b16 a[86:87], v61 offset:9472
ds_read_b64_tr_b16 a[156:157], v62 offset:9216
ds_read_b64_tr_b16 a[158:159], v62 offset:9472
s_waitcnt lgkmcnt(0)
s_add_u32 m0, s70, 9216
s_add_u32 s71, s48, 589824
buffer_load_dwordx4 v63, s[8:11], s71 offen lds
s_add_u32 m0, s70, 10240
s_add_u32 s71, s49, 589824
buffer_load_dwordx4 v63, s[8:11], s71 offen lds
s_add_u32 m0, s70, 11264
s_add_u32 s71, s50, 589824
buffer_load_dwordx4 v63, s[8:11], s71 offen lds
s_waitcnt vmcnt(36)
ds_read_b64_tr_b16 a[16:17], v60 offset:12288
ds_read_b64_tr_b16 a[18:19], v60 offset:12544
ds_read_b64_tr_b16 a[88:89], v61 offset:12288
ds_read_b64_tr_b16 a[90:91], v61 offset:12544
ds_read_b64_tr_b16 a[160:161], v62 offset:12288
ds_read_b64_tr_b16 a[162:163], v62 offset:12544
s_waitcnt lgkmcnt(0)
s_add_u32 m0, s70, 12288
s_add_u32 s71, s48, 626688
buffer_load_dwordx4 v63, s[8:11], s71 offen lds
s_add_u32 m0, s70, 13312
s_add_u32 s71, s49, 626688
buffer_load_dwordx4 v63, s[8:11], s71 offen lds
s_add_u32 m0, s70, 14336
s_add_u32 s71, s50, 626688
buffer_load_dwordx4 v63, s[8:11], s71 offen lds
s_waitcnt vmcnt(36)
ds_read_b64_tr_b16 a[20:21], v60 offset:15360
ds_read_b64_tr_b16 a[22:23], v60 offset:15616
ds_read_b64_tr_b16 a[92:93], v61 offset:15360
ds_read_b64_tr_b16 a[94:95], v61 offset:15616
ds_read_b64_tr_b16 a[164:165], v62 offset:15360
ds_read_b64_tr_b16 a[166:167], v62 offset:15616
s_waitcnt vmcnt(33)
ds_read_b64_tr_b16 a[24:25], v60 offset:18432
ds_read_b64_tr_b16 a[26:27], v60 offset:18688
ds_read_b64_tr_b16 a[96:97], v61 offset:18432
ds_read_b64_tr_b16 a[98:99], v61 offset:18688
ds_read_b64_tr_b16 a[168:169], v62 offset:18432
ds_read_b64_tr_b16 a[170:171], v62 offset:18688
s_waitcnt vmcnt(30)
ds_read_b64_tr_b16 a[28:29], v60 offset:21504
ds_read_b64_tr_b16 a[30:31], v60 offset:21760
ds_read_b64_tr_b16 a[100:101], v61 offset:21504
ds_read_b64_tr_b16 a[102:103], v61 offset:21760
ds_read_b64_tr_b16 a[172:173], v62 offset:21504
ds_read_b64_tr_b16 a[174:175], v62 offset:21760
s_waitcnt vmcnt(27)
ds_read_b64_tr_b16 a[32:33], v60 offset:24576
ds_read_b64_tr_b16 a[34:35], v60 offset:24832
ds_read_b64_tr_b16 a[104:105], v61 offset:24576
ds_read_b64_tr_b16 a[106:107], v61 offset:24832
ds_read_b64_tr_b16 a[176:177], v62 offset:24576
ds_read_b64_tr_b16 a[178:179], v62 offset:24832
s_waitcnt vmcnt(24)
ds_read_b64_tr_b16 a[36:37], v60 offset:27648
ds_read_b64_tr_b16 a[38:39], v60 offset:27904
ds_read_b64_tr_b16 a[108:109], v61 offset:27648
ds_read_b64_tr_b16 a[110:111], v61 offset:27904
ds_read_b64_tr_b16 a[180:181], v62 offset:27648
ds_read_b64_tr_b16 a[182:183], v62 offset:27904
s_waitcnt vmcnt(21)
ds_read_b64_tr_b16 a[40:41], v60 offset:30720
ds_read_b64_tr_b16 a[42:43], v60 offset:30976
ds_read_b64_tr_b16 a[112:113], v61 offset:30720
ds_read_b64_tr_b16 a[114:115], v61 offset:30976
ds_read_b64_tr_b16 a[184:185], v62 offset:30720
ds_read_b64_tr_b16 a[186:187], v62 offset:30976
s_waitcnt vmcnt(18)
ds_read_b64_tr_b16 a[44:45], v60 offset:33792
ds_read_b64_tr_b16 a[46:47], v60 offset:34048
ds_read_b64_tr_b16 a[116:117], v61 offset:33792
ds_read_b64_tr_b16 a[118:119], v61 offset:34048
ds_read_b64_tr_b16 a[188:189], v62 offset:33792
ds_read_b64_tr_b16 a[190:191], v62 offset:34048
s_waitcnt vmcnt(15)
ds_read_b64_tr_b16 a[48:49], v60 offset:36864
ds_read_b64_tr_b16 a[50:51], v60 offset:37120
ds_read_b64_tr_b16 a[120:121], v61 offset:36864
ds_read_b64_tr_b16 a[122:123], v61 offset:37120
ds_read_b64_tr_b16 a[192:193], v62 offset:36864
ds_read_b64_tr_b16 a[194:195], v62 offset:37120
s_waitcnt vmcnt(12)
ds_read_b64_tr_b16 a[52:53], v60 offset:0
ds_read_b64_tr_b16 a[54:55], v60 offset:256
ds_read_b64_tr_b16 a[124:125], v61 offset:0
ds_read_b64_tr_b16 a[126:127], v61 offset:256
ds_read_b64_tr_b16 a[196:197], v62 offset:0
ds_read_b64_tr_b16 a[198:199], v62 offset:256
s_waitcnt vmcnt(9)
ds_read_b64_tr_b16 a[56:57], v60 offset:3072
ds_read_b64_tr_b16 a[58:59], v60 offset:3328
ds_read_b64_tr_b16 a[128:129], v61 offset:3072
ds_read_b64_tr_b16 a[130:131], v61 offset:3328
ds_read_b64_tr_b16 a[200:201], v62 offset:3072
ds_read_b64_tr_b16 a[202:203], v62 offset:3328
s_waitcnt vmcnt(6)
ds_read_b64_tr_b16 a[60:61], v60 offset:6144
ds_read_b64_tr_b16 a[62:63], v60 offset:6400
ds_read_b64_tr_b16 a[132:133], v61 offset:6144
ds_read_b64_tr_b16 a[134:135], v61 offset:6400
ds_read_b64_tr_b16 a[204:205], v62 offset:6144
ds_read_b64_tr_b16 a[206:207], v62 offset:6400
s_waitcnt vmcnt(3)
ds_read_b64_tr_b16 a[64:65], v60 offset:9216
ds_read_b64_tr_b16 a[66:67], v60 offset:9472
ds_read_b64_tr_b16 a[136:137], v61 offset:9216
ds_read_b64_tr_b16 a[138:139], v61 offset:9472
ds_read_b64_tr_b16 a[208:209], v62 offset:9216
ds_read_b64_tr_b16 a[210:211], v62 offset:9472
s_waitcnt vmcnt(0)
ds_read_b64_tr_b16 a[68:69], v60 offset:12288
ds_read_b64_tr_b16 a[70:71], v60 offset:12544
ds_read_b64_tr_b16 a[140:141], v61 offset:12288
ds_read_b64_tr_b16 a[142:143], v61 offset:12544
ds_read_b64_tr_b16 a[212:213], v62 offset:12288
ds_read_b64_tr_b16 a[214:215], v62 offset:12544
s_waitcnt lgkmcnt(0)
v_lshlrev_b32 v17, 4, v0
s_lshl_b32 s70, s3, 10
v_add_u32 v1, s70, v17
v_add_u32 v8, 4096, v1
v_add_u32 v9, 7168, v1
v_add_u32 v10, 10240, v1
v_add_u32 v11, 13312, v1
v_add_u32 v12, 20480, v1
v_add_u32 v13, 23552, v1
v_add_u32 v14, 26624, v1
v_add_u32 v15, 29696, v1
v_add_u32 v16, 36864, v1
s_mul_i32 s77, s75, 6
v_and_b32 v2, 31, v0
v_add_u32 v1, s77, v2
v_mul_u32_u24 v1, 128, v1
v_lshrrev_b32 v3, 5, v0
v_mul_u32_u24 v3, 32768, v3
v_add_u32 v1, 23552, v1
v_add_u32 v1, v1, v3
v_mov_b32 v3, 2147483632
s_cmp_eq_u32 s3, 0
s_cselect_b32 s71, 6, 0
v_cmp_gt_u32 vcc, s71, v2
s_nop 1
v_cndmask_b32 v22, v3, v1, vcc
s_mov_b32 s56, 0x3f
s_mul_i32 s70, s74, 128
s_add_u32 s70, s70, 29696
v_mov_b32 v1, s70
s_min_u32 s71, s71, 1
v_cmp_gt_u32 vcc, s71, v0
s_nop 1
v_cndmask_b32 v44, v3, v1, vcc
v_add_u32 v45, 65536, v44
s_getpc_b64 s[96:97]
pc_115:
s_add_u32 s96, s96, L_writers-pc_115
s_addc_u32 s97, s97, 0
v_subrev_u32 v23, 0, v22
v_lshrrev_b32 v23, 7, v23
v_cmp_gt_u32 vcc, 0x200, v23
s_nop 1
v_cndmask_b32 v23, 0, v23, vcc
global_load_ubyte v23, v23, s[96:97]
s_mul_i32 s77, s75, 36864
s_add_u32 s44, s77, 161517568
s_mov_b32 s45, 218144768
s_mov_b32 s52, 1
s_mov_b32 s53, 0
s_add_u32 s46, s77, 180391936
s_mov_b32 s47, 218144768
s_mov_b32 s54, 1
s_mov_b32 s55, 32768
s_mov_b32 s25, 200
s_mov_b32 s20, 294912
s_mov_b32 s21, 294912
s_branch G_sss18
H_wo:
s_mul_i32 s75, s74, 43
s_lshr_b32 s75, s75, 7
s_mul_i32 s76, s75, 3
s_sub_u32 s76, s74, s76
s_mov_b32 s8, s30
s_and_b32 s9, s31, 0xffff
s_mov_b32 s10, 4718592
s_mov_b32 s11, 0x20000
s_mul_i32 s77, s76, 12
s_mul_i32 s78, s3, 3
s_add_u32 s77, s77, s78
s_mul_i32 s78, s75, 589824
v_bfe_u32 v1, v0, 4, 1
v_bfe_u32 v2, v0, 1, 3
v_lshl_add_u32 v1, v1, 3, v2
v_mul_u32_u24 v1, 2304, v1
v_lshrrev_b32 v2, 5, v0
v_lshl_add_u32 v1, v2, 5, v1
v_and_b32 v2, 1, v0
v_lshl_add_u32 v5, v2, 4, v1
s_mul_i32 s79, s75, 36864
s_add_u32 s80, s77, 0
s_lshl_b32 s81, s80, 5
s_add_u32 s48, s81, s78
s_lshl_b32 s81, s80, 6
s_add_u32 s81, s81, s79
v_add_u32 v19, s81, v5
s_add_u32 s80, s77, 1
s_lshl_b32 s81, s80, 5
s_add_u32 s49, s81, s78
s_lshl_b32 s81, s80, 6
s_add_u32 s81, s81, s79
v_add_u32 v20, s81, v5
s_add_u32 s80, s77, 2
s_lshl_b32 s81, s80, 5
s_add_u32 s50, s81, s78
s_lshl_b32 s81, s80, 6
s_add_u32 s81, s81, s79
v_add_u32 v21, s81, v5
v_lshrrev_b32 v1, 5, v0
v_bfe_u32 v2, v0, 3, 1
v_lshl_add_u32 v1, v1, 1, v2
v_bfe_u32 v2, v0, 4, 1
v_bfe_u32 v3, v0, 1, 2
v_lshlrev_b32 v1, 2, v1
v_lshl_add_u32 v1, v2, 4, v1
v_add_u32 v1, v1, v3
v_mul_u32_u24 v1, 1152, v1
v_and_b32 v2, 1, v0
v_lshl_add_u32 v63, v2, 4, v1
s_mul_i32 s70, s3, 40960
v_lshrrev_b32 v1, 5, v0
v_lshlrev_b32 v1, 9, v1
v_bfe_u32 v2, v0, 4, 1
v_lshl_add_u32 v1, v2, 7, v1
v_add_u32 v1, s70, v1
v_and_b32 v2, 15, v0
v_lshl_add_u32 v2, v2, 3, v1
v_add_u32 v60, 0, v2
v_add_u32 v61, 1024, v2
v_add_u32 v62, 2048, v2
s_add_u32 m0, s70, 0
s_add_u32 s71, s48, 0
buffer_load_dwordx4 v63, s[8:11], s71 offen lds
s_add_u32 m0, s70, 1024
s_add_u32 s71, s49, 0
buffer_load_dwordx4 v63, s[8:11], s71 offen lds
s_add_u32 m0, s70, 2048
s_add_u32 s71, s50, 0
buffer_load_dwordx4 v63, s[8:11], s71 offen lds
s_add_u32 m0, s70, 3072
s_add_u32 s71, s48, 36864
buffer_load_dwordx4 v63, s[8:11], s71 offen lds
s_add_u32 m0, s70, 4096
s_add_u32 s71, s49, 36864
buffer_load_dwordx4 v63, s[8:11], s71 offen lds
s_add_u32 m0, s70, 5120
s_add_u32 s71, s50, 36864
buffer_load_dwordx4 v63, s[8:11], s71 offen lds
s_add_u32 m0, s70, 6144
s_add_u32 s71, s48, 73728
buffer_load_dwordx4 v63, s[8:11], s71 offen lds
s_add_u32 m0, s70, 7168
s_add_u32 s71, s49, 73728
buffer_load_dwordx4 v63, s[8:11], s71 offen lds
s_add_u32 m0, s70, 8192
s_add_u32 s71, s50, 73728
buffer_load_dwordx4 v63, s[8:11], s71 offen lds
s_add_u32 m0, s70, 9216
s_add_u32 s71, s48, 110592
buffer_load_dwordx4 v63, s[8:11], s71 offen lds
s_add_u32 m0, s70, 10240
s_add_u32 s71, s49, 110592
buffer_load_dwordx4 v63, s[8:11], s71 offen lds
s_add_u32 m0, s70, 11264
s_add_u32 s71, s50, 110592
buffer_load_dwordx4 v63, s[8:11], s71 offen lds
s_add_u32 m0, s70, 12288
s_add_u32 s71, s48, 147456
buffer_load_dwordx4 v63, s[8:11], s71 offen lds
s_add_u32 m0, s70, 13312
s_add_u32 s71, s49, 147456
buffer_load_dwordx4 v63, s[8:11], s71 offen lds
s_add_u32 m0, s70, 14336
s_add_u32 s71, s50, 147456
buffer_load_dwordx4 v63, s[8:11], s71 offen lds
s_add_u32 m0, s70, 15360
s_add_u32 s71, s48, 184320
buffer_load_dwordx4 v63, s[8:11], s71 offen lds
s_add_u32 m0, s70, 16384
s_add_u32 s71, s49, 184320
buffer_load_dwordx4 v63, s[8:11], s71 offen lds
s_add_u32 m0, s70, 17408
s_add_u32 s71, s50, 184320
buffer_load_dwordx4 v63, s[8:11], s71 offen lds
s_add_u32 m0, s70, 18432
s_add_u32 s71, s48, 221184
buffer_load_dwordx4 v63, s[8:11], s71 offen lds
s_add_u32 m0, s70, 19456
s_add_u32 s71, s49, 221184
buffer_load_dwordx4 v63, s[8:11], s71 offen lds
s_add_u32 m0, s70, 20480
s_add_u32 s71, s50, 221184
buffer_load_dwordx4 v63, s[8:11], s71 offen lds
s_add_u32 m0, s70, 21504
s_add_u32 s71, s48, 258048
buffer_load_dwordx4 v63, s[8:11], s71 offen lds
s_add_u32 m0, s70, 22528
s_add_u32 s71, s49, 258048
buffer_load_dwordx4 v63, s[8:11], s71 offen lds
s_add_u32 m0, s70, 23552
s_add_u32 s71, s50, 258048
buffer_load_dwordx4 v63, s[8:11], s71 offen lds
s_add_u32 m0, s70, 24576
s_add_u32 s71, s48, 294912
buffer_load_dwordx4 v63, s[8:11], s71 offen lds
s_add_u32 m0, s70, 25600
s_add_u32 s71, s49, 294912
buffer_load_dwordx4 v63, s[8:11], s71 offen lds
s_add_u32 m0, s70, 26624
s_add_u32 s71, s50, 294912
buffer_load_dwordx4 v63, s[8:11], s71 offen lds
s_add_u32 m0, s70, 27648
s_add_u32 s71, s48, 331776
buffer_load_dwordx4 v63, s[8:11], s71 offen lds
s_add_u32 m0, s70, 28672
s_add_u32 s71, s49, 331776
buffer_load_dwordx4 v63, s[8:11], s71 offen lds
s_add_u32 m0, s70, 29696
s_add_u32 s71, s50, 331776
buffer_load_dwordx4 v63, s[8:11], s71 offen lds
s_add_u32 m0, s70, 30720
s_add_u32 s71, s48, 368640
buffer_load_dwordx4 v63, s[8:11], s71 offen lds
s_add_u32 m0, s70, 31744
s_add_u32 s71, s49, 368640
buffer_load_dwordx4 v63, s[8:11], s71 offen lds
s_add_u32 m0, s70, 32768
s_add_u32 s71, s50, 368640
buffer_load_dwordx4 v63, s[8:11], s71 offen lds
s_add_u32 m0, s70, 33792
s_add_u32 s71, s48, 405504
buffer_load_dwordx4 v63, s[8:11], s71 offen lds
s_add_u32 m0, s70, 34816
s_add_u32 s71, s49, 405504
buffer_load_dwordx4 v63, s[8:11], s71 offen lds
s_add_u32 m0, s70, 35840
s_add_u32 s71, s50, 405504
buffer_load_dwordx4 v63, s[8:11], s71 offen lds
s_add_u32 m0, s70, 36864
s_add_u32 s71, s48, 442368
buffer_load_dwordx4 v63, s[8:11], s71 offen lds
s_add_u32 m0, s70, 37888
s_add_u32 s71, s49, 442368
buffer_load_dwordx4 v63, s[8:11], s71 offen lds
s_add_u32 m0, s70, 38912
s_add_u32 s71, s50, 442368
buffer_load_dwordx4 v63, s[8:11], s71 offen lds
s_waitcnt vmcnt(36)
ds_read_b64_tr_b16 a[0:1], v60 offset:0
ds_read_b64_tr_b16 a[2:3], v60 offset:256
ds_read_b64_tr_b16 a[72:73], v61 offset:0
ds_read_b64_tr_b16 a[74:75], v61 offset:256
ds_read_b64_tr_b16 a[144:145], v62 offset:0
ds_read_b64_tr_b16 a[146:147], v62 offset:256
s_waitcnt lgkmcnt(0)
s_add_u32 m0, s70, 0
s_add_u32 s71, s48, 479232
buffer_load_dwordx4 v63, s[8:11], s71 offen lds
s_add_u32 m0, s70, 1024
s_add_u32 s71, s49, 479232
buffer_load_dwordx4 v63, s[8:11], s71 offen lds
s_add_u32 m0, s70, 2048
s_add_u32 s71, s50, 479232
buffer_load_dwordx4 v63, s[8:11], s71 offen lds
s_waitcnt vmcnt(36)
ds_read_b64_tr_b16 a[4:5], v60 offset:3072
ds_read_b64_tr_b16 a[6:7], v60 offset:3328
ds_read_b64_tr_b16 a[76:77], v61 offset:3072
ds_read_b64_tr_b16 a[78:79], v61 offset:3328
ds_read_b64_tr_b16 a[148:149], v62 offset:3072
ds_read_b64_tr_b16 a[150:151], v62 offset:3328
s_waitcnt lgkmcnt(0)
s_add_u32 m0, s70, 3072
s_add_u32 s71, s48, 516096
buffer_load_dwordx4 v63, s[8:11], s71 offen lds
s_add_u32 m0, s70, 4096
s_add_u32 s71, s49, 516096
buffer_load_dwordx4 v63, s[8:11], s71 offen lds
s_add_u32 m0, s70, 5120
s_add_u32 s71, s50, 516096
buffer_load_dwordx4 v63, s[8:11], s71 offen lds
s_waitcnt vmcnt(36)
ds_read_b64_tr_b16 a[8:9], v60 offset:6144
ds_read_b64_tr_b16 a[10:11], v60 offset:6400
ds_read_b64_tr_b16 a[80:81], v61 offset:6144
ds_read_b64_tr_b16 a[82:83], v61 offset:6400
ds_read_b64_tr_b16 a[152:153], v62 offset:6144
ds_read_b64_tr_b16 a[154:155], v62 offset:6400
s_waitcnt lgkmcnt(0)
s_add_u32 m0, s70, 6144
s_add_u32 s71, s48, 552960
buffer_load_dwordx4 v63, s[8:11], s71 offen lds
s_add_u32 m0, s70, 7168
s_add_u32 s71, s49, 552960
buffer_load_dwordx4 v63, s[8:11], s71 offen lds
s_add_u32 m0, s70, 8192
s_add_u32 s71, s50, 552960
buffer_load_dwordx4 v63, s[8:11], s71 offen lds
s_waitcnt vmcnt(36)
ds_read_b64_tr_b16 a[12:13], v60 offset:9216
ds_read_b64_tr_b16 a[14:15], v60 offset:9472
ds_read_b64_tr_b16 a[84:85], v61 offset:9216
ds_read_b64_tr_b16 a[86:87], v61 offset:9472
ds_read_b64_tr_b16 a[156:157], v62 offset:9216
ds_read_b64_tr_b16 a[158:159], v62 offset:9472
s_waitcnt vmcnt(33)
ds_read_b64_tr_b16 a[16:17], v60 offset:12288
ds_read_b64_tr_b16 a[18:19], v60 offset:12544
ds_read_b64_tr_b16 a[88:89], v61 offset:12288
ds_read_b64_tr_b16 a[90:91], v61 offset:12544
ds_read_b64_tr_b16 a[160:161], v62 offset:12288
ds_read_b64_tr_b16 a[162:163], v62 offset:12544
s_waitcnt vmcnt(30)
ds_read_b64_tr_b16 a[20:21], v60 offset:15360
ds_read_b64_tr_b16 a[22:23], v60 offset:15616
ds_read_b64_tr_b16 a[92:93], v61 offset:15360
ds_read_b64_tr_b16 a[94:95], v61 offset:15616
ds_read_b64_tr_b16 a[164:165], v62 offset:15360
ds_read_b64_tr_b16 a[166:167], v62 offset:15616
s_waitcnt vmcnt(27)
ds_read_b64_tr_b16 a[24:25], v60 offset:18432
ds_read_b64_tr_b16 a[26:27], v60 offset:18688
ds_read_b64_tr_b16 a[96:97], v61 offset:18432
ds_read_b64_tr_b16 a[98:99], v61 offset:18688
ds_read_b64_tr_b16 a[168:169], v62 offset:18432
ds_read_b64_tr_b16 a[170:171], v62 offset:18688
s_waitcnt vmcnt(24)
ds_read_b64_tr_b16 a[28:29], v60 offset:21504
ds_read_b64_tr_b16 a[30:31], v60 offset:21760
ds_read_b64_tr_b16 a[100:101], v61 offset:21504
ds_read_b64_tr_b16 a[102:103], v61 offset:21760
ds_read_b64_tr_b16 a[172:173], v62 offset:21504
ds_read_b64_tr_b16 a[174:175], v62 offset:21760
s_waitcnt vmcnt(21)
ds_read_b64_tr_b16 a[32:33], v60 offset:24576
ds_read_b64_tr_b16 a[34:35], v60 offset:24832
ds_read_b64_tr_b16 a[104:105], v61 offset:24576
ds_read_b64_tr_b16 a[106:107], v61 offset:24832
ds_read_b64_tr_b16 a[176:177], v62 offset:24576
ds_read_b64_tr_b16 a[178:179], v62 offset:24832
s_waitcnt vmcnt(18)
ds_read_b64_tr_b16 a[36:37], v60 offset:27648
ds_read_b64_tr_b16 a[38:39], v60 offset:27904
ds_read_b64_tr_b16 a[108:109], v61 offset:27648
ds_read_b64_tr_b16 a[110:111], v61 offset:27904
ds_read_b64_tr_b16 a[180:181], v62 offset:27648
ds_read_b64_tr_b16 a[182:183], v62 offset:27904
s_waitcnt vmcnt(15)
ds_read_b64_tr_b16 a[40:41], v60 offset:30720
ds_read_b64_tr_b16 a[42:43], v60 offset:30976
ds_read_b64_tr_b16 a[112:113], v61 offset:30720
ds_read_b64_tr_b16 a[114:115], v61 offset:30976
ds_read_b64_tr_b16 a[184:185], v62 offset:30720
ds_read_b64_tr_b16 a[186:187], v62 offset:30976
s_waitcnt vmcnt(12)
ds_read_b64_tr_b16 a[44:45], v60 offset:33792
ds_read_b64_tr_b16 a[46:47], v60 offset:34048
ds_read_b64_tr_b16 a[116:117], v61 offset:33792
ds_read_b64_tr_b16 a[118:119], v61 offset:34048
ds_read_b64_tr_b16 a[188:189], v62 offset:33792
ds_read_b64_tr_b16 a[190:191], v62 offset:34048
s_waitcnt vmcnt(9)
ds_read_b64_tr_b16 a[48:49], v60 offset:36864
ds_read_b64_tr_b16 a[50:51], v60 offset:37120
ds_read_b64_tr_b16 a[120:121], v61 offset:36864
ds_read_b64_tr_b16 a[122:123], v61 offset:37120
ds_read_b64_tr_b16 a[192:193], v62 offset:36864
ds_read_b64_tr_b16 a[194:195], v62 offset:37120
s_waitcnt vmcnt(6)
ds_read_b64_tr_b16 a[52:53], v60 offset:0
ds_read_b64_tr_b16 a[54:55], v60 offset:256
ds_read_b64_tr_b16 a[124:125], v61 offset:0
ds_read_b64_tr_b16 a[126:127], v61 offset:256
ds_read_b64_tr_b16 a[196:197], v62 offset:0
ds_read_b64_tr_b16 a[198:199], v62 offset:256
s_waitcnt vmcnt(3)
ds_read_b64_tr_b16 a[56:57], v60 offset:3072
ds_read_b64_tr_b16 a[58:59], v60 offset:3328
ds_read_b64_tr_b16 a[128:129], v61 offset:3072
ds_read_b64_tr_b16 a[130:131], v61 offset:3328
ds_read_b64_tr_b16 a[200:201], v62 offset:3072
ds_read_b64_tr_b16 a[202:203], v62 offset:3328
s_waitcnt vmcnt(0)
ds_read_b64_tr_b16 a[60:61], v60 offset:6144
ds_read_b64_tr_b16 a[62:63], v60 offset:6400
ds_read_b64_tr_b16 a[132:133], v61 offset:6144
ds_read_b64_tr_b16 a[134:135], v61 offset:6400
ds_read_b64_tr_b16 a[204:205], v62 offset:6144
ds_read_b64_tr_b16 a[206:207], v62 offset:6400
s_waitcnt lgkmcnt(0)
v_lshlrev_b32 v17, 4, v0
s_lshl_b32 s70, s3, 10
v_add_u32 v1, s70, v17
v_add_u32 v8, 4096, v1
v_add_u32 v9, 7168, v1
v_add_u32 v10, 10240, v1
v_add_u32 v11, 13312, v1
v_add_u32 v12, 20480, v1
v_add_u32 v13, 23552, v1
v_add_u32 v14, 26624, v1
v_add_u32 v15, 29696, v1
s_mul_i32 s77, s75, 4
v_and_b32 v2, 31, v0
v_add_u32 v1, s77, v2
v_mul_u32_u24 v1, 128, v1
v_lshrrev_b32 v3, 5, v0
v_mul_u32_u24 v3, 32768, v3
v_add_u32 v1, 14336, v1
v_add_u32 v1, v1, v3
v_mov_b32 v3, 2147483632
s_cmp_eq_u32 s3, 0
s_cselect_b32 s71, 4, 0
v_cmp_gt_u32 vcc, s71, v2
s_nop 1
v_cndmask_b32 v22, v3, v1, vcc
s_mov_b32 s56, 0xf
s_mul_i32 s70, s74, 128
s_add_u32 s70, s70, 18432
v_mov_b32 v1, s70
s_min_u32 s71, s71, 1
v_cmp_gt_u32 vcc, s71, v0
s_nop 1
v_cndmask_b32 v44, v3, v1, vcc
v_add_u32 v45, 65536, v44
s_getpc_b64 s[96:97]
pc_116:
s_add_u32 s96, s96, L_writers-pc_116
s_addc_u32 s97, s97, 0
v_subrev_u32 v23, 0, v22
v_lshrrev_b32 v23, 7, v23
v_cmp_gt_u32 vcc, 0x200, v23
s_nop 1
v_cndmask_b32 v23, 0, v23, vcc
global_load_ubyte v23, v23, s[96:97]
s_mul_i32 s77, s75, 32768
s_add_u32 s44, s77, 127995904
s_mov_b32 s45, 199270400
s_mov_b32 s52, 1
s_mov_b32 s53, 0
s_add_u32 s46, s77, 144773120
s_mov_b32 s47, 199270400
s_mov_b32 s54, 1
s_mov_b32 s55, 32768
s_mov_b32 s25, 200
s_mov_b32 s20, 262144
s_mov_b32 s21, 294912
s_mov_b32 s8, s42
s_and_b32 s9, s43, 0xffff
s_mov_b32 s10, 0
s_mov_b32 s11, 0x20000
s_mov_b32 s22, 0
s_mul_i32 s48, s3, 8192
s_add_u32 s49, s48, 36864
s_add_u32 s50, s48, 73728
s_add_u32 s51, s48, 110592
s_mov_b32 s57, 0xbfb8aa3b
v_add_u32 v28, 0, v17
v_add_u32 v29, 36864, v17
v_add_u32 v30, 73728, v17
v_add_u32 v31, 110592, v17
v_lshlrev_b32 v1, 2, v0
v_add_u32 v32, 147456, v1
s_lshl_b32 s70, s3, 8
v_add_u32 v18, s70, v32
v_mov_b64 v[224:225], 0
v_mov_b64 v[236:237], 0
v_mov_b64 v[226:227], 0
v_mov_b64 v[238:239], 0
v_mov_b64 v[228:229], 0
v_mov_b64 v[240:241], 0
v_mov_b64 v[230:231], 0
v_mov_b64 v[242:243], 0
s_mov_b32 s12, s40
s_and_b32 s13, s41, 0xffff
s_mov_b32 s14, 256
s_mov_b32 s15, 0x20000
v_lshlrev_b32 v26, 2, v0
v_add_u32 v27, 128, v26
v_cmp_le_u32 vcc, 2, v0
s_nop 1
v_cndmask_b32 v26, v26, v27, vcc
v_mov_b32 v27, 192
v_cmp_eq_u32 vcc, 8, v0
s_nop 1
v_cndmask_b32 v26, v26, v27, vcc
v_mov_b32 v27, 2147483632
v_cmp_lt_u32 vcc, 8, v0
s_nop 1
v_cndmask_b32 v26, v26, v27, vcc
s_mov_b32 s98, 0
wi_loop_122:
buffer_load_dword v27, v26, s[12:15], 0 offen sc1
s_add_u32 s98, s98, 1
s_cmp_gt_u32 s98, 150000
s_cbranch_scc1 wi_bad_124
s_waitcnt vmcnt(0)
v_cmp_eq_u32 vcc, 32, v27
s_nop 0
s_and_b32 s97, vcc_lo, 0x1ff
s_cmp_eq_u32 s97, 0x1ff
s_cbranch_scc1 wi_ok_123
v_cmp_lt_u32 vcc, 32, v27
s_nop 0
s_and_b32 s96, vcc_lo, 0xff
s_cselect_b32 s96, 0x100, 0
s_and_b32 s96, s96, s97
s_cbranch_scc1 wi_over_125
s_sleep 8
s_branch wi_loop_122
wi_bad_124:
s_mov_b32 s98, 512
s_branch L_fail
wi_over_125:
s_mov_b32 s100, 255
wi_ok_123:
v_add_u32 v26, 65536, v22
v_cmp_eq_u32 vcc, s100, v23
s_nop 1
v_cndmask_b32 v22, v22, v26, vcc
s_mov_b32 s90, 0
s_mov_b32 s91, 1879048192
s_mov_b32 s93, 1879048192
v_mov_b32 v34, 2147483632
s_barrier
s_mov_b32 s95, 1
s_cmp_lg_u32 s3, 0
s_cbranch_scc1 sp_ok_127_j
s_mov_b32 s23, 0
sp_loop_126:
buffer_load_dword v33, v22, s[4:7], 0 offen sc1
s_add_u32 s23, s23, 1
s_cmp_gt_u32 s23, 150000
s_cbranch_scc1 sp_bad_128
s_waitcnt vmcnt(0)
sp_loop_126_e:
v_cmp_gt_u32 vcc, s52, v33
v_cmp_gt_u32 s[58:59], s54, v33
s_and_b32 vcc_lo, vcc_lo, s56
s_cbranch_scc0 sp_ok_127
s_cmp_gt_u32 s23, 4
s_cselect_b32 s70, 0, s56
s_cmp_lg_u32 s95, 0
s_cselect_b32 s70, 0, s70
s_or_b32 s59, s59, s70
s_and_b32 s59, s59, s56
s_cbranch_scc0 sp_ok_127
s_sleep 1
s_branch sp_loop_126
sp_bad_128:
s_mov_b32 s98, 1029
s_branch L_fail
sp_ok_127:
ds_write_b32 v18, v33
s_waitcnt lgkmcnt(0)
sp_ok_127_j:
s_barrier
ds_read_b32 v33, v32
s_waitcnt lgkmcnt(0)
v_cmp_gt_u32 vcc, s52, v33
v_cmp_gt_u32 s[58:59], s54, v33
s_and_b32 vcc_lo, vcc_lo, s56
s_cselect_b32 s70, 0, 1
s_and_b32 s59, s59, s56
s_cselect_b32 s71, 0, 1
s_or_b32 s76, s70, s71
s_cselect_b32 s10, 268435456, 0
s_cmp_lg_u32 s70, 0
s_cselect_b64 s[72:73], s[52:53], s[54:55]
s_cselect_b64 s[58:59], s[44:45], s[46:47]
s_mul_i32 s74, s72, s20
s_add_u32 s74, s74, s58
s_mul_i32 s75, s72, s21
s_add_u32 s75, s75, s59
s_andn2_b32 s71, s71, s70
s_add_u32 s52, s52, s70
s_add_u32 s54, s54, s71
s_mov_b32 s77, s76
s_add_u32 m0, s48, 0
s_nop 0
buffer_load_dwordx4 v8, s[4:7], s74 offen offset:0 sc1 lds
buffer_load_dwordx4 v9, s[4:7], s74 offen offset:1024 sc1 lds
buffer_load_dwordx4 v10, s[4:7], s74 offen offset:2048 sc1 lds
buffer_load_dwordx4 v11, s[4:7], s74 offen offset:3072 sc1 lds
s_add_u32 m0, s48, 4096
s_nop 0
buffer_load_dwordx4 v12, s[4:7], s74 offen offset:0 sc1 lds
buffer_load_dwordx4 v13, s[4:7], s74 offen offset:1024 sc1 lds
buffer_load_dwordx4 v14, s[4:7], s74 offen offset:2048 sc1 lds
buffer_load_dwordx4 v15, s[4:7], s74 offen offset:3072 sc1 lds
buffer_load_dword v24, v22, s[4:7], 0 offen sc1
buffer_store_dword v27, v34, s[4:7], 0 offen
v_mov_b32 v27, s90
s_waitcnt vmcnt(8)
s_barrier
buffer_store_dword v27, v45, s[4:7], s91 offen
buffer_store_dword v27, v44, s[4:7], s91 offen sc1
s_mov_b32 s91, 1879048192
ds_read_b128 v[64:67], v28 offset:0
ds_read_b128 v[68:71], v28 offset:8192
ds_read_b128 v[72:75], v28 offset:16384
ds_read_b128 v[76:79], v28 offset:24576
ds_read_b128 v[80:83], v28 offset:1024
ds_read_b128 v[84:87], v28 offset:9216
ds_read_b128 v[88:91], v28 offset:17408
ds_read_b128 v[92:95], v28 offset:25600
s_waitcnt vmcnt(7)
s_barrier
s_branch g_body_117
g_body_117:
s_waitcnt lgkmcnt(4)
v_mfma_f32_16x16x32_bf16 v[208:211], a[0:3], v[64:67], 0
ds_read_b128 v[96:99], v28 offset:2048
v_mfma_f32_16x16x32_bf16 v[212:215], a[0:3], v[68:71], 0
ds_read_b128 v[100:103], v28 offset:10240
v_mfma_f32_16x16x32_bf16 v[216:219], a[72:75], v[64:67], 0
v_mfma_f32_16x16x32_bf16 v[208:211], a[4:7], v[72:75], v[208:211]
ds_read_b128 v[104:107], v28 offset:18432
v_cvt_pk_bf16_f32 v56, v224, v225
v_mfma_f32_16x16x32_bf16 v[212:215], a[4:7], v[76:79], v[212:215]
ds_read_b128 v[108:111], v28 offset:26624
v_cvt_pk_bf16_f32 v57, v226, v227
v_mfma_f32_16x16x32_bf16 v[220:223], a[72:75], v[68:71], 0
v_cvt_pk_bf16_f32 v58, v228, v229
s_waitcnt lgkmcnt(4)
v_mfma_f32_16x16x32_bf16 v[208:211], a[8:11], v[80:83], v[208:211]
ds_read_b128 v[112:115], v28 offset:3072
v_cvt_pk_bf16_f32 v59, v230, v231
v_mfma_f32_16x16x32_bf16 v[212:215], a[8:11], v[84:87], v[212:215]
ds_read_b128 v[116:119], v28 offset:11264
v_permlane16_swap_b32 v56, v58
v_mfma_f32_16x16x32_bf16 v[216:219], a[76:79], v[72:75], v[216:219]
v_permlane16_swap_b32 v57, v59
v_mfma_f32_16x16x32_bf16 v[208:211], a[12:15], v[88:91], v[208:211]
ds_read_b128 v[120:123], v28 offset:19456
v_mfma_f32_16x16x32_bf16 v[212:215], a[12:15], v[92:95], v[212:215]
ds_read_b128 v[124:127], v28 offset:27648
v_mfma_f32_16x16x32_bf16 v[220:223], a[76:79], v[76:79], v[220:223]
s_waitcnt lgkmcnt(4)
v_mfma_f32_16x16x32_bf16 v[208:211], a[16:19], v[96:99], v[208:211]
ds_read_b128 v[128:131], v28 offset:4096
v_mfma_f32_16x16x32_bf16 v[212:215], a[16:19], v[100:103], v[212:215]
ds_read_b128 v[132:135], v28 offset:12288
v_mfma_f32_16x16x32_bf16 v[216:219], a[80:83], v[80:83], v[216:219]
buffer_store_dwordx4 v[56:59], v21, s[4:7], s93 offen sc1
v_mfma_f32_16x16x32_bf16 v[208:211], a[20:23], v[104:107], v[208:211]
ds_read_b128 v[136:139], v28 offset:20480
v_mfma_f32_16x16x32_bf16 v[212:215], a[20:23], v[108:111], v[212:215]
ds_read_b128 v[140:143], v28 offset:28672
v_mfma_f32_16x16x32_bf16 v[220:223], a[80:83], v[84:87], v[220:223]
s_waitcnt vmcnt(5)
s_barrier
s_waitcnt lgkmcnt(4)
v_mfma_f32_16x16x32_bf16 v[208:211], a[24:27], v[112:115], v[208:211]
ds_read_b128 v[144:147], v28 offset:5120
v_mov_b32 v27, s90
v_mfma_f32_16x16x32_bf16 v[212:215], a[24:27], v[116:119], v[212:215]
ds_read_b128 v[148:151], v28 offset:13312
v_mfma_f32_16x16x32_bf16 v[216:219], a[84:87], v[88:91], v[216:219]
v_mfma_f32_16x16x32_bf16 v[208:211], a[28:31], v[120:123], v[208:211]
ds_read_b128 v[152:155], v28 offset:21504
v_mfma_f32_16x16x32_bf16 v[212:215], a[28:31], v[124:127], v[212:215]
ds_read_b128 v[156:159], v28 offset:29696
v_mfma_f32_16x16x32_bf16 v[220:223], a[84:87], v[92:95], v[220:223]
s_waitcnt lgkmcnt(4)
v_mfma_f32_16x16x32_bf16 v[208:211], a[32:35], v[128:131], v[208:211]
ds_read_b128 v[160:163], v28 offset:6144
v_mfma_f32_16x16x32_bf16 v[212:215], a[32:35], v[132:135], v[212:215]
ds_read_b128 v[164:167], v28 offset:14336
v_mfma_f32_16x16x32_bf16 v[216:219], a[88:91], v[96:99], v[216:219]
v_mfma_f32_16x16x32_bf16 v[208:211], a[36:39], v[136:139], v[208:211]
ds_read_b128 v[168:171], v28 offset:22528
s_waitcnt vmcnt(4)
ds_write_b32 v18, v24
v_mfma_f32_16x16x32_bf16 v[212:215], a[36:39], v[140:143], v[212:215]
ds_read_b128 v[172:175], v28 offset:30720
v_mfma_f32_16x16x32_bf16 v[220:223], a[88:91], v[100:103], v[220:223]
s_waitcnt lgkmcnt(5)
v_mfma_f32_16x16x32_bf16 v[208:211], a[40:43], v[144:147], v[208:211]
ds_read_b128 v[176:179], v28 offset:7168
s_waitcnt lgkmcnt(2)
s_barrier
v_mfma_f32_16x16x32_bf16 v[212:215], a[40:43], v[148:151], v[212:215]
ds_read_b128 v[180:183], v28 offset:15360
ds_read_b32 v33, v32
v_mfma_f32_16x16x32_bf16 v[216:219], a[92:95], v[104:107], v[216:219]
v_mfma_f32_16x16x32_bf16 v[208:211], a[44:47], v[152:155], v[208:211]
ds_read_b128 v[184:187], v28 offset:23552
v_mfma_f32_16x16x32_bf16 v[212:215], a[44:47], v[156:159], v[212:215]
ds_read_b128 v[188:191], v28 offset:31744
s_waitcnt lgkmcnt(2)
v_cmp_gt_u32 vcc, s52, v33
v_mfma_f32_16x16x32_bf16 v[220:223], a[92:95], v[108:111], v[220:223]
v_cmp_gt_u32 s[58:59], s54, v33
v_mfma_f32_16x16x32_bf16 v[208:211], a[48:51], v[160:163], v[208:211]
s_and_b32 vcc_lo, vcc_lo, s56
s_cselect_b32 s70, 0, 1
v_mfma_f32_16x16x32_bf16 v[212:215], a[48:51], v[164:167], v[212:215]
s_and_b32 s59, s59, s56
s_cselect_b32 s71, 0, s77
v_mfma_f32_16x16x32_bf16 v[216:219], a[96:99], v[112:115], v[216:219]
s_or_b32 s82, s70, s71
s_cselect_b32 s10, 268435456, 0
v_mfma_f32_16x16x32_bf16 v[208:211], a[52:55], v[168:171], v[208:211]
s_cmp_lg_u32 s70, 0
s_cselect_b64 s[78:79], s[52:53], s[54:55]
s_cselect_b64 s[58:59], s[44:45], s[46:47]
v_mfma_f32_16x16x32_bf16 v[212:215], a[52:55], v[172:175], v[212:215]
s_mul_i32 s80, s78, s20
s_add_u32 s80, s80, s58
v_mfma_f32_16x16x32_bf16 v[220:223], a[96:99], v[116:119], v[220:223]
s_add_u32 m0, s49, 0
s_waitcnt lgkmcnt(0)
v_mfma_f32_16x16x32_bf16 v[208:211], a[56:59], v[176:179], v[208:211]
buffer_load_dwordx4 v8, s[8:11], s80 offen offset:0 sc1 lds
v_mfma_f32_16x16x32_bf16 v[212:215], a[56:59], v[180:183], v[212:215]
s_mul_i32 s81, s78, s21
s_add_u32 s81, s81, s59
s_andn2_b32 s71, s71, s70
v_mfma_f32_16x16x32_bf16 v[216:219], a[100:103], v[120:123], v[216:219]
s_add_u32 s52, s52, s70
s_add_u32 s54, s54, s71
s_mov_b32 s83, s82
v_mfma_f32_16x16x32_bf16 v[208:211], a[60:63], v[184:187], v[208:211]
buffer_load_dwordx4 v9, s[8:11], s80 offen offset:1024 sc1 lds
v_mfma_f32_16x16x32_bf16 v[212:215], a[60:63], v[188:191], v[212:215]
v_mfma_f32_16x16x32_bf16 v[220:223], a[100:103], v[124:127], v[220:223]
v_mfma_f32_16x16x32_bf16 v[216:219], a[104:107], v[128:131], v[216:219]
buffer_load_dwordx4 v10, s[8:11], s80 offen offset:2048 sc1 lds
v_mfma_f32_16x16x32_bf16 v[220:223], a[104:107], v[132:135], v[220:223]
v_mfma_f32_16x16x32_bf16 v[216:219], a[108:111], v[136:139], v[216:219]
v_mfma_f32_16x16x32_bf16 v[220:223], a[108:111], v[140:143], v[220:223]
buffer_load_dwordx4 v11, s[8:11], s80 offen offset:3072 sc1 lds
v_mfma_f32_16x16x32_bf16 v[216:219], a[112:115], v[144:147], v[216:219]
v_cvt_pk_bf16_f32 v48, v208, v209
v_cvt_pk_bf16_f32 v49, v210, v211
v_mfma_f32_16x16x32_bf16 v[220:223], a[112:115], v[148:151], v[220:223]
s_add_u32 m0, s49, 4096
v_cvt_pk_bf16_f32 v50, v212, v213
v_mfma_f32_16x16x32_bf16 v[216:219], a[116:119], v[152:155], v[216:219]
buffer_load_dwordx4 v12, s[8:11], s80 offen offset:0 sc1 lds
v_mfma_f32_16x16x32_bf16 v[220:223], a[116:119], v[156:159], v[220:223]
v_cvt_pk_bf16_f32 v51, v214, v215
v_mfma_f32_16x16x32_bf16 v[216:219], a[120:123], v[160:163], v[216:219]
v_permlane16_swap_b32 v48, v50
v_mfma_f32_16x16x32_bf16 v[220:223], a[120:123], v[164:167], v[220:223]
buffer_load_dwordx4 v13, s[8:11], s80 offen offset:1024 sc1 lds
v_mfma_f32_16x16x32_bf16 v[216:219], a[124:127], v[168:171], v[216:219]
v_permlane16_swap_b32 v49, v51
v_mfma_f32_16x16x32_bf16 v[220:223], a[124:127], v[172:175], v[220:223]
buffer_store_dwordx4 v[48:51], v19, s[4:7], s75 offen sc1
v_mfma_f32_16x16x32_bf16 v[216:219], a[128:131], v[176:179], v[216:219]
buffer_load_dwordx4 v14, s[8:11], s80 offen offset:2048 sc1 lds
v_mfma_f32_16x16x32_bf16 v[220:223], a[128:131], v[180:183], v[220:223]
v_mfma_f32_16x16x32_bf16 v[216:219], a[132:135], v[184:187], v[216:219]
v_mfma_f32_16x16x32_bf16 v[220:223], a[132:135], v[188:191], v[220:223]
buffer_load_dwordx4 v15, s[8:11], s80 offen offset:3072 sc1 lds
v_mfma_f32_16x16x32_bf16 v[224:227], a[144:147], v[64:67], 0
v_mfma_f32_16x16x32_bf16 v[228:231], a[144:147], v[68:71], 0
v_mfma_f32_16x16x32_bf16 v[224:227], a[148:151], v[72:75], v[224:227]
v_mfma_f32_16x16x32_bf16 v[228:231], a[148:151], v[76:79], v[228:231]
buffer_load_dword v24, v22, s[4:7], 0 offen sc1
v_mfma_f32_16x16x32_bf16 v[224:227], a[152:155], v[80:83], v[224:227]
v_mfma_f32_16x16x32_bf16 v[228:231], a[152:155], v[84:87], v[228:231]
s_waitcnt vmcnt(10)
s_barrier
v_mfma_f32_16x16x32_bf16 v[224:227], a[156:159], v[88:91], v[224:227]
buffer_store_dword v27, v45, s[4:7], s91 offen
v_mfma_f32_16x16x32_bf16 v[228:231], a[156:159], v[92:95], v[228:231]
buffer_store_dword v27, v44, s[4:7], s91 offen sc1
v_mfma_f32_16x16x32_bf16 v[224:227], a[160:163], v[96:99], v[224:227]
v_cvt_pk_bf16_f32 v52, v216, v217
v_cvt_pk_bf16_f32 v53, v218, v219
v_mfma_f32_16x16x32_bf16 v[228:231], a[160:163], v[100:103], v[228:231]
v_cvt_pk_bf16_f32 v54, v220, v221
v_cvt_pk_bf16_f32 v55, v222, v223
v_mfma_f32_16x16x32_bf16 v[224:227], a[164:167], v[104:107], v[224:227]
v_permlane16_swap_b32 v52, v54
v_mfma_f32_16x16x32_bf16 v[228:231], a[164:167], v[108:111], v[228:231]
v_permlane16_swap_b32 v53, v55
v_mfma_f32_16x16x32_bf16 v[224:227], a[168:171], v[112:115], v[224:227]
buffer_store_dwordx4 v[52:55], v20, s[4:7], s75 offen sc1
v_mfma_f32_16x16x32_bf16 v[228:231], a[168:171], v[116:119], v[228:231]
v_mfma_f32_16x16x32_bf16 v[224:227], a[172:175], v[120:123], v[224:227]
v_mfma_f32_16x16x32_bf16 v[228:231], a[172:175], v[124:127], v[228:231]
v_mfma_f32_16x16x32_bf16 v[224:227], a[176:179], v[128:131], v[224:227]
v_mfma_f32_16x16x32_bf16 v[228:231], a[176:179], v[132:135], v[228:231]
v_mfma_f32_16x16x32_bf16 v[224:227], a[180:183], v[136:139], v[224:227]
v_mfma_f32_16x16x32_bf16 v[228:231], a[180:183], v[140:143], v[228:231]
v_mfma_f32_16x16x32_bf16 v[224:227], a[184:187], v[144:147], v[224:227]
s_waitcnt vmcnt(11)
s_barrier
v_mfma_f32_16x16x32_bf16 v[228:231], a[184:187], v[148:151], v[228:231]
v_mfma_f32_16x16x32_bf16 v[224:227], a[188:191], v[152:155], v[224:227]
s_cmp_eq_u32 s82, 0
s_cbranch_scc1 g_slow_129
v_mfma_f32_16x16x32_bf16 v[228:231], a[188:191], v[156:159], v[228:231]
ds_read_b128 v[64:67], v29 offset:0
v_mfma_f32_16x16x32_bf16 v[224:227], a[192:195], v[160:163], v[224:227]
ds_read_b128 v[68:71], v29 offset:8192
v_mfma_f32_16x16x32_bf16 v[228:231], a[192:195], v[164:167], v[228:231]
ds_read_b128 v[72:75], v29 offset:16384
v_mfma_f32_16x16x32_bf16 v[224:227], a[196:199], v[168:171], v[224:227]
ds_read_b128 v[76:79], v29 offset:24576
v_mfma_f32_16x16x32_bf16 v[228:231], a[196:199], v[172:175], v[228:231]
ds_read_b128 v[80:83], v29 offset:1024
v_mfma_f32_16x16x32_bf16 v[224:227], a[200:203], v[176:179], v[224:227]
ds_read_b128 v[84:87], v29 offset:9216
v_mfma_f32_16x16x32_bf16 v[228:231], a[200:203], v[180:183], v[228:231]
ds_read_b128 v[88:91], v29 offset:17408
v_mfma_f32_16x16x32_bf16 v[224:227], a[204:207], v[184:187], v[224:227]
ds_read_b128 v[92:95], v29 offset:25600
v_mfma_f32_16x16x32_bf16 v[228:231], a[204:207], v[188:191], v[228:231]
s_waitcnt vmcnt(8)
s_barrier
g_body_118:
s_waitcnt lgkmcnt(4)
v_mfma_f32_16x16x32_bf16 v[208:211], a[0:3], v[64:67], 0
ds_read_b128 v[96:99], v29 offset:2048
v_mfma_f32_16x16x32_bf16 v[212:215], a[0:3], v[68:71], 0
ds_read_b128 v[100:103], v29 offset:10240
v_mfma_f32_16x16x32_bf16 v[216:219], a[72:75], v[64:67], 0
v_mfma_f32_16x16x32_bf16 v[208:211], a[4:7], v[72:75], v[208:211]
ds_read_b128 v[104:107], v29 offset:18432
v_cvt_pk_bf16_f32 v56, v224, v225
v_mfma_f32_16x16x32_bf16 v[212:215], a[4:7], v[76:79], v[212:215]
ds_read_b128 v[108:111], v29 offset:26624
v_cvt_pk_bf16_f32 v57, v226, v227
v_mfma_f32_16x16x32_bf16 v[220:223], a[72:75], v[68:71], 0
v_cvt_pk_bf16_f32 v58, v228, v229
s_waitcnt lgkmcnt(4)
v_mfma_f32_16x16x32_bf16 v[208:211], a[8:11], v[80:83], v[208:211]
ds_read_b128 v[112:115], v29 offset:3072
v_cvt_pk_bf16_f32 v59, v230, v231
v_mfma_f32_16x16x32_bf16 v[212:215], a[8:11], v[84:87], v[212:215]
ds_read_b128 v[116:119], v29 offset:11264
v_permlane16_swap_b32 v56, v58
v_mfma_f32_16x16x32_bf16 v[216:219], a[76:79], v[72:75], v[216:219]
v_permlane16_swap_b32 v57, v59
v_mfma_f32_16x16x32_bf16 v[208:211], a[12:15], v[88:91], v[208:211]
ds_read_b128 v[120:123], v29 offset:19456
v_mfma_f32_16x16x32_bf16 v[212:215], a[12:15], v[92:95], v[212:215]
ds_read_b128 v[124:127], v29 offset:27648
v_mfma_f32_16x16x32_bf16 v[220:223], a[76:79], v[76:79], v[220:223]
s_waitcnt lgkmcnt(4)
v_mfma_f32_16x16x32_bf16 v[208:211], a[16:19], v[96:99], v[208:211]
ds_read_b128 v[128:131], v29 offset:4096
v_mfma_f32_16x16x32_bf16 v[212:215], a[16:19], v[100:103], v[212:215]
ds_read_b128 v[132:135], v29 offset:12288
v_mfma_f32_16x16x32_bf16 v[216:219], a[80:83], v[80:83], v[216:219]
buffer_store_dwordx4 v[56:59], v21, s[4:7], s75 offen sc1
v_mfma_f32_16x16x32_bf16 v[208:211], a[20:23], v[104:107], v[208:211]
ds_read_b128 v[136:139], v29 offset:20480
v_mfma_f32_16x16x32_bf16 v[212:215], a[20:23], v[108:111], v[212:215]
ds_read_b128 v[140:143], v29 offset:28672
v_mfma_f32_16x16x32_bf16 v[220:223], a[80:83], v[84:87], v[220:223]
s_waitcnt vmcnt(5)
s_barrier
s_waitcnt lgkmcnt(4)
v_mfma_f32_16x16x32_bf16 v[208:211], a[24:27], v[112:115], v[208:211]
ds_read_b128 v[144:147], v29 offset:5120
v_mov_b32 v27, s72
v_mfma_f32_16x16x32_bf16 v[212:215], a[24:27], v[116:119], v[212:215]
ds_read_b128 v[148:151], v29 offset:13312
v_mfma_f32_16x16x32_bf16 v[216:219], a[84:87], v[88:91], v[216:219]
v_mfma_f32_16x16x32_bf16 v[208:211], a[28:31], v[120:123], v[208:211]
ds_read_b128 v[152:155], v29 offset:21504
v_mfma_f32_16x16x32_bf16 v[212:215], a[28:31], v[124:127], v[212:215]
ds_read_b128 v[156:159], v29 offset:29696
v_mfma_f32_16x16x32_bf16 v[220:223], a[84:87], v[92:95], v[220:223]
s_waitcnt lgkmcnt(4)
v_mfma_f32_16x16x32_bf16 v[208:211], a[32:35], v[128:131], v[208:211]
ds_read_b128 v[160:163], v29 offset:6144
v_mfma_f32_16x16x32_bf16 v[212:215], a[32:35], v[132:135], v[212:215]
ds_read_b128 v[164:167], v29 offset:14336
v_mfma_f32_16x16x32_bf16 v[216:219], a[88:91], v[96:99], v[216:219]
v_mfma_f32_16x16x32_bf16 v[208:211], a[36:39], v[136:139], v[208:211]
ds_read_b128 v[168:171], v29 offset:22528
s_waitcnt vmcnt(4)
ds_write_b32 v18, v24
v_mfma_f32_16x16x32_bf16 v[212:215], a[36:39], v[140:143], v[212:215]
ds_read_b128 v[172:175], v29 offset:30720
v_mfma_f32_16x16x32_bf16 v[220:223], a[88:91], v[100:103], v[220:223]
s_waitcnt lgkmcnt(5)
v_mfma_f32_16x16x32_bf16 v[208:211], a[40:43], v[144:147], v[208:211]
ds_read_b128 v[176:179], v29 offset:7168
s_waitcnt lgkmcnt(2)
s_barrier
v_mfma_f32_16x16x32_bf16 v[212:215], a[40:43], v[148:151], v[212:215]
ds_read_b128 v[180:183], v29 offset:15360
ds_read_b32 v33, v32
v_mfma_f32_16x16x32_bf16 v[216:219], a[92:95], v[104:107], v[216:219]
v_mfma_f32_16x16x32_bf16 v[208:211], a[44:47], v[152:155], v[208:211]
ds_read_b128 v[184:187], v29 offset:23552
v_mfma_f32_16x16x32_bf16 v[212:215], a[44:47], v[156:159], v[212:215]
ds_read_b128 v[188:191], v29 offset:31744
s_waitcnt lgkmcnt(2)
v_cmp_gt_u32 vcc, s52, v33
v_mfma_f32_16x16x32_bf16 v[220:223], a[92:95], v[108:111], v[220:223]
v_cmp_gt_u32 s[58:59], s54, v33
v_mfma_f32_16x16x32_bf16 v[208:211], a[48:51], v[160:163], v[208:211]
s_and_b32 vcc_lo, vcc_lo, s56
s_cselect_b32 s70, 0, 1
v_mfma_f32_16x16x32_bf16 v[212:215], a[48:51], v[164:167], v[212:215]
s_and_b32 s59, s59, s56
s_cselect_b32 s71, 0, s83
v_mfma_f32_16x16x32_bf16 v[216:219], a[96:99], v[112:115], v[216:219]
s_or_b32 s88, s70, s71
s_cselect_b32 s10, 268435456, 0
v_mfma_f32_16x16x32_bf16 v[208:211], a[52:55], v[168:171], v[208:211]
s_cmp_lg_u32 s70, 0
s_cselect_b64 s[84:85], s[52:53], s[54:55]
s_cselect_b64 s[58:59], s[44:45], s[46:47]
v_mfma_f32_16x16x32_bf16 v[212:215], a[52:55], v[172:175], v[212:215]
s_mul_i32 s86, s84, s20
s_add_u32 s86, s86, s58
v_mfma_f32_16x16x32_bf16 v[220:223], a[96:99], v[116:119], v[220:223]
s_add_u32 m0, s50, 0
s_waitcnt lgkmcnt(0)
v_mfma_f32_16x16x32_bf16 v[208:211], a[56:59], v[176:179], v[208:211]
buffer_load_dwordx4 v8, s[8:11], s86 offen offset:0 sc1 lds
v_mfma_f32_16x16x32_bf16 v[212:215], a[56:59], v[180:183], v[212:215]
s_mul_i32 s87, s84, s21
s_add_u32 s87, s87, s59
s_andn2_b32 s71, s71, s70
v_mfma_f32_16x16x32_bf16 v[216:219], a[100:103], v[120:123], v[216:219]
s_add_u32 s52, s52, s70
s_add_u32 s54, s54, s71
s_mov_b32 s89, s88
v_mfma_f32_16x16x32_bf16 v[208:211], a[60:63], v[184:187], v[208:211]
buffer_load_dwordx4 v9, s[8:11], s86 offen offset:1024 sc1 lds
v_mfma_f32_16x16x32_bf16 v[212:215], a[60:63], v[188:191], v[212:215]
v_mfma_f32_16x16x32_bf16 v[220:223], a[100:103], v[124:127], v[220:223]
v_mfma_f32_16x16x32_bf16 v[216:219], a[104:107], v[128:131], v[216:219]
buffer_load_dwordx4 v10, s[8:11], s86 offen offset:2048 sc1 lds
v_mfma_f32_16x16x32_bf16 v[220:223], a[104:107], v[132:135], v[220:223]
v_mfma_f32_16x16x32_bf16 v[216:219], a[108:111], v[136:139], v[216:219]
v_mfma_f32_16x16x32_bf16 v[220:223], a[108:111], v[140:143], v[220:223]
buffer_load_dwordx4 v11, s[8:11], s86 offen offset:3072 sc1 lds
v_mfma_f32_16x16x32_bf16 v[216:219], a[112:115], v[144:147], v[216:219]
v_cvt_pk_bf16_f32 v48, v208, v209
v_cvt_pk_bf16_f32 v49, v210, v211
v_mfma_f32_16x16x32_bf16 v[220:223], a[112:115], v[148:151], v[220:223]
s_add_u32 m0, s50, 4096
v_cvt_pk_bf16_f32 v50, v212, v213
v_mfma_f32_16x16x32_bf16 v[216:219], a[116:119], v[152:155], v[216:219]
buffer_load_dwordx4 v12, s[8:11], s86 offen offset:0 sc1 lds
v_mfma_f32_16x16x32_bf16 v[220:223], a[116:119], v[156:159], v[220:223]
v_cvt_pk_bf16_f32 v51, v214, v215
v_mfma_f32_16x16x32_bf16 v[216:219], a[120:123], v[160:163], v[216:219]
v_permlane16_swap_b32 v48, v50
v_mfma_f32_16x16x32_bf16 v[220:223], a[120:123], v[164:167], v[220:223]
buffer_load_dwordx4 v13, s[8:11], s86 offen offset:1024 sc1 lds
v_mfma_f32_16x16x32_bf16 v[216:219], a[124:127], v[168:171], v[216:219]
v_permlane16_swap_b32 v49, v51
v_mfma_f32_16x16x32_bf16 v[220:223], a[124:127], v[172:175], v[220:223]
buffer_store_dwordx4 v[48:51], v19, s[4:7], s81 offen sc1
v_mfma_f32_16x16x32_bf16 v[216:219], a[128:131], v[176:179], v[216:219]
buffer_load_dwordx4 v14, s[8:11], s86 offen offset:2048 sc1 lds
v_mfma_f32_16x16x32_bf16 v[220:223], a[128:131], v[180:183], v[220:223]
v_mfma_f32_16x16x32_bf16 v[216:219], a[132:135], v[184:187], v[216:219]
v_mfma_f32_16x16x32_bf16 v[220:223], a[132:135], v[188:191], v[220:223]
buffer_load_dwordx4 v15, s[8:11], s86 offen offset:3072 sc1 lds
v_mfma_f32_16x16x32_bf16 v[224:227], a[144:147], v[64:67], 0
v_mfma_f32_16x16x32_bf16 v[228:231], a[144:147], v[68:71], 0
v_mfma_f32_16x16x32_bf16 v[224:227], a[148:151], v[72:75], v[224:227]
v_mfma_f32_16x16x32_bf16 v[228:231], a[148:151], v[76:79], v[228:231]
buffer_load_dword v24, v22, s[4:7], 0 offen sc1
v_mfma_f32_16x16x32_bf16 v[224:227], a[152:155], v[80:83], v[224:227]
v_mfma_f32_16x16x32_bf16 v[228:231], a[152:155], v[84:87], v[228:231]
s_waitcnt vmcnt(10)
s_barrier
v_mfma_f32_16x16x32_bf16 v[224:227], a[156:159], v[88:91], v[224:227]
buffer_store_dword v27, v45, s[4:7], s73 offen
v_mfma_f32_16x16x32_bf16 v[228:231], a[156:159], v[92:95], v[228:231]
buffer_store_dword v27, v44, s[4:7], s73 offen sc1
v_mfma_f32_16x16x32_bf16 v[224:227], a[160:163], v[96:99], v[224:227]
v_cvt_pk_bf16_f32 v52, v216, v217
v_cvt_pk_bf16_f32 v53, v218, v219
v_mfma_f32_16x16x32_bf16 v[228:231], a[160:163], v[100:103], v[228:231]
v_cvt_pk_bf16_f32 v54, v220, v221
v_cvt_pk_bf16_f32 v55, v222, v223
v_mfma_f32_16x16x32_bf16 v[224:227], a[164:167], v[104:107], v[224:227]
v_permlane16_swap_b32 v52, v54
v_mfma_f32_16x16x32_bf16 v[228:231], a[164:167], v[108:111], v[228:231]
v_permlane16_swap_b32 v53, v55
v_mfma_f32_16x16x32_bf16 v[224:227], a[168:171], v[112:115], v[224:227]
buffer_store_dwordx4 v[52:55], v20, s[4:7], s81 offen sc1
v_mfma_f32_16x16x32_bf16 v[228:231], a[168:171], v[116:119], v[228:231]
v_mfma_f32_16x16x32_bf16 v[224:227], a[172:175], v[120:123], v[224:227]
v_mfma_f32_16x16x32_bf16 v[228:231], a[172:175], v[124:127], v[228:231]
v_mfma_f32_16x16x32_bf16 v[224:227], a[176:179], v[128:131], v[224:227]
v_mfma_f32_16x16x32_bf16 v[228:231], a[176:179], v[132:135], v[228:231]
v_mfma_f32_16x16x32_bf16 v[224:227], a[180:183], v[136:139], v[224:227]
v_mfma_f32_16x16x32_bf16 v[228:231], a[180:183], v[140:143], v[228:231]
v_mfma_f32_16x16x32_bf16 v[224:227], a[184:187], v[144:147], v[224:227]
s_waitcnt vmcnt(11)
s_barrier
v_mfma_f32_16x16x32_bf16 v[228:231], a[184:187], v[148:151], v[228:231]
v_mfma_f32_16x16x32_bf16 v[224:227], a[188:191], v[152:155], v[224:227]
s_cmp_eq_u32 s88, 0
s_cbranch_scc1 g_slow_130
v_mfma_f32_16x16x32_bf16 v[228:231], a[188:191], v[156:159], v[228:231]
ds_read_b128 v[64:67], v30 offset:0
v_mfma_f32_16x16x32_bf16 v[224:227], a[192:195], v[160:163], v[224:227]
ds_read_b128 v[68:71], v30 offset:8192
v_mfma_f32_16x16x32_bf16 v[228:231], a[192:195], v[164:167], v[228:231]
ds_read_b128 v[72:75], v30 offset:16384
v_mfma_f32_16x16x32_bf16 v[224:227], a[196:199], v[168:171], v[224:227]
ds_read_b128 v[76:79], v30 offset:24576
v_mfma_f32_16x16x32_bf16 v[228:231], a[196:199], v[172:175], v[228:231]
ds_read_b128 v[80:83], v30 offset:1024
v_mfma_f32_16x16x32_bf16 v[224:227], a[200:203], v[176:179], v[224:227]
ds_read_b128 v[84:87], v30 offset:9216
v_mfma_f32_16x16x32_bf16 v[228:231], a[200:203], v[180:183], v[228:231]
ds_read_b128 v[88:91], v30 offset:17408
v_mfma_f32_16x16x32_bf16 v[224:227], a[204:207], v[184:187], v[224:227]
ds_read_b128 v[92:95], v30 offset:25600
v_mfma_f32_16x16x32_bf16 v[228:231], a[204:207], v[188:191], v[228:231]
s_waitcnt vmcnt(8)
s_barrier
g_body_119:
s_waitcnt lgkmcnt(4)
v_mfma_f32_16x16x32_bf16 v[208:211], a[0:3], v[64:67], 0
ds_read_b128 v[96:99], v30 offset:2048
v_mfma_f32_16x16x32_bf16 v[212:215], a[0:3], v[68:71], 0
ds_read_b128 v[100:103], v30 offset:10240
v_mfma_f32_16x16x32_bf16 v[216:219], a[72:75], v[64:67], 0
v_mfma_f32_16x16x32_bf16 v[208:211], a[4:7], v[72:75], v[208:211]
ds_read_b128 v[104:107], v30 offset:18432
v_cvt_pk_bf16_f32 v56, v224, v225
v_mfma_f32_16x16x32_bf16 v[212:215], a[4:7], v[76:79], v[212:215]
ds_read_b128 v[108:111], v30 offset:26624
v_cvt_pk_bf16_f32 v57, v226, v227
v_mfma_f32_16x16x32_bf16 v[220:223], a[72:75], v[68:71], 0
v_cvt_pk_bf16_f32 v58, v228, v229
s_waitcnt lgkmcnt(4)
v_mfma_f32_16x16x32_bf16 v[208:211], a[8:11], v[80:83], v[208:211]
ds_read_b128 v[112:115], v30 offset:3072
v_cvt_pk_bf16_f32 v59, v230, v231
v_mfma_f32_16x16x32_bf16 v[212:215], a[8:11], v[84:87], v[212:215]
ds_read_b128 v[116:119], v30 offset:11264
v_permlane16_swap_b32 v56, v58
v_mfma_f32_16x16x32_bf16 v[216:219], a[76:79], v[72:75], v[216:219]
v_permlane16_swap_b32 v57, v59
v_mfma_f32_16x16x32_bf16 v[208:211], a[12:15], v[88:91], v[208:211]
ds_read_b128 v[120:123], v30 offset:19456
v_mfma_f32_16x16x32_bf16 v[212:215], a[12:15], v[92:95], v[212:215]
ds_read_b128 v[124:127], v30 offset:27648
v_mfma_f32_16x16x32_bf16 v[220:223], a[76:79], v[76:79], v[220:223]
s_waitcnt lgkmcnt(4)
v_mfma_f32_16x16x32_bf16 v[208:211], a[16:19], v[96:99], v[208:211]
ds_read_b128 v[128:131], v30 offset:4096
v_mfma_f32_16x16x32_bf16 v[212:215], a[16:19], v[100:103], v[212:215]
ds_read_b128 v[132:135], v30 offset:12288
v_mfma_f32_16x16x32_bf16 v[216:219], a[80:83], v[80:83], v[216:219]
buffer_store_dwordx4 v[56:59], v21, s[4:7], s81 offen sc1
v_mfma_f32_16x16x32_bf16 v[208:211], a[20:23], v[104:107], v[208:211]
ds_read_b128 v[136:139], v30 offset:20480
v_mfma_f32_16x16x32_bf16 v[212:215], a[20:23], v[108:111], v[212:215]
ds_read_b128 v[140:143], v30 offset:28672
v_mfma_f32_16x16x32_bf16 v[220:223], a[80:83], v[84:87], v[220:223]
s_waitcnt vmcnt(5)
s_barrier
s_waitcnt lgkmcnt(4)
v_mfma_f32_16x16x32_bf16 v[208:211], a[24:27], v[112:115], v[208:211]
ds_read_b128 v[144:147], v30 offset:5120
v_mov_b32 v27, s78
v_mfma_f32_16x16x32_bf16 v[212:215], a[24:27], v[116:119], v[212:215]
ds_read_b128 v[148:151], v30 offset:13312
v_mfma_f32_16x16x32_bf16 v[216:219], a[84:87], v[88:91], v[216:219]
v_mfma_f32_16x16x32_bf16 v[208:211], a[28:31], v[120:123], v[208:211]
ds_read_b128 v[152:155], v30 offset:21504
v_mfma_f32_16x16x32_bf16 v[212:215], a[28:31], v[124:127], v[212:215]
ds_read_b128 v[156:159], v30 offset:29696
v_mfma_f32_16x16x32_bf16 v[220:223], a[84:87], v[92:95], v[220:223]
s_waitcnt lgkmcnt(4)
v_mfma_f32_16x16x32_bf16 v[208:211], a[32:35], v[128:131], v[208:211]
ds_read_b128 v[160:163], v30 offset:6144
v_mfma_f32_16x16x32_bf16 v[212:215], a[32:35], v[132:135], v[212:215]
ds_read_b128 v[164:167], v30 offset:14336
v_mfma_f32_16x16x32_bf16 v[216:219], a[88:91], v[96:99], v[216:219]
v_mfma_f32_16x16x32_bf16 v[208:211], a[36:39], v[136:139], v[208:211]
ds_read_b128 v[168:171], v30 offset:22528
s_waitcnt vmcnt(4)
ds_write_b32 v18, v24
v_mfma_f32_16x16x32_bf16 v[212:215], a[36:39], v[140:143], v[212:215]
ds_read_b128 v[172:175], v30 offset:30720
v_mfma_f32_16x16x32_bf16 v[220:223], a[88:91], v[100:103], v[220:223]
s_waitcnt lgkmcnt(5)
v_mfma_f32_16x16x32_bf16 v[208:211], a[40:43], v[144:147], v[208:211]
ds_read_b128 v[176:179], v30 offset:7168
s_waitcnt lgkmcnt(2)
s_barrier
v_mfma_f32_16x16x32_bf16 v[212:215], a[40:43], v[148:151], v[212:215]
ds_read_b128 v[180:183], v30 offset:15360
ds_read_b32 v33, v32
v_mfma_f32_16x16x32_bf16 v[216:219], a[92:95], v[104:107], v[216:219]
v_mfma_f32_16x16x32_bf16 v[208:211], a[44:47], v[152:155], v[208:211]
ds_read_b128 v[184:187], v30 offset:23552
v_mfma_f32_16x16x32_bf16 v[212:215], a[44:47], v[156:159], v[212:215]
ds_read_b128 v[188:191], v30 offset:31744
s_waitcnt lgkmcnt(2)
v_cmp_gt_u32 vcc, s52, v33
v_mfma_f32_16x16x32_bf16 v[220:223], a[92:95], v[108:111], v[220:223]
v_cmp_gt_u32 s[58:59], s54, v33
v_mfma_f32_16x16x32_bf16 v[208:211], a[48:51], v[160:163], v[208:211]
s_and_b32 vcc_lo, vcc_lo, s56
s_cselect_b32 s70, 0, 1
v_mfma_f32_16x16x32_bf16 v[212:215], a[48:51], v[164:167], v[212:215]
s_and_b32 s59, s59, s56
s_cselect_b32 s71, 0, s89
v_mfma_f32_16x16x32_bf16 v[216:219], a[96:99], v[112:115], v[216:219]
s_or_b32 s94, s70, s71
s_cselect_b32 s10, 268435456, 0
v_mfma_f32_16x16x32_bf16 v[208:211], a[52:55], v[168:171], v[208:211]
s_cmp_lg_u32 s70, 0
s_cselect_b64 s[90:91], s[52:53], s[54:55]
s_cselect_b64 s[58:59], s[44:45], s[46:47]
v_mfma_f32_16x16x32_bf16 v[212:215], a[52:55], v[172:175], v[212:215]
s_mul_i32 s92, s90, s20
s_add_u32 s92, s92, s58
v_mfma_f32_16x16x32_bf16 v[220:223], a[96:99], v[116:119], v[220:223]
s_add_u32 m0, s51, 0
s_waitcnt lgkmcnt(0)
v_mfma_f32_16x16x32_bf16 v[208:211], a[56:59], v[176:179], v[208:211]
buffer_load_dwordx4 v8, s[8:11], s92 offen offset:0 sc1 lds
v_mfma_f32_16x16x32_bf16 v[212:215], a[56:59], v[180:183], v[212:215]
s_mul_i32 s93, s90, s21
s_add_u32 s93, s93, s59
s_andn2_b32 s71, s71, s70
v_mfma_f32_16x16x32_bf16 v[216:219], a[100:103], v[120:123], v[216:219]
s_add_u32 s52, s52, s70
s_add_u32 s54, s54, s71
s_mov_b32 s95, s94
v_mfma_f32_16x16x32_bf16 v[208:211], a[60:63], v[184:187], v[208:211]
buffer_load_dwordx4 v9, s[8:11], s92 offen offset:1024 sc1 lds
v_mfma_f32_16x16x32_bf16 v[212:215], a[60:63], v[188:191], v[212:215]
v_mfma_f32_16x16x32_bf16 v[220:223], a[100:103], v[124:127], v[220:223]
v_mfma_f32_16x16x32_bf16 v[216:219], a[104:107], v[128:131], v[216:219]
buffer_load_dwordx4 v10, s[8:11], s92 offen offset:2048 sc1 lds
v_mfma_f32_16x16x32_bf16 v[220:223], a[104:107], v[132:135], v[220:223]
v_mfma_f32_16x16x32_bf16 v[216:219], a[108:111], v[136:139], v[216:219]
v_mfma_f32_16x16x32_bf16 v[220:223], a[108:111], v[140:143], v[220:223]
buffer_load_dwordx4 v11, s[8:11], s92 offen offset:3072 sc1 lds
v_mfma_f32_16x16x32_bf16 v[216:219], a[112:115], v[144:147], v[216:219]
v_cvt_pk_bf16_f32 v48, v208, v209
v_cvt_pk_bf16_f32 v49, v210, v211
v_mfma_f32_16x16x32_bf16 v[220:223], a[112:115], v[148:151], v[220:223]
s_add_u32 m0, s51, 4096
v_cvt_pk_bf16_f32 v50, v212, v213
v_mfma_f32_16x16x32_bf16 v[216:219], a[116:119], v[152:155], v[216:219]
buffer_load_dwordx4 v12, s[8:11], s92 offen offset:0 sc1 lds
v_mfma_f32_16x16x32_bf16 v[220:223], a[116:119], v[156:159], v[220:223]
v_cvt_pk_bf16_f32 v51, v214, v215
v_mfma_f32_16x16x32_bf16 v[216:219], a[120:123], v[160:163], v[216:219]
v_permlane16_swap_b32 v48, v50
v_mfma_f32_16x16x32_bf16 v[220:223], a[120:123], v[164:167], v[220:223]
buffer_load_dwordx4 v13, s[8:11], s92 offen offset:1024 sc1 lds
v_mfma_f32_16x16x32_bf16 v[216:219], a[124:127], v[168:171], v[216:219]
v_permlane16_swap_b32 v49, v51
v_mfma_f32_16x16x32_bf16 v[220:223], a[124:127], v[172:175], v[220:223]
buffer_store_dwordx4 v[48:51], v19, s[4:7], s87 offen sc1
v_mfma_f32_16x16x32_bf16 v[216:219], a[128:131], v[176:179], v[216:219]
buffer_load_dwordx4 v14, s[8:11], s92 offen offset:2048 sc1 lds
v_mfma_f32_16x16x32_bf16 v[220:223], a[128:131], v[180:183], v[220:223]
v_mfma_f32_16x16x32_bf16 v[216:219], a[132:135], v[184:187], v[216:219]
v_mfma_f32_16x16x32_bf16 v[220:223], a[132:135], v[188:191], v[220:223]
buffer_load_dwordx4 v15, s[8:11], s92 offen offset:3072 sc1 lds
v_mfma_f32_16x16x32_bf16 v[224:227], a[144:147], v[64:67], 0
v_mfma_f32_16x16x32_bf16 v[228:231], a[144:147], v[68:71], 0
v_mfma_f32_16x16x32_bf16 v[224:227], a[148:151], v[72:75], v[224:227]
v_mfma_f32_16x16x32_bf16 v[228:231], a[148:151], v[76:79], v[228:231]
buffer_load_dword v24, v22, s[4:7], 0 offen sc1
v_mfma_f32_16x16x32_bf16 v[224:227], a[152:155], v[80:83], v[224:227]
v_mfma_f32_16x16x32_bf16 v[228:231], a[152:155], v[84:87], v[228:231]
s_waitcnt vmcnt(10)
s_barrier
v_mfma_f32_16x16x32_bf16 v[224:227], a[156:159], v[88:91], v[224:227]
buffer_store_dword v27, v45, s[4:7], s79 offen
v_mfma_f32_16x16x32_bf16 v[228:231], a[156:159], v[92:95], v[228:231]
buffer_store_dword v27, v44, s[4:7], s79 offen sc1
v_mfma_f32_16x16x32_bf16 v[224:227], a[160:163], v[96:99], v[224:227]
v_cvt_pk_bf16_f32 v52, v216, v217
v_cvt_pk_bf16_f32 v53, v218, v219
v_mfma_f32_16x16x32_bf16 v[228:231], a[160:163], v[100:103], v[228:231]
v_cvt_pk_bf16_f32 v54, v220, v221
v_cvt_pk_bf16_f32 v55, v222, v223
v_mfma_f32_16x16x32_bf16 v[224:227], a[164:167], v[104:107], v[224:227]
v_permlane16_swap_b32 v52, v54
v_mfma_f32_16x16x32_bf16 v[228:231], a[164:167], v[108:111], v[228:231]
v_permlane16_swap_b32 v53, v55
v_mfma_f32_16x16x32_bf16 v[224:227], a[168:171], v[112:115], v[224:227]
buffer_store_dwordx4 v[52:55], v20, s[4:7], s87 offen sc1
v_mfma_f32_16x16x32_bf16 v[228:231], a[168:171], v[116:119], v[228:231]
v_mfma_f32_16x16x32_bf16 v[224:227], a[172:175], v[120:123], v[224:227]
v_mfma_f32_16x16x32_bf16 v[228:231], a[172:175], v[124:127], v[228:231]
v_mfma_f32_16x16x32_bf16 v[224:227], a[176:179], v[128:131], v[224:227]
v_mfma_f32_16x16x32_bf16 v[228:231], a[176:179], v[132:135], v[228:231]
v_mfma_f32_16x16x32_bf16 v[224:227], a[180:183], v[136:139], v[224:227]
v_mfma_f32_16x16x32_bf16 v[228:231], a[180:183], v[140:143], v[228:231]
v_mfma_f32_16x16x32_bf16 v[224:227], a[184:187], v[144:147], v[224:227]
s_waitcnt vmcnt(11)
s_barrier
v_mfma_f32_16x16x32_bf16 v[228:231], a[184:187], v[148:151], v[228:231]
v_mfma_f32_16x16x32_bf16 v[224:227], a[188:191], v[152:155], v[224:227]
s_cmp_eq_u32 s94, 0
s_cbranch_scc1 g_slow_131
v_mfma_f32_16x16x32_bf16 v[228:231], a[188:191], v[156:159], v[228:231]
ds_read_b128 v[64:67], v31 offset:0
v_mfma_f32_16x16x32_bf16 v[224:227], a[192:195], v[160:163], v[224:227]
ds_read_b128 v[68:71], v31 offset:8192
v_mfma_f32_16x16x32_bf16 v[228:231], a[192:195], v[164:167], v[228:231]
ds_read_b128 v[72:75], v31 offset:16384
v_mfma_f32_16x16x32_bf16 v[224:227], a[196:199], v[168:171], v[224:227]
ds_read_b128 v[76:79], v31 offset:24576
v_mfma_f32_16x16x32_bf16 v[228:231], a[196:199], v[172:175], v[228:231]
ds_read_b128 v[80:83], v31 offset:1024
v_mfma_f32_16x16x32_bf16 v[224:227], a[200:203], v[176:179], v[224:227]
ds_read_b128 v[84:87], v31 offset:9216
v_mfma_f32_16x16x32_bf16 v[228:231], a[200:203], v[180:183], v[228:231]
ds_read_b128 v[88:91], v31 offset:17408
v_mfma_f32_16x16x32_bf16 v[224:227], a[204:207], v[184:187], v[224:227]
ds_read_b128 v[92:95], v31 offset:25600
v_mfma_f32_16x16x32_bf16 v[228:231], a[204:207], v[188:191], v[228:231]
s_waitcnt vmcnt(8)
s_barrier
g_body_120:
s_waitcnt lgkmcnt(4)
v_mfma_f32_16x16x32_bf16 v[208:211], a[0:3], v[64:67], 0
ds_read_b128 v[96:99], v31 offset:2048
v_mfma_f32_16x16x32_bf16 v[212:215], a[0:3], v[68:71], 0
ds_read_b128 v[100:103], v31 offset:10240
v_mfma_f32_16x16x32_bf16 v[216:219], a[72:75], v[64:67], 0
v_mfma_f32_16x16x32_bf16 v[208:211], a[4:7], v[72:75], v[208:211]
ds_read_b128 v[104:107], v31 offset:18432
v_cvt_pk_bf16_f32 v56, v224, v225
v_mfma_f32_16x16x32_bf16 v[212:215], a[4:7], v[76:79], v[212:215]
ds_read_b128 v[108:111], v31 offset:26624
v_cvt_pk_bf16_f32 v57, v226, v227
v_mfma_f32_16x16x32_bf16 v[220:223], a[72:75], v[68:71], 0
v_cvt_pk_bf16_f32 v58, v228, v229
s_waitcnt lgkmcnt(4)
v_mfma_f32_16x16x32_bf16 v[208:211], a[8:11], v[80:83], v[208:211]
ds_read_b128 v[112:115], v31 offset:3072
v_cvt_pk_bf16_f32 v59, v230, v231
v_mfma_f32_16x16x32_bf16 v[212:215], a[8:11], v[84:87], v[212:215]
ds_read_b128 v[116:119], v31 offset:11264
v_permlane16_swap_b32 v56, v58
v_mfma_f32_16x16x32_bf16 v[216:219], a[76:79], v[72:75], v[216:219]
v_permlane16_swap_b32 v57, v59
v_mfma_f32_16x16x32_bf16 v[208:211], a[12:15], v[88:91], v[208:211]
ds_read_b128 v[120:123], v31 offset:19456
v_mfma_f32_16x16x32_bf16 v[212:215], a[12:15], v[92:95], v[212:215]
ds_read_b128 v[124:127], v31 offset:27648
v_mfma_f32_16x16x32_bf16 v[220:223], a[76:79], v[76:79], v[220:223]
s_waitcnt lgkmcnt(4)
v_mfma_f32_16x16x32_bf16 v[208:211], a[16:19], v[96:99], v[208:211]
ds_read_b128 v[128:131], v31 offset:4096
v_mfma_f32_16x16x32_bf16 v[212:215], a[16:19], v[100:103], v[212:215]
ds_read_b128 v[132:135], v31 offset:12288
v_mfma_f32_16x16x32_bf16 v[216:219], a[80:83], v[80:83], v[216:219]
buffer_store_dwordx4 v[56:59], v21, s[4:7], s87 offen sc1
v_mfma_f32_16x16x32_bf16 v[208:211], a[20:23], v[104:107], v[208:211]
ds_read_b128 v[136:139], v31 offset:20480
v_mfma_f32_16x16x32_bf16 v[212:215], a[20:23], v[108:111], v[212:215]
ds_read_b128 v[140:143], v31 offset:28672
v_mfma_f32_16x16x32_bf16 v[220:223], a[80:83], v[84:87], v[220:223]
s_waitcnt vmcnt(5)
s_barrier
s_waitcnt lgkmcnt(4)
v_mfma_f32_16x16x32_bf16 v[208:211], a[24:27], v[112:115], v[208:211]
ds_read_b128 v[144:147], v31 offset:5120
v_mov_b32 v27, s84
v_mfma_f32_16x16x32_bf16 v[212:215], a[24:27], v[116:119], v[212:215]
ds_read_b128 v[148:151], v31 offset:13312
v_mfma_f32_16x16x32_bf16 v[216:219], a[84:87], v[88:91], v[216:219]
v_mfma_f32_16x16x32_bf16 v[208:211], a[28:31], v[120:123], v[208:211]
ds_read_b128 v[152:155], v31 offset:21504
v_mfma_f32_16x16x32_bf16 v[212:215], a[28:31], v[124:127], v[212:215]
ds_read_b128 v[156:159], v31 offset:29696
v_mfma_f32_16x16x32_bf16 v[220:223], a[84:87], v[92:95], v[220:223]
s_waitcnt lgkmcnt(4)
v_mfma_f32_16x16x32_bf16 v[208:211], a[32:35], v[128:131], v[208:211]
ds_read_b128 v[160:163], v31 offset:6144
v_mfma_f32_16x16x32_bf16 v[212:215], a[32:35], v[132:135], v[212:215]
ds_read_b128 v[164:167], v31 offset:14336
v_mfma_f32_16x16x32_bf16 v[216:219], a[88:91], v[96:99], v[216:219]
v_mfma_f32_16x16x32_bf16 v[208:211], a[36:39], v[136:139], v[208:211]
ds_read_b128 v[168:171], v31 offset:22528
s_waitcnt vmcnt(4)
ds_write_b32 v18, v24
v_mfma_f32_16x16x32_bf16 v[212:215], a[36:39], v[140:143], v[212:215]
ds_read_b128 v[172:175], v31 offset:30720
v_mfma_f32_16x16x32_bf16 v[220:223], a[88:91], v[100:103], v[220:223]
s_waitcnt lgkmcnt(5)
v_mfma_f32_16x16x32_bf16 v[208:211], a[40:43], v[144:147], v[208:211]
ds_read_b128 v[176:179], v31 offset:7168
s_waitcnt lgkmcnt(2)
s_barrier
v_mfma_f32_16x16x32_bf16 v[212:215], a[40:43], v[148:151], v[212:215]
ds_read_b128 v[180:183], v31 offset:15360
ds_read_b32 v33, v32
v_mfma_f32_16x16x32_bf16 v[216:219], a[92:95], v[104:107], v[216:219]
v_mfma_f32_16x16x32_bf16 v[208:211], a[44:47], v[152:155], v[208:211]
ds_read_b128 v[184:187], v31 offset:23552
v_mfma_f32_16x16x32_bf16 v[212:215], a[44:47], v[156:159], v[212:215]
ds_read_b128 v[188:191], v31 offset:31744
s_waitcnt lgkmcnt(2)
v_cmp_gt_u32 vcc, s52, v33
v_mfma_f32_16x16x32_bf16 v[220:223], a[92:95], v[108:111], v[220:223]
v_cmp_gt_u32 s[58:59], s54, v33
v_mfma_f32_16x16x32_bf16 v[208:211], a[48:51], v[160:163], v[208:211]
s_and_b32 vcc_lo, vcc_lo, s56
s_cselect_b32 s70, 0, 1
v_mfma_f32_16x16x32_bf16 v[212:215], a[48:51], v[164:167], v[212:215]
s_and_b32 s59, s59, s56
s_cselect_b32 s71, 0, s95
v_mfma_f32_16x16x32_bf16 v[216:219], a[96:99], v[112:115], v[216:219]
s_or_b32 s76, s70, s71
s_cselect_b32 s10, 268435456, 0
v_mfma_f32_16x16x32_bf16 v[208:211], a[52:55], v[168:171], v[208:211]
s_cmp_lg_u32 s70, 0
s_cselect_b64 s[72:73], s[52:53], s[54:55]
s_cselect_b64 s[58:59], s[44:45], s[46:47]
v_mfma_f32_16x16x32_bf16 v[212:215], a[52:55], v[172:175], v[212:215]
s_mul_i32 s74, s72, s20
s_add_u32 s74, s74, s58
v_mfma_f32_16x16x32_bf16 v[220:223], a[96:99], v[116:119], v[220:223]
s_add_u32 m0, s48, 0
s_waitcnt lgkmcnt(0)
v_mfma_f32_16x16x32_bf16 v[208:211], a[56:59], v[176:179], v[208:211]
buffer_load_dwordx4 v8, s[8:11], s74 offen offset:0 sc1 lds
v_mfma_f32_16x16x32_bf16 v[212:215], a[56:59], v[180:183], v[212:215]
s_mul_i32 s75, s72, s21
s_add_u32 s75, s75, s59
s_andn2_b32 s71, s71, s70
v_mfma_f32_16x16x32_bf16 v[216:219], a[100:103], v[120:123], v[216:219]
s_add_u32 s52, s52, s70
s_add_u32 s54, s54, s71
s_mov_b32 s77, s76
v_mfma_f32_16x16x32_bf16 v[208:211], a[60:63], v[184:187], v[208:211]
buffer_load_dwordx4 v9, s[8:11], s74 offen offset:1024 sc1 lds
v_mfma_f32_16x16x32_bf16 v[212:215], a[60:63], v[188:191], v[212:215]
v_mfma_f32_16x16x32_bf16 v[220:223], a[100:103], v[124:127], v[220:223]
v_mfma_f32_16x16x32_bf16 v[216:219], a[104:107], v[128:131], v[216:219]
buffer_load_dwordx4 v10, s[8:11], s74 offen offset:2048 sc1 lds
v_mfma_f32_16x16x32_bf16 v[220:223], a[104:107], v[132:135], v[220:223]
v_mfma_f32_16x16x32_bf16 v[216:219], a[108:111], v[136:139], v[216:219]
v_mfma_f32_16x16x32_bf16 v[220:223], a[108:111], v[140:143], v[220:223]
buffer_load_dwordx4 v11, s[8:11], s74 offen offset:3072 sc1 lds
v_mfma_f32_16x16x32_bf16 v[216:219], a[112:115], v[144:147], v[216:219]
v_cvt_pk_bf16_f32 v48, v208, v209
v_cvt_pk_bf16_f32 v49, v210, v211
v_mfma_f32_16x16x32_bf16 v[220:223], a[112:115], v[148:151], v[220:223]
s_add_u32 m0, s48, 4096
v_cvt_pk_bf16_f32 v50, v212, v213
v_mfma_f32_16x16x32_bf16 v[216:219], a[116:119], v[152:155], v[216:219]
buffer_load_dwordx4 v12, s[8:11], s74 offen offset:0 sc1 lds
v_mfma_f32_16x16x32_bf16 v[220:223], a[116:119], v[156:159], v[220:223]
v_cvt_pk_bf16_f32 v51, v214, v215
v_mfma_f32_16x16x32_bf16 v[216:219], a[120:123], v[160:163], v[216:219]
v_permlane16_swap_b32 v48, v50
v_mfma_f32_16x16x32_bf16 v[220:223], a[120:123], v[164:167], v[220:223]
buffer_load_dwordx4 v13, s[8:11], s74 offen offset:1024 sc1 lds
v_mfma_f32_16x16x32_bf16 v[216:219], a[124:127], v[168:171], v[216:219]
v_permlane16_swap_b32 v49, v51
v_mfma_f32_16x16x32_bf16 v[220:223], a[124:127], v[172:175], v[220:223]
buffer_store_dwordx4 v[48:51], v19, s[4:7], s93 offen sc1
v_mfma_f32_16x16x32_bf16 v[216:219], a[128:131], v[176:179], v[216:219]
buffer_load_dwordx4 v14, s[8:11], s74 offen offset:2048 sc1 lds
v_mfma_f32_16x16x32_bf16 v[220:223], a[128:131], v[180:183], v[220:223]
v_mfma_f32_16x16x32_bf16 v[216:219], a[132:135], v[184:187], v[216:219]
v_mfma_f32_16x16x32_bf16 v[220:223], a[132:135], v[188:191], v[220:223]
buffer_load_dwordx4 v15, s[8:11], s74 offen offset:3072 sc1 lds
v_mfma_f32_16x16x32_bf16 v[224:227], a[144:147], v[64:67], 0
v_mfma_f32_16x16x32_bf16 v[228:231], a[144:147], v[68:71], 0
v_mfma_f32_16x16x32_bf16 v[224:227], a[148:151], v[72:75], v[224:227]
v_mfma_f32_16x16x32_bf16 v[228:231], a[148:151], v[76:79], v[228:231]
buffer_load_dword v24, v22, s[4:7], 0 offen sc1
v_mfma_f32_16x16x32_bf16 v[224:227], a[152:155], v[80:83], v[224:227]
v_mfma_f32_16x16x32_bf16 v[228:231], a[152:155], v[84:87], v[228:231]
s_waitcnt vmcnt(10)
s_barrier
v_mfma_f32_16x16x32_bf16 v[224:227], a[156:159], v[88:91], v[224:227]
buffer_store_dword v27, v45, s[4:7], s85 offen
v_mfma_f32_16x16x32_bf16 v[228:231], a[156:159], v[92:95], v[228:231]
buffer_store_dword v27, v44, s[4:7], s85 offen sc1
v_mfma_f32_16x16x32_bf16 v[224:227], a[160:163], v[96:99], v[224:227]
v_cvt_pk_bf16_f32 v52, v216, v217
v_cvt_pk_bf16_f32 v53, v218, v219
v_mfma_f32_16x16x32_bf16 v[228:231], a[160:163], v[100:103], v[228:231]
v_cvt_pk_bf16_f32 v54, v220, v221
v_cvt_pk_bf16_f32 v55, v222, v223
v_mfma_f32_16x16x32_bf16 v[224:227], a[164:167], v[104:107], v[224:227]
v_permlane16_swap_b32 v52, v54
v_mfma_f32_16x16x32_bf16 v[228:231], a[164:167], v[108:111], v[228:231]
v_permlane16_swap_b32 v53, v55
v_mfma_f32_16x16x32_bf16 v[224:227], a[168:171], v[112:115], v[224:227]
buffer_store_dwordx4 v[52:55], v20, s[4:7], s93 offen sc1
v_mfma_f32_16x16x32_bf16 v[228:231], a[168:171], v[116:119], v[228:231]
v_mfma_f32_16x16x32_bf16 v[224:227], a[172:175], v[120:123], v[224:227]
v_mfma_f32_16x16x32_bf16 v[228:231], a[172:175], v[124:127], v[228:231]
v_mfma_f32_16x16x32_bf16 v[224:227], a[176:179], v[128:131], v[224:227]
v_mfma_f32_16x16x32_bf16 v[228:231], a[176:179], v[132:135], v[228:231]
v_mfma_f32_16x16x32_bf16 v[224:227], a[180:183], v[136:139], v[224:227]
v_mfma_f32_16x16x32_bf16 v[228:231], a[180:183], v[140:143], v[228:231]
v_mfma_f32_16x16x32_bf16 v[224:227], a[184:187], v[144:147], v[224:227]
s_waitcnt vmcnt(11)
s_barrier
v_mfma_f32_16x16x32_bf16 v[228:231], a[184:187], v[148:151], v[228:231]
v_mfma_f32_16x16x32_bf16 v[224:227], a[188:191], v[152:155], v[224:227]
s_cmp_eq_u32 s76, 0
s_cbranch_scc1 g_slow_132
v_mfma_f32_16x16x32_bf16 v[228:231], a[188:191], v[156:159], v[228:231]
ds_read_b128 v[64:67], v28 offset:0
v_mfma_f32_16x16x32_bf16 v[224:227], a[192:195], v[160:163], v[224:227]
ds_read_b128 v[68:71], v28 offset:8192
v_mfma_f32_16x16x32_bf16 v[228:231], a[192:195], v[164:167], v[228:231]
ds_read_b128 v[72:75], v28 offset:16384
v_mfma_f32_16x16x32_bf16 v[224:227], a[196:199], v[168:171], v[224:227]
ds_read_b128 v[76:79], v28 offset:24576
v_mfma_f32_16x16x32_bf16 v[228:231], a[196:199], v[172:175], v[228:231]
ds_read_b128 v[80:83], v28 offset:1024
v_mfma_f32_16x16x32_bf16 v[224:227], a[200:203], v[176:179], v[224:227]
ds_read_b128 v[84:87], v28 offset:9216
v_mfma_f32_16x16x32_bf16 v[228:231], a[200:203], v[180:183], v[228:231]
ds_read_b128 v[88:91], v28 offset:17408
v_mfma_f32_16x16x32_bf16 v[224:227], a[204:207], v[184:187], v[224:227]
ds_read_b128 v[92:95], v28 offset:25600
v_mfma_f32_16x16x32_bf16 v[228:231], a[204:207], v[188:191], v[228:231]
s_waitcnt vmcnt(8)
s_barrier
s_branch g_body_117
g_slow_129:
v_mfma_f32_16x16x32_bf16 v[228:231], a[188:191], v[156:159], v[228:231]
v_mfma_f32_16x16x32_bf16 v[224:227], a[192:195], v[160:163], v[224:227]
v_mfma_f32_16x16x32_bf16 v[228:231], a[192:195], v[164:167], v[228:231]
v_mfma_f32_16x16x32_bf16 v[224:227], a[196:199], v[168:171], v[224:227]
v_mfma_f32_16x16x32_bf16 v[228:231], a[196:199], v[172:175], v[228:231]
v_mfma_f32_16x16x32_bf16 v[224:227], a[200:203], v[176:179], v[224:227]
v_mfma_f32_16x16x32_bf16 v[228:231], a[200:203], v[180:183], v[228:231]
v_mfma_f32_16x16x32_bf16 v[224:227], a[204:207], v[184:187], v[224:227]
v_mfma_f32_16x16x32_bf16 v[228:231], a[204:207], v[188:191], v[228:231]
s_nop 6
v_cvt_pk_bf16_f32 v56, v224, v225
v_cvt_pk_bf16_f32 v57, v226, v227
v_cvt_pk_bf16_f32 v58, v228, v229
v_cvt_pk_bf16_f32 v59, v230, v231
s_nop 0
v_permlane16_swap_b32 v56, v58
v_permlane16_swap_b32 v57, v59
buffer_store_dwordx4 v[56:59], v21, s[4:7], s75 offen sc1
s_mov_b32 s75, 1879048192
s_waitcnt vmcnt(4)
ds_write_b32 v18, v24
s_waitcnt lgkmcnt(0)
s_barrier
ds_read_b32 v33, v32
s_waitcnt lgkmcnt(0)
v_cmp_gt_u32 vcc, s52, v33
v_cmp_gt_u32 s[58:59], s54, v33
s_and_b32 vcc_lo, vcc_lo, s56
s_cselect_b32 s70, 0, 1
s_and_b32 s59, s59, s56
s_cselect_b32 s71, 0, s77
s_or_b32 s82, s70, s71
s_cselect_b32 s10, 268435456, 0
s_cmp_lg_u32 s70, 0
s_cselect_b64 s[78:79], s[52:53], s[54:55]
s_cselect_b64 s[58:59], s[44:45], s[46:47]
s_mul_i32 s80, s78, s20
s_add_u32 s80, s80, s58
s_mul_i32 s81, s78, s21
s_add_u32 s81, s81, s59
s_andn2_b32 s71, s71, s70
s_add_u32 s52, s52, s70
s_add_u32 s54, s54, s71
s_mov_b32 s83, s82
s_cmp_lg_u32 s82, 0
s_cbranch_scc1 g_go_133
v_mov_b32 v27, s72
s_waitcnt vmcnt(0)
s_barrier
s_add_u32 s70, s52, s54
s_cmp_eq_u32 s70, 130
s_cbranch_scc1 g_fin_121
s_cmp_lg_u32 s3, 0
s_cbranch_scc1 sp_ok_135_j
s_mov_b32 s23, 0
buffer_load_dword v33, v22, s[4:7], 0 offen sc1
buffer_store_dword v27, v45, s[4:7], s73 offen
buffer_store_dword v27, v44, s[4:7], s73 offen sc1
s_waitcnt vmcnt(2)
s_branch sp_loop_134_e
sp_loop_134:
buffer_load_dword v33, v22, s[4:7], 0 offen sc1
s_add_u32 s23, s23, 1
s_cmp_gt_u32 s23, 150000
s_cbranch_scc1 sp_bad_136
s_waitcnt vmcnt(0)
sp_loop_134_e:
v_cmp_gt_u32 vcc, s52, v33
v_cmp_gt_u32 s[58:59], s54, v33
s_and_b32 vcc_lo, vcc_lo, s56
s_cbranch_scc0 sp_ok_135
s_cmp_gt_u32 s23, 4
s_cselect_b32 s70, 0, s56
s_cmp_lg_u32 s77, 0
s_cselect_b32 s70, 0, s70
s_or_b32 s59, s59, s70
s_and_b32 s59, s59, s56
s_cbranch_scc0 sp_ok_135
s_sleep 1
s_branch sp_loop_134
sp_bad_136:
s_mov_b32 s98, 1029
s_branch L_fail
sp_ok_135:
ds_write_b32 v18, v33
s_waitcnt lgkmcnt(0)
sp_ok_135_j:
s_barrier
ds_read_b32 v33, v32
s_waitcnt lgkmcnt(0)
s_mov_b32 s73, 1879048192
v_cmp_gt_u32 vcc, s52, v33
v_cmp_gt_u32 s[58:59], s54, v33
s_and_b32 vcc_lo, vcc_lo, s56
s_cselect_b32 s70, 0, 1
s_and_b32 s59, s59, s56
s_cselect_b32 s71, 0, 1
s_or_b32 s82, s70, s71
s_cselect_b32 s10, 268435456, 0
s_cmp_lg_u32 s70, 0
s_cselect_b64 s[78:79], s[52:53], s[54:55]
s_cselect_b64 s[58:59], s[44:45], s[46:47]
s_mul_i32 s80, s78, s20
s_add_u32 s80, s80, s58
s_mul_i32 s81, s78, s21
s_add_u32 s81, s81, s59
s_andn2_b32 s71, s71, s70
s_add_u32 s52, s52, s70
s_add_u32 s54, s54, s71
s_mov_b32 s83, s82
g_go_133:
s_add_u32 m0, s49, 0
s_nop 0
buffer_load_dwordx4 v8, s[4:7], s80 offen offset:0 sc1 lds
buffer_load_dwordx4 v9, s[4:7], s80 offen offset:1024 sc1 lds
buffer_load_dwordx4 v10, s[4:7], s80 offen offset:2048 sc1 lds
buffer_load_dwordx4 v11, s[4:7], s80 offen offset:3072 sc1 lds
s_add_u32 m0, s49, 4096
s_nop 0
buffer_load_dwordx4 v12, s[4:7], s80 offen offset:0 sc1 lds
buffer_load_dwordx4 v13, s[4:7], s80 offen offset:1024 sc1 lds
buffer_load_dwordx4 v14, s[4:7], s80 offen offset:2048 sc1 lds
buffer_load_dwordx4 v15, s[4:7], s80 offen offset:3072 sc1 lds
buffer_load_dword v24, v22, s[4:7], 0 offen sc1
buffer_store_dword v27, v34, s[4:7], 0 offen
v_mov_b32 v27, s72
s_waitcnt vmcnt(8)
s_barrier
buffer_store_dword v27, v45, s[4:7], s73 offen
buffer_store_dword v27, v44, s[4:7], s73 offen sc1
s_mov_b32 s73, 1879048192
ds_read_b128 v[64:67], v29 offset:0
ds_read_b128 v[68:71], v29 offset:8192
ds_read_b128 v[72:75], v29 offset:16384
ds_read_b128 v[76:79], v29 offset:24576
ds_read_b128 v[80:83], v29 offset:1024
ds_read_b128 v[84:87], v29 offset:9216
ds_read_b128 v[88:91], v29 offset:17408
ds_read_b128 v[92:95], v29 offset:25600
s_waitcnt vmcnt(7)
s_barrier
s_branch g_body_118
g_slow_130:
v_mfma_f32_16x16x32_bf16 v[228:231], a[188:191], v[156:159], v[228:231]
v_mfma_f32_16x16x32_bf16 v[224:227], a[192:195], v[160:163], v[224:227]
v_mfma_f32_16x16x32_bf16 v[228:231], a[192:195], v[164:167], v[228:231]
v_mfma_f32_16x16x32_bf16 v[224:227], a[196:199], v[168:171], v[224:227]
v_mfma_f32_16x16x32_bf16 v[228:231], a[196:199], v[172:175], v[228:231]
v_mfma_f32_16x16x32_bf16 v[224:227], a[200:203], v[176:179], v[224:227]
v_mfma_f32_16x16x32_bf16 v[228:231], a[200:203], v[180:183], v[228:231]
v_mfma_f32_16x16x32_bf16 v[224:227], a[204:207], v[184:187], v[224:227]
v_mfma_f32_16x16x32_bf16 v[228:231], a[204:207], v[188:191], v[228:231]
s_nop 6
v_cvt_pk_bf16_f32 v56, v224, v225
v_cvt_pk_bf16_f32 v57, v226, v227
v_cvt_pk_bf16_f32 v58, v228, v229
v_cvt_pk_bf16_f32 v59, v230, v231
s_nop 0
v_permlane16_swap_b32 v56, v58
v_permlane16_swap_b32 v57, v59
buffer_store_dwordx4 v[56:59], v21, s[4:7], s81 offen sc1
s_mov_b32 s81, 1879048192
s_waitcnt vmcnt(4)
ds_write_b32 v18, v24
s_waitcnt lgkmcnt(0)
s_barrier
ds_read_b32 v33, v32
s_waitcnt lgkmcnt(0)
v_cmp_gt_u32 vcc, s52, v33
v_cmp_gt_u32 s[58:59], s54, v33
s_and_b32 vcc_lo, vcc_lo, s56
s_cselect_b32 s70, 0, 1
s_and_b32 s59, s59, s56
s_cselect_b32 s71, 0, s83
s_or_b32 s88, s70, s71
s_cselect_b32 s10, 268435456, 0
s_cmp_lg_u32 s70, 0
s_cselect_b64 s[84:85], s[52:53], s[54:55]
s_cselect_b64 s[58:59], s[44:45], s[46:47]
s_mul_i32 s86, s84, s20
s_add_u32 s86, s86, s58
s_mul_i32 s87, s84, s21
s_add_u32 s87, s87, s59
s_andn2_b32 s71, s71, s70
s_add_u32 s52, s52, s70
s_add_u32 s54, s54, s71
s_mov_b32 s89, s88
s_cmp_lg_u32 s88, 0
s_cbranch_scc1 g_go_137
v_mov_b32 v27, s78
s_waitcnt vmcnt(0)
s_barrier
s_add_u32 s70, s52, s54
s_cmp_eq_u32 s70, 130
s_cbranch_scc1 g_fin_121
s_cmp_lg_u32 s3, 0
s_cbranch_scc1 sp_ok_139_j
s_mov_b32 s23, 0
buffer_load_dword v33, v22, s[4:7], 0 offen sc1
buffer_store_dword v27, v45, s[4:7], s79 offen
buffer_store_dword v27, v44, s[4:7], s79 offen sc1
s_waitcnt vmcnt(2)
s_branch sp_loop_138_e
sp_loop_138:
buffer_load_dword v33, v22, s[4:7], 0 offen sc1
s_add_u32 s23, s23, 1
s_cmp_gt_u32 s23, 150000
s_cbranch_scc1 sp_bad_140
s_waitcnt vmcnt(0)
sp_loop_138_e:
v_cmp_gt_u32 vcc, s52, v33
v_cmp_gt_u32 s[58:59], s54, v33
s_and_b32 vcc_lo, vcc_lo, s56
s_cbranch_scc0 sp_ok_139
s_cmp_gt_u32 s23, 4
s_cselect_b32 s70, 0, s56
s_cmp_lg_u32 s83, 0
s_cselect_b32 s70, 0, s70
s_or_b32 s59, s59, s70
s_and_b32 s59, s59, s56
s_cbranch_scc0 sp_ok_139
s_sleep 1
s_branch sp_loop_138
sp_bad_140:
s_mov_b32 s98, 1029
s_branch L_fail
sp_ok_139:
ds_write_b32 v18, v33
s_waitcnt lgkmcnt(0)
sp_ok_139_j:
s_barrier
ds_read_b32 v33, v32
s_waitcnt lgkmcnt(0)
s_mov_b32 s79, 1879048192
v_cmp_gt_u32 vcc, s52, v33
v_cmp_gt_u32 s[58:59], s54, v33
s_and_b32 vcc_lo, vcc_lo, s56
s_cselect_b32 s70, 0, 1
s_and_b32 s59, s59, s56
s_cselect_b32 s71, 0, 1
s_or_b32 s88, s70, s71
s_cselect_b32 s10, 268435456, 0
s_cmp_lg_u32 s70, 0
s_cselect_b64 s[84:85], s[52:53], s[54:55]
s_cselect_b64 s[58:59], s[44:45], s[46:47]
s_mul_i32 s86, s84, s20
s_add_u32 s86, s86, s58
s_mul_i32 s87, s84, s21
s_add_u32 s87, s87, s59
s_andn2_b32 s71, s71, s70
s_add_u32 s52, s52, s70
s_add_u32 s54, s54, s71
s_mov_b32 s89, s88
g_go_137:
s_add_u32 m0, s50, 0
s_nop 0
buffer_load_dwordx4 v8, s[4:7], s86 offen offset:0 sc1 lds
buffer_load_dwordx4 v9, s[4:7], s86 offen offset:1024 sc1 lds
buffer_load_dwordx4 v10, s[4:7], s86 offen offset:2048 sc1 lds
buffer_load_dwordx4 v11, s[4:7], s86 offen offset:3072 sc1 lds
s_add_u32 m0, s50, 4096
s_nop 0
buffer_load_dwordx4 v12, s[4:7], s86 offen offset:0 sc1 lds
buffer_load_dwordx4 v13, s[4:7], s86 offen offset:1024 sc1 lds
buffer_load_dwordx4 v14, s[4:7], s86 offen offset:2048 sc1 lds
buffer_load_dwordx4 v15, s[4:7], s86 offen offset:3072 sc1 lds
buffer_load_dword v24, v22, s[4:7], 0 offen sc1
buffer_store_dword v27, v34, s[4:7], 0 offen
v_mov_b32 v27, s78
s_waitcnt vmcnt(8)
s_barrier
buffer_store_dword v27, v45, s[4:7], s79 offen
buffer_store_dword v27, v44, s[4:7], s79 offen sc1
s_mov_b32 s79, 1879048192
ds_read_b128 v[64:67], v30 offset:0
ds_read_b128 v[68:71], v30 offset:8192
ds_read_b128 v[72:75], v30 offset:16384
ds_read_b128 v[76:79], v30 offset:24576
ds_read_b128 v[80:83], v30 offset:1024
ds_read_b128 v[84:87], v30 offset:9216
ds_read_b128 v[88:91], v30 offset:17408
ds_read_b128 v[92:95], v30 offset:25600
s_waitcnt vmcnt(7)
s_barrier
s_branch g_body_119
g_slow_131:
v_mfma_f32_16x16x32_bf16 v[228:231], a[188:191], v[156:159], v[228:231]
v_mfma_f32_16x16x32_bf16 v[224:227], a[192:195], v[160:163], v[224:227]
v_mfma_f32_16x16x32_bf16 v[228:231], a[192:195], v[164:167], v[228:231]
v_mfma_f32_16x16x32_bf16 v[224:227], a[196:199], v[168:171], v[224:227]
v_mfma_f32_16x16x32_bf16 v[228:231], a[196:199], v[172:175], v[228:231]
v_mfma_f32_16x16x32_bf16 v[224:227], a[200:203], v[176:179], v[224:227]
v_mfma_f32_16x16x32_bf16 v[228:231], a[200:203], v[180:183], v[228:231]
v_mfma_f32_16x16x32_bf16 v[224:227], a[204:207], v[184:187], v[224:227]
v_mfma_f32_16x16x32_bf16 v[228:231], a[204:207], v[188:191], v[228:231]
s_nop 6
v_cvt_pk_bf16_f32 v56, v224, v225
v_cvt_pk_bf16_f32 v57, v226, v227
v_cvt_pk_bf16_f32 v58, v228, v229
v_cvt_pk_bf16_f32 v59, v230, v231
s_nop 0
v_permlane16_swap_b32 v56, v58
v_permlane16_swap_b32 v57, v59
buffer_store_dwordx4 v[56:59], v21, s[4:7], s87 offen sc1
s_mov_b32 s87, 1879048192
s_waitcnt vmcnt(4)
ds_write_b32 v18, v24
s_waitcnt lgkmcnt(0)
s_barrier
ds_read_b32 v33, v32
s_waitcnt lgkmcnt(0)
v_cmp_gt_u32 vcc, s52, v33
v_cmp_gt_u32 s[58:59], s54, v33
s_and_b32 vcc_lo, vcc_lo, s56
s_cselect_b32 s70, 0, 1
s_and_b32 s59, s59, s56
s_cselect_b32 s71, 0, s89
s_or_b32 s94, s70, s71
s_cselect_b32 s10, 268435456, 0
s_cmp_lg_u32 s70, 0
s_cselect_b64 s[90:91], s[52:53], s[54:55]
s_cselect_b64 s[58:59], s[44:45], s[46:47]
s_mul_i32 s92, s90, s20
s_add_u32 s92, s92, s58
s_mul_i32 s93, s90, s21
s_add_u32 s93, s93, s59
s_andn2_b32 s71, s71, s70
s_add_u32 s52, s52, s70
s_add_u32 s54, s54, s71
s_mov_b32 s95, s94
s_cmp_lg_u32 s94, 0
s_cbranch_scc1 g_go_141
v_mov_b32 v27, s84
s_waitcnt vmcnt(0)
s_barrier
s_add_u32 s70, s52, s54
s_cmp_eq_u32 s70, 130
s_cbranch_scc1 g_fin_121
s_cmp_lg_u32 s3, 0
s_cbranch_scc1 sp_ok_143_j
s_mov_b32 s23, 0
buffer_load_dword v33, v22, s[4:7], 0 offen sc1
buffer_store_dword v27, v45, s[4:7], s85 offen
buffer_store_dword v27, v44, s[4:7], s85 offen sc1
s_waitcnt vmcnt(2)
s_branch sp_loop_142_e
sp_loop_142:
buffer_load_dword v33, v22, s[4:7], 0 offen sc1
s_add_u32 s23, s23, 1
s_cmp_gt_u32 s23, 150000
s_cbranch_scc1 sp_bad_144
s_waitcnt vmcnt(0)
sp_loop_142_e:
v_cmp_gt_u32 vcc, s52, v33
v_cmp_gt_u32 s[58:59], s54, v33
s_and_b32 vcc_lo, vcc_lo, s56
s_cbranch_scc0 sp_ok_143
s_cmp_gt_u32 s23, 4
s_cselect_b32 s70, 0, s56
s_cmp_lg_u32 s89, 0
s_cselect_b32 s70, 0, s70
s_or_b32 s59, s59, s70
s_and_b32 s59, s59, s56
s_cbranch_scc0 sp_ok_143
s_sleep 1
s_branch sp_loop_142
sp_bad_144:
s_mov_b32 s98, 1029
s_branch L_fail
sp_ok_143:
ds_write_b32 v18, v33
s_waitcnt lgkmcnt(0)
sp_ok_143_j:
s_barrier
ds_read_b32 v33, v32
s_waitcnt lgkmcnt(0)
s_mov_b32 s85, 1879048192
v_cmp_gt_u32 vcc, s52, v33
v_cmp_gt_u32 s[58:59], s54, v33
s_and_b32 vcc_lo, vcc_lo, s56
s_cselect_b32 s70, 0, 1
s_and_b32 s59, s59, s56
s_cselect_b32 s71, 0, 1
s_or_b32 s94, s70, s71
s_cselect_b32 s10, 268435456, 0
s_cmp_lg_u32 s70, 0
s_cselect_b64 s[90:91], s[52:53], s[54:55]
s_cselect_b64 s[58:59], s[44:45], s[46:47]
s_mul_i32 s92, s90, s20
s_add_u32 s92, s92, s58
s_mul_i32 s93, s90, s21
s_add_u32 s93, s93, s59
s_andn2_b32 s71, s71, s70
s_add_u32 s52, s52, s70
s_add_u32 s54, s54, s71
s_mov_b32 s95, s94
g_go_141:
s_add_u32 m0, s51, 0
s_nop 0
buffer_load_dwordx4 v8, s[4:7], s92 offen offset:0 sc1 lds
buffer_load_dwordx4 v9, s[4:7], s92 offen offset:1024 sc1 lds
buffer_load_dwordx4 v10, s[4:7], s92 offen offset:2048 sc1 lds
buffer_load_dwordx4 v11, s[4:7], s92 offen offset:3072 sc1 lds
s_add_u32 m0, s51, 4096
s_nop 0
buffer_load_dwordx4 v12, s[4:7], s92 offen offset:0 sc1 lds
buffer_load_dwordx4 v13, s[4:7], s92 offen offset:1024 sc1 lds
buffer_load_dwordx4 v14, s[4:7], s92 offen offset:2048 sc1 lds
buffer_load_dwordx4 v15, s[4:7], s92 offen offset:3072 sc1 lds
buffer_load_dword v24, v22, s[4:7], 0 offen sc1
buffer_store_dword v27, v34, s[4:7], 0 offen
v_mov_b32 v27, s84
s_waitcnt vmcnt(8)
s_barrier
buffer_store_dword v27, v45, s[4:7], s85 offen
buffer_store_dword v27, v44, s[4:7], s85 offen sc1
s_mov_b32 s85, 1879048192
ds_read_b128 v[64:67], v31 offset:0
ds_read_b128 v[68:71], v31 offset:8192
ds_read_b128 v[72:75], v31 offset:16384
ds_read_b128 v[76:79], v31 offset:24576
ds_read_b128 v[80:83], v31 offset:1024
ds_read_b128 v[84:87], v31 offset:9216
ds_read_b128 v[88:91], v31 offset:17408
ds_read_b128 v[92:95], v31 offset:25600
s_waitcnt vmcnt(7)
s_barrier
s_branch g_body_120
g_slow_132:
v_mfma_f32_16x16x32_bf16 v[228:231], a[188:191], v[156:159], v[228:231]
v_mfma_f32_16x16x32_bf16 v[224:227], a[192:195], v[160:163], v[224:227]
v_mfma_f32_16x16x32_bf16 v[228:231], a[192:195], v[164:167], v[228:231]
v_mfma_f32_16x16x32_bf16 v[224:227], a[196:199], v[168:171], v[224:227]
v_mfma_f32_16x16x32_bf16 v[228:231], a[196:199], v[172:175], v[228:231]
v_mfma_f32_16x16x32_bf16 v[224:227], a[200:203], v[176:179], v[224:227]
v_mfma_f32_16x16x32_bf16 v[228:231], a[200:203], v[180:183], v[228:231]
v_mfma_f32_16x16x32_bf16 v[224:227], a[204:207], v[184:187], v[224:227]
v_mfma_f32_16x16x32_bf16 v[228:231], a[204:207], v[188:191], v[228:231]
s_nop 6
v_cvt_pk_bf16_f32 v56, v224, v225
v_cvt_pk_bf16_f32 v57, v226, v227
v_cvt_pk_bf16_f32 v58, v228, v229
v_cvt_pk_bf16_f32 v59, v230, v231
s_nop 0
v_permlane16_swap_b32 v56, v58
v_permlane16_swap_b32 v57, v59
buffer_store_dwordx4 v[56:59], v21, s[4:7], s93 offen sc1
s_mov_b32 s93, 1879048192
s_waitcnt vmcnt(4)
ds_write_b32 v18, v24
s_waitcnt lgkmcnt(0)
s_barrier
ds_read_b32 v33, v32
s_waitcnt lgkmcnt(0)
v_cmp_gt_u32 vcc, s52, v33
v_cmp_gt_u32 s[58:59], s54, v33
s_and_b32 vcc_lo, vcc_lo, s56
s_cselect_b32 s70, 0, 1
s_and_b32 s59, s59, s56
s_cselect_b32 s71, 0, s95
s_or_b32 s76, s70, s71
s_cselect_b32 s10, 268435456, 0
s_cmp_lg_u32 s70, 0
s_cselect_b64 s[72:73], s[52:53], s[54:55]
s_cselect_b64 s[58:59], s[44:45], s[46:47]
s_mul_i32 s74, s72, s20
s_add_u32 s74, s74, s58
s_mul_i32 s75, s72, s21
s_add_u32 s75, s75, s59
s_andn2_b32 s71, s71, s70
s_add_u32 s52, s52, s70
s_add_u32 s54, s54, s71
s_mov_b32 s77, s76
s_cmp_lg_u32 s76, 0
s_cbranch_scc1 g_go_145
v_mov_b32 v27, s90
s_waitcnt vmcnt(0)
s_barrier
s_add_u32 s70, s52, s54
s_cmp_eq_u32 s70, 130
s_cbranch_scc1 g_fin_121
s_cmp_lg_u32 s3, 0
s_cbranch_scc1 sp_ok_147_j
s_mov_b32 s23, 0
buffer_load_dword v33, v22, s[4:7], 0 offen sc1
buffer_store_dword v27, v45, s[4:7], s91 offen
buffer_store_dword v27, v44, s[4:7], s91 offen sc1
s_waitcnt vmcnt(2)
s_branch sp_loop_146_e
sp_loop_146:
buffer_load_dword v33, v22, s[4:7], 0 offen sc1
s_add_u32 s23, s23, 1
s_cmp_gt_u32 s23, 150000
s_cbranch_scc1 sp_bad_148
s_waitcnt vmcnt(0)
sp_loop_146_e:
v_cmp_gt_u32 vcc, s52, v33
v_cmp_gt_u32 s[58:59], s54, v33
s_and_b32 vcc_lo, vcc_lo, s56
s_cbranch_scc0 sp_ok_147
s_cmp_gt_u32 s23, 4
s_cselect_b32 s70, 0, s56
s_cmp_lg_u32 s95, 0
s_cselect_b32 s70, 0, s70
s_or_b32 s59, s59, s70
s_and_b32 s59, s59, s56
s_cbranch_scc0 sp_ok_147
s_sleep 1
s_branch sp_loop_146
sp_bad_148:
s_mov_b32 s98, 1029
s_branch L_fail
sp_ok_147:
ds_write_b32 v18, v33
s_waitcnt lgkmcnt(0)
sp_ok_147_j:
s_barrier
ds_read_b32 v33, v32
s_waitcnt lgkmcnt(0)
s_mov_b32 s91, 1879048192
v_cmp_gt_u32 vcc, s52, v33
v_cmp_gt_u32 s[58:59], s54, v33
s_and_b32 vcc_lo, vcc_lo, s56
s_cselect_b32 s70, 0, 1
s_and_b32 s59, s59, s56
s_cselect_b32 s71, 0, 1
s_or_b32 s76, s70, s71
s_cselect_b32 s10, 268435456, 0
s_cmp_lg_u32 s70, 0
s_cselect_b64 s[72:73], s[52:53], s[54:55]
s_cselect_b64 s[58:59], s[44:45], s[46:47]
s_mul_i32 s74, s72, s20
s_add_u32 s74, s74, s58
s_mul_i32 s75, s72, s21
s_add_u32 s75, s75, s59
s_andn2_b32 s71, s71, s70
s_add_u32 s52, s52, s70
s_add_u32 s54, s54, s71
s_mov_b32 s77, s76
g_go_145:
s_add_u32 m0, s48, 0
s_nop 0
buffer_load_dwordx4 v8, s[4:7], s74 offen offset:0 sc1 lds
buffer_load_dwordx4 v9, s[4:7], s74 offen offset:1024 sc1 lds
buffer_load_dwordx4 v10, s[4:7], s74 offen offset:2048 sc1 lds
buffer_load_dwordx4 v11, s[4:7], s74 offen offset:3072 sc1 lds
s_add_u32 m0, s48, 4096
s_nop 0
buffer_load_dwordx4 v12, s[4:7], s74 offen offset:0 sc1 lds
buffer_load_dwordx4 v13, s[4:7], s74 offen offset:1024 sc1 lds
buffer_load_dwordx4 v14, s[4:7], s74 offen offset:2048 sc1 lds
buffer_load_dwordx4 v15, s[4:7], s74 offen offset:3072 sc1 lds
buffer_load_dword v24, v22, s[4:7], 0 offen sc1
buffer_store_dword v27, v34, s[4:7], 0 offen
v_mov_b32 v27, s90
s_waitcnt vmcnt(8)
s_barrier
buffer_store_dword v27, v45, s[4:7], s91 offen
buffer_store_dword v27, v44, s[4:7], s91 offen sc1
s_mov_b32 s91, 1879048192
ds_read_b128 v[64:67], v28 offset:0
ds_read_b128 v[68:71], v28 offset:8192
ds_read_b128 v[72:75], v28 offset:16384
ds_read_b128 v[76:79], v28 offset:24576
ds_read_b128 v[80:83], v28 offset:1024
ds_read_b128 v[84:87], v28 offset:9216
ds_read_b128 v[88:91], v28 offset:17408
ds_read_b128 v[92:95], v28 offset:25600
s_waitcnt vmcnt(7)
s_barrier
s_branch g_body_117
g_fin_121:
buffer_store_dword v27, v45, s[4:7], s91 offen
buffer_store_dword v27, v44, s[4:7], s91 offen sc1
s_endpgm
H_up:
s_mov_b32 s8, s32
s_and_b32 s9, s33, 0xffff
s_mov_b32 s10, 5308416
s_mov_b32 s11, 0x20000
s_mov_b32 s12, s34
s_and_b32 s13, s35, 0xffff
s_mov_b32 s14, 5308416
s_mov_b32 s15, 0x20000
s_mul_i32 s75, s74, 192
s_lshl_b32 s76, s3, 5
s_add_u32 s48, s75, s76
s_mov_b32 s49, s48
s_lshr_b32 s77, s3, 1
s_lshl_b32 s76, s77, 5
s_add_u32 s76, s76, s75
s_add_u32 s50, s76, 128
s_mov_b32 s51, s50
s_mul_i32 s75, s74, 6144
v_lshrrev_b32 v1, 5, v0
v_lshlrev_b32 v1, 10, v1
v_and_b32 v2, 15, v0
v_lshl_add_u32 v1, v2, 4, v1
v_bfe_u32 v2, v0, 4, 1
v_lshl_add_u32 v1, v2, 3, v1
s_lshl_b32 s76, s3, 8
s_add_u32 s76, s76, s75
s_add_u32 s76, s76, 4096
v_add_u32 v19, s76, v1
v_bfe_u32 v1, v0, 4, 1
v_lshlrev_b32 v1, 10, v1
v_lshrrev_b32 v2, 5, v0
v_lshl_add_u32 v1, v2, 8, v1
v_and_b32 v2, 15, v0
v_lshl_add_u32 v5, v2, 4, v1
s_lshl_b32 s76, s77, 11
s_add_u32 s76, s76, s75
s_and_b32 s77, s3, 1
s_lshl_b32 s77, s77, 9
s_add_u32 s76, s76, s77
v_add_u32 v20, s76, v5
s_cmp_lg_u32 s3, 0
s_cbranch_scc1 wp_ok_150
s_mov_b32 s16, s40
s_and_b32 s17, s41, 0xffff
s_mov_b32 s18, 256
s_mov_b32 s19, 0x20000
v_mov_b32 v1, 224
s_mov_b32 s98, 0
s_mov_b64 exec, 1
wp_loop_149:
buffer_load_dword v2, v1, s[16:19], 0 offen sc1
s_add_u32 s98, s98, 1
s_cmp_gt_u32 s98, 150000
s_cbranch_scc1 wp_bad_151
s_waitcnt vmcnt(0)
v_readfirstlane_b32 s97, v2
s_nop 0
s_cmp_ge_u32 s97, 32
s_cbranch_scc1 wp_ok_150
s_sleep 8
s_branch wp_loop_149
wp_bad_151:
s_mov_b32 s98, 513
s_branch L_fail
wp_ok_150:
s_mov_b64 exec, -1
s_barrier
v_lshrrev_b32 v1, 5, v0
v_bfe_u32 v2, v0, 3, 1
v_lshl_add_u32 v1, v1, 1, v2
v_bfe_u32 v2, v0, 4, 1
v_bfe_u32 v3, v0, 1, 2
v_lshlrev_b32 v1, 3, v1
v_lshl_add_u32 v1, v2, 2, v1
v_add_u32 v1, v1, v3
v_mul_u32_u24 v1, 9216, v1
v_and_b32 v2, 1, v0
v_lshl_add_u32 v63, v2, 4, v1
s_mul_i32 s70, s3, 40960
v_lshrrev_b32 v1, 5, v0
v_lshlrev_b32 v1, 9, v1
v_bfe_u32 v2, v0, 4, 1
v_lshl_add_u32 v1, v2, 7, v1
v_add_u32 v1, s70, v1
v_and_b32 v2, 15, v0
v_lshl_add_u32 v2, v2, 3, v1
v_mov_b32 v61, v2
v_add_u32 v62, 1024, v2
v_bfe_u32 v2, v0, 2, 2
v_lshl_add_u32 v1, v2, 5, v1
v_bfe_u32 v2, v0, 1, 1
v_lshl_add_u32 v1, v2, 10, v1
v_and_b32 v2, 1, v0
v_lshl_add_u32 v1, v2, 3, v1
s_and_b32 s71, s3, 1
s_lshl_b32 s71, s71, 4
s_add_u32 s71, s71, 2048
v_add_u32 v60, s71, v1
s_add_u32 m0, s70, 0
s_add_u32 s71, s48, 0
buffer_load_dwordx4 v63, s[8:11], s71 offen lds
s_add_u32 m0, s70, 1024
s_add_u32 s71, s49, 0
buffer_load_dwordx4 v63, s[12:15], s71 offen lds
s_add_u32 m0, s70, 2048
s_add_u32 s71, s50, 0
buffer_load_dwordx4 v63, s[8:11], s71 offen lds
s_add_u32 m0, s70, 3072
s_add_u32 s71, s51, 0
buffer_load_dwordx4 v63, s[12:15], s71 offen lds
s_add_u32 m0, s70, 4096
s_add_u32 s71, s48, 294912
buffer_load_dwordx4 v63, s[8:11], s71 offen lds
s_add_u32 m0, s70, 5120
s_add_u32 s71, s49, 294912
buffer_load_dwordx4 v63, s[12:15], s71 offen lds
s_add_u32 m0, s70, 6144
s_add_u32 s71, s50, 294912
buffer_load_dwordx4 v63, s[8:11], s71 offen lds
s_add_u32 m0, s70, 7168
s_add_u32 s71, s51, 294912
buffer_load_dwordx4 v63, s[12:15], s71 offen lds
s_add_u32 m0, s70, 8192
s_add_u32 s71, s48, 589824
buffer_load_dwordx4 v63, s[8:11], s71 offen lds
s_add_u32 m0, s70, 9216
s_add_u32 s71, s49, 589824
buffer_load_dwordx4 v63, s[12:15], s71 offen lds
s_add_u32 m0, s70, 10240
s_add_u32 s71, s50, 589824
buffer_load_dwordx4 v63, s[8:11], s71 offen lds
s_add_u32 m0, s70, 11264
s_add_u32 s71, s51, 589824
buffer_load_dwordx4 v63, s[12:15], s71 offen lds
s_add_u32 m0, s70, 12288
s_add_u32 s71, s48, 884736
buffer_load_dwordx4 v63, s[8:11], s71 offen lds
s_add_u32 m0, s70, 13312
s_add_u32 s71, s49, 884736
buffer_load_dwordx4 v63, s[12:15], s71 offen lds
s_add_u32 m0, s70, 14336
s_add_u32 s71, s50, 884736
buffer_load_dwordx4 v63, s[8:11], s71 offen lds
s_add_u32 m0, s70, 15360
s_add_u32 s71, s51, 884736
buffer_load_dwordx4 v63, s[12:15], s71 offen lds
s_add_u32 m0, s70, 16384
s_add_u32 s71, s48, 1179648
buffer_load_dwordx4 v63, s[8:11], s71 offen lds
s_add_u32 m0, s70, 17408
s_add_u32 s71, s49, 1179648
buffer_load_dwordx4 v63, s[12:15], s71 offen lds
s_add_u32 m0, s70, 18432
s_add_u32 s71, s50, 1179648
buffer_load_dwordx4 v63, s[8:11], s71 offen lds
s_add_u32 m0, s70, 19456
s_add_u32 s71, s51, 1179648
buffer_load_dwordx4 v63, s[12:15], s71 offen lds
s_add_u32 m0, s70, 20480
s_add_u32 s71, s48, 1474560
buffer_load_dwordx4 v63, s[8:11], s71 offen lds
s_add_u32 m0, s70, 21504
s_add_u32 s71, s49, 1474560
buffer_load_dwordx4 v63, s[12:15], s71 offen lds
s_add_u32 m0, s70, 22528
s_add_u32 s71, s50, 1474560
buffer_load_dwordx4 v63, s[8:11], s71 offen lds
s_add_u32 m0, s70, 23552
s_add_u32 s71, s51, 1474560
buffer_load_dwordx4 v63, s[12:15], s71 offen lds
s_add_u32 m0, s70, 24576
s_add_u32 s71, s48, 1769472
buffer_load_dwordx4 v63, s[8:11], s71 offen lds
s_add_u32 m0, s70, 25600
s_add_u32 s71, s49, 1769472
buffer_load_dwordx4 v63, s[12:15], s71 offen lds
s_add_u32 m0, s70, 26624
s_add_u32 s71, s50, 1769472
buffer_load_dwordx4 v63, s[8:11], s71 offen lds
s_add_u32 m0, s70, 27648
s_add_u32 s71, s51, 1769472
buffer_load_dwordx4 v63, s[12:15], s71 offen lds
s_add_u32 m0, s70, 28672
s_add_u32 s71, s48, 2064384
buffer_load_dwordx4 v63, s[8:11], s71 offen lds
s_add_u32 m0, s70, 29696
s_add_u32 s71, s49, 2064384
buffer_load_dwordx4 v63, s[12:15], s71 offen lds
s_add_u32 m0, s70, 30720
s_add_u32 s71, s50, 2064384
buffer_load_dwordx4 v63, s[8:11], s71 offen lds
s_add_u32 m0, s70, 31744
s_add_u32 s71, s51, 2064384
buffer_load_dwordx4 v63, s[12:15], s71 offen lds
s_add_u32 m0, s70, 32768
s_add_u32 s71, s48, 2359296
buffer_load_dwordx4 v63, s[8:11], s71 offen lds
s_add_u32 m0, s70, 33792
s_add_u32 s71, s49, 2359296
buffer_load_dwordx4 v63, s[12:15], s71 offen lds
s_add_u32 m0, s70, 34816
s_add_u32 s71, s50, 2359296
buffer_load_dwordx4 v63, s[8:11], s71 offen lds
s_add_u32 m0, s70, 35840
s_add_u32 s71, s51, 2359296
buffer_load_dwordx4 v63, s[12:15], s71 offen lds
s_add_u32 m0, s70, 36864
s_add_u32 s71, s48, 2654208
buffer_load_dwordx4 v63, s[8:11], s71 offen lds
s_add_u32 m0, s70, 37888
s_add_u32 s71, s49, 2654208
buffer_load_dwordx4 v63, s[12:15], s71 offen lds
s_add_u32 m0, s70, 38912
s_add_u32 s71, s50, 2654208
buffer_load_dwordx4 v63, s[8:11], s71 offen lds
s_add_u32 m0, s70, 39936
s_add_u32 s71, s51, 2654208
buffer_load_dwordx4 v63, s[12:15], s71 offen lds
s_waitcnt vmcnt(36)
ds_read_b64_tr_b16 a[0:1], v60 offset:0
ds_read_b64_tr_b16 a[2:3], v60 offset:256
ds_read_b64_tr_b16 a[72:73], v61 offset:0
ds_read_b64_tr_b16 a[74:75], v61 offset:256
ds_read_b64_tr_b16 a[144:145], v62 offset:0
ds_read_b64_tr_b16 a[146:147], v62 offset:256
s_waitcnt lgkmcnt(0)
s_add_u32 m0, s70, 0
s_add_u32 s71, s48, 2949120
buffer_load_dwordx4 v63, s[8:11], s71 offen lds
s_add_u32 m0, s70, 1024
s_add_u32 s71, s49, 2949120
buffer_load_dwordx4 v63, s[12:15], s71 offen lds
s_add_u32 m0, s70, 2048
s_add_u32 s71, s50, 2949120
buffer_load_dwordx4 v63, s[8:11], s71 offen lds
s_add_u32 m0, s70, 3072
s_add_u32 s71, s51, 2949120
buffer_load_dwordx4 v63, s[12:15], s71 offen lds
s_waitcnt vmcnt(36)
ds_read_b64_tr_b16 a[4:5], v60 offset:4096
ds_read_b64_tr_b16 a[6:7], v60 offset:4352
ds_read_b64_tr_b16 a[76:77], v61 offset:4096
ds_read_b64_tr_b16 a[78:79], v61 offset:4352
ds_read_b64_tr_b16 a[148:149], v62 offset:4096
ds_read_b64_tr_b16 a[150:151], v62 offset:4352
s_waitcnt lgkmcnt(0)
s_add_u32 m0, s70, 4096
s_add_u32 s71, s48, 3244032
buffer_load_dwordx4 v63, s[8:11], s71 offen lds
s_add_u32 m0, s70, 5120
s_add_u32 s71, s49, 3244032
buffer_load_dwordx4 v63, s[12:15], s71 offen lds
s_add_u32 m0, s70, 6144
s_add_u32 s71, s50, 3244032
buffer_load_dwordx4 v63, s[8:11], s71 offen lds
s_add_u32 m0, s70, 7168
s_add_u32 s71, s51, 3244032
buffer_load_dwordx4 v63, s[12:15], s71 offen lds
s_waitcnt vmcnt(36)
ds_read_b64_tr_b16 a[8:9], v60 offset:8192
ds_read_b64_tr_b16 a[10:11], v60 offset:8448
ds_read_b64_tr_b16 a[80:81], v61 offset:8192
ds_read_b64_tr_b16 a[82:83], v61 offset:8448
ds_read_b64_tr_b16 a[152:153], v62 offset:8192
ds_read_b64_tr_b16 a[154:155], v62 offset:8448
s_waitcnt lgkmcnt(0)
s_add_u32 m0, s70, 8192
s_add_u32 s71, s48, 3538944
buffer_load_dwordx4 v63, s[8:11], s71 offen lds
s_add_u32 m0, s70, 9216
s_add_u32 s71, s49, 3538944
buffer_load_dwordx4 v63, s[12:15], s71 offen lds
s_add_u32 m0, s70, 10240
s_add_u32 s71, s50, 3538944
buffer_load_dwordx4 v63, s[8:11], s71 offen lds
s_add_u32 m0, s70, 11264
s_add_u32 s71, s51, 3538944
buffer_load_dwordx4 v63, s[12:15], s71 offen lds
s_waitcnt vmcnt(36)
ds_read_b64_tr_b16 a[12:13], v60 offset:12288
ds_read_b64_tr_b16 a[14:15], v60 offset:12544
ds_read_b64_tr_b16 a[84:85], v61 offset:12288
ds_read_b64_tr_b16 a[86:87], v61 offset:12544
ds_read_b64_tr_b16 a[156:157], v62 offset:12288
ds_read_b64_tr_b16 a[158:159], v62 offset:12544
s_waitcnt lgkmcnt(0)
s_add_u32 m0, s70, 12288
s_add_u32 s71, s48, 3833856
buffer_load_dwordx4 v63, s[8:11], s71 offen lds
s_add_u32 m0, s70, 13312
s_add_u32 s71, s49, 3833856
buffer_load_dwordx4 v63, s[12:15], s71 offen lds
s_add_u32 m0, s70, 14336
s_add_u32 s71, s50, 3833856
buffer_load_dwordx4 v63, s[8:11], s71 offen lds
s_add_u32 m0, s70, 15360
s_add_u32 s71, s51, 3833856
buffer_load_dwordx4 v63, s[12:15], s71 offen lds
s_waitcnt vmcnt(36)
ds_read_b64_tr_b16 a[16:17], v60 offset:16384
ds_read_b64_tr_b16 a[18:19], v60 offset:16640
ds_read_b64_tr_b16 a[88:89], v61 offset:16384
ds_read_b64_tr_b16 a[90:91], v61 offset:16640
ds_read_b64_tr_b16 a[160:161], v62 offset:16384
ds_read_b64_tr_b16 a[162:163], v62 offset:16640
s_waitcnt lgkmcnt(0)
s_add_u32 m0, s70, 16384
s_add_u32 s71, s48, 4128768
buffer_load_dwordx4 v63, s[8:11], s71 offen lds
s_add_u32 m0, s70, 17408
s_add_u32 s71, s49, 4128768
buffer_load_dwordx4 v63, s[12:15], s71 offen lds
s_add_u32 m0, s70, 18432
s_add_u32 s71, s50, 4128768
buffer_load_dwordx4 v63, s[8:11], s71 offen lds
s_add_u32 m0, s70, 19456
s_add_u32 s71, s51, 4128768
buffer_load_dwordx4 v63, s[12:15], s71 offen lds
s_waitcnt vmcnt(36)
ds_read_b64_tr_b16 a[20:21], v60 offset:20480
ds_read_b64_tr_b16 a[22:23], v60 offset:20736
ds_read_b64_tr_b16 a[92:93], v61 offset:20480
ds_read_b64_tr_b16 a[94:95], v61 offset:20736
ds_read_b64_tr_b16 a[164:165], v62 offset:20480
ds_read_b64_tr_b16 a[166:167], v62 offset:20736
s_waitcnt lgkmcnt(0)
s_add_u32 m0, s70, 20480
s_add_u32 s71, s48, 4423680
buffer_load_dwordx4 v63, s[8:11], s71 offen lds
s_add_u32 m0, s70, 21504
s_add_u32 s71, s49, 4423680
buffer_load_dwordx4 v63, s[12:15], s71 offen lds
s_add_u32 m0, s70, 22528
s_add_u32 s71, s50, 4423680
buffer_load_dwordx4 v63, s[8:11], s71 offen lds
s_add_u32 m0, s70, 23552
s_add_u32 s71, s51, 4423680
buffer_load_dwordx4 v63, s[12:15], s71 offen lds
s_waitcnt vmcnt(36)
ds_read_b64_tr_b16 a[24:25], v60 offset:24576
ds_read_b64_tr_b16 a[26:27], v60 offset:24832
ds_read_b64_tr_b16 a[96:97], v61 offset:24576
ds_read_b64_tr_b16 a[98:99], v61 offset:24832
ds_read_b64_tr_b16 a[168:169], v62 offset:24576
ds_read_b64_tr_b16 a[170:171], v62 offset:24832
s_waitcnt lgkmcnt(0)
s_add_u32 m0, s70, 24576
s_add_u32 s71, s48, 4718592
buffer_load_dwordx4 v63, s[8:11], s71 offen lds
s_add_u32 m0, s70, 25600
s_add_u32 s71, s49, 4718592
buffer_load_dwordx4 v63, s[12:15], s71 offen lds
s_add_u32 m0, s70, 26624
s_add_u32 s71, s50, 4718592
buffer_load_dwordx4 v63, s[8:11], s71 offen lds
s_add_u32 m0, s70, 27648
s_add_u32 s71, s51, 4718592
buffer_load_dwordx4 v63, s[12:15], s71 offen lds
s_waitcnt vmcnt(36)
ds_read_b64_tr_b16 a[28:29], v60 offset:28672
ds_read_b64_tr_b16 a[30:31], v60 offset:28928
ds_read_b64_tr_b16 a[100:101], v61 offset:28672
ds_read_b64_tr_b16 a[102:103], v61 offset:28928
ds_read_b64_tr_b16 a[172:173], v62 offset:28672
ds_read_b64_tr_b16 a[174:175], v62 offset:28928
s_waitcnt lgkmcnt(0)
s_add_u32 m0, s70, 28672
s_add_u32 s71, s48, 5013504
buffer_load_dwordx4 v63, s[8:11], s71 offen lds
s_add_u32 m0, s70, 29696
s_add_u32 s71, s49, 5013504
buffer_load_dwordx4 v63, s[12:15], s71 offen lds
s_add_u32 m0, s70, 30720
s_add_u32 s71, s50, 5013504
buffer_load_dwordx4 v63, s[8:11], s71 offen lds
s_add_u32 m0, s70, 31744
s_add_u32 s71, s51, 5013504
buffer_load_dwordx4 v63, s[12:15], s71 offen lds
s_waitcnt vmcnt(36)
ds_read_b64_tr_b16 a[32:33], v60 offset:32768
ds_read_b64_tr_b16 a[34:35], v60 offset:33024
ds_read_b64_tr_b16 a[104:105], v61 offset:32768
ds_read_b64_tr_b16 a[106:107], v61 offset:33024
ds_read_b64_tr_b16 a[176:177], v62 offset:32768
ds_read_b64_tr_b16 a[178:179], v62 offset:33024
s_waitcnt vmcnt(32)
ds_read_b64_tr_b16 a[36:37], v60 offset:36864
ds_read_b64_tr_b16 a[38:39], v60 offset:37120
ds_read_b64_tr_b16 a[108:109], v61 offset:36864
ds_read_b64_tr_b16 a[110:111], v61 offset:37120
ds_read_b64_tr_b16 a[180:181], v62 offset:36864
ds_read_b64_tr_b16 a[182:183], v62 offset:37120
s_waitcnt vmcnt(28)
ds_read_b64_tr_b16 a[40:41], v60 offset:0
ds_read_b64_tr_b16 a[42:43], v60 offset:256
ds_read_b64_tr_b16 a[112:113], v61 offset:0
ds_read_b64_tr_b16 a[114:115], v61 offset:256
ds_read_b64_tr_b16 a[184:185], v62 offset:0
ds_read_b64_tr_b16 a[186:187], v62 offset:256
s_waitcnt vmcnt(24)
ds_read_b64_tr_b16 a[44:45], v60 offset:4096
ds_read_b64_tr_b16 a[46:47], v60 offset:4352
ds_read_b64_tr_b16 a[116:117], v61 offset:4096
ds_read_b64_tr_b16 a[118:119], v61 offset:4352
ds_read_b64_tr_b16 a[188:189], v62 offset:4096
ds_read_b64_tr_b16 a[190:191], v62 offset:4352
s_waitcnt vmcnt(20)
ds_read_b64_tr_b16 a[48:49], v60 offset:8192
ds_read_b64_tr_b16 a[50:51], v60 offset:8448
ds_read_b64_tr_b16 a[120:121], v61 offset:8192
ds_read_b64_tr_b16 a[122:123], v61 offset:8448
ds_read_b64_tr_b16 a[192:193], v62 offset:8192
ds_read_b64_tr_b16 a[194:195], v62 offset:8448
s_waitcnt vmcnt(16)
ds_read_b64_tr_b16 a[52:53], v60 offset:12288
ds_read_b64_tr_b16 a[54:55], v60 offset:12544
ds_read_b64_tr_b16 a[124:125], v61 offset:12288
ds_read_b64_tr_b16 a[126:127], v61 offset:12544
ds_read_b64_tr_b16 a[196:197], v62 offset:12288
ds_read_b64_tr_b16 a[198:199], v62 offset:12544
s_waitcnt vmcnt(12)
ds_read_b64_tr_b16 a[56:57], v60 offset:16384
ds_read_b64_tr_b16 a[58:59], v60 offset:16640
ds_read_b64_tr_b16 a[128:129], v61 offset:16384
ds_read_b64_tr_b16 a[130:131], v61 offset:16640
ds_read_b64_tr_b16 a[200:201], v62 offset:16384
ds_read_b64_tr_b16 a[202:203], v62 offset:16640
s_waitcnt vmcnt(8)
ds_read_b64_tr_b16 a[60:61], v60 offset:20480
ds_read_b64_tr_b16 a[62:63], v60 offset:20736
ds_read_b64_tr_b16 a[132:133], v61 offset:20480
ds_read_b64_tr_b16 a[134:135], v61 offset:20736
ds_read_b64_tr_b16 a[204:205], v62 offset:20480
ds_read_b64_tr_b16 a[206:207], v62 offset:20736
s_waitcnt vmcnt(4)
ds_read_b64_tr_b16 a[64:65], v60 offset:24576
ds_read_b64_tr_b16 a[66:67], v60 offset:24832
ds_read_b64_tr_b16 a[136:137], v61 offset:24576
ds_read_b64_tr_b16 a[138:139], v61 offset:24832
ds_read_b64_tr_b16 a[208:209], v62 offset:24576
ds_read_b64_tr_b16 a[210:211], v62 offset:24832
s_waitcnt vmcnt(0)
ds_read_b64_tr_b16 a[68:69], v60 offset:28672
ds_read_b64_tr_b16 a[70:71], v60 offset:28928
ds_read_b64_tr_b16 a[140:141], v61 offset:28672
ds_read_b64_tr_b16 a[142:143], v61 offset:28928
ds_read_b64_tr_b16 a[212:213], v62 offset:28672
ds_read_b64_tr_b16 a[214:215], v62 offset:28928
s_waitcnt lgkmcnt(0)
v_lshrrev_b32 v1, 3, v0
v_bfe_u32 v2, v0, 1, 2
v_lshrrev_b32 v3, 5, v0
v_lshlrev_b32 v3, 1, v3
v_xor_b32 v2, v2, v3
v_mul_u32_u24 v1, 2304, v1
v_lshl_add_u32 v1, v2, 5, v1
v_and_b32 v2, 1, v0
v_lshl_add_u32 v1, v2, 4, v1
s_and_b32 s70, s3, 1
s_mul_i32 s70, s70, 18432
s_lshr_b32 s71, s3, 1
s_lshl_b32 s71, s71, 7
s_add_u32 s70, s70, s71
v_add_u32 v1, s70, v1
v_add_u32 v8, 4096, v1
v_add_u32 v9, 3328, v1
v_add_u32 v10, 2560, v1
v_add_u32 v11, 1792, v1
v_add_u32 v12, 5120, v1
v_add_u32 v13, 4352, v1
v_add_u32 v14, 3584, v1
v_add_u32 v15, 2816, v1
v_add_u32 v16, 6144, v1
v_bfe_u32 v1, v0, 1, 3
v_lshlrev_b32 v1, 7, v1
v_lshrrev_b32 v2, 4, v0
v_bfe_u32 v3, v0, 3, 1
v_lshlrev_b32 v3, 1, v3
v_xor_b32 v2, v2, v3
v_lshl_add_u32 v1, v2, 5, v1
v_and_b32 v2, 1, v0
v_lshl_add_u32 v17, v2, 4, v1
v_and_b32 v2, 31, v0
v_add_u32 v1, 0, v2
v_mul_u32_u24 v1, 128, v1
v_lshrrev_b32 v3, 5, v0
v_mul_u32_u24 v3, 32768, v3
v_add_u32 v1, 21504, v1
v_add_u32 v1, v1, v3
v_mov_b32 v3, 2147483632
s_cmp_eq_u32 s3, 0
s_cselect_b32 s71, 16, 0
v_cmp_gt_u32 vcc, s71, v2
s_nop 1
v_cndmask_b32 v22, v3, v1, vcc
s_mov_b32 s56, 0xffff
s_mul_i32 s70, s74, 128
s_add_u32 s70, s70, 23552
v_mov_b32 v1, s70
s_min_u32 s71, s71, 1
v_cmp_gt_u32 vcc, s71, v0
s_nop 1
v_cndmask_b32 v44, v3, v1, vcc
v_add_u32 v45, 65536, v44
s_getpc_b64 s[96:97]
pc_152:
s_add_u32 s96, s96, L_writers-pc_152
s_addc_u32 s97, s97, 0
v_subrev_u32 v23, 0, v22
v_lshrrev_b32 v23, 7, v23
v_cmp_gt_u32 vcc, 0x200, v23
s_nop 1
v_cndmask_b32 v23, 0, v23, vcc
global_load_ubyte v23, v23, s[96:97]
s_mov_b32 s44, 6062080
s_mov_b32 s45, 161521664
s_mov_b32 s52, 1
s_mov_b32 s53, 0
s_mov_b32 s46, 8421376
s_mov_b32 s47, 180396032
s_mov_b32 s54, 1
s_mov_b32 s55, 32768
s_mov_b32 s25, 200
s_mov_b32 s20, 36864
s_mov_b32 s21, 294912
s_mov_b32 s8, s42
s_and_b32 s9, s43, 0xffff
s_mov_b32 s10, 0
s_mov_b32 s11, 0x20000
s_mov_b32 s22, 0
s_mul_i32 s48, s3, 9216
s_add_u32 s49, s48, 36864
s_add_u32 s50, s48, 73728
s_add_u32 s51, s48, 110592
s_mov_b32 s57, 0xbfb8aa3b
v_add_u32 v28, 0, v17
v_add_u32 v29, 36864, v17
v_add_u32 v30, 73728, v17
v_add_u32 v31, 110592, v17
v_lshlrev_b32 v1, 2, v0
v_add_u32 v32, 147456, v1
s_lshl_b32 s70, s3, 8
v_add_u32 v18, s70, v32
v_mov_b64 v[224:225], 0
v_mov_b64 v[236:237], 0
v_mov_b64 v[226:227], 0
v_mov_b64 v[238:239], 0
v_mov_b64 v[228:229], 0
v_mov_b64 v[240:241], 0
v_mov_b64 v[230:231], 0
v_mov_b64 v[242:243], 0
s_mov_b32 s12, s40
s_and_b32 s13, s41, 0xffff
s_mov_b32 s14, 256
s_mov_b32 s15, 0x20000
v_lshlrev_b32 v26, 2, v0
v_add_u32 v27, 128, v26
v_cmp_le_u32 vcc, 2, v0
s_nop 1
v_cndmask_b32 v26, v26, v27, vcc
v_mov_b32 v27, 192
v_cmp_eq_u32 vcc, 8, v0
s_nop 1
v_cndmask_b32 v26, v26, v27, vcc
v_mov_b32 v27, 2147483632
v_cmp_lt_u32 vcc, 8, v0
s_nop 1
v_cndmask_b32 v26, v26, v27, vcc
s_mov_b32 s98, 0
wi_loop_158:
buffer_load_dword v27, v26, s[12:15], 0 offen sc1
s_add_u32 s98, s98, 1
s_cmp_gt_u32 s98, 150000
s_cbranch_scc1 wi_bad_160
s_waitcnt vmcnt(0)
v_cmp_eq_u32 vcc, 32, v27
s_nop 0
s_and_b32 s97, vcc_lo, 0x1ff
s_cmp_eq_u32 s97, 0x1ff
s_cbranch_scc1 wi_ok_159
v_cmp_lt_u32 vcc, 32, v27
s_nop 0
s_and_b32 s96, vcc_lo, 0xff
s_cselect_b32 s96, 0x100, 0
s_and_b32 s96, s96, s97
s_cbranch_scc1 wi_over_161
s_sleep 8
s_branch wi_loop_158
wi_bad_160:
s_mov_b32 s98, 512
s_branch L_fail
wi_over_161:
s_mov_b32 s100, 255
wi_ok_159:
v_add_u32 v26, 65536, v22
v_cmp_eq_u32 vcc, s100, v23
s_nop 1
v_cndmask_b32 v22, v22, v26, vcc
v_mov_b32 v26, 2147483632
s_cmp_lg_u32 s100, 255
s_cselect_b64 vcc, -1, 0
v_cndmask_b32 v44, v44, v26, vcc
s_cselect_b32 s38, 1, 0
s_mov_b32 s90, 0
s_mov_b32 s91, 1879048192
s_mov_b32 s93, 1879048192
v_mov_b32 v34, 2147483632
s_barrier
s_mov_b32 s95, 1
s_cmp_lg_u32 s3, 0
s_cbranch_scc1 sp_ok_163_j
s_mov_b32 s23, 0
sp_loop_162:
buffer_load_dword v33, v22, s[4:7], 0 offen sc1
s_add_u32 s23, s23, 1
s_cmp_gt_u32 s23, 150000
s_cbranch_scc1 sp_bad_164
s_waitcnt vmcnt(0)
sp_loop_162_e:
v_cmp_gt_u32 vcc, s52, v33
v_cmp_gt_u32 s[58:59], s54, v33
s_and_b32 vcc_lo, vcc_lo, s56
s_cbranch_scc0 sp_ok_163
s_cmp_gt_u32 s23, 4
s_cselect_b32 s70, 0, s56
s_cmp_lg_u32 s95, 0
s_cselect_b32 s70, 0, s70
s_or_b32 s59, s59, s70
s_and_b32 s59, s59, s56
s_cbranch_scc0 sp_ok_163
s_sleep 1
s_branch sp_loop_162
sp_bad_164:
s_mov_b32 s98, 1028
s_branch L_fail
sp_ok_163:
ds_write_b32 v18, v33
s_waitcnt lgkmcnt(0)
sp_ok_163_j:
s_barrier
ds_read_b32 v33, v32
s_waitcnt lgkmcnt(0)
v_cmp_gt_u32 vcc, s52, v33
v_cmp_gt_u32 s[58:59], s54, v33
s_and_b32 vcc_lo, vcc_lo, s56
s_cselect_b32 s70, 0, 1
s_and_b32 s59, s59, s56
s_cselect_b32 s71, 0, 1
s_or_b32 s76, s70, s71
s_cselect_b32 s10, 268435456, 0
s_cmp_lg_u32 s70, 0
s_cselect_b64 s[72:73], s[52:53], s[54:55]
s_cselect_b64 s[58:59], s[44:45], s[46:47]
s_mul_i32 s74, s72, s20
s_add_u32 s74, s74, s58
s_mul_i32 s75, s72, s21
s_add_u32 s75, s75, s59
s_andn2_b32 s71, s71, s70
s_add_u32 s52, s52, s70
s_add_u32 s54, s54, s71
s_mov_b32 s77, s76
s_add_u32 m0, s48, 0
s_nop 0
buffer_load_dwordx4 v8, s[4:7], s74 offen offset:0 sc1 lds
buffer_load_dwordx4 v9, s[4:7], s74 offen offset:1024 sc1 lds
buffer_load_dwordx4 v10, s[4:7], s74 offen offset:2048 sc1 lds
buffer_load_dwordx4 v11, s[4:7], s74 offen offset:3072 sc1 lds
s_add_u32 m0, s48, 4096
s_nop 0
buffer_load_dwordx4 v12, s[4:7], s74 offen offset:0 sc1 lds
buffer_load_dwordx4 v13, s[4:7], s74 offen offset:1024 sc1 lds
buffer_load_dwordx4 v14, s[4:7], s74 offen offset:2048 sc1 lds
buffer_load_dwordx4 v15, s[4:7], s74 offen offset:3072 sc1 lds
s_add_u32 m0, s48, 8192
s_nop 0
buffer_load_dwordx4 v16, s[4:7], s74 offen offset:0 sc1 lds
buffer_load_dword v24, v22, s[4:7], 0 offen sc1
buffer_store_dword v27, v34, s[4:7], 0 offen
v_mov_b32 v27, s90
s_waitcnt vmcnt(9)
s_barrier
buffer_store_dword v27, v45, s[4:7], s91 offen
buffer_store_dword v27, v44, s[4:7], s91 offen sc1
s_mov_b32 s91, 1879048192
ds_read_b128 v[64:67], v28 offset:0
ds_read_b128 v[68:71], v28 offset:9216
ds_read_b128 v[72:75], v28 offset:18432
ds_read_b128 v[76:79], v28 offset:27648
ds_read_b128 v[80:83], v28 offset:1024
ds_read_b128 v[84:87], v28 offset:10240
ds_read_b128 v[88:91], v28 offset:19456
ds_read_b128 v[92:95], v28 offset:28672
s_waitcnt vmcnt(8)
s_barrier
s_branch g_body_153
g_body_153:
s_waitcnt lgkmcnt(4)
v_mfma_f32_16x16x32_bf16 v[208:211], a[0:3], v[64:67], 0
ds_read_b128 v[96:99], v28 offset:2048
v_mfma_f32_16x16x32_bf16 v[212:215], a[0:3], v[68:71], 0
ds_read_b128 v[100:103], v28 offset:11264
v_mfma_f32_16x16x32_bf16 v[208:211], a[4:7], v[72:75], v[208:211]
ds_read_b128 v[104:107], v28 offset:20480
v_mfma_f32_16x16x32_bf16 v[212:215], a[4:7], v[76:79], v[212:215]
ds_read_b128 v[108:111], v28 offset:29696
v_mul_f32 v224, v224, v236
v_mul_f32 v225, v225, v237
v_mul_f32 v226, v226, v238
v_mul_f32 v227, v227, v239
v_mul_f32 v228, v228, v240
v_mfma_f32_16x16x32_bf16 v[216:219], a[72:75], v[64:67], 0
v_mul_f32 v229, v229, v241
s_waitcnt lgkmcnt(4)
v_mfma_f32_16x16x32_bf16 v[208:211], a[8:11], v[80:83], v[208:211]
ds_read_b128 v[112:115], v28 offset:3072
v_mul_f32 v230, v230, v242
v_mfma_f32_16x16x32_bf16 v[212:215], a[8:11], v[84:87], v[212:215]
ds_read_b128 v[116:119], v28 offset:12288
v_mul_f32 v231, v231, v243
v_mfma_f32_16x16x32_bf16 v[208:211], a[12:15], v[88:91], v[208:211]
ds_read_b128 v[120:123], v28 offset:21504
v_cvt_pk_bf16_f32 v52, v224, v225
v_mfma_f32_16x16x32_bf16 v[212:215], a[12:15], v[92:95], v[212:215]
ds_read_b128 v[124:127], v28 offset:30720
v_cvt_pk_bf16_f32 v53, v226, v227
v_mfma_f32_16x16x32_bf16 v[220:223], a[72:75], v[68:71], 0
v_cvt_pk_bf16_f32 v54, v228, v229
s_waitcnt lgkmcnt(4)
v_mfma_f32_16x16x32_bf16 v[208:211], a[16:19], v[96:99], v[208:211]
ds_read_b128 v[128:131], v28 offset:4096
v_cvt_pk_bf16_f32 v55, v230, v231
v_mfma_f32_16x16x32_bf16 v[212:215], a[16:19], v[100:103], v[212:215]
ds_read_b128 v[132:135], v28 offset:13312
v_permlane16_swap_b32 v52, v54
v_mfma_f32_16x16x32_bf16 v[208:211], a[20:23], v[104:107], v[208:211]
ds_read_b128 v[136:139], v28 offset:22528
v_permlane16_swap_b32 v53, v55
v_mfma_f32_16x16x32_bf16 v[212:215], a[20:23], v[108:111], v[212:215]
ds_read_b128 v[140:143], v28 offset:31744
buffer_store_dwordx4 v[52:55], v20, s[4:7], s93 offen sc1
v_mfma_f32_16x16x32_bf16 v[216:219], a[76:79], v[72:75], v[216:219]
s_waitcnt vmcnt(5)
s_barrier
s_waitcnt lgkmcnt(4)
v_mfma_f32_16x16x32_bf16 v[208:211], a[24:27], v[112:115], v[208:211]
ds_read_b128 v[144:147], v28 offset:5120
v_mov_b32 v27, s90
v_mfma_f32_16x16x32_bf16 v[212:215], a[24:27], v[116:119], v[212:215]
ds_read_b128 v[148:151], v28 offset:14336
v_mfma_f32_16x16x32_bf16 v[208:211], a[28:31], v[120:123], v[208:211]
ds_read_b128 v[152:155], v28 offset:23552
v_mfma_f32_16x16x32_bf16 v[212:215], a[28:31], v[124:127], v[212:215]
ds_read_b128 v[156:159], v28 offset:32768
v_mfma_f32_16x16x32_bf16 v[220:223], a[76:79], v[76:79], v[220:223]
s_waitcnt lgkmcnt(4)
v_mfma_f32_16x16x32_bf16 v[208:211], a[32:35], v[128:131], v[208:211]
ds_read_b128 v[160:163], v28 offset:6144
v_mfma_f32_16x16x32_bf16 v[212:215], a[32:35], v[132:135], v[212:215]
ds_read_b128 v[164:167], v28 offset:15360
v_mfma_f32_16x16x32_bf16 v[208:211], a[36:39], v[136:139], v[208:211]
ds_read_b128 v[168:171], v28 offset:24576
v_mfma_f32_16x16x32_bf16 v[212:215], a[36:39], v[140:143], v[212:215]
ds_read_b128 v[172:175], v28 offset:33792
v_mfma_f32_16x16x32_bf16 v[216:219], a[80:83], v[80:83], v[216:219]
s_waitcnt lgkmcnt(4)
v_mfma_f32_16x16x32_bf16 v[208:211], a[40:43], v[144:147], v[208:211]
ds_read_b128 v[176:179], v28 offset:7168
v_mfma_f32_16x16x32_bf16 v[212:215], a[40:43], v[148:151], v[212:215]
ds_read_b128 v[180:183], v28 offset:16384
v_mfma_f32_16x16x32_bf16 v[208:211], a[44:47], v[152:155], v[208:211]
ds_read_b128 v[184:187], v28 offset:25600
v_mfma_f32_16x16x32_bf16 v[212:215], a[44:47], v[156:159], v[212:215]
ds_read_b128 v[188:191], v28 offset:34816
v_mfma_f32_16x16x32_bf16 v[220:223], a[80:83], v[84:87], v[220:223]
s_waitcnt lgkmcnt(4)
v_mfma_f32_16x16x32_bf16 v[208:211], a[48:51], v[160:163], v[208:211]
ds_read_b128 v[192:195], v28 offset:8192
v_mfma_f32_16x16x32_bf16 v[212:215], a[48:51], v[164:167], v[212:215]
ds_read_b128 v[196:199], v28 offset:17408
s_waitcnt vmcnt(4)
ds_write_b32 v18, v24
v_mfma_f32_16x16x32_bf16 v[208:211], a[52:55], v[168:171], v[208:211]
ds_read_b128 v[200:203], v28 offset:26624
v_mfma_f32_16x16x32_bf16 v[212:215], a[52:55], v[172:175], v[212:215]
ds_read_b128 v[204:207], v28 offset:35840
v_mfma_f32_16x16x32_bf16 v[216:219], a[84:87], v[88:91], v[216:219]
s_waitcnt lgkmcnt(2)
s_barrier
v_mfma_f32_16x16x32_bf16 v[208:211], a[56:59], v[176:179], v[208:211]
ds_read_b32 v33, v32
v_mfma_f32_16x16x32_bf16 v[212:215], a[56:59], v[180:183], v[212:215]
v_mfma_f32_16x16x32_bf16 v[208:211], a[60:63], v[184:187], v[208:211]
v_mfma_f32_16x16x32_bf16 v[212:215], a[60:63], v[188:191], v[212:215]
s_waitcnt lgkmcnt(0)
v_cmp_gt_u32 vcc, s52, v33
v_mfma_f32_16x16x32_bf16 v[220:223], a[84:87], v[92:95], v[220:223]
v_cmp_gt_u32 s[58:59], s54, v33
v_mfma_f32_16x16x32_bf16 v[208:211], a[64:67], v[192:195], v[208:211]
s_and_b32 vcc_lo, vcc_lo, s56
s_cselect_b32 s70, 0, 1
v_mfma_f32_16x16x32_bf16 v[212:215], a[64:67], v[196:199], v[212:215]
s_and_b32 s59, s59, s56
s_cselect_b32 s71, 0, s77
v_mfma_f32_16x16x32_bf16 v[208:211], a[68:71], v[200:203], v[208:211]
s_or_b32 s82, s70, s71
s_cselect_b32 s10, 268435456, 0
v_mfma_f32_16x16x32_bf16 v[212:215], a[68:71], v[204:207], v[212:215]
s_cmp_lg_u32 s70, 0
s_cselect_b64 s[78:79], s[52:53], s[54:55]
s_cselect_b64 s[58:59], s[44:45], s[46:47]
v_mfma_f32_16x16x32_bf16 v[216:219], a[88:91], v[96:99], v[216:219]
s_mul_i32 s80, s78, s20
s_add_u32 s80, s80, s58
v_mfma_f32_16x16x32_bf16 v[220:223], a[88:91], v[100:103], v[220:223]
s_add_u32 m0, s49, 0
s_mul_i32 s81, s78, s21
s_add_u32 s81, s81, s59
v_mfma_f32_16x16x32_bf16 v[216:219], a[92:95], v[104:107], v[216:219]
buffer_load_dwordx4 v8, s[8:11], s80 offen offset:0 sc1 lds
v_mfma_f32_16x16x32_bf16 v[220:223], a[92:95], v[108:111], v[220:223]
s_andn2_b32 s71, s71, s70
s_add_u32 s52, s52, s70
s_add_u32 s54, s54, s71
v_mfma_f32_16x16x32_bf16 v[216:219], a[96:99], v[112:115], v[216:219]
s_mov_b32 s83, s82
v_mfma_f32_16x16x32_bf16 v[220:223], a[96:99], v[116:119], v[220:223]
buffer_load_dwordx4 v9, s[8:11], s80 offen offset:1024 sc1 lds
v_mfma_f32_16x16x32_bf16 v[216:219], a[100:103], v[120:123], v[216:219]
v_permlane32_swap_b32 v208, v212
v_mfma_f32_16x16x32_bf16 v[220:223], a[100:103], v[124:127], v[220:223]
v_permlane32_swap_b32 v209, v213
v_mfma_f32_16x16x32_bf16 v[216:219], a[104:107], v[128:131], v[216:219]
buffer_load_dwordx4 v10, s[8:11], s80 offen offset:2048 sc1 lds
v_mfma_f32_16x16x32_bf16 v[220:223], a[104:107], v[132:135], v[220:223]
v_permlane32_swap_b32 v210, v214
v_mfma_f32_16x16x32_bf16 v[216:219], a[108:111], v[136:139], v[216:219]
v_permlane32_swap_b32 v211, v215
v_mfma_f32_16x16x32_bf16 v[220:223], a[108:111], v[140:143], v[220:223]
buffer_load_dwordx4 v11, s[8:11], s80 offen offset:3072 sc1 lds
v_mfma_f32_16x16x32_bf16 v[216:219], a[112:115], v[144:147], v[216:219]
v_mul_f32 v232, s57, v208
v_mul_f32 v233, s57, v209
v_mfma_f32_16x16x32_bf16 v[220:223], a[112:115], v[148:151], v[220:223]
s_add_u32 m0, s49, 4096
v_mul_f32 v234, s57, v210
v_mfma_f32_16x16x32_bf16 v[216:219], a[116:119], v[152:155], v[216:219]
buffer_load_dwordx4 v12, s[8:11], s80 offen offset:0 sc1 lds
v_mfma_f32_16x16x32_bf16 v[220:223], a[116:119], v[156:159], v[220:223]
v_mul_f32 v235, s57, v211
v_mfma_f32_16x16x32_bf16 v[216:219], a[120:123], v[160:163], v[216:219]
v_exp_f32 v232, v232
v_mfma_f32_16x16x32_bf16 v[220:223], a[120:123], v[164:167], v[220:223]
buffer_load_dwordx4 v13, s[8:11], s80 offen offset:1024 sc1 lds
v_mfma_f32_16x16x32_bf16 v[216:219], a[124:127], v[168:171], v[216:219]
v_exp_f32 v233, v233
v_mfma_f32_16x16x32_bf16 v[220:223], a[124:127], v[172:175], v[220:223]
v_exp_f32 v234, v234
v_mfma_f32_16x16x32_bf16 v[216:219], a[128:131], v[176:179], v[216:219]
buffer_load_dwordx4 v14, s[8:11], s80 offen offset:2048 sc1 lds
v_mfma_f32_16x16x32_bf16 v[220:223], a[128:131], v[180:183], v[220:223]
v_exp_f32 v235, v235
v_mfma_f32_16x16x32_bf16 v[216:219], a[132:135], v[184:187], v[216:219]
v_add_f32 v232, 1.0, v232
v_add_f32 v233, 1.0, v233
v_mfma_f32_16x16x32_bf16 v[220:223], a[132:135], v[188:191], v[220:223]
buffer_load_dwordx4 v15, s[8:11], s80 offen offset:3072 sc1 lds
v_mfma_f32_16x16x32_bf16 v[216:219], a[136:139], v[192:195], v[216:219]
v_add_f32 v234, 1.0, v234
v_add_f32 v235, 1.0, v235
v_mfma_f32_16x16x32_bf16 v[220:223], a[136:139], v[196:199], v[220:223]
s_add_u32 m0, s49, 8192
v_mfma_f32_16x16x32_bf16 v[216:219], a[140:143], v[200:203], v[216:219]
buffer_load_dwordx4 v16, s[8:11], s80 offen offset:0 sc1 lds
v_mfma_f32_16x16x32_bf16 v[220:223], a[140:143], v[204:207], v[220:223]
v_rcp_f32 v232, v232
v_mfma_f32_16x16x32_bf16 v[224:227], a[144:147], v[64:67], 0
v_rcp_f32 v233, v233
v_mfma_f32_16x16x32_bf16 v[228:231], a[144:147], v[68:71], 0
v_rcp_f32 v234, v234
v_mfma_f32_16x16x32_bf16 v[224:227], a[148:151], v[72:75], v[224:227]
v_rcp_f32 v235, v235
v_mfma_f32_16x16x32_bf16 v[228:231], a[148:151], v[76:79], v[228:231]
v_mul_f32 v212, v208, v212
v_mul_f32 v213, v209, v213
v_mfma_f32_16x16x32_bf16 v[224:227], a[152:155], v[80:83], v[224:227]
buffer_load_dword v24, v22, s[4:7], 0 offen sc1
v_mfma_f32_16x16x32_bf16 v[228:231], a[152:155], v[84:87], v[228:231]
v_mul_f32 v214, v210, v214
v_mul_f32 v215, v211, v215
v_mul_f32 v236, s57, v216
v_mul_f32 v237, s57, v217
v_mul_f32 v238, s57, v218
v_mul_f32 v239, s57, v219
v_exp_f32 v236, v236
v_exp_f32 v237, v237
v_exp_f32 v238, v238
v_exp_f32 v239, v239
v_add_f32 v236, 1.0, v236
v_add_f32 v237, 1.0, v237
v_add_f32 v238, 1.0, v238
v_add_f32 v239, 1.0, v239
v_rcp_f32 v236, v236
v_rcp_f32 v237, v237
v_mfma_f32_16x16x32_bf16 v[224:227], a[156:159], v[88:91], v[224:227]
s_waitcnt vmcnt(10)
s_barrier
v_mfma_f32_16x16x32_bf16 v[228:231], a[156:159], v[92:95], v[228:231]
buffer_store_dword v27, v45, s[4:7], s91 offen
v_mfma_f32_16x16x32_bf16 v[224:227], a[160:163], v[96:99], v[224:227]
buffer_store_dword v27, v44, s[4:7], s91 offen sc1
v_mfma_f32_16x16x32_bf16 v[228:231], a[160:163], v[100:103], v[228:231]
v_mul_f32 v212, v212, v232
v_mul_f32 v213, v213, v233
v_mfma_f32_16x16x32_bf16 v[224:227], a[164:167], v[104:107], v[224:227]
v_mul_f32 v214, v214, v234
v_mul_f32 v215, v215, v235
v_mfma_f32_16x16x32_bf16 v[228:231], a[164:167], v[108:111], v[228:231]
v_cvt_pk_bf16_f32 v48, v212, v213
v_cvt_pk_bf16_f32 v49, v214, v215
v_mfma_f32_16x16x32_bf16 v[224:227], a[168:171], v[112:115], v[224:227]
buffer_store_dwordx2 v[48:49], v19, s[4:7], s75 offen sc1
v_mfma_f32_16x16x32_bf16 v[228:231], a[168:171], v[116:119], v[228:231]
v_rcp_f32 v238, v238
v_mfma_f32_16x16x32_bf16 v[224:227], a[172:175], v[120:123], v[224:227]
v_rcp_f32 v239, v239
v_mfma_f32_16x16x32_bf16 v[228:231], a[172:175], v[124:127], v[228:231]
v_mul_f32 v240, s57, v220
v_mul_f32 v241, s57, v221
v_mfma_f32_16x16x32_bf16 v[224:227], a[176:179], v[128:131], v[224:227]
v_mul_f32 v242, s57, v222
v_mul_f32 v243, s57, v223
v_mfma_f32_16x16x32_bf16 v[228:231], a[176:179], v[132:135], v[228:231]
v_mul_f32 v236, v216, v236
v_mul_f32 v237, v217, v237
v_mfma_f32_16x16x32_bf16 v[224:227], a[180:183], v[136:139], v[224:227]
v_mul_f32 v238, v218, v238
v_mul_f32 v239, v219, v239
v_mfma_f32_16x16x32_bf16 v[228:231], a[180:183], v[140:143], v[228:231]
v_exp_f32 v240, v240
v_mfma_f32_16x16x32_bf16 v[224:227], a[184:187], v[144:147], v[224:227]
v_exp_f32 v241, v241
v_mfma_f32_16x16x32_bf16 v[228:231], a[184:187], v[148:151], v[228:231]
v_exp_f32 v242, v242
v_mfma_f32_16x16x32_bf16 v[224:227], a[188:191], v[152:155], v[224:227]
v_exp_f32 v243, v243
v_mfma_f32_16x16x32_bf16 v[228:231], a[188:191], v[156:159], v[228:231]
v_add_f32 v240, 1.0, v240
v_add_f32 v241, 1.0, v241
v_mfma_f32_16x16x32_bf16 v[224:227], a[192:195], v[160:163], v[224:227]
s_waitcnt vmcnt(11)
s_barrier
v_mfma_f32_16x16x32_bf16 v[228:231], a[192:195], v[164:167], v[228:231]
v_add_f32 v242, 1.0, v242
v_add_f32 v243, 1.0, v243
v_mfma_f32_16x16x32_bf16 v[224:227], a[196:199], v[168:171], v[224:227]
s_cmp_eq_u32 s82, 0
s_cbranch_scc1 g_slow_165
v_mfma_f32_16x16x32_bf16 v[228:231], a[196:199], v[172:175], v[228:231]
v_rcp_f32 v240, v240
ds_read_b128 v[64:67], v29 offset:0
v_mfma_f32_16x16x32_bf16 v[224:227], a[200:203], v[176:179], v[224:227]
v_rcp_f32 v241, v241
ds_read_b128 v[68:71], v29 offset:9216
v_mfma_f32_16x16x32_bf16 v[228:231], a[200:203], v[180:183], v[228:231]
v_rcp_f32 v242, v242
ds_read_b128 v[72:75], v29 offset:18432
v_mfma_f32_16x16x32_bf16 v[224:227], a[204:207], v[184:187], v[224:227]
v_rcp_f32 v243, v243
ds_read_b128 v[76:79], v29 offset:27648
v_mfma_f32_16x16x32_bf16 v[228:231], a[204:207], v[188:191], v[228:231]
v_mul_f32 v240, v220, v240
ds_read_b128 v[80:83], v29 offset:1024
v_mfma_f32_16x16x32_bf16 v[224:227], a[208:211], v[192:195], v[224:227]
v_mul_f32 v241, v221, v241
ds_read_b128 v[84:87], v29 offset:10240
v_mfma_f32_16x16x32_bf16 v[228:231], a[208:211], v[196:199], v[228:231]
v_mul_f32 v242, v222, v242
ds_read_b128 v[88:91], v29 offset:19456
v_mfma_f32_16x16x32_bf16 v[224:227], a[212:215], v[200:203], v[224:227]
v_mul_f32 v243, v223, v243
ds_read_b128 v[92:95], v29 offset:28672
v_mfma_f32_16x16x32_bf16 v[228:231], a[212:215], v[204:207], v[228:231]
s_waitcnt vmcnt(8)
s_barrier
g_body_154:
s_waitcnt lgkmcnt(4)
v_mfma_f32_16x16x32_bf16 v[208:211], a[0:3], v[64:67], 0
ds_read_b128 v[96:99], v29 offset:2048
v_mfma_f32_16x16x32_bf16 v[212:215], a[0:3], v[68:71], 0
ds_read_b128 v[100:103], v29 offset:11264
v_mfma_f32_16x16x32_bf16 v[208:211], a[4:7], v[72:75], v[208:211]
ds_read_b128 v[104:107], v29 offset:20480
v_mfma_f32_16x16x32_bf16 v[212:215], a[4:7], v[76:79], v[212:215]
ds_read_b128 v[108:111], v29 offset:29696
v_mul_f32 v224, v224, v236
v_mul_f32 v225, v225, v237
v_mul_f32 v226, v226, v238
v_mul_f32 v227, v227, v239
v_mul_f32 v228, v228, v240
v_mfma_f32_16x16x32_bf16 v[216:219], a[72:75], v[64:67], 0
v_mul_f32 v229, v229, v241
s_waitcnt lgkmcnt(4)
v_mfma_f32_16x16x32_bf16 v[208:211], a[8:11], v[80:83], v[208:211]
ds_read_b128 v[112:115], v29 offset:3072
v_mul_f32 v230, v230, v242
v_mfma_f32_16x16x32_bf16 v[212:215], a[8:11], v[84:87], v[212:215]
ds_read_b128 v[116:119], v29 offset:12288
v_mul_f32 v231, v231, v243
v_mfma_f32_16x16x32_bf16 v[208:211], a[12:15], v[88:91], v[208:211]
ds_read_b128 v[120:123], v29 offset:21504
v_cvt_pk_bf16_f32 v52, v224, v225
v_mfma_f32_16x16x32_bf16 v[212:215], a[12:15], v[92:95], v[212:215]
ds_read_b128 v[124:127], v29 offset:30720
v_cvt_pk_bf16_f32 v53, v226, v227
v_mfma_f32_16x16x32_bf16 v[220:223], a[72:75], v[68:71], 0
v_cvt_pk_bf16_f32 v54, v228, v229
s_waitcnt lgkmcnt(4)
v_mfma_f32_16x16x32_bf16 v[208:211], a[16:19], v[96:99], v[208:211]
ds_read_b128 v[128:131], v29 offset:4096
v_cvt_pk_bf16_f32 v55, v230, v231
v_mfma_f32_16x16x32_bf16 v[212:215], a[16:19], v[100:103], v[212:215]
ds_read_b128 v[132:135], v29 offset:13312
v_permlane16_swap_b32 v52, v54
v_mfma_f32_16x16x32_bf16 v[208:211], a[20:23], v[104:107], v[208:211]
ds_read_b128 v[136:139], v29 offset:22528
v_permlane16_swap_b32 v53, v55
v_mfma_f32_16x16x32_bf16 v[212:215], a[20:23], v[108:111], v[212:215]
ds_read_b128 v[140:143], v29 offset:31744
buffer_store_dwordx4 v[52:55], v20, s[4:7], s75 offen sc1
v_mfma_f32_16x16x32_bf16 v[216:219], a[76:79], v[72:75], v[216:219]
s_waitcnt vmcnt(5)
s_barrier
s_waitcnt lgkmcnt(4)
v_mfma_f32_16x16x32_bf16 v[208:211], a[24:27], v[112:115], v[208:211]
ds_read_b128 v[144:147], v29 offset:5120
v_mov_b32 v27, s72
v_mfma_f32_16x16x32_bf16 v[212:215], a[24:27], v[116:119], v[212:215]
ds_read_b128 v[148:151], v29 offset:14336
v_mfma_f32_16x16x32_bf16 v[208:211], a[28:31], v[120:123], v[208:211]
ds_read_b128 v[152:155], v29 offset:23552
v_mfma_f32_16x16x32_bf16 v[212:215], a[28:31], v[124:127], v[212:215]
ds_read_b128 v[156:159], v29 offset:32768
v_mfma_f32_16x16x32_bf16 v[220:223], a[76:79], v[76:79], v[220:223]
s_waitcnt lgkmcnt(4)
v_mfma_f32_16x16x32_bf16 v[208:211], a[32:35], v[128:131], v[208:211]
ds_read_b128 v[160:163], v29 offset:6144
v_mfma_f32_16x16x32_bf16 v[212:215], a[32:35], v[132:135], v[212:215]
ds_read_b128 v[164:167], v29 offset:15360
v_mfma_f32_16x16x32_bf16 v[208:211], a[36:39], v[136:139], v[208:211]
ds_read_b128 v[168:171], v29 offset:24576
v_mfma_f32_16x16x32_bf16 v[212:215], a[36:39], v[140:143], v[212:215]
ds_read_b128 v[172:175], v29 offset:33792
v_mfma_f32_16x16x32_bf16 v[216:219], a[80:83], v[80:83], v[216:219]
s_waitcnt lgkmcnt(4)
v_mfma_f32_16x16x32_bf16 v[208:211], a[40:43], v[144:147], v[208:211]
ds_read_b128 v[176:179], v29 offset:7168
v_mfma_f32_16x16x32_bf16 v[212:215], a[40:43], v[148:151], v[212:215]
ds_read_b128 v[180:183], v29 offset:16384
v_mfma_f32_16x16x32_bf16 v[208:211], a[44:47], v[152:155], v[208:211]
ds_read_b128 v[184:187], v29 offset:25600
v_mfma_f32_16x16x32_bf16 v[212:215], a[44:47], v[156:159], v[212:215]
ds_read_b128 v[188:191], v29 offset:34816
v_mfma_f32_16x16x32_bf16 v[220:223], a[80:83], v[84:87], v[220:223]
s_waitcnt lgkmcnt(4)
v_mfma_f32_16x16x32_bf16 v[208:211], a[48:51], v[160:163], v[208:211]
ds_read_b128 v[192:195], v29 offset:8192
v_mfma_f32_16x16x32_bf16 v[212:215], a[48:51], v[164:167], v[212:215]
ds_read_b128 v[196:199], v29 offset:17408
s_waitcnt vmcnt(4)
ds_write_b32 v18, v24
v_mfma_f32_16x16x32_bf16 v[208:211], a[52:55], v[168:171], v[208:211]
ds_read_b128 v[200:203], v29 offset:26624
v_mfma_f32_16x16x32_bf16 v[212:215], a[52:55], v[172:175], v[212:215]
ds_read_b128 v[204:207], v29 offset:35840
v_mfma_f32_16x16x32_bf16 v[216:219], a[84:87], v[88:91], v[216:219]
s_waitcnt lgkmcnt(2)
s_barrier
v_mfma_f32_16x16x32_bf16 v[208:211], a[56:59], v[176:179], v[208:211]
ds_read_b32 v33, v32
v_mfma_f32_16x16x32_bf16 v[212:215], a[56:59], v[180:183], v[212:215]
v_mfma_f32_16x16x32_bf16 v[208:211], a[60:63], v[184:187], v[208:211]
v_mfma_f32_16x16x32_bf16 v[212:215], a[60:63], v[188:191], v[212:215]
s_waitcnt lgkmcnt(0)
v_cmp_gt_u32 vcc, s52, v33
v_mfma_f32_16x16x32_bf16 v[220:223], a[84:87], v[92:95], v[220:223]
v_cmp_gt_u32 s[58:59], s54, v33
v_mfma_f32_16x16x32_bf16 v[208:211], a[64:67], v[192:195], v[208:211]
s_and_b32 vcc_lo, vcc_lo, s56
s_cselect_b32 s70, 0, 1
v_mfma_f32_16x16x32_bf16 v[212:215], a[64:67], v[196:199], v[212:215]
s_and_b32 s59, s59, s56
s_cselect_b32 s71, 0, s83
v_mfma_f32_16x16x32_bf16 v[208:211], a[68:71], v[200:203], v[208:211]
s_or_b32 s88, s70, s71
s_cselect_b32 s10, 268435456, 0
v_mfma_f32_16x16x32_bf16 v[212:215], a[68:71], v[204:207], v[212:215]
s_cmp_lg_u32 s70, 0
s_cselect_b64 s[84:85], s[52:53], s[54:55]
s_cselect_b64 s[58:59], s[44:45], s[46:47]
v_mfma_f32_16x16x32_bf16 v[216:219], a[88:91], v[96:99], v[216:219]
s_mul_i32 s86, s84, s20
s_add_u32 s86, s86, s58
v_mfma_f32_16x16x32_bf16 v[220:223], a[88:91], v[100:103], v[220:223]
s_add_u32 m0, s50, 0
s_mul_i32 s87, s84, s21
s_add_u32 s87, s87, s59
v_mfma_f32_16x16x32_bf16 v[216:219], a[92:95], v[104:107], v[216:219]
buffer_load_dwordx4 v8, s[8:11], s86 offen offset:0 sc1 lds
v_mfma_f32_16x16x32_bf16 v[220:223], a[92:95], v[108:111], v[220:223]
s_andn2_b32 s71, s71, s70
s_add_u32 s52, s52, s70
s_add_u32 s54, s54, s71
v_mfma_f32_16x16x32_bf16 v[216:219], a[96:99], v[112:115], v[216:219]
s_mov_b32 s89, s88
v_mfma_f32_16x16x32_bf16 v[220:223], a[96:99], v[116:119], v[220:223]
buffer_load_dwordx4 v9, s[8:11], s86 offen offset:1024 sc1 lds
v_mfma_f32_16x16x32_bf16 v[216:219], a[100:103], v[120:123], v[216:219]
v_permlane32_swap_b32 v208, v212
v_mfma_f32_16x16x32_bf16 v[220:223], a[100:103], v[124:127], v[220:223]
v_permlane32_swap_b32 v209, v213
v_mfma_f32_16x16x32_bf16 v[216:219], a[104:107], v[128:131], v[216:219]
buffer_load_dwordx4 v10, s[8:11], s86 offen offset:2048 sc1 lds
v_mfma_f32_16x16x32_bf16 v[220:223], a[104:107], v[132:135], v[220:223]
v_permlane32_swap_b32 v210, v214
v_mfma_f32_16x16x32_bf16 v[216:219], a[108:111], v[136:139], v[216:219]
v_permlane32_swap_b32 v211, v215
v_mfma_f32_16x16x32_bf16 v[220:223], a[108:111], v[140:143], v[220:223]
buffer_load_dwordx4 v11, s[8:11], s86 offen offset:3072 sc1 lds
v_mfma_f32_16x16x32_bf16 v[216:219], a[112:115], v[144:147], v[216:219]
v_mul_f32 v232, s57, v208
v_mul_f32 v233, s57, v209
v_mfma_f32_16x16x32_bf16 v[220:223], a[112:115], v[148:151], v[220:223]
s_add_u32 m0, s50, 4096
v_mul_f32 v234, s57, v210
v_mfma_f32_16x16x32_bf16 v[216:219], a[116:119], v[152:155], v[216:219]
buffer_load_dwordx4 v12, s[8:11], s86 offen offset:0 sc1 lds
v_mfma_f32_16x16x32_bf16 v[220:223], a[116:119], v[156:159], v[220:223]
v_mul_f32 v235, s57, v211
v_mfma_f32_16x16x32_bf16 v[216:219], a[120:123], v[160:163], v[216:219]
v_exp_f32 v232, v232
v_mfma_f32_16x16x32_bf16 v[220:223], a[120:123], v[164:167], v[220:223]
buffer_load_dwordx4 v13, s[8:11], s86 offen offset:1024 sc1 lds
v_mfma_f32_16x16x32_bf16 v[216:219], a[124:127], v[168:171], v[216:219]
v_exp_f32 v233, v233
v_mfma_f32_16x16x32_bf16 v[220:223], a[124:127], v[172:175], v[220:223]
v_exp_f32 v234, v234
v_mfma_f32_16x16x32_bf16 v[216:219], a[128:131], v[176:179], v[216:219]
buffer_load_dwordx4 v14, s[8:11], s86 offen offset:2048 sc1 lds
v_mfma_f32_16x16x32_bf16 v[220:223], a[128:131], v[180:183], v[220:223]
v_exp_f32 v235, v235
v_mfma_f32_16x16x32_bf16 v[216:219], a[132:135], v[184:187], v[216:219]
v_add_f32 v232, 1.0, v232
v_add_f32 v233, 1.0, v233
v_mfma_f32_16x16x32_bf16 v[220:223], a[132:135], v[188:191], v[220:223]
buffer_load_dwordx4 v15, s[8:11], s86 offen offset:3072 sc1 lds
v_mfma_f32_16x16x32_bf16 v[216:219], a[136:139], v[192:195], v[216:219]
v_add_f32 v234, 1.0, v234
v_add_f32 v235, 1.0, v235
v_mfma_f32_16x16x32_bf16 v[220:223], a[136:139], v[196:199], v[220:223]
s_add_u32 m0, s50, 8192
v_mfma_f32_16x16x32_bf16 v[216:219], a[140:143], v[200:203], v[216:219]
buffer_load_dwordx4 v16, s[8:11], s86 offen offset:0 sc1 lds
v_mfma_f32_16x16x32_bf16 v[220:223], a[140:143], v[204:207], v[220:223]
v_rcp_f32 v232, v232
v_mfma_f32_16x16x32_bf16 v[224:227], a[144:147], v[64:67], 0
v_rcp_f32 v233, v233
v_mfma_f32_16x16x32_bf16 v[228:231], a[144:147], v[68:71], 0
v_rcp_f32 v234, v234
v_mfma_f32_16x16x32_bf16 v[224:227], a[148:151], v[72:75], v[224:227]
v_rcp_f32 v235, v235
v_mfma_f32_16x16x32_bf16 v[228:231], a[148:151], v[76:79], v[228:231]
v_mul_f32 v212, v208, v212
v_mul_f32 v213, v209, v213
v_mfma_f32_16x16x32_bf16 v[224:227], a[152:155], v[80:83], v[224:227]
buffer_load_dword v24, v22, s[4:7], 0 offen sc1
v_mfma_f32_16x16x32_bf16 v[228:231], a[152:155], v[84:87], v[228:231]
v_mul_f32 v214, v210, v214
v_mul_f32 v215, v211, v215
v_mul_f32 v236, s57, v216
v_mul_f32 v237, s57, v217
v_mul_f32 v238, s57, v218
v_mul_f32 v239, s57, v219
v_exp_f32 v236, v236
v_exp_f32 v237, v237
v_exp_f32 v238, v238
v_exp_f32 v239, v239
v_add_f32 v236, 1.0, v236
v_add_f32 v237, 1.0, v237
v_add_f32 v238, 1.0, v238
v_add_f32 v239, 1.0, v239
v_rcp_f32 v236, v236
v_rcp_f32 v237, v237
v_mfma_f32_16x16x32_bf16 v[224:227], a[156:159], v[88:91], v[224:227]
s_waitcnt vmcnt(10)
s_barrier
v_mfma_f32_16x16x32_bf16 v[228:231], a[156:159], v[92:95], v[228:231]
buffer_store_dword v27, v45, s[4:7], s73 offen
v_mfma_f32_16x16x32_bf16 v[224:227], a[160:163], v[96:99], v[224:227]
buffer_store_dword v27, v44, s[4:7], s73 offen sc1
v_mfma_f32_16x16x32_bf16 v[228:231], a[160:163], v[100:103], v[228:231]
v_mul_f32 v212, v212, v232
v_mul_f32 v213, v213, v233
v_mfma_f32_16x16x32_bf16 v[224:227], a[164:167], v[104:107], v[224:227]
v_mul_f32 v214, v214, v234
v_mul_f32 v215, v215, v235
v_mfma_f32_16x16x32_bf16 v[228:231], a[164:167], v[108:111], v[228:231]
v_cvt_pk_bf16_f32 v48, v212, v213
v_cvt_pk_bf16_f32 v49, v214, v215
v_mfma_f32_16x16x32_bf16 v[224:227], a[168:171], v[112:115], v[224:227]
buffer_store_dwordx2 v[48:49], v19, s[4:7], s81 offen sc1
v_mfma_f32_16x16x32_bf16 v[228:231], a[168:171], v[116:119], v[228:231]
v_rcp_f32 v238, v238
v_mfma_f32_16x16x32_bf16 v[224:227], a[172:175], v[120:123], v[224:227]
v_rcp_f32 v239, v239
v_mfma_f32_16x16x32_bf16 v[228:231], a[172:175], v[124:127], v[228:231]
v_mul_f32 v240, s57, v220
v_mul_f32 v241, s57, v221
v_mfma_f32_16x16x32_bf16 v[224:227], a[176:179], v[128:131], v[224:227]
v_mul_f32 v242, s57, v222
v_mul_f32 v243, s57, v223
v_mfma_f32_16x16x32_bf16 v[228:231], a[176:179], v[132:135], v[228:231]
v_mul_f32 v236, v216, v236
v_mul_f32 v237, v217, v237
v_mfma_f32_16x16x32_bf16 v[224:227], a[180:183], v[136:139], v[224:227]
v_mul_f32 v238, v218, v238
v_mul_f32 v239, v219, v239
v_mfma_f32_16x16x32_bf16 v[228:231], a[180:183], v[140:143], v[228:231]
v_exp_f32 v240, v240
v_mfma_f32_16x16x32_bf16 v[224:227], a[184:187], v[144:147], v[224:227]
v_exp_f32 v241, v241
v_mfma_f32_16x16x32_bf16 v[228:231], a[184:187], v[148:151], v[228:231]
v_exp_f32 v242, v242
v_mfma_f32_16x16x32_bf16 v[224:227], a[188:191], v[152:155], v[224:227]
v_exp_f32 v243, v243
v_mfma_f32_16x16x32_bf16 v[228:231], a[188:191], v[156:159], v[228:231]
v_add_f32 v240, 1.0, v240
v_add_f32 v241, 1.0, v241
v_mfma_f32_16x16x32_bf16 v[224:227], a[192:195], v[160:163], v[224:227]
s_waitcnt vmcnt(11)
s_barrier
v_mfma_f32_16x16x32_bf16 v[228:231], a[192:195], v[164:167], v[228:231]
v_add_f32 v242, 1.0, v242
v_add_f32 v243, 1.0, v243
v_mfma_f32_16x16x32_bf16 v[224:227], a[196:199], v[168:171], v[224:227]
s_cmp_eq_u32 s88, 0
s_cbranch_scc1 g_slow_166
v_mfma_f32_16x16x32_bf16 v[228:231], a[196:199], v[172:175], v[228:231]
v_rcp_f32 v240, v240
ds_read_b128 v[64:67], v30 offset:0
v_mfma_f32_16x16x32_bf16 v[224:227], a[200:203], v[176:179], v[224:227]
v_rcp_f32 v241, v241
ds_read_b128 v[68:71], v30 offset:9216
v_mfma_f32_16x16x32_bf16 v[228:231], a[200:203], v[180:183], v[228:231]
v_rcp_f32 v242, v242
ds_read_b128 v[72:75], v30 offset:18432
v_mfma_f32_16x16x32_bf16 v[224:227], a[204:207], v[184:187], v[224:227]
v_rcp_f32 v243, v243
ds_read_b128 v[76:79], v30 offset:27648
v_mfma_f32_16x16x32_bf16 v[228:231], a[204:207], v[188:191], v[228:231]
v_mul_f32 v240, v220, v240
ds_read_b128 v[80:83], v30 offset:1024
v_mfma_f32_16x16x32_bf16 v[224:227], a[208:211], v[192:195], v[224:227]
v_mul_f32 v241, v221, v241
ds_read_b128 v[84:87], v30 offset:10240
v_mfma_f32_16x16x32_bf16 v[228:231], a[208:211], v[196:199], v[228:231]
v_mul_f32 v242, v222, v242
ds_read_b128 v[88:91], v30 offset:19456
v_mfma_f32_16x16x32_bf16 v[224:227], a[212:215], v[200:203], v[224:227]
v_mul_f32 v243, v223, v243
ds_read_b128 v[92:95], v30 offset:28672
v_mfma_f32_16x16x32_bf16 v[228:231], a[212:215], v[204:207], v[228:231]
s_waitcnt vmcnt(8)
s_barrier
g_body_155:
s_waitcnt lgkmcnt(4)
v_mfma_f32_16x16x32_bf16 v[208:211], a[0:3], v[64:67], 0
ds_read_b128 v[96:99], v30 offset:2048
v_mfma_f32_16x16x32_bf16 v[212:215], a[0:3], v[68:71], 0
ds_read_b128 v[100:103], v30 offset:11264
v_mfma_f32_16x16x32_bf16 v[208:211], a[4:7], v[72:75], v[208:211]
ds_read_b128 v[104:107], v30 offset:20480
v_mfma_f32_16x16x32_bf16 v[212:215], a[4:7], v[76:79], v[212:215]
ds_read_b128 v[108:111], v30 offset:29696
v_mul_f32 v224, v224, v236
v_mul_f32 v225, v225, v237
v_mul_f32 v226, v226, v238
v_mul_f32 v227, v227, v239
v_mul_f32 v228, v228, v240
v_mfma_f32_16x16x32_bf16 v[216:219], a[72:75], v[64:67], 0
v_mul_f32 v229, v229, v241
s_waitcnt lgkmcnt(4)
v_mfma_f32_16x16x32_bf16 v[208:211], a[8:11], v[80:83], v[208:211]
ds_read_b128 v[112:115], v30 offset:3072
v_mul_f32 v230, v230, v242
v_mfma_f32_16x16x32_bf16 v[212:215], a[8:11], v[84:87], v[212:215]
ds_read_b128 v[116:119], v30 offset:12288
v_mul_f32 v231, v231, v243
v_mfma_f32_16x16x32_bf16 v[208:211], a[12:15], v[88:91], v[208:211]
ds_read_b128 v[120:123], v30 offset:21504
v_cvt_pk_bf16_f32 v52, v224, v225
v_mfma_f32_16x16x32_bf16 v[212:215], a[12:15], v[92:95], v[212:215]
ds_read_b128 v[124:127], v30 offset:30720
v_cvt_pk_bf16_f32 v53, v226, v227
v_mfma_f32_16x16x32_bf16 v[220:223], a[72:75], v[68:71], 0
v_cvt_pk_bf16_f32 v54, v228, v229
s_waitcnt lgkmcnt(4)
v_mfma_f32_16x16x32_bf16 v[208:211], a[16:19], v[96:99], v[208:211]
ds_read_b128 v[128:131], v30 offset:4096
v_cvt_pk_bf16_f32 v55, v230, v231
v_mfma_f32_16x16x32_bf16 v[212:215], a[16:19], v[100:103], v[212:215]
ds_read_b128 v[132:135], v30 offset:13312
v_permlane16_swap_b32 v52, v54
v_mfma_f32_16x16x32_bf16 v[208:211], a[20:23], v[104:107], v[208:211]
ds_read_b128 v[136:139], v30 offset:22528
v_permlane16_swap_b32 v53, v55
v_mfma_f32_16x16x32_bf16 v[212:215], a[20:23], v[108:111], v[212:215]
ds_read_b128 v[140:143], v30 offset:31744
buffer_store_dwordx4 v[52:55], v20, s[4:7], s81 offen sc1
v_mfma_f32_16x16x32_bf16 v[216:219], a[76:79], v[72:75], v[216:219]
s_waitcnt vmcnt(5)
s_barrier
s_waitcnt lgkmcnt(4)
v_mfma_f32_16x16x32_bf16 v[208:211], a[24:27], v[112:115], v[208:211]
ds_read_b128 v[144:147], v30 offset:5120
v_mov_b32 v27, s78
v_mfma_f32_16x16x32_bf16 v[212:215], a[24:27], v[116:119], v[212:215]
ds_read_b128 v[148:151], v30 offset:14336
v_mfma_f32_16x16x32_bf16 v[208:211], a[28:31], v[120:123], v[208:211]
ds_read_b128 v[152:155], v30 offset:23552
v_mfma_f32_16x16x32_bf16 v[212:215], a[28:31], v[124:127], v[212:215]
ds_read_b128 v[156:159], v30 offset:32768
v_mfma_f32_16x16x32_bf16 v[220:223], a[76:79], v[76:79], v[220:223]
s_waitcnt lgkmcnt(4)
v_mfma_f32_16x16x32_bf16 v[208:211], a[32:35], v[128:131], v[208:211]
ds_read_b128 v[160:163], v30 offset:6144
v_mfma_f32_16x16x32_bf16 v[212:215], a[32:35], v[132:135], v[212:215]
ds_read_b128 v[164:167], v30 offset:15360
v_mfma_f32_16x16x32_bf16 v[208:211], a[36:39], v[136:139], v[208:211]
ds_read_b128 v[168:171], v30 offset:24576
v_mfma_f32_16x16x32_bf16 v[212:215], a[36:39], v[140:143], v[212:215]
ds_read_b128 v[172:175], v30 offset:33792
v_mfma_f32_16x16x32_bf16 v[216:219], a[80:83], v[80:83], v[216:219]
s_waitcnt lgkmcnt(4)
v_mfma_f32_16x16x32_bf16 v[208:211], a[40:43], v[144:147], v[208:211]
ds_read_b128 v[176:179], v30 offset:7168
v_mfma_f32_16x16x32_bf16 v[212:215], a[40:43], v[148:151], v[212:215]
ds_read_b128 v[180:183], v30 offset:16384
v_mfma_f32_16x16x32_bf16 v[208:211], a[44:47], v[152:155], v[208:211]
ds_read_b128 v[184:187], v30 offset:25600
v_mfma_f32_16x16x32_bf16 v[212:215], a[44:47], v[156:159], v[212:215]
ds_read_b128 v[188:191], v30 offset:34816
v_mfma_f32_16x16x32_bf16 v[220:223], a[80:83], v[84:87], v[220:223]
s_waitcnt lgkmcnt(4)
v_mfma_f32_16x16x32_bf16 v[208:211], a[48:51], v[160:163], v[208:211]
ds_read_b128 v[192:195], v30 offset:8192
v_mfma_f32_16x16x32_bf16 v[212:215], a[48:51], v[164:167], v[212:215]
ds_read_b128 v[196:199], v30 offset:17408
s_waitcnt vmcnt(4)
ds_write_b32 v18, v24
v_mfma_f32_16x16x32_bf16 v[208:211], a[52:55], v[168:171], v[208:211]
ds_read_b128 v[200:203], v30 offset:26624
v_mfma_f32_16x16x32_bf16 v[212:215], a[52:55], v[172:175], v[212:215]
ds_read_b128 v[204:207], v30 offset:35840
v_mfma_f32_16x16x32_bf16 v[216:219], a[84:87], v[88:91], v[216:219]
s_waitcnt lgkmcnt(2)
s_barrier
v_mfma_f32_16x16x32_bf16 v[208:211], a[56:59], v[176:179], v[208:211]
ds_read_b32 v33, v32
v_mfma_f32_16x16x32_bf16 v[212:215], a[56:59], v[180:183], v[212:215]
v_mfma_f32_16x16x32_bf16 v[208:211], a[60:63], v[184:187], v[208:211]
v_mfma_f32_16x16x32_bf16 v[212:215], a[60:63], v[188:191], v[212:215]
s_waitcnt lgkmcnt(0)
v_cmp_gt_u32 vcc, s52, v33
v_mfma_f32_16x16x32_bf16 v[220:223], a[84:87], v[92:95], v[220:223]
v_cmp_gt_u32 s[58:59], s54, v33
v_mfma_f32_16x16x32_bf16 v[208:211], a[64:67], v[192:195], v[208:211]
s_and_b32 vcc_lo, vcc_lo, s56
s_cselect_b32 s70, 0, 1
v_mfma_f32_16x16x32_bf16 v[212:215], a[64:67], v[196:199], v[212:215]
s_and_b32 s59, s59, s56
s_cselect_b32 s71, 0, s89
v_mfma_f32_16x16x32_bf16 v[208:211], a[68:71], v[200:203], v[208:211]
s_or_b32 s94, s70, s71
s_cselect_b32 s10, 268435456, 0
v_mfma_f32_16x16x32_bf16 v[212:215], a[68:71], v[204:207], v[212:215]
s_cmp_lg_u32 s70, 0
s_cselect_b64 s[90:91], s[52:53], s[54:55]
s_cselect_b64 s[58:59], s[44:45], s[46:47]
v_mfma_f32_16x16x32_bf16 v[216:219], a[88:91], v[96:99], v[216:219]
s_mul_i32 s92, s90, s20
s_add_u32 s92, s92, s58
v_mfma_f32_16x16x32_bf16 v[220:223], a[88:91], v[100:103], v[220:223]
s_add_u32 m0, s51, 0
s_mul_i32 s93, s90, s21
s_add_u32 s93, s93, s59
v_mfma_f32_16x16x32_bf16 v[216:219], a[92:95], v[104:107], v[216:219]
buffer_load_dwordx4 v8, s[8:11], s92 offen offset:0 sc1 lds
v_mfma_f32_16x16x32_bf16 v[220:223], a[92:95], v[108:111], v[220:223]
s_andn2_b32 s71, s71, s70
s_add_u32 s52, s52, s70
s_add_u32 s54, s54, s71
v_mfma_f32_16x16x32_bf16 v[216:219], a[96:99], v[112:115], v[216:219]
s_mov_b32 s95, s94
v_mfma_f32_16x16x32_bf16 v[220:223], a[96:99], v[116:119], v[220:223]
buffer_load_dwordx4 v9, s[8:11], s92 offen offset:1024 sc1 lds
v_mfma_f32_16x16x32_bf16 v[216:219], a[100:103], v[120:123], v[216:219]
v_permlane32_swap_b32 v208, v212
v_mfma_f32_16x16x32_bf16 v[220:223], a[100:103], v[124:127], v[220:223]
v_permlane32_swap_b32 v209, v213
v_mfma_f32_16x16x32_bf16 v[216:219], a[104:107], v[128:131], v[216:219]
buffer_load_dwordx4 v10, s[8:11], s92 offen offset:2048 sc1 lds
v_mfma_f32_16x16x32_bf16 v[220:223], a[104:107], v[132:135], v[220:223]
v_permlane32_swap_b32 v210, v214
v_mfma_f32_16x16x32_bf16 v[216:219], a[108:111], v[136:139], v[216:219]
v_permlane32_swap_b32 v211, v215
v_mfma_f32_16x16x32_bf16 v[220:223], a[108:111], v[140:143], v[220:223]
buffer_load_dwordx4 v11, s[8:11], s92 offen offset:3072 sc1 lds
v_mfma_f32_16x16x32_bf16 v[216:219], a[112:115], v[144:147], v[216:219]
v_mul_f32 v232, s57, v208
v_mul_f32 v233, s57, v209
v_mfma_f32_16x16x32_bf16 v[220:223], a[112:115], v[148:151], v[220:223]
s_add_u32 m0, s51, 4096
v_mul_f32 v234, s57, v210
v_mfma_f32_16x16x32_bf16 v[216:219], a[116:119], v[152:155], v[216:219]
buffer_load_dwordx4 v12, s[8:11], s92 offen offset:0 sc1 lds
v_mfma_f32_16x16x32_bf16 v[220:223], a[116:119], v[156:159], v[220:223]
v_mul_f32 v235, s57, v211
v_mfma_f32_16x16x32_bf16 v[216:219], a[120:123], v[160:163], v[216:219]
v_exp_f32 v232, v232
v_mfma_f32_16x16x32_bf16 v[220:223], a[120:123], v[164:167], v[220:223]
buffer_load_dwordx4 v13, s[8:11], s92 offen offset:1024 sc1 lds
v_mfma_f32_16x16x32_bf16 v[216:219], a[124:127], v[168:171], v[216:219]
v_exp_f32 v233, v233
v_mfma_f32_16x16x32_bf16 v[220:223], a[124:127], v[172:175], v[220:223]
v_exp_f32 v234, v234
v_mfma_f32_16x16x32_bf16 v[216:219], a[128:131], v[176:179], v[216:219]
buffer_load_dwordx4 v14, s[8:11], s92 offen offset:2048 sc1 lds
v_mfma_f32_16x16x32_bf16 v[220:223], a[128:131], v[180:183], v[220:223]
v_exp_f32 v235, v235
v_mfma_f32_16x16x32_bf16 v[216:219], a[132:135], v[184:187], v[216:219]
v_add_f32 v232, 1.0, v232
v_add_f32 v233, 1.0, v233
v_mfma_f32_16x16x32_bf16 v[220:223], a[132:135], v[188:191], v[220:223]
buffer_load_dwordx4 v15, s[8:11], s92 offen offset:3072 sc1 lds
v_mfma_f32_16x16x32_bf16 v[216:219], a[136:139], v[192:195], v[216:219]
v_add_f32 v234, 1.0, v234
v_add_f32 v235, 1.0, v235
v_mfma_f32_16x16x32_bf16 v[220:223], a[136:139], v[196:199], v[220:223]
s_add_u32 m0, s51, 8192
v_mfma_f32_16x16x32_bf16 v[216:219], a[140:143], v[200:203], v[216:219]
buffer_load_dwordx4 v16, s[8:11], s92 offen offset:0 sc1 lds
v_mfma_f32_16x16x32_bf16 v[220:223], a[140:143], v[204:207], v[220:223]
v_rcp_f32 v232, v232
v_mfma_f32_16x16x32_bf16 v[224:227], a[144:147], v[64:67], 0
v_rcp_f32 v233, v233
v_mfma_f32_16x16x32_bf16 v[228:231], a[144:147], v[68:71], 0
v_rcp_f32 v234, v234
v_mfma_f32_16x16x32_bf16 v[224:227], a[148:151], v[72:75], v[224:227]
v_rcp_f32 v235, v235
v_mfma_f32_16x16x32_bf16 v[228:231], a[148:151], v[76:79], v[228:231]
v_mul_f32 v212, v208, v212
v_mul_f32 v213, v209, v213
v_mfma_f32_16x16x32_bf16 v[224:227], a[152:155], v[80:83], v[224:227]
buffer_load_dword v24, v22, s[4:7], 0 offen sc1
v_mfma_f32_16x16x32_bf16 v[228:231], a[152:155], v[84:87], v[228:231]
v_mul_f32 v214, v210, v214
v_mul_f32 v215, v211, v215
v_mul_f32 v236, s57, v216
v_mul_f32 v237, s57, v217
v_mul_f32 v238, s57, v218
v_mul_f32 v239, s57, v219
v_exp_f32 v236, v236
v_exp_f32 v237, v237
v_exp_f32 v238, v238
v_exp_f32 v239, v239
v_add_f32 v236, 1.0, v236
v_add_f32 v237, 1.0, v237
v_add_f32 v238, 1.0, v238
v_add_f32 v239, 1.0, v239
v_rcp_f32 v236, v236
v_rcp_f32 v237, v237
v_mfma_f32_16x16x32_bf16 v[224:227], a[156:159], v[88:91], v[224:227]
s_waitcnt vmcnt(10)
s_barrier
v_mfma_f32_16x16x32_bf16 v[228:231], a[156:159], v[92:95], v[228:231]
buffer_store_dword v27, v45, s[4:7], s79 offen
v_mfma_f32_16x16x32_bf16 v[224:227], a[160:163], v[96:99], v[224:227]
buffer_store_dword v27, v44, s[4:7], s79 offen sc1
v_mfma_f32_16x16x32_bf16 v[228:231], a[160:163], v[100:103], v[228:231]
v_mul_f32 v212, v212, v232
v_mul_f32 v213, v213, v233
v_mfma_f32_16x16x32_bf16 v[224:227], a[164:167], v[104:107], v[224:227]
v_mul_f32 v214, v214, v234
v_mul_f32 v215, v215, v235
v_mfma_f32_16x16x32_bf16 v[228:231], a[164:167], v[108:111], v[228:231]
v_cvt_pk_bf16_f32 v48, v212, v213
v_cvt_pk_bf16_f32 v49, v214, v215
v_mfma_f32_16x16x32_bf16 v[224:227], a[168:171], v[112:115], v[224:227]
buffer_store_dwordx2 v[48:49], v19, s[4:7], s87 offen sc1
v_mfma_f32_16x16x32_bf16 v[228:231], a[168:171], v[116:119], v[228:231]
v_rcp_f32 v238, v238
v_mfma_f32_16x16x32_bf16 v[224:227], a[172:175], v[120:123], v[224:227]
v_rcp_f32 v239, v239
v_mfma_f32_16x16x32_bf16 v[228:231], a[172:175], v[124:127], v[228:231]
v_mul_f32 v240, s57, v220
v_mul_f32 v241, s57, v221
v_mfma_f32_16x16x32_bf16 v[224:227], a[176:179], v[128:131], v[224:227]
v_mul_f32 v242, s57, v222
v_mul_f32 v243, s57, v223
v_mfma_f32_16x16x32_bf16 v[228:231], a[176:179], v[132:135], v[228:231]
v_mul_f32 v236, v216, v236
v_mul_f32 v237, v217, v237
v_mfma_f32_16x16x32_bf16 v[224:227], a[180:183], v[136:139], v[224:227]
v_mul_f32 v238, v218, v238
v_mul_f32 v239, v219, v239
v_mfma_f32_16x16x32_bf16 v[228:231], a[180:183], v[140:143], v[228:231]
v_exp_f32 v240, v240
v_mfma_f32_16x16x32_bf16 v[224:227], a[184:187], v[144:147], v[224:227]
v_exp_f32 v241, v241
v_mfma_f32_16x16x32_bf16 v[228:231], a[184:187], v[148:151], v[228:231]
v_exp_f32 v242, v242
v_mfma_f32_16x16x32_bf16 v[224:227], a[188:191], v[152:155], v[224:227]
v_exp_f32 v243, v243
v_mfma_f32_16x16x32_bf16 v[228:231], a[188:191], v[156:159], v[228:231]
v_add_f32 v240, 1.0, v240
v_add_f32 v241, 1.0, v241
v_mfma_f32_16x16x32_bf16 v[224:227], a[192:195], v[160:163], v[224:227]
s_waitcnt vmcnt(11)
s_barrier
v_mfma_f32_16x16x32_bf16 v[228:231], a[192:195], v[164:167], v[228:231]
v_add_f32 v242, 1.0, v242
v_add_f32 v243, 1.0, v243
v_mfma_f32_16x16x32_bf16 v[224:227], a[196:199], v[168:171], v[224:227]
s_cmp_eq_u32 s94, 0
s_cbranch_scc1 g_slow_167
v_mfma_f32_16x16x32_bf16 v[228:231], a[196:199], v[172:175], v[228:231]
v_rcp_f32 v240, v240
ds_read_b128 v[64:67], v31 offset:0
v_mfma_f32_16x16x32_bf16 v[224:227], a[200:203], v[176:179], v[224:227]
v_rcp_f32 v241, v241
ds_read_b128 v[68:71], v31 offset:9216
v_mfma_f32_16x16x32_bf16 v[228:231], a[200:203], v[180:183], v[228:231]
v_rcp_f32 v242, v242
ds_read_b128 v[72:75], v31 offset:18432
v_mfma_f32_16x16x32_bf16 v[224:227], a[204:207], v[184:187], v[224:227]
v_rcp_f32 v243, v243
ds_read_b128 v[76:79], v31 offset:27648
v_mfma_f32_16x16x32_bf16 v[228:231], a[204:207], v[188:191], v[228:231]
v_mul_f32 v240, v220, v240
ds_read_b128 v[80:83], v31 offset:1024
v_mfma_f32_16x16x32_bf16 v[224:227], a[208:211], v[192:195], v[224:227]
v_mul_f32 v241, v221, v241
ds_read_b128 v[84:87], v31 offset:10240
v_mfma_f32_16x16x32_bf16 v[228:231], a[208:211], v[196:199], v[228:231]
v_mul_f32 v242, v222, v242
ds_read_b128 v[88:91], v31 offset:19456
v_mfma_f32_16x16x32_bf16 v[224:227], a[212:215], v[200:203], v[224:227]
v_mul_f32 v243, v223, v243
ds_read_b128 v[92:95], v31 offset:28672
v_mfma_f32_16x16x32_bf16 v[228:231], a[212:215], v[204:207], v[228:231]
s_waitcnt vmcnt(8)
s_barrier
g_body_156:
s_waitcnt lgkmcnt(4)
v_mfma_f32_16x16x32_bf16 v[208:211], a[0:3], v[64:67], 0
ds_read_b128 v[96:99], v31 offset:2048
v_mfma_f32_16x16x32_bf16 v[212:215], a[0:3], v[68:71], 0
ds_read_b128 v[100:103], v31 offset:11264
v_mfma_f32_16x16x32_bf16 v[208:211], a[4:7], v[72:75], v[208:211]
ds_read_b128 v[104:107], v31 offset:20480
v_mfma_f32_16x16x32_bf16 v[212:215], a[4:7], v[76:79], v[212:215]
ds_read_b128 v[108:111], v31 offset:29696
v_mul_f32 v224, v224, v236
v_mul_f32 v225, v225, v237
v_mul_f32 v226, v226, v238
v_mul_f32 v227, v227, v239
v_mul_f32 v228, v228, v240
v_mfma_f32_16x16x32_bf16 v[216:219], a[72:75], v[64:67], 0
v_mul_f32 v229, v229, v241
s_waitcnt lgkmcnt(4)
v_mfma_f32_16x16x32_bf16 v[208:211], a[8:11], v[80:83], v[208:211]
ds_read_b128 v[112:115], v31 offset:3072
v_mul_f32 v230, v230, v242
v_mfma_f32_16x16x32_bf16 v[212:215], a[8:11], v[84:87], v[212:215]
ds_read_b128 v[116:119], v31 offset:12288
v_mul_f32 v231, v231, v243
v_mfma_f32_16x16x32_bf16 v[208:211], a[12:15], v[88:91], v[208:211]
ds_read_b128 v[120:123], v31 offset:21504
v_cvt_pk_bf16_f32 v52, v224, v225
v_mfma_f32_16x16x32_bf16 v[212:215], a[12:15], v[92:95], v[212:215]
ds_read_b128 v[124:127], v31 offset:30720
v_cvt_pk_bf16_f32 v53, v226, v227
v_mfma_f32_16x16x32_bf16 v[220:223], a[72:75], v[68:71], 0
v_cvt_pk_bf16_f32 v54, v228, v229
s_waitcnt lgkmcnt(4)
v_mfma_f32_16x16x32_bf16 v[208:211], a[16:19], v[96:99], v[208:211]
ds_read_b128 v[128:131], v31 offset:4096
v_cvt_pk_bf16_f32 v55, v230, v231
v_mfma_f32_16x16x32_bf16 v[212:215], a[16:19], v[100:103], v[212:215]
ds_read_b128 v[132:135], v31 offset:13312
v_permlane16_swap_b32 v52, v54
v_mfma_f32_16x16x32_bf16 v[208:211], a[20:23], v[104:107], v[208:211]
ds_read_b128 v[136:139], v31 offset:22528
v_permlane16_swap_b32 v53, v55
v_mfma_f32_16x16x32_bf16 v[212:215], a[20:23], v[108:111], v[212:215]
ds_read_b128 v[140:143], v31 offset:31744
buffer_store_dwordx4 v[52:55], v20, s[4:7], s87 offen sc1
v_mfma_f32_16x16x32_bf16 v[216:219], a[76:79], v[72:75], v[216:219]
s_waitcnt vmcnt(5)
s_barrier
s_waitcnt lgkmcnt(4)
v_mfma_f32_16x16x32_bf16 v[208:211], a[24:27], v[112:115], v[208:211]
ds_read_b128 v[144:147], v31 offset:5120
v_mov_b32 v27, s84
v_mfma_f32_16x16x32_bf16 v[212:215], a[24:27], v[116:119], v[212:215]
ds_read_b128 v[148:151], v31 offset:14336
v_mfma_f32_16x16x32_bf16 v[208:211], a[28:31], v[120:123], v[208:211]
ds_read_b128 v[152:155], v31 offset:23552
v_mfma_f32_16x16x32_bf16 v[212:215], a[28:31], v[124:127], v[212:215]
ds_read_b128 v[156:159], v31 offset:32768
v_mfma_f32_16x16x32_bf16 v[220:223], a[76:79], v[76:79], v[220:223]
s_waitcnt lgkmcnt(4)
v_mfma_f32_16x16x32_bf16 v[208:211], a[32:35], v[128:131], v[208:211]
ds_read_b128 v[160:163], v31 offset:6144
v_mfma_f32_16x16x32_bf16 v[212:215], a[32:35], v[132:135], v[212:215]
ds_read_b128 v[164:167], v31 offset:15360
v_mfma_f32_16x16x32_bf16 v[208:211], a[36:39], v[136:139], v[208:211]
ds_read_b128 v[168:171], v31 offset:24576
v_mfma_f32_16x16x32_bf16 v[212:215], a[36:39], v[140:143], v[212:215]
ds_read_b128 v[172:175], v31 offset:33792
v_mfma_f32_16x16x32_bf16 v[216:219], a[80:83], v[80:83], v[216:219]
s_waitcnt lgkmcnt(4)
v_mfma_f32_16x16x32_bf16 v[208:211], a[40:43], v[144:147], v[208:211]
ds_read_b128 v[176:179], v31 offset:7168
v_mfma_f32_16x16x32_bf16 v[212:215], a[40:43], v[148:151], v[212:215]
ds_read_b128 v[180:183], v31 offset:16384
v_mfma_f32_16x16x32_bf16 v[208:211], a[44:47], v[152:155], v[208:211]
ds_read_b128 v[184:187], v31 offset:25600
v_mfma_f32_16x16x32_bf16 v[212:215], a[44:47], v[156:159], v[212:215]
ds_read_b128 v[188:191], v31 offset:34816
v_mfma_f32_16x16x32_bf16 v[220:223], a[80:83], v[84:87], v[220:223]
s_waitcnt lgkmcnt(4)
v_mfma_f32_16x16x32_bf16 v[208:211], a[48:51], v[160:163], v[208:211]
ds_read_b128 v[192:195], v31 offset:8192
v_mfma_f32_16x16x32_bf16 v[212:215], a[48:51], v[164:167], v[212:215]
ds_read_b128 v[196:199], v31 offset:17408
s_waitcnt vmcnt(4)
ds_write_b32 v18, v24
v_mfma_f32_16x16x32_bf16 v[208:211], a[52:55], v[168:171], v[208:211]
ds_read_b128 v[200:203], v31 offset:26624
v_mfma_f32_16x16x32_bf16 v[212:215], a[52:55], v[172:175], v[212:215]
ds_read_b128 v[204:207], v31 offset:35840
v_mfma_f32_16x16x32_bf16 v[216:219], a[84:87], v[88:91], v[216:219]
s_waitcnt lgkmcnt(2)
s_barrier
v_mfma_f32_16x16x32_bf16 v[208:211], a[56:59], v[176:179], v[208:211]
ds_read_b32 v33, v32
v_mfma_f32_16x16x32_bf16 v[212:215], a[56:59], v[180:183], v[212:215]
v_mfma_f32_16x16x32_bf16 v[208:211], a[60:63], v[184:187], v[208:211]
v_mfma_f32_16x16x32_bf16 v[212:215], a[60:63], v[188:191], v[212:215]
s_waitcnt lgkmcnt(0)
v_cmp_gt_u32 vcc, s52, v33
v_mfma_f32_16x16x32_bf16 v[220:223], a[84:87], v[92:95], v[220:223]
v_cmp_gt_u32 s[58:59], s54, v33
v_mfma_f32_16x16x32_bf16 v[208:211], a[64:67], v[192:195], v[208:211]
s_and_b32 vcc_lo, vcc_lo, s56
s_cselect_b32 s70, 0, 1
v_mfma_f32_16x16x32_bf16 v[212:215], a[64:67], v[196:199], v[212:215]
s_and_b32 s59, s59, s56
s_cselect_b32 s71, 0, s95
v_mfma_f32_16x16x32_bf16 v[208:211], a[68:71], v[200:203], v[208:211]
s_or_b32 s76, s70, s71
s_cselect_b32 s10, 268435456, 0
v_mfma_f32_16x16x32_bf16 v[212:215], a[68:71], v[204:207], v[212:215]
s_cmp_lg_u32 s70, 0
s_cselect_b64 s[72:73], s[52:53], s[54:55]
s_cselect_b64 s[58:59], s[44:45], s[46:47]
v_mfma_f32_16x16x32_bf16 v[216:219], a[88:91], v[96:99], v[216:219]
s_mul_i32 s74, s72, s20
s_add_u32 s74, s74, s58
v_mfma_f32_16x16x32_bf16 v[220:223], a[88:91], v[100:103], v[220:223]
s_add_u32 m0, s48, 0
s_mul_i32 s75, s72, s21
s_add_u32 s75, s75, s59
v_mfma_f32_16x16x32_bf16 v[216:219], a[92:95], v[104:107], v[216:219]
buffer_load_dwordx4 v8, s[8:11], s74 offen offset:0 sc1 lds
v_mfma_f32_16x16x32_bf16 v[220:223], a[92:95], v[108:111], v[220:223]
s_andn2_b32 s71, s71, s70
s_add_u32 s52, s52, s70
s_add_u32 s54, s54, s71
v_mfma_f32_16x16x32_bf16 v[216:219], a[96:99], v[112:115], v[216:219]
s_mov_b32 s77, s76
v_mfma_f32_16x16x32_bf16 v[220:223], a[96:99], v[116:119], v[220:223]
buffer_load_dwordx4 v9, s[8:11], s74 offen offset:1024 sc1 lds
v_mfma_f32_16x16x32_bf16 v[216:219], a[100:103], v[120:123], v[216:219]
v_permlane32_swap_b32 v208, v212
v_mfma_f32_16x16x32_bf16 v[220:223], a[100:103], v[124:127], v[220:223]
v_permlane32_swap_b32 v209, v213
v_mfma_f32_16x16x32_bf16 v[216:219], a[104:107], v[128:131], v[216:219]
buffer_load_dwordx4 v10, s[8:11], s74 offen offset:2048 sc1 lds
v_mfma_f32_16x16x32_bf16 v[220:223], a[104:107], v[132:135], v[220:223]
v_permlane32_swap_b32 v210, v214
v_mfma_f32_16x16x32_bf16 v[216:219], a[108:111], v[136:139], v[216:219]
v_permlane32_swap_b32 v211, v215
v_mfma_f32_16x16x32_bf16 v[220:223], a[108:111], v[140:143], v[220:223]
buffer_load_dwordx4 v11, s[8:11], s74 offen offset:3072 sc1 lds
v_mfma_f32_16x16x32_bf16 v[216:219], a[112:115], v[144:147], v[216:219]
v_mul_f32 v232, s57, v208
v_mul_f32 v233, s57, v209
v_mfma_f32_16x16x32_bf16 v[220:223], a[112:115], v[148:151], v[220:223]
s_add_u32 m0, s48, 4096
v_mul_f32 v234, s57, v210
v_mfma_f32_16x16x32_bf16 v[216:219], a[116:119], v[152:155], v[216:219]
buffer_load_dwordx4 v12, s[8:11], s74 offen offset:0 sc1 lds
v_mfma_f32_16x16x32_bf16 v[220:223], a[116:119], v[156:159], v[220:223]
v_mul_f32 v235, s57, v211
v_mfma_f32_16x16x32_bf16 v[216:219], a[120:123], v[160:163], v[216:219]
v_exp_f32 v232, v232
v_mfma_f32_16x16x32_bf16 v[220:223], a[120:123], v[164:167], v[220:223]
buffer_load_dwordx4 v13, s[8:11], s74 offen offset:1024 sc1 lds
v_mfma_f32_16x16x32_bf16 v[216:219], a[124:127], v[168:171], v[216:219]
v_exp_f32 v233, v233
v_mfma_f32_16x16x32_bf16 v[220:223], a[124:127], v[172:175], v[220:223]
v_exp_f32 v234, v234
v_mfma_f32_16x16x32_bf16 v[216:219], a[128:131], v[176:179], v[216:219]
buffer_load_dwordx4 v14, s[8:11], s74 offen offset:2048 sc1 lds
v_mfma_f32_16x16x32_bf16 v[220:223], a[128:131], v[180:183], v[220:223]
v_exp_f32 v235, v235
v_mfma_f32_16x16x32_bf16 v[216:219], a[132:135], v[184:187], v[216:219]
v_add_f32 v232, 1.0, v232
v_add_f32 v233, 1.0, v233
v_mfma_f32_16x16x32_bf16 v[220:223], a[132:135], v[188:191], v[220:223]
buffer_load_dwordx4 v15, s[8:11], s74 offen offset:3072 sc1 lds
v_mfma_f32_16x16x32_bf16 v[216:219], a[136:139], v[192:195], v[216:219]
v_add_f32 v234, 1.0, v234
v_add_f32 v235, 1.0, v235
v_mfma_f32_16x16x32_bf16 v[220:223], a[136:139], v[196:199], v[220:223]
s_add_u32 m0, s48, 8192
v_mfma_f32_16x16x32_bf16 v[216:219], a[140:143], v[200:203], v[216:219]
buffer_load_dwordx4 v16, s[8:11], s74 offen offset:0 sc1 lds
v_mfma_f32_16x16x32_bf16 v[220:223], a[140:143], v[204:207], v[220:223]
v_rcp_f32 v232, v232
v_mfma_f32_16x16x32_bf16 v[224:227], a[144:147], v[64:67], 0
v_rcp_f32 v233, v233
v_mfma_f32_16x16x32_bf16 v[228:231], a[144:147], v[68:71], 0
v_rcp_f32 v234, v234
v_mfma_f32_16x16x32_bf16 v[224:227], a[148:151], v[72:75], v[224:227]
v_rcp_f32 v235, v235
v_mfma_f32_16x16x32_bf16 v[228:231], a[148:151], v[76:79], v[228:231]
v_mul_f32 v212, v208, v212
v_mul_f32 v213, v209, v213
v_mfma_f32_16x16x32_bf16 v[224:227], a[152:155], v[80:83], v[224:227]
buffer_load_dword v24, v22, s[4:7], 0 offen sc1
v_mfma_f32_16x16x32_bf16 v[228:231], a[152:155], v[84:87], v[228:231]
v_mul_f32 v214, v210, v214
v_mul_f32 v215, v211, v215
v_mul_f32 v236, s57, v216
v_mul_f32 v237, s57, v217
v_mul_f32 v238, s57, v218
v_mul_f32 v239, s57, v219
v_exp_f32 v236, v236
v_exp_f32 v237, v237
v_exp_f32 v238, v238
v_exp_f32 v239, v239
v_add_f32 v236, 1.0, v236
v_add_f32 v237, 1.0, v237
v_add_f32 v238, 1.0, v238
v_add_f32 v239, 1.0, v239
v_rcp_f32 v236, v236
v_rcp_f32 v237, v237
v_mfma_f32_16x16x32_bf16 v[224:227], a[156:159], v[88:91], v[224:227]
s_waitcnt vmcnt(10)
s_barrier
v_mfma_f32_16x16x32_bf16 v[228:231], a[156:159], v[92:95], v[228:231]
buffer_store_dword v27, v45, s[4:7], s85 offen
v_mfma_f32_16x16x32_bf16 v[224:227], a[160:163], v[96:99], v[224:227]
buffer_store_dword v27, v44, s[4:7], s85 offen sc1
v_mfma_f32_16x16x32_bf16 v[228:231], a[160:163], v[100:103], v[228:231]
v_mul_f32 v212, v212, v232
v_mul_f32 v213, v213, v233
v_mfma_f32_16x16x32_bf16 v[224:227], a[164:167], v[104:107], v[224:227]
v_mul_f32 v214, v214, v234
v_mul_f32 v215, v215, v235
v_mfma_f32_16x16x32_bf16 v[228:231], a[164:167], v[108:111], v[228:231]
v_cvt_pk_bf16_f32 v48, v212, v213
v_cvt_pk_bf16_f32 v49, v214, v215
v_mfma_f32_16x16x32_bf16 v[224:227], a[168:171], v[112:115], v[224:227]
buffer_store_dwordx2 v[48:49], v19, s[4:7], s93 offen sc1
v_mfma_f32_16x16x32_bf16 v[228:231], a[168:171], v[116:119], v[228:231]
v_rcp_f32 v238, v238
v_mfma_f32_16x16x32_bf16 v[224:227], a[172:175], v[120:123], v[224:227]
v_rcp_f32 v239, v239
v_mfma_f32_16x16x32_bf16 v[228:231], a[172:175], v[124:127], v[228:231]
v_mul_f32 v240, s57, v220
v_mul_f32 v241, s57, v221
v_mfma_f32_16x16x32_bf16 v[224:227], a[176:179], v[128:131], v[224:227]
v_mul_f32 v242, s57, v222
v_mul_f32 v243, s57, v223
v_mfma_f32_16x16x32_bf16 v[228:231], a[176:179], v[132:135], v[228:231]
v_mul_f32 v236, v216, v236
v_mul_f32 v237, v217, v237
v_mfma_f32_16x16x32_bf16 v[224:227], a[180:183], v[136:139], v[224:227]
v_mul_f32 v238, v218, v238
v_mul_f32 v239, v219, v239
v_mfma_f32_16x16x32_bf16 v[228:231], a[180:183], v[140:143], v[228:231]
v_exp_f32 v240, v240
v_mfma_f32_16x16x32_bf16 v[224:227], a[184:187], v[144:147], v[224:227]
v_exp_f32 v241, v241
v_mfma_f32_16x16x32_bf16 v[228:231], a[184:187], v[148:151], v[228:231]
v_exp_f32 v242, v242
v_mfma_f32_16x16x32_bf16 v[224:227], a[188:191], v[152:155], v[224:227]
v_exp_f32 v243, v243
v_mfma_f32_16x16x32_bf16 v[228:231], a[188:191], v[156:159], v[228:231]
v_add_f32 v240, 1.0, v240
v_add_f32 v241, 1.0, v241
v_mfma_f32_16x16x32_bf16 v[224:227], a[192:195], v[160:163], v[224:227]
s_waitcnt vmcnt(11)
s_barrier
v_mfma_f32_16x16x32_bf16 v[228:231], a[192:195], v[164:167], v[228:231]
v_add_f32 v242, 1.0, v242
v_add_f32 v243, 1.0, v243
v_mfma_f32_16x16x32_bf16 v[224:227], a[196:199], v[168:171], v[224:227]
s_cmp_eq_u32 s76, 0
s_cbranch_scc1 g_slow_168
v_mfma_f32_16x16x32_bf16 v[228:231], a[196:199], v[172:175], v[228:231]
v_rcp_f32 v240, v240
ds_read_b128 v[64:67], v28 offset:0
v_mfma_f32_16x16x32_bf16 v[224:227], a[200:203], v[176:179], v[224:227]
v_rcp_f32 v241, v241
ds_read_b128 v[68:71], v28 offset:9216
v_mfma_f32_16x16x32_bf16 v[228:231], a[200:203], v[180:183], v[228:231]
v_rcp_f32 v242, v242
ds_read_b128 v[72:75], v28 offset:18432
v_mfma_f32_16x16x32_bf16 v[224:227], a[204:207], v[184:187], v[224:227]
v_rcp_f32 v243, v243
ds_read_b128 v[76:79], v28 offset:27648
v_mfma_f32_16x16x32_bf16 v[228:231], a[204:207], v[188:191], v[228:231]
v_mul_f32 v240, v220, v240
ds_read_b128 v[80:83], v28 offset:1024
v_mfma_f32_16x16x32_bf16 v[224:227], a[208:211], v[192:195], v[224:227]
v_mul_f32 v241, v221, v241
ds_read_b128 v[84:87], v28 offset:10240
v_mfma_f32_16x16x32_bf16 v[228:231], a[208:211], v[196:199], v[228:231]
v_mul_f32 v242, v222, v242
ds_read_b128 v[88:91], v28 offset:19456
v_mfma_f32_16x16x32_bf16 v[224:227], a[212:215], v[200:203], v[224:227]
v_mul_f32 v243, v223, v243
ds_read_b128 v[92:95], v28 offset:28672
v_mfma_f32_16x16x32_bf16 v[228:231], a[212:215], v[204:207], v[228:231]
s_waitcnt vmcnt(8)
s_barrier
s_branch g_body_153
g_slow_165:
v_mfma_f32_16x16x32_bf16 v[228:231], a[196:199], v[172:175], v[228:231]
v_rcp_f32 v240, v240
v_mfma_f32_16x16x32_bf16 v[224:227], a[200:203], v[176:179], v[224:227]
v_rcp_f32 v241, v241
v_mfma_f32_16x16x32_bf16 v[228:231], a[200:203], v[180:183], v[228:231]
v_rcp_f32 v242, v242
v_mfma_f32_16x16x32_bf16 v[224:227], a[204:207], v[184:187], v[224:227]
v_rcp_f32 v243, v243
v_mfma_f32_16x16x32_bf16 v[228:231], a[204:207], v[188:191], v[228:231]
v_mul_f32 v240, v220, v240
v_mfma_f32_16x16x32_bf16 v[224:227], a[208:211], v[192:195], v[224:227]
v_mul_f32 v241, v221, v241
v_mfma_f32_16x16x32_bf16 v[228:231], a[208:211], v[196:199], v[228:231]
v_mul_f32 v242, v222, v242
v_mfma_f32_16x16x32_bf16 v[224:227], a[212:215], v[200:203], v[224:227]
v_mul_f32 v243, v223, v243
v_mfma_f32_16x16x32_bf16 v[228:231], a[212:215], v[204:207], v[228:231]
s_nop 5
v_mul_f32 v224, v224, v236
v_mul_f32 v225, v225, v237
v_mul_f32 v226, v226, v238
v_mul_f32 v227, v227, v239
v_mul_f32 v228, v228, v240
v_mul_f32 v229, v229, v241
v_mul_f32 v230, v230, v242
v_mul_f32 v231, v231, v243
v_cvt_pk_bf16_f32 v52, v224, v225
v_cvt_pk_bf16_f32 v53, v226, v227
v_cvt_pk_bf16_f32 v54, v228, v229
v_cvt_pk_bf16_f32 v55, v230, v231
s_nop 0
v_permlane16_swap_b32 v52, v54
v_permlane16_swap_b32 v53, v55
buffer_store_dwordx4 v[52:55], v20, s[4:7], s75 offen sc1
s_mov_b32 s75, 1879048192
s_waitcnt vmcnt(4)
ds_write_b32 v18, v24
s_waitcnt lgkmcnt(0)
s_barrier
ds_read_b32 v33, v32
s_waitcnt lgkmcnt(0)
v_cmp_gt_u32 vcc, s52, v33
v_cmp_gt_u32 s[58:59], s54, v33
s_and_b32 vcc_lo, vcc_lo, s56
s_cselect_b32 s70, 0, 1
s_and_b32 s59, s59, s56
s_cselect_b32 s71, 0, s77
s_or_b32 s82, s70, s71
s_cselect_b32 s10, 268435456, 0
s_cmp_lg_u32 s70, 0
s_cselect_b64 s[78:79], s[52:53], s[54:55]
s_cselect_b64 s[58:59], s[44:45], s[46:47]
s_mul_i32 s80, s78, s20
s_add_u32 s80, s80, s58
s_mul_i32 s81, s78, s21
s_add_u32 s81, s81, s59
s_andn2_b32 s71, s71, s70
s_add_u32 s52, s52, s70
s_add_u32 s54, s54, s71
s_mov_b32 s83, s82
s_cmp_lg_u32 s82, 0
s_cbranch_scc1 g_go_169
v_mov_b32 v27, s72
s_waitcnt vmcnt(0)
s_barrier
s_add_u32 s70, s52, s54
s_cmp_eq_u32 s70, 130
s_cbranch_scc1 g_fin_157
s_cmp_lg_u32 s3, 0
s_cbranch_scc1 sp_ok_171_j
s_mov_b32 s23, 0
buffer_load_dword v33, v22, s[4:7], 0 offen sc1
buffer_store_dword v27, v45, s[4:7], s73 offen
buffer_store_dword v27, v44, s[4:7], s73 offen sc1
s_waitcnt vmcnt(2)
s_branch sp_loop_170_e
sp_loop_170:
buffer_load_dword v33, v22, s[4:7], 0 offen sc1
s_add_u32 s23, s23, 1
s_cmp_gt_u32 s23, 150000
s_cbranch_scc1 sp_bad_172
s_waitcnt vmcnt(0)
sp_loop_170_e:
v_cmp_gt_u32 vcc, s52, v33
v_cmp_gt_u32 s[58:59], s54, v33
s_and_b32 vcc_lo, vcc_lo, s56
s_cbranch_scc0 sp_ok_171
s_cmp_gt_u32 s23, 4
s_cselect_b32 s70, 0, s56
s_cmp_lg_u32 s77, 0
s_cselect_b32 s70, 0, s70
s_or_b32 s59, s59, s70
s_and_b32 s59, s59, s56
s_cbranch_scc0 sp_ok_171
s_sleep 1
s_branch sp_loop_170
sp_bad_172:
s_mov_b32 s98, 1028
s_branch L_fail
sp_ok_171:
ds_write_b32 v18, v33
s_waitcnt lgkmcnt(0)
sp_ok_171_j:
s_barrier
ds_read_b32 v33, v32
s_waitcnt lgkmcnt(0)
s_mov_b32 s73, 1879048192
v_cmp_gt_u32 vcc, s52, v33
v_cmp_gt_u32 s[58:59], s54, v33
s_and_b32 vcc_lo, vcc_lo, s56
s_cselect_b32 s70, 0, 1
s_and_b32 s59, s59, s56
s_cselect_b32 s71, 0, 1
s_or_b32 s82, s70, s71
s_cselect_b32 s10, 268435456, 0
s_cmp_lg_u32 s70, 0
s_cselect_b64 s[78:79], s[52:53], s[54:55]
s_cselect_b64 s[58:59], s[44:45], s[46:47]
s_mul_i32 s80, s78, s20
s_add_u32 s80, s80, s58
s_mul_i32 s81, s78, s21
s_add_u32 s81, s81, s59
s_andn2_b32 s71, s71, s70
s_add_u32 s52, s52, s70
s_add_u32 s54, s54, s71
s_mov_b32 s83, s82
g_go_169:
s_add_u32 m0, s49, 0
s_nop 0
buffer_load_dwordx4 v8, s[4:7], s80 offen offset:0 sc1 lds
buffer_load_dwordx4 v9, s[4:7], s80 offen offset:1024 sc1 lds
buffer_load_dwordx4 v10, s[4:7], s80 offen offset:2048 sc1 lds
buffer_load_dwordx4 v11, s[4:7], s80 offen offset:3072 sc1 lds
s_add_u32 m0, s49, 4096
s_nop 0
buffer_load_dwordx4 v12, s[4:7], s80 offen offset:0 sc1 lds
buffer_load_dwordx4 v13, s[4:7], s80 offen offset:1024 sc1 lds
buffer_load_dwordx4 v14, s[4:7], s80 offen offset:2048 sc1 lds
buffer_load_dwordx4 v15, s[4:7], s80 offen offset:3072 sc1 lds
s_add_u32 m0, s49, 8192
s_nop 0
buffer_load_dwordx4 v16, s[4:7], s80 offen offset:0 sc1 lds
buffer_load_dword v24, v22, s[4:7], 0 offen sc1
buffer_store_dword v27, v34, s[4:7], 0 offen
v_mov_b32 v27, s72
s_waitcnt vmcnt(9)
s_barrier
buffer_store_dword v27, v45, s[4:7], s73 offen
buffer_store_dword v27, v44, s[4:7], s73 offen sc1
s_mov_b32 s73, 1879048192
ds_read_b128 v[64:67], v29 offset:0
ds_read_b128 v[68:71], v29 offset:9216
ds_read_b128 v[72:75], v29 offset:18432
ds_read_b128 v[76:79], v29 offset:27648
ds_read_b128 v[80:83], v29 offset:1024
ds_read_b128 v[84:87], v29 offset:10240
ds_read_b128 v[88:91], v29 offset:19456
ds_read_b128 v[92:95], v29 offset:28672
s_waitcnt vmcnt(8)
s_barrier
s_branch g_body_154
g_slow_166:
v_mfma_f32_16x16x32_bf16 v[228:231], a[196:199], v[172:175], v[228:231]
v_rcp_f32 v240, v240
v_mfma_f32_16x16x32_bf16 v[224:227], a[200:203], v[176:179], v[224:227]
v_rcp_f32 v241, v241
v_mfma_f32_16x16x32_bf16 v[228:231], a[200:203], v[180:183], v[228:231]
v_rcp_f32 v242, v242
v_mfma_f32_16x16x32_bf16 v[224:227], a[204:207], v[184:187], v[224:227]
v_rcp_f32 v243, v243
v_mfma_f32_16x16x32_bf16 v[228:231], a[204:207], v[188:191], v[228:231]
v_mul_f32 v240, v220, v240
v_mfma_f32_16x16x32_bf16 v[224:227], a[208:211], v[192:195], v[224:227]
v_mul_f32 v241, v221, v241
v_mfma_f32_16x16x32_bf16 v[228:231], a[208:211], v[196:199], v[228:231]
v_mul_f32 v242, v222, v242
v_mfma_f32_16x16x32_bf16 v[224:227], a[212:215], v[200:203], v[224:227]
v_mul_f32 v243, v223, v243
v_mfma_f32_16x16x32_bf16 v[228:231], a[212:215], v[204:207], v[228:231]
s_nop 5
v_mul_f32 v224, v224, v236
v_mul_f32 v225, v225, v237
v_mul_f32 v226, v226, v238
v_mul_f32 v227, v227, v239
v_mul_f32 v228, v228, v240
v_mul_f32 v229, v229, v241
v_mul_f32 v230, v230, v242
v_mul_f32 v231, v231, v243
v_cvt_pk_bf16_f32 v52, v224, v225
v_cvt_pk_bf16_f32 v53, v226, v227
v_cvt_pk_bf16_f32 v54, v228, v229
v_cvt_pk_bf16_f32 v55, v230, v231
s_nop 0
v_permlane16_swap_b32 v52, v54
v_permlane16_swap_b32 v53, v55
buffer_store_dwordx4 v[52:55], v20, s[4:7], s81 offen sc1
s_mov_b32 s81, 1879048192
s_waitcnt vmcnt(4)
ds_write_b32 v18, v24
s_waitcnt lgkmcnt(0)
s_barrier
ds_read_b32 v33, v32
s_waitcnt lgkmcnt(0)
v_cmp_gt_u32 vcc, s52, v33
v_cmp_gt_u32 s[58:59], s54, v33
s_and_b32 vcc_lo, vcc_lo, s56
s_cselect_b32 s70, 0, 1
s_and_b32 s59, s59, s56
s_cselect_b32 s71, 0, s83
s_or_b32 s88, s70, s71
s_cselect_b32 s10, 268435456, 0
s_cmp_lg_u32 s70, 0
s_cselect_b64 s[84:85], s[52:53], s[54:55]
s_cselect_b64 s[58:59], s[44:45], s[46:47]
s_mul_i32 s86, s84, s20
s_add_u32 s86, s86, s58
s_mul_i32 s87, s84, s21
s_add_u32 s87, s87, s59
s_andn2_b32 s71, s71, s70
s_add_u32 s52, s52, s70
s_add_u32 s54, s54, s71
s_mov_b32 s89, s88
s_cmp_lg_u32 s88, 0
s_cbranch_scc1 g_go_173
v_mov_b32 v27, s78
s_waitcnt vmcnt(0)
s_barrier
s_add_u32 s70, s52, s54
s_cmp_eq_u32 s70, 130
s_cbranch_scc1 g_fin_157
s_cmp_lg_u32 s3, 0
s_cbranch_scc1 sp_ok_175_j
s_mov_b32 s23, 0
buffer_load_dword v33, v22, s[4:7], 0 offen sc1
buffer_store_dword v27, v45, s[4:7], s79 offen
buffer_store_dword v27, v44, s[4:7], s79 offen sc1
s_waitcnt vmcnt(2)
s_branch sp_loop_174_e
sp_loop_174:
buffer_load_dword v33, v22, s[4:7], 0 offen sc1
s_add_u32 s23, s23, 1
s_cmp_gt_u32 s23, 150000
s_cbranch_scc1 sp_bad_176
s_waitcnt vmcnt(0)
sp_loop_174_e:
v_cmp_gt_u32 vcc, s52, v33
v_cmp_gt_u32 s[58:59], s54, v33
s_and_b32 vcc_lo, vcc_lo, s56
s_cbranch_scc0 sp_ok_175
s_cmp_gt_u32 s23, 4
s_cselect_b32 s70, 0, s56
s_cmp_lg_u32 s83, 0
s_cselect_b32 s70, 0, s70
s_or_b32 s59, s59, s70
s_and_b32 s59, s59, s56
s_cbranch_scc0 sp_ok_175
s_sleep 1
s_branch sp_loop_174
sp_bad_176:
s_mov_b32 s98, 1028
s_branch L_fail
sp_ok_175:
ds_write_b32 v18, v33
s_waitcnt lgkmcnt(0)
sp_ok_175_j:
s_barrier
ds_read_b32 v33, v32
s_waitcnt lgkmcnt(0)
s_mov_b32 s79, 1879048192
v_cmp_gt_u32 vcc, s52, v33
v_cmp_gt_u32 s[58:59], s54, v33
s_and_b32 vcc_lo, vcc_lo, s56
s_cselect_b32 s70, 0, 1
s_and_b32 s59, s59, s56
s_cselect_b32 s71, 0, 1
s_or_b32 s88, s70, s71
s_cselect_b32 s10, 268435456, 0
s_cmp_lg_u32 s70, 0
s_cselect_b64 s[84:85], s[52:53], s[54:55]
s_cselect_b64 s[58:59], s[44:45], s[46:47]
s_mul_i32 s86, s84, s20
s_add_u32 s86, s86, s58
s_mul_i32 s87, s84, s21
s_add_u32 s87, s87, s59
s_andn2_b32 s71, s71, s70
s_add_u32 s52, s52, s70
s_add_u32 s54, s54, s71
s_mov_b32 s89, s88
g_go_173:
s_add_u32 m0, s50, 0
s_nop 0
buffer_load_dwordx4 v8, s[4:7], s86 offen offset:0 sc1 lds
buffer_load_dwordx4 v9, s[4:7], s86 offen offset:1024 sc1 lds
buffer_load_dwordx4 v10, s[4:7], s86 offen offset:2048 sc1 lds
buffer_load_dwordx4 v11, s[4:7], s86 offen offset:3072 sc1 lds
s_add_u32 m0, s50, 4096
s_nop 0
buffer_load_dwordx4 v12, s[4:7], s86 offen offset:0 sc1 lds
buffer_load_dwordx4 v13, s[4:7], s86 offen offset:1024 sc1 lds
buffer_load_dwordx4 v14, s[4:7], s86 offen offset:2048 sc1 lds
buffer_load_dwordx4 v15, s[4:7], s86 offen offset:3072 sc1 lds
s_add_u32 m0, s50, 8192
s_nop 0
buffer_load_dwordx4 v16, s[4:7], s86 offen offset:0 sc1 lds
buffer_load_dword v24, v22, s[4:7], 0 offen sc1
buffer_store_dword v27, v34, s[4:7], 0 offen
v_mov_b32 v27, s78
s_waitcnt vmcnt(9)
s_barrier
buffer_store_dword v27, v45, s[4:7], s79 offen
buffer_store_dword v27, v44, s[4:7], s79 offen sc1
s_mov_b32 s79, 1879048192
ds_read_b128 v[64:67], v30 offset:0
ds_read_b128 v[68:71], v30 offset:9216
ds_read_b128 v[72:75], v30 offset:18432
ds_read_b128 v[76:79], v30 offset:27648
ds_read_b128 v[80:83], v30 offset:1024
ds_read_b128 v[84:87], v30 offset:10240
ds_read_b128 v[88:91], v30 offset:19456
ds_read_b128 v[92:95], v30 offset:28672
s_waitcnt vmcnt(8)
s_barrier
s_branch g_body_155
g_slow_167:
v_mfma_f32_16x16x32_bf16 v[228:231], a[196:199], v[172:175], v[228:231]
v_rcp_f32 v240, v240
v_mfma_f32_16x16x32_bf16 v[224:227], a[200:203], v[176:179], v[224:227]
v_rcp_f32 v241, v241
v_mfma_f32_16x16x32_bf16 v[228:231], a[200:203], v[180:183], v[228:231]
v_rcp_f32 v242, v242
v_mfma_f32_16x16x32_bf16 v[224:227], a[204:207], v[184:187], v[224:227]
v_rcp_f32 v243, v243
v_mfma_f32_16x16x32_bf16 v[228:231], a[204:207], v[188:191], v[228:231]
v_mul_f32 v240, v220, v240
v_mfma_f32_16x16x32_bf16 v[224:227], a[208:211], v[192:195], v[224:227]
v_mul_f32 v241, v221, v241
v_mfma_f32_16x16x32_bf16 v[228:231], a[208:211], v[196:199], v[228:231]
v_mul_f32 v242, v222, v242
v_mfma_f32_16x16x32_bf16 v[224:227], a[212:215], v[200:203], v[224:227]
v_mul_f32 v243, v223, v243
v_mfma_f32_16x16x32_bf16 v[228:231], a[212:215], v[204:207], v[228:231]
s_nop 5
v_mul_f32 v224, v224, v236
v_mul_f32 v225, v225, v237
v_mul_f32 v226, v226, v238
v_mul_f32 v227, v227, v239
v_mul_f32 v228, v228, v240
v_mul_f32 v229, v229, v241
v_mul_f32 v230, v230, v242
v_mul_f32 v231, v231, v243
v_cvt_pk_bf16_f32 v52, v224, v225
v_cvt_pk_bf16_f32 v53, v226, v227
v_cvt_pk_bf16_f32 v54, v228, v229
v_cvt_pk_bf16_f32 v55, v230, v231
s_nop 0
v_permlane16_swap_b32 v52, v54
v_permlane16_swap_b32 v53, v55
buffer_store_dwordx4 v[52:55], v20, s[4:7], s87 offen sc1
s_mov_b32 s87, 1879048192
s_waitcnt vmcnt(4)
ds_write_b32 v18, v24
s_waitcnt lgkmcnt(0)
s_barrier
ds_read_b32 v33, v32
s_waitcnt lgkmcnt(0)
v_cmp_gt_u32 vcc, s52, v33
v_cmp_gt_u32 s[58:59], s54, v33
s_and_b32 vcc_lo, vcc_lo, s56
s_cselect_b32 s70, 0, 1
s_and_b32 s59, s59, s56
s_cselect_b32 s71, 0, s89
s_or_b32 s94, s70, s71
s_cselect_b32 s10, 268435456, 0
s_cmp_lg_u32 s70, 0
s_cselect_b64 s[90:91], s[52:53], s[54:55]
s_cselect_b64 s[58:59], s[44:45], s[46:47]
s_mul_i32 s92, s90, s20
s_add_u32 s92, s92, s58
s_mul_i32 s93, s90, s21
s_add_u32 s93, s93, s59
s_andn2_b32 s71, s71, s70
s_add_u32 s52, s52, s70
s_add_u32 s54, s54, s71
s_mov_b32 s95, s94
s_cmp_lg_u32 s94, 0
s_cbranch_scc1 g_go_177
v_mov_b32 v27, s84
s_waitcnt vmcnt(0)
s_barrier
s_add_u32 s70, s52, s54
s_cmp_eq_u32 s70, 130
s_cbranch_scc1 g_fin_157
s_cmp_lg_u32 s3, 0
s_cbranch_scc1 sp_ok_179_j
s_mov_b32 s23, 0
buffer_load_dword v33, v22, s[4:7], 0 offen sc1
buffer_store_dword v27, v45, s[4:7], s85 offen
buffer_store_dword v27, v44, s[4:7], s85 offen sc1
s_waitcnt vmcnt(2)
s_branch sp_loop_178_e
sp_loop_178:
buffer_load_dword v33, v22, s[4:7], 0 offen sc1
s_add_u32 s23, s23, 1
s_cmp_gt_u32 s23, 150000
s_cbranch_scc1 sp_bad_180
s_waitcnt vmcnt(0)
sp_loop_178_e:
v_cmp_gt_u32 vcc, s52, v33
v_cmp_gt_u32 s[58:59], s54, v33
s_and_b32 vcc_lo, vcc_lo, s56
s_cbranch_scc0 sp_ok_179
s_cmp_gt_u32 s23, 4
s_cselect_b32 s70, 0, s56
s_cmp_lg_u32 s89, 0
s_cselect_b32 s70, 0, s70
s_or_b32 s59, s59, s70
s_and_b32 s59, s59, s56
s_cbranch_scc0 sp_ok_179
s_sleep 1
s_branch sp_loop_178
sp_bad_180:
s_mov_b32 s98, 1028
s_branch L_fail
sp_ok_179:
ds_write_b32 v18, v33
s_waitcnt lgkmcnt(0)
sp_ok_179_j:
s_barrier
ds_read_b32 v33, v32
s_waitcnt lgkmcnt(0)
s_mov_b32 s85, 1879048192
v_cmp_gt_u32 vcc, s52, v33
v_cmp_gt_u32 s[58:59], s54, v33
s_and_b32 vcc_lo, vcc_lo, s56
s_cselect_b32 s70, 0, 1
s_and_b32 s59, s59, s56
s_cselect_b32 s71, 0, 1
s_or_b32 s94, s70, s71
s_cselect_b32 s10, 268435456, 0
s_cmp_lg_u32 s70, 0
s_cselect_b64 s[90:91], s[52:53], s[54:55]
s_cselect_b64 s[58:59], s[44:45], s[46:47]
s_mul_i32 s92, s90, s20
s_add_u32 s92, s92, s58
s_mul_i32 s93, s90, s21
s_add_u32 s93, s93, s59
s_andn2_b32 s71, s71, s70
s_add_u32 s52, s52, s70
s_add_u32 s54, s54, s71
s_mov_b32 s95, s94
g_go_177:
s_add_u32 m0, s51, 0
s_nop 0
buffer_load_dwordx4 v8, s[4:7], s92 offen offset:0 sc1 lds
buffer_load_dwordx4 v9, s[4:7], s92 offen offset:1024 sc1 lds
buffer_load_dwordx4 v10, s[4:7], s92 offen offset:2048 sc1 lds
buffer_load_dwordx4 v11, s[4:7], s92 offen offset:3072 sc1 lds
s_add_u32 m0, s51, 4096
s_nop 0
buffer_load_dwordx4 v12, s[4:7], s92 offen offset:0 sc1 lds
buffer_load_dwordx4 v13, s[4:7], s92 offen offset:1024 sc1 lds
buffer_load_dwordx4 v14, s[4:7], s92 offen offset:2048 sc1 lds
buffer_load_dwordx4 v15, s[4:7], s92 offen offset:3072 sc1 lds
s_add_u32 m0, s51, 8192
s_nop 0
buffer_load_dwordx4 v16, s[4:7], s92 offen offset:0 sc1 lds
buffer_load_dword v24, v22, s[4:7], 0 offen sc1
buffer_store_dword v27, v34, s[4:7], 0 offen
v_mov_b32 v27, s84
s_waitcnt vmcnt(9)
s_barrier
buffer_store_dword v27, v45, s[4:7], s85 offen
buffer_store_dword v27, v44, s[4:7], s85 offen sc1
s_mov_b32 s85, 1879048192
ds_read_b128 v[64:67], v31 offset:0
ds_read_b128 v[68:71], v31 offset:9216
ds_read_b128 v[72:75], v31 offset:18432
ds_read_b128 v[76:79], v31 offset:27648
ds_read_b128 v[80:83], v31 offset:1024
ds_read_b128 v[84:87], v31 offset:10240
ds_read_b128 v[88:91], v31 offset:19456
ds_read_b128 v[92:95], v31 offset:28672
s_waitcnt vmcnt(8)
s_barrier
s_branch g_body_156
g_slow_168:
v_mfma_f32_16x16x32_bf16 v[228:231], a[196:199], v[172:175], v[228:231]
v_rcp_f32 v240, v240
v_mfma_f32_16x16x32_bf16 v[224:227], a[200:203], v[176:179], v[224:227]
v_rcp_f32 v241, v241
v_mfma_f32_16x16x32_bf16 v[228:231], a[200:203], v[180:183], v[228:231]
v_rcp_f32 v242, v242
v_mfma_f32_16x16x32_bf16 v[224:227], a[204:207], v[184:187], v[224:227]
v_rcp_f32 v243, v243
v_mfma_f32_16x16x32_bf16 v[228:231], a[204:207], v[188:191], v[228:231]
v_mul_f32 v240, v220, v240
v_mfma_f32_16x16x32_bf16 v[224:227], a[208:211], v[192:195], v[224:227]
v_mul_f32 v241, v221, v241
v_mfma_f32_16x16x32_bf16 v[228:231], a[208:211], v[196:199], v[228:231]
v_mul_f32 v242, v222, v242
v_mfma_f32_16x16x32_bf16 v[224:227], a[212:215], v[200:203], v[224:227]
v_mul_f32 v243, v223, v243
v_mfma_f32_16x16x32_bf16 v[228:231], a[212:215], v[204:207], v[228:231]
s_nop 5
v_mul_f32 v224, v224, v236
v_mul_f32 v225, v225, v237
v_mul_f32 v226, v226, v238
v_mul_f32 v227, v227, v239
v_mul_f32 v228, v228, v240
v_mul_f32 v229, v229, v241
v_mul_f32 v230, v230, v242
v_mul_f32 v231, v231, v243
v_cvt_pk_bf16_f32 v52, v224, v225
v_cvt_pk_bf16_f32 v53, v226, v227
v_cvt_pk_bf16_f32 v54, v228, v229
v_cvt_pk_bf16_f32 v55, v230, v231
s_nop 0
v_permlane16_swap_b32 v52, v54
v_permlane16_swap_b32 v53, v55
buffer_store_dwordx4 v[52:55], v20, s[4:7], s93 offen sc1
s_mov_b32 s93, 1879048192
s_waitcnt vmcnt(4)
ds_write_b32 v18, v24
s_waitcnt lgkmcnt(0)
s_barrier
ds_read_b32 v33, v32
s_waitcnt lgkmcnt(0)
v_cmp_gt_u32 vcc, s52, v33
v_cmp_gt_u32 s[58:59], s54, v33
s_and_b32 vcc_lo, vcc_lo, s56
s_cselect_b32 s70, 0, 1
s_and_b32 s59, s59, s56
s_cselect_b32 s71, 0, s95
s_or_b32 s76, s70, s71
s_cselect_b32 s10, 268435456, 0
s_cmp_lg_u32 s70, 0
s_cselect_b64 s[72:73], s[52:53], s[54:55]
s_cselect_b64 s[58:59], s[44:45], s[46:47]
s_mul_i32 s74, s72, s20
s_add_u32 s74, s74, s58
s_mul_i32 s75, s72, s21
s_add_u32 s75, s75, s59
s_andn2_b32 s71, s71, s70
s_add_u32 s52, s52, s70
s_add_u32 s54, s54, s71
s_mov_b32 s77, s76
s_cmp_lg_u32 s76, 0
s_cbranch_scc1 g_go_181
v_mov_b32 v27, s90
s_waitcnt vmcnt(0)
s_barrier
s_add_u32 s70, s52, s54
s_cmp_eq_u32 s70, 130
s_cbranch_scc1 g_fin_157
s_cmp_lg_u32 s3, 0
s_cbranch_scc1 sp_ok_183_j
s_mov_b32 s23, 0
buffer_load_dword v33, v22, s[4:7], 0 offen sc1
buffer_store_dword v27, v45, s[4:7], s91 offen
buffer_store_dword v27, v44, s[4:7], s91 offen sc1
s_waitcnt vmcnt(2)
s_branch sp_loop_182_e
sp_loop_182:
buffer_load_dword v33, v22, s[4:7], 0 offen sc1
s_add_u32 s23, s23, 1
s_cmp_gt_u32 s23, 150000
s_cbranch_scc1 sp_bad_184
s_waitcnt vmcnt(0)
sp_loop_182_e:
v_cmp_gt_u32 vcc, s52, v33
v_cmp_gt_u32 s[58:59], s54, v33
s_and_b32 vcc_lo, vcc_lo, s56
s_cbranch_scc0 sp_ok_183
s_cmp_gt_u32 s23, 4
s_cselect_b32 s70, 0, s56
s_cmp_lg_u32 s95, 0
s_cselect_b32 s70, 0, s70
s_or_b32 s59, s59, s70
s_and_b32 s59, s59, s56
s_cbranch_scc0 sp_ok_183
s_sleep 1
s_branch sp_loop_182
sp_bad_184:
s_mov_b32 s98, 1028
s_branch L_fail
sp_ok_183:
ds_write_b32 v18, v33
s_waitcnt lgkmcnt(0)
sp_ok_183_j:
s_barrier
ds_read_b32 v33, v32
s_waitcnt lgkmcnt(0)
s_mov_b32 s91, 1879048192
v_cmp_gt_u32 vcc, s52, v33
v_cmp_gt_u32 s[58:59], s54, v33
s_and_b32 vcc_lo, vcc_lo, s56
s_cselect_b32 s70, 0, 1
s_and_b32 s59, s59, s56
s_cselect_b32 s71, 0, 1
s_or_b32 s76, s70, s71
s_cselect_b32 s10, 268435456, 0
s_cmp_lg_u32 s70, 0
s_cselect_b64 s[72:73], s[52:53], s[54:55]
s_cselect_b64 s[58:59], s[44:45], s[46:47]
s_mul_i32 s74, s72, s20
s_add_u32 s74, s74, s58
s_mul_i32 s75, s72, s21
s_add_u32 s75, s75, s59
s_andn2_b32 s71, s71, s70
s_add_u32 s52, s52, s70
s_add_u32 s54, s54, s71
s_mov_b32 s77, s76
g_go_181:
s_add_u32 m0, s48, 0
s_nop 0
buffer_load_dwordx4 v8, s[4:7], s74 offen offset:0 sc1 lds
buffer_load_dwordx4 v9, s[4:7], s74 offen offset:1024 sc1 lds
buffer_load_dwordx4 v10, s[4:7], s74 offen offset:2048 sc1 lds
buffer_load_dwordx4 v11, s[4:7], s74 offen offset:3072 sc1 lds
s_add_u32 m0, s48, 4096
s_nop 0
buffer_load_dwordx4 v12, s[4:7], s74 offen offset:0 sc1 lds
buffer_load_dwordx4 v13, s[4:7], s74 offen offset:1024 sc1 lds
buffer_load_dwordx4 v14, s[4:7], s74 offen offset:2048 sc1 lds
buffer_load_dwordx4 v15, s[4:7], s74 offen offset:3072 sc1 lds
s_add_u32 m0, s48, 8192
s_nop 0
buffer_load_dwordx4 v16, s[4:7], s74 offen offset:0 sc1 lds
buffer_load_dword v24, v22, s[4:7], 0 offen sc1
buffer_store_dword v27, v34, s[4:7], 0 offen
v_mov_b32 v27, s90
s_waitcnt vmcnt(9)
s_barrier
buffer_store_dword v27, v45, s[4:7], s91 offen
buffer_store_dword v27, v44, s[4:7], s91 offen sc1
s_mov_b32 s91, 1879048192
ds_read_b128 v[64:67], v28 offset:0
ds_read_b128 v[68:71], v28 offset:9216
ds_read_b128 v[72:75], v28 offset:18432
ds_read_b128 v[76:79], v28 offset:27648
ds_read_b128 v[80:83], v28 offset:1024
ds_read_b128 v[84:87], v28 offset:10240
ds_read_b128 v[88:91], v28 offset:19456
ds_read_b128 v[92:95], v28 offset:28672
s_waitcnt vmcnt(8)
s_barrier
s_branch g_body_153
g_fin_157:
buffer_store_dword v27, v45, s[4:7], s91 offen
buffer_store_dword v27, v44, s[4:7], s91 offen sc1
s_endpgm
H_att:
s_lshr_b32 s75, s74, 1
s_and_b32 s76, s74, 1
s_lshl_b32 s44, s75, 2
s_add_u32 s44, s44, s3
s_mul_i32 s52, s76, 32768
s_mul_i32 s46, s76, 50331648
s_add_u32 s46, s46, 10821632
s_mul_i32 s49, s44, 24576
s_add_u32 s46, s46, s49
s_mul_i32 s47, s76, 8388608
s_add_u32 s47, s47, 111484928
s_mul_i32 s49, s44, 4096
s_add_u32 s47, s47, s49
s_mul_i32 s48, s76, 16777216
s_add_u32 s48, s48, 128262144
s_mul_i32 s49, s44, 8192
s_add_u32 s48, s48, s49
s_mov_b32 s64, s47
s_mov_b32 s50, 0x3e0293ee
v_lshlrev_b32 v8, 4, v0
v_lshlrev_b32 v10, 3, v0
v_add_u32 v10, 2048, v10
v_bfe_u32 v1, v0, 2, 2
v_and_b32 v2, 1, v0
v_lshl_add_u32 v1, v1, 1, v2
v_lshlrev_b32 v1, 4, v1
v_lshrrev_b32 v2, 4, v0
v_lshl_add_u32 v9, v2, 7, v1
v_and_b32 v1, 15, v0
v_lshlrev_b32 v2, 2, v2
v_sub_u32 v1, v1, v2
v_cmp_le_i32 s[56:57], 0, v1
v_cmp_le_i32 s[58:59], 1, v1
v_cmp_le_i32 s[60:61], 2, v1
v_cmp_le_i32 s[62:63], 3, v1
v_mov_b32 v16, 0xff800000
v_mov_b64 v[50:51], 0
v_mov_b32 v57, 0
v_mov_b32 v58, 0
v_mov_b32 v61, 0
v_mov_b32 v62, 0
v_min_u32 v1, 5, v0
v_lshrrev_b32 v2, 1, v1
v_lshlrev_b32 v2, 8, v2
v_and_b32 v1, 1, v1
v_mul_u32_u24 v1, 7, v1
v_add_u32 v1, v1, v2
s_lshl_b32 s49, s44, 3
v_add_u32 v1, s49, v1
v_mul_u32_u24 v1, 43691, v1
v_lshrrev_b32 v1, 19, v1
v_mul_u32_u24 v1, 128, v1
v_add_u32 v1, 2048, v1
v_mov_b32 v7, 2147483632
v_cmp_gt_u32 vcc, 6, v0
s_nop 1
v_cndmask_b32 v11, v7, v1, vcc
s_mul_i32 s49, s44, 128
s_add_u32 s49, s49, 10240
v_mov_b32 v1, s49
v_mov_b32 v7, 2147483632
v_cmp_gt_u32 vcc, 1, v0
s_nop 1
v_cndmask_b32 v124, v7, v1, vcc
v_mov_b64 v[120:121], 0
v_mov_b64 v[122:123], 0
s_mul_i32 s49, s44, 128
s_add_u32 s49, s49, 14336
v_mov_b32 v1, s49
v_mov_b32 v2, 2147483632
v_cmp_eq_u32 vcc, 0, v0
s_nop 1
v_cndmask_b32 v22, v2, v1, vcc
v_add_u32 v23, 65536, v22
s_mov_b32 s45, 0
s_getpc_b64 s[96:97]
pc_185:
s_add_u32 s96, s96, L_writers-pc_185
s_addc_u32 s97, s97, 0
v_subrev_u32 v2, 0, v11
v_lshrrev_b32 v2, 7, v2
v_cmp_gt_u32 vcc, 0x200, v2
s_nop 1
v_cndmask_b32 v2, 0, v2, vcc
global_load_ubyte v2, v2, s[96:97]
s_mov_b32 s12, s40
s_and_b32 s13, s41, 0xffff
s_mov_b32 s14, 256
s_mov_b32 s15, 0x20000
v_lshlrev_b32 v14, 2, v0
v_add_u32 v15, 128, v14
v_cmp_le_u32 vcc, 2, v0
s_nop 1
v_cndmask_b32 v14, v14, v15, vcc
v_mov_b32 v15, 192
v_cmp_eq_u32 vcc, 8, v0
s_nop 1
v_cndmask_b32 v14, v14, v15, vcc
v_mov_b32 v15, 2147483632
v_cmp_lt_u32 vcc, 8, v0
s_nop 1
v_cndmask_b32 v14, v14, v15, vcc
s_mov_b32 s98, 0
wi_loop_186:
buffer_load_dword v15, v14, s[12:15], 0 offen sc1
s_add_u32 s98, s98, 1
s_cmp_gt_u32 s98, 150000
s_cbranch_scc1 wi_bad_188
s_waitcnt vmcnt(0)
v_cmp_eq_u32 vcc, 32, v15
s_nop 0
s_and_b32 s97, vcc_lo, 0x1ff
s_cmp_eq_u32 s97, 0x1ff
s_cbranch_scc1 wi_ok_187
v_cmp_lt_u32 vcc, 32, v15
s_nop 0
s_and_b32 s96, vcc_lo, 0xff
s_cselect_b32 s96, 0x100, 0
s_and_b32 s96, s96, s97
s_cbranch_scc1 wi_over_189
s_sleep 8
s_branch wi_loop_186
wi_bad_188:
s_mov_b32 s98, 512
s_branch L_fail
wi_over_189:
s_mov_b32 s100, 255
wi_ok_187:
v_add_u32 v3, 65536, v11
v_cmp_eq_u32 vcc, s100, v2
s_nop 1
v_cndmask_b32 v11, v11, v3, vcc
v_mov_b32 v3, 2147483632
s_cmp_lg_u32 s100, 255
s_cselect_b64 vcc, -1, 0
v_cndmask_b32 v22, v22, v3, vcc
s_mov_b32 s8, s42
s_and_b32 s9, s43, 0xffff
s_mov_b32 s10, 0
s_mov_b32 s11, 0x20000
s_add_u32 s49, s47, 0
buffer_store_dwordx4 v[120:123], v8, s[4:7], s49 offen offset:0 sc1
buffer_store_dwordx4 v[120:123], v8, s[4:7], s49 offen offset:1024 sc1
buffer_store_dwordx4 v[120:123], v8, s[4:7], s49 offen offset:2048 sc1
buffer_store_dwordx4 v[120:123], v8, s[4:7], s49 offen offset:3072 sc1
s_add_u32 s49, s47, 131072
buffer_store_dwordx4 v[120:123], v8, s[4:7], s49 offen offset:0 sc1
buffer_store_dwordx4 v[120:123], v8, s[4:7], s49 offen offset:1024 sc1
buffer_store_dwordx4 v[120:123], v8, s[4:7], s49 offen offset:2048 sc1
buffer_store_dwordx4 v[120:123], v8, s[4:7], s49 offen offset:3072 sc1
s_add_u32 s49, s47, 262144
buffer_store_dwordx4 v[120:123], v8, s[4:7], s49 offen offset:0 sc1
buffer_store_dwordx4 v[120:123], v8, s[4:7], s49 offen offset:1024 sc1
buffer_store_dwordx4 v[120:123], v8, s[4:7], s49 offen offset:2048 sc1
buffer_store_dwordx4 v[120:123], v8, s[4:7], s49 offen offset:3072 sc1
s_add_u32 s49, s47, 393216
buffer_store_dwordx4 v[120:123], v8, s[4:7], s49 offen offset:0 sc1
buffer_store_dwordx4 v[120:123], v8, s[4:7], s49 offen offset:1024 sc1
buffer_store_dwordx4 v[120:123], v8, s[4:7], s49 offen offset:2048 sc1
buffer_store_dwordx4 v[120:123], v8, s[4:7], s49 offen offset:3072 sc1
s_add_u32 s49, s47, 524288
buffer_store_dwordx4 v[120:123], v8, s[4:7], s49 offen offset:0 sc1
buffer_store_dwordx4 v[120:123], v8, s[4:7], s49 offen offset:1024 sc1
buffer_store_dwordx4 v[120:123], v8, s[4:7], s49 offen offset:2048 sc1
buffer_store_dwordx4 v[120:123], v8, s[4:7], s49 offen offset:3072 sc1
s_add_u32 s49, s47, 655360
buffer_store_dwordx4 v[120:123], v8, s[4:7], s49 offen offset:0 sc1
buffer_store_dwordx4 v[120:123], v8, s[4:7], s49 offen offset:1024 sc1
buffer_store_dwordx4 v[120:123], v8, s[4:7], s49 offen offset:2048 sc1
buffer_store_dwordx4 v[120:123], v8, s[4:7], s49 offen offset:3072 sc1
s_add_u32 s49, s47, 786432
buffer_store_dwordx4 v[120:123], v8, s[4:7], s49 offen offset:0 sc1
buffer_store_dwordx4 v[120:123], v8, s[4:7], s49 offen offset:1024 sc1
buffer_store_dwordx4 v[120:123], v8, s[4:7], s49 offen offset:2048 sc1
buffer_store_dwordx4 v[120:123], v8, s[4:7], s49 offen offset:3072 sc1
s_add_u32 s49, s47, 917504
buffer_store_dwordx4 v[120:123], v8, s[4:7], s49 offen offset:0 sc1
buffer_store_dwordx4 v[120:123], v8, s[4:7], s49 offen offset:1024 sc1
buffer_store_dwordx4 v[120:123], v8, s[4:7], s49 offen offset:2048 sc1
buffer_store_dwordx4 v[120:123], v8, s[4:7], s49 offen offset:3072 sc1
s_waitcnt vmcnt(0)
v_mov_b32 v125, 8
buffer_store_dword v125, v124, s[4:7], s52 offen sc1
s_mov_b32 s98, 0
sp_loop_192:
buffer_load_dword v24, v11, s[4:7], s52 offen sc1
s_add_u32 s98, s98, 1
s_cmp_gt_u32 s98, 150000
s_cbranch_scc1 sp_bad_194
s_waitcnt vmcnt(0)
v_cmp_gt_u32 vcc, 1, v24
s_nop 0
s_and_b32 vcc_lo, vcc_lo, 0x3f
s_cbranch_scc0 sp_ok_193
s_sleep 2
s_branch sp_loop_192
sp_bad_194:
s_mov_b32 s98, 1536
s_branch L_fail
sp_ok_193:
s_add_u32 s54, s46, 0
buffer_load_dwordx4 a[0:3], v8, s[4:7], s54 offen offset:0 sc1
buffer_load_dwordx4 a[4:7], v8, s[4:7], s54 offen offset:1024 sc1
buffer_load_dwordx4 a[8:11], v8, s[4:7], s54 offen offset:2048 sc1
buffer_load_dwordx4 a[12:15], v8, s[4:7], s54 offen offset:3072 sc1
s_add_u32 s54, s46, 4096
buffer_load_dwordx4 a[16:19], v8, s[4:7], s54 offen offset:0 sc1
buffer_load_dwordx4 a[20:23], v8, s[4:7], s54 offen offset:1024 sc1
buffer_load_dwordx4 a[24:27], v8, s[4:7], s54 offen offset:2048 sc1
buffer_load_dwordx4 a[28:31], v8, s[4:7], s54 offen offset:3072 sc1
s_add_u32 s54, s46, 8192
buffer_load_dwordx4 a[32:35], v8, s[4:7], s54 offen offset:0 sc1
buffer_load_dwordx4 a[36:39], v8, s[4:7], s54 offen offset:1024 sc1
buffer_load_dwordx4 a[40:43], v8, s[4:7], s54 offen offset:2048 sc1
buffer_load_dwordx4 a[44:47], v8, s[4:7], s54 offen offset:3072 sc1
s_add_u32 s54, s46, 12288
buffer_load_dwordx4 a[48:51], v8, s[4:7], s54 offen offset:0 sc1
buffer_load_dwordx4 a[52:55], v8, s[4:7], s54 offen offset:1024 sc1
buffer_load_dwordx4 a[56:59], v8, s[4:7], s54 offen offset:2048 sc1
buffer_load_dwordx4 a[60:63], v8, s[4:7], s54 offen offset:3072 sc1
s_add_u32 s54, s46, 16384
buffer_load_dwordx4 a[64:67], v8, s[4:7], s54 offen offset:0 sc1
buffer_load_dwordx4 a[68:71], v8, s[4:7], s54 offen offset:1024 sc1
buffer_load_dwordx4 a[72:75], v8, s[4:7], s54 offen offset:2048 sc1
buffer_load_dwordx4 a[76:79], v8, s[4:7], s54 offen offset:3072 sc1
s_add_u32 s54, s46, 20480
buffer_load_dwordx4 a[80:83], v8, s[4:7], s54 offen offset:0 sc1
buffer_load_dwordx4 a[84:87], v8, s[4:7], s54 offen offset:1024 sc1
buffer_load_dwordx4 a[88:91], v8, s[4:7], s54 offen offset:2048 sc1
buffer_load_dwordx4 a[92:95], v8, s[4:7], s54 offen offset:3072 sc1
s_waitcnt vmcnt(0)
buffer_load_dwordx4 v[64:67], v9, s[4:7], s47 offen offset:0 sc1
buffer_load_dwordx4 v[68:71], v9, s[4:7], s47 offen offset:512 sc1
buffer_load_dwordx4 v[72:75], v9, s[4:7], s47 offen offset:1024 sc1
buffer_load_dwordx4 v[76:79], v9, s[4:7], s47 offen offset:1536 sc1
buffer_load_dwordx2 v[80:81], v10, s[4:7], s47 offen offset:0 sc1
buffer_load_dwordx2 v[82:83], v10, s[4:7], s47 offen offset:512 sc1
buffer_load_dwordx2 v[84:85], v10, s[4:7], s47 offen offset:1024 sc1
buffer_load_dwordx2 v[86:87], v10, s[4:7], s47 offen offset:1536 sc1
v_mfma_f32_16x16x32_bf16 v[28:31], a[32:35], a[0:3], 0
v_mfma_f32_16x16x32_bf16 v[32:35], a[32:35], a[4:7], 0
v_mfma_f32_16x16x32_bf16 v[36:39], a[36:39], a[4:7], 0
v_mfma_f32_16x16x32_bf16 v[28:31], a[40:43], a[8:11], v[28:31]
v_mfma_f32_16x16x32_bf16 v[32:35], a[40:43], a[12:15], v[32:35]
v_mfma_f32_16x16x32_bf16 v[36:39], a[44:47], a[12:15], v[36:39]
v_mfma_f32_16x16x32_bf16 v[28:31], a[48:51], a[16:19], v[28:31]
v_mfma_f32_16x16x32_bf16 v[32:35], a[48:51], a[20:23], v[32:35]
v_mfma_f32_16x16x32_bf16 v[36:39], a[52:55], a[20:23], v[36:39]
v_mfma_f32_16x16x32_bf16 v[28:31], a[56:59], a[24:27], v[28:31]
v_mfma_f32_16x16x32_bf16 v[32:35], a[56:59], a[28:31], v[32:35]
v_mfma_f32_16x16x32_bf16 v[36:39], a[60:63], a[28:31], v[36:39]
s_add_u32 s53, s45, 1
s_nop 4
v_cndmask_b32 v28, v16, v28, s[56:57]
v_cndmask_b32 v29, v16, v29, s[58:59]
v_cndmask_b32 v30, v16, v30, s[60:61]
v_cndmask_b32 v31, v16, v31, s[62:63]
v_cndmask_b32 v36, v16, v36, s[56:57]
v_cndmask_b32 v37, v16, v37, s[58:59]
v_cndmask_b32 v38, v16, v38, s[60:61]
v_cndmask_b32 v39, v16, v39, s[62:63]
v_max3_f32 v18, v32, v33, v34
v_max3_f32 v17, v28, v29, v30
v_max3_f32 v18, v18, v35, v36
v_max_f32 v17, v17, v31
v_max3_f32 v18, v18, v37, v38
v_max_f32 v18, v18, v39
s_waitcnt vmcnt(0)
att_loop_190:
s_mov_b32 s98, 0
s_bfe_u32 s55, s45, 0x10003
s_xor_b32 s55, s55, 1
att_sp_195:
v_xor_b32 v14, s55, v64
v_xor_b32 v19, s55, v80
v_bitop3_b32 v14, v14, v68, s55 bitop3:0xf6
v_bitop3_b32 v19, v19, v82, s55 bitop3:0xf6
v_bitop3_b32 v14, v14, v72, s55 bitop3:0xf6
v_bitop3_b32 v19, v19, v84, s55 bitop3:0xf6
v_bitop3_b32 v14, v14, v76, s55 bitop3:0xf6
v_bitop3_b32 v19, v19, v86, s55 bitop3:0xf6
v_or_b32 v14, v14, v19
v_and_b32 v14, 1, v14
v_cmp_ne_u32 vcc, 0, v14
s_nop 0
s_cbranch_vccz att_ok_196
s_sleep 2
buffer_load_dwordx4 v[64:67], v9, s[4:7], s47 offen offset:0 sc1
buffer_load_dwordx4 v[68:71], v9, s[4:7], s47 offen offset:512 sc1
buffer_load_dwordx4 v[72:75], v9, s[4:7], s47 offen offset:1024 sc1
buffer_load_dwordx4 v[76:79], v9, s[4:7], s47 offen offset:1536 sc1
buffer_load_dwordx2 v[80:81], v10, s[4:7], s47 offen offset:0 sc1
buffer_load_dwordx2 v[82:83], v10, s[4:7], s47 offen offset:512 sc1
buffer_load_dwordx2 v[84:85], v10, s[4:7], s47 offen offset:1024 sc1
buffer_load_dwordx2 v[86:87], v10, s[4:7], s47 offen offset:1536 sc1
buffer_load_dword v24, v11, s[4:7], s52 offen sc1
s_add_u32 s98, s98, 1
s_cmp_gt_u32 s98, 150000
s_cbranch_scc1 att_bad_197
s_waitcnt vmcnt(0)
s_branch att_sp_195
att_bad_197:
s_mov_b32 s98, 1537
s_branch L_fail
att_ok_196:
s_add_u32 s49, s53, 1
v_cmp_gt_u32 vcc, s49, v24
s_nop 0
s_and_b32 vcc_lo, vcc_lo, 0x3f
s_cselect_b32 s51, 0, 1
s_cselect_b32 s10, 0, 268435456
s_add_u32 s46, s46, 786432
s_and_b32 s49, s53, 7
s_mul_i32 s49, s49, 131072
s_add_u32 s47, s64, s49
v_mfma_f32_16x16x32_bf16 v[40:43], v[64:67], a[0:3], 0
v_mfma_f32_16x16x32_bf16 v[44:47], v[64:67], a[4:7], 0
s_add_u32 s54, s46, 0
buffer_load_dwordx4 a[96:99], v8, s[8:11], s54 offen offset:0 sc1
v_mfma_f32_16x16x32_bf16 v[40:43], v[68:71], a[8:11], v[40:43]
v_mfma_f32_16x16x32_bf16 v[44:47], v[68:71], a[12:15], v[44:47]
buffer_load_dwordx4 a[100:103], v8, s[8:11], s54 offen offset:1024 sc1
v_mfma_f32_16x16x32_bf16 v[40:43], v[72:75], a[16:19], v[40:43]
v_mfma_f32_16x16x32_bf16 v[44:47], v[72:75], a[20:23], v[44:47]
buffer_load_dwordx4 a[104:107], v8, s[8:11], s54 offen offset:2048 sc1
v_mfma_f32_16x16x32_bf16 v[40:43], v[76:79], a[24:27], v[40:43]
v_mfma_f32_16x16x32_bf16 v[44:47], v[76:79], a[28:31], v[44:47]
buffer_load_dwordx4 a[108:111], v8, s[8:11], s54 offen offset:3072 sc1
s_add_u32 s54, s46, 4096
buffer_load_dwordx4 a[112:115], v8, s[8:11], s54 offen offset:0 sc1
buffer_load_dwordx4 a[116:119], v8, s[8:11], s54 offen offset:1024 sc1
s_nop 2
v_max3_f32 v17, v17, v40, v41
v_max3_f32 v18, v18, v44, v45
s_nop 1
v_permlane32_swap_b32 v17, v18
v_max_f32 v17, v17, v18
v_mov_b32 v19, v17
s_nop 1
v_permlane16_swap_b32 v17, v19
v_max_f32 v17, v17, v19
v_mul_f32 v17, s50, v17
v_mov_b32 v18, v17
buffer_load_dwordx4 a[120:123], v8, s[8:11], s54 offen offset:2048 sc1
s_nop 0
v_permlane32_swap_b32 v17, v18
v_fma_f32 v28, v28, s50, -v17
v_fma_f32 v29, v29, s50, -v17
v_fma_f32 v30, v30, s50, -v17
v_fma_f32 v31, v31, s50, -v17
v_fma_f32 v40, v40, s50, -v17
v_fma_f32 v41, v41, s50, -v17
v_fma_f32 v32, v32, s50, -v18
v_fma_f32 v33, v33, s50, -v18
v_fma_f32 v34, v34, s50, -v18
v_fma_f32 v35, v35, s50, -v18
v_fma_f32 v36, v36, s50, -v18
v_fma_f32 v37, v37, s50, -v18
v_fma_f32 v38, v38, s50, -v18
v_fma_f32 v39, v39, s50, -v18
v_fma_f32 v44, v44, s50, -v18
v_fma_f32 v45, v45, s50, -v18
buffer_load_dwordx4 a[124:127], v8, s[8:11], s54 offen offset:3072 sc1
v_exp_f32 v28, v28
v_exp_f32 v29, v29
v_exp_f32 v30, v30
v_exp_f32 v31, v31
v_exp_f32 v40, v40
v_exp_f32 v41, v41
s_add_u32 s54, s46, 8192
buffer_load_dwordx4 a[128:131], v8, s[8:11], s54 offen offset:0 sc1
v_exp_f32 v32, v32
v_exp_f32 v33, v33
v_exp_f32 v34, v34
v_exp_f32 v35, v35
v_exp_f32 v36, v36
v_exp_f32 v37, v37
v_exp_f32 v38, v38
v_exp_f32 v39, v39
v_exp_f32 v44, v44
v_exp_f32 v45, v45
buffer_load_dwordx4 a[132:135], v8, s[8:11], s54 offen offset:1024 sc1
v_add_f32 v17, v28, v29
v_add_f32 v18, v32, v33
v_add_f32 v17, v17, v30
v_add_f32 v18, v18, v34
v_add_f32 v17, v17, v31
v_add_f32 v18, v18, v35
v_add_f32 v17, v17, v40
v_add_f32 v18, v18, v36
v_add_f32 v17, v17, v41
v_add_f32 v18, v18, v37
v_add_f32 v18, v18, v38
v_add_f32 v18, v18, v39
v_add_f32 v18, v18, v44
v_add_f32 v18, v18, v45
buffer_load_dwordx4 a[136:139], v8, s[8:11], s54 offen offset:2048 sc1
s_nop 0
v_permlane32_swap_b32 v17, v18
v_add_f32 v17, v17, v18
v_mov_b32 v19, v17
s_nop 1
v_permlane16_swap_b32 v17, v19
v_add_f32 v17, v17, v19
v_rcp_f32 v17, v17
buffer_load_dwordx4 a[140:143], v8, s[8:11], s54 offen offset:3072 sc1
v_mov_b32 v18, v17
s_add_u32 s54, s46, 12288
buffer_load_dwordx4 a[144:147], v8, s[8:11], s54 offen offset:0 sc1
v_permlane32_swap_b32 v17, v18
v_mul_f32 v28, v28, v17
v_mul_f32 v29, v29, v17
v_mul_f32 v30, v30, v17
v_mul_f32 v31, v31, v17
v_mul_f32 v40, v40, v17
v_mul_f32 v41, v41, v17
v_cvt_pk_bf16_f32 v48, v28, v29
v_cvt_pk_bf16_f32 v49, v30, v31
v_cvt_pk_bf16_f32 v56, v40, v41
v_cvt_pk_bf16_f32 v59, v40, v41
buffer_load_dwordx4 a[148:151], v8, s[8:11], s54 offen offset:1024 sc1
v_mul_f32 v32, v32, v18
v_mul_f32 v33, v33, v18
v_mul_f32 v34, v34, v18
v_mul_f32 v35, v35, v18
v_mul_f32 v36, v36, v18
v_mul_f32 v37, v37, v18
v_mul_f32 v38, v38, v18
v_mul_f32 v39, v39, v18
v_mul_f32 v44, v44, v18
v_mul_f32 v45, v45, v18
v_cvt_pk_bf16_f32 v52, v32, v33
v_cvt_pk_bf16_f32 v53, v34, v35
v_cvt_pk_bf16_f32 v54, v36, v37
v_cvt_pk_bf16_f32 v55, v38, v39
v_cvt_pk_bf16_f32 v60, v44, v45
v_cvt_pk_bf16_f32 v63, v44, v45
buffer_load_dwordx4 a[152:155], v8, s[8:11], s54 offen offset:2048 sc1
s_add_u32 s49, s48, 4096
buffer_load_dword v24, v11, s[4:7], s52 offen sc1
v_mfma_f32_16x16x32_bf16 v[128:131], a[64:67], v[48:51], 0
v_mfma_f32_16x16x32_bf16 v[132:135], a[68:71], v[48:51], 0
v_mfma_f32_16x16x16_bf16 v[128:131], v[80:81], v[56:57], v[128:131]
v_mfma_f32_16x16x16_bf16 v[132:135], v[80:81], v[58:59], v[132:135]
v_mfma_f32_16x16x32_bf16 v[136:139], a[72:75], v[48:51], 0
v_mfma_f32_16x16x32_bf16 v[140:143], a[76:79], v[48:51], 0
v_mfma_f32_16x16x16_bf16 v[136:139], v[82:83], v[56:57], v[136:139]
v_mfma_f32_16x16x16_bf16 v[140:143], v[82:83], v[58:59], v[140:143]
v_mfma_f32_16x16x32_bf16 v[144:147], a[80:83], v[48:51], 0
s_nop 1
v_cvt_pk_bf16_f32 v88, v128, v129
v_mfma_f32_16x16x32_bf16 v[148:151], a[84:87], v[48:51], 0
v_cvt_pk_bf16_f32 v89, v130, v131
v_mfma_f32_16x16x16_bf16 v[144:147], v[84:85], v[56:57], v[144:147]
v_cvt_pk_bf16_f32 v90, v132, v133
v_mfma_f32_16x16x16_bf16 v[148:151], v[84:85], v[58:59], v[148:151]
v_cvt_pk_bf16_f32 v91, v134, v135
buffer_store_dwordx4 v[88:91], v8, s[4:7], s48 offen offset:0 sc1
v_mfma_f32_16x16x32_bf16 v[152:155], a[88:91], v[48:51], 0
v_cvt_pk_bf16_f32 v92, v136, v137
v_mfma_f32_16x16x32_bf16 v[156:159], a[92:95], v[48:51], 0
v_cvt_pk_bf16_f32 v93, v138, v139
v_mfma_f32_16x16x16_bf16 v[152:155], v[86:87], v[56:57], v[152:155]
v_cvt_pk_bf16_f32 v94, v140, v141
v_mfma_f32_16x16x16_bf16 v[156:159], v[86:87], v[58:59], v[156:159]
v_cvt_pk_bf16_f32 v95, v142, v143
buffer_store_dwordx4 v[92:95], v8, s[4:7], s48 offen offset:2048 sc1
v_mfma_f32_16x16x32_bf16 v[160:163], a[64:67], v[52:55], 0
v_cvt_pk_bf16_f32 v96, v144, v145
v_mfma_f32_16x16x32_bf16 v[164:167], a[68:71], v[52:55], 0
v_cvt_pk_bf16_f32 v97, v146, v147
v_mfma_f32_16x16x16_bf16 v[160:163], v[80:81], v[60:61], v[160:163]
v_cvt_pk_bf16_f32 v98, v148, v149
v_mfma_f32_16x16x16_bf16 v[164:167], v[80:81], v[62:63], v[164:167]
v_cvt_pk_bf16_f32 v99, v150, v151
buffer_store_dwordx4 v[96:99], v8, s[4:7], s49 offen offset:0 sc1
v_mfma_f32_16x16x32_bf16 v[168:171], a[72:75], v[52:55], 0
v_cvt_pk_bf16_f32 v100, v152, v153
v_mfma_f32_16x16x32_bf16 v[172:175], a[76:79], v[52:55], 0
v_cvt_pk_bf16_f32 v101, v154, v155
v_mfma_f32_16x16x16_bf16 v[168:171], v[82:83], v[60:61], v[168:171]
v_cvt_pk_bf16_f32 v102, v156, v157
v_mfma_f32_16x16x16_bf16 v[172:175], v[82:83], v[62:63], v[172:175]
v_cvt_pk_bf16_f32 v103, v158, v159
buffer_store_dwordx4 v[100:103], v8, s[4:7], s49 offen offset:2048 sc1
v_mfma_f32_16x16x32_bf16 v[176:179], a[80:83], v[52:55], 0
v_cvt_pk_bf16_f32 v104, v160, v161
v_mfma_f32_16x16x32_bf16 v[180:183], a[84:87], v[52:55], 0
v_cvt_pk_bf16_f32 v105, v162, v163
v_mfma_f32_16x16x16_bf16 v[176:179], v[84:85], v[60:61], v[176:179]
v_cvt_pk_bf16_f32 v106, v164, v165
v_mfma_f32_16x16x16_bf16 v[180:183], v[84:85], v[62:63], v[180:183]
v_cvt_pk_bf16_f32 v107, v166, v167
buffer_store_dwordx4 v[104:107], v8, s[4:7], s48 offen offset:1024 sc1
v_mfma_f32_16x16x32_bf16 v[184:187], a[88:91], v[52:55], 0
v_cvt_pk_bf16_f32 v108, v168, v169
v_mfma_f32_16x16x32_bf16 v[188:191], a[92:95], v[52:55], 0
v_cvt_pk_bf16_f32 v109, v170, v171
v_mfma_f32_16x16x16_bf16 v[184:187], v[86:87], v[60:61], v[184:187]
v_cvt_pk_bf16_f32 v110, v172, v173
v_mfma_f32_16x16x16_bf16 v[188:191], v[86:87], v[62:63], v[188:191]
v_cvt_pk_bf16_f32 v111, v174, v175
buffer_store_dwordx4 v[108:111], v8, s[4:7], s48 offen offset:3072 sc1
v_cvt_pk_bf16_f32 v112, v176, v177
v_cvt_pk_bf16_f32 v113, v178, v179
v_cvt_pk_bf16_f32 v114, v180, v181
v_cvt_pk_bf16_f32 v115, v182, v183
buffer_store_dwordx4 v[112:115], v8, s[4:7], s49 offen offset:1024 sc1
v_cvt_pk_bf16_f32 v116, v184, v185
v_cvt_pk_bf16_f32 v117, v186, v187
v_cvt_pk_bf16_f32 v118, v188, v189
v_cvt_pk_bf16_f32 v119, v190, v191
buffer_store_dwordx4 v[116:119], v8, s[4:7], s49 offen offset:3072 sc1
buffer_load_dwordx4 a[156:159], v8, s[8:11], s54 offen offset:3072 sc1
s_add_u32 s54, s46, 16384
buffer_load_dwordx4 a[160:163], v8, s[8:11], s54 offen offset:0 sc1
buffer_load_dwordx4 a[164:167], v8, s[8:11], s54 offen offset:1024 sc1
buffer_load_dwordx4 a[168:171], v8, s[8:11], s54 offen offset:2048 sc1
buffer_load_dwordx4 a[172:175], v8, s[8:11], s54 offen offset:3072 sc1
s_add_u32 s54, s46, 20480
buffer_load_dwordx4 a[176:179], v8, s[8:11], s54 offen offset:0 sc1
buffer_load_dwordx4 a[180:183], v8, s[8:11], s54 offen offset:1024 sc1
buffer_load_dwordx4 a[184:187], v8, s[8:11], s54 offen offset:2048 sc1
buffer_load_dwordx4 a[188:191], v8, s[8:11], s54 offen offset:3072 sc1
s_add_u32 s48, s48, 262144
v_mov_b32 v15, s53
s_mov_b32 s45, s53
s_cmp_eq_u32 s51, 0
s_cbranch_scc1 att_nopre_198
s_waitcnt vmcnt(9)
buffer_store_dword v15, v23, s[4:7], s52 offen
buffer_store_dword v15, v22, s[4:7], s52 offen sc1
buffer_load_dwordx4 v[64:67], v9, s[4:7], s47 offen offset:0 sc1
buffer_load_dwordx4 v[68:71], v9, s[4:7], s47 offen offset:512 sc1
buffer_load_dwordx4 v[72:75], v9, s[4:7], s47 offen offset:1024 sc1
buffer_load_dwordx4 v[76:79], v9, s[4:7], s47 offen offset:1536 sc1
buffer_load_dwordx2 v[80:81], v10, s[4:7], s47 offen offset:0 sc1
buffer_load_dwordx2 v[82:83], v10, s[4:7], s47 offen offset:512 sc1
buffer_load_dwordx2 v[84:85], v10, s[4:7], s47 offen offset:1024 sc1
buffer_load_dwordx2 v[86:87], v10, s[4:7], s47 offen offset:1536 sc1
s_add_u32 s49, s45, 8
v_mov_b32 v125, s49
buffer_store_dword v125, v124, s[4:7], s52 offen sc1
s_waitcnt vmcnt(11)
v_mfma_f32_16x16x32_bf16 v[28:31], a[128:131], a[96:99], 0
v_mfma_f32_16x16x32_bf16 v[32:35], a[128:131], a[100:103], 0
v_mfma_f32_16x16x32_bf16 v[36:39], a[132:135], a[100:103], 0
v_mfma_f32_16x16x32_bf16 v[28:31], a[136:139], a[104:107], v[28:31]
v_mfma_f32_16x16x32_bf16 v[32:35], a[136:139], a[108:111], v[32:35]
v_mfma_f32_16x16x32_bf16 v[36:39], a[140:143], a[108:111], v[36:39]
v_mfma_f32_16x16x32_bf16 v[28:31], a[144:147], a[112:115], v[28:31]
v_mfma_f32_16x16x32_bf16 v[32:35], a[144:147], a[116:119], v[32:35]
v_mfma_f32_16x16x32_bf16 v[36:39], a[148:151], a[116:119], v[36:39]
v_mfma_f32_16x16x32_bf16 v[28:31], a[152:155], a[120:123], v[28:31]
v_mfma_f32_16x16x32_bf16 v[32:35], a[152:155], a[124:127], v[32:35]
v_mfma_f32_16x16x32_bf16 v[36:39], a[156:159], a[124:127], v[36:39]
s_add_u32 s53, s45, 1
s_nop 4
v_cndmask_b32 v28, v16, v28, s[56:57]
v_cndmask_b32 v29, v16, v29, s[58:59]
v_cndmask_b32 v30, v16, v30, s[60:61]
v_cndmask_b32 v31, v16, v31, s[62:63]
v_cndmask_b32 v36, v16, v36, s[56:57]
v_cndmask_b32 v37, v16, v37, s[58:59]
v_cndmask_b32 v38, v16, v38, s[60:61]
v_cndmask_b32 v39, v16, v39, s[62:63]
v_max3_f32 v18, v32, v33, v34
v_max3_f32 v17, v28, v29, v30
v_max3_f32 v18, v18, v35, v36
v_max_f32 v17, v17, v31
v_max3_f32 v18, v18, v37, v38
v_max_f32 v18, v18, v39
s_waitcnt vmcnt(1)
att_j2_199:
s_mov_b32 s98, 0
s_bfe_u32 s55, s45, 0x10003
s_xor_b32 s55, s55, 1
att_sp_200:
v_xor_b32 v14, s55, v64
v_xor_b32 v19, s55, v80
v_bitop3_b32 v14, v14, v68, s55 bitop3:0xf6
v_bitop3_b32 v19, v19, v82, s55 bitop3:0xf6
v_bitop3_b32 v14, v14, v72, s55 bitop3:0xf6
v_bitop3_b32 v19, v19, v84, s55 bitop3:0xf6
v_bitop3_b32 v14, v14, v76, s55 bitop3:0xf6
v_bitop3_b32 v19, v19, v86, s55 bitop3:0xf6
v_or_b32 v14, v14, v19
v_and_b32 v14, 1, v14
v_cmp_ne_u32 vcc, 0, v14
s_nop 0
s_cbranch_vccz att_ok_201
s_sleep 2
buffer_load_dwordx4 v[64:67], v9, s[4:7], s47 offen offset:0 sc1
buffer_load_dwordx4 v[68:71], v9, s[4:7], s47 offen offset:512 sc1
buffer_load_dwordx4 v[72:75], v9, s[4:7], s47 offen offset:1024 sc1
buffer_load_dwordx4 v[76:79], v9, s[4:7], s47 offen offset:1536 sc1
buffer_load_dwordx2 v[80:81], v10, s[4:7], s47 offen offset:0 sc1
buffer_load_dwordx2 v[82:83], v10, s[4:7], s47 offen offset:512 sc1
buffer_load_dwordx2 v[84:85], v10, s[4:7], s47 offen offset:1024 sc1
buffer_load_dwordx2 v[86:87], v10, s[4:7], s47 offen offset:1536 sc1
buffer_load_dword v24, v11, s[4:7], s52 offen sc1
s_add_u32 s98, s98, 1
s_cmp_gt_u32 s98, 150000
s_cbranch_scc1 att_bad_202
s_waitcnt vmcnt(0)
s_branch att_sp_200
att_bad_202:
s_mov_b32 s98, 1537
s_branch L_fail
att_ok_201:
s_add_u32 s49, s53, 1
v_cmp_gt_u32 vcc, s49, v24
s_nop 0
s_and_b32 vcc_lo, vcc_lo, 0x3f
s_cselect_b32 s51, 0, 1
s_cselect_b32 s10, 0, 268435456
s_add_u32 s46, s46, 786432
s_and_b32 s49, s53, 7
s_mul_i32 s49, s49, 131072
s_add_u32 s47, s64, s49
v_mfma_f32_16x16x32_bf16 v[40:43], v[64:67], a[96:99], 0
v_mfma_f32_16x16x32_bf16 v[44:47], v[64:67], a[100:103], 0
s_add_u32 s54, s46, 0
buffer_load_dwordx4 a[0:3], v8, s[8:11], s54 offen offset:0 sc1
v_mfma_f32_16x16x32_bf16 v[40:43], v[68:71], a[104:107], v[40:43]
v_mfma_f32_16x16x32_bf16 v[44:47], v[68:71], a[108:111], v[44:47]
buffer_load_dwordx4 a[4:7], v8, s[8:11], s54 offen offset:1024 sc1
v_mfma_f32_16x16x32_bf16 v[40:43], v[72:75], a[112:115], v[40:43]
v_mfma_f32_16x16x32_bf16 v[44:47], v[72:75], a[116:119], v[44:47]
buffer_load_dwordx4 a[8:11], v8, s[8:11], s54 offen offset:2048 sc1
v_mfma_f32_16x16x32_bf16 v[40:43], v[76:79], a[120:123], v[40:43]
v_mfma_f32_16x16x32_bf16 v[44:47], v[76:79], a[124:127], v[44:47]
buffer_load_dwordx4 a[12:15], v8, s[8:11], s54 offen offset:3072 sc1
s_add_u32 s54, s46, 4096
buffer_load_dwordx4 a[16:19], v8, s[8:11], s54 offen offset:0 sc1
buffer_load_dwordx4 a[20:23], v8, s[8:11], s54 offen offset:1024 sc1
s_nop 2
v_max3_f32 v17, v17, v40, v41
v_max3_f32 v18, v18, v44, v45
s_nop 1
v_permlane32_swap_b32 v17, v18
v_max_f32 v17, v17, v18
v_mov_b32 v19, v17
s_nop 1
v_permlane16_swap_b32 v17, v19
v_max_f32 v17, v17, v19
v_mul_f32 v17, s50, v17
v_mov_b32 v18, v17
buffer_load_dwordx4 a[24:27], v8, s[8:11], s54 offen offset:2048 sc1
s_nop 0
v_permlane32_swap_b32 v17, v18
v_fma_f32 v28, v28, s50, -v17
v_fma_f32 v29, v29, s50, -v17
v_fma_f32 v30, v30, s50, -v17
v_fma_f32 v31, v31, s50, -v17
v_fma_f32 v40, v40, s50, -v17
v_fma_f32 v41, v41, s50, -v17
v_fma_f32 v32, v32, s50, -v18
v_fma_f32 v33, v33, s50, -v18
v_fma_f32 v34, v34, s50, -v18
v_fma_f32 v35, v35, s50, -v18
v_fma_f32 v36, v36, s50, -v18
v_fma_f32 v37, v37, s50, -v18
v_fma_f32 v38, v38, s50, -v18
v_fma_f32 v39, v39, s50, -v18
v_fma_f32 v44, v44, s50, -v18
v_fma_f32 v45, v45, s50, -v18
buffer_load_dwordx4 a[28:31], v8, s[8:11], s54 offen offset:3072 sc1
v_exp_f32 v28, v28
v_exp_f32 v29, v29
v_exp_f32 v30, v30
v_exp_f32 v31, v31
v_exp_f32 v40, v40
v_exp_f32 v41, v41
s_add_u32 s54, s46, 8192
buffer_load_dwordx4 a[32:35], v8, s[8:11], s54 offen offset:0 sc1
v_exp_f32 v32, v32
v_exp_f32 v33, v33
v_exp_f32 v34, v34
v_exp_f32 v35, v35
v_exp_f32 v36, v36
v_exp_f32 v37, v37
v_exp_f32 v38, v38
v_exp_f32 v39, v39
v_exp_f32 v44, v44
v_exp_f32 v45, v45
buffer_load_dwordx4 a[36:39], v8, s[8:11], s54 offen offset:1024 sc1
v_add_f32 v17, v28, v29
v_add_f32 v18, v32, v33
v_add_f32 v17, v17, v30
v_add_f32 v18, v18, v34
v_add_f32 v17, v17, v31
v_add_f32 v18, v18, v35
v_add_f32 v17, v17, v40
v_add_f32 v18, v18, v36
v_add_f32 v17, v17, v41
v_add_f32 v18, v18, v37
v_add_f32 v18, v18, v38
v_add_f32 v18, v18, v39
v_add_f32 v18, v18, v44
v_add_f32 v18, v18, v45
buffer_load_dwordx4 a[40:43], v8, s[8:11], s54 offen offset:2048 sc1
s_nop 0
v_permlane32_swap_b32 v17, v18
v_add_f32 v17, v17, v18
v_mov_b32 v19, v17
s_nop 1
v_permlane16_swap_b32 v17, v19
v_add_f32 v17, v17, v19
v_rcp_f32 v17, v17
buffer_load_dwordx4 a[44:47], v8, s[8:11], s54 offen offset:3072 sc1
v_mov_b32 v18, v17
s_add_u32 s54, s46, 12288
buffer_load_dwordx4 a[48:51], v8, s[8:11], s54 offen offset:0 sc1
v_permlane32_swap_b32 v17, v18
v_mul_f32 v28, v28, v17
v_mul_f32 v29, v29, v17
v_mul_f32 v30, v30, v17
v_mul_f32 v31, v31, v17
v_mul_f32 v40, v40, v17
v_mul_f32 v41, v41, v17
v_cvt_pk_bf16_f32 v48, v28, v29
v_cvt_pk_bf16_f32 v49, v30, v31
v_cvt_pk_bf16_f32 v56, v40, v41
v_cvt_pk_bf16_f32 v59, v40, v41
buffer_load_dwordx4 a[52:55], v8, s[8:11], s54 offen offset:1024 sc1
v_mul_f32 v32, v32, v18
v_mul_f32 v33, v33, v18
v_mul_f32 v34, v34, v18
v_mul_f32 v35, v35, v18
v_mul_f32 v36, v36, v18
v_mul_f32 v37, v37, v18
v_mul_f32 v38, v38, v18
v_mul_f32 v39, v39, v18
v_mul_f32 v44, v44, v18
v_mul_f32 v45, v45, v18
v_cvt_pk_bf16_f32 v52, v32, v33
v_cvt_pk_bf16_f32 v53, v34, v35
v_cvt_pk_bf16_f32 v54, v36, v37
v_cvt_pk_bf16_f32 v55, v38, v39
v_cvt_pk_bf16_f32 v60, v44, v45
v_cvt_pk_bf16_f32 v63, v44, v45
buffer_load_dwordx4 a[56:59], v8, s[8:11], s54 offen offset:2048 sc1
s_add_u32 s49, s48, 4096
buffer_load_dword v24, v11, s[4:7], s52 offen sc1
v_mfma_f32_16x16x32_bf16 v[128:131], a[160:163], v[48:51], 0
v_mfma_f32_16x16x32_bf16 v[132:135], a[164:167], v[48:51], 0
v_mfma_f32_16x16x16_bf16 v[128:131], v[80:81], v[56:57], v[128:131]
v_mfma_f32_16x16x16_bf16 v[132:135], v[80:81], v[58:59], v[132:135]
v_mfma_f32_16x16x32_bf16 v[136:139], a[168:171], v[48:51], 0
v_mfma_f32_16x16x32_bf16 v[140:143], a[172:175], v[48:51], 0
v_mfma_f32_16x16x16_bf16 v[136:139], v[82:83], v[56:57], v[136:139]
v_mfma_f32_16x16x16_bf16 v[140:143], v[82:83], v[58:59], v[140:143]
v_mfma_f32_16x16x32_bf16 v[144:147], a[176:179], v[48:51], 0
s_nop 1
v_cvt_pk_bf16_f32 v88, v128, v129
v_mfma_f32_16x16x32_bf16 v[148:151], a[180:183], v[48:51], 0
v_cvt_pk_bf16_f32 v89, v130, v131
v_mfma_f32_16x16x16_bf16 v[144:147], v[84:85], v[56:57], v[144:147]
v_cvt_pk_bf16_f32 v90, v132, v133
v_mfma_f32_16x16x16_bf16 v[148:151], v[84:85], v[58:59], v[148:151]
v_cvt_pk_bf16_f32 v91, v134, v135
buffer_store_dwordx4 v[88:91], v8, s[4:7], s48 offen offset:0 sc1
v_mfma_f32_16x16x32_bf16 v[152:155], a[184:187], v[48:51], 0
v_cvt_pk_bf16_f32 v92, v136, v137
v_mfma_f32_16x16x32_bf16 v[156:159], a[188:191], v[48:51], 0
v_cvt_pk_bf16_f32 v93, v138, v139
v_mfma_f32_16x16x16_bf16 v[152:155], v[86:87], v[56:57], v[152:155]
v_cvt_pk_bf16_f32 v94, v140, v141
v_mfma_f32_16x16x16_bf16 v[156:159], v[86:87], v[58:59], v[156:159]
v_cvt_pk_bf16_f32 v95, v142, v143
buffer_store_dwordx4 v[92:95], v8, s[4:7], s48 offen offset:2048 sc1
v_mfma_f32_16x16x32_bf16 v[160:163], a[160:163], v[52:55], 0
v_cvt_pk_bf16_f32 v96, v144, v145
v_mfma_f32_16x16x32_bf16 v[164:167], a[164:167], v[52:55], 0
v_cvt_pk_bf16_f32 v97, v146, v147
v_mfma_f32_16x16x16_bf16 v[160:163], v[80:81], v[60:61], v[160:163]
v_cvt_pk_bf16_f32 v98, v148, v149
v_mfma_f32_16x16x16_bf16 v[164:167], v[80:81], v[62:63], v[164:167]
v_cvt_pk_bf16_f32 v99, v150, v151
buffer_store_dwordx4 v[96:99], v8, s[4:7], s49 offen offset:0 sc1
v_mfma_f32_16x16x32_bf16 v[168:171], a[168:171], v[52:55], 0
v_cvt_pk_bf16_f32 v100, v152, v153
v_mfma_f32_16x16x32_bf16 v[172:175], a[172:175], v[52:55], 0
v_cvt_pk_bf16_f32 v101, v154, v155
v_mfma_f32_16x16x16_bf16 v[168:171], v[82:83], v[60:61], v[168:171]
v_cvt_pk_bf16_f32 v102, v156, v157
v_mfma_f32_16x16x16_bf16 v[172:175], v[82:83], v[62:63], v[172:175]
v_cvt_pk_bf16_f32 v103, v158, v159
buffer_store_dwordx4 v[100:103], v8, s[4:7], s49 offen offset:2048 sc1
v_mfma_f32_16x16x32_bf16 v[176:179], a[176:179], v[52:55], 0
v_cvt_pk_bf16_f32 v104, v160, v161
v_mfma_f32_16x16x32_bf16 v[180:183], a[180:183], v[52:55], 0
v_cvt_pk_bf16_f32 v105, v162, v163
v_mfma_f32_16x16x16_bf16 v[176:179], v[84:85], v[60:61], v[176:179]
v_cvt_pk_bf16_f32 v106, v164, v165
v_mfma_f32_16x16x16_bf16 v[180:183], v[84:85], v[62:63], v[180:183]
v_cvt_pk_bf16_f32 v107, v166, v167
buffer_store_dwordx4 v[104:107], v8, s[4:7], s48 offen offset:1024 sc1
v_mfma_f32_16x16x32_bf16 v[184:187], a[184:187], v[52:55], 0
v_cvt_pk_bf16_f32 v108, v168, v169
v_mfma_f32_16x16x32_bf16 v[188:191], a[188:191], v[52:55], 0
v_cvt_pk_bf16_f32 v109, v170, v171
v_mfma_f32_16x16x16_bf16 v[184:187], v[86:87], v[60:61], v[184:187]
v_cvt_pk_bf16_f32 v110, v172, v173
v_mfma_f32_16x16x16_bf16 v[188:191], v[86:87], v[62:63], v[188:191]
v_cvt_pk_bf16_f32 v111, v174, v175
buffer_store_dwordx4 v[108:111], v8, s[4:7], s48 offen offset:3072 sc1
v_cvt_pk_bf16_f32 v112, v176, v177
v_cvt_pk_bf16_f32 v113, v178, v179
v_cvt_pk_bf16_f32 v114, v180, v181
v_cvt_pk_bf16_f32 v115, v182, v183
buffer_store_dwordx4 v[112:115], v8, s[4:7], s49 offen offset:1024 sc1
v_cvt_pk_bf16_f32 v116, v184, v185
v_cvt_pk_bf16_f32 v117, v186, v187
v_cvt_pk_bf16_f32 v118, v188, v189
v_cvt_pk_bf16_f32 v119, v190, v191
buffer_store_dwordx4 v[116:119], v8, s[4:7], s49 offen offset:3072 sc1
buffer_load_dwordx4 a[60:63], v8, s[8:11], s54 offen offset:3072 sc1
s_add_u32 s54, s46, 16384
buffer_load_dwordx4 a[64:67], v8, s[8:11], s54 offen offset:0 sc1
buffer_load_dwordx4 a[68:71], v8, s[8:11], s54 offen offset:1024 sc1
buffer_load_dwordx4 a[72:75], v8, s[8:11], s54 offen offset:2048 sc1
buffer_load_dwordx4 a[76:79], v8, s[8:11], s54 offen offset:3072 sc1
s_add_u32 s54, s46, 20480
buffer_load_dwordx4 a[80:83], v8, s[8:11], s54 offen offset:0 sc1
buffer_load_dwordx4 a[84:87], v8, s[8:11], s54 offen offset:1024 sc1
buffer_load_dwordx4 a[88:91], v8, s[8:11], s54 offen offset:2048 sc1
buffer_load_dwordx4 a[92:95], v8, s[8:11], s54 offen offset:3072 sc1
s_add_u32 s48, s48, 262144
v_mov_b32 v15, s53
s_mov_b32 s45, s53
s_cmp_eq_u32 s51, 0
s_cbranch_scc1 att_nopre_203
s_waitcnt vmcnt(9)
buffer_store_dword v15, v23, s[4:7], s52 offen
buffer_store_dword v15, v22, s[4:7], s52 offen sc1
buffer_load_dwordx4 v[64:67], v9, s[4:7], s47 offen offset:0 sc1
buffer_load_dwordx4 v[68:71], v9, s[4:7], s47 offen offset:512 sc1
buffer_load_dwordx4 v[72:75], v9, s[4:7], s47 offen offset:1024 sc1
buffer_load_dwordx4 v[76:79], v9, s[4:7], s47 offen offset:1536 sc1
buffer_load_dwordx2 v[80:81], v10, s[4:7], s47 offen offset:0 sc1
buffer_load_dwordx2 v[82:83], v10, s[4:7], s47 offen offset:512 sc1
buffer_load_dwordx2 v[84:85], v10, s[4:7], s47 offen offset:1024 sc1
buffer_load_dwordx2 v[86:87], v10, s[4:7], s47 offen offset:1536 sc1
s_add_u32 s49, s45, 8
v_mov_b32 v125, s49
buffer_store_dword v125, v124, s[4:7], s52 offen sc1
s_waitcnt vmcnt(11)
v_mfma_f32_16x16x32_bf16 v[28:31], a[32:35], a[0:3], 0
v_mfma_f32_16x16x32_bf16 v[32:35], a[32:35], a[4:7], 0
v_mfma_f32_16x16x32_bf16 v[36:39], a[36:39], a[4:7], 0
v_mfma_f32_16x16x32_bf16 v[28:31], a[40:43], a[8:11], v[28:31]
v_mfma_f32_16x16x32_bf16 v[32:35], a[40:43], a[12:15], v[32:35]
v_mfma_f32_16x16x32_bf16 v[36:39], a[44:47], a[12:15], v[36:39]
v_mfma_f32_16x16x32_bf16 v[28:31], a[48:51], a[16:19], v[28:31]
v_mfma_f32_16x16x32_bf16 v[32:35], a[48:51], a[20:23], v[32:35]
v_mfma_f32_16x16x32_bf16 v[36:39], a[52:55], a[20:23], v[36:39]
v_mfma_f32_16x16x32_bf16 v[28:31], a[56:59], a[24:27], v[28:31]
v_mfma_f32_16x16x32_bf16 v[32:35], a[56:59], a[28:31], v[32:35]
v_mfma_f32_16x16x32_bf16 v[36:39], a[60:63], a[28:31], v[36:39]
s_add_u32 s53, s45, 1
s_nop 4
v_cndmask_b32 v28, v16, v28, s[56:57]
v_cndmask_b32 v29, v16, v29, s[58:59]
v_cndmask_b32 v30, v16, v30, s[60:61]
v_cndmask_b32 v31, v16, v31, s[62:63]
v_cndmask_b32 v36, v16, v36, s[56:57]
v_cndmask_b32 v37, v16, v37, s[58:59]
v_cndmask_b32 v38, v16, v38, s[60:61]
v_cndmask_b32 v39, v16, v39, s[62:63]
v_max3_f32 v18, v32, v33, v34
v_max3_f32 v17, v28, v29, v30
v_max3_f32 v18, v18, v35, v36
v_max_f32 v17, v17, v31
v_max3_f32 v18, v18, v37, v38
v_max_f32 v18, v18, v39
s_waitcnt vmcnt(1)
att_j2_204:
s_branch att_loop_190
att_nopre_198:
s_waitcnt vmcnt(17)
s_add_u32 s49, s45, 1
v_cmp_gt_u32 vcc, s49, v24
s_nop 0
s_and_b32 vcc_lo, vcc_lo, 0x3f
s_cbranch_scc1 att_still_205
s_add_u32 s54, s46, 0
buffer_load_dwordx4 a[96:99], v8, s[4:7], s54 offen offset:0 sc1
buffer_load_dwordx4 a[100:103], v8, s[4:7], s54 offen offset:1024 sc1
buffer_load_dwordx4 a[104:107], v8, s[4:7], s54 offen offset:2048 sc1
buffer_load_dwordx4 a[108:111], v8, s[4:7], s54 offen offset:3072 sc1
s_add_u32 s54, s46, 4096
buffer_load_dwordx4 a[112:115], v8, s[4:7], s54 offen offset:0 sc1
buffer_load_dwordx4 a[116:119], v8, s[4:7], s54 offen offset:1024 sc1
buffer_load_dwordx4 a[120:123], v8, s[4:7], s54 offen offset:2048 sc1
buffer_load_dwordx4 a[124:127], v8, s[4:7], s54 offen offset:3072 sc1
s_add_u32 s54, s46, 8192
buffer_load_dwordx4 a[128:131], v8, s[4:7], s54 offen offset:0 sc1
buffer_load_dwordx4 a[132:135], v8, s[4:7], s54 offen offset:1024 sc1
buffer_load_dwordx4 a[136:139], v8, s[4:7], s54 offen offset:2048 sc1
buffer_load_dwordx4 a[140:143], v8, s[4:7], s54 offen offset:3072 sc1
s_waitcnt vmcnt(21)
buffer_store_dword v15, v23, s[4:7], s52 offen
buffer_store_dword v15, v22, s[4:7], s52 offen sc1
s_add_u32 s54, s46, 12288
buffer_load_dwordx4 a[144:147], v8, s[4:7], s54 offen offset:0 sc1
buffer_load_dwordx4 a[148:151], v8, s[4:7], s54 offen offset:1024 sc1
buffer_load_dwordx4 a[152:155], v8, s[4:7], s54 offen offset:2048 sc1
buffer_load_dwordx4 a[156:159], v8, s[4:7], s54 offen offset:3072 sc1
buffer_load_dwordx4 v[64:67], v9, s[4:7], s47 offen offset:0 sc1
buffer_load_dwordx4 v[68:71], v9, s[4:7], s47 offen offset:512 sc1
buffer_load_dwordx4 v[72:75], v9, s[4:7], s47 offen offset:1024 sc1
buffer_load_dwordx4 v[76:79], v9, s[4:7], s47 offen offset:1536 sc1
buffer_load_dwordx2 v[80:81], v10, s[4:7], s47 offen offset:0 sc1
buffer_load_dwordx2 v[82:83], v10, s[4:7], s47 offen offset:512 sc1
buffer_load_dwordx2 v[84:85], v10, s[4:7], s47 offen offset:1024 sc1
buffer_load_dwordx2 v[86:87], v10, s[4:7], s47 offen offset:1536 sc1
s_add_u32 s54, s46, 16384
buffer_load_dwordx4 a[160:163], v8, s[4:7], s54 offen offset:0 sc1
buffer_load_dwordx4 a[164:167], v8, s[4:7], s54 offen offset:1024 sc1
buffer_load_dwordx4 a[168:171], v8, s[4:7], s54 offen offset:2048 sc1
buffer_load_dwordx4 a[172:175], v8, s[4:7], s54 offen offset:3072 sc1
s_add_u32 s54, s46, 20480
buffer_load_dwordx4 a[176:179], v8, s[4:7], s54 offen offset:0 sc1
buffer_load_dwordx4 a[180:183], v8, s[4:7], s54 offen offset:1024 sc1
buffer_load_dwordx4 a[184:187], v8, s[4:7], s54 offen offset:2048 sc1
buffer_load_dwordx4 a[188:191], v8, s[4:7], s54 offen offset:3072 sc1
s_add_u32 s49, s45, 8
v_mov_b32 v125, s49
buffer_store_dword v125, v124, s[4:7], s52 offen sc1
s_waitcnt vmcnt(17)
v_mfma_f32_16x16x32_bf16 v[28:31], a[128:131], a[96:99], 0
v_mfma_f32_16x16x32_bf16 v[32:35], a[128:131], a[100:103], 0
v_mfma_f32_16x16x32_bf16 v[36:39], a[132:135], a[100:103], 0
v_mfma_f32_16x16x32_bf16 v[28:31], a[136:139], a[104:107], v[28:31]
v_mfma_f32_16x16x32_bf16 v[32:35], a[136:139], a[108:111], v[32:35]
v_mfma_f32_16x16x32_bf16 v[36:39], a[140:143], a[108:111], v[36:39]
v_mfma_f32_16x16x32_bf16 v[28:31], a[144:147], a[112:115], v[28:31]
v_mfma_f32_16x16x32_bf16 v[32:35], a[144:147], a[116:119], v[32:35]
v_mfma_f32_16x16x32_bf16 v[36:39], a[148:151], a[116:119], v[36:39]
v_mfma_f32_16x16x32_bf16 v[28:31], a[152:155], a[120:123], v[28:31]
v_mfma_f32_16x16x32_bf16 v[32:35], a[152:155], a[124:127], v[32:35]
v_mfma_f32_16x16x32_bf16 v[36:39], a[156:159], a[124:127], v[36:39]
s_add_u32 s53, s45, 1
s_nop 4
v_cndmask_b32 v28, v16, v28, s[56:57]
v_cndmask_b32 v29, v16, v29, s[58:59]
v_cndmask_b32 v30, v16, v30, s[60:61]
v_cndmask_b32 v31, v16, v31, s[62:63]
v_cndmask_b32 v36, v16, v36, s[56:57]
v_cndmask_b32 v37, v16, v37, s[58:59]
v_cndmask_b32 v38, v16, v38, s[60:61]
v_cndmask_b32 v39, v16, v39, s[62:63]
v_max3_f32 v18, v32, v33, v34
v_max3_f32 v17, v28, v29, v30
v_max3_f32 v18, v18, v35, v36
v_max_f32 v17, v17, v31
v_max3_f32 v18, v18, v37, v38
v_max_f32 v18, v18, v39
s_waitcnt vmcnt(1)
s_branch att_j2_199
att_still_205:
s_waitcnt vmcnt(0)
buffer_store_dword v15, v23, s[4:7], s52 offen
buffer_store_dword v15, v22, s[4:7], s52 offen sc1
s_cmp_ge_u32 s45, 64
s_cbranch_scc1 att_done_191
s_add_u32 s49, s45, 8
v_mov_b32 v125, s49
buffer_store_dword v125, v124, s[4:7], s52 offen sc1
s_add_u32 s49, s45, 1
s_mov_b32 s98, 0
sp_loop_206:
buffer_load_dword v24, v11, s[4:7], s52 offen sc1
s_add_u32 s98, s98, 1
s_cmp_gt_u32 s98, 150000
s_cbranch_scc1 sp_bad_208
s_waitcnt vmcnt(0)
v_cmp_gt_u32 vcc, s49, v24
s_nop 0
s_and_b32 vcc_lo, vcc_lo, 0x3f
s_cbranch_scc0 sp_ok_207
s_sleep 2
s_branch sp_loop_206
sp_bad_208:
s_mov_b32 s98, 1536
s_branch L_fail
sp_ok_207:
s_add_u32 s54, s46, 0
buffer_load_dwordx4 a[96:99], v8, s[4:7], s54 offen offset:0 sc1
buffer_load_dwordx4 a[100:103], v8, s[4:7], s54 offen offset:1024 sc1
buffer_load_dwordx4 a[104:107], v8, s[4:7], s54 offen offset:2048 sc1
buffer_load_dwordx4 a[108:111], v8, s[4:7], s54 offen offset:3072 sc1
s_add_u32 s54, s46, 4096
buffer_load_dwordx4 a[112:115], v8, s[4:7], s54 offen offset:0 sc1
buffer_load_dwordx4 a[116:119], v8, s[4:7], s54 offen offset:1024 sc1
buffer_load_dwordx4 a[120:123], v8, s[4:7], s54 offen offset:2048 sc1
buffer_load_dwordx4 a[124:127], v8, s[4:7], s54 offen offset:3072 sc1
s_add_u32 s54, s46, 8192
buffer_load_dwordx4 a[128:131], v8, s[4:7], s54 offen offset:0 sc1
buffer_load_dwordx4 a[132:135], v8, s[4:7], s54 offen offset:1024 sc1
buffer_load_dwordx4 a[136:139], v8, s[4:7], s54 offen offset:2048 sc1
buffer_load_dwordx4 a[140:143], v8, s[4:7], s54 offen offset:3072 sc1
s_add_u32 s54, s46, 12288
buffer_load_dwordx4 a[144:147], v8, s[4:7], s54 offen offset:0 sc1
buffer_load_dwordx4 a[148:151], v8, s[4:7], s54 offen offset:1024 sc1
buffer_load_dwordx4 a[152:155], v8, s[4:7], s54 offen offset:2048 sc1
buffer_load_dwordx4 a[156:159], v8, s[4:7], s54 offen offset:3072 sc1
buffer_load_dwordx4 v[64:67], v9, s[4:7], s47 offen offset:0 sc1
buffer_load_dwordx4 v[68:71], v9, s[4:7], s47 offen offset:512 sc1
buffer_load_dwordx4 v[72:75], v9, s[4:7], s47 offen offset:1024 sc1
buffer_load_dwordx4 v[76:79], v9, s[4:7], s47 offen offset:1536 sc1
buffer_load_dwordx2 v[80:81], v10, s[4:7], s47 offen offset:0 sc1
buffer_load_dwordx2 v[82:83], v10, s[4:7], s47 offen offset:512 sc1
buffer_load_dwordx2 v[84:85], v10, s[4:7], s47 offen offset:1024 sc1
buffer_load_dwordx2 v[86:87], v10, s[4:7], s47 offen offset:1536 sc1
s_add_u32 s54, s46, 16384
buffer_load_dwordx4 a[160:163], v8, s[4:7], s54 offen offset:0 sc1
buffer_load_dwordx4 a[164:167], v8, s[4:7], s54 offen offset:1024 sc1
buffer_load_dwordx4 a[168:171], v8, s[4:7], s54 offen offset:2048 sc1
buffer_load_dwordx4 a[172:175], v8, s[4:7], s54 offen offset:3072 sc1
s_add_u32 s54, s46, 20480
buffer_load_dwordx4 a[176:179], v8, s[4:7], s54 offen offset:0 sc1
buffer_load_dwordx4 a[180:183], v8, s[4:7], s54 offen offset:1024 sc1
buffer_load_dwordx4 a[184:187], v8, s[4:7], s54 offen offset:2048 sc1
buffer_load_dwordx4 a[188:191], v8, s[4:7], s54 offen offset:3072 sc1
s_waitcnt vmcnt(16)
v_mfma_f32_16x16x32_bf16 v[28:31], a[128:131], a[96:99], 0
v_mfma_f32_16x16x32_bf16 v[32:35], a[128:131], a[100:103], 0
v_mfma_f32_16x16x32_bf16 v[36:39], a[132:135], a[100:103], 0
v_mfma_f32_16x16x32_bf16 v[28:31], a[136:139], a[104:107], v[28:31]
v_mfma_f32_16x16x32_bf16 v[32:35], a[136:139], a[108:111], v[32:35]
v_mfma_f32_16x16x32_bf16 v[36:39], a[140:143], a[108:111], v[36:39]
v_mfma_f32_16x16x32_bf16 v[28:31], a[144:147], a[112:115], v[28:31]
v_mfma_f32_16x16x32_bf16 v[32:35], a[144:147], a[116:119], v[32:35]
v_mfma_f32_16x16x32_bf16 v[36:39], a[148:151], a[116:119], v[36:39]
v_mfma_f32_16x16x32_bf16 v[28:31], a[152:155], a[120:123], v[28:31]
v_mfma_f32_16x16x32_bf16 v[32:35], a[152:155], a[124:127], v[32:35]
v_mfma_f32_16x16x32_bf16 v[36:39], a[156:159], a[124:127], v[36:39]
s_add_u32 s53, s45, 1
s_nop 4
v_cndmask_b32 v28, v16, v28, s[56:57]
v_cndmask_b32 v29, v16, v29, s[58:59]
v_cndmask_b32 v30, v16, v30, s[60:61]
v_cndmask_b32 v31, v16, v31, s[62:63]
v_cndmask_b32 v36, v16, v36, s[56:57]
v_cndmask_b32 v37, v16, v37, s[58:59]
v_cndmask_b32 v38, v16, v38, s[60:61]
v_cndmask_b32 v39, v16, v39, s[62:63]
v_max3_f32 v18, v32, v33, v34
v_max3_f32 v17, v28, v29, v30
v_max3_f32 v18, v18, v35, v36
v_max_f32 v17, v17, v31
v_max3_f32 v18, v18, v37, v38
v_max_f32 v18, v18, v39
s_waitcnt vmcnt(0)
s_branch att_j2_199
att_nopre_203:
s_waitcnt vmcnt(17)
s_add_u32 s49, s45, 1
v_cmp_gt_u32 vcc, s49, v24
s_nop 0
s_and_b32 vcc_lo, vcc_lo, 0x3f
s_cbranch_scc1 att_still_209
s_add_u32 s54, s46, 0
buffer_load_dwordx4 a[0:3], v8, s[4:7], s54 offen offset:0 sc1
buffer_load_dwordx4 a[4:7], v8, s[4:7], s54 offen offset:1024 sc1
buffer_load_dwordx4 a[8:11], v8, s[4:7], s54 offen offset:2048 sc1
buffer_load_dwordx4 a[12:15], v8, s[4:7], s54 offen offset:3072 sc1
s_add_u32 s54, s46, 4096
buffer_load_dwordx4 a[16:19], v8, s[4:7], s54 offen offset:0 sc1
buffer_load_dwordx4 a[20:23], v8, s[4:7], s54 offen offset:1024 sc1
buffer_load_dwordx4 a[24:27], v8, s[4:7], s54 offen offset:2048 sc1
buffer_load_dwordx4 a[28:31], v8, s[4:7], s54 offen offset:3072 sc1
s_add_u32 s54, s46, 8192
buffer_load_dwordx4 a[32:35], v8, s[4:7], s54 offen offset:0 sc1
buffer_load_dwordx4 a[36:39], v8, s[4:7], s54 offen offset:1024 sc1
buffer_load_dwordx4 a[40:43], v8, s[4:7], s54 offen offset:2048 sc1
buffer_load_dwordx4 a[44:47], v8, s[4:7], s54 offen offset:3072 sc1
s_waitcnt vmcnt(21)
buffer_store_dword v15, v23, s[4:7], s52 offen
buffer_store_dword v15, v22, s[4:7], s52 offen sc1
s_add_u32 s54, s46, 12288
buffer_load_dwordx4 a[48:51], v8, s[4:7], s54 offen offset:0 sc1
buffer_load_dwordx4 a[52:55], v8, s[4:7], s54 offen offset:1024 sc1
buffer_load_dwordx4 a[56:59], v8, s[4:7], s54 offen offset:2048 sc1
buffer_load_dwordx4 a[60:63], v8, s[4:7], s54 offen offset:3072 sc1
buffer_load_dwordx4 v[64:67], v9, s[4:7], s47 offen offset:0 sc1
buffer_load_dwordx4 v[68:71], v9, s[4:7], s47 offen offset:512 sc1
buffer_load_dwordx4 v[72:75], v9, s[4:7], s47 offen offset:1024 sc1
buffer_load_dwordx4 v[76:79], v9, s[4:7], s47 offen offset:1536 sc1
buffer_load_dwordx2 v[80:81], v10, s[4:7], s47 offen offset:0 sc1
buffer_load_dwordx2 v[82:83], v10, s[4:7], s47 offen offset:512 sc1
buffer_load_dwordx2 v[84:85], v10, s[4:7], s47 offen offset:1024 sc1
buffer_load_dwordx2 v[86:87], v10, s[4:7], s47 offen offset:1536 sc1
s_add_u32 s54, s46, 16384
buffer_load_dwordx4 a[64:67], v8, s[4:7], s54 offen offset:0 sc1
buffer_load_dwordx4 a[68:71], v8, s[4:7], s54 offen offset:1024 sc1
buffer_load_dwordx4 a[72:75], v8, s[4:7], s54 offen offset:2048 sc1
buffer_load_dwordx4 a[76:79], v8, s[4:7], s54 offen offset:3072 sc1
s_add_u32 s54, s46, 20480
buffer_load_dwordx4 a[80:83], v8, s[4:7], s54 offen offset:0 sc1
buffer_load_dwordx4 a[84:87], v8, s[4:7], s54 offen offset:1024 sc1
buffer_load_dwordx4 a[88:91], v8, s[4:7], s54 offen offset:2048 sc1
buffer_load_dwordx4 a[92:95], v8, s[4:7], s54 offen offset:3072 sc1
s_add_u32 s49, s45, 8
v_mov_b32 v125, s49
buffer_store_dword v125, v124, s[4:7], s52 offen sc1
s_waitcnt vmcnt(17)
v_mfma_f32_16x16x32_bf16 v[28:31], a[32:35], a[0:3], 0
v_mfma_f32_16x16x32_bf16 v[32:35], a[32:35], a[4:7], 0
v_mfma_f32_16x16x32_bf16 v[36:39], a[36:39], a[4:7], 0
v_mfma_f32_16x16x32_bf16 v[28:31], a[40:43], a[8:11], v[28:31]
v_mfma_f32_16x16x32_bf16 v[32:35], a[40:43], a[12:15], v[32:35]
v_mfma_f32_16x16x32_bf16 v[36:39], a[44:47], a[12:15], v[36:39]
v_mfma_f32_16x16x32_bf16 v[28:31], a[48:51], a[16:19], v[28:31]
v_mfma_f32_16x16x32_bf16 v[32:35], a[48:51], a[20:23], v[32:35]
v_mfma_f32_16x16x32_bf16 v[36:39], a[52:55], a[20:23], v[36:39]
v_mfma_f32_16x16x32_bf16 v[28:31], a[56:59], a[24:27], v[28:31]
v_mfma_f32_16x16x32_bf16 v[32:35], a[56:59], a[28:31], v[32:35]
v_mfma_f32_16x16x32_bf16 v[36:39], a[60:63], a[28:31], v[36:39]
s_add_u32 s53, s45, 1
s_nop 4
v_cndmask_b32 v28, v16, v28, s[56:57]
v_cndmask_b32 v29, v16, v29, s[58:59]
v_cndmask_b32 v30, v16, v30, s[60:61]
v_cndmask_b32 v31, v16, v31, s[62:63]
v_cndmask_b32 v36, v16, v36, s[56:57]
v_cndmask_b32 v37, v16, v37, s[58:59]
v_cndmask_b32 v38, v16, v38, s[60:61]
v_cndmask_b32 v39, v16, v39, s[62:63]
v_max3_f32 v18, v32, v33, v34
v_max3_f32 v17, v28, v29, v30
v_max3_f32 v18, v18, v35, v36
v_max_f32 v17, v17, v31
v_max3_f32 v18, v18, v37, v38
v_max_f32 v18, v18, v39
s_waitcnt vmcnt(1)
s_branch att_j2_204
att_still_209:
s_waitcnt vmcnt(0)
buffer_store_dword v15, v23, s[4:7], s52 offen
buffer_store_dword v15, v22, s[4:7], s52 offen sc1
s_cmp_ge_u32 s45, 64
s_cbranch_scc1 att_done_191
s_add_u32 s49, s45, 8
v_mov_b32 v125, s49
buffer_store_dword v125, v124, s[4:7], s52 offen sc1
s_add_u32 s49, s45, 1
s_mov_b32 s98, 0
sp_loop_210:
buffer_load_dword v24, v11, s[4:7], s52 offen sc1
s_add_u32 s98, s98, 1
s_cmp_gt_u32 s98, 150000
s_cbranch_scc1 sp_bad_212
s_waitcnt vmcnt(0)
v_cmp_gt_u32 vcc, s49, v24
s_nop 0
s_and_b32 vcc_lo, vcc_lo, 0x3f
s_cbranch_scc0 sp_ok_211
s_sleep 2
s_branch sp_loop_210
sp_bad_212:
s_mov_b32 s98, 1536
s_branch L_fail
sp_ok_211:
s_add_u32 s54, s46, 0
buffer_load_dwordx4 a[0:3], v8, s[4:7], s54 offen offset:0 sc1
buffer_load_dwordx4 a[4:7], v8, s[4:7], s54 offen offset:1024 sc1
buffer_load_dwordx4 a[8:11], v8, s[4:7], s54 offen offset:2048 sc1
buffer_load_dwordx4 a[12:15], v8, s[4:7], s54 offen offset:3072 sc1
s_add_u32 s54, s46, 4096
buffer_load_dwordx4 a[16:19], v8, s[4:7], s54 offen offset:0 sc1
buffer_load_dwordx4 a[20:23], v8, s[4:7], s54 offen offset:1024 sc1
buffer_load_dwordx4 a[24:27], v8, s[4:7], s54 offen offset:2048 sc1
buffer_load_dwordx4 a[28:31], v8, s[4:7], s54 offen offset:3072 sc1
s_add_u32 s54, s46, 8192
buffer_load_dwordx4 a[32:35], v8, s[4:7], s54 offen offset:0 sc1
buffer_load_dwordx4 a[36:39], v8, s[4:7], s54 offen offset:1024 sc1
buffer_load_dwordx4 a[40:43], v8, s[4:7], s54 offen offset:2048 sc1
buffer_load_dwordx4 a[44:47], v8, s[4:7], s54 offen offset:3072 sc1
s_add_u32 s54, s46, 12288
buffer_load_dwordx4 a[48:51], v8, s[4:7], s54 offen offset:0 sc1
buffer_load_dwordx4 a[52:55], v8, s[4:7], s54 offen offset:1024 sc1
buffer_load_dwordx4 a[56:59], v8, s[4:7], s54 offen offset:2048 sc1
buffer_load_dwordx4 a[60:63], v8, s[4:7], s54 offen offset:3072 sc1
buffer_load_dwordx4 v[64:67], v9, s[4:7], s47 offen offset:0 sc1
buffer_load_dwordx4 v[68:71], v9, s[4:7], s47 offen offset:512 sc1
buffer_load_dwordx4 v[72:75], v9, s[4:7], s47 offen offset:1024 sc1
buffer_load_dwordx4 v[76:79], v9, s[4:7], s47 offen offset:1536 sc1
buffer_load_dwordx2 v[80:81], v10, s[4:7], s47 offen offset:0 sc1
buffer_load_dwordx2 v[82:83], v10, s[4:7], s47 offen offset:512 sc1
buffer_load_dwordx2 v[84:85], v10, s[4:7], s47 offen offset:1024 sc1
buffer_load_dwordx2 v[86:87], v10, s[4:7], s47 offen offset:1536 sc1
s_add_u32 s54, s46, 16384
buffer_load_dwordx4 a[64:67], v8, s[4:7], s54 offen offset:0 sc1
buffer_load_dwordx4 a[68:71], v8, s[4:7], s54 offen offset:1024 sc1
buffer_load_dwordx4 a[72:75], v8, s[4:7], s54 offen offset:2048 sc1
buffer_load_dwordx4 a[76:79], v8, s[4:7], s54 offen offset:3072 sc1
s_add_u32 s54, s46, 20480
buffer_load_dwordx4 a[80:83], v8, s[4:7], s54 offen offset:0 sc1
buffer_load_dwordx4 a[84:87], v8, s[4:7], s54 offen offset:1024 sc1
buffer_load_dwordx4 a[88:91], v8, s[4:7], s54 offen offset:2048 sc1
buffer_load_dwordx4 a[92:95], v8, s[4:7], s54 offen offset:3072 sc1
s_waitcnt vmcnt(16)
v_mfma_f32_16x16x32_bf16 v[28:31], a[32:35], a[0:3], 0
v_mfma_f32_16x16x32_bf16 v[32:35], a[32:35], a[4:7], 0
v_mfma_f32_16x16x32_bf16 v[36:39], a[36:39], a[4:7], 0
v_mfma_f32_16x16x32_bf16 v[28:31], a[40:43], a[8:11], v[28:31]
v_mfma_f32_16x16x32_bf16 v[32:35], a[40:43], a[12:15], v[32:35]
v_mfma_f32_16x16x32_bf16 v[36:39], a[44:47], a[12:15], v[36:39]
v_mfma_f32_16x16x32_bf16 v[28:31], a[48:51], a[16:19], v[28:31]
v_mfma_f32_16x16x32_bf16 v[32:35], a[48:51], a[20:23], v[32:35]
v_mfma_f32_16x16x32_bf16 v[36:39], a[52:55], a[20:23], v[36:39]
v_mfma_f32_16x16x32_bf16 v[28:31], a[56:59], a[24:27], v[28:31]
v_mfma_f32_16x16x32_bf16 v[32:35], a[56:59], a[28:31], v[32:35]
v_mfma_f32_16x16x32_bf16 v[36:39], a[60:63], a[28:31], v[36:39]
s_add_u32 s53, s45, 1
s_nop 4
v_cndmask_b32 v28, v16, v28, s[56:57]
v_cndmask_b32 v29, v16, v29, s[58:59]
v_cndmask_b32 v30, v16, v30, s[60:61]
v_cndmask_b32 v31, v16, v31, s[62:63]
v_cndmask_b32 v36, v16, v36, s[56:57]
v_cndmask_b32 v37, v16, v37, s[58:59]
v_cndmask_b32 v38, v16, v38, s[60:61]
v_cndmask_b32 v39, v16, v39, s[62:63]
v_max3_f32 v18, v32, v33, v34
v_max3_f32 v17, v28, v29, v30
v_max3_f32 v18, v18, v35, v36
v_max_f32 v17, v17, v31
v_max3_f32 v18, v18, v37, v38
v_max_f32 v18, v18, v39
s_waitcnt vmcnt(0)
s_branch att_j2_204
att_done_191:
s_endpgm
H_red:
s_mov_b32 s44, s74
s_cmp_lg_u32 s44, 0
s_cbranch_scc1 nozero_213
s_lshl_b32 s46, s3, 15
s_add_u32 s46, s46, 0
v_lshlrev_b32 v2, 4, v0
v_mov_b64 v[4:5], 0
v_mov_b64 v[6:7], 0
buffer_store_dwordx4 v[4:7], v2, s[4:7], s46 offen offset:0 sc1
buffer_store_dwordx4 v[4:7], v2, s[4:7], s46 offen offset:1024 sc1
buffer_store_dwordx4 v[4:7], v2, s[4:7], s46 offen offset:2048 sc1
buffer_store_dwordx4 v[4:7], v2, s[4:7], s46 offen offset:3072 sc1
s_add_u32 s46, s46, 4096
buffer_store_dwordx4 v[4:7], v2, s[4:7], s46 offen offset:0 sc1
buffer_store_dwordx4 v[4:7], v2, s[4:7], s46 offen offset:1024 sc1
buffer_store_dwordx4 v[4:7], v2, s[4:7], s46 offen offset:2048 sc1
buffer_store_dwordx4 v[4:7], v2, s[4:7], s46 offen offset:3072 sc1
s_add_u32 s46, s46, 4096
buffer_store_dwordx4 v[4:7], v2, s[4:7], s46 offen offset:0 sc1
buffer_store_dwordx4 v[4:7], v2, s[4:7], s46 offen offset:1024 sc1
buffer_store_dwordx4 v[4:7], v2, s[4:7], s46 offen offset:2048 sc1
buffer_store_dwordx4 v[4:7], v2, s[4:7], s46 offen offset:3072 sc1
s_add_u32 s46, s46, 4096
buffer_store_dwordx4 v[4:7], v2, s[4:7], s46 offen offset:0 sc1
buffer_store_dwordx4 v[4:7], v2, s[4:7], s46 offen offset:1024 sc1
buffer_store_dwordx4 v[4:7], v2, s[4:7], s46 offen offset:2048 sc1
buffer_store_dwordx4 v[4:7], v2, s[4:7], s46 offen offset:3072 sc1
s_add_u32 s46, s46, 4096
buffer_store_dwordx4 v[4:7], v2, s[4:7], s46 offen offset:0 sc1
buffer_store_dwordx4 v[4:7], v2, s[4:7], s46 offen offset:1024 sc1
buffer_store_dwordx4 v[4:7], v2, s[4:7], s46 offen offset:2048 sc1
buffer_store_dwordx4 v[4:7], v2, s[4:7], s46 offen offset:3072 sc1
s_add_u32 s46, s46, 4096
buffer_store_dwordx4 v[4:7], v2, s[4:7], s46 offen offset:0 sc1
buffer_store_dwordx4 v[4:7], v2, s[4:7], s46 offen offset:1024 sc1
buffer_store_dwordx4 v[4:7], v2, s[4:7], s46 offen offset:2048 sc1
buffer_store_dwordx4 v[4:7], v2, s[4:7], s46 offen offset:3072 sc1
s_add_u32 s46, s46, 4096
buffer_store_dwordx4 v[4:7], v2, s[4:7], s46 offen offset:0 sc1
buffer_store_dwordx4 v[4:7], v2, s[4:7], s46 offen offset:1024 sc1
buffer_store_dwordx4 v[4:7], v2, s[4:7], s46 offen offset:2048 sc1
buffer_store_dwordx4 v[4:7], v2, s[4:7], s46 offen offset:3072 sc1
s_add_u32 s46, s46, 4096
buffer_store_dwordx4 v[4:7], v2, s[4:7], s46 offen offset:0 sc1
buffer_store_dwordx4 v[4:7], v2, s[4:7], s46 offen offset:1024 sc1
buffer_store_dwordx4 v[4:7], v2, s[4:7], s46 offen offset:2048 sc1
buffer_store_dwordx4 v[4:7], v2, s[4:7], s46 offen offset:3072 sc1
s_add_u32 s46, s46, 4096
s_waitcnt vmcnt(0)
s_barrier
s_cmp_lg_u32 s3, 0
s_cbranch_scc1 nozero_213
s_mov_b32 s12, s40
s_and_b32 s13, s41, 0xffff
s_mov_b32 s14, 256
s_mov_b32 s15, 0x20000
v_mov_b32 v2, 32
v_mov_b32 v3, 192
s_mov_b64 exec, 1
buffer_store_dword v2, v3, s[12:15], 0 offen sc1
s_mov_b64 exec, -1
nozero_213:
v_and_b32 v1, 15, v0
v_lshrrev_b32 v2, 4, v0
v_and_b32 v3, 1, v0
v_bfe_u32 v4, v0, 1, 3
v_bfe_u32 v5, v0, 4, 1
v_lshrrev_b32 v6, 5, v0
s_mul_i32 s46, s44, 2304
v_mul_u32_u24 v7, 36864, v2
v_lshl_add_u32 v7, v1, 4, v7
v_add_u32 v8, s46, v7
v_lshlrev_b32 v7, 9, v5
v_lshl_add_u32 v7, v6, 8, v7
v_lshl_add_u32 v7, v1, 4, v7
v_add_u32 v10, s46, v7
v_lshlrev_b32 v7, 4, v1
v_lshl_add_u32 v7, v5, 3, v7
v_add_u32 v11, s46, v7
v_mul_u32_u24 v7, 1152, v3
v_lshl_add_u32 v7, v4, 4, v7
v_add_u32 v7, s46, v7
v_lshl_add_u32 v13, v5, 3, v7
v_lshl_add_u32 v9, v6, 7, v13
v_lshl_add_u32 v7, v6, 7, v7
v_lshl_add_u32 v12, v5, 8, v7
v_lshlrev_b32 v7, 4, v3
v_mov_b32 v22, 0x3f80
v_lshlrev_b32 v7, v7, v22
v_cmp_eq_u32 vcc, 0, v4
s_nop 1
v_cndmask_b32 v28, 0, v7, vcc
v_cmp_eq_u32 vcc, 1, v4
s_nop 1
v_cndmask_b32 v29, 0, v7, vcc
v_cmp_eq_u32 vcc, 2, v4
s_nop 1
v_cndmask_b32 v30, 0, v7, vcc
v_cmp_eq_u32 vcc, 3, v4
s_nop 1
v_cndmask_b32 v31, 0, v7, vcc
v_cmp_eq_u32 vcc, 4, v4
s_nop 1
v_cndmask_b32 v32, 0, v7, vcc
v_cmp_eq_u32 vcc, 5, v4
s_nop 1
v_cndmask_b32 v33, 0, v7, vcc
v_cmp_eq_u32 vcc, 6, v4
s_nop 1
v_cndmask_b32 v34, 0, v7, vcc
v_cmp_eq_u32 vcc, 7, v4
s_nop 1
v_cndmask_b32 v35, 0, v7, vcc
s_mul_i32 s46, s44, 128
v_mov_b32 v1, s46
v_mov_b32 v22, 2147483632
v_cmp_eq_u32 vcc, 0, v0
s_nop 1
v_cndmask_b32 v36, v22, v1, vcc
v_add_u32 v37, 65536, v36
v_lshlrev_b32 v1, 2, v0
v_add_u32 v1, 147456, v1
v_mov_b32 v2, 0
ds_write_b32 v1, v2
v_mov_b32 v14, 147460
s_mov_b32 s8, s20
s_and_b32 s9, s21, 0xffff
s_mov_b32 s10, 2359296
s_mov_b32 s11, 0x20000
s_mov_b32 s16, s38
s_and_b32 s17, s39, 0xffff
s_mov_b32 s18, 2359296
s_mov_b32 s19, 0x20000
s_mov_b32 s45, s3
s_mov_b32 s52, 1384448
s_mov_b32 s50, 0
s_mul_i32 s47, s45, 36864
buffer_load_dwordx2 v[60:61], v9, s[8:11], s47 offen offset:0
buffer_load_dwordx2 v[62:63], v9, s[8:11], s47 offen offset:256
buffer_load_dwordx2 v[64:65], v9, s[8:11], s47 offen offset:512
buffer_load_dwordx2 v[66:67], v9, s[8:11], s47 offen offset:768
v_mov_b64 v[68:69], 0
s_mov_b64 exec, 0xffffffff
buffer_load_dwordx2 v[68:69], v9, s[8:11], s47 offen offset:1024
s_mov_b64 exec, -1
s_waitcnt lgkmcnt(0)
s_barrier
s_mov_b32 s12, s40
s_and_b32 s13, s41, 0xffff
s_mov_b32 s14, 256
s_mov_b32 s15, 0x20000
v_lshlrev_b32 v17, 2, v0
v_add_u32 v18, 128, v17
v_cmp_le_u32 vcc, 2, v0
s_nop 1
v_cndmask_b32 v17, v17, v18, vcc
v_mov_b32 v18, 192
v_cmp_eq_u32 vcc, 8, v0
s_nop 1
v_cndmask_b32 v17, v17, v18, vcc
v_mov_b32 v18, 2147483632
v_cmp_lt_u32 vcc, 8, v0
s_nop 1
v_cndmask_b32 v17, v17, v18, vcc
s_mov_b32 s98, 0
wi_loop_214:
buffer_load_dword v18, v17, s[12:15], 0 offen sc1
s_add_u32 s98, s98, 1
s_cmp_gt_u32 s98, 150000
s_cbranch_scc1 wi_bad_216
s_waitcnt vmcnt(0)
v_cmp_eq_u32 vcc, 32, v18
s_nop 0
s_and_b32 s97, vcc_lo, 0x1ff
s_cmp_eq_u32 s97, 0x1ff
s_cbranch_scc1 wi_ok_215
v_cmp_lt_u32 vcc, 32, v18
s_nop 0
s_and_b32 s96, vcc_lo, 0xff
s_cselect_b32 s96, 0x100, 0
s_and_b32 s96, s96, s97
s_cbranch_scc1 wi_over_217
s_sleep 8
s_branch wi_loop_214
wi_bad_216:
s_mov_b32 s98, 512
s_branch L_fail
wi_over_217:
s_mov_b32 s100, 255
wi_ok_215:
ln0_218:
v_lshlrev_b32 v40, 16, v60
v_and_b32 v41, 0xffff0000, v60
v_lshlrev_b32 v42, 16, v61
v_and_b32 v43, 0xffff0000, v61
v_lshlrev_b32 v44, 16, v62
v_and_b32 v45, 0xffff0000, v62
v_lshlrev_b32 v46, 16, v63
v_and_b32 v47, 0xffff0000, v63
v_lshlrev_b32 v48, 16, v64
v_and_b32 v49, 0xffff0000, v64
v_lshlrev_b32 v50, 16, v65
v_and_b32 v51, 0xffff0000, v65
v_lshlrev_b32 v52, 16, v66
v_and_b32 v53, 0xffff0000, v66
v_lshlrev_b32 v54, 16, v67
v_and_b32 v55, 0xffff0000, v67
v_lshlrev_b32 v56, 16, v68
v_and_b32 v57, 0xffff0000, v68
v_lshlrev_b32 v58, 16, v69
v_and_b32 v59, 0xffff0000, v69
v_mul_f32 v20, v40, v40
v_add_f32 v19, v40, v41
v_fmac_f32 v20, v41, v41
v_add_f32 v19, v19, v42
v_fmac_f32 v20, v42, v42
v_add_f32 v19, v19, v43
v_fmac_f32 v20, v43, v43
v_add_f32 v19, v19, v44
v_fmac_f32 v20, v44, v44
v_add_f32 v19, v19, v45
v_fmac_f32 v20, v45, v45
v_add_f32 v19, v19, v46
v_fmac_f32 v20, v46, v46
v_add_f32 v19, v19, v47
v_fmac_f32 v20, v47, v47
v_add_f32 v19, v19, v48
v_fmac_f32 v20, v48, v48
v_add_f32 v19, v19, v49
v_fmac_f32 v20, v49, v49
v_add_f32 v19, v19, v50
v_fmac_f32 v20, v50, v50
v_add_f32 v19, v19, v51
v_fmac_f32 v20, v51, v51
v_add_f32 v19, v19, v52
v_fmac_f32 v20, v52, v52
v_add_f32 v19, v19, v53
v_fmac_f32 v20, v53, v53
v_add_f32 v19, v19, v54
v_fmac_f32 v20, v54, v54
v_add_f32 v19, v19, v55
v_fmac_f32 v20, v55, v55
v_add_f32 v19, v19, v56
v_fmac_f32 v20, v56, v56
v_add_f32 v19, v19, v57
v_fmac_f32 v20, v57, v57
v_add_f32 v19, v19, v58
v_fmac_f32 v20, v58, v58
v_add_f32 v19, v19, v59
v_fmac_f32 v20, v59, v59
s_mul_i32 s47, s45, 36864
s_add_u32 s47, s47, s52
v_permlane32_swap_b32 v19, v20
v_add_f32 v19, v19, v20
v_mov_b32 v21, v19
s_nop 1
v_permlane16_swap_b32 v19, v21
v_add_f32 v19, v19, v21
s_nop 1
v_add_f32_dpp v19, v19, v19 quad_perm:[2,3,0,1] row_mask:0xf bank_mask:0xf
s_nop 1
v_add_f32_dpp v19, v19, v19 row_ror:4 row_mask:0xf bank_mask:0xf
s_nop 1
v_add_f32_dpp v19, v19, v19 row_ror:8 row_mask:0xf bank_mask:0xf
v_mul_f32 v19, 0x3ae38e39, v19
v_mov_b32 v20, v19
s_nop 1
v_permlane32_swap_b32 v19, v20
v_fma_f32 v20, -v19, v19, v20
v_max_f32 v20, 0, v20
v_add_f32 v20, 0x3727c5ac, v20
v_rsq_f32 v20, v20
s_nop 0
v_mul_f32 v19, v19, v20
v_fma_f32 v40, v40, v20, -v19
v_fma_f32 v41, v41, v20, -v19
v_fma_f32 v42, v42, v20, -v19
v_fma_f32 v43, v43, v20, -v19
v_fma_f32 v44, v44, v20, -v19
v_fma_f32 v45, v45, v20, -v19
v_fma_f32 v46, v46, v20, -v19
v_fma_f32 v47, v47, v20, -v19
v_fma_f32 v48, v48, v20, -v19
v_fma_f32 v49, v49, v20, -v19
v_fma_f32 v50, v50, v20, -v19
v_fma_f32 v51, v51, v20, -v19
v_fma_f32 v52, v52, v20, -v19
v_fma_f32 v53, v53, v20, -v19
v_fma_f32 v54, v54, v20, -v19
v_fma_f32 v55, v55, v20, -v19
v_fma_f32 v56, v56, v20, -v19
v_fma_f32 v57, v57, v20, -v19
v_fma_f32 v58, v58, v20, -v19
v_fma_f32 v59, v59, v20, -v19
v_cvt_pk_bf16_f32 v72, v40, v41
v_cvt_pk_bf16_f32 v74, v44, v45
v_cvt_pk_bf16_f32 v73, v42, v43
v_cvt_pk_bf16_f32 v75, v46, v47
v_permlane16_swap_b32 v72, v74
s_nop 0
v_permlane16_swap_b32 v73, v75
buffer_store_dwordx4 v[72:75], v10, s[4:7], s47 offen offset:0 sc1
v_cvt_pk_bf16_f32 v76, v48, v49
v_cvt_pk_bf16_f32 v78, v52, v53
v_cvt_pk_bf16_f32 v77, v50, v51
v_cvt_pk_bf16_f32 v79, v54, v55
v_permlane16_swap_b32 v76, v78
s_nop 0
v_permlane16_swap_b32 v77, v79
buffer_store_dwordx4 v[76:79], v10, s[4:7], s47 offen offset:1024 sc1
v_cvt_pk_bf16_f32 v80, v56, v57
v_cvt_pk_bf16_f32 v81, v58, v59
s_mov_b64 exec, 0xffffffff
buffer_store_dwordx2 v[80:81], v11, s[4:7], s47 offen offset:2048 sc1
s_mov_b64 exec, -1
s_add_u32 s45, s45, 4
s_cmp_ge_u32 s45, 64
s_cbranch_scc1 ln0_done_219
s_mul_i32 s47, s45, 36864
buffer_load_dwordx2 v[60:61], v9, s[8:11], s47 offen offset:0
buffer_load_dwordx2 v[62:63], v9, s[8:11], s47 offen offset:256
buffer_load_dwordx2 v[64:65], v9, s[8:11], s47 offen offset:512
buffer_load_dwordx2 v[66:67], v9, s[8:11], s47 offen offset:768
v_mov_b64 v[68:69], 0
s_mov_b64 exec, 0xffffffff
buffer_load_dwordx2 v[68:69], v9, s[8:11], s47 offen offset:1024
s_mov_b64 exec, -1
s_waitcnt vmcnt(0)
v_mov_b32 v17, 1
s_mov_b64 exec, 1
ds_add_rtn_u32 v17, v14, v17
s_mov_b64 exec, -1
s_andn2_b32 s48, s45, 3
s_waitcnt lgkmcnt(0)
v_readfirstlane_b32 s47, v17
v_mov_b32 v18, s48
s_and_b32 s47, s47, 3
s_cmp_lg_u32 s47, 3
s_cbranch_scc1 nolast_220
buffer_store_dword v18, v36, s[4:7], s50 offen sc1
buffer_store_dword v18, v37, s[4:7], s50 offen
nolast_220:
v_add_u32 v14, 4, v14
s_branch ln0_218
ln0_done_219:
s_waitcnt vmcnt(0)
v_mov_b32 v17, 1
s_mov_b64 exec, 1
ds_add_rtn_u32 v17, v14, v17
s_mov_b64 exec, -1
s_andn2_b32 s48, s45, 3
s_waitcnt lgkmcnt(0)
v_readfirstlane_b32 s47, v17
v_mov_b32 v18, s48
s_and_b32 s47, s47, 3
s_cmp_lg_u32 s47, 3
s_cbranch_scc1 nolast_221
buffer_store_dword v18, v36, s[4:7], s50 offen sc1
buffer_store_dword v18, v37, s[4:7], s50 offen
nolast_221:
v_add_u32 v14, 4, v14
s_mov_b32 s99, 100
s_and_b32 s47, s3, 1
s_mul_i32 s51, s47, 18874368
s_add_u32 s51, s51, 199565312
s_mul_i32 s47, s47, 11264
s_add_u32 s47, s47, 18432
v_mul_u32_u24 v1, 128, v0
v_add_u32 v1, s47, v1
v_mov_b32 v7, 2147483632
v_cmp_gt_u32 vcc, 24, v0
s_nop 1
v_cndmask_b32 v15, v7, v1, vcc
s_getpc_b64 s[96:97]
pc_222:
s_add_u32 s96, s96, L_writers-pc_222
s_addc_u32 s97, s97, 0
v_subrev_u32 v2, 0, v15
v_lshrrev_b32 v2, 7, v2
v_cmp_gt_u32 vcc, 0x200, v2
s_nop 1
v_cndmask_b32 v2, 0, v2, vcc
global_load_ubyte v2, v2, s[96:97]
s_waitcnt vmcnt(0)
v_add_u32 v3, 65536, v15
v_cmp_eq_u32 vcc, s100, v2
s_nop 1
v_cndmask_b32 v15, v15, v3, vcc
s_lshr_b32 s47, s3, 1
s_mul_i32 s49, s47, 32768
s_mov_b32 s52, 6103040
s_mov_b32 s50, 21504
s_cmp_eq_u32 s3, 1
s_cselect_b32 s52, 3743744, s52
s_cselect_b32 s50, 32768, s50
s_cmp_eq_u32 s3, 2
s_cselect_b32 s52, 8462336, s52
s_cselect_b32 s50, 54272, s50
s_mov_b32 s45, 0
v_mov_b32 v16, 2147483632
s_cmp_eq_u32 s3, 3
s_cbranch_scc1 red_fin_224
s_cmp_lg_u32 s3, 0
s_cbranch_scc1 red_mid_223
red_loop_225:
s_add_u32 s48, s45, 1
s_mov_b32 s98, 0
grd_228:
v_mov_b32 v1, 147456
ds_read_b32 v2, v1
s_waitcnt lgkmcnt(0)
v_readfirstlane_b32 s47, v2
s_nop 0
s_add_u32 s47, s47, 32
s_cmp_gt_u32 s47, s45
s_cbranch_scc1 grd_ok_229
s_add_u32 s98, s98, 1
s_cmp_gt_u32 s98, 600000
s_cbranch_scc1 grd_bad_230
s_sleep 2
s_branch grd_228
grd_bad_230:
s_mov_b32 s98, 1280
s_branch L_fail
grd_ok_229:
s_mov_b32 s98, 0
sp_loop_231:
buffer_load_dword v24, v15, s[4:7], s49 offen sc1
s_add_u32 s98, s98, 1
s_cmp_gt_u32 s98, 150000
s_cbranch_scc1 sp_bad_233
s_waitcnt vmcnt(0)
v_cmp_gt_u32 vcc, s48, v24
s_nop 0
s_and_b32 vcc_lo, vcc_lo, 0xffffff
s_cbranch_scc0 sp_ok_232
s_sleep 2
s_branch sp_loop_231
sp_bad_233:
s_mov_b32 s98, 1281
s_branch L_fail
sp_ok_232:
s_mul_i32 s47, s45, 36864
buffer_load_dwordx2 v[60:61], v9, s[8:11], s47 offen offset:0
buffer_load_dwordx2 v[62:63], v9, s[8:11], s47 offen offset:256
buffer_load_dwordx2 v[64:65], v9, s[8:11], s47 offen offset:512
buffer_load_dwordx2 v[66:67], v9, s[8:11], s47 offen offset:768
v_mov_b64 v[68:69], 0
s_mov_b64 exec, 0xffffffff
buffer_load_dwordx2 v[68:69], v9, s[8:11], s47 offen offset:1024
s_mov_b64 exec, -1
s_mul_i32 s47, s45, 294912
s_add_u32 s47, s47, s51
s_add_u32 s46, s47, 147456
buffer_load_dwordx4 v[96:99], v8, s[4:7], s47 offen offset:0 sc1
buffer_load_dwordx4 v[100:103], v8, s[4:7], s46 offen offset:0 sc1
buffer_load_dwordx4 v[104:107], v8, s[4:7], s47 offen offset:256 sc1
buffer_load_dwordx4 v[108:111], v8, s[4:7], s46 offen offset:256 sc1
buffer_load_dwordx4 v[112:115], v8, s[4:7], s47 offen offset:512 sc1
buffer_load_dwordx4 v[116:119], v8, s[4:7], s46 offen offset:512 sc1
buffer_load_dwordx4 v[120:123], v8, s[4:7], s47 offen offset:768 sc1
buffer_load_dwordx4 v[124:127], v8, s[4:7], s46 offen offset:768 sc1
buffer_load_dwordx4 v[128:131], v8, s[4:7], s47 offen offset:1024 sc1
buffer_load_dwordx4 v[132:135], v8, s[4:7], s46 offen offset:1024 sc1
buffer_load_dwordx4 v[136:139], v8, s[4:7], s47 offen offset:1280 sc1
buffer_load_dwordx4 v[140:143], v8, s[4:7], s46 offen offset:1280 sc1
buffer_load_dwordx4 v[144:147], v8, s[4:7], s47 offen offset:1536 sc1
buffer_load_dwordx4 v[148:151], v8, s[4:7], s46 offen offset:1536 sc1
buffer_load_dwordx4 v[152:155], v8, s[4:7], s47 offen offset:1792 sc1
buffer_load_dwordx4 v[156:159], v8, s[4:7], s46 offen offset:1792 sc1
buffer_load_dwordx4 v[160:163], v8, s[4:7], s47 offen offset:2048 sc1
buffer_load_dwordx4 v[164:167], v8, s[4:7], s46 offen offset:2048 sc1
buffer_store_dword v18, v16, s[4:7], 0 offen
buffer_store_dword v18, v16, s[4:7], 0 offen
red_have_226:
buffer_load_dword v24, v15, s[4:7], s49 offen sc1
s_and_b32 s47, s45, 31
s_mul_i32 s47, s47, 4608
v_lshlrev_b32 v14, 4, v0
v_add_u32 v14, s47, v14
s_waitcnt vmcnt(21)
v_lshlrev_b32 v40, 16, v60
v_and_b32 v41, 0xffff0000, v60
v_lshlrev_b32 v42, 16, v61
v_and_b32 v43, 0xffff0000, v61
v_lshlrev_b32 v44, 16, v62
v_and_b32 v45, 0xffff0000, v62
v_lshlrev_b32 v46, 16, v63
v_and_b32 v47, 0xffff0000, v63
v_lshlrev_b32 v48, 16, v64
v_and_b32 v49, 0xffff0000, v64
v_lshlrev_b32 v50, 16, v65
v_and_b32 v51, 0xffff0000, v65
v_lshlrev_b32 v52, 16, v66
v_and_b32 v53, 0xffff0000, v66
v_lshlrev_b32 v54, 16, v67
v_and_b32 v55, 0xffff0000, v67
v_lshlrev_b32 v56, 16, v68
v_and_b32 v57, 0xffff0000, v68
v_lshlrev_b32 v58, 16, v69
v_and_b32 v59, 0xffff0000, v69
s_waitcnt vmcnt(20)
v_mfma_f32_16x16x32_bf16 v[40:43], v[28:31], v[96:99], v[40:43]
s_waitcnt vmcnt(19)
v_mfma_f32_16x16x32_bf16 v[40:43], v[28:31], v[100:103], v[40:43]
s_waitcnt vmcnt(18)
v_mfma_f32_16x16x32_bf16 v[40:43], v[32:35], v[104:107], v[40:43]
s_waitcnt vmcnt(17)
v_mfma_f32_16x16x32_bf16 v[40:43], v[32:35], v[108:111], v[40:43]
s_waitcnt vmcnt(16)
v_mfma_f32_16x16x32_bf16 v[44:47], v[28:31], v[112:115], v[44:47]
s_waitcnt vmcnt(15)
v_mfma_f32_16x16x32_bf16 v[44:47], v[28:31], v[116:119], v[44:47]
s_nop 3
ds_write_b128 v14, v[40:43] offset:0
v_mul_f32 v20, v40, v40
v_add_f32 v19, v40, v41
v_fmac_f32 v20, v41, v41
v_add_f32 v19, v19, v42
v_fmac_f32 v20, v42, v42
v_add_f32 v19, v19, v43
v_fmac_f32 v20, v43, v43
s_waitcnt vmcnt(14)
v_mfma_f32_16x16x32_bf16 v[44:47], v[32:35], v[120:123], v[44:47]
s_waitcnt vmcnt(13)
v_mfma_f32_16x16x32_bf16 v[44:47], v[32:35], v[124:127], v[44:47]
s_waitcnt vmcnt(12)
v_mfma_f32_16x16x32_bf16 v[48:51], v[28:31], v[128:131], v[48:51]
s_waitcnt vmcnt(11)
v_mfma_f32_16x16x32_bf16 v[48:51], v[28:31], v[132:135], v[48:51]
s_nop 3
ds_write_b128 v14, v[44:47] offset:1024
v_add_f32 v19, v19, v44
v_fmac_f32 v20, v44, v44
v_add_f32 v19, v19, v45
v_fmac_f32 v20, v45, v45
v_add_f32 v19, v19, v46
v_fmac_f32 v20, v46, v46
v_add_f32 v19, v19, v47
v_fmac_f32 v20, v47, v47
s_waitcnt vmcnt(10)
v_mfma_f32_16x16x32_bf16 v[48:51], v[32:35], v[136:139], v[48:51]
s_waitcnt vmcnt(9)
v_mfma_f32_16x16x32_bf16 v[48:51], v[32:35], v[140:143], v[48:51]
s_waitcnt vmcnt(8)
v_mfma_f32_16x16x32_bf16 v[52:55], v[28:31], v[144:147], v[52:55]
s_waitcnt vmcnt(7)
v_mfma_f32_16x16x32_bf16 v[52:55], v[28:31], v[148:151], v[52:55]
s_nop 3
ds_write_b128 v14, v[48:51] offset:2048
v_add_f32 v19, v19, v48
v_fmac_f32 v20, v48, v48
v_add_f32 v19, v19, v49
v_fmac_f32 v20, v49, v49
v_add_f32 v19, v19, v50
v_fmac_f32 v20, v50, v50
v_add_f32 v19, v19, v51
v_fmac_f32 v20, v51, v51
s_waitcnt vmcnt(6)
v_mfma_f32_16x16x32_bf16 v[52:55], v[32:35], v[152:155], v[52:55]
s_waitcnt vmcnt(5)
v_mfma_f32_16x16x32_bf16 v[52:55], v[32:35], v[156:159], v[52:55]
s_waitcnt vmcnt(4)
v_mfma_f32_16x16x32_bf16 v[56:59], v[28:31], v[160:163], v[56:59]
s_waitcnt vmcnt(3)
v_mfma_f32_16x16x32_bf16 v[56:59], v[28:31], v[164:167], v[56:59]
s_nop 3
ds_write_b128 v14, v[52:55] offset:3072
v_add_f32 v19, v19, v52
v_fmac_f32 v20, v52, v52
v_add_f32 v19, v19, v53
v_fmac_f32 v20, v53, v53
v_add_f32 v19, v19, v54
v_fmac_f32 v20, v54, v54
v_add_f32 v19, v19, v55
v_fmac_f32 v20, v55, v55
s_mov_b64 exec, 0xffffffff
ds_write_b128 v14, v[56:59] offset:4096
s_mov_b64 exec, -1
v_add_f32 v19, v19, v56
v_fmac_f32 v20, v56, v56
v_add_f32 v19, v19, v57
v_fmac_f32 v20, v57, v57
v_add_f32 v19, v19, v58
v_fmac_f32 v20, v58, v58
v_add_f32 v19, v19, v59
v_fmac_f32 v20, v59, v59
s_mul_i32 s47, s45, 36864
s_add_u32 s47, s47, s52
v_permlane32_swap_b32 v19, v20
v_add_f32 v19, v19, v20
v_mov_b32 v21, v19
s_nop 1
v_permlane16_swap_b32 v19, v21
v_add_f32 v19, v19, v21
s_nop 1
v_add_f32_dpp v19, v19, v19 quad_perm:[2,3,0,1] row_mask:0xf bank_mask:0xf
s_nop 1
v_add_f32_dpp v19, v19, v19 row_ror:4 row_mask:0xf bank_mask:0xf
s_nop 1
v_add_f32_dpp v19, v19, v19 row_ror:8 row_mask:0xf bank_mask:0xf
v_mul_f32 v19, 0x3ae38e39, v19
v_mov_b32 v20, v19
s_nop 1
v_permlane32_swap_b32 v19, v20
v_fma_f32 v20, -v19, v19, v20
v_max_f32 v20, 0, v20
v_add_f32 v20, 0x3727c5ac, v20
v_rsq_f32 v20, v20
s_nop 0
v_mul_f32 v19, v19, v20
v_fma_f32 v40, v40, v20, -v19
v_fma_f32 v41, v41, v20, -v19
v_fma_f32 v42, v42, v20, -v19
v_fma_f32 v43, v43, v20, -v19
v_fma_f32 v44, v44, v20, -v19
v_fma_f32 v45, v45, v20, -v19
v_fma_f32 v46, v46, v20, -v19
v_fma_f32 v47, v47, v20, -v19
v_fma_f32 v48, v48, v20, -v19
v_fma_f32 v49, v49, v20, -v19
v_fma_f32 v50, v50, v20, -v19
v_fma_f32 v51, v51, v20, -v19
v_fma_f32 v52, v52, v20, -v19
v_fma_f32 v53, v53, v20, -v19
v_fma_f32 v54, v54, v20, -v19
v_fma_f32 v55, v55, v20, -v19
v_fma_f32 v56, v56, v20, -v19
v_fma_f32 v57, v57, v20, -v19
v_fma_f32 v58, v58, v20, -v19
v_fma_f32 v59, v59, v20, -v19
v_cvt_pk_bf16_f32 v72, v40, v41
v_cvt_pk_bf16_f32 v74, v44, v45
v_cvt_pk_bf16_f32 v73, v42, v43
v_cvt_pk_bf16_f32 v75, v46, v47
v_permlane16_swap_b32 v72, v74
s_nop 0
v_permlane16_swap_b32 v73, v75
buffer_store_dwordx4 v[72:75], v10, s[4:7], s47 offen offset:0 sc1
v_cvt_pk_bf16_f32 v76, v48, v49
v_cvt_pk_bf16_f32 v78, v52, v53
v_cvt_pk_bf16_f32 v77, v50, v51
v_cvt_pk_bf16_f32 v79, v54, v55
v_permlane16_swap_b32 v76, v78
s_nop 0
v_permlane16_swap_b32 v77, v79
buffer_store_dwordx4 v[76:79], v10, s[4:7], s47 offen offset:1024 sc1
v_cvt_pk_bf16_f32 v80, v56, v57
v_cvt_pk_bf16_f32 v81, v58, v59
s_mov_b64 exec, 0xffffffff
buffer_store_dwordx2 v[80:81], v11, s[4:7], s47 offen offset:2048 sc1
s_mov_b64 exec, -1
v_mov_b32 v18, s48
s_mov_b32 s45, s48
s_add_u32 s48, s48, 1
s_waitcnt vmcnt(3)
v_cmp_gt_u32 vcc, s48, v24
s_nop 0
s_and_b32 vcc_lo, vcc_lo, 0xffffff
s_cbranch_scc1 red_late_227
v_mov_b32 v1, 147456
ds_read_b32 v2, v1
s_waitcnt lgkmcnt(0)
v_readfirstlane_b32 s47, v2
s_nop 0
s_add_u32 s47, s47, 32
s_cmp_gt_u32 s47, s45
s_cbranch_scc0 red_late_227
s_mul_i32 s47, s45, 36864
buffer_load_dwordx2 v[60:61], v9, s[8:11], s47 offen offset:0
buffer_load_dwordx2 v[62:63], v9, s[8:11], s47 offen offset:256
buffer_load_dwordx2 v[64:65], v9, s[8:11], s47 offen offset:512
buffer_load_dwordx2 v[66:67], v9, s[8:11], s47 offen offset:768
v_mov_b64 v[68:69], 0
s_mov_b64 exec, 0xffffffff
buffer_load_dwordx2 v[68:69], v9, s[8:11], s47 offen offset:1024
s_mov_b64 exec, -1
s_mul_i32 s47, s45, 294912
s_add_u32 s47, s47, s51
s_add_u32 s46, s47, 147456
buffer_load_dwordx4 v[96:99], v8, s[4:7], s47 offen offset:0 sc1
buffer_load_dwordx4 v[100:103], v8, s[4:7], s46 offen offset:0 sc1
buffer_load_dwordx4 v[104:107], v8, s[4:7], s47 offen offset:256 sc1
buffer_load_dwordx4 v[108:111], v8, s[4:7], s46 offen offset:256 sc1
buffer_load_dwordx4 v[112:115], v8, s[4:7], s47 offen offset:512 sc1
buffer_load_dwordx4 v[116:119], v8, s[4:7], s46 offen offset:512 sc1
buffer_load_dwordx4 v[120:123], v8, s[4:7], s47 offen offset:768 sc1
buffer_load_dwordx4 v[124:127], v8, s[4:7], s46 offen offset:768 sc1
buffer_load_dwordx4 v[128:131], v8, s[4:7], s47 offen offset:1024 sc1
buffer_load_dwordx4 v[132:135], v8, s[4:7], s46 offen offset:1024 sc1
buffer_load_dwordx4 v[136:139], v8, s[4:7], s47 offen offset:1280 sc1
buffer_load_dwordx4 v[140:143], v8, s[4:7], s46 offen offset:1280 sc1
buffer_load_dwordx4 v[144:147], v8, s[4:7], s47 offen offset:1536 sc1
buffer_load_dwordx4 v[148:151], v8, s[4:7], s46 offen offset:1536 sc1
buffer_load_dwordx4 v[152:155], v8, s[4:7], s47 offen offset:1792 sc1
buffer_load_dwordx4 v[156:159], v8, s[4:7], s46 offen offset:1792 sc1
buffer_load_dwordx4 v[160:163], v8, s[4:7], s47 offen offset:2048 sc1
buffer_load_dwordx4 v[164:167], v8, s[4:7], s46 offen offset:2048 sc1
s_waitcnt vmcnt(23) lgkmcnt(0)
buffer_store_dword v18, v36, s[4:7], s50 offen sc1
buffer_store_dword v18, v37, s[4:7], s50 offen
s_branch red_have_226
red_late_227:
s_waitcnt vmcnt(0) lgkmcnt(0)
buffer_store_dword v18, v36, s[4:7], s50 offen sc1
buffer_store_dword v18, v37, s[4:7], s50 offen
s_cmp_lt_u32 s45, 64
s_cbranch_scc1 red_loop_225
s_endpgm
red_mid_223:
red_loop_234:
s_add_u32 s48, s45, 1
s_mov_b32 s98, 0
sp_loop_237:
buffer_load_dword v24, v15, s[4:7], s49 offen sc1
s_add_u32 s98, s98, 1
s_cmp_gt_u32 s98, 150000
s_cbranch_scc1 sp_bad_239
s_waitcnt vmcnt(0)
v_cmp_gt_u32 vcc, s48, v24
s_nop 0
s_and_b32 vcc_lo, vcc_lo, 0xffffff
s_cbranch_scc0 sp_ok_238
s_sleep 2
s_branch sp_loop_237
sp_bad_239:
s_mov_b32 s98, 1281
s_branch L_fail
sp_ok_238:
s_mul_i32 s47, s45, 294912
s_add_u32 s47, s47, s51
s_add_u32 s46, s47, 147456
buffer_load_dwordx4 v[96:99], v8, s[4:7], s47 offen offset:0 sc1
buffer_load_dwordx4 v[100:103], v8, s[4:7], s46 offen offset:0 sc1
buffer_load_dwordx4 v[104:107], v8, s[4:7], s47 offen offset:256 sc1
buffer_load_dwordx4 v[108:111], v8, s[4:7], s46 offen offset:256 sc1
buffer_load_dwordx4 v[112:115], v8, s[4:7], s47 offen offset:512 sc1
buffer_load_dwordx4 v[116:119], v8, s[4:7], s46 offen offset:512 sc1
buffer_load_dwordx4 v[120:123], v8, s[4:7], s47 offen offset:768 sc1
buffer_load_dwordx4 v[124:127], v8, s[4:7], s46 offen offset:768 sc1
buffer_load_dwordx4 v[128:131], v8, s[4:7], s47 offen offset:1024 sc1
buffer_load_dwordx4 v[132:135], v8, s[4:7], s46 offen offset:1024 sc1
buffer_load_dwordx4 v[136:139], v8, s[4:7], s47 offen offset:1280 sc1
buffer_load_dwordx4 v[140:143], v8, s[4:7], s46 offen offset:1280 sc1
buffer_load_dwordx4 v[144:147], v8, s[4:7], s47 offen offset:1536 sc1
buffer_load_dwordx4 v[148:151], v8, s[4:7], s46 offen offset:1536 sc1
buffer_load_dwordx4 v[152:155], v8, s[4:7], s47 offen offset:1792 sc1
buffer_load_dwordx4 v[156:159], v8, s[4:7], s46 offen offset:1792 sc1
buffer_load_dwordx4 v[160:163], v8, s[4:7], s47 offen offset:2048 sc1
buffer_load_dwordx4 v[164:167], v8, s[4:7], s46 offen offset:2048 sc1
buffer_store_dword v18, v16, s[4:7], 0 offen
buffer_store_dword v18, v16, s[4:7], 0 offen
red_have_235:
buffer_load_dword v24, v15, s[4:7], s49 offen sc1
s_and_b32 s47, s45, 31
s_mul_i32 s47, s47, 4608
v_lshlrev_b32 v14, 4, v0
v_add_u32 v14, s47, v14
ds_read_b128 v[40:43], v14 offset:0
ds_read_b128 v[44:47], v14 offset:1024
ds_read_b128 v[48:51], v14 offset:2048
ds_read_b128 v[52:55], v14 offset:3072
v_mov_b64 v[56:57], 0
v_mov_b64 v[58:59], 0
s_mov_b64 exec, 0xffffffff
ds_read_b128 v[56:59], v14 offset:4096
s_mov_b64 exec, -1
s_waitcnt lgkmcnt(0)
s_waitcnt vmcnt(20)
v_mfma_f32_16x16x32_bf16 v[40:43], v[28:31], v[96:99], v[40:43]
s_waitcnt vmcnt(19)
v_mfma_f32_16x16x32_bf16 v[40:43], v[28:31], v[100:103], v[40:43]
s_waitcnt vmcnt(18)
v_mfma_f32_16x16x32_bf16 v[40:43], v[32:35], v[104:107], v[40:43]
s_waitcnt vmcnt(17)
v_mfma_f32_16x16x32_bf16 v[40:43], v[32:35], v[108:111], v[40:43]
s_waitcnt vmcnt(16)
v_mfma_f32_16x16x32_bf16 v[44:47], v[28:31], v[112:115], v[44:47]
s_waitcnt vmcnt(15)
v_mfma_f32_16x16x32_bf16 v[44:47], v[28:31], v[116:119], v[44:47]
s_nop 3
ds_write_b128 v14, v[40:43] offset:0
v_mul_f32 v20, v40, v40
v_add_f32 v19, v40, v41
v_fmac_f32 v20, v41, v41
v_add_f32 v19, v19, v42
v_fmac_f32 v20, v42, v42
v_add_f32 v19, v19, v43
v_fmac_f32 v20, v43, v43
s_waitcnt vmcnt(14)
v_mfma_f32_16x16x32_bf16 v[44:47], v[32:35], v[120:123], v[44:47]
s_waitcnt vmcnt(13)
v_mfma_f32_16x16x32_bf16 v[44:47], v[32:35], v[124:127], v[44:47]
s_waitcnt vmcnt(12)
v_mfma_f32_16x16x32_bf16 v[48:51], v[28:31], v[128:131], v[48:51]
s_waitcnt vmcnt(11)
v_mfma_f32_16x16x32_bf16 v[48:51], v[28:31], v[132:135], v[48:51]
s_nop 3
ds_write_b128 v14, v[44:47] offset:1024
v_add_f32 v19, v19, v44
v_fmac_f32 v20, v44, v44
v_add_f32 v19, v19, v45
v_fmac_f32 v20, v45, v45
v_add_f32 v19, v19, v46
v_fmac_f32 v20, v46, v46
v_add_f32 v19, v19, v47
v_fmac_f32 v20, v47, v47
s_waitcnt vmcnt(10)
v_mfma_f32_16x16x32_bf16 v[48:51], v[32:35], v[136:139], v[48:51]
s_waitcnt vmcnt(9)
v_mfma_f32_16x16x32_bf16 v[48:51], v[32:35], v[140:143], v[48:51]
s_waitcnt vmcnt(8)
v_mfma_f32_16x16x32_bf16 v[52:55], v[28:31], v[144:147], v[52:55]
s_waitcnt vmcnt(7)
v_mfma_f32_16x16x32_bf16 v[52:55], v[28:31], v[148:151], v[52:55]
s_nop 3
ds_write_b128 v14, v[48:51] offset:2048
v_add_f32 v19, v19, v48
v_fmac_f32 v20, v48, v48
v_add_f32 v19, v19, v49
v_fmac_f32 v20, v49, v49
v_add_f32 v19, v19, v50
v_fmac_f32 v20, v50, v50
v_add_f32 v19, v19, v51
v_fmac_f32 v20, v51, v51
s_waitcnt vmcnt(6)
v_mfma_f32_16x16x32_bf16 v[52:55], v[32:35], v[152:155], v[52:55]
s_waitcnt vmcnt(5)
v_mfma_f32_16x16x32_bf16 v[52:55], v[32:35], v[156:159], v[52:55]
s_waitcnt vmcnt(4)
v_mfma_f32_16x16x32_bf16 v[56:59], v[28:31], v[160:163], v[56:59]
s_waitcnt vmcnt(3)
v_mfma_f32_16x16x32_bf16 v[56:59], v[28:31], v[164:167], v[56:59]
s_nop 3
ds_write_b128 v14, v[52:55] offset:3072
v_add_f32 v19, v19, v52
v_fmac_f32 v20, v52, v52
v_add_f32 v19, v19, v53
v_fmac_f32 v20, v53, v53
v_add_f32 v19, v19, v54
v_fmac_f32 v20, v54, v54
v_add_f32 v19, v19, v55
v_fmac_f32 v20, v55, v55
s_mov_b64 exec, 0xffffffff
ds_write_b128 v14, v[56:59] offset:4096
s_mov_b64 exec, -1
v_add_f32 v19, v19, v56
v_fmac_f32 v20, v56, v56
v_add_f32 v19, v19, v57
v_fmac_f32 v20, v57, v57
v_add_f32 v19, v19, v58
v_fmac_f32 v20, v58, v58
v_add_f32 v19, v19, v59
v_fmac_f32 v20, v59, v59
s_mul_i32 s47, s45, 36864
s_add_u32 s47, s47, s52
v_permlane32_swap_b32 v19, v20
v_add_f32 v19, v19, v20
v_mov_b32 v21, v19
s_nop 1
v_permlane16_swap_b32 v19, v21
v_add_f32 v19, v19, v21
s_nop 1
v_add_f32_dpp v19, v19, v19 quad_perm:[2,3,0,1] row_mask:0xf bank_mask:0xf
s_nop 1
v_add_f32_dpp v19, v19, v19 row_ror:4 row_mask:0xf bank_mask:0xf
s_nop 1
v_add_f32_dpp v19, v19, v19 row_ror:8 row_mask:0xf bank_mask:0xf
v_mul_f32 v19, 0x3ae38e39, v19
v_mov_b32 v20, v19
s_nop 1
v_permlane32_swap_b32 v19, v20
v_fma_f32 v20, -v19, v19, v20
v_max_f32 v20, 0, v20
v_add_f32 v20, 0x3727c5ac, v20
v_rsq_f32 v20, v20
s_nop 0
v_mul_f32 v19, v19, v20
v_fma_f32 v40, v40, v20, -v19
v_fma_f32 v41, v41, v20, -v19
v_fma_f32 v42, v42, v20, -v19
v_fma_f32 v43, v43, v20, -v19
v_fma_f32 v44, v44, v20, -v19
v_fma_f32 v45, v45, v20, -v19
v_fma_f32 v46, v46, v20, -v19
v_fma_f32 v47, v47, v20, -v19
v_fma_f32 v48, v48, v20, -v19
v_fma_f32 v49, v49, v20, -v19
v_fma_f32 v50, v50, v20, -v19
v_fma_f32 v51, v51, v20, -v19
v_fma_f32 v52, v52, v20, -v19
v_fma_f32 v53, v53, v20, -v19
v_fma_f32 v54, v54, v20, -v19
v_fma_f32 v55, v55, v20, -v19
v_fma_f32 v56, v56, v20, -v19
v_fma_f32 v57, v57, v20, -v19
v_fma_f32 v58, v58, v20, -v19
v_fma_f32 v59, v59, v20, -v19
v_cvt_pk_bf16_f32 v72, v40, v41
v_cvt_pk_bf16_f32 v74, v44, v45
v_cvt_pk_bf16_f32 v73, v42, v43
v_cvt_pk_bf16_f32 v75, v46, v47
v_permlane16_swap_b32 v72, v74
s_nop 0
v_permlane16_swap_b32 v73, v75
buffer_store_dwordx4 v[72:75], v10, s[4:7], s47 offen offset:0 sc1
v_cvt_pk_bf16_f32 v76, v48, v49
v_cvt_pk_bf16_f32 v78, v52, v53
v_cvt_pk_bf16_f32 v77, v50, v51
v_cvt_pk_bf16_f32 v79, v54, v55
v_permlane16_swap_b32 v76, v78
s_nop 0
v_permlane16_swap_b32 v77, v79
buffer_store_dwordx4 v[76:79], v10, s[4:7], s47 offen offset:1024 sc1
v_cvt_pk_bf16_f32 v80, v56, v57
v_cvt_pk_bf16_f32 v81, v58, v59
s_mov_b64 exec, 0xffffffff
buffer_store_dwordx2 v[80:81], v11, s[4:7], s47 offen offset:2048 sc1
s_mov_b64 exec, -1
v_mov_b32 v18, s48
s_mov_b32 s45, s48
s_add_u32 s48, s48, 1
s_waitcnt vmcnt(3)
v_cmp_gt_u32 vcc, s48, v24
s_nop 0
s_and_b32 vcc_lo, vcc_lo, 0xffffff
s_cbranch_scc1 red_late_236
s_mul_i32 s47, s45, 294912
s_add_u32 s47, s47, s51
s_add_u32 s46, s47, 147456
buffer_load_dwordx4 v[96:99], v8, s[4:7], s47 offen offset:0 sc1
buffer_load_dwordx4 v[100:103], v8, s[4:7], s46 offen offset:0 sc1
buffer_load_dwordx4 v[104:107], v8, s[4:7], s47 offen offset:256 sc1
buffer_load_dwordx4 v[108:111], v8, s[4:7], s46 offen offset:256 sc1
buffer_load_dwordx4 v[112:115], v8, s[4:7], s47 offen offset:512 sc1
buffer_load_dwordx4 v[116:119], v8, s[4:7], s46 offen offset:512 sc1
buffer_load_dwordx4 v[120:123], v8, s[4:7], s47 offen offset:768 sc1
buffer_load_dwordx4 v[124:127], v8, s[4:7], s46 offen offset:768 sc1
buffer_load_dwordx4 v[128:131], v8, s[4:7], s47 offen offset:1024 sc1
buffer_load_dwordx4 v[132:135], v8, s[4:7], s46 offen offset:1024 sc1
buffer_load_dwordx4 v[136:139], v8, s[4:7], s47 offen offset:1280 sc1
buffer_load_dwordx4 v[140:143], v8, s[4:7], s46 offen offset:1280 sc1
buffer_load_dwordx4 v[144:147], v8, s[4:7], s47 offen offset:1536 sc1
buffer_load_dwordx4 v[148:151], v8, s[4:7], s46 offen offset:1536 sc1
buffer_load_dwordx4 v[152:155], v8, s[4:7], s47 offen offset:1792 sc1
buffer_load_dwordx4 v[156:159], v8, s[4:7], s46 offen offset:1792 sc1
buffer_load_dwordx4 v[160:163], v8, s[4:7], s47 offen offset:2048 sc1
buffer_load_dwordx4 v[164:167], v8, s[4:7], s46 offen offset:2048 sc1
s_waitcnt vmcnt(18) lgkmcnt(0)
buffer_store_dword v18, v36, s[4:7], s50 offen sc1
buffer_store_dword v18, v37, s[4:7], s50 offen
s_branch red_have_235
red_late_236:
s_waitcnt vmcnt(0) lgkmcnt(0)
buffer_store_dword v18, v36, s[4:7], s50 offen sc1
buffer_store_dword v18, v37, s[4:7], s50 offen
s_cmp_lt_u32 s45, 64
s_cbranch_scc1 red_loop_234
s_endpgm
red_fin_224:
red_loop_240:
s_add_u32 s48, s45, 1
s_mov_b32 s98, 0
sp_loop_243:
buffer_load_dword v24, v15, s[4:7], s49 offen sc1
s_add_u32 s98, s98, 1
s_cmp_gt_u32 s98, 150000
s_cbranch_scc1 sp_bad_245
s_waitcnt vmcnt(0)
v_cmp_gt_u32 vcc, s48, v24
s_nop 0
s_and_b32 vcc_lo, vcc_lo, 0xffffff
s_cbranch_scc0 sp_ok_244
s_sleep 2
s_branch sp_loop_243
sp_bad_245:
s_mov_b32 s98, 1281
s_branch L_fail
sp_ok_244:
s_mul_i32 s47, s45, 294912
s_add_u32 s47, s47, s51
s_add_u32 s46, s47, 147456
buffer_load_dwordx4 v[96:99], v8, s[4:7], s47 offen offset:0 sc1
buffer_load_dwordx4 v[100:103], v8, s[4:7], s46 offen offset:0 sc1
buffer_load_dwordx4 v[104:107], v8, s[4:7], s47 offen offset:256 sc1
buffer_load_dwordx4 v[108:111], v8, s[4:7], s46 offen offset:256 sc1
buffer_load_dwordx4 v[112:115], v8, s[4:7], s47 offen offset:512 sc1
buffer_load_dwordx4 v[116:119], v8, s[4:7], s46 offen offset:512 sc1
buffer_load_dwordx4 v[120:123], v8, s[4:7], s47 offen offset:768 sc1
buffer_load_dwordx4 v[124:127], v8, s[4:7], s46 offen offset:768 sc1
buffer_load_dwordx4 v[128:131], v8, s[4:7], s47 offen offset:1024 sc1
buffer_load_dwordx4 v[132:135], v8, s[4:7], s46 offen offset:1024 sc1
buffer_load_dwordx4 v[136:139], v8, s[4:7], s47 offen offset:1280 sc1
buffer_load_dwordx4 v[140:143], v8, s[4:7], s46 offen offset:1280 sc1
buffer_load_dwordx4 v[144:147], v8, s[4:7], s47 offen offset:1536 sc1
buffer_load_dwordx4 v[148:151], v8, s[4:7], s46 offen offset:1536 sc1
buffer_load_dwordx4 v[152:155], v8, s[4:7], s47 offen offset:1792 sc1
buffer_load_dwordx4 v[156:159], v8, s[4:7], s46 offen offset:1792 sc1
buffer_load_dwordx4 v[160:163], v8, s[4:7], s47 offen offset:2048 sc1
buffer_load_dwordx4 v[164:167], v8, s[4:7], s46 offen offset:2048 sc1
red_have_241:
buffer_load_dword v24, v15, s[4:7], s49 offen sc1
s_and_b32 s47, s45, 31
s_mul_i32 s47, s47, 4608
v_lshlrev_b32 v14, 4, v0
v_add_u32 v14, s47, v14
ds_read_b128 v[40:43], v14 offset:0
ds_read_b128 v[44:47], v14 offset:1024
ds_read_b128 v[48:51], v14 offset:2048
ds_read_b128 v[52:55], v14 offset:3072
v_mov_b64 v[56:57], 0
v_mov_b64 v[58:59], 0
s_mov_b64 exec, 0xffffffff
ds_read_b128 v[56:59], v14 offset:4096
s_mov_b64 exec, -1
s_waitcnt lgkmcnt(0)
v_mov_b32 v1, 147456
v_mov_b32 v2, s48
ds_write_b32 v1, v2
s_waitcnt vmcnt(18)
v_mfma_f32_16x16x32_bf16 v[40:43], v[28:31], v[96:99], v[40:43]
s_waitcnt vmcnt(17)
v_mfma_f32_16x16x32_bf16 v[40:43], v[28:31], v[100:103], v[40:43]
s_waitcnt vmcnt(16)
v_mfma_f32_16x16x32_bf16 v[40:43], v[32:35], v[104:107], v[40:43]
s_waitcnt vmcnt(15)
v_mfma_f32_16x16x32_bf16 v[40:43], v[32:35], v[108:111], v[40:43]
s_waitcnt vmcnt(14)
v_mfma_f32_16x16x32_bf16 v[44:47], v[28:31], v[112:115], v[44:47]
s_waitcnt vmcnt(13)
v_mfma_f32_16x16x32_bf16 v[44:47], v[28:31], v[116:119], v[44:47]
s_waitcnt vmcnt(12)
v_mfma_f32_16x16x32_bf16 v[44:47], v[32:35], v[120:123], v[44:47]
s_waitcnt vmcnt(11)
v_mfma_f32_16x16x32_bf16 v[44:47], v[32:35], v[124:127], v[44:47]
s_waitcnt vmcnt(10)
v_mfma_f32_16x16x32_bf16 v[48:51], v[28:31], v[128:131], v[48:51]
s_waitcnt vmcnt(9)
v_mfma_f32_16x16x32_bf16 v[48:51], v[28:31], v[132:135], v[48:51]
s_waitcnt vmcnt(8)
v_mfma_f32_16x16x32_bf16 v[48:51], v[32:35], v[136:139], v[48:51]
s_waitcnt vmcnt(7)
v_mfma_f32_16x16x32_bf16 v[48:51], v[32:35], v[140:143], v[48:51]
s_waitcnt vmcnt(6)
v_mfma_f32_16x16x32_bf16 v[52:55], v[28:31], v[144:147], v[52:55]
s_waitcnt vmcnt(5)
v_mfma_f32_16x16x32_bf16 v[52:55], v[28:31], v[148:151], v[52:55]
s_waitcnt vmcnt(4)
v_mfma_f32_16x16x32_bf16 v[52:55], v[32:35], v[152:155], v[52:55]
s_waitcnt vmcnt(3)
v_mfma_f32_16x16x32_bf16 v[52:55], v[32:35], v[156:159], v[52:55]
s_waitcnt vmcnt(2)
v_mfma_f32_16x16x32_bf16 v[56:59], v[28:31], v[160:163], v[56:59]
s_waitcnt vmcnt(1)
v_mfma_f32_16x16x32_bf16 v[56:59], v[28:31], v[164:167], v[56:59]
s_mul_i32 s47, s45, 36864
v_cvt_pk_bf16_f32 v72, v40, v41
v_cvt_pk_bf16_f32 v74, v44, v45
v_cvt_pk_bf16_f32 v73, v42, v43
v_cvt_pk_bf16_f32 v75, v46, v47
v_permlane16_swap_b32 v72, v74
s_nop 0
v_permlane16_swap_b32 v73, v75
buffer_store_dwordx4 v[72:75], v12, s[16:19], s47 offen offset:0
v_cvt_pk_bf16_f32 v76, v48, v49
v_cvt_pk_bf16_f32 v78, v52, v53
v_cvt_pk_bf16_f32 v77, v50, v51
v_cvt_pk_bf16_f32 v79, v54, v55
v_permlane16_swap_b32 v76, v78
s_nop 0
v_permlane16_swap_b32 v77, v79
buffer_store_dwordx4 v[76:79], v12, s[16:19], s47 offen offset:512
v_cvt_pk_bf16_f32 v80, v56, v57
v_cvt_pk_bf16_f32 v81, v58, v59
s_mov_b64 exec, 0xffffffff
buffer_store_dwordx2 v[80:81], v13, s[16:19], s47 offen offset:1024
s_mov_b64 exec, -1
v_mov_b32 v18, s48
s_mov_b32 s45, s48
s_add_u32 s48, s48, 1
s_waitcnt vmcnt(3)
v_cmp_gt_u32 vcc, s48, v24
s_nop 0
s_and_b32 vcc_lo, vcc_lo, 0xffffff
s_cbranch_scc1 red_late_242
s_mul_i32 s47, s45, 294912
s_add_u32 s47, s47, s51
s_add_u32 s46, s47, 147456
buffer_load_dwordx4 v[96:99], v8, s[4:7], s47 offen offset:0 sc1
buffer_load_dwordx4 v[100:103], v8, s[4:7], s46 offen offset:0 sc1
buffer_load_dwordx4 v[104:107], v8, s[4:7], s47 offen offset:256 sc1
buffer_load_dwordx4 v[108:111], v8, s[4:7], s46 offen offset:256 sc1
buffer_load_dwordx4 v[112:115], v8, s[4:7], s47 offen offset:512 sc1
buffer_load_dwordx4 v[116:119], v8, s[4:7], s46 offen offset:512 sc1
buffer_load_dwordx4 v[120:123], v8, s[4:7], s47 offen offset:768 sc1
buffer_load_dwordx4 v[124:127], v8, s[4:7], s46 offen offset:768 sc1
buffer_load_dwordx4 v[128:131], v8, s[4:7], s47 offen offset:1024 sc1
buffer_load_dwordx4 v[132:135], v8, s[4:7], s46 offen offset:1024 sc1
buffer_load_dwordx4 v[136:139], v8, s[4:7], s47 offen offset:1280 sc1
buffer_load_dwordx4 v[140:143], v8, s[4:7], s46 offen offset:1280 sc1
buffer_load_dwordx4 v[144:147], v8, s[4:7], s47 offen offset:1536 sc1
buffer_load_dwordx4 v[148:151], v8, s[4:7], s46 offen offset:1536 sc1
buffer_load_dwordx4 v[152:155], v8, s[4:7], s47 offen offset:1792 sc1
buffer_load_dwordx4 v[156:159], v8, s[4:7], s46 offen offset:1792 sc1
buffer_load_dwordx4 v[160:163], v8, s[4:7], s47 offen offset:2048 sc1
buffer_load_dwordx4 v[164:167], v8, s[4:7], s46 offen offset:2048 sc1
s_branch red_have_241
red_late_242:
s_cmp_lt_u32 s45, 64
s_cbranch_scc1 red_loop_240
s_endpgm
L_fail:
s_mov_b64 exec, -1
v_mov_b32 v2, s98
v_mov_b32 v3, 252
s_mov_b32 s12, s40
s_and_b32 s13, s41, 0xffff
s_mov_b32 s14, 256
s_mov_b32 s15, 0x20000
buffer_store_dword v2, v3, s[12:15], 0 offen
s_waitcnt vmcnt(0)
s_endpgm
L_chain:
s_mul_i32 s53, s50, 50331648
s_add_u32 s53, s53, 10821632
s_mul_i32 s54, s50, 8388608
s_add_u32 s54, s54, 111484928
s_mul_i32 s55, s50, 589824
s_add_u32 s55, s55, 131072
s_mul_i32 s56, s50, 36864
s_add_u32 s56, s56, 1310720
s_mul_i32 s57, s50, 4
s_add_u32 s57, s57, 48
s_mul_i32 s58, s50, 32768
s_add_u32 s58, s58, 0
v_lshlrev_b32 v1, 4, v0
v_lshrrev_b32 v28, 4, v0
v_lshlrev_b32 v29, 1, v28
v_and_b32 v32, 15, v0
v_xor_b32 v32, v32, v29
v_lshlrev_b32 v32, 4, v32
v_lshlrev_b32 v28, 13, v28
v_add_u32 v32, v28, v32
v_xor_b32 v33, 128, v32
s_mov_b32 s8, s24
s_and_b32 s9, s25, 0xffff
s_mov_b32 s10, 4718592
s_mov_b32 s11, 0x20000
s_lshl_b32 s61, s51, 8
s_mul_i32 s60, s3, 393216
s_add_u32 s61, s61, s60
s_add_u32 s61, s61, 0
s_mul_i32 s60, s3, 12288
s_add_u32 m0, s60, 0
s_mul_i32 s62, s3, 48
s_add_u32 s63, s62, 48
sq_248:
s_bitcmp1_b32 s62, 5
s_cbranch_scc1 sq_249
buffer_load_dwordx4 v32, s[8:11], s61 offen lds
s_branch sq_250
sq_249:
buffer_load_dwordx4 v33, s[8:11], s61 offen lds
sq_250:
s_add_u32 s62, s62, 4
s_add_u32 s61, s61, 32768
s_add_u32 m0, m0, 1024
s_cmp_lt_u32 s62, s63
s_cbranch_scc1 sq_248
s_mov_b32 s8, s24
s_and_b32 s9, s25, 0xffff
s_mov_b32 s10, 4718592
s_mov_b32 s11, 0x20000
s_lshl_b32 s61, s51, 8
s_mul_i32 s60, s3, 393216
s_add_u32 s61, s61, s60
s_add_u32 s61, s61, 1572864
s_mul_i32 s60, s3, 12288
s_add_u32 m0, s60, 49152
s_mul_i32 s62, s3, 48
s_add_u32 s63, s62, 48
sq_251:
s_bitcmp1_b32 s62, 5
s_cbranch_scc1 sq_252
buffer_load_dwordx4 v32, s[8:11], s61 offen lds
s_branch sq_253
sq_252:
buffer_load_dwordx4 v33, s[8:11], s61 offen lds
sq_253:
s_add_u32 s62, s62, 4
s_add_u32 s61, s61, 32768
s_add_u32 m0, m0, 1024
s_cmp_lt_u32 s62, s63
s_cbranch_scc1 sq_251
s_mov_b32 s8, s24
s_and_b32 s9, s25, 0xffff
s_mov_b32 s10, 4718592
s_mov_b32 s11, 0x20000
s_lshl_b32 s61, s51, 8
s_mul_i32 s60, s3, 393216
s_add_u32 s61, s61, s60
s_add_u32 s61, s61, 3145728
s_mul_i32 s60, s3, 12288
s_add_u32 m0, s60, 98304
s_mul_i32 s62, s3, 48
s_add_u32 s63, s62, 48
sq_254:
s_bitcmp1_b32 s62, 5
s_cbranch_scc1 sq_255
buffer_load_dwordx4 v32, s[8:11], s61 offen lds
s_branch sq_256
sq_255:
buffer_load_dwordx4 v33, s[8:11], s61 offen lds
sq_256:
s_add_u32 s62, s62, 4
s_add_u32 s61, s61, 32768
s_add_u32 m0, m0, 1024
s_cmp_lt_u32 s62, s63
s_cbranch_scc1 sq_254
v_lshlrev_b32 v1, 4, v0
v_lshlrev_b32 v15, 3, v0
v_add_u32 v2, 139264, v15
v_and_b32 v24, 1, v0
v_mov_b32 v25, 0x88888888
v_mov_b32 v26, 0xdddddddd
v_cmp_eq_u32 vcc, 1, v24
s_nop 1
v_cndmask_b32 v3, v25, v26, vcc
v_lshrrev_b32 v24, 5, v0
v_bfe_u32 v25, v0, 4, 1
v_and_b32 v26, 15, v0
v_lshrrev_b32 v27, 4, v0
s_lshl_b32 s60, s3, 5
v_bfe_u32 v28, v0, 2, 1
v_lshlrev_b32 v28, 3, v28
v_bfe_u32 v29, v0, 3, 1
v_lshl_add_u32 v28, v29, 2, v28
v_and_b32 v29, 3, v0
v_add3_u32 v28, v28, v29, s60
v_lshlrev_b32 v28, 5, v28
v_lshl_add_u32 v28, v27, 3, v28
v_add_u32 v4, 148480, v28
v_bfe_u32 v28, v0, 1, 3
v_lshlrev_b32 v28, 5, v28
v_and_b32 v29, 1, v0
v_lshl_add_u32 v28, v29, 9, v28
v_lshl_add_u32 v28, v27, 3, v28
s_mul_i32 s60, s3, 2304
s_add_u32 s60, s60, 139264
v_add_u32 v11, s60, v28
s_add_u32 s68, s60, 2048
s_lshl_b32 s78, s3, 9
s_sub_u32 s78, s78, 137216
v_lshrrev_b32 v28, 3, v0
v_lshlrev_b32 v28, 12, v28
v_and_b32 v29, 7, v0
v_lshl_add_u32 v9, v29, 4, v28
v_lshlrev_b32 v28, 9, v24
v_lshl_add_u32 v28, v25, 7, v28
v_lshl_add_u32 v28, v26, 3, v28
v_add_u32 v5, 148480, v28
v_bfe_u32 v28, v0, 2, 2
v_lshlrev_b32 v28, 1, v28
v_and_b32 v30, 1, v0
v_add_u32 v30, v28, v30
v_lshlrev_b32 v28, 8, v24
v_lshl_add_u32 v28, v25, 7, v28
v_lshl_add_u32 v12, v30, 4, v28
v_mov_b32 v31, v30
v_min_u32 v28, 3, v0
v_lshrrev_b32 v29, 1, v28
v_lshlrev_b32 v29, 8, v29
v_and_b32 v28, 1, v28
v_mul_u32_u24 v28, 7, v28
s_lshl_b32 s60, s51, 3
s_add_u32 s60, s60, 256
v_add3_u32 v28, v28, v29, s60
v_mul_u32_u24 v28, 43691, v28
v_lshrrev_b32 v28, 19, v28
v_mul_u32_u24 v28, 128, v28
v_add_u32 v28, 2048, v28
s_mul_i32 s60, s51, 128
s_add_u32 s60, s60, 10240
v_mov_b32 v29, s60
v_cmp_eq_u32 vcc, 4, v0
s_nop 1
v_cndmask_b32 v28, v28, v29, vcc
v_mov_b32 v29, 2147483632
s_cmp_eq_u32 s3, 3
s_cselect_b32 s61, 5, 0
v_cmp_gt_u32 vcc, s61, v0
s_nop 1
v_cndmask_b32 v7, v29, v28, vcc
s_lshr_b32 s60, s3, 1
s_lshl_b32 s60, s60, 10
s_and_b32 s61, s3, 1
s_lshl_b32 s61, s61, 9
s_add_u32 s60, s60, s61
s_add_u32 s60, s60, 152576
v_lshrrev_b32 v28, 4, v0
v_lshlrev_b32 v28, 2, v28
v_lshl_add_u32 v28, v31, 5, v28
v_add_u32 v6, s60, v28
v_lshlrev_b32 v29, 6, v25
v_lshl_add_u32 v29, v24, 5, v29
v_lshl_add_u32 v10, v26, 2, v29
v_mov_b32 v29, 2147483632
v_cmp_gt_u32 vcc, 8, v26
s_nop 1
v_cndmask_b32 v10, v29, v10, vcc
s_mov_b32 s66, 0x3e0293ee
s_mov_b32 s70, 0xfffffffe
s_mov_b32 s98, 0xff800000
s_mov_b32 s99, 0xff800000
s_mul_i32 s60, s3, 65536
s_lshl_b32 s61, s51, 7
s_add_u32 s74, s60, s61
s_add_u32 s74, s74, s55
s_lshl_b32 s69, s51, 1
s_add_u32 s69, s69, s3
s_add_u32 s60, s51, 64
s_cmp_lt_u32 s3, 2
s_cselect_b32 s69, s69, s60
s_cselect_b32 s48, 1, 0
s_cmp_eq_u32 s3, 2
s_cselect_b32 s60, 1, 0
s_cmp_lt_u32 s51, 8
s_cselect_b32 s60, s60, 0
s_or_b32 s48, s48, s60
s_lshl_b32 s60, s3, 13
s_lshl_b32 s49, s51, 7
s_add_u32 s49, s49, s60
s_add_u32 s49, s49, s55
s_add_u32 s49, s49, 262144
s_lshl_b32 s75, s69, 12
s_add_u32 s75, s75, s55
s_lshl_b32 s76, s69, 7
s_cmp_eq_u32 s48, 0
s_cselect_b32 s76, 0x70000000, s76
s_add_u32 s79, s56, 9216
s_add_u32 s71, s56, 18432
s_mov_b32 s73, s56
s_mov_b32 s72, 0x00ff00ff
s_cmp_eq_u32 s48, 0
s_cselect_b32 s61, 0x70000000, s75
v_mov_b64 v[24:25], 0
v_mov_b64 v[26:27], 0
buffer_store_dwordx4 v[24:27], v1, s[4:7], s61 offen offset:0 sc1
buffer_store_dwordx4 v[24:27], v1, s[4:7], s61 offen offset:1024 sc1
buffer_store_dwordx4 v[24:27], v1, s[4:7], s61 offen offset:2048 sc1
buffer_store_dwordx4 v[24:27], v1, s[4:7], s61 offen offset:3072 sc1
v_mov_b32 v28, -1
s_mov_b32 exec_lo, s72
s_mov_b32 exec_hi, s72
s_add_u32 s60, s76, s56
s_add_u32 s60, s60, 0
buffer_store_dword v28, v10, s[4:7], s60 offen sc1
s_add_u32 s60, s76, s56
s_add_u32 s60, s60, 9216
buffer_store_dword v28, v10, s[4:7], s60 offen sc1
s_add_u32 s60, s76, s56
s_add_u32 s60, s60, 18432
buffer_store_dword v28, v10, s[4:7], s60 offen sc1
s_mov_b64 exec, -1
s_mov_b32 s8, s22
s_and_b32 s9, s23, 0xffff
s_mov_b32 s10, 9216
s_mov_b32 s11, 0x20000
s_lshl_b32 s60, s3, 6
v_add_u32 v24, s60, v0
v_lshrrev_b32 v26, 3, v24
v_lshlrev_b32 v26, 2, v26
v_and_b32 v27, 7, v24
v_mul_u32_u24 v27, 1152, v27
v_add_u32 v26, v26, v27
buffer_load_dword v16, v26, s[8:11], 0 offen offset:0
buffer_load_dword v17, v26, s[8:11], 0 offen offset:128
buffer_load_dword v18, v26, s[8:11], 0 offen offset:256
buffer_load_dword v19, v26, s[8:11], 0 offen offset:384
buffer_load_dword v20, v26, s[8:11], 0 offen offset:512
buffer_load_dword v21, v26, s[8:11], 0 offen offset:640
buffer_load_dword v22, v26, s[8:11], 0 offen offset:768
buffer_load_dword v23, v26, s[8:11], 0 offen offset:896
buffer_load_dword v14, v26, s[8:11], 0 offen offset:1024
v_bfe_u32 v24, v0, 4, 1
v_lshrrev_b32 v25, 5, v0
v_bfe_u32 v26, v0, 2, 2
v_lshlrev_b32 v27, 5, v24
v_lshl_add_u32 v27, v25, 3, v27
v_add_u32 v27, v27, v26
v_lshlrev_b32 v27, 8, v27
v_lshl_add_u32 v26, v24, 2, v26
s_lshl_b32 s60, s3, 1
s_add_u32 s60, s60, 0
v_xor_b32 v26, s60, v26
v_lshl_add_u32 v27, v26, 5, v27
v_and_b32 v26, 3, v0
v_lshl_add_u32 v15, v26, 3, v27
v_bfe_u32 v24, v0, 4, 1
v_lshrrev_b32 v25, 5, v0
v_bfe_u32 v26, v0, 2, 2
v_lshlrev_b32 v27, 5, v24
v_lshl_add_u32 v27, v25, 3, v27
v_add_u32 v27, v27, v26
v_lshlrev_b32 v27, 8, v27
v_lshl_add_u32 v26, v24, 2, v26
s_lshl_b32 s60, s3, 1
s_add_u32 s60, s60, 1
v_xor_b32 v26, s60, v26
v_lshl_add_u32 v27, v26, 5, v27
v_and_b32 v26, 3, v0
v_lshl_add_u32 v13, v26, 3, v27
v_lshrrev_b32 v24, 4, v0
v_lshlrev_b32 v24, 3, v24
v_bfe_u32 v25, v0, 2, 2
v_add_u32 v24, v24, v25
v_mul_u32_u24 v24, 1152, v24
v_and_b32 v25, 3, v0
v_lshl_add_u32 v24, v25, 3, v24
s_mul_i32 s60, s3, 288
v_add_u32 v8, s60, v24
s_waitcnt vmcnt(40)
s_barrier
v_add_u32 v28, 0, v15
v_add_u32 v29, 0, v13
ds_read_b64_tr_b16 a[0:1], v28 offset:0
ds_read_b64_tr_b16 a[2:3], v28 offset:1024
ds_read_b64_tr_b16 a[4:5], v28 offset:4096
ds_read_b64_tr_b16 a[6:7], v28 offset:5120
ds_read_b64_tr_b16 a[72:73], v29 offset:0
ds_read_b64_tr_b16 a[74:75], v29 offset:1024
ds_read_b64_tr_b16 a[76:77], v29 offset:4096
ds_read_b64_tr_b16 a[78:79], v29 offset:5120
s_waitcnt lgkmcnt(0)
ds_read_b64_tr_b16 a[8:9], v28 offset:16384
ds_read_b64_tr_b16 a[10:11], v28 offset:17408
ds_read_b64_tr_b16 a[12:13], v28 offset:20480
ds_read_b64_tr_b16 a[14:15], v28 offset:21504
ds_read_b64_tr_b16 a[80:81], v29 offset:16384
ds_read_b64_tr_b16 a[82:83], v29 offset:17408
ds_read_b64_tr_b16 a[84:85], v29 offset:20480
ds_read_b64_tr_b16 a[86:87], v29 offset:21504
s_waitcnt lgkmcnt(0)
ds_read_b64_tr_b16 a[16:17], v28 offset:32768
ds_read_b64_tr_b16 a[18:19], v28 offset:33792
ds_read_b64_tr_b16 a[20:21], v28 offset:36864
ds_read_b64_tr_b16 a[22:23], v28 offset:37888
ds_read_b64_tr_b16 a[88:89], v29 offset:32768
ds_read_b64_tr_b16 a[90:91], v29 offset:33792
ds_read_b64_tr_b16 a[92:93], v29 offset:36864
ds_read_b64_tr_b16 a[94:95], v29 offset:37888
s_waitcnt lgkmcnt(0)
s_barrier
s_mov_b32 s8, s26
s_and_b32 s9, s27, 0xffff
s_mov_b32 s10, 4718592
s_mov_b32 s11, 0x20000
s_lshl_b32 s61, s51, 8
s_mul_i32 s60, s3, 393216
s_add_u32 s61, s61, s60
s_add_u32 s61, s61, 0
s_mul_i32 s60, s3, 12288
s_add_u32 m0, s60, 0
s_mul_i32 s62, s3, 48
s_add_u32 s63, s62, 48
sq_257:
s_bitcmp1_b32 s62, 5
s_cbranch_scc1 sq_258
buffer_load_dwordx4 v32, s[8:11], s61 offen lds
s_branch sq_259
sq_258:
buffer_load_dwordx4 v33, s[8:11], s61 offen lds
sq_259:
s_add_u32 s62, s62, 4
s_add_u32 s61, s61, 32768
s_add_u32 m0, m0, 1024
s_cmp_lt_u32 s62, s63
s_cbranch_scc1 sq_257
s_waitcnt vmcnt(40)
s_barrier
v_add_u32 v28, 49152, v15
v_add_u32 v29, 49152, v13
ds_read_b64_tr_b16 a[24:25], v28 offset:0
ds_read_b64_tr_b16 a[26:27], v28 offset:1024
ds_read_b64_tr_b16 a[28:29], v28 offset:4096
ds_read_b64_tr_b16 a[30:31], v28 offset:5120
ds_read_b64_tr_b16 a[96:97], v29 offset:0
ds_read_b64_tr_b16 a[98:99], v29 offset:1024
ds_read_b64_tr_b16 a[100:101], v29 offset:4096
ds_read_b64_tr_b16 a[102:103], v29 offset:5120
s_waitcnt lgkmcnt(0)
ds_read_b64_tr_b16 a[32:33], v28 offset:16384
ds_read_b64_tr_b16 a[34:35], v28 offset:17408
ds_read_b64_tr_b16 a[36:37], v28 offset:20480
ds_read_b64_tr_b16 a[38:39], v28 offset:21504
ds_read_b64_tr_b16 a[104:105], v29 offset:16384
ds_read_b64_tr_b16 a[106:107], v29 offset:17408
ds_read_b64_tr_b16 a[108:109], v29 offset:20480
ds_read_b64_tr_b16 a[110:111], v29 offset:21504
s_waitcnt lgkmcnt(0)
ds_read_b64_tr_b16 a[40:41], v28 offset:32768
ds_read_b64_tr_b16 a[42:43], v28 offset:33792
ds_read_b64_tr_b16 a[44:45], v28 offset:36864
ds_read_b64_tr_b16 a[46:47], v28 offset:37888
ds_read_b64_tr_b16 a[112:113], v29 offset:32768
ds_read_b64_tr_b16 a[114:115], v29 offset:33792
ds_read_b64_tr_b16 a[116:117], v29 offset:36864
ds_read_b64_tr_b16 a[118:119], v29 offset:37888
s_waitcnt lgkmcnt(0)
s_barrier
s_mov_b32 s8, s26
s_and_b32 s9, s27, 0xffff
s_mov_b32 s10, 4718592
s_mov_b32 s11, 0x20000
s_lshl_b32 s61, s51, 8
s_mul_i32 s60, s3, 393216
s_add_u32 s61, s61, s60
s_add_u32 s61, s61, 1572864
s_mul_i32 s60, s3, 12288
s_add_u32 m0, s60, 49152
s_mul_i32 s62, s3, 48
s_add_u32 s63, s62, 48
sq_260:
s_bitcmp1_b32 s62, 5
s_cbranch_scc1 sq_261
buffer_load_dwordx4 v32, s[8:11], s61 offen lds
s_branch sq_262
sq_261:
buffer_load_dwordx4 v33, s[8:11], s61 offen lds
sq_262:
s_add_u32 s62, s62, 4
s_add_u32 s61, s61, 32768
s_add_u32 m0, m0, 1024
s_cmp_lt_u32 s62, s63
s_cbranch_scc1 sq_260
s_waitcnt vmcnt(40)
s_barrier
s_or_b32 s60, s3, s58
s_cbranch_scc1 pri_263
v_mov_b32 v24, 1
v_mov_b32 v25, 224
s_mov_b64 exec, 1
buffer_atomic_add v24, v25, s[12:15], 0 offen
s_mov_b64 exec, -1
pri_263:
v_add_u32 v28, 98304, v15
v_add_u32 v29, 98304, v13
ds_read_b64_tr_b16 a[48:49], v28 offset:0
ds_read_b64_tr_b16 a[50:51], v28 offset:1024
ds_read_b64_tr_b16 a[52:53], v28 offset:4096
ds_read_b64_tr_b16 a[54:55], v28 offset:5120
ds_read_b64_tr_b16 a[120:121], v29 offset:0
ds_read_b64_tr_b16 a[122:123], v29 offset:1024
ds_read_b64_tr_b16 a[124:125], v29 offset:4096
ds_read_b64_tr_b16 a[126:127], v29 offset:5120
s_waitcnt lgkmcnt(0)
ds_read_b64_tr_b16 a[56:57], v28 offset:16384
ds_read_b64_tr_b16 a[58:59], v28 offset:17408
ds_read_b64_tr_b16 a[60:61], v28 offset:20480
ds_read_b64_tr_b16 a[62:63], v28 offset:21504
ds_read_b64_tr_b16 a[128:129], v29 offset:16384
ds_read_b64_tr_b16 a[130:131], v29 offset:17408
ds_read_b64_tr_b16 a[132:133], v29 offset:20480
ds_read_b64_tr_b16 a[134:135], v29 offset:21504
s_waitcnt lgkmcnt(0)
ds_read_b64_tr_b16 a[64:65], v28 offset:32768
ds_read_b64_tr_b16 a[66:67], v28 offset:33792
ds_read_b64_tr_b16 a[68:69], v28 offset:36864
ds_read_b64_tr_b16 a[70:71], v28 offset:37888
ds_read_b64_tr_b16 a[136:137], v29 offset:32768
ds_read_b64_tr_b16 a[138:139], v29 offset:33792
ds_read_b64_tr_b16 a[140:141], v29 offset:36864
ds_read_b64_tr_b16 a[142:143], v29 offset:37888
s_waitcnt lgkmcnt(0)
s_barrier
s_mov_b32 s8, s26
s_and_b32 s9, s27, 0xffff
s_mov_b32 s10, 4718592
s_mov_b32 s11, 0x20000
s_lshl_b32 s61, s51, 8
s_mul_i32 s60, s3, 393216
s_add_u32 s61, s61, s60
s_add_u32 s61, s61, 3145728
s_mul_i32 s60, s3, 12288
s_add_u32 m0, s60, 98304
s_mul_i32 s62, s3, 48
s_add_u32 s63, s62, 48
sq_264:
s_bitcmp1_b32 s62, 5
s_cbranch_scc1 sq_265
buffer_load_dwordx4 v32, s[8:11], s61 offen lds
s_branch sq_266
sq_265:
buffer_load_dwordx4 v33, s[8:11], s61 offen lds
sq_266:
s_add_u32 s62, s62, 4
s_add_u32 s61, s61, 32768
s_add_u32 m0, m0, 1024
s_cmp_lt_u32 s62, s63
s_cbranch_scc1 sq_264
s_waitcnt vmcnt(24)
s_barrier
s_cmp_lg_u32 s3, 0
s_cbranch_scc1 cb_267
v_mov_b32 v24, s52
v_mov_b32 v25, s57
s_mov_b64 exec, 1
buffer_atomic_add v24, v25, s[12:15], 0 offen
s_mov_b64 exec, -1
cb_267:
v_add_u32 v28, 0, v15
v_add_u32 v29, 0, v13
ds_read_b64_tr_b16 a[144:145], v28 offset:0
ds_read_b64_tr_b16 a[146:147], v28 offset:1024
ds_read_b64_tr_b16 a[148:149], v28 offset:4096
ds_read_b64_tr_b16 a[150:151], v28 offset:5120
ds_read_b64_tr_b16 a[216:217], v29 offset:0
ds_read_b64_tr_b16 a[218:219], v29 offset:1024
ds_read_b64_tr_b16 a[220:221], v29 offset:4096
ds_read_b64_tr_b16 a[222:223], v29 offset:5120
s_waitcnt lgkmcnt(0)
ds_read_b64_tr_b16 a[152:153], v28 offset:16384
ds_read_b64_tr_b16 a[154:155], v28 offset:17408
ds_read_b64_tr_b16 a[156:157], v28 offset:20480
ds_read_b64_tr_b16 a[158:159], v28 offset:21504
ds_read_b64_tr_b16 a[224:225], v29 offset:16384
ds_read_b64_tr_b16 a[226:227], v29 offset:17408
ds_read_b64_tr_b16 a[228:229], v29 offset:20480
ds_read_b64_tr_b16 a[230:231], v29 offset:21504
s_waitcnt lgkmcnt(0)
ds_read_b64_tr_b16 a[160:161], v28 offset:32768
ds_read_b64_tr_b16 a[162:163], v28 offset:33792
ds_read_b64_tr_b16 a[164:165], v28 offset:36864
ds_read_b64_tr_b16 a[166:167], v28 offset:37888
ds_read_b64_tr_b16 a[232:233], v29 offset:32768
ds_read_b64_tr_b16 a[234:235], v29 offset:33792
ds_read_b64_tr_b16 a[236:237], v29 offset:36864
ds_read_b64_tr_b16 a[238:239], v29 offset:37888
s_waitcnt lgkmcnt(0)
s_barrier
s_mov_b32 s8, s30
s_and_b32 s9, s31, 0xffff
s_mov_b32 s10, 4718592
s_mov_b32 s11, 0x20000
s_mul_i32 s61, s51, 147456
s_mul_i32 s60, s3, 9216
s_add_u32 s61, s61, s60
s_add_u32 s61, s61, 0
s_add_u32 m0, s60, 0
s_mov_b32 s62, 9
so_268:
buffer_load_dwordx4 v1, s[8:11], s61 offen lds
s_add_u32 s61, s61, 1024
s_add_u32 m0, m0, 1024
s_sub_u32 s62, s62, 1
s_cmp_lg_u32 s62, 0
s_cbranch_scc1 so_268
s_waitcnt vmcnt(21)
s_barrier
v_add_u32 v28, 49152, v15
v_add_u32 v29, 49152, v13
ds_read_b64_tr_b16 a[168:169], v28 offset:0
ds_read_b64_tr_b16 a[170:171], v28 offset:1024
ds_read_b64_tr_b16 a[172:173], v28 offset:4096
ds_read_b64_tr_b16 a[174:175], v28 offset:5120
ds_read_b64_tr_b16 a[240:241], v29 offset:0
ds_read_b64_tr_b16 a[242:243], v29 offset:1024
ds_read_b64_tr_b16 a[244:245], v29 offset:4096
ds_read_b64_tr_b16 a[246:247], v29 offset:5120
s_waitcnt lgkmcnt(0)
ds_read_b64_tr_b16 a[176:177], v28 offset:16384
ds_read_b64_tr_b16 a[178:179], v28 offset:17408
ds_read_b64_tr_b16 a[180:181], v28 offset:20480
ds_read_b64_tr_b16 a[182:183], v28 offset:21504
ds_read_b64_tr_b16 a[248:249], v29 offset:16384
ds_read_b64_tr_b16 a[250:251], v29 offset:17408
ds_read_b64_tr_b16 a[252:253], v29 offset:20480
ds_read_b64_tr_b16 a[254:255], v29 offset:21504
s_waitcnt lgkmcnt(0)
ds_read_b64_tr_b16 a[184:185], v28 offset:32768
ds_read_b64_tr_b16 a[186:187], v28 offset:33792
ds_read_b64_tr_b16 a[188:189], v28 offset:36864
ds_read_b64_tr_b16 a[190:191], v28 offset:37888
ds_read_b64_tr_b16 v[72:73], v29 offset:32768
ds_read_b64_tr_b16 v[74:75], v29 offset:33792
ds_read_b64_tr_b16 v[76:77], v29 offset:36864
ds_read_b64_tr_b16 v[78:79], v29 offset:37888
s_waitcnt lgkmcnt(0)
s_barrier
s_mov_b32 s8, s30
s_and_b32 s9, s31, 0xffff
s_mov_b32 s10, 4718592
s_mov_b32 s11, 0x20000
s_mul_i32 s61, s51, 147456
s_mul_i32 s60, s3, 9216
s_add_u32 s61, s61, s60
s_add_u32 s61, s61, 36864
s_add_u32 m0, s60, 49152
s_mov_b32 s62, 9
so_269:
buffer_load_dwordx4 v1, s[8:11], s61 offen lds
s_add_u32 s61, s61, 1024
s_add_u32 m0, m0, 1024
s_sub_u32 s62, s62, 1
s_cmp_lg_u32 s62, 0
s_cbranch_scc1 so_269
s_waitcnt vmcnt(18)
s_barrier
v_add_u32 v28, 98304, v15
v_add_u32 v29, 98304, v13
ds_read_b64_tr_b16 a[192:193], v28 offset:0
ds_read_b64_tr_b16 a[194:195], v28 offset:1024
ds_read_b64_tr_b16 a[196:197], v28 offset:4096
ds_read_b64_tr_b16 a[198:199], v28 offset:5120
ds_read_b64_tr_b16 v[80:81], v29 offset:0
ds_read_b64_tr_b16 v[82:83], v29 offset:1024
ds_read_b64_tr_b16 v[84:85], v29 offset:4096
ds_read_b64_tr_b16 v[86:87], v29 offset:5120
s_waitcnt lgkmcnt(0)
ds_read_b64_tr_b16 a[200:201], v28 offset:16384
ds_read_b64_tr_b16 a[202:203], v28 offset:17408
ds_read_b64_tr_b16 a[204:205], v28 offset:20480
ds_read_b64_tr_b16 a[206:207], v28 offset:21504
ds_read_b64_tr_b16 v[88:89], v29 offset:16384
ds_read_b64_tr_b16 v[90:91], v29 offset:17408
ds_read_b64_tr_b16 v[92:93], v29 offset:20480
ds_read_b64_tr_b16 v[94:95], v29 offset:21504
s_waitcnt lgkmcnt(0)
ds_read_b64_tr_b16 a[208:209], v28 offset:32768
ds_read_b64_tr_b16 a[210:211], v28 offset:33792
ds_read_b64_tr_b16 a[212:213], v28 offset:36864
ds_read_b64_tr_b16 a[214:215], v28 offset:37888
ds_read_b64_tr_b16 v[96:97], v29 offset:32768
ds_read_b64_tr_b16 v[98:99], v29 offset:33792
ds_read_b64_tr_b16 v[100:101], v29 offset:36864
ds_read_b64_tr_b16 v[102:103], v29 offset:37888
s_waitcnt lgkmcnt(0)
s_barrier
s_mov_b32 s8, s30
s_and_b32 s9, s31, 0xffff
s_mov_b32 s10, 4718592
s_mov_b32 s11, 0x20000
s_mul_i32 s61, s51, 147456
s_mul_i32 s60, s3, 9216
s_add_u32 s61, s61, s60
s_add_u32 s61, s61, 73728
s_add_u32 m0, s60, 98304
s_mov_b32 s62, 9
so_270:
buffer_load_dwordx4 v1, s[8:11], s61 offen lds
s_add_u32 s61, s61, 1024
s_add_u32 m0, m0, 1024
s_sub_u32 s62, s62, 1
s_cmp_lg_u32 s62, 0
s_cbranch_scc1 so_270
s_waitcnt vmcnt(18)
s_barrier
v_add_u32 v28, 0, v8
ds_read_b64_tr_b16 v[104:105], v28 offset:0
ds_read_b64_tr_b16 v[106:107], v28 offset:4608
ds_read_b64_tr_b16 v[120:121], v28 offset:32
ds_read_b64_tr_b16 v[122:123], v28 offset:4640
ds_read_b64_tr_b16 v[136:137], v28 offset:64
ds_read_b64_tr_b16 v[138:139], v28 offset:4672
s_waitcnt lgkmcnt(0)
ds_read_b64_tr_b16 v[152:153], v28 offset:96
ds_read_b64_tr_b16 v[154:155], v28 offset:4704
ds_read_b64_tr_b16 v[168:169], v28 offset:128
ds_read_b64_tr_b16 v[170:171], v28 offset:4736
ds_read_b64_tr_b16 v[184:185], v28 offset:160
ds_read_b64_tr_b16 v[186:187], v28 offset:4768
s_waitcnt lgkmcnt(0)
ds_read_b64_tr_b16 v[200:201], v28 offset:192
ds_read_b64_tr_b16 v[202:203], v28 offset:4800
ds_read_b64_tr_b16 v[216:217], v28 offset:224
ds_read_b64_tr_b16 v[218:219], v28 offset:4832
ds_read_b64_tr_b16 v[232:233], v28 offset:256
ds_read_b64_tr_b16 v[234:235], v28 offset:4864
s_waitcnt lgkmcnt(0)
s_barrier
s_mov_b32 s8, s30
s_and_b32 s9, s31, 0xffff
s_mov_b32 s10, 4718592
s_mov_b32 s11, 0x20000
s_mul_i32 s61, s51, 147456
s_mul_i32 s60, s3, 9216
s_add_u32 s61, s61, s60
s_add_u32 s61, s61, 110592
s_add_u32 m0, s60, 0
s_mov_b32 s62, 9
so_271:
buffer_load_dwordx4 v1, s[8:11], s61 offen lds
s_add_u32 s61, s61, 1024
s_add_u32 m0, m0, 1024
s_sub_u32 s62, s62, 1
s_cmp_lg_u32 s62, 0
s_cbranch_scc1 so_271
s_waitcnt vmcnt(18)
s_barrier
v_add_u32 v28, 49152, v8
ds_read_b64_tr_b16 v[108:109], v28 offset:0
ds_read_b64_tr_b16 v[110:111], v28 offset:4608
ds_read_b64_tr_b16 v[124:125], v28 offset:32
ds_read_b64_tr_b16 v[126:127], v28 offset:4640
ds_read_b64_tr_b16 v[140:141], v28 offset:64
ds_read_b64_tr_b16 v[142:143], v28 offset:4672
s_waitcnt lgkmcnt(0)
ds_read_b64_tr_b16 v[156:157], v28 offset:96
ds_read_b64_tr_b16 v[158:159], v28 offset:4704
ds_read_b64_tr_b16 v[172:173], v28 offset:128
ds_read_b64_tr_b16 v[174:175], v28 offset:4736
ds_read_b64_tr_b16 v[188:189], v28 offset:160
ds_read_b64_tr_b16 v[190:191], v28 offset:4768
s_waitcnt lgkmcnt(0)
ds_read_b64_tr_b16 v[204:205], v28 offset:192
ds_read_b64_tr_b16 v[206:207], v28 offset:4800
ds_read_b64_tr_b16 v[220:221], v28 offset:224
ds_read_b64_tr_b16 v[222:223], v28 offset:4832
ds_read_b64_tr_b16 v[236:237], v28 offset:256
ds_read_b64_tr_b16 v[238:239], v28 offset:4864
s_waitcnt lgkmcnt(0)
s_barrier
s_mov_b32 s8, s28
s_and_b32 s9, s29, 0xffff
s_mov_b32 s10, 4718592
s_mov_b32 s11, 0x20000
s_lshl_b32 s61, s51, 8
s_mul_i32 s60, s3, 393216
s_add_u32 s61, s61, s60
s_add_u32 s61, s61, 1572864
s_mul_i32 s60, s3, 12288
s_add_u32 m0, s60, 49152
s_mul_i32 s62, s3, 48
s_add_u32 s63, s62, 48
sq_272:
s_bitcmp1_b32 s62, 5
s_cbranch_scc1 sq_273
buffer_load_dwordx4 v32, s[8:11], s61 offen lds
s_branch sq_274
sq_273:
buffer_load_dwordx4 v33, s[8:11], s61 offen lds
sq_274:
s_add_u32 s62, s62, 4
s_add_u32 s61, s61, 32768
s_add_u32 m0, m0, 1024
s_cmp_lt_u32 s62, s63
s_cbranch_scc1 sq_272
s_waitcnt vmcnt(21)
s_barrier
v_lshlrev_b32 v24, 2, v0
v_add_u32 v25, 128, v24
v_cmp_le_u32 vcc, 2, v0
s_nop 1
v_cndmask_b32 v24, v24, v25, vcc
s_mov_b32 s60, 192
v_writelane_b32 v24, s60, 8
v_writelane_b32 v24, s57, 9
s_mov_b64 exec, 0x3ff
buffer_load_dword v27, v24, s[12:15], 0 offen sc1
s_mov_b64 exec, -1
v_add_u32 v28, 98304, v8
ds_read_b64_tr_b16 v[112:113], v28 offset:0
ds_read_b64_tr_b16 v[114:115], v28 offset:4608
ds_read_b64_tr_b16 v[128:129], v28 offset:32
ds_read_b64_tr_b16 v[130:131], v28 offset:4640
ds_read_b64_tr_b16 v[144:145], v28 offset:64
ds_read_b64_tr_b16 v[146:147], v28 offset:4672
s_waitcnt lgkmcnt(0)
ds_read_b64_tr_b16 v[160:161], v28 offset:96
ds_read_b64_tr_b16 v[162:163], v28 offset:4704
ds_read_b64_tr_b16 v[176:177], v28 offset:128
ds_read_b64_tr_b16 v[178:179], v28 offset:4736
ds_read_b64_tr_b16 v[192:193], v28 offset:160
ds_read_b64_tr_b16 v[194:195], v28 offset:4768
s_waitcnt lgkmcnt(0)
ds_read_b64_tr_b16 v[208:209], v28 offset:192
ds_read_b64_tr_b16 v[210:211], v28 offset:4800
ds_read_b64_tr_b16 v[224:225], v28 offset:224
ds_read_b64_tr_b16 v[226:227], v28 offset:4832
ds_read_b64_tr_b16 v[240:241], v28 offset:256
ds_read_b64_tr_b16 v[242:243], v28 offset:4864
s_waitcnt lgkmcnt(0)
s_barrier
s_mov_b32 s8, s28
s_and_b32 s9, s29, 0xffff
s_mov_b32 s10, 4718592
s_mov_b32 s11, 0x20000
s_lshl_b32 s61, s51, 8
s_mul_i32 s60, s3, 393216
s_add_u32 s61, s61, s60
s_add_u32 s61, s61, 3145728
s_mul_i32 s60, s3, 12288
s_add_u32 m0, s60, 98304
s_mul_i32 s62, s3, 48
s_add_u32 s63, s62, 48
sq_275:
s_bitcmp1_b32 s62, 5
s_cbranch_scc1 sq_276
buffer_load_dwordx4 v32, s[8:11], s61 offen lds
s_branch sq_277
sq_276:
buffer_load_dwordx4 v33, s[8:11], s61 offen lds
sq_277:
s_add_u32 s62, s62, 4
s_add_u32 s61, s61, 32768
s_add_u32 m0, m0, 1024
s_cmp_lt_u32 s62, s63
s_cbranch_scc1 sq_275
s_waitcnt vmcnt(24)
s_barrier
v_add_u32 v28, 0, v8
ds_read_b64_tr_b16 v[116:117], v28 offset:0
ds_read_b64_tr_b16 v[118:119], v28 offset:4608
ds_read_b64_tr_b16 v[132:133], v28 offset:32
ds_read_b64_tr_b16 v[134:135], v28 offset:4640
ds_read_b64_tr_b16 v[148:149], v28 offset:64
ds_read_b64_tr_b16 v[150:151], v28 offset:4672
s_waitcnt lgkmcnt(0)
ds_read_b64_tr_b16 v[164:165], v28 offset:96
ds_read_b64_tr_b16 v[166:167], v28 offset:4704
ds_read_b64_tr_b16 v[180:181], v28 offset:128
ds_read_b64_tr_b16 v[182:183], v28 offset:4736
ds_read_b64_tr_b16 v[196:197], v28 offset:160
ds_read_b64_tr_b16 v[198:199], v28 offset:4768
s_waitcnt lgkmcnt(0)
ds_read_b64_tr_b16 v[212:213], v28 offset:192
ds_read_b64_tr_b16 v[214:215], v28 offset:4800
ds_read_b64_tr_b16 v[228:229], v28 offset:224
ds_read_b64_tr_b16 v[230:231], v28 offset:4832
ds_read_b64_tr_b16 v[244:245], v28 offset:256
ds_read_b64_tr_b16 v[246:247], v28 offset:4864
s_waitcnt lgkmcnt(0)
s_barrier
s_mov_b32 s8, s28
s_and_b32 s9, s29, 0xffff
s_mov_b32 s10, 4718592
s_mov_b32 s11, 0x20000
s_lshl_b32 s61, s51, 8
s_mul_i32 s60, s3, 393216
s_add_u32 s61, s61, s60
s_add_u32 s61, s61, 0
s_mul_i32 s60, s3, 12288
s_add_u32 m0, s60, 0
s_mul_i32 s62, s3, 48
s_add_u32 s63, s62, 48
sq_278:
s_bitcmp1_b32 s62, 5
s_cbranch_scc1 sq_279
buffer_load_dwordx4 v32, s[8:11], s61 offen lds
s_branch sq_280
sq_279:
buffer_load_dwordx4 v33, s[8:11], s61 offen lds
sq_280:
s_add_u32 s62, s62, 4
s_add_u32 s61, s61, 32768
s_add_u32 m0, m0, 1024
s_cmp_lt_u32 s62, s63
s_cbranch_scc1 sq_278
s_waitcnt vmcnt(24)
s_barrier
v_cmp_eq_u32 vcc, 32, v27
s_nop 0
s_and_b32 s60, vcc_lo, 0x3ff
s_cmp_eq_u32 s60, 0x3ff
s_cselect_b32 s100, 1, 0
buffer_load_dword v26, v7, s[4:7], s58 offen sc1
v_add_u32 v28, 49152, v15
v_add_u32 v29, 49152, v13
ds_read_b64_tr_b16 v[32:33], v28 offset:0
ds_read_b64_tr_b16 v[34:35], v28 offset:1024
ds_read_b64_tr_b16 v[36:37], v28 offset:4096
ds_read_b64_tr_b16 v[38:39], v28 offset:5120
ds_read_b64_tr_b16 v[40:41], v29 offset:0
ds_read_b64_tr_b16 v[42:43], v29 offset:1024
ds_read_b64_tr_b16 v[44:45], v29 offset:4096
ds_read_b64_tr_b16 v[46:47], v29 offset:5120
s_waitcnt lgkmcnt(0)
ds_read_b64_tr_b16 v[48:49], v28 offset:16384
ds_read_b64_tr_b16 v[50:51], v28 offset:17408
ds_read_b64_tr_b16 v[52:53], v28 offset:20480
ds_read_b64_tr_b16 v[54:55], v28 offset:21504
ds_read_b64_tr_b16 v[56:57], v29 offset:16384
ds_read_b64_tr_b16 v[58:59], v29 offset:17408
ds_read_b64_tr_b16 v[60:61], v29 offset:20480
ds_read_b64_tr_b16 v[62:63], v29 offset:21504
s_waitcnt lgkmcnt(0)
ds_read_b64_tr_b16 v[64:65], v28 offset:32768
ds_read_b64_tr_b16 v[66:67], v28 offset:33792
ds_read_b64_tr_b16 v[68:69], v28 offset:36864
ds_read_b64_tr_b16 v[70:71], v28 offset:37888
ds_read_b64_tr_b16 v[248:249], v29 offset:32768
ds_read_b64_tr_b16 v[250:251], v29 offset:33792
ds_read_b64_tr_b16 v[252:253], v29 offset:36864
ds_read_b64_tr_b16 v[254:255], v29 offset:37888
s_waitcnt lgkmcnt(0)
s_barrier
s_lshl_b32 s60, s3, 12
s_add_u32 s60, s60, 49152
v_add_u32 v28, s60, v1
ds_write_b128 v28, v[32:35] offset:0
ds_write_b128 v28, v[36:39] offset:1024
ds_write_b128 v28, v[40:43] offset:2048
ds_write_b128 v28, v[44:47] offset:3072
ds_write_b128 v28, v[48:51] offset:16384
ds_write_b128 v28, v[52:55] offset:17408
ds_write_b128 v28, v[56:59] offset:18432
ds_write_b128 v28, v[60:63] offset:19456
ds_write_b128 v28, v[64:67] offset:32768
ds_write_b128 v28, v[68:71] offset:33792
ds_write_b128 v28, v[248:251] offset:34816
ds_write_b128 v28, v[252:255] offset:35840
s_waitcnt lgkmcnt(0)
s_barrier
s_waitcnt vmcnt(0)
s_barrier
v_add_u32 v28, 0, v15
v_add_u32 v29, 0, v13
ds_read_b64_tr_b16 v[32:33], v28 offset:0
ds_read_b64_tr_b16 v[34:35], v28 offset:1024
ds_read_b64_tr_b16 v[36:37], v28 offset:4096
ds_read_b64_tr_b16 v[38:39], v28 offset:5120
ds_read_b64_tr_b16 v[40:41], v29 offset:0
ds_read_b64_tr_b16 v[42:43], v29 offset:1024
ds_read_b64_tr_b16 v[44:45], v29 offset:4096
ds_read_b64_tr_b16 v[46:47], v29 offset:5120
s_waitcnt lgkmcnt(0)
ds_read_b64_tr_b16 v[48:49], v28 offset:16384
ds_read_b64_tr_b16 v[50:51], v28 offset:17408
ds_read_b64_tr_b16 v[52:53], v28 offset:20480
ds_read_b64_tr_b16 v[54:55], v28 offset:21504
ds_read_b64_tr_b16 v[56:57], v29 offset:16384
ds_read_b64_tr_b16 v[58:59], v29 offset:17408
ds_read_b64_tr_b16 v[60:61], v29 offset:20480
ds_read_b64_tr_b16 v[62:63], v29 offset:21504
s_waitcnt lgkmcnt(0)
ds_read_b64_tr_b16 v[64:65], v28 offset:32768
ds_read_b64_tr_b16 v[66:67], v28 offset:33792
ds_read_b64_tr_b16 v[68:69], v28 offset:36864
ds_read_b64_tr_b16 v[70:71], v28 offset:37888
ds_read_b64_tr_b16 v[248:249], v29 offset:32768
ds_read_b64_tr_b16 v[250:251], v29 offset:33792
ds_read_b64_tr_b16 v[252:253], v29 offset:36864
ds_read_b64_tr_b16 v[254:255], v29 offset:37888
s_waitcnt lgkmcnt(0)
s_barrier
s_lshl_b32 s60, s3, 12
s_add_u32 s60, s60, 0
v_add_u32 v28, s60, v1
ds_write_b128 v28, v[32:35] offset:0
ds_write_b128 v28, v[36:39] offset:1024
ds_write_b128 v28, v[40:43] offset:2048
ds_write_b128 v28, v[44:47] offset:3072
ds_write_b128 v28, v[48:51] offset:16384
ds_write_b128 v28, v[52:55] offset:17408
ds_write_b128 v28, v[56:59] offset:18432
ds_write_b128 v28, v[60:63] offset:19456
ds_write_b128 v28, v[64:67] offset:32768
ds_write_b128 v28, v[68:71] offset:33792
ds_write_b128 v28, v[248:251] offset:34816
ds_write_b128 v28, v[252:255] offset:35840
s_waitcnt lgkmcnt(0)
s_barrier
s_waitcnt vmcnt(12)
s_barrier
v_add_u32 v28, 98304, v15
v_add_u32 v29, 98304, v13
ds_read_b64_tr_b16 v[32:33], v28 offset:0
ds_read_b64_tr_b16 v[34:35], v28 offset:1024
ds_read_b64_tr_b16 v[36:37], v28 offset:4096
ds_read_b64_tr_b16 v[38:39], v28 offset:5120
ds_read_b64_tr_b16 v[40:41], v29 offset:0
ds_read_b64_tr_b16 v[42:43], v29 offset:1024
ds_read_b64_tr_b16 v[44:45], v29 offset:4096
ds_read_b64_tr_b16 v[46:47], v29 offset:5120
s_waitcnt lgkmcnt(0)
ds_read_b64_tr_b16 v[48:49], v28 offset:16384
ds_read_b64_tr_b16 v[50:51], v28 offset:17408
ds_read_b64_tr_b16 v[52:53], v28 offset:20480
ds_read_b64_tr_b16 v[54:55], v28 offset:21504
ds_read_b64_tr_b16 v[56:57], v29 offset:16384
ds_read_b64_tr_b16 v[58:59], v29 offset:17408
ds_read_b64_tr_b16 v[60:61], v29 offset:20480
ds_read_b64_tr_b16 v[62:63], v29 offset:21504
s_waitcnt lgkmcnt(0)
ds_read_b64_tr_b16 v[64:65], v28 offset:32768
ds_read_b64_tr_b16 v[66:67], v28 offset:33792
ds_read_b64_tr_b16 v[68:69], v28 offset:36864
ds_read_b64_tr_b16 v[70:71], v28 offset:37888
ds_read_b64_tr_b16 v[248:249], v29 offset:32768
ds_read_b64_tr_b16 v[250:251], v29 offset:33792
ds_read_b64_tr_b16 v[252:253], v29 offset:36864
ds_read_b64_tr_b16 v[254:255], v29 offset:37888
s_waitcnt lgkmcnt(0)
s_barrier
s_lshl_b32 s60, s3, 12
s_add_u32 s60, s60, 98304
v_add_u32 v28, s60, v1
ds_write_b128 v28, v[32:35] offset:0
ds_write_b128 v28, v[36:39] offset:1024
ds_write_b128 v28, v[40:43] offset:2048
ds_write_b128 v28, v[44:47] offset:3072
ds_write_b128 v28, v[48:51] offset:16384
ds_write_b128 v28, v[52:55] offset:17408
ds_write_b128 v28, v[56:59] offset:18432
ds_write_b128 v28, v[60:63] offset:19456
s_lshl_b32 s60, s3, 11
s_add_u32 s60, s60, 131072
v_add_u32 v29, s60, v1
ds_write_b128 v29, v[64:67] offset:0
ds_write_b128 v29, v[68:71] offset:1024
s_waitcnt lgkmcnt(0)
s_barrier
s_lshl_b32 s60, s3, 6
v_add_u32 v24, s60, v0
v_lshlrev_b32 v25, 2, v24
v_add_u32 v25, 139264, v25
ds_write_b32 v25, v16 offset:0
ds_write_b32 v25, v17 offset:1024
ds_write_b32 v25, v18 offset:2048
ds_write_b32 v25, v19 offset:3072
ds_write_b32 v25, v20 offset:4096
ds_write_b32 v25, v21 offset:5120
ds_write_b32 v25, v22 offset:6144
ds_write_b32 v25, v23 offset:7168
ds_write_b32 v25, v14 offset:8192
s_waitcnt lgkmcnt(0)
s_mov_b32 s47, 0
s_cmp_lg_u32 s100, 0
s_cbranch_scc1 quick_281
s_mov_b32 s67, 0
v_mov_b32 v25, s57
cbp_282:
buffer_load_dword v24, v25, s[12:15], 0 offen sc1
s_add_u32 s67, s67, 1
s_cmp_gt_u32 s67, 400000
s_cbranch_scc1 chain_fail_246
s_waitcnt vmcnt(0)
v_readfirstlane_b32 s61, v24
s_nop 0
s_and_b32 s60, s61, 0xffff
s_cmp_lt_u32 s60, 32
s_cbranch_scc1 cbp_282
s_lshr_b32 s47, s61, 16
s_mov_b32 s12, s40
s_and_b32 s13, s41, 0xffff
s_mov_b32 s14, 256
s_mov_b32 s15, 0x20000
v_lshlrev_b32 v24, 2, v0
v_add_u32 v25, 128, v24
v_cmp_le_u32 vcc, 2, v0
s_nop 1
v_cndmask_b32 v24, v24, v25, vcc
v_mov_b32 v25, 192
v_cmp_eq_u32 vcc, 8, v0
s_nop 1
v_cndmask_b32 v24, v24, v25, vcc
v_mov_b32 v25, 2147483632
v_cmp_lt_u32 vcc, 8, v0
s_nop 1
v_cndmask_b32 v24, v24, v25, vcc
s_mov_b32 s98, 0
wi_loop_283:
buffer_load_dword v25, v24, s[12:15], 0 offen sc1
s_add_u32 s98, s98, 1
s_cmp_gt_u32 s98, 150000
s_cbranch_scc1 wi_bad_285
s_waitcnt vmcnt(0)
v_cmp_eq_u32 vcc, 32, v25
s_nop 0
s_and_b32 s97, vcc_lo, 0x1ff
s_cmp_eq_u32 s97, 0x1ff
s_cbranch_scc1 wi_ok_284
v_cmp_lt_u32 vcc, 32, v25
s_nop 0
s_and_b32 s96, vcc_lo, 0xff
s_cselect_b32 s96, 0x100, 0
s_and_b32 s96, s96, s97
s_cbranch_scc1 wi_over_286
s_sleep 8
s_branch wi_loop_283
wi_bad_285:
s_mov_b32 s98, 512
s_branch L_fail
wi_over_286:
s_mov_b32 s100, 255
wi_ok_284:
v_mov_b32 v26, 0
quick_281:
s_waitcnt vmcnt(0)
v_cmp_gt_u32 vcc, 1, v26
s_nop 0
s_and_b32 vcc_lo, vcc_lo, 31
s_cselect_b32 s100, 0, 1
s_mov_b32 s98, 0xff800000
s_mov_b32 s99, 0xff800000
s_cmp_lg_u32 s47, 0
s_cbranch_scc1 chain_foreign_287
s_mov_b32 s62, 0
s_lshl_b32 s65, s3, 11
s_add_u32 s65, s65, 16384
s_mul_i32 s63, s51, 24576
s_add_u32 s63, s63, s53
s_mul_i32 s77, s51, 4096
s_add_u32 s77, s77, s54
s_mov_b32 s59, s77
v_mov_b32 v8, 1
v_mov_b64 v[48:49], 0
v_mov_b64 v[50:51], 0
v_mov_b64 v[52:53], 0
v_mov_b64 v[54:55], 0
v_mov_b64 v[56:57], 0
v_mov_b64 v[58:59], 0
v_mov_b64 v[60:61], 0
v_mov_b64 v[62:63], 0
v_mov_b64 v[64:65], 0
v_mov_b64 v[66:67], 0
v_mov_b64 v[68:69], 0
v_mov_b64 v[70:71], 0
s_lshl_b32 s60, s3, 12
v_add_u32 v15, s60, v1
s_lshl_b32 s60, s3, 11
s_add_u32 s60, s60, 131072
v_add_u32 v14, s60, v1
s_cmp_lg_u32 s3, 3
s_cbranch_scc1 kx0_288
s_cmp_lg_u32 s100, 0
s_cbranch_scc1 kx0_288
s_add_u32 s61, s62, 1
s_mov_b32 s67, 0
sp_loop_289:
buffer_load_dword v32, v7, s[4:7], s58 offen sc1
s_add_u32 s67, s67, 1
s_cmp_gt_u32 s67, 150000
s_cbranch_scc1 sp_bad_291
s_waitcnt vmcnt(0)
v_cmp_gt_u32 vcc, s61, v32
s_nop 0
s_and_b32 vcc_lo, vcc_lo, 31
s_cbranch_scc0 sp_ok_290
s_sleep 1
s_branch sp_loop_289
sp_bad_291:
s_mov_b32 s98, 1792
s_branch L_fail
sp_ok_290:
kx0_288:
s_barrier
chain_loop_292:
ds_read_b64_tr_b16 v[24:25], v2 offset:0
ds_read_b64_tr_b16 v[26:27], v2 offset:512
ds_read_b128 v[32:35], v15 offset:0
ds_read_b128 v[36:39], v15 offset:1024
ds_read_b64_tr_b16 v[28:29], v2 offset:1024
ds_read_b64_tr_b16 v[30:31], v2 offset:1536
s_sub_u32 s60, s65, 8192
s_add_u32 m0, s60, 146432
s_add_u32 s60, s60, s63
v_lshlrev_b32 v13, 7, v0
s_add_u32 s61, s63, s65
buffer_load_dwordx4 v1, s[4:7], s60 offen offset:0 sc1 lds
buffer_load_dwordx4 v1, s[4:7], s60 offen offset:1024 sc1 lds
s_mov_b64 exec, 0xffff
buffer_load_dword v13, v13, s[4:7], s61 offen sc1
s_mov_b64 exec, -1
s_waitcnt lgkmcnt(4)
v_smfmac_f32_16x16x64_bf16 v[48:51], v[24:27], a[0:7], v3
ds_read_b128 v[40:43], v15 offset:2048
v_smfmac_f32_16x16x64_bf16 v[52:55], v[24:27], a[72:79], v3
ds_read_b128 v[44:47], v15 offset:3072
v_smfmac_f32_16x16x64_bf16 v[56:59], v[24:27], a[144:151], v3
ds_read_b128 v[16:19], v15 offset:16384
v_smfmac_f32_16x16x64_bf16 v[60:63], v[24:27], a[216:223], v3
ds_read_b128 v[20:23], v15 offset:17408
s_waitcnt lgkmcnt(6)
v_smfmac_f32_16x16x64_bf16 v[64:67], v[24:27], v[32:39], v3
ds_read_b128 v[32:35], v15 offset:18432
s_waitcnt lgkmcnt(3)
v_smfmac_f32_16x16x64_bf16 v[68:71], v[24:27], v[40:47], v3
ds_read_b128 v[36:39], v15 offset:19456
v_smfmac_f32_16x16x64_bf16 v[48:51], v[28:31], a[8:15], v3
ds_read_b64_tr_b16 v[24:25], v2 offset:2048
v_smfmac_f32_16x16x64_bf16 v[52:55], v[28:31], a[80:87], v3
ds_read_b64_tr_b16 v[26:27], v2 offset:2560
v_smfmac_f32_16x16x64_bf16 v[56:59], v[28:31], a[152:159], v3
ds_read_b128 v[40:43], v15 offset:32768
v_smfmac_f32_16x16x64_bf16 v[60:63], v[28:31], a[224:231], v3
ds_read_b128 v[44:47], v15 offset:33792
s_waitcnt lgkmcnt(6)
v_smfmac_f32_16x16x64_bf16 v[64:67], v[28:31], v[16:23], v3
ds_read_b128 v[16:19], v15 offset:34816
s_waitcnt lgkmcnt(5)
v_smfmac_f32_16x16x64_bf16 v[68:71], v[28:31], v[32:39], v3
ds_read_b128 v[20:23], v15 offset:35840
s_waitcnt lgkmcnt(4)
v_smfmac_f32_16x16x64_bf16 v[48:51], v[24:27], a[16:23], v3
ds_read_b64_tr_b16 v[28:29], v2 offset:3072
v_smfmac_f32_16x16x64_bf16 v[52:55], v[24:27], a[88:95], v3
ds_read_b64_tr_b16 v[30:31], v2 offset:3584
v_smfmac_f32_16x16x64_bf16 v[56:59], v[24:27], a[160:167], v3
ds_read_b128 v[32:35], v15 offset:49152
v_smfmac_f32_16x16x64_bf16 v[60:63], v[24:27], a[232:239], v3
ds_read_b128 v[36:39], v15 offset:50176
s_waitcnt lgkmcnt(6)
v_smfmac_f32_16x16x64_bf16 v[64:67], v[24:27], v[40:47], v3
ds_read_b128 v[40:43], v15 offset:51200
s_waitcnt lgkmcnt(5)
v_smfmac_f32_16x16x64_bf16 v[68:71], v[24:27], v[16:23], v3
ds_read_b128 v[44:47], v15 offset:52224
s_waitcnt lgkmcnt(4)
v_smfmac_f32_16x16x64_bf16 v[48:51], v[28:31], a[24:31], v3
ds_read_b64_tr_b16 v[24:25], v2 offset:4096
v_smfmac_f32_16x16x64_bf16 v[52:55], v[28:31], a[96:103], v3
ds_read_b64_tr_b16 v[26:27], v2 offset:4608
v_smfmac_f32_16x16x64_bf16 v[56:59], v[28:31], a[168:175], v3
v_add_u32 v15, 65536, v15
ds_read_b128 v[16:19], v15 offset:0
v_smfmac_f32_16x16x64_bf16 v[60:63], v[28:31], a[240:247], v3
ds_read_b128 v[20:23], v15 offset:1024
s_waitcnt lgkmcnt(6)
v_smfmac_f32_16x16x64_bf16 v[64:67], v[28:31], v[32:39], v3
ds_read_b128 v[32:35], v15 offset:2048
s_waitcnt lgkmcnt(5)
v_smfmac_f32_16x16x64_bf16 v[68:71], v[28:31], v[40:47], v3
ds_read_b128 v[36:39], v15 offset:3072
s_waitcnt lgkmcnt(4)
v_smfmac_f32_16x16x64_bf16 v[48:51], v[24:27], a[32:39], v3
ds_read_b64_tr_b16 v[28:29], v2 offset:5120
v_smfmac_f32_16x16x64_bf16 v[52:55], v[24:27], a[104:111], v3
ds_read_b64_tr_b16 v[30:31], v2 offset:5632
v_smfmac_f32_16x16x64_bf16 v[56:59], v[24:27], a[176:183], v3
ds_read_b128 v[40:43], v15 offset:16384
v_smfmac_f32_16x16x64_bf16 v[60:63], v[24:27], a[248:255], v3
ds_read_b128 v[44:47], v15 offset:17408
s_waitcnt lgkmcnt(6)
v_smfmac_f32_16x16x64_bf16 v[64:67], v[24:27], v[16:23], v3
ds_read_b128 v[16:19], v15 offset:18432
s_waitcnt lgkmcnt(5)
v_smfmac_f32_16x16x64_bf16 v[68:71], v[24:27], v[32:39], v3
ds_read_b128 v[20:23], v15 offset:19456
s_waitcnt lgkmcnt(4)
v_smfmac_f32_16x16x64_bf16 v[48:51], v[28:31], a[40:47], v3
ds_read_b64_tr_b16 v[24:25], v2 offset:6144
v_smfmac_f32_16x16x64_bf16 v[52:55], v[28:31], a[112:119], v3
ds_read_b64_tr_b16 v[26:27], v2 offset:6656
v_smfmac_f32_16x16x64_bf16 v[56:59], v[28:31], a[184:191], v3
ds_read_b128 v[32:35], v15 offset:32768
v_smfmac_f32_16x16x64_bf16 v[60:63], v[28:31], v[72:79], v3
ds_read_b128 v[36:39], v15 offset:33792
s_waitcnt lgkmcnt(6)
v_smfmac_f32_16x16x64_bf16 v[64:67], v[28:31], v[40:47], v3
ds_read_b128 v[40:43], v15 offset:34816
s_waitcnt lgkmcnt(5)
v_smfmac_f32_16x16x64_bf16 v[68:71], v[28:31], v[16:23], v3
ds_read_b128 v[44:47], v15 offset:35840
s_waitcnt lgkmcnt(4)
v_smfmac_f32_16x16x64_bf16 v[48:51], v[24:27], a[48:55], v3
ds_read_b64_tr_b16 v[28:29], v2 offset:7168
v_smfmac_f32_16x16x64_bf16 v[52:55], v[24:27], a[120:127], v3
ds_read_b64_tr_b16 v[30:31], v2 offset:7680
v_smfmac_f32_16x16x64_bf16 v[56:59], v[24:27], a[192:199], v3
ds_read_b128 v[16:19], v15 offset:49152
v_smfmac_f32_16x16x64_bf16 v[60:63], v[24:27], v[80:87], v3
ds_read_b128 v[20:23], v15 offset:50176
s_waitcnt lgkmcnt(6)
v_smfmac_f32_16x16x64_bf16 v[64:67], v[24:27], v[32:39], v3
ds_read_b128 v[32:35], v15 offset:51200
s_waitcnt lgkmcnt(5)
v_smfmac_f32_16x16x64_bf16 v[68:71], v[24:27], v[40:47], v3
ds_read_b128 v[36:39], v15 offset:52224
s_waitcnt lgkmcnt(4)
v_smfmac_f32_16x16x64_bf16 v[48:51], v[28:31], a[56:63], v3
ds_read_b64_tr_b16 v[24:25], v2 offset:8192
v_smfmac_f32_16x16x64_bf16 v[52:55], v[28:31], a[128:135], v3
ds_read_b64_tr_b16 v[26:27], v2 offset:8704
v_smfmac_f32_16x16x64_bf16 v[56:59], v[28:31], a[200:207], v3
ds_read_b128 v[40:43], v14 offset:0
v_smfmac_f32_16x16x64_bf16 v[60:63], v[28:31], v[88:95], v3
ds_read_b128 v[44:47], v14 offset:1024
v_add_u32 v15, 152576, v1
s_waitcnt lgkmcnt(2)
v_smfmac_f32_16x16x64_bf16 v[48:51], v[24:27], a[64:71], v3
v_smfmac_f32_16x16x64_bf16 v[52:55], v[24:27], a[136:143], v3
v_smfmac_f32_16x16x64_bf16 v[56:59], v[24:27], a[208:215], v3
v_smfmac_f32_16x16x64_bf16 v[60:63], v[24:27], v[96:103], v3
s_add_u32 s61, s63, s65
v_smfmac_f32_16x16x64_bf16 v[64:67], v[28:31], v[16:23], v3
v_smfmac_f32_16x16x64_bf16 v[68:71], v[28:31], v[32:39], v3
s_nop 1
v_add_f32 v48, v48, v49
v_add_f32 v50, v50, v51
v_cvt_pk_bf16_f32 v49, v48, v50
s_waitcnt lgkmcnt(0)
v_smfmac_f32_16x16x64_bf16 v[64:67], v[24:27], v[40:47], v3
v_add_f32 v52, v52, v53
v_add_f32 v54, v54, v55
v_cvt_pk_bf16_f32 v53, v52, v54
v_smfmac_f32_16x16x64_bf16 v[68:71], v[24:27], v[248:255], v3
v_add_f32 v56, v56, v57
v_add_f32 v58, v58, v59
v_cvt_pk_bf16_f32 v48, v56, v58
ds_write_b64 v4, v[48:49] offset:0
v_add_f32 v60, v60, v61
v_add_f32 v62, v62, v63
v_cvt_pk_bf16_f32 v52, v60, v62
ds_write_b64 v4, v[52:53] offset:512
buffer_load_dwordx4 v[16:19], v1, s[4:7], s61 offen sc1
buffer_load_dwordx4 v[20:23], v1, s[4:7], s61 offen offset:1024 sc1
v_add_f32 v64, v64, v65
v_add_f32 v66, v66, v67
v_cvt_pk_bf16_f32 v28, v64, v66
v_add_f32 v68, v68, v69
v_add_f32 v70, v70, v71
v_cvt_pk_bf16_f32 v29, v68, v70
s_waitcnt vmcnt(3) lgkmcnt(0)
s_barrier
ds_read_b64_tr_b16 v[48:49], v5 offset:0
ds_read_b64_tr_b16 v[50:51], v5 offset:256
ds_read_b128 v[32:35], v15 offset:2048
ds_read_b128 v[36:39], v15 offset:3072
ds_read_b64_tr_b16 v[52:53], v5 offset:1024
ds_read_b64_tr_b16 v[54:55], v5 offset:1280
ds_read_b128 v[40:43], v15 offset:4096
ds_read_b128 v[44:47], v15 offset:5120
ds_read_b64_tr_b16 v[64:65], v5 offset:2048
ds_read_b64_tr_b16 v[66:67], v5 offset:2304
ds_read_b64_tr_b16 v[68:69], v5 offset:3072
ds_read_b64_tr_b16 v[70:71], v5 offset:3328
s_add_u32 s61, s77, s78
v_and_or_b32 v28, v28, s70, v8
buffer_store_dwordx2 v[28:29], v2, s[4:7], s61 offen sc1
v_mov_b64 v[24:25], 0
v_mov_b64 v[26:27], s[98:99]
s_waitcnt lgkmcnt(10)
s_nop 0
v_mfma_f32_16x16x32_bf16 v[24:27], v[48:51], v[48:51], v[24:27]
s_waitcnt lgkmcnt(8)
v_mfma_f32_16x16x32_bf16 v[56:59], v[32:35], v[48:51], 0
v_mfma_f32_16x16x32_bf16 v[60:63], v[36:39], v[48:51], 0
ds_read_b128 v[32:35], v15 offset:6144
ds_read_b128 v[36:39], v15 offset:7168
s_waitcnt lgkmcnt(8)
v_mfma_f32_16x16x32_bf16 v[24:27], v[52:55], v[52:55], v[24:27]
s_waitcnt lgkmcnt(6)
v_mfma_f32_16x16x32_bf16 v[56:59], v[40:43], v[52:55], v[56:59]
v_mfma_f32_16x16x32_bf16 v[60:63], v[44:47], v[52:55], v[60:63]
ds_read_b128 v[40:43], v15 offset:8192
ds_read_b128 v[44:47], v15 offset:9216
s_waitcnt lgkmcnt(6)
v_mfma_f32_16x16x32_bf16 v[24:27], v[64:67], v[64:67], v[24:27]
s_waitcnt lgkmcnt(2)
v_mfma_f32_16x16x32_bf16 v[56:59], v[32:35], v[64:67], v[56:59]
v_mfma_f32_16x16x32_bf16 v[60:63], v[36:39], v[64:67], v[60:63]
v_mfma_f32_16x16x32_bf16 v[24:27], v[68:71], v[68:71], v[24:27]
s_waitcnt lgkmcnt(0)
v_mfma_f32_16x16x32_bf16 v[56:59], v[40:43], v[68:71], v[56:59]
v_mfma_f32_16x16x32_bf16 v[60:63], v[44:47], v[68:71], v[60:63]
s_mov_b32 exec_lo, 0x33333333
s_mov_b32 exec_hi, 0x33333333
s_cmp_ge_u32 s3, 2
s_cbranch_scc1 km23_294
s_bitcmp1_b32 s3, 0
s_cbranch_scc1 km_295
v_and_or_b32 v48, v48, s70, v8
buffer_store_dwordx4 v[48:51], v12, s[4:7], s77 offen offset:0 sc1
s_branch kmd_293
km_295:
v_and_or_b32 v52, v52, s70, v8
buffer_store_dwordx4 v[52:55], v12, s[4:7], s77 offen offset:512 sc1
s_branch kmd_293
km23_294:
s_bitcmp1_b32 s3, 0
s_cbranch_scc1 km_296
v_and_or_b32 v64, v64, s70, v8
buffer_store_dwordx4 v[64:67], v12, s[4:7], s77 offen offset:1024 sc1
s_branch kmd_293
km_296:
v_and_or_b32 v68, v68, s70, v8
buffer_store_dwordx4 v[68:71], v12, s[4:7], s77 offen offset:1536 sc1
kmd_293:
s_mov_b64 exec, -1
s_cmp_eq_u32 s62, 63
s_cbranch_scc1 chain_done_247
v_mov_b32 v36, 0x3f803f80
v_mov_b32 v37, 0x3f803f80
v_mov_b32 v45, 0
v_mov_b32 v46, 0
v_mov_b64 v[38:39], v[36:37]
v_max3_f32 v32, v24, v25, v56
v_max3_f32 v32, v32, v57, v58
v_max3_f32 v32, v32, v59, v60
v_max3_f32 v32, v32, v61, v62
v_max_f32 v32, v32, v63
v_mov_b32 v33, v32
s_add_u32 s63, s63, 786432
s_add_u32 s62, s62, 1
v_permlane16_swap_b32 v33, v32
v_max_f32 v32, v32, v33
v_mov_b32 v33, v32
s_and_b32 s64, s62, 1
s_nop 0
v_permlane32_swap_b32 v33, v32
v_max_f32 v32, v32, v33
v_mul_f32 v32, s66, v32
v_pk_fma_f32 v[24:25], v[24:25], s[66:67], v[32:33] op_sel_hi:[1,0,0] neg_lo:[0,0,1] neg_hi:[0,0,1]
v_pk_fma_f32 v[56:57], v[56:57], s[66:67], v[32:33] op_sel_hi:[1,0,0] neg_lo:[0,0,1] neg_hi:[0,0,1]
v_pk_fma_f32 v[58:59], v[58:59], s[66:67], v[32:33] op_sel_hi:[1,0,0] neg_lo:[0,0,1] neg_hi:[0,0,1]
v_pk_fma_f32 v[60:61], v[60:61], s[66:67], v[32:33] op_sel_hi:[1,0,0] neg_lo:[0,0,1] neg_hi:[0,0,1]
v_pk_fma_f32 v[62:63], v[62:63], s[66:67], v[32:33] op_sel_hi:[1,0,0] neg_lo:[0,0,1] neg_hi:[0,0,1]
v_exp_f32 v24, v24
v_exp_f32 v25, v25
v_exp_f32 v56, v56
v_exp_f32 v57, v57
v_cvt_pk_bf16_f32 v44, v24, v25
v_cvt_pk_bf16_f32 v47, v24, v25
v_exp_f32 v58, v58
v_exp_f32 v59, v59
v_mfma_f32_16x16x16_bf16 v[48:51], v[36:37], v[44:45], 0
v_exp_f32 v60, v60
v_mfma_f32_16x16x16_bf16 v[68:71], v[28:29], v[46:47], 0
v_exp_f32 v61, v61
v_mfma_f32_16x16x16_bf16 v[64:67], v[28:29], v[44:45], 0
v_exp_f32 v62, v62
v_exp_f32 v63, v63
v_cvt_pk_bf16_f32 v40, v56, v57
v_cvt_pk_bf16_f32 v41, v58, v59
v_cvt_pk_bf16_f32 v42, v60, v61
v_cvt_pk_bf16_f32 v43, v62, v63
s_waitcnt vmcnt(2)
s_nop 0
v_mfma_f32_16x16x32_bf16 v[48:51], v[36:39], v[40:43], v[48:51]
v_mfma_f32_16x16x32_bf16 v[68:71], v[20:23], v[40:43], v[68:71]
v_mfma_f32_16x16x32_bf16 v[64:67], v[16:19], v[40:43], v[64:67]
v_mov_b32 v13, s64
v_mov_b64 v[24:25], 0
v_mov_b64 v[26:27], 0
v_mov_b64 v[56:57], 0
v_mov_b64 v[58:59], 0
v_mov_b64 v[60:61], 0
v_mov_b64 v[62:63], 0
v_rcp_f32 v52, v48
s_nop 0
v_pk_mul_f32 v[68:69], v[68:69], v[52:53] op_sel_hi:[1,0]
v_pk_mul_f32 v[70:71], v[70:71], v[52:53] op_sel_hi:[1,0]
s_nop 0
v_cvt_pk_bf16_f32 v50, v68, v70
v_cvt_pk_bf16_f32 v51, v69, v71
v_pk_mul_f32 v[64:65], v[64:65], v[52:53] op_sel_hi:[1,0]
v_pk_mul_f32 v[66:67], v[66:67], v[52:53] op_sel_hi:[1,0]
s_mov_b32 exec_lo, 0xcccccccc
s_mov_b32 exec_hi, 0xcccccccc
ds_write_b32 v6, v50 offset:256
ds_write_b32 v6, v51 offset:272
s_mov_b64 exec, -1
v_cvt_pk_bf16_f32 v48, v64, v66
v_cvt_pk_bf16_f32 v49, v65, v67
s_mov_b32 exec_lo, 0xcccccccc
s_mov_b32 exec_hi, 0xcccccccc
ds_write_b32 v6, v48
ds_write_b32 v6, v49 offset:16
s_mov_b64 exec, -1
v_mov_b64 v[32:33], 0
v_mov_b64 v[34:35], 0
v_mov_b64 v[36:37], 0
v_mov_b64 v[38:39], 0
v_mov_b64 v[40:41], 0
v_mov_b64 v[42:43], 0
v_mov_b64 v[44:45], 0
v_mov_b64 v[46:47], 0
v_add_u32 v20, 152576, v1
s_waitcnt lgkmcnt(0)
s_barrier
ds_read_b128 v[48:51], v20 offset:0
ds_read_b128 v[52:55], v20 offset:1024
v_mov_b64 v[64:65], 0
v_mov_b64 v[66:67], 0
v_mov_b64 v[68:69], 0
v_mov_b64 v[70:71], 0
s_mov_b64 exec, 31
buffer_load_dword v23, v7, s[4:7], s58 offen sc1
s_mov_b64 exec, -1
s_add_u32 s45, s74, 32768
s_waitcnt lgkmcnt(0)
v_smfmac_f32_16x16x64_bf16 v[24:27], v[48:51], v[232:239], v3
v_smfmac_f32_16x16x64_bf16 v[24:27], v[52:55], v[240:247], v3
v_smfmac_f32_16x16x64_bf16 v[32:35], v[48:51], v[104:111], v3
v_smfmac_f32_16x16x64_bf16 v[36:39], v[48:51], v[120:127], v3
v_smfmac_f32_16x16x64_bf16 v[40:43], v[48:51], v[136:143], v3
v_smfmac_f32_16x16x64_bf16 v[44:47], v[48:51], v[152:159], v3
s_nop 3
v_add_f32 v24, v24, v25
v_add_f32 v26, v26, v27
v_smfmac_f32_16x16x64_bf16 v[32:35], v[52:55], v[112:119], v3
v_cvt_pk_bf16_f32 v24, v24, v26
v_smfmac_f32_16x16x64_bf16 v[36:39], v[52:55], v[128:135], v3
s_nop 0
v_permlane32_swap_b32 v24, v26
v_smfmac_f32_16x16x64_bf16 v[40:43], v[52:55], v[144:151], v3
s_nop 0
v_permlane16_swap_b32 v24, v25
v_permlane16_swap_b32 v26, v27
v_smfmac_f32_16x16x64_bf16 v[44:47], v[52:55], v[160:167], v3
v_and_or_b32 v24, v24, s70, v13
v_smfmac_f32_16x16x64_bf16 v[56:59], v[48:51], v[168:175], v3
s_mov_b64 exec, 0xffff
buffer_store_dwordx4 v[24:27], v9, s[4:7], s49 offen
s_mov_b64 exec, -1
v_smfmac_f32_16x16x64_bf16 v[60:63], v[48:51], v[184:191], v3
v_add_f32 v32, v32, v33
v_add_f32 v34, v34, v35
v_smfmac_f32_16x16x64_bf16 v[64:67], v[48:51], v[200:207], v3
v_cvt_pk_bf16_f32 v28, v32, v34
v_add_f32 v36, v36, v37
v_smfmac_f32_16x16x64_bf16 v[68:71], v[48:51], v[216:223], v3
v_add_f32 v38, v38, v39
v_cvt_pk_bf16_f32 v29, v36, v38
v_smfmac_f32_16x16x64_bf16 v[56:59], v[52:55], v[176:183], v3
v_add_f32 v40, v40, v41
v_add_f32 v42, v42, v43
v_smfmac_f32_16x16x64_bf16 v[60:63], v[52:55], v[192:199], v3
v_cvt_pk_bf16_f32 v30, v40, v42
v_add_f32 v44, v44, v45
v_smfmac_f32_16x16x64_bf16 v[64:67], v[52:55], v[208:215], v3
v_add_f32 v46, v46, v47
v_cvt_pk_bf16_f32 v31, v44, v46
v_smfmac_f32_16x16x64_bf16 v[68:71], v[52:55], v[224:231], v3
v_and_or_b32 v28, v28, s70, v13
buffer_store_dwordx4 v[28:31], v9, s[4:7], s74 offen
v_add_f32 v56, v56, v57
v_add_f32 v58, v58, v59
v_cvt_pk_bf16_f32 v32, v56, v58
v_add_f32 v60, v60, v61
v_add_f32 v62, v62, v63
v_cvt_pk_bf16_f32 v33, v60, v62
v_add_f32 v64, v64, v65
v_add_f32 v66, v66, v67
v_cvt_pk_bf16_f32 v34, v64, v66
v_add_f32 v68, v68, v69
v_add_f32 v70, v70, v71
v_cvt_pk_bf16_f32 v35, v68, v70
v_and_or_b32 v32, v32, s70, v13
buffer_store_dwordx4 v[32:35], v9, s[4:7], s45 offen
s_and_b32 s60, s62, 7
s_mul_i32 s60, s60, 131072
s_add_u32 s77, s59, s60
s_bfe_u32 s60, s62, 0x10003
s_xor_b32 s60, s60, 1
v_mov_b32 v8, s60
v_mov_b64 v[48:49], 0
v_mov_b64 v[50:51], 0
v_mov_b64 v[52:53], 0
v_mov_b64 v[54:55], 0
v_mov_b64 v[56:57], 0
v_mov_b64 v[58:59], 0
v_mov_b64 v[60:61], 0
v_mov_b64 v[62:63], 0
v_mov_b64 v[64:65], 0
v_mov_b64 v[66:67], 0
v_mov_b64 v[68:69], 0
v_mov_b64 v[70:71], 0
s_lshl_b32 s60, s3, 12
v_add_u32 v15, s60, v1
s_cmp_eq_u32 s48, 0
s_cbranch_scc1 noown_297
v_and_b32 v20, 15, v0
v_and_b32 v21, 1, v0
v_lshlrev_b32 v21, 4, v21
v_mov_b32 v22, 0x3f80
v_lshlrev_b32 v21, v21, v22
v_lshrrev_b32 v22, 1, v20
v_cmp_eq_u32 vcc, 0, v22
s_nop 1
v_cndmask_b32 v16, 0, v21, vcc
v_cmp_eq_u32 vcc, 1, v22
s_nop 1
v_cndmask_b32 v17, 0, v21, vcc
v_cmp_eq_u32 vcc, 2, v22
s_nop 1
v_cndmask_b32 v18, 0, v21, vcc
v_cmp_eq_u32 vcc, 3, v22
s_nop 1
v_cndmask_b32 v19, 0, v21, vcc
s_sleep 2
s_mov_b32 s67, 0
s_mov_b32 s97, 15
h1_300:
buffer_load_dwordx4 v[32:35], v1, s[4:7], s75 offen offset:0 sc1
buffer_load_dwordx4 v[36:39], v1, s[4:7], s75 offen offset:1024 sc1
buffer_load_dwordx4 v[40:43], v1, s[4:7], s75 offen offset:2048 sc1
buffer_load_dwordx4 v[44:47], v1, s[4:7], s75 offen offset:3072 sc1
s_add_u32 s67, s67, 1
s_cmp_gt_u32 s67, 400000
s_cbranch_scc1 chain_fail_246
s_waitcnt vmcnt(3)
v_mfma_f32_16x16x32_bf16 v[24:27], v[32:35], v[16:19], 0
v_xor_b32 v28, v32, v13
s_waitcnt vmcnt(2)
v_mfma_f32_16x16x32_bf16 v[24:27], v[36:39], v[16:19], v[24:27]
v_bitop3_b32 v28, v28, v36, v13 bitop3:0xf6
s_waitcnt vmcnt(1)
v_mfma_f32_16x16x32_bf16 v[24:27], v[40:43], v[16:19], v[24:27]
v_bitop3_b32 v28, v28, v40, v13 bitop3:0xf6
s_waitcnt vmcnt(0)
v_mfma_f32_16x16x32_bf16 v[24:27], v[44:47], v[16:19], v[24:27]
v_bitop3_b32 v28, v28, v44, v13 bitop3:0xf6
v_and_b32 v28, 1, v28
v_cmp_ne_u32 vcc, 0, v28
s_nop 0
s_cbranch_vccnz h1_300
s_add_u32 s60, s79, s76
s_nop 1
v_permlane32_swap_b32 v24, v26
v_permlane32_swap_b32 v25, v27
v_add_f32 v24, v24, v26
v_add_f32 v25, v25, v27
v_cvt_pk_bf16_f32 v30, v24, v25
v_min_u32 v30, s70, v30
buffer_store_dword v30, v10, s[4:7], s60 offen
noown_297:
s_lshl_b32 s45, s3, 11
s_add_u32 s45, s45, s79
s_lshl_b32 s46, s3, 8
s_add_u32 s46, s46, 8192
s_add_u32 s46, s46, s79
v_and_b32 v20, 0xf0, v1
v_add_u32 v21, s68, v20
s_barrier
s_sleep 1
s_mov_b32 s67, 0
h2_301:
buffer_load_dwordx4 v[24:27], v1, s[4:7], s45 offen offset:0 sc1
buffer_load_dwordx4 v[28:31], v1, s[4:7], s45 offen offset:1024 sc1
buffer_load_dwordx4 v[32:35], v20, s[4:7], s46 offen sc1
s_add_u32 s67, s67, 1
s_cmp_gt_u32 s67, 400000
s_cbranch_scc1 chain_fail_246
s_waitcnt vmcnt(2)
ds_write2_b64 v11, v[24:25], v[26:27] offset1:32
v_max3_u32 v40, v24, v25, v26
v_max3_u32 v40, v40, v26, v27
s_waitcnt vmcnt(1)
ds_write2_b64 v11, v[28:29], v[30:31] offset0:128 offset1:160
v_max3_u32 v40, v28, v29, v40
v_max3_u32 v40, v40, v30, v31
s_waitcnt vmcnt(0)
ds_write_b128 v21, v[32:35]
v_max3_u32 v40, v32, v33, v40
v_max3_u32 v40, v40, v34, v35
v_cmp_eq_u32 vcc, -1, v40
s_nop 0
s_cbranch_vccnz h2_301
v_mov_b32 v41, -1
s_add_u32 s60, s73, s76
buffer_store_dword v41, v10, s[4:7], s60 offen
s_cmp_eq_u32 s3, 3
s_cbranch_scc1 io_298
io_end_299:
s_mov_b32 s60, s79
s_mov_b32 s79, s71
s_mov_b32 s71, s73
s_mov_b32 s73, s60
s_waitcnt lgkmcnt(0)
s_barrier
s_branch chain_loop_292
io_298:
s_sub_u32 s62, s62, 1
s_add_u32 s62, s62, 1
s_add_u32 s61, s62, 1
v_cmp_gt_u32 vcc, s61, v23
s_nop 0
s_and_b32 vcc_lo, vcc_lo, 31
s_cbranch_scc0 io_end_299
s_add_u32 s61, s62, 1
s_mov_b32 s67, 0
sp_loop_302:
buffer_load_dword v32, v7, s[4:7], s58 offen sc1
s_add_u32 s67, s67, 1
s_cmp_gt_u32 s67, 150000
s_cbranch_scc1 sp_bad_304
s_waitcnt vmcnt(0)
v_cmp_gt_u32 vcc, s61, v32
s_nop 0
s_and_b32 vcc_lo, vcc_lo, 31
s_cbranch_scc0 sp_ok_303
s_sleep 1
s_branch sp_loop_302
sp_bad_304:
s_mov_b32 s98, 1792
s_branch L_fail
sp_ok_303:
s_branch io_end_299
chain_foreign_287:
s_mov_b32 s62, 0
s_lshl_b32 s65, s3, 11
s_add_u32 s65, s65, 16384
s_mul_i32 s63, s51, 24576
s_add_u32 s63, s63, s53
s_mul_i32 s77, s51, 4096
s_add_u32 s77, s77, s54
s_mov_b32 s59, s77
v_mov_b32 v8, 1
v_mov_b64 v[48:49], 0
v_mov_b64 v[50:51], 0
v_mov_b64 v[52:53], 0
v_mov_b64 v[54:55], 0
v_mov_b64 v[56:57], 0
v_mov_b64 v[58:59], 0
v_mov_b64 v[60:61], 0
v_mov_b64 v[62:63], 0
v_mov_b64 v[64:65], 0
v_mov_b64 v[66:67], 0
v_mov_b64 v[68:69], 0
v_mov_b64 v[70:71], 0
s_lshl_b32 s60, s3, 12
v_add_u32 v15, s60, v1
s_lshl_b32 s60, s3, 11
s_add_u32 s60, s60, 131072
v_add_u32 v14, s60, v1
s_cmp_lg_u32 s3, 3
s_cbranch_scc1 kx0_305
s_cmp_lg_u32 s100, 0
s_cbranch_scc1 kx0_305
s_add_u32 s61, s62, 1
s_mov_b32 s67, 0
sp_loop_306:
buffer_load_dword v32, v7, s[4:7], s58 offen sc1
s_add_u32 s67, s67, 1
s_cmp_gt_u32 s67, 150000
s_cbranch_scc1 sp_bad_308
s_waitcnt vmcnt(0)
v_cmp_gt_u32 vcc, s61, v32
s_nop 0
s_and_b32 vcc_lo, vcc_lo, 31
s_cbranch_scc0 sp_ok_307
s_sleep 1
s_branch sp_loop_306
sp_bad_308:
s_mov_b32 s98, 1792
s_branch L_fail
sp_ok_307:
kx0_305:
s_barrier
chain_loop_309:
ds_read_b64_tr_b16 v[24:25], v2 offset:0
ds_read_b64_tr_b16 v[26:27], v2 offset:512
ds_read_b128 v[32:35], v15 offset:0
ds_read_b128 v[36:39], v15 offset:1024
ds_read_b64_tr_b16 v[28:29], v2 offset:1024
ds_read_b64_tr_b16 v[30:31], v2 offset:1536
s_sub_u32 s60, s65, 8192
s_add_u32 m0, s60, 146432
s_add_u32 s60, s60, s63
v_lshlrev_b32 v13, 7, v0
s_add_u32 s61, s63, s65
buffer_load_dwordx4 v1, s[4:7], s60 offen offset:0 sc1 lds
buffer_load_dwordx4 v1, s[4:7], s60 offen offset:1024 sc1 lds
s_mov_b64 exec, 0xffff
buffer_load_dword v13, v13, s[4:7], s61 offen sc1
s_mov_b64 exec, -1
s_waitcnt lgkmcnt(4)
v_smfmac_f32_16x16x64_bf16 v[48:51], v[24:27], a[0:7], v3
ds_read_b128 v[40:43], v15 offset:2048
v_smfmac_f32_16x16x64_bf16 v[52:55], v[24:27], a[72:79], v3
ds_read_b128 v[44:47], v15 offset:3072
v_smfmac_f32_16x16x64_bf16 v[56:59], v[24:27], a[144:151], v3
ds_read_b128 v[16:19], v15 offset:16384
v_smfmac_f32_16x16x64_bf16 v[60:63], v[24:27], a[216:223], v3
ds_read_b128 v[20:23], v15 offset:17408
s_waitcnt lgkmcnt(6)
v_smfmac_f32_16x16x64_bf16 v[64:67], v[24:27], v[32:39], v3
ds_read_b128 v[32:35], v15 offset:18432
s_waitcnt lgkmcnt(3)
v_smfmac_f32_16x16x64_bf16 v[68:71], v[24:27], v[40:47], v3
ds_read_b128 v[36:39], v15 offset:19456
v_smfmac_f32_16x16x64_bf16 v[48:51], v[28:31], a[8:15], v3
ds_read_b64_tr_b16 v[24:25], v2 offset:2048
v_smfmac_f32_16x16x64_bf16 v[52:55], v[28:31], a[80:87], v3
ds_read_b64_tr_b16 v[26:27], v2 offset:2560
v_smfmac_f32_16x16x64_bf16 v[56:59], v[28:31], a[152:159], v3
ds_read_b128 v[40:43], v15 offset:32768
v_smfmac_f32_16x16x64_bf16 v[60:63], v[28:31], a[224:231], v3
ds_read_b128 v[44:47], v15 offset:33792
s_waitcnt lgkmcnt(6)
v_smfmac_f32_16x16x64_bf16 v[64:67], v[28:31], v[16:23], v3
ds_read_b128 v[16:19], v15 offset:34816
s_waitcnt lgkmcnt(5)
v_smfmac_f32_16x16x64_bf16 v[68:71], v[28:31], v[32:39], v3
ds_read_b128 v[20:23], v15 offset:35840
s_waitcnt lgkmcnt(4)
v_smfmac_f32_16x16x64_bf16 v[48:51], v[24:27], a[16:23], v3
ds_read_b64_tr_b16 v[28:29], v2 offset:3072
v_smfmac_f32_16x16x64_bf16 v[52:55], v[24:27], a[88:95], v3
ds_read_b64_tr_b16 v[30:31], v2 offset:3584
v_smfmac_f32_16x16x64_bf16 v[56:59], v[24:27], a[160:167], v3
ds_read_b128 v[32:35], v15 offset:49152
v_smfmac_f32_16x16x64_bf16 v[60:63], v[24:27], a[232:239], v3
ds_read_b128 v[36:39], v15 offset:50176
s_waitcnt lgkmcnt(6)
v_smfmac_f32_16x16x64_bf16 v[64:67], v[24:27], v[40:47], v3
ds_read_b128 v[40:43], v15 offset:51200
s_waitcnt lgkmcnt(5)
v_smfmac_f32_16x16x64_bf16 v[68:71], v[24:27], v[16:23], v3
ds_read_b128 v[44:47], v15 offset:52224
s_waitcnt lgkmcnt(4)
v_smfmac_f32_16x16x64_bf16 v[48:51], v[28:31], a[24:31], v3
ds_read_b64_tr_b16 v[24:25], v2 offset:4096
v_smfmac_f32_16x16x64_bf16 v[52:55], v[28:31], a[96:103], v3
ds_read_b64_tr_b16 v[26:27], v2 offset:4608
v_smfmac_f32_16x16x64_bf16 v[56:59], v[28:31], a[168:175], v3
v_add_u32 v15, 65536, v15
ds_read_b128 v[16:19], v15 offset:0
v_smfmac_f32_16x16x64_bf16 v[60:63], v[28:31], a[240:247], v3
ds_read_b128 v[20:23], v15 offset:1024
s_waitcnt lgkmcnt(6)
v_smfmac_f32_16x16x64_bf16 v[64:67], v[28:31], v[32:39], v3
ds_read_b128 v[32:35], v15 offset:2048
s_waitcnt lgkmcnt(5)
v_smfmac_f32_16x16x64_bf16 v[68:71], v[28:31], v[40:47], v3
ds_read_b128 v[36:39], v15 offset:3072
s_waitcnt lgkmcnt(4)
v_smfmac_f32_16x16x64_bf16 v[48:51], v[24:27], a[32:39], v3
ds_read_b64_tr_b16 v[28:29], v2 offset:5120
v_smfmac_f32_16x16x64_bf16 v[52:55], v[24:27], a[104:111], v3
ds_read_b64_tr_b16 v[30:31], v2 offset:5632
v_smfmac_f32_16x16x64_bf16 v[56:59], v[24:27], a[176:183], v3
ds_read_b128 v[40:43], v15 offset:16384
v_smfmac_f32_16x16x64_bf16 v[60:63], v[24:27], a[248:255], v3
ds_read_b128 v[44:47], v15 offset:17408
s_waitcnt lgkmcnt(6)
v_smfmac_f32_16x16x64_bf16 v[64:67], v[24:27], v[16:23], v3
ds_read_b128 v[16:19], v15 offset:18432
s_waitcnt lgkmcnt(5)
v_smfmac_f32_16x16x64_bf16 v[68:71], v[24:27], v[32:39], v3
ds_read_b128 v[20:23], v15 offset:19456
s_waitcnt lgkmcnt(4)
v_smfmac_f32_16x16x64_bf16 v[48:51], v[28:31], a[40:47], v3
ds_read_b64_tr_b16 v[24:25], v2 offset:6144
v_smfmac_f32_16x16x64_bf16 v[52:55], v[28:31], a[112:119], v3
ds_read_b64_tr_b16 v[26:27], v2 offset:6656
v_smfmac_f32_16x16x64_bf16 v[56:59], v[28:31], a[184:191], v3
ds_read_b128 v[32:35], v15 offset:32768
v_smfmac_f32_16x16x64_bf16 v[60:63], v[28:31], v[72:79], v3
ds_read_b128 v[36:39], v15 offset:33792
s_waitcnt lgkmcnt(6)
v_smfmac_f32_16x16x64_bf16 v[64:67], v[28:31], v[40:47], v3
ds_read_b128 v[40:43], v15 offset:34816
s_waitcnt lgkmcnt(5)
v_smfmac_f32_16x16x64_bf16 v[68:71], v[28:31], v[16:23], v3
ds_read_b128 v[44:47], v15 offset:35840
s_waitcnt lgkmcnt(4)
v_smfmac_f32_16x16x64_bf16 v[48:51], v[24:27], a[48:55], v3
ds_read_b64_tr_b16 v[28:29], v2 offset:7168
v_smfmac_f32_16x16x64_bf16 v[52:55], v[24:27], a[120:127], v3
ds_read_b64_tr_b16 v[30:31], v2 offset:7680
v_smfmac_f32_16x16x64_bf16 v[56:59], v[24:27], a[192:199], v3
ds_read_b128 v[16:19], v15 offset:49152
v_smfmac_f32_16x16x64_bf16 v[60:63], v[24:27], v[80:87], v3
ds_read_b128 v[20:23], v15 offset:50176
s_waitcnt lgkmcnt(6)
v_smfmac_f32_16x16x64_bf16 v[64:67], v[24:27], v[32:39], v3
ds_read_b128 v[32:35], v15 offset:51200
s_waitcnt lgkmcnt(5)
v_smfmac_f32_16x16x64_bf16 v[68:71], v[24:27], v[40:47], v3
ds_read_b128 v[36:39], v15 offset:52224
s_waitcnt lgkmcnt(4)
v_smfmac_f32_16x16x64_bf16 v[48:51], v[28:31], a[56:63], v3
ds_read_b64_tr_b16 v[24:25], v2 offset:8192
v_smfmac_f32_16x16x64_bf16 v[52:55], v[28:31], a[128:135], v3
ds_read_b64_tr_b16 v[26:27], v2 offset:8704
v_smfmac_f32_16x16x64_bf16 v[56:59], v[28:31], a[200:207], v3
ds_read_b128 v[40:43], v14 offset:0
v_smfmac_f32_16x16x64_bf16 v[60:63], v[28:31], v[88:95], v3
ds_read_b128 v[44:47], v14 offset:1024
v_add_u32 v15, 152576, v1
s_waitcnt lgkmcnt(2)
v_smfmac_f32_16x16x64_bf16 v[48:51], v[24:27], a[64:71], v3
v_smfmac_f32_16x16x64_bf16 v[52:55], v[24:27], a[136:143], v3
v_smfmac_f32_16x16x64_bf16 v[56:59], v[24:27], a[208:215], v3
v_smfmac_f32_16x16x64_bf16 v[60:63], v[24:27], v[96:103], v3
s_add_u32 s61, s63, s65
v_smfmac_f32_16x16x64_bf16 v[64:67], v[28:31], v[16:23], v3
v_smfmac_f32_16x16x64_bf16 v[68:71], v[28:31], v[32:39], v3
s_nop 1
v_add_f32 v48, v48, v49
v_add_f32 v50, v50, v51
v_cvt_pk_bf16_f32 v49, v48, v50
s_waitcnt lgkmcnt(0)
v_smfmac_f32_16x16x64_bf16 v[64:67], v[24:27], v[40:47], v3
v_add_f32 v52, v52, v53
v_add_f32 v54, v54, v55
v_cvt_pk_bf16_f32 v53, v52, v54
v_smfmac_f32_16x16x64_bf16 v[68:71], v[24:27], v[248:255], v3
v_add_f32 v56, v56, v57
v_add_f32 v58, v58, v59
v_cvt_pk_bf16_f32 v48, v56, v58
ds_write_b64 v4, v[48:49] offset:0
v_add_f32 v60, v60, v61
v_add_f32 v62, v62, v63
v_cvt_pk_bf16_f32 v52, v60, v62
ds_write_b64 v4, v[52:53] offset:512
buffer_load_dwordx4 v[16:19], v1, s[4:7], s61 offen sc1
buffer_load_dwordx4 v[20:23], v1, s[4:7], s61 offen offset:1024 sc1
v_add_f32 v64, v64, v65
v_add_f32 v66, v66, v67
v_cvt_pk_bf16_f32 v28, v64, v66
v_add_f32 v68, v68, v69
v_add_f32 v70, v70, v71
v_cvt_pk_bf16_f32 v29, v68, v70
s_waitcnt vmcnt(3) lgkmcnt(0)
s_barrier
ds_read_b64_tr_b16 v[48:49], v5 offset:0
ds_read_b64_tr_b16 v[50:51], v5 offset:256
ds_read_b128 v[32:35], v15 offset:2048
ds_read_b128 v[36:39], v15 offset:3072
ds_read_b64_tr_b16 v[52:53], v5 offset:1024
ds_read_b64_tr_b16 v[54:55], v5 offset:1280
ds_read_b128 v[40:43], v15 offset:4096
ds_read_b128 v[44:47], v15 offset:5120
ds_read_b64_tr_b16 v[64:65], v5 offset:2048
ds_read_b64_tr_b16 v[66:67], v5 offset:2304
ds_read_b64_tr_b16 v[68:69], v5 offset:3072
ds_read_b64_tr_b16 v[70:71], v5 offset:3328
s_add_u32 s61, s77, s78
v_and_or_b32 v28, v28, s70, v8
buffer_store_dwordx2 v[28:29], v2, s[4:7], s61 offen sc1
v_mov_b64 v[24:25], 0
v_mov_b64 v[26:27], s[98:99]
s_waitcnt lgkmcnt(10)
s_nop 0
v_mfma_f32_16x16x32_bf16 v[24:27], v[48:51], v[48:51], v[24:27]
s_waitcnt lgkmcnt(8)
v_mfma_f32_16x16x32_bf16 v[56:59], v[32:35], v[48:51], 0
v_mfma_f32_16x16x32_bf16 v[60:63], v[36:39], v[48:51], 0
ds_read_b128 v[32:35], v15 offset:6144
ds_read_b128 v[36:39], v15 offset:7168
s_waitcnt lgkmcnt(8)
v_mfma_f32_16x16x32_bf16 v[24:27], v[52:55], v[52:55], v[24:27]
s_waitcnt lgkmcnt(6)
v_mfma_f32_16x16x32_bf16 v[56:59], v[40:43], v[52:55], v[56:59]
v_mfma_f32_16x16x32_bf16 v[60:63], v[44:47], v[52:55], v[60:63]
ds_read_b128 v[40:43], v15 offset:8192
ds_read_b128 v[44:47], v15 offset:9216
s_waitcnt lgkmcnt(6)
v_mfma_f32_16x16x32_bf16 v[24:27], v[64:67], v[64:67], v[24:27]
s_waitcnt lgkmcnt(2)
v_mfma_f32_16x16x32_bf16 v[56:59], v[32:35], v[64:67], v[56:59]
v_mfma_f32_16x16x32_bf16 v[60:63], v[36:39], v[64:67], v[60:63]
v_mfma_f32_16x16x32_bf16 v[24:27], v[68:71], v[68:71], v[24:27]
s_waitcnt lgkmcnt(0)
v_mfma_f32_16x16x32_bf16 v[56:59], v[40:43], v[68:71], v[56:59]
v_mfma_f32_16x16x32_bf16 v[60:63], v[44:47], v[68:71], v[60:63]
s_mov_b32 exec_lo, 0x33333333
s_mov_b32 exec_hi, 0x33333333
s_cmp_ge_u32 s3, 2
s_cbranch_scc1 km23_311
s_bitcmp1_b32 s3, 0
s_cbranch_scc1 km_312
v_and_or_b32 v48, v48, s70, v8
buffer_store_dwordx4 v[48:51], v12, s[4:7], s77 offen offset:0 sc1
s_branch kmd_310
km_312:
v_and_or_b32 v52, v52, s70, v8
buffer_store_dwordx4 v[52:55], v12, s[4:7], s77 offen offset:512 sc1
s_branch kmd_310
km23_311:
s_bitcmp1_b32 s3, 0
s_cbranch_scc1 km_313
v_and_or_b32 v64, v64, s70, v8
buffer_store_dwordx4 v[64:67], v12, s[4:7], s77 offen offset:1024 sc1
s_branch kmd_310
km_313:
v_and_or_b32 v68, v68, s70, v8
buffer_store_dwordx4 v[68:71], v12, s[4:7], s77 offen offset:1536 sc1
kmd_310:
s_mov_b64 exec, -1
s_cmp_eq_u32 s62, 63
s_cbranch_scc1 chain_done_247
v_mov_b32 v36, 0x3f803f80
v_mov_b32 v37, 0x3f803f80
v_mov_b32 v45, 0
v_mov_b32 v46, 0
v_mov_b64 v[38:39], v[36:37]
v_max3_f32 v32, v24, v25, v56
v_max3_f32 v32, v32, v57, v58
v_max3_f32 v32, v32, v59, v60
v_max3_f32 v32, v32, v61, v62
v_max_f32 v32, v32, v63
v_mov_b32 v33, v32
s_add_u32 s63, s63, 786432
s_add_u32 s62, s62, 1
v_permlane16_swap_b32 v33, v32
v_max_f32 v32, v32, v33
v_mov_b32 v33, v32
s_and_b32 s64, s62, 1
s_nop 0
v_permlane32_swap_b32 v33, v32
v_max_f32 v32, v32, v33
v_mul_f32 v32, s66, v32
v_pk_fma_f32 v[24:25], v[24:25], s[66:67], v[32:33] op_sel_hi:[1,0,0] neg_lo:[0,0,1] neg_hi:[0,0,1]
v_pk_fma_f32 v[56:57], v[56:57], s[66:67], v[32:33] op_sel_hi:[1,0,0] neg_lo:[0,0,1] neg_hi:[0,0,1]
v_pk_fma_f32 v[58:59], v[58:59], s[66:67], v[32:33] op_sel_hi:[1,0,0] neg_lo:[0,0,1] neg_hi:[0,0,1]
v_pk_fma_f32 v[60:61], v[60:61], s[66:67], v[32:33] op_sel_hi:[1,0,0] neg_lo:[0,0,1] neg_hi:[0,0,1]
v_pk_fma_f32 v[62:63], v[62:63], s[66:67], v[32:33] op_sel_hi:[1,0,0] neg_lo:[0,0,1] neg_hi:[0,0,1]
v_exp_f32 v24, v24
v_exp_f32 v25, v25
v_exp_f32 v56, v56
v_exp_f32 v57, v57
v_cvt_pk_bf16_f32 v44, v24, v25
v_cvt_pk_bf16_f32 v47, v24, v25
v_exp_f32 v58, v58
v_exp_f32 v59, v59
v_mfma_f32_16x16x16_bf16 v[48:51], v[36:37], v[44:45], 0
v_exp_f32 v60, v60
v_mfma_f32_16x16x16_bf16 v[68:71], v[28:29], v[46:47], 0
v_exp_f32 v61, v61
v_mfma_f32_16x16x16_bf16 v[64:67], v[28:29], v[44:45], 0
v_exp_f32 v62, v62
v_exp_f32 v63, v63
v_cvt_pk_bf16_f32 v40, v56, v57
v_cvt_pk_bf16_f32 v41, v58, v59
v_cvt_pk_bf16_f32 v42, v60, v61
v_cvt_pk_bf16_f32 v43, v62, v63
s_waitcnt vmcnt(2)
s_nop 0
v_mfma_f32_16x16x32_bf16 v[48:51], v[36:39], v[40:43], v[48:51]
v_mfma_f32_16x16x32_bf16 v[68:71], v[20:23], v[40:43], v[68:71]
v_mfma_f32_16x16x32_bf16 v[64:67], v[16:19], v[40:43], v[64:67]
v_mov_b32 v13, s64
v_mov_b64 v[24:25], 0
v_mov_b64 v[26:27], 0
v_mov_b64 v[56:57], 0
v_mov_b64 v[58:59], 0
v_mov_b64 v[60:61], 0
v_mov_b64 v[62:63], 0
v_rcp_f32 v52, v48
s_nop 0
v_pk_mul_f32 v[68:69], v[68:69], v[52:53] op_sel_hi:[1,0]
v_pk_mul_f32 v[70:71], v[70:71], v[52:53] op_sel_hi:[1,0]
s_nop 0
v_cvt_pk_bf16_f32 v50, v68, v70
v_cvt_pk_bf16_f32 v51, v69, v71
v_pk_mul_f32 v[64:65], v[64:65], v[52:53] op_sel_hi:[1,0]
v_pk_mul_f32 v[66:67], v[66:67], v[52:53] op_sel_hi:[1,0]
s_mov_b32 exec_lo, 0xcccccccc
s_mov_b32 exec_hi, 0xcccccccc
ds_write_b32 v6, v50 offset:256
ds_write_b32 v6, v51 offset:272
s_mov_b64 exec, -1
v_cvt_pk_bf16_f32 v48, v64, v66
v_cvt_pk_bf16_f32 v49, v65, v67
s_mov_b32 exec_lo, 0xcccccccc
s_mov_b32 exec_hi, 0xcccccccc
ds_write_b32 v6, v48
ds_write_b32 v6, v49 offset:16
s_mov_b64 exec, -1
v_mov_b64 v[32:33], 0
v_mov_b64 v[34:35], 0
v_mov_b64 v[36:37], 0
v_mov_b64 v[38:39], 0
v_mov_b64 v[40:41], 0
v_mov_b64 v[42:43], 0
v_mov_b64 v[44:45], 0
v_mov_b64 v[46:47], 0
v_add_u32 v20, 152576, v1
s_waitcnt lgkmcnt(0)
s_barrier
ds_read_b128 v[48:51], v20 offset:0
ds_read_b128 v[52:55], v20 offset:1024
v_mov_b64 v[64:65], 0
v_mov_b64 v[66:67], 0
v_mov_b64 v[68:69], 0
v_mov_b64 v[70:71], 0
s_mov_b64 exec, 31
buffer_load_dword v23, v7, s[4:7], s58 offen sc1
s_mov_b64 exec, -1
s_add_u32 s45, s74, 32768
s_waitcnt lgkmcnt(0)
v_smfmac_f32_16x16x64_bf16 v[24:27], v[48:51], v[232:239], v3
v_smfmac_f32_16x16x64_bf16 v[24:27], v[52:55], v[240:247], v3
v_smfmac_f32_16x16x64_bf16 v[32:35], v[48:51], v[104:111], v3
v_smfmac_f32_16x16x64_bf16 v[36:39], v[48:51], v[120:127], v3
v_smfmac_f32_16x16x64_bf16 v[40:43], v[48:51], v[136:143], v3
v_smfmac_f32_16x16x64_bf16 v[44:47], v[48:51], v[152:159], v3
s_nop 3
v_add_f32 v24, v24, v25
v_add_f32 v26, v26, v27
v_smfmac_f32_16x16x64_bf16 v[32:35], v[52:55], v[112:119], v3
v_cvt_pk_bf16_f32 v24, v24, v26
v_smfmac_f32_16x16x64_bf16 v[36:39], v[52:55], v[128:135], v3
s_nop 0
v_permlane32_swap_b32 v24, v26
v_smfmac_f32_16x16x64_bf16 v[40:43], v[52:55], v[144:151], v3
s_nop 0
v_permlane16_swap_b32 v24, v25
v_permlane16_swap_b32 v26, v27
v_smfmac_f32_16x16x64_bf16 v[44:47], v[52:55], v[160:167], v3
v_and_or_b32 v24, v24, s70, v13
v_smfmac_f32_16x16x64_bf16 v[56:59], v[48:51], v[168:175], v3
s_mov_b64 exec, 0xffff
buffer_store_dwordx4 v[24:27], v9, s[4:7], s49 offen sc1
s_mov_b64 exec, -1
v_smfmac_f32_16x16x64_bf16 v[60:63], v[48:51], v[184:191], v3
v_add_f32 v32, v32, v33
v_add_f32 v34, v34, v35
v_smfmac_f32_16x16x64_bf16 v[64:67], v[48:51], v[200:207], v3
v_cvt_pk_bf16_f32 v28, v32, v34
v_add_f32 v36, v36, v37
v_smfmac_f32_16x16x64_bf16 v[68:71], v[48:51], v[216:223], v3
v_add_f32 v38, v38, v39
v_cvt_pk_bf16_f32 v29, v36, v38
v_smfmac_f32_16x16x64_bf16 v[56:59], v[52:55], v[176:183], v3
v_add_f32 v40, v40, v41
v_add_f32 v42, v42, v43
v_smfmac_f32_16x16x64_bf16 v[60:63], v[52:55], v[192:199], v3
v_cvt_pk_bf16_f32 v30, v40, v42
v_add_f32 v44, v44, v45
v_smfmac_f32_16x16x64_bf16 v[64:67], v[52:55], v[208:215], v3
v_add_f32 v46, v46, v47
v_cvt_pk_bf16_f32 v31, v44, v46
v_smfmac_f32_16x16x64_bf16 v[68:71], v[52:55], v[224:231], v3
v_and_or_b32 v28, v28, s70, v13
buffer_store_dwordx4 v[28:31], v9, s[4:7], s74 offen sc1
v_add_f32 v56, v56, v57
v_add_f32 v58, v58, v59
v_cvt_pk_bf16_f32 v32, v56, v58
v_add_f32 v60, v60, v61
v_add_f32 v62, v62, v63
v_cvt_pk_bf16_f32 v33, v60, v62
v_add_f32 v64, v64, v65
v_add_f32 v66, v66, v67
v_cvt_pk_bf16_f32 v34, v64, v66
v_add_f32 v68, v68, v69
v_add_f32 v70, v70, v71
v_cvt_pk_bf16_f32 v35, v68, v70
v_and_or_b32 v32, v32, s70, v13
buffer_store_dwordx4 v[32:35], v9, s[4:7], s45 offen sc1
s_and_b32 s60, s62, 7
s_mul_i32 s60, s60, 131072
s_add_u32 s77, s59, s60
s_bfe_u32 s60, s62, 0x10003
s_xor_b32 s60, s60, 1
v_mov_b32 v8, s60
v_mov_b64 v[48:49], 0
v_mov_b64 v[50:51], 0
v_mov_b64 v[52:53], 0
v_mov_b64 v[54:55], 0
v_mov_b64 v[56:57], 0
v_mov_b64 v[58:59], 0
v_mov_b64 v[60:61], 0
v_mov_b64 v[62:63], 0
v_mov_b64 v[64:65], 0
v_mov_b64 v[66:67], 0
v_mov_b64 v[68:69], 0
v_mov_b64 v[70:71], 0
s_lshl_b32 s60, s3, 12
v_add_u32 v15, s60, v1
s_cmp_eq_u32 s48, 0
s_cbranch_scc1 noown_314
v_and_b32 v20, 15, v0
v_and_b32 v21, 1, v0
v_lshlrev_b32 v21, 4, v21
v_mov_b32 v22, 0x3f80
v_lshlrev_b32 v21, v21, v22
v_lshrrev_b32 v22, 1, v20
v_cmp_eq_u32 vcc, 0, v22
s_nop 1
v_cndmask_b32 v16, 0, v21, vcc
v_cmp_eq_u32 vcc, 1, v22
s_nop 1
v_cndmask_b32 v17, 0, v21, vcc
v_cmp_eq_u32 vcc, 2, v22
s_nop 1
v_cndmask_b32 v18, 0, v21, vcc
v_cmp_eq_u32 vcc, 3, v22
s_nop 1
v_cndmask_b32 v19, 0, v21, vcc
s_sleep 2
s_mov_b32 s67, 0
s_mov_b32 s97, 15
h1_317:
buffer_load_dwordx4 v[32:35], v1, s[4:7], s75 offen offset:0 sc1
buffer_load_dwordx4 v[36:39], v1, s[4:7], s75 offen offset:1024 sc1
buffer_load_dwordx4 v[40:43], v1, s[4:7], s75 offen offset:2048 sc1
buffer_load_dwordx4 v[44:47], v1, s[4:7], s75 offen offset:3072 sc1
s_add_u32 s67, s67, 1
s_cmp_gt_u32 s67, 400000
s_cbranch_scc1 chain_fail_246
s_waitcnt vmcnt(3)
v_mfma_f32_16x16x32_bf16 v[24:27], v[32:35], v[16:19], 0
v_xor_b32 v28, v32, v13
s_waitcnt vmcnt(2)
v_mfma_f32_16x16x32_bf16 v[24:27], v[36:39], v[16:19], v[24:27]
v_bitop3_b32 v28, v28, v36, v13 bitop3:0xf6
s_waitcnt vmcnt(1)
v_mfma_f32_16x16x32_bf16 v[24:27], v[40:43], v[16:19], v[24:27]
v_bitop3_b32 v28, v28, v40, v13 bitop3:0xf6
s_waitcnt vmcnt(0)
v_mfma_f32_16x16x32_bf16 v[24:27], v[44:47], v[16:19], v[24:27]
v_bitop3_b32 v28, v28, v44, v13 bitop3:0xf6
v_and_b32 v28, 1, v28
v_cmp_ne_u32 vcc, 0, v28
s_nop 0
s_cbranch_vccnz h1_317
s_add_u32 s60, s79, s76
s_nop 1
v_permlane32_swap_b32 v24, v26
v_permlane32_swap_b32 v25, v27
v_add_f32 v24, v24, v26
v_add_f32 v25, v25, v27
v_cvt_pk_bf16_f32 v30, v24, v25
v_min_u32 v30, s70, v30
buffer_store_dword v30, v10, s[4:7], s60 offen sc1
noown_314:
s_lshl_b32 s45, s3, 11
s_add_u32 s45, s45, s79
s_lshl_b32 s46, s3, 8
s_add_u32 s46, s46, 8192
s_add_u32 s46, s46, s79
v_and_b32 v20, 0xf0, v1
v_add_u32 v21, s68, v20
s_barrier
s_sleep 1
s_mov_b32 s67, 0
h2_318:
buffer_load_dwordx4 v[24:27], v1, s[4:7], s45 offen offset:0 sc1
buffer_load_dwordx4 v[28:31], v1, s[4:7], s45 offen offset:1024 sc1
buffer_load_dwordx4 v[32:35], v20, s[4:7], s46 offen sc1
s_add_u32 s67, s67, 1
s_cmp_gt_u32 s67, 400000
s_cbranch_scc1 chain_fail_246
s_waitcnt vmcnt(2)
ds_write2_b64 v11, v[24:25], v[26:27] offset1:32
v_max3_u32 v40, v24, v25, v26
v_max3_u32 v40, v40, v26, v27
s_waitcnt vmcnt(1)
ds_write2_b64 v11, v[28:29], v[30:31] offset0:128 offset1:160
v_max3_u32 v40, v28, v29, v40
v_max3_u32 v40, v40, v30, v31
s_waitcnt vmcnt(0)
ds_write_b128 v21, v[32:35]
v_max3_u32 v40, v32, v33, v40
v_max3_u32 v40, v40, v34, v35
v_cmp_eq_u32 vcc, -1, v40
s_nop 0
s_cbranch_vccnz h2_318
v_mov_b32 v41, -1
s_add_u32 s60, s73, s76
buffer_store_dword v41, v10, s[4:7], s60 offen sc1
s_cmp_eq_u32 s3, 3
s_cbranch_scc1 io_315
io_end_316:
s_mov_b32 s60, s79
s_mov_b32 s79, s71
s_mov_b32 s71, s73
s_mov_b32 s73, s60
s_waitcnt lgkmcnt(0)
s_barrier
s_branch chain_loop_309
io_315:
s_sub_u32 s62, s62, 1
s_add_u32 s62, s62, 1
s_add_u32 s61, s62, 1
v_cmp_gt_u32 vcc, s61, v23
s_nop 0
s_and_b32 vcc_lo, vcc_lo, 31
s_cbranch_scc0 io_end_316
s_add_u32 s61, s62, 1
s_mov_b32 s67, 0
sp_loop_319:
buffer_load_dword v32, v7, s[4:7], s58 offen sc1
s_add_u32 s67, s67, 1
s_cmp_gt_u32 s67, 150000
s_cbranch_scc1 sp_bad_321
s_waitcnt vmcnt(0)
v_cmp_gt_u32 vcc, s61, v32
s_nop 0
s_and_b32 vcc_lo, vcc_lo, 31
s_cbranch_scc0 sp_ok_320
s_sleep 1
s_branch sp_loop_319
sp_bad_321:
s_mov_b32 s98, 1792
s_branch L_fail
sp_ok_320:
s_branch io_end_316
chain_fail_246:
v_mov_b32 v24, 0xdead
v_mov_b32 v25, 252
buffer_store_dword v24, v25, s[12:15], 0 offen
s_waitcnt vmcnt(0)
s_endpgm
chain_done_247:
s_endpgm
.p2align 2
L_roles:
.short 0,0,0,0,0,0,0,0,0,0,0,0,0,0,0,0,0,0,0,0,0,0,0,0,0,0,0,0,0,0,0,0
.short 0,0,0,0,0,0,0,0,0,0,0,0,0,0,0,0,0,0,0,0,0,0,0,0,0,0,0,0,0,0,0,0
.short 1024,1025,1280,1281,1282,1283,1284,1285,1286,768,769,512,513,514,0,1,2,3,4,5,6,7,8,9,10,11,256,257,258,259,260,261
.short 1026,1027,1287,1288,1289,1290,1291,1292,1293,770,771,515,516,517,12,13,14,15,16,17,18,19,20,21,22,23,262,263,264,265,266,267
.short 1028,1029,1301,1302,1303,1304,1294,1295,1296,1297,1298,1299,1300,772,773,774,775,518,519,520,521,522,523,24,25,26,27,28,29,268,269,270
.short 1030,1031,1305,1306,1307,1308,1309,1310,1311,1312,1313,1314,1315,776,777,778,779,524,525,526,527,528,529,30,31,32,33,34,35,271,272,273
.short 1032,1033,1034,1035,1316,1317,1318,1319,1320,1321,1322,1323,1324,1325,1326,1327,1328,1329,780,781,530,531,532,36,37,38,39,40,41,274,275,276
.short 1036,1037,1038,1039,1330,1331,1332,1333,1334,1335,1336,1337,1338,1339,1340,1341,1342,1343,782,783,533,534,535,42,43,44,45,46,47,277,278,279
L_writers:
.byte 2,2,3,3,4,4,5,5,6,6,6,6,7,7,7,7,2,2,2,2,2,2,2,3,3,3,3,3,3,3,4,4,4,4,4,4,4,4,4,4,4,5,5,5,5,5,5,5,5,5,5,5,6,6,6,6,6,6,6,6,6,6,6,6
.byte 6,6,7,7,7,7,7,7,7,7,7,7,7,7,7,7,0,0,0,0,0,0,0,0,0,0,0,0,0,0,0,0,0,0,0,0,0,0,0,0,0,0,0,0,0,0,0,0,2,2,2,2,3,3,3,3,4,4,4,4,4,4,4,4
.byte 5,5,5,5,5,5,5,5,6,6,6,6,7,7,7,7,2,2,2,3,3,3,4,4,4,4,4,4,5,5,5,5,5,5,6,6,6,7,7,7,2,2,3,3,4,4,5,5,6,6,6,6,7,7,7,7,2,2,2,2,2,2,2,2
.byte 2,2,2,2,3,3,3,3,3,3,3,3,3,3,3,3,4,4,4,4,4,4,5,5,5,5,5,5,6,6,6,6,6,6,7,7,7,7,7,7,2,2,2,2,2,2,3,3,3,3,3,3,4,4,4,5,5,5,6,6,6,7,7,7
.byte 2,2,3,3,4,4,5,5,6,6,6,6,7,7,7,7,2,2,2,2,2,2,2,3,3,3,3,3,3,3,4,4,4,4,4,4,4,4,4,4,4,5,5,5,5,5,5,5,5,5,5,5,6,6,6,6,6,6,6,6,6,6,6,6
.byte 6,6,7,7,7,7,7,7,7,7,7,7,7,7,7,7,1,1,1,1,1,1,1,1,1,1,1,1,1,1,1,1,1,1,1,1,1,1,1,1,1,1,1,1,1,1,1,1,2,2,2,2,3,3,3,3,4,4,4,4,4,4,4,4
.byte 5,5,5,5,5,5,5,5,6,6,6,6,7,7,7,7,2,2,2,3,3,3,4,4,4,4,4,4,5,5,5,5,5,5,6,6,6,7,7,7,2,2,3,3,4,4,5,5,6,6,6,6,7,7,7,7,2,2,2,2,2,2,2,2
.byte 2,2,2,2,3,3,3,3,3,3,3,3,3,3,3,3,4,4,4,4,4,4,5,5,5,5,5,5,6,6,6,6,6,6,7,7,7,7,7,7,2,2,2,2,2,2,3,3,3,3,3,3,4,4,4,5,5,5,6,6,6,7,7,7
L_code_end:
.section .rodata,"a"
.p2align 6
.amdhsa_kernel interleave_layers__memory_aug_recurrent_mem_tr__glu_gated_swiglu__prompt_kernel
  .amdhsa_next_free_vgpr 512
  .amdhsa_next_free_sgpr 102
  .amdhsa_accum_offset 256
  .amdhsa_group_segment_fixed_size 0
  .amdhsa_kernarg_size 112
  .amdhsa_user_sgpr_count 2
  .amdhsa_user_sgpr_kernarg_segment_ptr 1
  .amdhsa_system_sgpr_workgroup_id_x 1
  .amdhsa_float_denorm_mode_32 3
.end_amdhsa_kernel
```

```asm
; @launch grid=(256,1,1) block=(256,1,1) lds=163840
.amdgcn_target "amdgcn-amd-amdhsa--gfx950"
.text
.globl interleave_layers__memory_aug_recurrent_mem_tr__glu_gated_swiglu__prompt_kernel
.p2align 8
.type interleave_layers__memory_aug_recurrent_mem_tr__glu_gated_swiglu__prompt_kernel,@function
interleave_layers__memory_aug_recurrent_mem_tr__glu_gated_swiglu__prompt_kernel:
s_cmp_lt_u32 s2, 256
s_cbranch_scc1 L_go
L_end:
s_endpgm
L_go:
s_getpc_b64 s[56:57]
L_pc0:
s_sub_u32 s56, s56, L_pc0-interleave_layers__memory_aug_recurrent_mem_tr__glu_gated_swiglu__prompt_kernel
s_subb_u32 s57, s57, 0
s_lshr_b32 s58, s2, 3
s_and_b32 s58, s58, 31
s_mul_i32 s58, s58, (L_code_end-interleave_layers__memory_aug_recurrent_mem_tr__glu_gated_swiglu__prompt_kernel+32*4096-1)/(32*4096)*4096
v_lshlrev_b32 v2, 4, v0
v_add_u32 v2, s58, v2
v_add_u32 v3, 0, v2
v_min_u32 v3, L_code_end-interleave_layers__memory_aug_recurrent_mem_tr__glu_gated_swiglu__prompt_kernel-16, v3
global_load_dwordx4 v[200:203], v3, s[56:57]
v_add_u32 v3, 4096, v2
v_min_u32 v3, L_code_end-interleave_layers__memory_aug_recurrent_mem_tr__glu_gated_swiglu__prompt_kernel-16, v3
global_load_dwordx4 v[204:207], v3, s[56:57]
s_load_dwordx4 s[20:23], s[0:1], 0
s_load_dwordx4 s[24:27], s[0:1], 16
s_load_dwordx4 s[28:31], s[0:1], 32
s_load_dwordx4 s[32:35], s[0:1], 64
s_load_dwordx4 s[36:39], s[0:1], 80
s_load_dwordx4 s[40:43], s[0:1], 96
v_lshrrev_b32 v1, 6, v0
v_and_b32 v0, 63, v0
v_readfirstlane_b32 s3, v1
s_waitcnt lgkmcnt(0)
s_mov_b32 s4, s42
s_and_b32 s5, s43, 0xffff
s_mov_b32 s6, 268435456
s_mov_b32 s7, 0x20000
s_mov_b32 s12, s40
s_and_b32 s13, s41, 0xffff
s_mov_b32 s14, 256
s_mov_b32 s15, 0x20000
s_getreg_b32 s50, hwreg(HW_REG_XCC_ID, 0, 4)
s_and_b32 s50, s50, 7
s_cmp_lg_u32 s3, 0
s_cbranch_scc1 tk_1
v_mov_b32 v2, 1
s_lshl_b32 s51, s50, 2
s_cmp_ge_u32 s50, 2
s_cselect_b32 s52, 128, 0
s_add_u32 s51, s51, s52
v_mov_b32 v3, s51
s_mov_b64 exec, 1
buffer_atomic_add v2, v3, s[12:15], 0 offen sc0
s_waitcnt vmcnt(0)
v_readfirstlane_b32 s51, v2
s_mov_b32 s52, 1
s_cmp_lt_u32 s51, 32
s_cbranch_scc1 native_2
v_mov_b32 v2, 1
v_mov_b32 v3, 32
buffer_atomic_add v2, v3, s[12:15], 0 offen sc0
s_waitcnt vmcnt(0)
v_readfirstlane_b32 s53, v2
s_mov_b64 exec, 0xff
v_lshlrev_b32 v3, 2, v0
v_add_u32 v5, 128, v3
v_cmp_le_u32 vcc, 2, v0
s_nop 1
v_cndmask_b32 v3, v3, v5, vcc
s_mov_b32 s98, 0
olp_3:
buffer_load_dword v4, v3, s[12:15], 0 offen sc1
s_add_u32 s98, s98, 1
s_cmp_gt_u32 s98, 150000
s_cbranch_scc1 obad_4
s_waitcnt vmcnt(0)
s_mov_b32 s54, 0
v_readlane_b32 s55, v4, 0
s_nop 0
s_add_u32 s54, s54, s55
v_readlane_b32 s55, v4, 1
s_nop 0
s_add_u32 s54, s54, s55
v_readlane_b32 s55, v4, 2
s_nop 0
s_add_u32 s54, s54, s55
v_readlane_b32 s55, v4, 3
s_nop 0
s_add_u32 s54, s54, s55
v_readlane_b32 s55, v4, 4
s_nop 0
s_add_u32 s54, s54, s55
v_readlane_b32 s55, v4, 5
s_nop 0
s_add_u32 s54, s54, s55
v_readlane_b32 s55, v4, 6
s_nop 0
s_add_u32 s54, s54, s55
v_readlane_b32 s55, v4, 7
s_nop 0
s_add_u32 s54, s54, s55
s_cmp_lt_u32 s54, 256
s_cbranch_scc1 olp_3
v_readlane_b32 s55, v4, 0
s_nop 0
s_min_u32 s55, s55, 32
s_sub_u32 s54, 32, s55
s_cmp_ge_u32 s53, s54
s_cbranch_scc1 onx_6
s_mov_b32 s50, 0
s_add_u32 s51, s55, s53
s_branch ofin_5
onx_6:
s_sub_u32 s53, s53, s54
v_readlane_b32 s55, v4, 1
s_nop 0
s_min_u32 s55, s55, 32
s_sub_u32 s54, 32, s55
s_cmp_ge_u32 s53, s54
s_cbranch_scc1 onx_7
s_mov_b32 s50, 1
s_add_u32 s51, s55, s53
s_branch ofin_5
onx_7:
s_sub_u32 s53, s53, s54
v_readlane_b32 s55, v4, 2
s_nop 0
s_min_u32 s55, s55, 32
s_sub_u32 s54, 32, s55
s_cmp_ge_u32 s53, s54
s_cbranch_scc1 onx_8
s_mov_b32 s50, 2
s_add_u32 s51, s55, s53
s_branch ofin_5
onx_8:
s_sub_u32 s53, s53, s54
v_readlane_b32 s55, v4, 3
s_nop 0
s_min_u32 s55, s55, 32
s_sub_u32 s54, 32, s55
s_cmp_ge_u32 s53, s54
s_cbranch_scc1 onx_9
s_mov_b32 s50, 3
s_add_u32 s51, s55, s53
s_branch ofin_5
onx_9:
s_sub_u32 s53, s53, s54
v_readlane_b32 s55, v4, 4
s_nop 0
s_min_u32 s55, s55, 32
s_sub_u32 s54, 32, s55
s_cmp_ge_u32 s53, s54
s_cbranch_scc1 onx_10
s_mov_b32 s50, 4
s_add_u32 s51, s55, s53
s_branch ofin_5
onx_10:
s_sub_u32 s53, s53, s54
v_readlane_b32 s55, v4, 5
s_nop 0
s_min_u32 s55, s55, 32
s_sub_u32 s54, 32, s55
s_cmp_ge_u32 s53, s54
s_cbranch_scc1 onx_11
s_mov_b32 s50, 5
s_add_u32 s51, s55, s53
s_branch ofin_5
onx_11:
s_sub_u32 s53, s53, s54
v_readlane_b32 s55, v4, 6
s_nop 0
s_min_u32 s55, s55, 32
s_sub_u32 s54, 32, s55
s_cmp_ge_u32 s53, s54
s_cbranch_scc1 onx_12
s_mov_b32 s50, 6
s_add_u32 s51, s55, s53
s_branch ofin_5
onx_12:
s_sub_u32 s53, s53, s54
v_readlane_b32 s55, v4, 7
s_nop 0
s_min_u32 s55, s55, 32
s_sub_u32 s54, 32, s55
s_cmp_ge_u32 s53, s54
s_cbranch_scc1 onx_13
s_mov_b32 s50, 7
s_add_u32 s51, s55, s53
s_branch ofin_5
onx_13:
s_sub_u32 s53, s53, s54
obad_4:
s_mov_b32 s50, 8
ofin_5:
s_mov_b32 s52, 0x10001
native_2:
s_mov_b64 exec, 1
v_mov_b32 v3, 0
v_mov_b32 v4, s50
v_mov_b32 v5, s51
v_mov_b32 v6, s52
v_mov_b32 v7, 0
ds_write_b128 v3, v[4:7]
s_mov_b64 exec, -1
s_waitcnt lgkmcnt(0)
tk_1:
s_barrier
v_mov_b32 v3, 0
ds_read_b128 v[4:7], v3
s_waitcnt lgkmcnt(0)
v_readfirstlane_b32 s50, v4
v_readfirstlane_b32 s51, v5
v_readfirstlane_b32 s52, v6
s_barrier
s_cmp_ge_u32 s50, 8
s_cbranch_scc1 L_end
s_cmp_ge_u32 s51, 32
s_cbranch_scc1 L_end
s_mov_b32 s100, s50
s_cmp_lt_u32 s50, 2
s_cbranch_scc1 L_chain
s_getpc_b64 s[96:97]
pc_14:
s_add_u32 s96, s96, L_roles-pc_14
s_addc_u32 s97, s97, 0
s_lshl_b32 s53, s50, 5
s_add_u32 s53, s53, s51
s_lshl_b32 s53, s53, 1
v_mov_b32 v1, s53
global_load_ushort v1, v1, s[96:97]
s_waitcnt vmcnt(0)
v_readfirstlane_b32 s53, v1
s_nop 0
s_and_b32 s74, s53, 0xff
s_lshr_b32 s53, s53, 8
s_cmp_eq_u32 s53, 0
s_cbranch_scc1 H_up
s_cmp_eq_u32 s53, 1
s_cbranch_scc1 H_dn
s_cmp_eq_u32 s53, 2
s_cbranch_scc1 H_wo
s_cmp_eq_u32 s53, 3
s_cbranch_scc1 H_att
s_cmp_eq_u32 s53, 4
s_cbranch_scc1 H_red
H_qkv:
s_lshl_b32 s75, s74, 2
s_add_u32 s75, s75, s3
s_mul_i32 s76, s75, 3
v_bfe_u32 v1, v0, 4, 1
v_lshlrev_b32 v1, 10, v1
v_lshrrev_b32 v2, 5, v0
v_lshl_add_u32 v1, v2, 8, v1
v_and_b32 v2, 15, v0
v_lshl_add_u32 v5, v2, 4, v1
v_lshlrev_b32 v6, 4, v0
s_add_u32 s77, s76, 0
s_lshr_b32 s78, s77, 8
s_and_b32 s77, s77, 255
s_lshl_b32 s48, s77, 5
s_cmp_eq_u32 s78, 0
s_cselect_b32 s80, s24, s26
s_cselect_b32 s81, s25, s27
s_cmp_eq_u32 s78, 2
s_cselect_b32 s80, s28, s80
s_cselect_b32 s81, s29, s81
s_mov_b32 s8, s80
s_and_b32 s9, s81, 0xffff
s_mov_b32 s10, 4718592
s_mov_b32 s11, 0x20000
s_lshr_b32 s79, s77, 3
s_mul_i32 s79, s79, 24576
s_lshl_b32 s82, s78, 13
s_add_u32 s79, s79, s82
s_and_b32 s82, s77, 7
s_lshl_b32 s83, s82, 10
s_and_b32 s84, s82, 1
s_lshl_b32 s84, s84, 9
s_andn2_b32 s82, s83, 1024
s_add_u32 s82, s82, s84
s_cmp_eq_u32 s78, 2
s_cselect_b32 s82, s83, s82
s_cselect_b64 vcc, -1, 0
s_add_u32 s79, s79, s82
v_cndmask_b32 v7, v5, v6, vcc
v_add_u32 v19, s79, v7
s_add_u32 s77, s76, 1
s_lshr_b32 s78, s77, 8
s_and_b32 s77, s77, 255
s_lshl_b32 s49, s77, 5
s_cmp_eq_u32 s78, 0
s_cselect_b32 s80, s24, s26
s_cselect_b32 s81, s25, s27
s_cmp_eq_u32 s78, 2
s_cselect_b32 s80, s28, s80
s_cselect_b32 s81, s29, s81
s_mov_b32 s12, s80
s_and_b32 s13, s81, 0xffff
s_mov_b32 s14, 4718592
s_mov_b32 s15, 0x20000
s_lshr_b32 s79, s77, 3
s_mul_i32 s79, s79, 24576
s_lshl_b32 s82, s78, 13
s_add_u32 s79, s79, s82
s_and_b32 s82, s77, 7
s_lshl_b32 s83, s82, 10
s_and_b32 s84, s82, 1
s_lshl_b32 s84, s84, 9
s_andn2_b32 s82, s83, 1024
s_add_u32 s82, s82, s84
s_cmp_eq_u32 s78, 2
s_cselect_b32 s82, s83, s82
s_cselect_b64 vcc, -1, 0
s_add_u32 s79, s79, s82
v_cndmask_b32 v7, v5, v6, vcc
v_add_u32 v20, s79, v7
s_add_u32 s77, s76, 2
s_lshr_b32 s78, s77, 8
s_and_b32 s77, s77, 255
s_lshl_b32 s50, s77, 5
s_cmp_eq_u32 s78, 0
s_cselect_b32 s80, s24, s26
s_cselect_b32 s81, s25, s27
s_cmp_eq_u32 s78, 2
s_cselect_b32 s80, s28, s80
s_cselect_b32 s81, s29, s81
s_mov_b32 s16, s80
s_and_b32 s17, s81, 0xffff
s_mov_b32 s18, 4718592
s_mov_b32 s19, 0x20000
s_lshr_b32 s79, s77, 3
s_mul_i32 s79, s79, 24576
s_lshl_b32 s82, s78, 13
s_add_u32 s79, s79, s82
s_and_b32 s82, s77, 7
s_lshl_b32 s83, s82, 10
s_and_b32 s84, s82, 1
s_lshl_b32 s84, s84, 9
s_andn2_b32 s82, s83, 1024
s_add_u32 s82, s82, s84
s_cmp_eq_u32 s78, 2
s_cselect_b32 s82, s83, s82
s_cselect_b64 vcc, -1, 0
s_add_u32 s79, s79, s82
v_cndmask_b32 v7, v5, v6, vcc
v_add_u32 v21, s79, v7
v_lshrrev_b32 v1, 5, v0
v_bfe_u32 v2, v0, 3, 1
v_lshl_add_u32 v1, v1, 1, v2
v_bfe_u32 v2, v0, 4, 1
v_bfe_u32 v3, v0, 1, 2
v_lshlrev_b32 v1, 3, v1
v_lshl_add_u32 v1, v2, 2, v1
v_add_u32 v1, v1, v3
v_mul_u32_u24 v1, 8192, v1
v_and_b32 v2, 1, v0
v_lshl_add_u32 v63, v2, 4, v1
s_mul_i32 s70, s3, 40960
v_lshrrev_b32 v1, 5, v0
v_lshlrev_b32 v1, 9, v1
v_bfe_u32 v2, v0, 4, 1
v_lshl_add_u32 v1, v2, 7, v1
v_add_u32 v1, s70, v1
v_and_b32 v2, 15, v0
v_lshl_add_u32 v2, v2, 3, v1
v_add_u32 v60, 0, v2
v_add_u32 v61, 1024, v2
v_add_u32 v62, 2048, v2
s_add_u32 m0, s70, 0
s_add_u32 s71, s48, 0
buffer_load_dwordx4 v63, s[8:11], s71 offen lds
s_add_u32 m0, s70, 1024
s_add_u32 s71, s49, 0
buffer_load_dwordx4 v63, s[12:15], s71 offen lds
s_add_u32 m0, s70, 2048
s_add_u32 s71, s50, 0
buffer_load_dwordx4 v63, s[16:19], s71 offen lds
s_add_u32 m0, s70, 3072
s_add_u32 s71, s48, 262144
buffer_load_dwordx4 v63, s[8:11], s71 offen lds
s_add_u32 m0, s70, 4096
s_add_u32 s71, s49, 262144
buffer_load_dwordx4 v63, s[12:15], s71 offen lds
s_add_u32 m0, s70, 5120
s_add_u32 s71, s50, 262144
buffer_load_dwordx4 v63, s[16:19], s71 offen lds
s_add_u32 m0, s70, 6144
s_add_u32 s71, s48, 524288
buffer_load_dwordx4 v63, s[8:11], s71 offen lds
s_add_u32 m0, s70, 7168
s_add_u32 s71, s49, 524288
buffer_load_dwordx4 v63, s[12:15], s71 offen lds
s_add_u32 m0, s70, 8192
s_add_u32 s71, s50, 524288
buffer_load_dwordx4 v63, s[16:19], s71 offen lds
s_add_u32 m0, s70, 9216
s_add_u32 s71, s48, 786432
buffer_load_dwordx4 v63, s[8:11], s71 offen lds
s_add_u32 m0, s70, 10240
s_add_u32 s71, s49, 786432
buffer_load_dwordx4 v63, s[12:15], s71 offen lds
s_add_u32 m0, s70, 11264
s_add_u32 s71, s50, 786432
buffer_load_dwordx4 v63, s[16:19], s71 offen lds
s_add_u32 m0, s70, 12288
s_add_u32 s71, s48, 1048576
buffer_load_dwordx4 v63, s[8:11], s71 offen lds
s_add_u32 m0, s70, 13312
s_add_u32 s71, s49, 1048576
buffer_load_dwordx4 v63, s[12:15], s71 offen lds
s_add_u32 m0, s70, 14336
s_add_u32 s71, s50, 1048576
buffer_load_dwordx4 v63, s[16:19], s71 offen lds
s_add_u32 m0, s70, 15360
s_add_u32 s71, s48, 1310720
buffer_load_dwordx4 v63, s[8:11], s71 offen lds
s_add_u32 m0, s70, 16384
s_add_u32 s71, s49, 1310720
buffer_load_dwordx4 v63, s[12:15], s71 offen lds
s_add_u32 m0, s70, 17408
s_add_u32 s71, s50, 1310720
buffer_load_dwordx4 v63, s[16:19], s71 offen lds
s_add_u32 m0, s70, 18432
s_add_u32 s71, s48, 1572864
buffer_load_dwordx4 v63, s[8:11], s71 offen lds
s_add_u32 m0, s70, 19456
s_add_u32 s71, s49, 1572864
buffer_load_dwordx4 v63, s[12:15], s71 offen lds
s_add_u32 m0, s70, 20480
s_add_u32 s71, s50, 1572864
buffer_load_dwordx4 v63, s[16:19], s71 offen lds
s_add_u32 m0, s70, 21504
s_add_u32 s71, s48, 1835008
buffer_load_dwordx4 v63, s[8:11], s71 offen lds
s_add_u32 m0, s70, 22528
s_add_u32 s71, s49, 1835008
buffer_load_dwordx4 v63, s[12:15], s71 offen lds
s_add_u32 m0, s70, 23552
s_add_u32 s71, s50, 1835008
buffer_load_dwordx4 v63, s[16:19], s71 offen lds
s_add_u32 m0, s70, 24576
s_add_u32 s71, s48, 2097152
buffer_load_dwordx4 v63, s[8:11], s71 offen lds
s_add_u32 m0, s70, 25600
s_add_u32 s71, s49, 2097152
buffer_load_dwordx4 v63, s[12:15], s71 offen lds
s_add_u32 m0, s70, 26624
s_add_u32 s71, s50, 2097152
buffer_load_dwordx4 v63, s[16:19], s71 offen lds
s_add_u32 m0, s70, 27648
s_add_u32 s71, s48, 2359296
buffer_load_dwordx4 v63, s[8:11], s71 offen lds
s_add_u32 m0, s70, 28672
s_add_u32 s71, s49, 2359296
buffer_load_dwordx4 v63, s[12:15], s71 offen lds
s_add_u32 m0, s70, 29696
s_add_u32 s71, s50, 2359296
buffer_load_dwordx4 v63, s[16:19], s71 offen lds
s_add_u32 m0, s70, 30720
s_add_u32 s71, s48, 2621440
buffer_load_dwordx4 v63, s[8:11], s71 offen lds
s_add_u32 m0, s70, 31744
s_add_u32 s71, s49, 2621440
buffer_load_dwordx4 v63, s[12:15], s71 offen lds
s_add_u32 m0, s70, 32768
s_add_u32 s71, s50, 2621440
buffer_load_dwordx4 v63, s[16:19], s71 offen lds
s_add_u32 m0, s70, 33792
s_add_u32 s71, s48, 2883584
buffer_load_dwordx4 v63, s[8:11], s71 offen lds
s_add_u32 m0, s70, 34816
s_add_u32 s71, s49, 2883584
buffer_load_dwordx4 v63, s[12:15], s71 offen lds
s_add_u32 m0, s70, 35840
s_add_u32 s71, s50, 2883584
buffer_load_dwordx4 v63, s[16:19], s71 offen lds
s_add_u32 m0, s70, 36864
s_add_u32 s71, s48, 3145728
buffer_load_dwordx4 v63, s[8:11], s71 offen lds
s_add_u32 m0, s70, 37888
s_add_u32 s71, s49, 3145728
buffer_load_dwordx4 v63, s[12:15], s71 offen lds
s_add_u32 m0, s70, 38912
s_add_u32 s71, s50, 3145728
buffer_load_dwordx4 v63, s[16:19], s71 offen lds
s_waitcnt vmcnt(36)
ds_read_b64_tr_b16 a[0:1], v60 offset:0
ds_read_b64_tr_b16 a[2:3], v60 offset:256
ds_read_b64_tr_b16 a[72:73], v61 offset:0
ds_read_b64_tr_b16 a[74:75], v61 offset:256
ds_read_b64_tr_b16 a[144:145], v62 offset:0
ds_read_b64_tr_b16 a[146:147], v62 offset:256
s_waitcnt lgkmcnt(0)
s_add_u32 m0, s70, 0
s_add_u32 s71, s48, 3407872
buffer_load_dwordx4 v63, s[8:11], s71 offen lds
s_add_u32 m0, s70, 1024
s_add_u32 s71, s49, 3407872
buffer_load_dwordx4 v63, s[12:15], s71 offen lds
s_add_u32 m0, s70, 2048
s_add_u32 s71, s50, 3407872
buffer_load_dwordx4 v63, s[16:19], s71 offen lds
s_waitcnt vmcnt(36)
ds_read_b64_tr_b16 a[4:5], v60 offset:3072
ds_read_b64_tr_b16 a[6:7], v60 offset:3328
ds_read_b64_tr_b16 a[76:77], v61 offset:3072
ds_read_b64_tr_b16 a[78:79], v61 offset:3328
ds_read_b64_tr_b16 a[148:149], v62 offset:3072
ds_read_b64_tr_b16 a[150:151], v62 offset:3328
s_waitcnt lgkmcnt(0)
s_add_u32 m0, s70, 3072
s_add_u32 s71, s48, 3670016
buffer_load_dwordx4 v63, s[8:11], s71 offen lds
s_add_u32 m0, s70, 4096
s_add_u32 s71, s49, 3670016
buffer_load_dwordx4 v63, s[12:15], s71 offen lds
s_add_u32 m0, s70, 5120
s_add_u32 s71, s50, 3670016
buffer_load_dwordx4 v63, s[16:19], s71 offen lds
s_waitcnt vmcnt(36)
ds_read_b64_tr_b16 a[8:9], v60 offset:6144
ds_read_b64_tr_b16 a[10:11], v60 offset:6400
ds_read_b64_tr_b16 a[80:81], v61 offset:6144
ds_read_b64_tr_b16 a[82:83], v61 offset:6400
ds_read_b64_tr_b16 a[152:153], v62 offset:6144
ds_read_b64_tr_b16 a[154:155], v62 offset:6400
s_waitcnt lgkmcnt(0)
s_add_u32 m0, s70, 6144
s_add_u32 s71, s48, 3932160
buffer_load_dwordx4 v63, s[8:11], s71 offen lds
s_add_u32 m0, s70, 7168
s_add_u32 s71, s49, 3932160
buffer_load_dwordx4 v63, s[12:15], s71 offen lds
s_add_u32 m0, s70, 8192
s_add_u32 s71, s50, 3932160
buffer_load_dwordx4 v63, s[16:19], s71 offen lds
s_waitcnt vmcnt(36)
ds_read_b64_tr_b16 a[12:13], v60 offset:9216
ds_read_b64_tr_b16 a[14:15], v60 offset:9472
ds_read_b64_tr_b16 a[84:85], v61 offset:9216
ds_read_b64_tr_b16 a[86:87], v61 offset:9472
ds_read_b64_tr_b16 a[156:157], v62 offset:9216
ds_read_b64_tr_b16 a[158:159], v62 offset:9472
s_waitcnt lgkmcnt(0)
s_add_u32 m0, s70, 9216
s_add_u32 s71, s48, 4194304
buffer_load_dwordx4 v63, s[8:11], s71 offen lds
s_add_u32 m0, s70, 10240
s_add_u32 s71, s49, 4194304
buffer_load_dwordx4 v63, s[12:15], s71 offen lds
s_add_u32 m0, s70, 11264
s_add_u32 s71, s50, 4194304
buffer_load_dwordx4 v63, s[16:19], s71 offen lds
s_waitcnt vmcnt(36)
ds_read_b64_tr_b16 a[16:17], v60 offset:12288
ds_read_b64_tr_b16 a[18:19], v60 offset:12544
ds_read_b64_tr_b16 a[88:89], v61 offset:12288
ds_read_b64_tr_b16 a[90:91], v61 offset:12544
ds_read_b64_tr_b16 a[160:161], v62 offset:12288
ds_read_b64_tr_b16 a[162:163], v62 offset:12544
s_waitcnt lgkmcnt(0)
s_add_u32 m0, s70, 12288
s_add_u32 s71, s48, 4456448
buffer_load_dwordx4 v63, s[8:11], s71 offen lds
s_add_u32 m0, s70, 13312
s_add_u32 s71, s49, 4456448
buffer_load_dwordx4 v63, s[12:15], s71 offen lds
s_add_u32 m0, s70, 14336
s_add_u32 s71, s50, 4456448
buffer_load_dwordx4 v63, s[16:19], s71 offen lds
s_waitcnt vmcnt(36)
ds_read_b64_tr_b16 a[20:21], v60 offset:15360
ds_read_b64_tr_b16 a[22:23], v60 offset:15616
ds_read_b64_tr_b16 a[92:93], v61 offset:15360
ds_read_b64_tr_b16 a[94:95], v61 offset:15616
ds_read_b64_tr_b16 a[164:165], v62 offset:15360
ds_read_b64_tr_b16 a[166:167], v62 offset:15616
s_waitcnt vmcnt(33)
ds_read_b64_tr_b16 a[24:25], v60 offset:18432
ds_read_b64_tr_b16 a[26:27], v60 offset:18688
ds_read_b64_tr_b16 a[96:97], v61 offset:18432
ds_read_b64_tr_b16 a[98:99], v61 offset:18688
ds_read_b64_tr_b16 a[168:169], v62 offset:18432
ds_read_b64_tr_b16 a[170:171], v62 offset:18688
s_waitcnt vmcnt(30)
ds_read_b64_tr_b16 a[28:29], v60 offset:21504
ds_read_b64_tr_b16 a[30:31], v60 offset:21760
ds_read_b64_tr_b16 a[100:101], v61 offset:21504
ds_read_b64_tr_b16 a[102:103], v61 offset:21760
ds_read_b64_tr_b16 a[172:173], v62 offset:21504
ds_read_b64_tr_b16 a[174:175], v62 offset:21760
s_waitcnt vmcnt(27)
ds_read_b64_tr_b16 a[32:33], v60 offset:24576
ds_read_b64_tr_b16 a[34:35], v60 offset:24832
ds_read_b64_tr_b16 a[104:105], v61 offset:24576
ds_read_b64_tr_b16 a[106:107], v61 offset:24832
ds_read_b64_tr_b16 a[176:177], v62 offset:24576
ds_read_b64_tr_b16 a[178:179], v62 offset:24832
s_waitcnt vmcnt(24)
ds_read_b64_tr_b16 a[36:37], v60 offset:27648
ds_read_b64_tr_b16 a[38:39], v60 offset:27904
ds_read_b64_tr_b16 a[108:109], v61 offset:27648
ds_read_b64_tr_b16 a[110:111], v61 offset:27904
ds_read_b64_tr_b16 a[180:181], v62 offset:27648
ds_read_b64_tr_b16 a[182:183], v62 offset:27904
s_waitcnt vmcnt(21)
ds_read_b64_tr_b16 a[40:41], v60 offset:30720
ds_read_b64_tr_b16 a[42:43], v60 offset:30976
ds_read_b64_tr_b16 a[112:113], v61 offset:30720
ds_read_b64_tr_b16 a[114:115], v61 offset:30976
ds_read_b64_tr_b16 a[184:185], v62 offset:30720
ds_read_b64_tr_b16 a[186:187], v62 offset:30976
s_waitcnt vmcnt(18)
ds_read_b64_tr_b16 a[44:45], v60 offset:33792
ds_read_b64_tr_b16 a[46:47], v60 offset:34048
ds_read_b64_tr_b16 a[116:117], v61 offset:33792
ds_read_b64_tr_b16 a[118:119], v61 offset:34048
ds_read_b64_tr_b16 a[188:189], v62 offset:33792
ds_read_b64_tr_b16 a[190:191], v62 offset:34048
s_waitcnt vmcnt(15)
ds_read_b64_tr_b16 a[48:49], v60 offset:36864
ds_read_b64_tr_b16 a[50:51], v60 offset:37120
ds_read_b64_tr_b16 a[120:121], v61 offset:36864
ds_read_b64_tr_b16 a[122:123], v61 offset:37120
ds_read_b64_tr_b16 a[192:193], v62 offset:36864
ds_read_b64_tr_b16 a[194:195], v62 offset:37120
s_waitcnt vmcnt(12)
ds_read_b64_tr_b16 a[52:53], v60 offset:0
ds_read_b64_tr_b16 a[54:55], v60 offset:256
ds_read_b64_tr_b16 a[124:125], v61 offset:0
ds_read_b64_tr_b16 a[126:127], v61 offset:256
ds_read_b64_tr_b16 a[196:197], v62 offset:0
ds_read_b64_tr_b16 a[198:199], v62 offset:256
s_waitcnt vmcnt(9)
ds_read_b64_tr_b16 a[56:57], v60 offset:3072
ds_read_b64_tr_b16 a[58:59], v60 offset:3328
ds_read_b64_tr_b16 a[128:129], v61 offset:3072
ds_read_b64_tr_b16 a[130:131], v61 offset:3328
ds_read_b64_tr_b16 a[200:201], v62 offset:3072
ds_read_b64_tr_b16 a[202:203], v62 offset:3328
s_waitcnt vmcnt(6)
ds_read_b64_tr_b16 a[60:61], v60 offset:6144
ds_read_b64_tr_b16 a[62:63], v60 offset:6400
ds_read_b64_tr_b16 a[132:133], v61 offset:6144
ds_read_b64_tr_b16 a[134:135], v61 offset:6400
ds_read_b64_tr_b16 a[204:205], v62 offset:6144
ds_read_b64_tr_b16 a[206:207], v62 offset:6400
s_waitcnt vmcnt(3)
ds_read_b64_tr_b16 a[64:65], v60 offset:9216
ds_read_b64_tr_b16 a[66:67], v60 offset:9472
ds_read_b64_tr_b16 a[136:137], v61 offset:9216
ds_read_b64_tr_b16 a[138:139], v61 offset:9472
ds_read_b64_tr_b16 a[208:209], v62 offset:9216
ds_read_b64_tr_b16 a[210:211], v62 offset:9472
s_waitcnt vmcnt(0)
ds_read_b64_tr_b16 a[68:69], v60 offset:12288
ds_read_b64_tr_b16 a[70:71], v60 offset:12544
ds_read_b64_tr_b16 a[140:141], v61 offset:12288
ds_read_b64_tr_b16 a[142:143], v61 offset:12544
ds_read_b64_tr_b16 a[212:213], v62 offset:12288
ds_read_b64_tr_b16 a[214:215], v62 offset:12544
s_waitcnt lgkmcnt(0)
v_lshrrev_b32 v1, 3, v0
v_bfe_u32 v2, v0, 1, 2
v_lshrrev_b32 v3, 5, v0
v_lshlrev_b32 v3, 1, v3
v_xor_b32 v2, v2, v3
v_mul_u32_u24 v1, 2304, v1
v_lshl_add_u32 v1, v2, 5, v1
v_and_b32 v2, 1, v0
v_lshl_add_u32 v1, v2, 4, v1
s_and_b32 s70, s3, 1
s_mul_i32 s70, s70, 18432
s_lshr_b32 s71, s3, 1
s_lshl_b32 s71, s71, 7
s_add_u32 s70, s70, s71
v_add_u32 v1, s70, v1
v_add_u32 v8, 4096, v1
v_add_u32 v9, 3328, v1
v_add_u32 v10, 2560, v1
v_add_u32 v11, 1792, v1
v_add_u32 v12, 5120, v1
v_add_u32 v13, 4352, v1
v_add_u32 v14, 3584, v1
v_add_u32 v15, 2816, v1
v_add_u32 v16, 6144, v1
v_bfe_u32 v1, v0, 1, 3
v_lshlrev_b32 v1, 7, v1
v_lshrrev_b32 v2, 4, v0
v_bfe_u32 v3, v0, 3, 1
v_lshlrev_b32 v3, 1, v3
v_xor_b32 v2, v2, v3
v_lshl_add_u32 v1, v2, 5, v1
v_and_b32 v2, 1, v0
v_lshl_add_u32 v17, v2, 4, v1
v_and_b32 v2, 31, v0
v_add_u32 v1, 0, v2
v_mul_u32_u24 v1, 128, v1
v_lshrrev_b32 v3, 5, v0
v_xor_b32 v3, 1, v3
v_mul_u32_u24 v3, 32768, v3
v_add_u32 v1, 0, v1
v_add_u32 v1, v1, v3
v_mov_b32 v3, 2147483632
s_cmp_eq_u32 s3, 0
s_cselect_b32 s71, 16, 0
v_cmp_gt_u32 vcc, s71, v2
s_nop 1
v_cndmask_b32 v22, v3, v1, vcc
s_mov_b32 s56, 0xffff
s_mul_i32 s70, s74, 128
s_add_u32 s70, s70, 2048
v_mov_b32 v1, s70
s_min_u32 s71, s71, 1
v_cmp_gt_u32 vcc, s71, v0
s_nop 1
v_cndmask_b32 v44, v3, v1, vcc
v_add_u32 v45, 65536, v44
s_getpc_b64 s[96:97]
pc_15:
s_add_u32 s96, s96, L_writers-pc_15
s_addc_u32 s97, s97, 0
v_subrev_u32 v23, 0, v22
v_lshrrev_b32 v23, 7, v23
v_cmp_gt_u32 vcc, 0x200, v23
s_nop 1
v_cndmask_b32 v23, 0, v23, vcc
global_load_ubyte v23, v23, s[96:97]
s_mov_b32 s44, 3702784
s_mov_b32 s45, 60366848
s_mov_b32 s52, 1
s_mov_b32 s53, 32768
s_mov_b32 s46, 1343488
s_mov_b32 s47, 10035200
s_mov_b32 s54, 1
s_mov_b32 s55, 0
s_mov_b32 s25, 64
s_mov_b32 s20, 36864
s_mov_b32 s21, 786432
s_cmp_lt_u32 s75, 170
s_cbranch_scc1 G_sss18
s_cmp_eq_u32 s75, 170
s_cbranch_scc1 G_ssv18
s_mov_b32 s8, s42
s_and_b32 s9, s43, 0xffff
s_mov_b32 s10, 0
s_mov_b32 s11, 0x20000
s_mov_b32 s22, 0
s_mul_i32 s48, s3, 9216
s_add_u32 s49, s48, 36864
s_add_u32 s50, s48, 73728
s_add_u32 s51, s48, 110592
s_mov_b32 s57, 0xbfb8aa3b
v_add_u32 v28, 0, v17
v_add_u32 v29, 36864, v17
v_add_u32 v30, 73728, v17
v_add_u32 v31, 110592, v17
v_lshlrev_b32 v1, 2, v0
v_add_u32 v32, 147456, v1
s_lshl_b32 s70, s3, 8
v_add_u32 v18, s70, v32
v_mov_b64 v[224:225], 0
v_mov_b64 v[236:237], 0
v_mov_b64 v[226:227], 0
v_mov_b64 v[238:239], 0
v_mov_b64 v[228:229], 0
v_mov_b64 v[240:241], 0
v_mov_b64 v[230:231], 0
v_mov_b64 v[242:243], 0
s_mov_b32 s12, s40
s_and_b32 s13, s41, 0xffff
s_mov_b32 s14, 256
s_mov_b32 s15, 0x20000
v_lshlrev_b32 v26, 2, v0
v_add_u32 v27, 128, v26
v_cmp_le_u32 vcc, 2, v0
s_nop 1
v_cndmask_b32 v26, v26, v27, vcc
v_mov_b32 v27, 192
v_cmp_eq_u32 vcc, 8, v0
s_nop 1
v_cndmask_b32 v26, v26, v27, vcc
v_mov_b32 v27, 2147483632
v_cmp_lt_u32 vcc, 8, v0
s_nop 1
v_cndmask_b32 v26, v26, v27, vcc
s_mov_b32 s98, 0
wi_loop_21:
buffer_load_dword v27, v26, s[12:15], 0 offen sc1
s_add_u32 s98, s98, 1
s_cmp_gt_u32 s98, 150000
s_cbranch_scc1 wi_bad_23
s_waitcnt vmcnt(0)
v_cmp_eq_u32 vcc, 32, v27
s_nop 0
s_and_b32 s97, vcc_lo, 0x1ff
s_cmp_eq_u32 s97, 0x1ff
s_cbranch_scc1 wi_ok_22
v_cmp_lt_u32 vcc, 32, v27
s_nop 0
s_and_b32 s96, vcc_lo, 0xff
s_cselect_b32 s96, 0x100, 0
s_and_b32 s96, s96, s97
s_cbranch_scc1 wi_over_24
s_sleep 8
s_branch wi_loop_21
wi_bad_23:
s_mov_b32 s98, 512
s_branch L_fail
wi_over_24:
s_mov_b32 s100, 255
wi_ok_22:
v_add_u32 v26, 65536, v22
v_cmp_eq_u32 vcc, s100, v23
s_nop 1
v_cndmask_b32 v22, v22, v26, vcc
s_mov_b32 s90, 0
s_mov_b32 s91, 1879048192
s_mov_b32 s93, 1879048192
v_mov_b32 v34, 2147483632
s_barrier
s_mov_b32 s95, 1
s_cmp_lg_u32 s3, 0
s_cbranch_scc1 sp_ok_26_j
s_mov_b32 s23, 0
sp_loop_25:
buffer_load_dword v33, v22, s[4:7], 0 offen sc1
s_add_u32 s23, s23, 1
s_cmp_gt_u32 s23, 150000
s_cbranch_scc1 sp_bad_27
s_waitcnt vmcnt(0)
sp_loop_25_e:
v_cmp_gt_u32 vcc, s52, v33
v_cmp_gt_u32 s[58:59], s54, v33
s_and_b32 vcc_lo, vcc_lo, s56
s_cbranch_scc0 sp_ok_26
s_cmp_gt_u32 s23, 4
s_cselect_b32 s70, 0, s56
s_cmp_lg_u32 s95, 0
s_cselect_b32 s70, 0, s70
s_or_b32 s59, s59, s70
s_and_b32 s59, s59, s56
s_cbranch_scc0 sp_ok_26
s_sleep 1
s_branch sp_loop_25
sp_bad_27:
s_mov_b32 s98, 1025
s_branch L_fail
sp_ok_26:
ds_write_b32 v18, v33
s_waitcnt lgkmcnt(0)
sp_ok_26_j:
s_barrier
ds_read_b32 v33, v32
s_waitcnt lgkmcnt(0)
v_cmp_gt_u32 vcc, s52, v33
v_cmp_gt_u32 s[58:59], s54, v33
s_and_b32 vcc_lo, vcc_lo, s56
s_cselect_b32 s70, 0, 1
s_and_b32 s59, s59, s56
s_cselect_b32 s71, 0, 1
s_or_b32 s76, s70, s71
s_cselect_b32 s10, 268435456, 0
s_cmp_lg_u32 s70, 0
s_cselect_b64 s[72:73], s[52:53], s[54:55]
s_cselect_b64 s[58:59], s[44:45], s[46:47]
s_mul_i32 s74, s72, s20
s_add_u32 s74, s74, s58
s_mul_i32 s75, s72, s21
s_add_u32 s75, s75, s59
s_andn2_b32 s71, s71, s70
s_add_u32 s52, s52, s70
s_add_u32 s54, s54, s71
s_mov_b32 s77, s76
s_add_u32 m0, s48, 0
s_nop 0
buffer_load_dwordx4 v8, s[4:7], s74 offen offset:0 sc1 lds
buffer_load_dwordx4 v9, s[4:7], s74 offen offset:1024 sc1 lds
buffer_load_dwordx4 v10, s[4:7], s74 offen offset:2048 sc1 lds
buffer_load_dwordx4 v11, s[4:7], s74 offen offset:3072 sc1 lds
s_add_u32 m0, s48, 4096
s_nop 0
buffer_load_dwordx4 v12, s[4:7], s74 offen offset:0 sc1 lds
buffer_load_dwordx4 v13, s[4:7], s74 offen offset:1024 sc1 lds
buffer_load_dwordx4 v14, s[4:7], s74 offen offset:2048 sc1 lds
buffer_load_dwordx4 v15, s[4:7], s74 offen offset:3072 sc1 lds
s_add_u32 m0, s48, 8192
s_nop 0
buffer_load_dwordx4 v16, s[4:7], s74 offen offset:0 sc1 lds
buffer_load_dword v24, v22, s[4:7], 0 offen sc1
buffer_store_dword v27, v34, s[4:7], 0 offen
v_mov_b32 v27, s90
s_waitcnt vmcnt(9)
s_barrier
buffer_store_dword v27, v45, s[4:7], s91 offen
buffer_store_dword v27, v44, s[4:7], s91 offen sc1
s_mov_b32 s91, 1879048192
ds_read_b128 v[64:67], v28 offset:0
ds_read_b128 v[68:71], v28 offset:9216
ds_read_b128 v[72:75], v28 offset:18432
ds_read_b128 v[76:79], v28 offset:27648
ds_read_b128 v[80:83], v28 offset:1024
ds_read_b128 v[84:87], v28 offset:10240
ds_read_b128 v[88:91], v28 offset:19456
ds_read_b128 v[92:95], v28 offset:28672
s_waitcnt vmcnt(7)
s_barrier
s_branch g_body_16
g_body_16:
s_waitcnt lgkmcnt(4)
v_mfma_f32_16x16x32_bf16 v[208:211], v[64:67], a[0:3], 0
ds_read_b128 v[96:99], v28 offset:2048
v_mfma_f32_16x16x32_bf16 v[212:215], v[68:71], a[0:3], 0
ds_read_b128 v[100:103], v28 offset:11264
v_mfma_f32_16x16x32_bf16 v[216:219], v[64:67], a[72:75], 0
v_mfma_f32_16x16x32_bf16 v[208:211], v[72:75], a[4:7], v[208:211]
ds_read_b128 v[104:107], v28 offset:20480
v_cvt_pk_bf16_f32 v56, v224, v225
v_mfma_f32_16x16x32_bf16 v[212:215], v[76:79], a[4:7], v[212:215]
ds_read_b128 v[108:111], v28 offset:29696
v_cvt_pk_bf16_f32 v57, v226, v227
v_mfma_f32_16x16x32_bf16 v[220:223], v[68:71], a[72:75], 0
v_cvt_pk_bf16_f32 v58, v228, v229
s_waitcnt lgkmcnt(4)
v_mfma_f32_16x16x32_bf16 v[208:211], v[80:83], a[8:11], v[208:211]
ds_read_b128 v[112:115], v28 offset:3072
v_cvt_pk_bf16_f32 v59, v230, v231
v_mfma_f32_16x16x32_bf16 v[212:215], v[84:87], a[8:11], v[212:215]
ds_read_b128 v[116:119], v28 offset:12288
v_mfma_f32_16x16x32_bf16 v[216:219], v[72:75], a[76:79], v[216:219]
buffer_store_dwordx4 v[56:59], v21, s[4:7], s93 offen sc1
v_mfma_f32_16x16x32_bf16 v[208:211], v[88:91], a[12:15], v[208:211]
ds_read_b128 v[120:123], v28 offset:21504
v_mov_b32 v27, s90
v_mfma_f32_16x16x32_bf16 v[212:215], v[92:95], a[12:15], v[212:215]
ds_read_b128 v[124:127], v28 offset:30720
v_mfma_f32_16x16x32_bf16 v[220:223], v[76:79], a[76:79], v[220:223]
s_waitcnt lgkmcnt(4)
v_mfma_f32_16x16x32_bf16 v[208:211], v[96:99], a[16:19], v[208:211]
ds_read_b128 v[128:131], v28 offset:4096
v_mfma_f32_16x16x32_bf16 v[212:215], v[100:103], a[16:19], v[212:215]
ds_read_b128 v[132:135], v28 offset:13312
v_mfma_f32_16x16x32_bf16 v[216:219], v[80:83], a[80:83], v[216:219]
v_mfma_f32_16x16x32_bf16 v[208:211], v[104:107], a[20:23], v[208:211]
ds_read_b128 v[136:139], v28 offset:22528
v_mfma_f32_16x16x32_bf16 v[212:215], v[108:111], a[20:23], v[212:215]
ds_read_b128 v[140:143], v28 offset:31744
v_mfma_f32_16x16x32_bf16 v[220:223], v[84:87], a[80:83], v[220:223]
s_waitcnt lgkmcnt(4)
v_mfma_f32_16x16x32_bf16 v[208:211], v[112:115], a[24:27], v[208:211]
ds_read_b128 v[144:147], v28 offset:5120
v_mfma_f32_16x16x32_bf16 v[212:215], v[116:119], a[24:27], v[212:215]
ds_read_b128 v[148:151], v28 offset:14336
v_mfma_f32_16x16x32_bf16 v[216:219], v[88:91], a[84:87], v[216:219]
v_mfma_f32_16x16x32_bf16 v[208:211], v[120:123], a[28:31], v[208:211]
ds_read_b128 v[152:155], v28 offset:23552
v_mfma_f32_16x16x32_bf16 v[212:215], v[124:127], a[28:31], v[212:215]
ds_read_b128 v[156:159], v28 offset:32768
v_mfma_f32_16x16x32_bf16 v[220:223], v[92:95], a[84:87], v[220:223]
s_waitcnt vmcnt(5)
s_barrier
s_waitcnt lgkmcnt(4)
v_mfma_f32_16x16x32_bf16 v[208:211], v[128:131], a[32:35], v[208:211]
ds_read_b128 v[160:163], v28 offset:6144
v_mfma_f32_16x16x32_bf16 v[212:215], v[132:135], a[32:35], v[212:215]
ds_read_b128 v[164:167], v28 offset:15360
s_waitcnt vmcnt(4)
ds_write_b32 v18, v24
v_mfma_f32_16x16x32_bf16 v[216:219], v[96:99], a[88:91], v[216:219]
v_mfma_f32_16x16x32_bf16 v[208:211], v[136:139], a[36:39], v[208:211]
ds_read_b128 v[168:171], v28 offset:24576
v_mfma_f32_16x16x32_bf16 v[212:215], v[140:143], a[36:39], v[212:215]
ds_read_b128 v[172:175], v28 offset:33792
s_waitcnt lgkmcnt(2)
s_barrier
v_mfma_f32_16x16x32_bf16 v[220:223], v[100:103], a[88:91], v[220:223]
ds_read_b32 v33, v32
v_mfma_f32_16x16x32_bf16 v[208:211], v[144:147], a[40:43], v[208:211]
ds_read_b128 v[176:179], v28 offset:7168
v_mfma_f32_16x16x32_bf16 v[212:215], v[148:151], a[40:43], v[212:215]
ds_read_b128 v[180:183], v28 offset:16384
v_mfma_f32_16x16x32_bf16 v[216:219], v[104:107], a[92:95], v[216:219]
s_waitcnt lgkmcnt(2)
v_cmp_gt_u32 vcc, s52, v33
v_mfma_f32_16x16x32_bf16 v[208:211], v[152:155], a[44:47], v[208:211]
ds_read_b128 v[184:187], v28 offset:25600
v_cmp_gt_u32 s[58:59], s54, v33
v_mfma_f32_16x16x32_bf16 v[212:215], v[156:159], a[44:47], v[212:215]
ds_read_b128 v[188:191], v28 offset:34816
s_and_b32 vcc_lo, vcc_lo, s56
s_cselect_b32 s70, 0, 1
v_mfma_f32_16x16x32_bf16 v[220:223], v[108:111], a[92:95], v[220:223]
s_and_b32 s59, s59, s56
s_cselect_b32 s71, 0, s77
v_mfma_f32_16x16x32_bf16 v[208:211], v[160:163], a[48:51], v[208:211]
ds_read_b128 v[192:195], v28 offset:8192
s_or_b32 s82, s70, s71
s_cselect_b32 s10, 268435456, 0
v_mfma_f32_16x16x32_bf16 v[212:215], v[164:167], a[48:51], v[212:215]
ds_read_b128 v[196:199], v28 offset:17408
v_mfma_f32_16x16x32_bf16 v[216:219], v[112:115], a[96:99], v[216:219]
s_cmp_lg_u32 s70, 0
s_cselect_b64 s[78:79], s[52:53], s[54:55]
s_cselect_b64 s[58:59], s[44:45], s[46:47]
s_mul_i32 s80, s78, s20
v_mfma_f32_16x16x32_bf16 v[208:211], v[168:171], a[52:55], v[208:211]
ds_read_b128 v[200:203], v28 offset:26624
s_add_u32 s80, s80, s58
v_mfma_f32_16x16x32_bf16 v[212:215], v[172:175], a[52:55], v[212:215]
ds_read_b128 v[204:207], v28 offset:35840
s_add_u32 m0, s49, 0
v_mfma_f32_16x16x32_bf16 v[220:223], v[116:119], a[96:99], v[220:223]
buffer_load_dwordx4 v8, s[8:11], s80 offen offset:0 sc1 lds
s_waitcnt lgkmcnt(4)
v_mfma_f32_16x16x32_bf16 v[208:211], v[176:179], a[56:59], v[208:211]
s_mul_i32 s81, s78, s21
s_add_u32 s81, s81, s59
s_andn2_b32 s71, s71, s70
v_mfma_f32_16x16x32_bf16 v[212:215], v[180:183], a[56:59], v[212:215]
s_add_u32 s52, s52, s70
s_add_u32 s54, s54, s71
s_mov_b32 s83, s82
v_mfma_f32_16x16x32_bf16 v[216:219], v[120:123], a[100:103], v[216:219]
buffer_load_dwordx4 v9, s[8:11], s80 offen offset:1024 sc1 lds
v_mfma_f32_16x16x32_bf16 v[208:211], v[184:187], a[60:63], v[208:211]
v_mfma_f32_16x16x32_bf16 v[212:215], v[188:191], a[60:63], v[212:215]
v_mfma_f32_16x16x32_bf16 v[220:223], v[124:127], a[100:103], v[220:223]
buffer_load_dwordx4 v10, s[8:11], s80 offen offset:2048 sc1 lds
s_waitcnt lgkmcnt(0)
v_mfma_f32_16x16x32_bf16 v[208:211], v[192:195], a[64:67], v[208:211]
v_mfma_f32_16x16x32_bf16 v[212:215], v[196:199], a[64:67], v[212:215]
v_mfma_f32_16x16x32_bf16 v[216:219], v[128:131], a[104:107], v[216:219]
buffer_load_dwordx4 v11, s[8:11], s80 offen offset:3072 sc1 lds
v_mfma_f32_16x16x32_bf16 v[208:211], v[200:203], a[68:71], v[208:211]
v_mfma_f32_16x16x32_bf16 v[212:215], v[204:207], a[68:71], v[212:215]
s_add_u32 m0, s49, 4096
v_mfma_f32_16x16x32_bf16 v[220:223], v[132:135], a[104:107], v[220:223]
buffer_load_dwordx4 v12, s[8:11], s80 offen offset:0 sc1 lds
v_mfma_f32_16x16x32_bf16 v[216:219], v[136:139], a[108:111], v[216:219]
v_mfma_f32_16x16x32_bf16 v[220:223], v[140:143], a[108:111], v[220:223]
v_mfma_f32_16x16x32_bf16 v[216:219], v[144:147], a[112:115], v[216:219]
buffer_load_dwordx4 v13, s[8:11], s80 offen offset:1024 sc1 lds
v_mfma_f32_16x16x32_bf16 v[220:223], v[148:151], a[112:115], v[220:223]
v_mfma_f32_16x16x32_bf16 v[216:219], v[152:155], a[116:119], v[216:219]
v_cvt_pk_bf16_f32 v48, v208, v209
v_cvt_pk_bf16_f32 v49, v210, v211
v_mfma_f32_16x16x32_bf16 v[220:223], v[156:159], a[116:119], v[220:223]
buffer_load_dwordx4 v14, s[8:11], s80 offen offset:2048 sc1 lds
v_mfma_f32_16x16x32_bf16 v[216:219], v[160:163], a[120:123], v[216:219]
v_cvt_pk_bf16_f32 v50, v212, v213
v_cvt_pk_bf16_f32 v51, v214, v215
v_mfma_f32_16x16x32_bf16 v[220:223], v[164:167], a[120:123], v[220:223]
buffer_store_dwordx4 v[48:51], v19, s[4:7], s75 offen sc1
v_mfma_f32_16x16x32_bf16 v[216:219], v[168:171], a[124:127], v[216:219]
buffer_load_dwordx4 v15, s[8:11], s80 offen offset:3072 sc1 lds
v_mfma_f32_16x16x32_bf16 v[220:223], v[172:175], a[124:127], v[220:223]
v_mfma_f32_16x16x32_bf16 v[216:219], v[176:179], a[128:131], v[216:219]
s_add_u32 m0, s49, 8192
v_mfma_f32_16x16x32_bf16 v[220:223], v[180:183], a[128:131], v[220:223]
buffer_load_dwordx4 v16, s[8:11], s80 offen offset:0 sc1 lds
v_mfma_f32_16x16x32_bf16 v[216:219], v[184:187], a[132:135], v[216:219]
v_mfma_f32_16x16x32_bf16 v[220:223], v[188:191], a[132:135], v[220:223]
v_mfma_f32_16x16x32_bf16 v[216:219], v[192:195], a[136:139], v[216:219]
v_mfma_f32_16x16x32_bf16 v[220:223], v[196:199], a[136:139], v[220:223]
v_mfma_f32_16x16x32_bf16 v[216:219], v[200:203], a[140:143], v[216:219]
v_mfma_f32_16x16x32_bf16 v[220:223], v[204:207], a[140:143], v[220:223]
v_mfma_f32_16x16x32_bf16 v[224:227], v[64:67], a[144:147], 0
v_mfma_f32_16x16x32_bf16 v[228:231], v[68:71], a[144:147], 0
v_mfma_f32_16x16x32_bf16 v[224:227], v[72:75], a[148:151], v[224:227]
v_mfma_f32_16x16x32_bf16 v[228:231], v[76:79], a[148:151], v[228:231]
v_mfma_f32_16x16x32_bf16 v[224:227], v[80:83], a[152:155], v[224:227]
buffer_load_dword v24, v22, s[4:7], 0 offen sc1
v_mfma_f32_16x16x32_bf16 v[228:231], v[84:87], a[152:155], v[228:231]
v_cvt_pk_bf16_f32 v52, v216, v217
v_cvt_pk_bf16_f32 v53, v218, v219
v_mfma_f32_16x16x32_bf16 v[224:227], v[88:91], a[156:159], v[224:227]
s_waitcnt vmcnt(11)
s_barrier
v_mfma_f32_16x16x32_bf16 v[228:231], v[92:95], a[156:159], v[228:231]
buffer_store_dword v27, v45, s[4:7], s91 offen
v_mfma_f32_16x16x32_bf16 v[224:227], v[96:99], a[160:163], v[224:227]
buffer_store_dword v27, v44, s[4:7], s91 offen sc1
v_mfma_f32_16x16x32_bf16 v[228:231], v[100:103], a[160:163], v[228:231]
v_cvt_pk_bf16_f32 v54, v220, v221
v_cvt_pk_bf16_f32 v55, v222, v223
v_mfma_f32_16x16x32_bf16 v[224:227], v[104:107], a[164:167], v[224:227]
buffer_store_dwordx4 v[52:55], v20, s[4:7], s75 offen sc1
v_mfma_f32_16x16x32_bf16 v[228:231], v[108:111], a[164:167], v[228:231]
v_mfma_f32_16x16x32_bf16 v[224:227], v[112:115], a[168:171], v[224:227]
v_mfma_f32_16x16x32_bf16 v[228:231], v[116:119], a[168:171], v[228:231]
v_mfma_f32_16x16x32_bf16 v[224:227], v[120:123], a[172:175], v[224:227]
v_mfma_f32_16x16x32_bf16 v[228:231], v[124:127], a[172:175], v[228:231]
v_mfma_f32_16x16x32_bf16 v[224:227], v[128:131], a[176:179], v[224:227]
v_mfma_f32_16x16x32_bf16 v[228:231], v[132:135], a[176:179], v[228:231]
v_mfma_f32_16x16x32_bf16 v[224:227], v[136:139], a[180:183], v[224:227]
v_mfma_f32_16x16x32_bf16 v[228:231], v[140:143], a[180:183], v[228:231]
v_mfma_f32_16x16x32_bf16 v[224:227], v[144:147], a[184:187], v[224:227]
v_mfma_f32_16x16x32_bf16 v[228:231], v[148:151], a[184:187], v[228:231]
v_mfma_f32_16x16x32_bf16 v[224:227], v[152:155], a[188:191], v[224:227]
v_mfma_f32_16x16x32_bf16 v[228:231], v[156:159], a[188:191], v[228:231]
v_mfma_f32_16x16x32_bf16 v[224:227], v[160:163], a[192:195], v[224:227]
s_waitcnt vmcnt(12)
s_barrier
v_mfma_f32_16x16x32_bf16 v[228:231], v[164:167], a[192:195], v[228:231]
v_mfma_f32_16x16x32_bf16 v[224:227], v[168:171], a[196:199], v[224:227]
s_cmp_eq_u32 s82, 0
s_cbranch_scc1 g_slow_28
v_mfma_f32_16x16x32_bf16 v[228:231], v[172:175], a[196:199], v[228:231]
ds_read_b128 v[64:67], v29 offset:0
v_mfma_f32_16x16x32_bf16 v[224:227], v[176:179], a[200:203], v[224:227]
ds_read_b128 v[68:71], v29 offset:9216
v_mfma_f32_16x16x32_bf16 v[228:231], v[180:183], a[200:203], v[228:231]
ds_read_b128 v[72:75], v29 offset:18432
v_mfma_f32_16x16x32_bf16 v[224:227], v[184:187], a[204:207], v[224:227]
ds_read_b128 v[76:79], v29 offset:27648
v_mfma_f32_16x16x32_bf16 v[228:231], v[188:191], a[204:207], v[228:231]
ds_read_b128 v[80:83], v29 offset:1024
v_mfma_f32_16x16x32_bf16 v[224:227], v[192:195], a[208:211], v[224:227]
ds_read_b128 v[84:87], v29 offset:10240
v_mfma_f32_16x16x32_bf16 v[228:231], v[196:199], a[208:211], v[228:231]
ds_read_b128 v[88:91], v29 offset:19456
v_mfma_f32_16x16x32_bf16 v[224:227], v[200:203], a[212:215], v[224:227]
ds_read_b128 v[92:95], v29 offset:28672
v_mfma_f32_16x16x32_bf16 v[228:231], v[204:207], a[212:215], v[228:231]
s_waitcnt vmcnt(8)
s_barrier
g_body_17:
s_waitcnt lgkmcnt(4)
v_mfma_f32_16x16x32_bf16 v[208:211], v[64:67], a[0:3], 0
ds_read_b128 v[96:99], v29 offset:2048
v_mfma_f32_16x16x32_bf16 v[212:215], v[68:71], a[0:3], 0
ds_read_b128 v[100:103], v29 offset:11264
v_mfma_f32_16x16x32_bf16 v[216:219], v[64:67], a[72:75], 0
v_mfma_f32_16x16x32_bf16 v[208:211], v[72:75], a[4:7], v[208:211]
ds_read_b128 v[104:107], v29 offset:20480
v_cvt_pk_bf16_f32 v56, v224, v225
v_mfma_f32_16x16x32_bf16 v[212:215], v[76:79], a[4:7], v[212:215]
ds_read_b128 v[108:111], v29 offset:29696
v_cvt_pk_bf16_f32 v57, v226, v227
v_mfma_f32_16x16x32_bf16 v[220:223], v[68:71], a[72:75], 0
v_cvt_pk_bf16_f32 v58, v228, v229
s_waitcnt lgkmcnt(4)
v_mfma_f32_16x16x32_bf16 v[208:211], v[80:83], a[8:11], v[208:211]
ds_read_b128 v[112:115], v29 offset:3072
v_cvt_pk_bf16_f32 v59, v230, v231
v_mfma_f32_16x16x32_bf16 v[212:215], v[84:87], a[8:11], v[212:215]
ds_read_b128 v[116:119], v29 offset:12288
v_mfma_f32_16x16x32_bf16 v[216:219], v[72:75], a[76:79], v[216:219]
buffer_store_dwordx4 v[56:59], v21, s[4:7], s75 offen sc1
v_mfma_f32_16x16x32_bf16 v[208:211], v[88:91], a[12:15], v[208:211]
ds_read_b128 v[120:123], v29 offset:21504
v_mov_b32 v27, s72
v_mfma_f32_16x16x32_bf16 v[212:215], v[92:95], a[12:15], v[212:215]
ds_read_b128 v[124:127], v29 offset:30720
v_mfma_f32_16x16x32_bf16 v[220:223], v[76:79], a[76:79], v[220:223]
s_waitcnt lgkmcnt(4)
v_mfma_f32_16x16x32_bf16 v[208:211], v[96:99], a[16:19], v[208:211]
ds_read_b128 v[128:131], v29 offset:4096
v_mfma_f32_16x16x32_bf16 v[212:215], v[100:103], a[16:19], v[212:215]
ds_read_b128 v[132:135], v29 offset:13312
v_mfma_f32_16x16x32_bf16 v[216:219], v[80:83], a[80:83], v[216:219]
v_mfma_f32_16x16x32_bf16 v[208:211], v[104:107], a[20:23], v[208:211]
ds_read_b128 v[136:139], v29 offset:22528
v_mfma_f32_16x16x32_bf16 v[212:215], v[108:111], a[20:23], v[212:215]
ds_read_b128 v[140:143], v29 offset:31744
v_mfma_f32_16x16x32_bf16 v[220:223], v[84:87], a[80:83], v[220:223]
s_waitcnt lgkmcnt(4)
v_mfma_f32_16x16x32_bf16 v[208:211], v[112:115], a[24:27], v[208:211]
ds_read_b128 v[144:147], v29 offset:5120
v_mfma_f32_16x16x32_bf16 v[212:215], v[116:119], a[24:27], v[212:215]
ds_read_b128 v[148:151], v29 offset:14336
v_mfma_f32_16x16x32_bf16 v[216:219], v[88:91], a[84:87], v[216:219]
v_mfma_f32_16x16x32_bf16 v[208:211], v[120:123], a[28:31], v[208:211]
ds_read_b128 v[152:155], v29 offset:23552
v_mfma_f32_16x16x32_bf16 v[212:215], v[124:127], a[28:31], v[212:215]
ds_read_b128 v[156:159], v29 offset:32768
v_mfma_f32_16x16x32_bf16 v[220:223], v[92:95], a[84:87], v[220:223]
s_waitcnt vmcnt(5)
s_barrier
s_waitcnt lgkmcnt(4)
v_mfma_f32_16x16x32_bf16 v[208:211], v[128:131], a[32:35], v[208:211]
ds_read_b128 v[160:163], v29 offset:6144
v_mfma_f32_16x16x32_bf16 v[212:215], v[132:135], a[32:35], v[212:215]
ds_read_b128 v[164:167], v29 offset:15360
s_waitcnt vmcnt(4)
ds_write_b32 v18, v24
v_mfma_f32_16x16x32_bf16 v[216:219], v[96:99], a[88:91], v[216:219]
v_mfma_f32_16x16x32_bf16 v[208:211], v[136:139], a[36:39], v[208:211]
ds_read_b128 v[168:171], v29 offset:24576
v_mfma_f32_16x16x32_bf16 v[212:215], v[140:143], a[36:39], v[212:215]
ds_read_b128 v[172:175], v29 offset:33792
s_waitcnt lgkmcnt(2)
s_barrier
v_mfma_f32_16x16x32_bf16 v[220:223], v[100:103], a[88:91], v[220:223]
ds_read_b32 v33, v32
v_mfma_f32_16x16x32_bf16 v[208:211], v[144:147], a[40:43], v[208:211]
ds_read_b128 v[176:179], v29 offset:7168
v_mfma_f32_16x16x32_bf16 v[212:215], v[148:151], a[40:43], v[212:215]
ds_read_b128 v[180:183], v29 offset:16384
v_mfma_f32_16x16x32_bf16 v[216:219], v[104:107], a[92:95], v[216:219]
s_waitcnt lgkmcnt(2)
v_cmp_gt_u32 vcc, s52, v33
v_mfma_f32_16x16x32_bf16 v[208:211], v[152:155], a[44:47], v[208:211]
ds_read_b128 v[184:187], v29 offset:25600
v_cmp_gt_u32 s[58:59], s54, v33
v_mfma_f32_16x16x32_bf16 v[212:215], v[156:159], a[44:47], v[212:215]
ds_read_b128 v[188:191], v29 offset:34816
s_and_b32 vcc_lo, vcc_lo, s56
s_cselect_b32 s70, 0, 1
v_mfma_f32_16x16x32_bf16 v[220:223], v[108:111], a[92:95], v[220:223]
s_and_b32 s59, s59, s56
s_cselect_b32 s71, 0, s83
v_mfma_f32_16x16x32_bf16 v[208:211], v[160:163], a[48:51], v[208:211]
ds_read_b128 v[192:195], v29 offset:8192
s_or_b32 s88, s70, s71
s_cselect_b32 s10, 268435456, 0
v_mfma_f32_16x16x32_bf16 v[212:215], v[164:167], a[48:51], v[212:215]
ds_read_b128 v[196:199], v29 offset:17408
v_mfma_f32_16x16x32_bf16 v[216:219], v[112:115], a[96:99], v[216:219]
s_cmp_lg_u32 s70, 0
s_cselect_b64 s[84:85], s[52:53], s[54:55]
s_cselect_b64 s[58:59], s[44:45], s[46:47]
s_mul_i32 s86, s84, s20
v_mfma_f32_16x16x32_bf16 v[208:211], v[168:171], a[52:55], v[208:211]
ds_read_b128 v[200:203], v29 offset:26624
s_add_u32 s86, s86, s58
v_mfma_f32_16x16x32_bf16 v[212:215], v[172:175], a[52:55], v[212:215]
ds_read_b128 v[204:207], v29 offset:35840
s_add_u32 m0, s50, 0
v_mfma_f32_16x16x32_bf16 v[220:223], v[116:119], a[96:99], v[220:223]
buffer_load_dwordx4 v8, s[8:11], s86 offen offset:0 sc1 lds
s_waitcnt lgkmcnt(4)
v_mfma_f32_16x16x32_bf16 v[208:211], v[176:179], a[56:59], v[208:211]
s_mul_i32 s87, s84, s21
s_add_u32 s87, s87, s59
s_andn2_b32 s71, s71, s70
v_mfma_f32_16x16x32_bf16 v[212:215], v[180:183], a[56:59], v[212:215]
s_add_u32 s52, s52, s70
s_add_u32 s54, s54, s71
s_mov_b32 s89, s88
v_mfma_f32_16x16x32_bf16 v[216:219], v[120:123], a[100:103], v[216:219]
buffer_load_dwordx4 v9, s[8:11], s86 offen offset:1024 sc1 lds
v_mfma_f32_16x16x32_bf16 v[208:211], v[184:187], a[60:63], v[208:211]
v_mfma_f32_16x16x32_bf16 v[212:215], v[188:191], a[60:63], v[212:215]
v_mfma_f32_16x16x32_bf16 v[220:223], v[124:127], a[100:103], v[220:223]
buffer_load_dwordx4 v10, s[8:11], s86 offen offset:2048 sc1 lds
s_waitcnt lgkmcnt(0)
v_mfma_f32_16x16x32_bf16 v[208:211], v[192:195], a[64:67], v[208:211]
v_mfma_f32_16x16x32_bf16 v[212:215], v[196:199], a[64:67], v[212:215]
v_mfma_f32_16x16x32_bf16 v[216:219], v[128:131], a[104:107], v[216:219]
buffer_load_dwordx4 v11, s[8:11], s86 offen offset:3072 sc1 lds
v_mfma_f32_16x16x32_bf16 v[208:211], v[200:203], a[68:71], v[208:211]
v_mfma_f32_16x16x32_bf16 v[212:215], v[204:207], a[68:71], v[212:215]
s_add_u32 m0, s50, 4096
v_mfma_f32_16x16x32_bf16 v[220:223], v[132:135], a[104:107], v[220:223]
buffer_load_dwordx4 v12, s[8:11], s86 offen offset:0 sc1 lds
v_mfma_f32_16x16x32_bf16 v[216:219], v[136:139], a[108:111], v[216:219]
v_mfma_f32_16x16x32_bf16 v[220:223], v[140:143], a[108:111], v[220:223]
v_mfma_f32_16x16x32_bf16 v[216:219], v[144:147], a[112:115], v[216:219]
buffer_load_dwordx4 v13, s[8:11], s86 offen offset:1024 sc1 lds
v_mfma_f32_16x16x32_bf16 v[220:223], v[148:151], a[112:115], v[220:223]
v_mfma_f32_16x16x32_bf16 v[216:219], v[152:155], a[116:119], v[216:219]
v_cvt_pk_bf16_f32 v48, v208, v209
v_cvt_pk_bf16_f32 v49, v210, v211
v_mfma_f32_16x16x32_bf16 v[220:223], v[156:159], a[116:119], v[220:223]
buffer_load_dwordx4 v14, s[8:11], s86 offen offset:2048 sc1 lds
v_mfma_f32_16x16x32_bf16 v[216:219], v[160:163], a[120:123], v[216:219]
v_cvt_pk_bf16_f32 v50, v212, v213
v_cvt_pk_bf16_f32 v51, v214, v215
v_mfma_f32_16x16x32_bf16 v[220:223], v[164:167], a[120:123], v[220:223]
buffer_store_dwordx4 v[48:51], v19, s[4:7], s81 offen sc1
v_mfma_f32_16x16x32_bf16 v[216:219], v[168:171], a[124:127], v[216:219]
buffer_load_dwordx4 v15, s[8:11], s86 offen offset:3072 sc1 lds
v_mfma_f32_16x16x32_bf16 v[220:223], v[172:175], a[124:127], v[220:223]
v_mfma_f32_16x16x32_bf16 v[216:219], v[176:179], a[128:131], v[216:219]
s_add_u32 m0, s50, 8192
v_mfma_f32_16x16x32_bf16 v[220:223], v[180:183], a[128:131], v[220:223]
buffer_load_dwordx4 v16, s[8:11], s86 offen offset:0 sc1 lds
v_mfma_f32_16x16x32_bf16 v[216:219], v[184:187], a[132:135], v[216:219]
v_mfma_f32_16x16x32_bf16 v[220:223], v[188:191], a[132:135], v[220:223]
v_mfma_f32_16x16x32_bf16 v[216:219], v[192:195], a[136:139], v[216:219]
v_mfma_f32_16x16x32_bf16 v[220:223], v[196:199], a[136:139], v[220:223]
v_mfma_f32_16x16x32_bf16 v[216:219], v[200:203], a[140:143], v[216:219]
v_mfma_f32_16x16x32_bf16 v[220:223], v[204:207], a[140:143], v[220:223]
v_mfma_f32_16x16x32_bf16 v[224:227], v[64:67], a[144:147], 0
v_mfma_f32_16x16x32_bf16 v[228:231], v[68:71], a[144:147], 0
v_mfma_f32_16x16x32_bf16 v[224:227], v[72:75], a[148:151], v[224:227]
v_mfma_f32_16x16x32_bf16 v[228:231], v[76:79], a[148:151], v[228:231]
v_mfma_f32_16x16x32_bf16 v[224:227], v[80:83], a[152:155], v[224:227]
buffer_load_dword v24, v22, s[4:7], 0 offen sc1
v_mfma_f32_16x16x32_bf16 v[228:231], v[84:87], a[152:155], v[228:231]
v_cvt_pk_bf16_f32 v52, v216, v217
v_cvt_pk_bf16_f32 v53, v218, v219
v_mfma_f32_16x16x32_bf16 v[224:227], v[88:91], a[156:159], v[224:227]
s_waitcnt vmcnt(11)
s_barrier
v_mfma_f32_16x16x32_bf16 v[228:231], v[92:95], a[156:159], v[228:231]
buffer_store_dword v27, v45, s[4:7], s73 offen
v_mfma_f32_16x16x32_bf16 v[224:227], v[96:99], a[160:163], v[224:227]
buffer_store_dword v27, v44, s[4:7], s73 offen sc1
v_mfma_f32_16x16x32_bf16 v[228:231], v[100:103], a[160:163], v[228:231]
v_cvt_pk_bf16_f32 v54, v220, v221
v_cvt_pk_bf16_f32 v55, v222, v223
v_mfma_f32_16x16x32_bf16 v[224:227], v[104:107], a[164:167], v[224:227]
buffer_store_dwordx4 v[52:55], v20, s[4:7], s81 offen sc1
v_mfma_f32_16x16x32_bf16 v[228:231], v[108:111], a[164:167], v[228:231]
v_mfma_f32_16x16x32_bf16 v[224:227], v[112:115], a[168:171], v[224:227]
v_mfma_f32_16x16x32_bf16 v[228:231], v[116:119], a[168:171], v[228:231]
v_mfma_f32_16x16x32_bf16 v[224:227], v[120:123], a[172:175], v[224:227]
v_mfma_f32_16x16x32_bf16 v[228:231], v[124:127], a[172:175], v[228:231]
v_mfma_f32_16x16x32_bf16 v[224:227], v[128:131], a[176:179], v[224:227]
v_mfma_f32_16x16x32_bf16 v[228:231], v[132:135], a[176:179], v[228:231]
v_mfma_f32_16x16x32_bf16 v[224:227], v[136:139], a[180:183], v[224:227]
v_mfma_f32_16x16x32_bf16 v[228:231], v[140:143], a[180:183], v[228:231]
v_mfma_f32_16x16x32_bf16 v[224:227], v[144:147], a[184:187], v[224:227]
v_mfma_f32_16x16x32_bf16 v[228:231], v[148:151], a[184:187], v[228:231]
v_mfma_f32_16x16x32_bf16 v[224:227], v[152:155], a[188:191], v[224:227]
v_mfma_f32_16x16x32_bf16 v[228:231], v[156:159], a[188:191], v[228:231]
v_mfma_f32_16x16x32_bf16 v[224:227], v[160:163], a[192:195], v[224:227]
s_waitcnt vmcnt(12)
s_barrier
v_mfma_f32_16x16x32_bf16 v[228:231], v[164:167], a[192:195], v[228:231]
v_mfma_f32_16x16x32_bf16 v[224:227], v[168:171], a[196:199], v[224:227]
s_cmp_eq_u32 s88, 0
s_cbranch_scc1 g_slow_29
v_mfma_f32_16x16x32_bf16 v[228:231], v[172:175], a[196:199], v[228:231]
ds_read_b128 v[64:67], v30 offset:0
v_mfma_f32_16x16x32_bf16 v[224:227], v[176:179], a[200:203], v[224:227]
ds_read_b128 v[68:71], v30 offset:9216
v_mfma_f32_16x16x32_bf16 v[228:231], v[180:183], a[200:203], v[228:231]
ds_read_b128 v[72:75], v30 offset:18432
v_mfma_f32_16x16x32_bf16 v[224:227], v[184:187], a[204:207], v[224:227]
ds_read_b128 v[76:79], v30 offset:27648
v_mfma_f32_16x16x32_bf16 v[228:231], v[188:191], a[204:207], v[228:231]
ds_read_b128 v[80:83], v30 offset:1024
v_mfma_f32_16x16x32_bf16 v[224:227], v[192:195], a[208:211], v[224:227]
ds_read_b128 v[84:87], v30 offset:10240
v_mfma_f32_16x16x32_bf16 v[228:231], v[196:199], a[208:211], v[228:231]
ds_read_b128 v[88:91], v30 offset:19456
v_mfma_f32_16x16x32_bf16 v[224:227], v[200:203], a[212:215], v[224:227]
ds_read_b128 v[92:95], v30 offset:28672
v_mfma_f32_16x16x32_bf16 v[228:231], v[204:207], a[212:215], v[228:231]
s_waitcnt vmcnt(8)
s_barrier
g_body_18:
s_waitcnt lgkmcnt(4)
v_mfma_f32_16x16x32_bf16 v[208:211], v[64:67], a[0:3], 0
ds_read_b128 v[96:99], v30 offset:2048
v_mfma_f32_16x16x32_bf16 v[212:215], v[68:71], a[0:3], 0
ds_read_b128 v[100:103], v30 offset:11264
v_mfma_f32_16x16x32_bf16 v[216:219], v[64:67], a[72:75], 0
v_mfma_f32_16x16x32_bf16 v[208:211], v[72:75], a[4:7], v[208:211]
ds_read_b128 v[104:107], v30 offset:20480
v_cvt_pk_bf16_f32 v56, v224, v225
v_mfma_f32_16x16x32_bf16 v[212:215], v[76:79], a[4:7], v[212:215]
ds_read_b128 v[108:111], v30 offset:29696
v_cvt_pk_bf16_f32 v57, v226, v227
v_mfma_f32_16x16x32_bf16 v[220:223], v[68:71], a[72:75], 0
v_cvt_pk_bf16_f32 v58, v228, v229
s_waitcnt lgkmcnt(4)
v_mfma_f32_16x16x32_bf16 v[208:211], v[80:83], a[8:11], v[208:211]
ds_read_b128 v[112:115], v30 offset:3072
v_cvt_pk_bf16_f32 v59, v230, v231
v_mfma_f32_16x16x32_bf16 v[212:215], v[84:87], a[8:11], v[212:215]
ds_read_b128 v[116:119], v30 offset:12288
v_mfma_f32_16x16x32_bf16 v[216:219], v[72:75], a[76:79], v[216:219]
buffer_store_dwordx4 v[56:59], v21, s[4:7], s81 offen sc1
v_mfma_f32_16x16x32_bf16 v[208:211], v[88:91], a[12:15], v[208:211]
ds_read_b128 v[120:123], v30 offset:21504
v_mov_b32 v27, s78
v_mfma_f32_16x16x32_bf16 v[212:215], v[92:95], a[12:15], v[212:215]
ds_read_b128 v[124:127], v30 offset:30720
v_mfma_f32_16x16x32_bf16 v[220:223], v[76:79], a[76:79], v[220:223]
s_waitcnt lgkmcnt(4)
v_mfma_f32_16x16x32_bf16 v[208:211], v[96:99], a[16:19], v[208:211]
ds_read_b128 v[128:131], v30 offset:4096
v_mfma_f32_16x16x32_bf16 v[212:215], v[100:103], a[16:19], v[212:215]
ds_read_b128 v[132:135], v30 offset:13312
v_mfma_f32_16x16x32_bf16 v[216:219], v[80:83], a[80:83], v[216:219]
v_mfma_f32_16x16x32_bf16 v[208:211], v[104:107], a[20:23], v[208:211]
ds_read_b128 v[136:139], v30 offset:22528
v_mfma_f32_16x16x32_bf16 v[212:215], v[108:111], a[20:23], v[212:215]
ds_read_b128 v[140:143], v30 offset:31744
v_mfma_f32_16x16x32_bf16 v[220:223], v[84:87], a[80:83], v[220:223]
s_waitcnt lgkmcnt(4)
v_mfma_f32_16x16x32_bf16 v[208:211], v[112:115], a[24:27], v[208:211]
ds_read_b128 v[144:147], v30 offset:5120
v_mfma_f32_16x16x32_bf16 v[212:215], v[116:119], a[24:27], v[212:215]
ds_read_b128 v[148:151], v30 offset:14336
v_mfma_f32_16x16x32_bf16 v[216:219], v[88:91], a[84:87], v[216:219]
v_mfma_f32_16x16x32_bf16 v[208:211], v[120:123], a[28:31], v[208:211]
ds_read_b128 v[152:155], v30 offset:23552
v_mfma_f32_16x16x32_bf16 v[212:215], v[124:127], a[28:31], v[212:215]
ds_read_b128 v[156:159], v30 offset:32768
v_mfma_f32_16x16x32_bf16 v[220:223], v[92:95], a[84:87], v[220:223]
s_waitcnt vmcnt(5)
s_barrier
s_waitcnt lgkmcnt(4)
v_mfma_f32_16x16x32_bf16 v[208:211], v[128:131], a[32:35], v[208:211]
ds_read_b128 v[160:163], v30 offset:6144
v_mfma_f32_16x16x32_bf16 v[212:215], v[132:135], a[32:35], v[212:215]
ds_read_b128 v[164:167], v30 offset:15360
s_waitcnt vmcnt(4)
ds_write_b32 v18, v24
v_mfma_f32_16x16x32_bf16 v[216:219], v[96:99], a[88:91], v[216:219]
v_mfma_f32_16x16x32_bf16 v[208:211], v[136:139], a[36:39], v[208:211]
ds_read_b128 v[168:171], v30 offset:24576
v_mfma_f32_16x16x32_bf16 v[212:215], v[140:143], a[36:39], v[212:215]
ds_read_b128 v[172:175], v30 offset:33792
s_waitcnt lgkmcnt(2)
s_barrier
v_mfma_f32_16x16x32_bf16 v[220:223], v[100:103], a[88:91], v[220:223]
ds_read_b32 v33, v32
v_mfma_f32_16x16x32_bf16 v[208:211], v[144:147], a[40:43], v[208:211]
ds_read_b128 v[176:179], v30 offset:7168
v_mfma_f32_16x16x32_bf16 v[212:215], v[148:151], a[40:43], v[212:215]
ds_read_b128 v[180:183], v30 offset:16384
v_mfma_f32_16x16x32_bf16 v[216:219], v[104:107], a[92:95], v[216:219]
s_waitcnt lgkmcnt(2)
v_cmp_gt_u32 vcc, s52, v33
v_mfma_f32_16x16x32_bf16 v[208:211], v[152:155], a[44:47], v[208:211]
ds_read_b128 v[184:187], v30 offset:25600
v_cmp_gt_u32 s[58:59], s54, v33
v_mfma_f32_16x16x32_bf16 v[212:215], v[156:159], a[44:47], v[212:215]
ds_read_b128 v[188:191], v30 offset:34816
s_and_b32 vcc_lo, vcc_lo, s56
s_cselect_b32 s70, 0, 1
v_mfma_f32_16x16x32_bf16 v[220:223], v[108:111], a[92:95], v[220:223]
s_and_b32 s59, s59, s56
s_cselect_b32 s71, 0, s89
v_mfma_f32_16x16x32_bf16 v[208:211], v[160:163], a[48:51], v[208:211]
ds_read_b128 v[192:195], v30 offset:8192
s_or_b32 s94, s70, s71
s_cselect_b32 s10, 268435456, 0
v_mfma_f32_16x16x32_bf16 v[212:215], v[164:167], a[48:51], v[212:215]
ds_read_b128 v[196:199], v30 offset:17408
v_mfma_f32_16x16x32_bf16 v[216:219], v[112:115], a[96:99], v[216:219]
s_cmp_lg_u32 s70, 0
s_cselect_b64 s[90:91], s[52:53], s[54:55]
s_cselect_b64 s[58:59], s[44:45], s[46:47]
s_mul_i32 s92, s90, s20
v_mfma_f32_16x16x32_bf16 v[208:211], v[168:171], a[52:55], v[208:211]
ds_read_b128 v[200:203], v30 offset:26624
s_add_u32 s92, s92, s58
v_mfma_f32_16x16x32_bf16 v[212:215], v[172:175], a[52:55], v[212:215]
ds_read_b128 v[204:207], v30 offset:35840
s_add_u32 m0, s51, 0
v_mfma_f32_16x16x32_bf16 v[220:223], v[116:119], a[96:99], v[220:223]
buffer_load_dwordx4 v8, s[8:11], s92 offen offset:0 sc1 lds
s_waitcnt lgkmcnt(4)
v_mfma_f32_16x16x32_bf16 v[208:211], v[176:179], a[56:59], v[208:211]
s_mul_i32 s93, s90, s21
s_add_u32 s93, s93, s59
s_andn2_b32 s71, s71, s70
v_mfma_f32_16x16x32_bf16 v[212:215], v[180:183], a[56:59], v[212:215]
s_add_u32 s52, s52, s70
s_add_u32 s54, s54, s71
s_mov_b32 s95, s94
v_mfma_f32_16x16x32_bf16 v[216:219], v[120:123], a[100:103], v[216:219]
buffer_load_dwordx4 v9, s[8:11], s92 offen offset:1024 sc1 lds
v_mfma_f32_16x16x32_bf16 v[208:211], v[184:187], a[60:63], v[208:211]
v_mfma_f32_16x16x32_bf16 v[212:215], v[188:191], a[60:63], v[212:215]
v_mfma_f32_16x16x32_bf16 v[220:223], v[124:127], a[100:103], v[220:223]
buffer_load_dwordx4 v10, s[8:11], s92 offen offset:2048 sc1 lds
s_waitcnt lgkmcnt(0)
v_mfma_f32_16x16x32_bf16 v[208:211], v[192:195], a[64:67], v[208:211]
v_mfma_f32_16x16x32_bf16 v[212:215], v[196:199], a[64:67], v[212:215]
v_mfma_f32_16x16x32_bf16 v[216:219], v[128:131], a[104:107], v[216:219]
buffer_load_dwordx4 v11, s[8:11], s92 offen offset:3072 sc1 lds
v_mfma_f32_16x16x32_bf16 v[208:211], v[200:203], a[68:71], v[208:211]
v_mfma_f32_16x16x32_bf16 v[212:215], v[204:207], a[68:71], v[212:215]
s_add_u32 m0, s51, 4096
v_mfma_f32_16x16x32_bf16 v[220:223], v[132:135], a[104:107], v[220:223]
buffer_load_dwordx4 v12, s[8:11], s92 offen offset:0 sc1 lds
v_mfma_f32_16x16x32_bf16 v[216:219], v[136:139], a[108:111], v[216:219]
v_mfma_f32_16x16x32_bf16 v[220:223], v[140:143], a[108:111], v[220:223]
v_mfma_f32_16x16x32_bf16 v[216:219], v[144:147], a[112:115], v[216:219]
buffer_load_dwordx4 v13, s[8:11], s92 offen offset:1024 sc1 lds
v_mfma_f32_16x16x32_bf16 v[220:223], v[148:151], a[112:115], v[220:223]
v_mfma_f32_16x16x32_bf16 v[216:219], v[152:155], a[116:119], v[216:219]
v_cvt_pk_bf16_f32 v48, v208, v209
v_cvt_pk_bf16_f32 v49, v210, v211
v_mfma_f32_16x16x32_bf16 v[220:223], v[156:159], a[116:119], v[220:223]
buffer_load_dwordx4 v14, s[8:11], s92 offen offset:2048 sc1 lds
v_mfma_f32_16x16x32_bf16 v[216:219], v[160:163], a[120:123], v[216:219]
v_cvt_pk_bf16_f32 v50, v212, v213
v_cvt_pk_bf16_f32 v51, v214, v215
v_mfma_f32_16x16x32_bf16 v[220:223], v[164:167], a[120:123], v[220:223]
buffer_store_dwordx4 v[48:51], v19, s[4:7], s87 offen sc1
v_mfma_f32_16x16x32_bf16 v[216:219], v[168:171], a[124:127], v[216:219]
buffer_load_dwordx4 v15, s[8:11], s92 offen offset:3072 sc1 lds
v_mfma_f32_16x16x32_bf16 v[220:223], v[172:175], a[124:127], v[220:223]
v_mfma_f32_16x16x32_bf16 v[216:219], v[176:179], a[128:131], v[216:219]
s_add_u32 m0, s51, 8192
v_mfma_f32_16x16x32_bf16 v[220:223], v[180:183], a[128:131], v[220:223]
buffer_load_dwordx4 v16, s[8:11], s92 offen offset:0 sc1 lds
v_mfma_f32_16x16x32_bf16 v[216:219], v[184:187], a[132:135], v[216:219]
v_mfma_f32_16x16x32_bf16 v[220:223], v[188:191], a[132:135], v[220:223]
v_mfma_f32_16x16x32_bf16 v[216:219], v[192:195], a[136:139], v[216:219]
v_mfma_f32_16x16x32_bf16 v[220:223], v[196:199], a[136:139], v[220:223]
v_mfma_f32_16x16x32_bf16 v[216:219], v[200:203], a[140:143], v[216:219]
v_mfma_f32_16x16x32_bf16 v[220:223], v[204:207], a[140:143], v[220:223]
v_mfma_f32_16x16x32_bf16 v[224:227], v[64:67], a[144:147], 0
v_mfma_f32_16x16x32_bf16 v[228:231], v[68:71], a[144:147], 0
v_mfma_f32_16x16x32_bf16 v[224:227], v[72:75], a[148:151], v[224:227]
v_mfma_f32_16x16x32_bf16 v[228:231], v[76:79], a[148:151], v[228:231]
v_mfma_f32_16x16x32_bf16 v[224:227], v[80:83], a[152:155], v[224:227]
buffer_load_dword v24, v22, s[4:7], 0 offen sc1
v_mfma_f32_16x16x32_bf16 v[228:231], v[84:87], a[152:155], v[228:231]
v_cvt_pk_bf16_f32 v52, v216, v217
v_cvt_pk_bf16_f32 v53, v218, v219
v_mfma_f32_16x16x32_bf16 v[224:227], v[88:91], a[156:159], v[224:227]
s_waitcnt vmcnt(11)
s_barrier
v_mfma_f32_16x16x32_bf16 v[228:231], v[92:95], a[156:159], v[228:231]
buffer_store_dword v27, v45, s[4:7], s79 offen
v_mfma_f32_16x16x32_bf16 v[224:227], v[96:99], a[160:163], v[224:227]
buffer_store_dword v27, v44, s[4:7], s79 offen sc1
v_mfma_f32_16x16x32_bf16 v[228:231], v[100:103], a[160:163], v[228:231]
v_cvt_pk_bf16_f32 v54, v220, v221
v_cvt_pk_bf16_f32 v55, v222, v223
v_mfma_f32_16x16x32_bf16 v[224:227], v[104:107], a[164:167], v[224:227]
buffer_store_dwordx4 v[52:55], v20, s[4:7], s87 offen sc1
v_mfma_f32_16x16x32_bf16 v[228:231], v[108:111], a[164:167], v[228:231]
v_mfma_f32_16x16x32_bf16 v[224:227], v[112:115], a[168:171], v[224:227]
v_mfma_f32_16x16x32_bf16 v[228:231], v[116:119], a[168:171], v[228:231]
v_mfma_f32_16x16x32_bf16 v[224:227], v[120:123], a[172:175], v[224:227]
v_mfma_f32_16x16x32_bf16 v[228:231], v[124:127], a[172:175], v[228:231]
v_mfma_f32_16x16x32_bf16 v[224:227], v[128:131], a[176:179], v[224:227]
v_mfma_f32_16x16x32_bf16 v[228:231], v[132:135], a[176:179], v[228:231]
v_mfma_f32_16x16x32_bf16 v[224:227], v[136:139], a[180:183], v[224:227]
v_mfma_f32_16x16x32_bf16 v[228:231], v[140:143], a[180:183], v[228:231]
v_mfma_f32_16x16x32_bf16 v[224:227], v[144:147], a[184:187], v[224:227]
v_mfma_f32_16x16x32_bf16 v[228:231], v[148:151], a[184:187], v[228:231]
v_mfma_f32_16x16x32_bf16 v[224:227], v[152:155], a[188:191], v[224:227]
v_mfma_f32_16x16x32_bf16 v[228:231], v[156:159], a[188:191], v[228:231]
v_mfma_f32_16x16x32_bf16 v[224:227], v[160:163], a[192:195], v[224:227]
s_waitcnt vmcnt(12)
s_barrier
v_mfma_f32_16x16x32_bf16 v[228:231], v[164:167], a[192:195], v[228:231]
v_mfma_f32_16x16x32_bf16 v[224:227], v[168:171], a[196:199], v[224:227]
s_cmp_eq_u32 s94, 0
s_cbranch_scc1 g_slow_30
v_mfma_f32_16x16x32_bf16 v[228:231], v[172:175], a[196:199], v[228:231]
ds_read_b128 v[64:67], v31 offset:0
v_mfma_f32_16x16x32_bf16 v[224:227], v[176:179], a[200:203], v[224:227]
ds_read_b128 v[68:71], v31 offset:9216
v_mfma_f32_16x16x32_bf16 v[228:231], v[180:183], a[200:203], v[228:231]
ds_read_b128 v[72:75], v31 offset:18432
v_mfma_f32_16x16x32_bf16 v[224:227], v[184:187], a[204:207], v[224:227]
ds_read_b128 v[76:79], v31 offset:27648
v_mfma_f32_16x16x32_bf16 v[228:231], v[188:191], a[204:207], v[228:231]
ds_read_b128 v[80:83], v31 offset:1024
v_mfma_f32_16x16x32_bf16 v[224:227], v[192:195], a[208:211], v[224:227]
ds_read_b128 v[84:87], v31 offset:10240
v_mfma_f32_16x16x32_bf16 v[228:231], v[196:199], a[208:211], v[228:231]
ds_read_b128 v[88:91], v31 offset:19456
v_mfma_f32_16x16x32_bf16 v[224:227], v[200:203], a[212:215], v[224:227]
ds_read_b128 v[92:95], v31 offset:28672
v_mfma_f32_16x16x32_bf16 v[228:231], v[204:207], a[212:215], v[228:231]
s_waitcnt vmcnt(8)
s_barrier
g_body_19:
s_waitcnt lgkmcnt(4)
v_mfma_f32_16x16x32_bf16 v[208:211], v[64:67], a[0:3], 0
ds_read_b128 v[96:99], v31 offset:2048
v_mfma_f32_16x16x32_bf16 v[212:215], v[68:71], a[0:3], 0
ds_read_b128 v[100:103], v31 offset:11264
v_mfma_f32_16x16x32_bf16 v[216:219], v[64:67], a[72:75], 0
v_mfma_f32_16x16x32_bf16 v[208:211], v[72:75], a[4:7], v[208:211]
ds_read_b128 v[104:107], v31 offset:20480
v_cvt_pk_bf16_f32 v56, v224, v225
v_mfma_f32_16x16x32_bf16 v[212:215], v[76:79], a[4:7], v[212:215]
ds_read_b128 v[108:111], v31 offset:29696
v_cvt_pk_bf16_f32 v57, v226, v227
v_mfma_f32_16x16x32_bf16 v[220:223], v[68:71], a[72:75], 0
v_cvt_pk_bf16_f32 v58, v228, v229
s_waitcnt lgkmcnt(4)
v_mfma_f32_16x16x32_bf16 v[208:211], v[80:83], a[8:11], v[208:211]
ds_read_b128 v[112:115], v31 offset:3072
v_cvt_pk_bf16_f32 v59, v230, v231
v_mfma_f32_16x16x32_bf16 v[212:215], v[84:87], a[8:11], v[212:215]
ds_read_b128 v[116:119], v31 offset:12288
v_mfma_f32_16x16x32_bf16 v[216:219], v[72:75], a[76:79], v[216:219]
buffer_store_dwordx4 v[56:59], v21, s[4:7], s87 offen sc1
v_mfma_f32_16x16x32_bf16 v[208:211], v[88:91], a[12:15], v[208:211]
ds_read_b128 v[120:123], v31 offset:21504
v_mov_b32 v27, s84
v_mfma_f32_16x16x32_bf16 v[212:215], v[92:95], a[12:15], v[212:215]
ds_read_b128 v[124:127], v31 offset:30720
v_mfma_f32_16x16x32_bf16 v[220:223], v[76:79], a[76:79], v[220:223]
s_waitcnt lgkmcnt(4)
v_mfma_f32_16x16x32_bf16 v[208:211], v[96:99], a[16:19], v[208:211]
ds_read_b128 v[128:131], v31 offset:4096
v_mfma_f32_16x16x32_bf16 v[212:215], v[100:103], a[16:19], v[212:215]
ds_read_b128 v[132:135], v31 offset:13312
v_mfma_f32_16x16x32_bf16 v[216:219], v[80:83], a[80:83], v[216:219]
v_mfma_f32_16x16x32_bf16 v[208:211], v[104:107], a[20:23], v[208:211]
ds_read_b128 v[136:139], v31 offset:22528
v_mfma_f32_16x16x32_bf16 v[212:215], v[108:111], a[20:23], v[212:215]
ds_read_b128 v[140:143], v31 offset:31744
v_mfma_f32_16x16x32_bf16 v[220:223], v[84:87], a[80:83], v[220:223]
s_waitcnt lgkmcnt(4)
v_mfma_f32_16x16x32_bf16 v[208:211], v[112:115], a[24:27], v[208:211]
ds_read_b128 v[144:147], v31 offset:5120
v_mfma_f32_16x16x32_bf16 v[212:215], v[116:119], a[24:27], v[212:215]
ds_read_b128 v[148:151], v31 offset:14336
v_mfma_f32_16x16x32_bf16 v[216:219], v[88:91], a[84:87], v[216:219]
v_mfma_f32_16x16x32_bf16 v[208:211], v[120:123], a[28:31], v[208:211]
ds_read_b128 v[152:155], v31 offset:23552
v_mfma_f32_16x16x32_bf16 v[212:215], v[124:127], a[28:31], v[212:215]
ds_read_b128 v[156:159], v31 offset:32768
v_mfma_f32_16x16x32_bf16 v[220:223], v[92:95], a[84:87], v[220:223]
s_waitcnt vmcnt(5)
s_barrier
s_waitcnt lgkmcnt(4)
v_mfma_f32_16x16x32_bf16 v[208:211], v[128:131], a[32:35], v[208:211]
ds_read_b128 v[160:163], v31 offset:6144
v_mfma_f32_16x16x32_bf16 v[212:215], v[132:135], a[32:35], v[212:215]
ds_read_b128 v[164:167], v31 offset:15360
s_waitcnt vmcnt(4)
ds_write_b32 v18, v24
v_mfma_f32_16x16x32_bf16 v[216:219], v[96:99], a[88:91], v[216:219]
v_mfma_f32_16x16x32_bf16 v[208:211], v[136:139], a[36:39], v[208:211]
ds_read_b128 v[168:171], v31 offset:24576
v_mfma_f32_16x16x32_bf16 v[212:215], v[140:143], a[36:39], v[212:215]
ds_read_b128 v[172:175], v31 offset:33792
s_waitcnt lgkmcnt(2)
s_barrier
v_mfma_f32_16x16x32_bf16 v[220:223], v[100:103], a[88:91], v[220:223]
ds_read_b32 v33, v32
v_mfma_f32_16x16x32_bf16 v[208:211], v[144:147], a[40:43], v[208:211]
ds_read_b128 v[176:179], v31 offset:7168
v_mfma_f32_16x16x32_bf16 v[212:215], v[148:151], a[40:43], v[212:215]
ds_read_b128 v[180:183], v31 offset:16384
v_mfma_f32_16x16x32_bf16 v[216:219], v[104:107], a[92:95], v[216:219]
s_waitcnt lgkmcnt(2)
v_cmp_gt_u32 vcc, s52, v33
v_mfma_f32_16x16x32_bf16 v[208:211], v[152:155], a[44:47], v[208:211]
ds_read_b128 v[184:187], v31 offset:25600
v_cmp_gt_u32 s[58:59], s54, v33
v_mfma_f32_16x16x32_bf16 v[212:215], v[156:159], a[44:47], v[212:215]
ds_read_b128 v[188:191], v31 offset:34816
s_and_b32 vcc_lo, vcc_lo, s56
s_cselect_b32 s70, 0, 1
v_mfma_f32_16x16x32_bf16 v[220:223], v[108:111], a[92:95], v[220:223]
s_and_b32 s59, s59, s56
s_cselect_b32 s71, 0, s95
v_mfma_f32_16x16x32_bf16 v[208:211], v[160:163], a[48:51], v[208:211]
ds_read_b128 v[192:195], v31 offset:8192
s_or_b32 s76, s70, s71
s_cselect_b32 s10, 268435456, 0
v_mfma_f32_16x16x32_bf16 v[212:215], v[164:167], a[48:51], v[212:215]
ds_read_b128 v[196:199], v31 offset:17408
v_mfma_f32_16x16x32_bf16 v[216:219], v[112:115], a[96:99], v[216:219]
s_cmp_lg_u32 s70, 0
s_cselect_b64 s[72:73], s[52:53], s[54:55]
s_cselect_b64 s[58:59], s[44:45], s[46:47]
s_mul_i32 s74, s72, s20
v_mfma_f32_16x16x32_bf16 v[208:211], v[168:171], a[52:55], v[208:211]
ds_read_b128 v[200:203], v31 offset:26624
s_add_u32 s74, s74, s58
v_mfma_f32_16x16x32_bf16 v[212:215], v[172:175], a[52:55], v[212:215]
ds_read_b128 v[204:207], v31 offset:35840
s_add_u32 m0, s48, 0
v_mfma_f32_16x16x32_bf16 v[220:223], v[116:119], a[96:99], v[220:223]
buffer_load_dwordx4 v8, s[8:11], s74 offen offset:0 sc1 lds
s_waitcnt lgkmcnt(4)
v_mfma_f32_16x16x32_bf16 v[208:211], v[176:179], a[56:59], v[208:211]
s_mul_i32 s75, s72, s21
s_add_u32 s75, s75, s59
s_andn2_b32 s71, s71, s70
v_mfma_f32_16x16x32_bf16 v[212:215], v[180:183], a[56:59], v[212:215]
s_add_u32 s52, s52, s70
s_add_u32 s54, s54, s71
s_mov_b32 s77, s76
v_mfma_f32_16x16x32_bf16 v[216:219], v[120:123], a[100:103], v[216:219]
buffer_load_dwordx4 v9, s[8:11], s74 offen offset:1024 sc1 lds
v_mfma_f32_16x16x32_bf16 v[208:211], v[184:187], a[60:63], v[208:211]
v_mfma_f32_16x16x32_bf16 v[212:215], v[188:191], a[60:63], v[212:215]
v_mfma_f32_16x16x32_bf16 v[220:223], v[124:127], a[100:103], v[220:223]
buffer_load_dwordx4 v10, s[8:11], s74 offen offset:2048 sc1 lds
s_waitcnt lgkmcnt(0)
v_mfma_f32_16x16x32_bf16 v[208:211], v[192:195], a[64:67], v[208:211]
v_mfma_f32_16x16x32_bf16 v[212:215], v[196:199], a[64:67], v[212:215]
v_mfma_f32_16x16x32_bf16 v[216:219], v[128:131], a[104:107], v[216:219]
buffer_load_dwordx4 v11, s[8:11], s74 offen offset:3072 sc1 lds
v_mfma_f32_16x16x32_bf16 v[208:211], v[200:203], a[68:71], v[208:211]
v_mfma_f32_16x16x32_bf16 v[212:215], v[204:207], a[68:71], v[212:215]
s_add_u32 m0, s48, 4096
v_mfma_f32_16x16x32_bf16 v[220:223], v[132:135], a[104:107], v[220:223]
buffer_load_dwordx4 v12, s[8:11], s74 offen offset:0 sc1 lds
v_mfma_f32_16x16x32_bf16 v[216:219], v[136:139], a[108:111], v[216:219]
v_mfma_f32_16x16x32_bf16 v[220:223], v[140:143], a[108:111], v[220:223]
v_mfma_f32_16x16x32_bf16 v[216:219], v[144:147], a[112:115], v[216:219]
buffer_load_dwordx4 v13, s[8:11], s74 offen offset:1024 sc1 lds
v_mfma_f32_16x16x32_bf16 v[220:223], v[148:151], a[112:115], v[220:223]
v_mfma_f32_16x16x32_bf16 v[216:219], v[152:155], a[116:119], v[216:219]
v_cvt_pk_bf16_f32 v48, v208, v209
v_cvt_pk_bf16_f32 v49, v210, v211
v_mfma_f32_16x16x32_bf16 v[220:223], v[156:159], a[116:119], v[220:223]
buffer_load_dwordx4 v14, s[8:11], s74 offen offset:2048 sc1 lds
v_mfma_f32_16x16x32_bf16 v[216:219], v[160:163], a[120:123], v[216:219]
v_cvt_pk_bf16_f32 v50, v212, v213
v_cvt_pk_bf16_f32 v51, v214, v215
v_mfma_f32_16x16x32_bf16 v[220:223], v[164:167], a[120:123], v[220:223]
buffer_store_dwordx4 v[48:51], v19, s[4:7], s93 offen sc1
v_mfma_f32_16x16x32_bf16 v[216:219], v[168:171], a[124:127], v[216:219]
buffer_load_dwordx4 v15, s[8:11], s74 offen offset:3072 sc1 lds
v_mfma_f32_16x16x32_bf16 v[220:223], v[172:175], a[124:127], v[220:223]
v_mfma_f32_16x16x32_bf16 v[216:219], v[176:179], a[128:131], v[216:219]
s_add_u32 m0, s48, 8192
v_mfma_f32_16x16x32_bf16 v[220:223], v[180:183], a[128:131], v[220:223]
buffer_load_dwordx4 v16, s[8:11], s74 offen offset:0 sc1 lds
v_mfma_f32_16x16x32_bf16 v[216:219], v[184:187], a[132:135], v[216:219]
v_mfma_f32_16x16x32_bf16 v[220:223], v[188:191], a[132:135], v[220:223]
v_mfma_f32_16x16x32_bf16 v[216:219], v[192:195], a[136:139], v[216:219]
v_mfma_f32_16x16x32_bf16 v[220:223], v[196:199], a[136:139], v[220:223]
v_mfma_f32_16x16x32_bf16 v[216:219], v[200:203], a[140:143], v[216:219]
v_mfma_f32_16x16x32_bf16 v[220:223], v[204:207], a[140:143], v[220:223]
v_mfma_f32_16x16x32_bf16 v[224:227], v[64:67], a[144:147], 0
v_mfma_f32_16x16x32_bf16 v[228:231], v[68:71], a[144:147], 0
v_mfma_f32_16x16x32_bf16 v[224:227], v[72:75], a[148:151], v[224:227]
v_mfma_f32_16x16x32_bf16 v[228:231], v[76:79], a[148:151], v[228:231]
v_mfma_f32_16x16x32_bf16 v[224:227], v[80:83], a[152:155], v[224:227]
buffer_load_dword v24, v22, s[4:7], 0 offen sc1
v_mfma_f32_16x16x32_bf16 v[228:231], v[84:87], a[152:155], v[228:231]
v_cvt_pk_bf16_f32 v52, v216, v217
v_cvt_pk_bf16_f32 v53, v218, v219
v_mfma_f32_16x16x32_bf16 v[224:227], v[88:91], a[156:159], v[224:227]
s_waitcnt vmcnt(11)
s_barrier
v_mfma_f32_16x16x32_bf16 v[228:231], v[92:95], a[156:159], v[228:231]
buffer_store_dword v27, v45, s[4:7], s85 offen
v_mfma_f32_16x16x32_bf16 v[224:227], v[96:99], a[160:163], v[224:227]
buffer_store_dword v27, v44, s[4:7], s85 offen sc1
v_mfma_f32_16x16x32_bf16 v[228:231], v[100:103], a[160:163], v[228:231]
v_cvt_pk_bf16_f32 v54, v220, v221
v_cvt_pk_bf16_f32 v55, v222, v223
v_mfma_f32_16x16x32_bf16 v[224:227], v[104:107], a[164:167], v[224:227]
buffer_store_dwordx4 v[52:55], v20, s[4:7], s93 offen sc1
v_mfma_f32_16x16x32_bf16 v[228:231], v[108:111], a[164:167], v[228:231]
v_mfma_f32_16x16x32_bf16 v[224:227], v[112:115], a[168:171], v[224:227]
v_mfma_f32_16x16x32_bf16 v[228:231], v[116:119], a[168:171], v[228:231]
v_mfma_f32_16x16x32_bf16 v[224:227], v[120:123], a[172:175], v[224:227]
v_mfma_f32_16x16x32_bf16 v[228:231], v[124:127], a[172:175], v[228:231]
v_mfma_f32_16x16x32_bf16 v[224:227], v[128:131], a[176:179], v[224:227]
v_mfma_f32_16x16x32_bf16 v[228:231], v[132:135], a[176:179], v[228:231]
v_mfma_f32_16x16x32_bf16 v[224:227], v[136:139], a[180:183], v[224:227]
v_mfma_f32_16x16x32_bf16 v[228:231], v[140:143], a[180:183], v[228:231]
v_mfma_f32_16x16x32_bf16 v[224:227], v[144:147], a[184:187], v[224:227]
v_mfma_f32_16x16x32_bf16 v[228:231], v[148:151], a[184:187], v[228:231]
v_mfma_f32_16x16x32_bf16 v[224:227], v[152:155], a[188:191], v[224:227]
v_mfma_f32_16x16x32_bf16 v[228:231], v[156:159], a[188:191], v[228:231]
v_mfma_f32_16x16x32_bf16 v[224:227], v[160:163], a[192:195], v[224:227]
s_waitcnt vmcnt(12)
s_barrier
v_mfma_f32_16x16x32_bf16 v[228:231], v[164:167], a[192:195], v[228:231]
v_mfma_f32_16x16x32_bf16 v[224:227], v[168:171], a[196:199], v[224:227]
s_cmp_eq_u32 s76, 0
s_cbranch_scc1 g_slow_31
v_mfma_f32_16x16x32_bf16 v[228:231], v[172:175], a[196:199], v[228:231]
ds_read_b128 v[64:67], v28 offset:0
v_mfma_f32_16x16x32_bf16 v[224:227], v[176:179], a[200:203], v[224:227]
ds_read_b128 v[68:71], v28 offset:9216
v_mfma_f32_16x16x32_bf16 v[228:231], v[180:183], a[200:203], v[228:231]
ds_read_b128 v[72:75], v28 offset:18432
v_mfma_f32_16x16x32_bf16 v[224:227], v[184:187], a[204:207], v[224:227]
ds_read_b128 v[76:79], v28 offset:27648
v_mfma_f32_16x16x32_bf16 v[228:231], v[188:191], a[204:207], v[228:231]
ds_read_b128 v[80:83], v28 offset:1024
v_mfma_f32_16x16x32_bf16 v[224:227], v[192:195], a[208:211], v[224:227]
ds_read_b128 v[84:87], v28 offset:10240
v_mfma_f32_16x16x32_bf16 v[228:231], v[196:199], a[208:211], v[228:231]
ds_read_b128 v[88:91], v28 offset:19456
v_mfma_f32_16x16x32_bf16 v[224:227], v[200:203], a[212:215], v[224:227]
ds_read_b128 v[92:95], v28 offset:28672
v_mfma_f32_16x16x32_bf16 v[228:231], v[204:207], a[212:215], v[228:231]
s_waitcnt vmcnt(8)
s_barrier
s_branch g_body_16
g_slow_28:
v_mfma_f32_16x16x32_bf16 v[228:231], v[172:175], a[196:199], v[228:231]
v_mfma_f32_16x16x32_bf16 v[224:227], v[176:179], a[200:203], v[224:227]
v_mfma_f32_16x16x32_bf16 v[228:231], v[180:183], a[200:203], v[228:231]
v_mfma_f32_16x16x32_bf16 v[224:227], v[184:187], a[204:207], v[224:227]
v_mfma_f32_16x16x32_bf16 v[228:231], v[188:191], a[204:207], v[228:231]
v_mfma_f32_16x16x32_bf16 v[224:227], v[192:195], a[208:211], v[224:227]
v_mfma_f32_16x16x32_bf16 v[228:231], v[196:199], a[208:211], v[228:231]
v_mfma_f32_16x16x32_bf16 v[224:227], v[200:203], a[212:215], v[224:227]
v_mfma_f32_16x16x32_bf16 v[228:231], v[204:207], a[212:215], v[228:231]
s_nop 6
v_cvt_pk_bf16_f32 v56, v224, v225
v_cvt_pk_bf16_f32 v57, v226, v227
v_cvt_pk_bf16_f32 v58, v228, v229
v_cvt_pk_bf16_f32 v59, v230, v231
buffer_store_dwordx4 v[56:59], v21, s[4:7], s75 offen sc1
s_mov_b32 s75, 1879048192
s_waitcnt vmcnt(4)
ds_write_b32 v18, v24
s_waitcnt lgkmcnt(0)
s_barrier
ds_read_b32 v33, v32
s_waitcnt lgkmcnt(0)
v_cmp_gt_u32 vcc, s52, v33
v_cmp_gt_u32 s[58:59], s54, v33
s_and_b32 vcc_lo, vcc_lo, s56
s_cselect_b32 s70, 0, 1
s_and_b32 s59, s59, s56
s_cselect_b32 s71, 0, s77
s_or_b32 s82, s70, s71
s_cselect_b32 s10, 268435456, 0
s_cmp_lg_u32 s70, 0
s_cselect_b64 s[78:79], s[52:53], s[54:55]
s_cselect_b64 s[58:59], s[44:45], s[46:47]
s_mul_i32 s80, s78, s20
s_add_u32 s80, s80, s58
s_mul_i32 s81, s78, s21
s_add_u32 s81, s81, s59
s_andn2_b32 s71, s71, s70
s_add_u32 s52, s52, s70
s_add_u32 s54, s54, s71
s_mov_b32 s83, s82
s_cmp_lg_u32 s82, 0
s_cbranch_scc1 g_go_32
v_mov_b32 v27, s72
s_waitcnt vmcnt(0)
s_barrier
s_add_u32 s70, s52, s54
s_cmp_eq_u32 s70, 130
s_cbranch_scc1 g_fin_20
s_cmp_lg_u32 s3, 0
s_cbranch_scc1 sp_ok_34_j
s_mov_b32 s23, 0
buffer_load_dword v33, v22, s[4:7], 0 offen sc1
buffer_store_dword v27, v45, s[4:7], s73 offen
buffer_store_dword v27, v44, s[4:7], s73 offen sc1
s_waitcnt vmcnt(2)
s_branch sp_loop_33_e
sp_loop_33:
buffer_load_dword v33, v22, s[4:7], 0 offen sc1
s_add_u32 s23, s23, 1
s_cmp_gt_u32 s23, 150000
s_cbranch_scc1 sp_bad_35
s_waitcnt vmcnt(0)
sp_loop_33_e:
v_cmp_gt_u32 vcc, s52, v33
v_cmp_gt_u32 s[58:59], s54, v33
s_and_b32 vcc_lo, vcc_lo, s56
s_cbranch_scc0 sp_ok_34
s_cmp_gt_u32 s23, 4
s_cselect_b32 s70, 0, s56
s_cmp_lg_u32 s77, 0
s_cselect_b32 s70, 0, s70
s_or_b32 s59, s59, s70
s_and_b32 s59, s59, s56
s_cbranch_scc0 sp_ok_34
s_sleep 1
s_branch sp_loop_33
sp_bad_35:
s_mov_b32 s98, 1025
s_branch L_fail
sp_ok_34:
ds_write_b32 v18, v33
s_waitcnt lgkmcnt(0)
sp_ok_34_j:
s_barrier
ds_read_b32 v33, v32
s_waitcnt lgkmcnt(0)
s_mov_b32 s73, 1879048192
v_cmp_gt_u32 vcc, s52, v33
v_cmp_gt_u32 s[58:59], s54, v33
s_and_b32 vcc_lo, vcc_lo, s56
s_cselect_b32 s70, 0, 1
s_and_b32 s59, s59, s56
s_cselect_b32 s71, 0, 1
s_or_b32 s82, s70, s71
s_cselect_b32 s10, 268435456, 0
s_cmp_lg_u32 s70, 0
s_cselect_b64 s[78:79], s[52:53], s[54:55]
s_cselect_b64 s[58:59], s[44:45], s[46:47]
s_mul_i32 s80, s78, s20
s_add_u32 s80, s80, s58
s_mul_i32 s81, s78, s21
s_add_u32 s81, s81, s59
s_andn2_b32 s71, s71, s70
s_add_u32 s52, s52, s70
s_add_u32 s54, s54, s71
s_mov_b32 s83, s82
g_go_32:
s_add_u32 m0, s49, 0
s_nop 0
buffer_load_dwordx4 v8, s[4:7], s80 offen offset:0 sc1 lds
buffer_load_dwordx4 v9, s[4:7], s80 offen offset:1024 sc1 lds
buffer_load_dwordx4 v10, s[4:7], s80 offen offset:2048 sc1 lds
buffer_load_dwordx4 v11, s[4:7], s80 offen offset:3072 sc1 lds
s_add_u32 m0, s49, 4096
s_nop 0
buffer_load_dwordx4 v12, s[4:7], s80 offen offset:0 sc1 lds
buffer_load_dwordx4 v13, s[4:7], s80 offen offset:1024 sc1 lds
buffer_load_dwordx4 v14, s[4:7], s80 offen offset:2048 sc1 lds
buffer_load_dwordx4 v15, s[4:7], s80 offen offset:3072 sc1 lds
s_add_u32 m0, s49, 8192
s_nop 0
buffer_load_dwordx4 v16, s[4:7], s80 offen offset:0 sc1 lds
buffer_load_dword v24, v22, s[4:7], 0 offen sc1
buffer_store_dword v27, v34, s[4:7], 0 offen
v_mov_b32 v27, s72
s_waitcnt vmcnt(9)
s_barrier
buffer_store_dword v27, v45, s[4:7], s73 offen
buffer_store_dword v27, v44, s[4:7], s73 offen sc1
s_mov_b32 s73, 1879048192
ds_read_b128 v[64:67], v29 offset:0
ds_read_b128 v[68:71], v29 offset:9216
ds_read_b128 v[72:75], v29 offset:18432
ds_read_b128 v[76:79], v29 offset:27648
ds_read_b128 v[80:83], v29 offset:1024
ds_read_b128 v[84:87], v29 offset:10240
ds_read_b128 v[88:91], v29 offset:19456
ds_read_b128 v[92:95], v29 offset:28672
s_waitcnt vmcnt(7)
s_barrier
s_branch g_body_17
g_slow_29:
v_mfma_f32_16x16x32_bf16 v[228:231], v[172:175], a[196:199], v[228:231]
v_mfma_f32_16x16x32_bf16 v[224:227], v[176:179], a[200:203], v[224:227]
v_mfma_f32_16x16x32_bf16 v[228:231], v[180:183], a[200:203], v[228:231]
v_mfma_f32_16x16x32_bf16 v[224:227], v[184:187], a[204:207], v[224:227]
v_mfma_f32_16x16x32_bf16 v[228:231], v[188:191], a[204:207], v[228:231]
v_mfma_f32_16x16x32_bf16 v[224:227], v[192:195], a[208:211], v[224:227]
v_mfma_f32_16x16x32_bf16 v[228:231], v[196:199], a[208:211], v[228:231]
v_mfma_f32_16x16x32_bf16 v[224:227], v[200:203], a[212:215], v[224:227]
v_mfma_f32_16x16x32_bf16 v[228:231], v[204:207], a[212:215], v[228:231]
s_nop 6
v_cvt_pk_bf16_f32 v56, v224, v225
v_cvt_pk_bf16_f32 v57, v226, v227
v_cvt_pk_bf16_f32 v58, v228, v229
v_cvt_pk_bf16_f32 v59, v230, v231
buffer_store_dwordx4 v[56:59], v21, s[4:7], s81 offen sc1
s_mov_b32 s81, 1879048192
s_waitcnt vmcnt(4)
ds_write_b32 v18, v24
s_waitcnt lgkmcnt(0)
s_barrier
ds_read_b32 v33, v32
s_waitcnt lgkmcnt(0)
v_cmp_gt_u32 vcc, s52, v33
v_cmp_gt_u32 s[58:59], s54, v33
s_and_b32 vcc_lo, vcc_lo, s56
s_cselect_b32 s70, 0, 1
s_and_b32 s59, s59, s56
s_cselect_b32 s71, 0, s83
s_or_b32 s88, s70, s71
s_cselect_b32 s10, 268435456, 0
s_cmp_lg_u32 s70, 0
s_cselect_b64 s[84:85], s[52:53], s[54:55]
s_cselect_b64 s[58:59], s[44:45], s[46:47]
s_mul_i32 s86, s84, s20
s_add_u32 s86, s86, s58
s_mul_i32 s87, s84, s21
s_add_u32 s87, s87, s59
s_andn2_b32 s71, s71, s70
s_add_u32 s52, s52, s70
s_add_u32 s54, s54, s71
s_mov_b32 s89, s88
s_cmp_lg_u32 s88, 0
s_cbranch_scc1 g_go_36
v_mov_b32 v27, s78
s_waitcnt vmcnt(0)
s_barrier
s_add_u32 s70, s52, s54
s_cmp_eq_u32 s70, 130
s_cbranch_scc1 g_fin_20
s_cmp_lg_u32 s3, 0
s_cbranch_scc1 sp_ok_38_j
s_mov_b32 s23, 0
buffer_load_dword v33, v22, s[4:7], 0 offen sc1
buffer_store_dword v27, v45, s[4:7], s79 offen
buffer_store_dword v27, v44, s[4:7], s79 offen sc1
s_waitcnt vmcnt(2)
s_branch sp_loop_37_e
sp_loop_37:
buffer_load_dword v33, v22, s[4:7], 0 offen sc1
s_add_u32 s23, s23, 1
s_cmp_gt_u32 s23, 150000
s_cbranch_scc1 sp_bad_39
s_waitcnt vmcnt(0)
sp_loop_37_e:
v_cmp_gt_u32 vcc, s52, v33
v_cmp_gt_u32 s[58:59], s54, v33
s_and_b32 vcc_lo, vcc_lo, s56
s_cbranch_scc0 sp_ok_38
s_cmp_gt_u32 s23, 4
s_cselect_b32 s70, 0, s56
s_cmp_lg_u32 s83, 0
s_cselect_b32 s70, 0, s70
s_or_b32 s59, s59, s70
s_and_b32 s59, s59, s56
s_cbranch_scc0 sp_ok_38
s_sleep 1
s_branch sp_loop_37
sp_bad_39:
s_mov_b32 s98, 1025
s_branch L_fail
sp_ok_38:
ds_write_b32 v18, v33
s_waitcnt lgkmcnt(0)
sp_ok_38_j:
s_barrier
ds_read_b32 v33, v32
s_waitcnt lgkmcnt(0)
s_mov_b32 s79, 1879048192
v_cmp_gt_u32 vcc, s52, v33
v_cmp_gt_u32 s[58:59], s54, v33
s_and_b32 vcc_lo, vcc_lo, s56
s_cselect_b32 s70, 0, 1
s_and_b32 s59, s59, s56
s_cselect_b32 s71, 0, 1
s_or_b32 s88, s70, s71
s_cselect_b32 s10, 268435456, 0
s_cmp_lg_u32 s70, 0
s_cselect_b64 s[84:85], s[52:53], s[54:55]
s_cselect_b64 s[58:59], s[44:45], s[46:47]
s_mul_i32 s86, s84, s20
s_add_u32 s86, s86, s58
s_mul_i32 s87, s84, s21
s_add_u32 s87, s87, s59
s_andn2_b32 s71, s71, s70
s_add_u32 s52, s52, s70
s_add_u32 s54, s54, s71
s_mov_b32 s89, s88
g_go_36:
s_add_u32 m0, s50, 0
s_nop 0
buffer_load_dwordx4 v8, s[4:7], s86 offen offset:0 sc1 lds
buffer_load_dwordx4 v9, s[4:7], s86 offen offset:1024 sc1 lds
buffer_load_dwordx4 v10, s[4:7], s86 offen offset:2048 sc1 lds
buffer_load_dwordx4 v11, s[4:7], s86 offen offset:3072 sc1 lds
s_add_u32 m0, s50, 4096
s_nop 0
buffer_load_dwordx4 v12, s[4:7], s86 offen offset:0 sc1 lds
buffer_load_dwordx4 v13, s[4:7], s86 offen offset:1024 sc1 lds
buffer_load_dwordx4 v14, s[4:7], s86 offen offset:2048 sc1 lds
buffer_load_dwordx4 v15, s[4:7], s86 offen offset:3072 sc1 lds
s_add_u32 m0, s50, 8192
s_nop 0
buffer_load_dwordx4 v16, s[4:7], s86 offen offset:0 sc1 lds
buffer_load_dword v24, v22, s[4:7], 0 offen sc1
buffer_store_dword v27, v34, s[4:7], 0 offen
v_mov_b32 v27, s78
s_waitcnt vmcnt(9)
s_barrier
buffer_store_dword v27, v45, s[4:7], s79 offen
buffer_store_dword v27, v44, s[4:7], s79 offen sc1
s_mov_b32 s79, 1879048192
ds_read_b128 v[64:67], v30 offset:0
ds_read_b128 v[68:71], v30 offset:9216
ds_read_b128 v[72:75], v30 offset:18432
ds_read_b128 v[76:79], v30 offset:27648
ds_read_b128 v[80:83], v30 offset:1024
ds_read_b128 v[84:87], v30 offset:10240
ds_read_b128 v[88:91], v30 offset:19456
ds_read_b128 v[92:95], v30 offset:28672
s_waitcnt vmcnt(7)
s_barrier
s_branch g_body_18
g_slow_30:
v_mfma_f32_16x16x32_bf16 v[228:231], v[172:175], a[196:199], v[228:231]
v_mfma_f32_16x16x32_bf16 v[224:227], v[176:179], a[200:203], v[224:227]
v_mfma_f32_16x16x32_bf16 v[228:231], v[180:183], a[200:203], v[228:231]
v_mfma_f32_16x16x32_bf16 v[224:227], v[184:187], a[204:207], v[224:227]
v_mfma_f32_16x16x32_bf16 v[228:231], v[188:191], a[204:207], v[228:231]
v_mfma_f32_16x16x32_bf16 v[224:227], v[192:195], a[208:211], v[224:227]
v_mfma_f32_16x16x32_bf16 v[228:231], v[196:199], a[208:211], v[228:231]
v_mfma_f32_16x16x32_bf16 v[224:227], v[200:203], a[212:215], v[224:227]
v_mfma_f32_16x16x32_bf16 v[228:231], v[204:207], a[212:215], v[228:231]
s_nop 6
v_cvt_pk_bf16_f32 v56, v224, v225
v_cvt_pk_bf16_f32 v57, v226, v227
v_cvt_pk_bf16_f32 v58, v228, v229
v_cvt_pk_bf16_f32 v59, v230, v231
buffer_store_dwordx4 v[56:59], v21, s[4:7], s87 offen sc1
s_mov_b32 s87, 1879048192
s_waitcnt vmcnt(4)
ds_write_b32 v18, v24
s_waitcnt lgkmcnt(0)
s_barrier
ds_read_b32 v33, v32
s_waitcnt lgkmcnt(0)
v_cmp_gt_u32 vcc, s52, v33
v_cmp_gt_u32 s[58:59], s54, v33
s_and_b32 vcc_lo, vcc_lo, s56
s_cselect_b32 s70, 0, 1
s_and_b32 s59, s59, s56
s_cselect_b32 s71, 0, s89
s_or_b32 s94, s70, s71
s_cselect_b32 s10, 268435456, 0
s_cmp_lg_u32 s70, 0
s_cselect_b64 s[90:91], s[52:53], s[54:55]
s_cselect_b64 s[58:59], s[44:45], s[46:47]
s_mul_i32 s92, s90, s20
s_add_u32 s92, s92, s58
s_mul_i32 s93, s90, s21
s_add_u32 s93, s93, s59
s_andn2_b32 s71, s71, s70
s_add_u32 s52, s52, s70
s_add_u32 s54, s54, s71
s_mov_b32 s95, s94
s_cmp_lg_u32 s94, 0
s_cbranch_scc1 g_go_40
v_mov_b32 v27, s84
s_waitcnt vmcnt(0)
s_barrier
s_add_u32 s70, s52, s54
s_cmp_eq_u32 s70, 130
s_cbranch_scc1 g_fin_20
s_cmp_lg_u32 s3, 0
s_cbranch_scc1 sp_ok_42_j
s_mov_b32 s23, 0
buffer_load_dword v33, v22, s[4:7], 0 offen sc1
buffer_store_dword v27, v45, s[4:7], s85 offen
buffer_store_dword v27, v44, s[4:7], s85 offen sc1
s_waitcnt vmcnt(2)
s_branch sp_loop_41_e
sp_loop_41:
buffer_load_dword v33, v22, s[4:7], 0 offen sc1
s_add_u32 s23, s23, 1
s_cmp_gt_u32 s23, 150000
s_cbranch_scc1 sp_bad_43
s_waitcnt vmcnt(0)
sp_loop_41_e:
v_cmp_gt_u32 vcc, s52, v33
v_cmp_gt_u32 s[58:59], s54, v33
s_and_b32 vcc_lo, vcc_lo, s56
s_cbranch_scc0 sp_ok_42
s_cmp_gt_u32 s23, 4
s_cselect_b32 s70, 0, s56
s_cmp_lg_u32 s89, 0
s_cselect_b32 s70, 0, s70
s_or_b32 s59, s59, s70
s_and_b32 s59, s59, s56
s_cbranch_scc0 sp_ok_42
s_sleep 1
s_branch sp_loop_41
sp_bad_43:
s_mov_b32 s98, 1025
s_branch L_fail
sp_ok_42:
ds_write_b32 v18, v33
s_waitcnt lgkmcnt(0)
sp_ok_42_j:
s_barrier
ds_read_b32 v33, v32
s_waitcnt lgkmcnt(0)
s_mov_b32 s85, 1879048192
v_cmp_gt_u32 vcc, s52, v33
v_cmp_gt_u32 s[58:59], s54, v33
s_and_b32 vcc_lo, vcc_lo, s56
s_cselect_b32 s70, 0, 1
s_and_b32 s59, s59, s56
s_cselect_b32 s71, 0, 1
s_or_b32 s94, s70, s71
s_cselect_b32 s10, 268435456, 0
s_cmp_lg_u32 s70, 0
s_cselect_b64 s[90:91], s[52:53], s[54:55]
s_cselect_b64 s[58:59], s[44:45], s[46:47]
s_mul_i32 s92, s90, s20
s_add_u32 s92, s92, s58
s_mul_i32 s93, s90, s21
s_add_u32 s93, s93, s59
s_andn2_b32 s71, s71, s70
s_add_u32 s52, s52, s70
s_add_u32 s54, s54, s71
s_mov_b32 s95, s94
g_go_40:
s_add_u32 m0, s51, 0
s_nop 0
buffer_load_dwordx4 v8, s[4:7], s92 offen offset:0 sc1 lds
buffer_load_dwordx4 v9, s[4:7], s92 offen offset:1024 sc1 lds
buffer_load_dwordx4 v10, s[4:7], s92 offen offset:2048 sc1 lds
buffer_load_dwordx4 v11, s[4:7], s92 offen offset:3072 sc1 lds
s_add_u32 m0, s51, 4096
s_nop 0
buffer_load_dwordx4 v12, s[4:7], s92 offen offset:0 sc1 lds
buffer_load_dwordx4 v13, s[4:7], s92 offen offset:1024 sc1 lds
buffer_load_dwordx4 v14, s[4:7], s92 offen offset:2048 sc1 lds
buffer_load_dwordx4 v15, s[4:7], s92 offen offset:3072 sc1 lds
s_add_u32 m0, s51, 8192
s_nop 0
buffer_load_dwordx4 v16, s[4:7], s92 offen offset:0 sc1 lds
buffer_load_dword v24, v22, s[4:7], 0 offen sc1
buffer_store_dword v27, v34, s[4:7], 0 offen
v_mov_b32 v27, s84
s_waitcnt vmcnt(9)
s_barrier
buffer_store_dword v27, v45, s[4:7], s85 offen
buffer_store_dword v27, v44, s[4:7], s85 offen sc1
s_mov_b32 s85, 1879048192
ds_read_b128 v[64:67], v31 offset:0
ds_read_b128 v[68:71], v31 offset:9216
ds_read_b128 v[72:75], v31 offset:18432
ds_read_b128 v[76:79], v31 offset:27648
ds_read_b128 v[80:83], v31 offset:1024
ds_read_b128 v[84:87], v31 offset:10240
ds_read_b128 v[88:91], v31 offset:19456
ds_read_b128 v[92:95], v31 offset:28672
s_waitcnt vmcnt(7)
s_barrier
s_branch g_body_19
g_slow_31:
v_mfma_f32_16x16x32_bf16 v[228:231], v[172:175], a[196:199], v[228:231]
v_mfma_f32_16x16x32_bf16 v[224:227], v[176:179], a[200:203], v[224:227]
v_mfma_f32_16x16x32_bf16 v[228:231], v[180:183], a[200:203], v[228:231]
v_mfma_f32_16x16x32_bf16 v[224:227], v[184:187], a[204:207], v[224:227]
v_mfma_f32_16x16x32_bf16 v[228:231], v[188:191], a[204:207], v[228:231]
v_mfma_f32_16x16x32_bf16 v[224:227], v[192:195], a[208:211], v[224:227]
v_mfma_f32_16x16x32_bf16 v[228:231], v[196:199], a[208:211], v[228:231]
v_mfma_f32_16x16x32_bf16 v[224:227], v[200:203], a[212:215], v[224:227]
v_mfma_f32_16x16x32_bf16 v[228:231], v[204:207], a[212:215], v[228:231]
s_nop 6
v_cvt_pk_bf16_f32 v56, v224, v225
v_cvt_pk_bf16_f32 v57, v226, v227
v_cvt_pk_bf16_f32 v58, v228, v229
v_cvt_pk_bf16_f32 v59, v230, v231
buffer_store_dwordx4 v[56:59], v21, s[4:7], s93 offen sc1
s_mov_b32 s93, 1879048192
s_waitcnt vmcnt(4)
ds_write_b32 v18, v24
s_waitcnt lgkmcnt(0)
s_barrier
ds_read_b32 v33, v32
s_waitcnt lgkmcnt(0)
v_cmp_gt_u32 vcc, s52, v33
v_cmp_gt_u32 s[58:59], s54, v33
s_and_b32 vcc_lo, vcc_lo, s56
s_cselect_b32 s70, 0, 1
s_and_b32 s59, s59, s56
s_cselect_b32 s71, 0, s95
s_or_b32 s76, s70, s71
s_cselect_b32 s10, 268435456, 0
s_cmp_lg_u32 s70, 0
s_cselect_b64 s[72:73], s[52:53], s[54:55]
s_cselect_b64 s[58:59], s[44:45], s[46:47]
s_mul_i32 s74, s72, s20
s_add_u32 s74, s74, s58
s_mul_i32 s75, s72, s21
s_add_u32 s75, s75, s59
s_andn2_b32 s71, s71, s70
s_add_u32 s52, s52, s70
s_add_u32 s54, s54, s71
s_mov_b32 s77, s76
s_cmp_lg_u32 s76, 0
s_cbranch_scc1 g_go_44
v_mov_b32 v27, s90
s_waitcnt vmcnt(0)
s_barrier
s_add_u32 s70, s52, s54
s_cmp_eq_u32 s70, 130
s_cbranch_scc1 g_fin_20
s_cmp_lg_u32 s3, 0
s_cbranch_scc1 sp_ok_46_j
s_mov_b32 s23, 0
buffer_load_dword v33, v22, s[4:7], 0 offen sc1
buffer_store_dword v27, v45, s[4:7], s91 offen
buffer_store_dword v27, v44, s[4:7], s91 offen sc1
s_waitcnt vmcnt(2)
s_branch sp_loop_45_e
sp_loop_45:
buffer_load_dword v33, v22, s[4:7], 0 offen sc1
s_add_u32 s23, s23, 1
s_cmp_gt_u32 s23, 150000
s_cbranch_scc1 sp_bad_47
s_waitcnt vmcnt(0)
sp_loop_45_e:
v_cmp_gt_u32 vcc, s52, v33
v_cmp_gt_u32 s[58:59], s54, v33
s_and_b32 vcc_lo, vcc_lo, s56
s_cbranch_scc0 sp_ok_46
s_cmp_gt_u32 s23, 4
s_cselect_b32 s70, 0, s56
s_cmp_lg_u32 s95, 0
s_cselect_b32 s70, 0, s70
s_or_b32 s59, s59, s70
s_and_b32 s59, s59, s56
s_cbranch_scc0 sp_ok_46
s_sleep 1
s_branch sp_loop_45
sp_bad_47:
s_mov_b32 s98, 1025
s_branch L_fail
sp_ok_46:
ds_write_b32 v18, v33
s_waitcnt lgkmcnt(0)
sp_ok_46_j:
s_barrier
ds_read_b32 v33, v32
s_waitcnt lgkmcnt(0)
s_mov_b32 s91, 1879048192
v_cmp_gt_u32 vcc, s52, v33
v_cmp_gt_u32 s[58:59], s54, v33
s_and_b32 vcc_lo, vcc_lo, s56
s_cselect_b32 s70, 0, 1
s_and_b32 s59, s59, s56
s_cselect_b32 s71, 0, 1
s_or_b32 s76, s70, s71
s_cselect_b32 s10, 268435456, 0
s_cmp_lg_u32 s70, 0
s_cselect_b64 s[72:73], s[52:53], s[54:55]
s_cselect_b64 s[58:59], s[44:45], s[46:47]
s_mul_i32 s74, s72, s20
s_add_u32 s74, s74, s58
s_mul_i32 s75, s72, s21
s_add_u32 s75, s75, s59
s_andn2_b32 s71, s71, s70
s_add_u32 s52, s52, s70
s_add_u32 s54, s54, s71
s_mov_b32 s77, s76
g_go_44:
s_add_u32 m0, s48, 0
s_nop 0
buffer_load_dwordx4 v8, s[4:7], s74 offen offset:0 sc1 lds
buffer_load_dwordx4 v9, s[4:7], s74 offen offset:1024 sc1 lds
buffer_load_dwordx4 v10, s[4:7], s74 offen offset:2048 sc1 lds
buffer_load_dwordx4 v11, s[4:7], s74 offen offset:3072 sc1 lds
s_add_u32 m0, s48, 4096
s_nop 0
buffer_load_dwordx4 v12, s[4:7], s74 offen offset:0 sc1 lds
buffer_load_dwordx4 v13, s[4:7], s74 offen offset:1024 sc1 lds
buffer_load_dwordx4 v14, s[4:7], s74 offen offset:2048 sc1 lds
buffer_load_dwordx4 v15, s[4:7], s74 offen offset:3072 sc1 lds
s_add_u32 m0, s48, 8192
s_nop 0
buffer_load_dwordx4 v16, s[4:7], s74 offen offset:0 sc1 lds
buffer_load_dword v24, v22, s[4:7], 0 offen sc1
buffer_store_dword v27, v34, s[4:7], 0 offen
v_mov_b32 v27, s90
s_waitcnt vmcnt(9)
s_barrier
buffer_store_dword v27, v45, s[4:7], s91 offen
buffer_store_dword v27, v44, s[4:7], s91 offen sc1
s_mov_b32 s91, 1879048192
ds_read_b128 v[64:67], v28 offset:0
ds_read_b128 v[68:71], v28 offset:9216
ds_read_b128 v[72:75], v28 offset:18432
ds_read_b128 v[76:79], v28 offset:27648
ds_read_b128 v[80:83], v28 offset:1024
ds_read_b128 v[84:87], v28 offset:10240
ds_read_b128 v[88:91], v28 offset:19456
ds_read_b128 v[92:95], v28 offset:28672
s_waitcnt vmcnt(7)
s_barrier
s_branch g_body_16
g_fin_20:
buffer_store_dword v27, v45, s[4:7], s91 offen
buffer_store_dword v27, v44, s[4:7], s91 offen sc1
s_endpgm
G_ssv18:
s_mov_b32 s8, s42
s_and_b32 s9, s43, 0xffff
s_mov_b32 s10, 0
s_mov_b32 s11, 0x20000
s_mov_b32 s22, 0
s_mul_i32 s48, s3, 9216
s_add_u32 s49, s48, 36864
s_add_u32 s50, s48, 73728
s_add_u32 s51, s48, 110592
s_mov_b32 s57, 0xbfb8aa3b
v_add_u32 v28, 0, v17
v_add_u32 v29, 36864, v17
v_add_u32 v30, 73728, v17
v_add_u32 v31, 110592, v17
v_lshlrev_b32 v1, 2, v0
v_add_u32 v32, 147456, v1
s_lshl_b32 s70, s3, 8
v_add_u32 v18, s70, v32
v_mov_b64 v[224:225], 0
v_mov_b64 v[236:237], 0
v_mov_b64 v[226:227], 0
v_mov_b64 v[238:239], 0
v_mov_b64 v[228:229], 0
v_mov_b64 v[240:241], 0
v_mov_b64 v[230:231], 0
v_mov_b64 v[242:243], 0
s_mov_b32 s12, s40
s_and_b32 s13, s41, 0xffff
s_mov_b32 s14, 256
s_mov_b32 s15, 0x20000
v_lshlrev_b32 v26, 2, v0
v_add_u32 v27, 128, v26
v_cmp_le_u32 vcc, 2, v0
s_nop 1
v_cndmask_b32 v26, v26, v27, vcc
v_mov_b32 v27, 192
v_cmp_eq_u32 vcc, 8, v0
s_nop 1
v_cndmask_b32 v26, v26, v27, vcc
v_mov_b32 v27, 2147483632
v_cmp_lt_u32 vcc, 8, v0
s_nop 1
v_cndmask_b32 v26, v26, v27, vcc
s_mov_b32 s98, 0
wi_loop_53:
buffer_load_dword v27, v26, s[12:15], 0 offen sc1
s_add_u32 s98, s98, 1
s_cmp_gt_u32 s98, 150000
s_cbranch_scc1 wi_bad_55
s_waitcnt vmcnt(0)
v_cmp_eq_u32 vcc, 32, v27
s_nop 0
s_and_b32 s97, vcc_lo, 0x1ff
s_cmp_eq_u32 s97, 0x1ff
s_cbranch_scc1 wi_ok_54
v_cmp_lt_u32 vcc, 32, v27
s_nop 0
s_and_b32 s96, vcc_lo, 0xff
s_cselect_b32 s96, 0x100, 0
s_and_b32 s96, s96, s97
s_cbranch_scc1 wi_over_56
s_sleep 8
s_branch wi_loop_53
wi_bad_55:
s_mov_b32 s98, 512
s_branch L_fail
wi_over_56:
s_mov_b32 s100, 255
wi_ok_54:
v_add_u32 v26, 65536, v22
v_cmp_eq_u32 vcc, s100, v23
s_nop 1
v_cndmask_b32 v22, v22, v26, vcc
s_mov_b32 s90, 0
s_mov_b32 s91, 1879048192
s_mov_b32 s93, 1879048192
v_mov_b32 v34, 2147483632
s_barrier
s_mov_b32 s95, 1
s_cmp_lg_u32 s3, 0
s_cbranch_scc1 sp_ok_58_j
s_mov_b32 s23, 0
sp_loop_57:
buffer_load_dword v33, v22, s[4:7], 0 offen sc1
s_add_u32 s23, s23, 1
s_cmp_gt_u32 s23, 150000
s_cbranch_scc1 sp_bad_59
s_waitcnt vmcnt(0)
sp_loop_57_e:
v_cmp_gt_u32 vcc, s52, v33
v_cmp_gt_u32 s[58:59], s54, v33
s_and_b32 vcc_lo, vcc_lo, s56
s_cbranch_scc0 sp_ok_58
s_cmp_gt_u32 s23, 4
s_cselect_b32 s70, 0, s56
s_cmp_lg_u32 s95, 0
s_cselect_b32 s70, 0, s70
s_or_b32 s59, s59, s70
s_and_b32 s59, s59, s56
s_cbranch_scc0 sp_ok_58
s_sleep 1
s_branch sp_loop_57
sp_bad_59:
s_mov_b32 s98, 1026
s_branch L_fail
sp_ok_58:
ds_write_b32 v18, v33
s_waitcnt lgkmcnt(0)
sp_ok_58_j:
s_barrier
ds_read_b32 v33, v32
s_waitcnt lgkmcnt(0)
v_cmp_gt_u32 vcc, s52, v33
v_cmp_gt_u32 s[58:59], s54, v33
s_and_b32 vcc_lo, vcc_lo, s56
s_cselect_b32 s70, 0, 1
s_and_b32 s59, s59, s56
s_cselect_b32 s71, 0, 1
s_or_b32 s76, s70, s71
s_cselect_b32 s10, 268435456, 0
s_cmp_lg_u32 s70, 0
s_cselect_b64 s[72:73], s[52:53], s[54:55]
s_cselect_b64 s[58:59], s[44:45], s[46:47]
s_mul_i32 s74, s72, s20
s_add_u32 s74, s74, s58
s_mul_i32 s75, s72, s21
s_add_u32 s75, s75, s59
s_andn2_b32 s71, s71, s70
s_add_u32 s52, s52, s70
s_add_u32 s54, s54, s71
s_mov_b32 s77, s76
s_add_u32 m0, s48, 0
s_nop 0
buffer_load_dwordx4 v8, s[4:7], s74 offen offset:0 sc1 lds
buffer_load_dwordx4 v9, s[4:7], s74 offen offset:1024 sc1 lds
buffer_load_dwordx4 v10, s[4:7], s74 offen offset:2048 sc1 lds
buffer_load_dwordx4 v11, s[4:7], s74 offen offset:3072 sc1 lds
s_add_u32 m0, s48, 4096
s_nop 0
buffer_load_dwordx4 v12, s[4:7], s74 offen offset:0 sc1 lds
buffer_load_dwordx4 v13, s[4:7], s74 offen offset:1024 sc1 lds
buffer_load_dwordx4 v14, s[4:7], s74 offen offset:2048 sc1 lds
buffer_load_dwordx4 v15, s[4:7], s74 offen offset:3072 sc1 lds
s_add_u32 m0, s48, 8192
s_nop 0
buffer_load_dwordx4 v16, s[4:7], s74 offen offset:0 sc1 lds
buffer_load_dword v24, v22, s[4:7], 0 offen sc1
buffer_store_dword v27, v34, s[4:7], 0 offen
buffer_store_dword v27, v34, s[4:7], 0 offen
v_mov_b32 v27, s90
s_waitcnt vmcnt(10)
s_barrier
buffer_store_dword v27, v45, s[4:7], s91 offen
buffer_store_dword v27, v44, s[4:7], s91 offen sc1
s_mov_b32 s91, 1879048192
ds_read_b128 v[64:67], v28 offset:0
ds_read_b128 v[68:71], v28 offset:9216
ds_read_b128 v[72:75], v28 offset:18432
ds_read_b128 v[76:79], v28 offset:27648
ds_read_b128 v[80:83], v28 offset:1024
ds_read_b128 v[84:87], v28 offset:10240
ds_read_b128 v[88:91], v28 offset:19456
ds_read_b128 v[92:95], v28 offset:28672
s_waitcnt vmcnt(8)
s_barrier
s_branch g_body_48
g_body_48:
s_waitcnt lgkmcnt(4)
v_mfma_f32_16x16x32_bf16 v[208:211], a[0:3], v[64:67], 0
ds_read_b128 v[96:99], v28 offset:2048
v_mfma_f32_16x16x32_bf16 v[212:215], a[0:3], v[68:71], 0
ds_read_b128 v[100:103], v28 offset:11264
v_mfma_f32_16x16x32_bf16 v[216:219], a[72:75], v[64:67], 0
v_mfma_f32_16x16x32_bf16 v[208:211], a[4:7], v[72:75], v[208:211]
ds_read_b128 v[104:107], v28 offset:20480
v_cvt_pk_bf16_f32 v56, v224, v225
v_mfma_f32_16x16x32_bf16 v[212:215], a[4:7], v[76:79], v[212:215]
ds_read_b128 v[108:111], v28 offset:29696
v_cvt_pk_bf16_f32 v57, v226, v227
v_mfma_f32_16x16x32_bf16 v[220:223], a[72:75], v[68:71], 0
v_cvt_pk_bf16_f32 v58, v228, v229
s_waitcnt lgkmcnt(4)
v_mfma_f32_16x16x32_bf16 v[208:211], a[8:11], v[80:83], v[208:211]
ds_read_b128 v[112:115], v28 offset:3072
v_cvt_pk_bf16_f32 v59, v230, v231
v_mfma_f32_16x16x32_bf16 v[212:215], a[8:11], v[84:87], v[212:215]
ds_read_b128 v[116:119], v28 offset:12288
v_mfma_f32_16x16x32_bf16 v[216:219], a[76:79], v[72:75], v[216:219]
buffer_store_dwordx4 v[56:59], v21, s[4:7], s93 offen sc1
v_mfma_f32_16x16x32_bf16 v[208:211], a[12:15], v[88:91], v[208:211]
ds_read_b128 v[120:123], v28 offset:21504
v_mov_b32 v27, s90
v_mfma_f32_16x16x32_bf16 v[212:215], a[12:15], v[92:95], v[212:215]
ds_read_b128 v[124:127], v28 offset:30720
v_mfma_f32_16x16x32_bf16 v[220:223], a[76:79], v[76:79], v[220:223]
s_waitcnt lgkmcnt(4)
v_mfma_f32_16x16x32_bf16 v[208:211], a[16:19], v[96:99], v[208:211]
ds_read_b128 v[128:131], v28 offset:4096
v_mfma_f32_16x16x32_bf16 v[212:215], a[16:19], v[100:103], v[212:215]
ds_read_b128 v[132:135], v28 offset:13312
v_mfma_f32_16x16x32_bf16 v[216:219], a[80:83], v[80:83], v[216:219]
v_mfma_f32_16x16x32_bf16 v[208:211], a[20:23], v[104:107], v[208:211]
ds_read_b128 v[136:139], v28 offset:22528
v_mfma_f32_16x16x32_bf16 v[212:215], a[20:23], v[108:111], v[212:215]
ds_read_b128 v[140:143], v28 offset:31744
v_mfma_f32_16x16x32_bf16 v[220:223], a[80:83], v[84:87], v[220:223]
s_waitcnt lgkmcnt(4)
v_mfma_f32_16x16x32_bf16 v[208:211], a[24:27], v[112:115], v[208:211]
ds_read_b128 v[144:147], v28 offset:5120
v_mfma_f32_16x16x32_bf16 v[212:215], a[24:27], v[116:119], v[212:215]
ds_read_b128 v[148:151], v28 offset:14336
v_mfma_f32_16x16x32_bf16 v[216:219], a[84:87], v[88:91], v[216:219]
v_mfma_f32_16x16x32_bf16 v[208:211], a[28:31], v[120:123], v[208:211]
ds_read_b128 v[152:155], v28 offset:23552
v_mfma_f32_16x16x32_bf16 v[212:215], a[28:31], v[124:127], v[212:215]
ds_read_b128 v[156:159], v28 offset:32768
v_mfma_f32_16x16x32_bf16 v[220:223], a[84:87], v[92:95], v[220:223]
s_waitcnt vmcnt(6)
s_barrier
s_waitcnt lgkmcnt(4)
v_mfma_f32_16x16x32_bf16 v[208:211], a[32:35], v[128:131], v[208:211]
ds_read_b128 v[160:163], v28 offset:6144
v_mfma_f32_16x16x32_bf16 v[212:215], a[32:35], v[132:135], v[212:215]
ds_read_b128 v[164:167], v28 offset:15360
s_waitcnt vmcnt(4)
ds_write_b32 v18, v24
v_mfma_f32_16x16x32_bf16 v[216:219], a[88:91], v[96:99], v[216:219]
v_mfma_f32_16x16x32_bf16 v[208:211], a[36:39], v[136:139], v[208:211]
ds_read_b128 v[168:171], v28 offset:24576
v_mfma_f32_16x16x32_bf16 v[212:215], a[36:39], v[140:143], v[212:215]
ds_read_b128 v[172:175], v28 offset:33792
s_waitcnt lgkmcnt(2)
s_barrier
v_mfma_f32_16x16x32_bf16 v[220:223], a[88:91], v[100:103], v[220:223]
ds_read_b32 v33, v32
v_mfma_f32_16x16x32_bf16 v[208:211], a[40:43], v[144:147], v[208:211]
ds_read_b128 v[176:179], v28 offset:7168
v_mfma_f32_16x16x32_bf16 v[212:215], a[40:43], v[148:151], v[212:215]
ds_read_b128 v[180:183], v28 offset:16384
v_mfma_f32_16x16x32_bf16 v[216:219], a[92:95], v[104:107], v[216:219]
s_waitcnt lgkmcnt(2)
v_cmp_gt_u32 vcc, s52, v33
v_mfma_f32_16x16x32_bf16 v[208:211], a[44:47], v[152:155], v[208:211]
ds_read_b128 v[184:187], v28 offset:25600
v_cmp_gt_u32 s[58:59], s54, v33
v_mfma_f32_16x16x32_bf16 v[212:215], a[44:47], v[156:159], v[212:215]
ds_read_b128 v[188:191], v28 offset:34816
s_and_b32 vcc_lo, vcc_lo, s56
s_cselect_b32 s70, 0, 1
v_mfma_f32_16x16x32_bf16 v[220:223], a[92:95], v[108:111], v[220:223]
s_and_b32 s59, s59, s56
s_cselect_b32 s71, 0, s77
v_mfma_f32_16x16x32_bf16 v[208:211], a[48:51], v[160:163], v[208:211]
ds_read_b128 v[192:195], v28 offset:8192
s_or_b32 s82, s70, s71
s_cselect_b32 s10, 268435456, 0
v_mfma_f32_16x16x32_bf16 v[212:215], a[48:51], v[164:167], v[212:215]
ds_read_b128 v[196:199], v28 offset:17408
v_mfma_f32_16x16x32_bf16 v[216:219], a[96:99], v[112:115], v[216:219]
s_cmp_lg_u32 s70, 0
s_cselect_b64 s[78:79], s[52:53], s[54:55]
s_cselect_b64 s[58:59], s[44:45], s[46:47]
s_mul_i32 s80, s78, s20
v_mfma_f32_16x16x32_bf16 v[208:211], a[52:55], v[168:171], v[208:211]
ds_read_b128 v[200:203], v28 offset:26624
s_add_u32 s80, s80, s58
v_mfma_f32_16x16x32_bf16 v[212:215], a[52:55], v[172:175], v[212:215]
ds_read_b128 v[204:207], v28 offset:35840
s_add_u32 m0, s49, 0
v_mfma_f32_16x16x32_bf16 v[220:223], a[96:99], v[116:119], v[220:223]
buffer_load_dwordx4 v8, s[8:11], s80 offen offset:0 sc1 lds
s_waitcnt lgkmcnt(4)
v_mfma_f32_16x16x32_bf16 v[208:211], a[56:59], v[176:179], v[208:211]
s_mul_i32 s81, s78, s21
s_add_u32 s81, s81, s59
s_andn2_b32 s71, s71, s70
v_mfma_f32_16x16x32_bf16 v[212:215], a[56:59], v[180:183], v[212:215]
s_add_u32 s52, s52, s70
s_add_u32 s54, s54, s71
s_mov_b32 s83, s82
v_mfma_f32_16x16x32_bf16 v[216:219], a[100:103], v[120:123], v[216:219]
buffer_load_dwordx4 v9, s[8:11], s80 offen offset:1024 sc1 lds
v_mfma_f32_16x16x32_bf16 v[208:211], a[60:63], v[184:187], v[208:211]
v_mfma_f32_16x16x32_bf16 v[212:215], a[60:63], v[188:191], v[212:215]
v_mfma_f32_16x16x32_bf16 v[220:223], a[100:103], v[124:127], v[220:223]
buffer_load_dwordx4 v10, s[8:11], s80 offen offset:2048 sc1 lds
s_waitcnt lgkmcnt(0)
v_mfma_f32_16x16x32_bf16 v[208:211], a[64:67], v[192:195], v[208:211]
v_mfma_f32_16x16x32_bf16 v[212:215], a[64:67], v[196:199], v[212:215]
v_mfma_f32_16x16x32_bf16 v[216:219], a[104:107], v[128:131], v[216:219]
buffer_load_dwordx4 v11, s[8:11], s80 offen offset:3072 sc1 lds
v_mfma_f32_16x16x32_bf16 v[208:211], a[68:71], v[200:203], v[208:211]
v_mfma_f32_16x16x32_bf16 v[212:215], a[68:71], v[204:207], v[212:215]
s_add_u32 m0, s49, 4096
v_mfma_f32_16x16x32_bf16 v[220:223], a[104:107], v[132:135], v[220:223]
buffer_load_dwordx4 v12, s[8:11], s80 offen offset:0 sc1 lds
v_mfma_f32_16x16x32_bf16 v[216:219], a[108:111], v[136:139], v[216:219]
v_mfma_f32_16x16x32_bf16 v[220:223], a[108:111], v[140:143], v[220:223]
v_mfma_f32_16x16x32_bf16 v[216:219], a[112:115], v[144:147], v[216:219]
buffer_load_dwordx4 v13, s[8:11], s80 offen offset:1024 sc1 lds
v_mfma_f32_16x16x32_bf16 v[220:223], a[112:115], v[148:151], v[220:223]
v_mfma_f32_16x16x32_bf16 v[216:219], a[116:119], v[152:155], v[216:219]
v_cvt_pk_bf16_f32 v48, v208, v209
v_cvt_pk_bf16_f32 v49, v210, v211
v_mfma_f32_16x16x32_bf16 v[220:223], a[116:119], v[156:159], v[220:223]
buffer_load_dwordx4 v14, s[8:11], s80 offen offset:2048 sc1 lds
v_mfma_f32_16x16x32_bf16 v[216:219], a[120:123], v[160:163], v[216:219]
v_cvt_pk_bf16_f32 v50, v212, v213
v_cvt_pk_bf16_f32 v51, v214, v215
v_mfma_f32_16x16x32_bf16 v[220:223], a[120:123], v[164:167], v[220:223]
v_permlane16_swap_b32 v48, v50
v_mfma_f32_16x16x32_bf16 v[216:219], a[124:127], v[168:171], v[216:219]
buffer_load_dwordx4 v15, s[8:11], s80 offen offset:3072 sc1 lds
v_mfma_f32_16x16x32_bf16 v[220:223], a[124:127], v[172:175], v[220:223]
v_permlane16_swap_b32 v49, v51
v_mfma_f32_16x16x32_bf16 v[216:219], a[128:131], v[176:179], v[216:219]
s_add_u32 m0, s49, 8192
v_mfma_f32_16x16x32_bf16 v[220:223], a[128:131], v[180:183], v[220:223]
buffer_load_dwordx4 v16, s[8:11], s80 offen offset:0 sc1 lds
v_mfma_f32_16x16x32_bf16 v[216:219], a[132:135], v[184:187], v[216:219]
buffer_store_dwordx4 v[48:51], v19, s[4:7], s75 offen sc1
v_mfma_f32_16x16x32_bf16 v[220:223], a[132:135], v[188:191], v[220:223]
v_mfma_f32_16x16x32_bf16 v[216:219], a[136:139], v[192:195], v[216:219]
v_mfma_f32_16x16x32_bf16 v[220:223], a[136:139], v[196:199], v[220:223]
v_mfma_f32_16x16x32_bf16 v[216:219], a[140:143], v[200:203], v[216:219]
v_mfma_f32_16x16x32_bf16 v[220:223], a[140:143], v[204:207], v[220:223]
v_mfma_f32_16x16x32_bf16 v[224:227], v[64:67], a[144:147], 0
v_mfma_f32_16x16x32_bf16 v[228:231], v[68:71], a[144:147], 0
v_mfma_f32_16x16x32_bf16 v[224:227], v[72:75], a[148:151], v[224:227]
v_mfma_f32_16x16x32_bf16 v[228:231], v[76:79], a[148:151], v[228:231]
v_mfma_f32_16x16x32_bf16 v[224:227], v[80:83], a[152:155], v[224:227]
buffer_load_dword v24, v22, s[4:7], 0 offen sc1
v_mfma_f32_16x16x32_bf16 v[228:231], v[84:87], a[152:155], v[228:231]
v_cvt_pk_bf16_f32 v52, v216, v217
v_cvt_pk_bf16_f32 v53, v218, v219
v_mfma_f32_16x16x32_bf16 v[224:227], v[88:91], a[156:159], v[224:227]
s_waitcnt vmcnt(11)
s_barrier
v_mfma_f32_16x16x32_bf16 v[228:231], v[92:95], a[156:159], v[228:231]
buffer_store_dword v27, v45, s[4:7], s91 offen
v_mfma_f32_16x16x32_bf16 v[224:227], v[96:99], a[160:163], v[224:227]
buffer_store_dword v27, v44, s[4:7], s91 offen sc1
v_mfma_f32_16x16x32_bf16 v[228:231], v[100:103], a[160:163], v[228:231]
v_cvt_pk_bf16_f32 v54, v220, v221
v_cvt_pk_bf16_f32 v55, v222, v223
v_mfma_f32_16x16x32_bf16 v[224:227], v[104:107], a[164:167], v[224:227]
v_permlane16_swap_b32 v52, v54
v_mfma_f32_16x16x32_bf16 v[228:231], v[108:111], a[164:167], v[228:231]
v_permlane16_swap_b32 v53, v55
v_mfma_f32_16x16x32_bf16 v[224:227], v[112:115], a[168:171], v[224:227]
buffer_store_dwordx4 v[52:55], v20, s[4:7], s75 offen sc1
v_mfma_f32_16x16x32_bf16 v[228:231], v[116:119], a[168:171], v[228:231]
v_mfma_f32_16x16x32_bf16 v[224:227], v[120:123], a[172:175], v[224:227]
v_mfma_f32_16x16x32_bf16 v[228:231], v[124:127], a[172:175], v[228:231]
v_mfma_f32_16x16x32_bf16 v[224:227], v[128:131], a[176:179], v[224:227]
v_mfma_f32_16x16x32_bf16 v[228:231], v[132:135], a[176:179], v[228:231]
v_mfma_f32_16x16x32_bf16 v[224:227], v[136:139], a[180:183], v[224:227]
v_mfma_f32_16x16x32_bf16 v[228:231], v[140:143], a[180:183], v[228:231]
v_mfma_f32_16x16x32_bf16 v[224:227], v[144:147], a[184:187], v[224:227]
v_mfma_f32_16x16x32_bf16 v[228:231], v[148:151], a[184:187], v[228:231]
v_mfma_f32_16x16x32_bf16 v[224:227], v[152:155], a[188:191], v[224:227]
v_mfma_f32_16x16x32_bf16 v[228:231], v[156:159], a[188:191], v[228:231]
v_mfma_f32_16x16x32_bf16 v[224:227], v[160:163], a[192:195], v[224:227]
s_waitcnt vmcnt(12)
s_barrier
v_mfma_f32_16x16x32_bf16 v[228:231], v[164:167], a[192:195], v[228:231]
v_mfma_f32_16x16x32_bf16 v[224:227], v[168:171], a[196:199], v[224:227]
s_cmp_eq_u32 s82, 0
s_cbranch_scc1 g_slow_60
v_mfma_f32_16x16x32_bf16 v[228:231], v[172:175], a[196:199], v[228:231]
ds_read_b128 v[64:67], v29 offset:0
v_mfma_f32_16x16x32_bf16 v[224:227], v[176:179], a[200:203], v[224:227]
ds_read_b128 v[68:71], v29 offset:9216
v_mfma_f32_16x16x32_bf16 v[228:231], v[180:183], a[200:203], v[228:231]
ds_read_b128 v[72:75], v29 offset:18432
v_mfma_f32_16x16x32_bf16 v[224:227], v[184:187], a[204:207], v[224:227]
ds_read_b128 v[76:79], v29 offset:27648
v_mfma_f32_16x16x32_bf16 v[228:231], v[188:191], a[204:207], v[228:231]
ds_read_b128 v[80:83], v29 offset:1024
v_mfma_f32_16x16x32_bf16 v[224:227], v[192:195], a[208:211], v[224:227]
ds_read_b128 v[84:87], v29 offset:10240
v_mfma_f32_16x16x32_bf16 v[228:231], v[196:199], a[208:211], v[228:231]
ds_read_b128 v[88:91], v29 offset:19456
v_mfma_f32_16x16x32_bf16 v[224:227], v[200:203], a[212:215], v[224:227]
ds_read_b128 v[92:95], v29 offset:28672
v_mfma_f32_16x16x32_bf16 v[228:231], v[204:207], a[212:215], v[228:231]
s_waitcnt vmcnt(8)
s_barrier
g_body_49:
s_waitcnt lgkmcnt(4)
v_mfma_f32_16x16x32_bf16 v[208:211], a[0:3], v[64:67], 0
ds_read_b128 v[96:99], v29 offset:2048
v_mfma_f32_16x16x32_bf16 v[212:215], a[0:3], v[68:71], 0
ds_read_b128 v[100:103], v29 offset:11264
v_mfma_f32_16x16x32_bf16 v[216:219], a[72:75], v[64:67], 0
v_mfma_f32_16x16x32_bf16 v[208:211], a[4:7], v[72:75], v[208:211]
ds_read_b128 v[104:107], v29 offset:20480
v_cvt_pk_bf16_f32 v56, v224, v225
v_mfma_f32_16x16x32_bf16 v[212:215], a[4:7], v[76:79], v[212:215]
ds_read_b128 v[108:111], v29 offset:29696
v_cvt_pk_bf16_f32 v57, v226, v227
v_mfma_f32_16x16x32_bf16 v[220:223], a[72:75], v[68:71], 0
v_cvt_pk_bf16_f32 v58, v228, v229
s_waitcnt lgkmcnt(4)
v_mfma_f32_16x16x32_bf16 v[208:211], a[8:11], v[80:83], v[208:211]
ds_read_b128 v[112:115], v29 offset:3072
v_cvt_pk_bf16_f32 v59, v230, v231
v_mfma_f32_16x16x32_bf16 v[212:215], a[8:11], v[84:87], v[212:215]
ds_read_b128 v[116:119], v29 offset:12288
v_mfma_f32_16x16x32_bf16 v[216:219], a[76:79], v[72:75], v[216:219]
buffer_store_dwordx4 v[56:59], v21, s[4:7], s75 offen sc1
v_mfma_f32_16x16x32_bf16 v[208:211], a[12:15], v[88:91], v[208:211]
ds_read_b128 v[120:123], v29 offset:21504
v_mov_b32 v27, s72
v_mfma_f32_16x16x32_bf16 v[212:215], a[12:15], v[92:95], v[212:215]
ds_read_b128 v[124:127], v29 offset:30720
v_mfma_f32_16x16x32_bf16 v[220:223], a[76:79], v[76:79], v[220:223]
s_waitcnt lgkmcnt(4)
v_mfma_f32_16x16x32_bf16 v[208:211], a[16:19], v[96:99], v[208:211]
ds_read_b128 v[128:131], v29 offset:4096
v_mfma_f32_16x16x32_bf16 v[212:215], a[16:19], v[100:103], v[212:215]
ds_read_b128 v[132:135], v29 offset:13312
v_mfma_f32_16x16x32_bf16 v[216:219], a[80:83], v[80:83], v[216:219]
v_mfma_f32_16x16x32_bf16 v[208:211], a[20:23], v[104:107], v[208:211]
ds_read_b128 v[136:139], v29 offset:22528
v_mfma_f32_16x16x32_bf16 v[212:215], a[20:23], v[108:111], v[212:215]
ds_read_b128 v[140:143], v29 offset:31744
v_mfma_f32_16x16x32_bf16 v[220:223], a[80:83], v[84:87], v[220:223]
s_waitcnt lgkmcnt(4)
v_mfma_f32_16x16x32_bf16 v[208:211], a[24:27], v[112:115], v[208:211]
ds_read_b128 v[144:147], v29 offset:5120
v_mfma_f32_16x16x32_bf16 v[212:215], a[24:27], v[116:119], v[212:215]
ds_read_b128 v[148:151], v29 offset:14336
v_mfma_f32_16x16x32_bf16 v[216:219], a[84:87], v[88:91], v[216:219]
v_mfma_f32_16x16x32_bf16 v[208:211], a[28:31], v[120:123], v[208:211]
ds_read_b128 v[152:155], v29 offset:23552
v_mfma_f32_16x16x32_bf16 v[212:215], a[28:31], v[124:127], v[212:215]
ds_read_b128 v[156:159], v29 offset:32768
v_mfma_f32_16x16x32_bf16 v[220:223], a[84:87], v[92:95], v[220:223]
s_waitcnt vmcnt(6)
s_barrier
s_waitcnt lgkmcnt(4)
v_mfma_f32_16x16x32_bf16 v[208:211], a[32:35], v[128:131], v[208:211]
ds_read_b128 v[160:163], v29 offset:6144
v_mfma_f32_16x16x32_bf16 v[212:215], a[32:35], v[132:135], v[212:215]
ds_read_b128 v[164:167], v29 offset:15360
s_waitcnt vmcnt(4)
ds_write_b32 v18, v24
v_mfma_f32_16x16x32_bf16 v[216:219], a[88:91], v[96:99], v[216:219]
v_mfma_f32_16x16x32_bf16 v[208:211], a[36:39], v[136:139], v[208:211]
ds_read_b128 v[168:171], v29 offset:24576
v_mfma_f32_16x16x32_bf16 v[212:215], a[36:39], v[140:143], v[212:215]
ds_read_b128 v[172:175], v29 offset:33792
s_waitcnt lgkmcnt(2)
s_barrier
v_mfma_f32_16x16x32_bf16 v[220:223], a[88:91], v[100:103], v[220:223]
ds_read_b32 v33, v32
v_mfma_f32_16x16x32_bf16 v[208:211], a[40:43], v[144:147], v[208:211]
ds_read_b128 v[176:179], v29 offset:7168
v_mfma_f32_16x16x32_bf16 v[212:215], a[40:43], v[148:151], v[212:215]
ds_read_b128 v[180:183], v29 offset:16384
v_mfma_f32_16x16x32_bf16 v[216:219], a[92:95], v[104:107], v[216:219]
s_waitcnt lgkmcnt(2)
v_cmp_gt_u32 vcc, s52, v33
v_mfma_f32_16x16x32_bf16 v[208:211], a[44:47], v[152:155], v[208:211]
ds_read_b128 v[184:187], v29 offset:25600
v_cmp_gt_u32 s[58:59], s54, v33
v_mfma_f32_16x16x32_bf16 v[212:215], a[44:47], v[156:159], v[212:215]
ds_read_b128 v[188:191], v29 offset:34816
s_and_b32 vcc_lo, vcc_lo, s56
s_cselect_b32 s70, 0, 1
v_mfma_f32_16x16x32_bf16 v[220:223], a[92:95], v[108:111], v[220:223]
s_and_b32 s59, s59, s56
s_cselect_b32 s71, 0, s83
v_mfma_f32_16x16x32_bf16 v[208:211], a[48:51], v[160:163], v[208:211]
ds_read_b128 v[192:195], v29 offset:8192
s_or_b32 s88, s70, s71
s_cselect_b32 s10, 268435456, 0
v_mfma_f32_16x16x32_bf16 v[212:215], a[48:51], v[164:167], v[212:215]
ds_read_b128 v[196:199], v29 offset:17408
v_mfma_f32_16x16x32_bf16 v[216:219], a[96:99], v[112:115], v[216:219]
s_cmp_lg_u32 s70, 0
s_cselect_b64 s[84:85], s[52:53], s[54:55]
s_cselect_b64 s[58:59], s[44:45], s[46:47]
s_mul_i32 s86, s84, s20
v_mfma_f32_16x16x32_bf16 v[208:211], a[52:55], v[168:171], v[208:211]
ds_read_b128 v[200:203], v29 offset:26624
s_add_u32 s86, s86, s58
v_mfma_f32_16x16x32_bf16 v[212:215], a[52:55], v[172:175], v[212:215]
ds_read_b128 v[204:207], v29 offset:35840
s_add_u32 m0, s50, 0
v_mfma_f32_16x16x32_bf16 v[220:223], a[96:99], v[116:119], v[220:223]
buffer_load_dwordx4 v8, s[8:11], s86 offen offset:0 sc1 lds
s_waitcnt lgkmcnt(4)
v_mfma_f32_16x16x32_bf16 v[208:211], a[56:59], v[176:179], v[208:211]
s_mul_i32 s87, s84, s21
s_add_u32 s87, s87, s59
s_andn2_b32 s71, s71, s70
v_mfma_f32_16x16x32_bf16 v[212:215], a[56:59], v[180:183], v[212:215]
s_add_u32 s52, s52, s70
s_add_u32 s54, s54, s71
s_mov_b32 s89, s88
v_mfma_f32_16x16x32_bf16 v[216:219], a[100:103], v[120:123], v[216:219]
buffer_load_dwordx4 v9, s[8:11], s86 offen offset:1024 sc1 lds
v_mfma_f32_16x16x32_bf16 v[208:211], a[60:63], v[184:187], v[208:211]
v_mfma_f32_16x16x32_bf16 v[212:215], a[60:63], v[188:191], v[212:215]
v_mfma_f32_16x16x32_bf16 v[220:223], a[100:103], v[124:127], v[220:223]
buffer_load_dwordx4 v10, s[8:11], s86 offen offset:2048 sc1 lds
s_waitcnt lgkmcnt(0)
v_mfma_f32_16x16x32_bf16 v[208:211], a[64:67], v[192:195], v[208:211]
v_mfma_f32_16x16x32_bf16 v[212:215], a[64:67], v[196:199], v[212:215]
v_mfma_f32_16x16x32_bf16 v[216:219], a[104:107], v[128:131], v[216:219]
buffer_load_dwordx4 v11, s[8:11], s86 offen offset:3072 sc1 lds
v_mfma_f32_16x16x32_bf16 v[208:211], a[68:71], v[200:203], v[208:211]
v_mfma_f32_16x16x32_bf16 v[212:215], a[68:71], v[204:207], v[212:215]
s_add_u32 m0, s50, 4096
v_mfma_f32_16x16x32_bf16 v[220:223], a[104:107], v[132:135], v[220:223]
buffer_load_dwordx4 v12, s[8:11], s86 offen offset:0 sc1 lds
v_mfma_f32_16x16x32_bf16 v[216:219], a[108:111], v[136:139], v[216:219]
v_mfma_f32_16x16x32_bf16 v[220:223], a[108:111], v[140:143], v[220:223]
v_mfma_f32_16x16x32_bf16 v[216:219], a[112:115], v[144:147], v[216:219]
buffer_load_dwordx4 v13, s[8:11], s86 offen offset:1024 sc1 lds
v_mfma_f32_16x16x32_bf16 v[220:223], a[112:115], v[148:151], v[220:223]
v_mfma_f32_16x16x32_bf16 v[216:219], a[116:119], v[152:155], v[216:219]
v_cvt_pk_bf16_f32 v48, v208, v209
v_cvt_pk_bf16_f32 v49, v210, v211
v_mfma_f32_16x16x32_bf16 v[220:223], a[116:119], v[156:159], v[220:223]
buffer_load_dwordx4 v14, s[8:11], s86 offen offset:2048 sc1 lds
v_mfma_f32_16x16x32_bf16 v[216:219], a[120:123], v[160:163], v[216:219]
v_cvt_pk_bf16_f32 v50, v212, v213
v_cvt_pk_bf16_f32 v51, v214, v215
v_mfma_f32_16x16x32_bf16 v[220:223], a[120:123], v[164:167], v[220:223]
v_permlane16_swap_b32 v48, v50
v_mfma_f32_16x16x32_bf16 v[216:219], a[124:127], v[168:171], v[216:219]
buffer_load_dwordx4 v15, s[8:11], s86 offen offset:3072 sc1 lds
v_mfma_f32_16x16x32_bf16 v[220:223], a[124:127], v[172:175], v[220:223]
v_permlane16_swap_b32 v49, v51
v_mfma_f32_16x16x32_bf16 v[216:219], a[128:131], v[176:179], v[216:219]
s_add_u32 m0, s50, 8192
v_mfma_f32_16x16x32_bf16 v[220:223], a[128:131], v[180:183], v[220:223]
buffer_load_dwordx4 v16, s[8:11], s86 offen offset:0 sc1 lds
v_mfma_f32_16x16x32_bf16 v[216:219], a[132:135], v[184:187], v[216:219]
buffer_store_dwordx4 v[48:51], v19, s[4:7], s81 offen sc1
v_mfma_f32_16x16x32_bf16 v[220:223], a[132:135], v[188:191], v[220:223]
v_mfma_f32_16x16x32_bf16 v[216:219], a[136:139], v[192:195], v[216:219]
v_mfma_f32_16x16x32_bf16 v[220:223], a[136:139], v[196:199], v[220:223]
v_mfma_f32_16x16x32_bf16 v[216:219], a[140:143], v[200:203], v[216:219]
v_mfma_f32_16x16x32_bf16 v[220:223], a[140:143], v[204:207], v[220:223]
v_mfma_f32_16x16x32_bf16 v[224:227], v[64:67], a[144:147], 0
v_mfma_f32_16x16x32_bf16 v[228:231], v[68:71], a[144:147], 0
v_mfma_f32_16x16x32_bf16 v[224:227], v[72:75], a[148:151], v[224:227]
v_mfma_f32_16x16x32_bf16 v[228:231], v[76:79], a[148:151], v[228:231]
v_mfma_f32_16x16x32_bf16 v[224:227], v[80:83], a[152:155], v[224:227]
buffer_load_dword v24, v22, s[4:7], 0 offen sc1
v_mfma_f32_16x16x32_bf16 v[228:231], v[84:87], a[152:155], v[228:231]
v_cvt_pk_bf16_f32 v52, v216, v217
v_cvt_pk_bf16_f32 v53, v218, v219
v_mfma_f32_16x16x32_bf16 v[224:227], v[88:91], a[156:159], v[224:227]
s_waitcnt vmcnt(11)
s_barrier
v_mfma_f32_16x16x32_bf16 v[228:231], v[92:95], a[156:159], v[228:231]
buffer_store_dword v27, v45, s[4:7], s73 offen
v_mfma_f32_16x16x32_bf16 v[224:227], v[96:99], a[160:163], v[224:227]
buffer_store_dword v27, v44, s[4:7], s73 offen sc1
v_mfma_f32_16x16x32_bf16 v[228:231], v[100:103], a[160:163], v[228:231]
v_cvt_pk_bf16_f32 v54, v220, v221
v_cvt_pk_bf16_f32 v55, v222, v223
v_mfma_f32_16x16x32_bf16 v[224:227], v[104:107], a[164:167], v[224:227]
v_permlane16_swap_b32 v52, v54
v_mfma_f32_16x16x32_bf16 v[228:231], v[108:111], a[164:167], v[228:231]
v_permlane16_swap_b32 v53, v55
v_mfma_f32_16x16x32_bf16 v[224:227], v[112:115], a[168:171], v[224:227]
buffer_store_dwordx4 v[52:55], v20, s[4:7], s81 offen sc1
v_mfma_f32_16x16x32_bf16 v[228:231], v[116:119], a[168:171], v[228:231]
v_mfma_f32_16x16x32_bf16 v[224:227], v[120:123], a[172:175], v[224:227]
v_mfma_f32_16x16x32_bf16 v[228:231], v[124:127], a[172:175], v[228:231]
v_mfma_f32_16x16x32_bf16 v[224:227], v[128:131], a[176:179], v[224:227]
v_mfma_f32_16x16x32_bf16 v[228:231], v[132:135], a[176:179], v[228:231]
v_mfma_f32_16x16x32_bf16 v[224:227], v[136:139], a[180:183], v[224:227]
v_mfma_f32_16x16x32_bf16 v[228:231], v[140:143], a[180:183], v[228:231]
v_mfma_f32_16x16x32_bf16 v[224:227], v[144:147], a[184:187], v[224:227]
v_mfma_f32_16x16x32_bf16 v[228:231], v[148:151], a[184:187], v[228:231]
v_mfma_f32_16x16x32_bf16 v[224:227], v[152:155], a[188:191], v[224:227]
v_mfma_f32_16x16x32_bf16 v[228:231], v[156:159], a[188:191], v[228:231]
v_mfma_f32_16x16x32_bf16 v[224:227], v[160:163], a[192:195], v[224:227]
s_waitcnt vmcnt(12)
s_barrier
v_mfma_f32_16x16x32_bf16 v[228:231], v[164:167], a[192:195], v[228:231]
v_mfma_f32_16x16x32_bf16 v[224:227], v[168:171], a[196:199], v[224:227]
s_cmp_eq_u32 s88, 0
s_cbranch_scc1 g_slow_61
v_mfma_f32_16x16x32_bf16 v[228:231], v[172:175], a[196:199], v[228:231]
ds_read_b128 v[64:67], v30 offset:0
v_mfma_f32_16x16x32_bf16 v[224:227], v[176:179], a[200:203], v[224:227]
ds_read_b128 v[68:71], v30 offset:9216
v_mfma_f32_16x16x32_bf16 v[228:231], v[180:183], a[200:203], v[228:231]
ds_read_b128 v[72:75], v30 offset:18432
v_mfma_f32_16x16x32_bf16 v[224:227], v[184:187], a[204:207], v[224:227]
ds_read_b128 v[76:79], v30 offset:27648
v_mfma_f32_16x16x32_bf16 v[228:231], v[188:191], a[204:207], v[228:231]
ds_read_b128 v[80:83], v30 offset:1024
v_mfma_f32_16x16x32_bf16 v[224:227], v[192:195], a[208:211], v[224:227]
ds_read_b128 v[84:87], v30 offset:10240
v_mfma_f32_16x16x32_bf16 v[228:231], v[196:199], a[208:211], v[228:231]
ds_read_b128 v[88:91], v30 offset:19456
v_mfma_f32_16x16x32_bf16 v[224:227], v[200:203], a[212:215], v[224:227]
ds_read_b128 v[92:95], v30 offset:28672
v_mfma_f32_16x16x32_bf16 v[228:231], v[204:207], a[212:215], v[228:231]
s_waitcnt vmcnt(8)
s_barrier
g_body_50:
s_waitcnt lgkmcnt(4)
v_mfma_f32_16x16x32_bf16 v[208:211], a[0:3], v[64:67], 0
ds_read_b128 v[96:99], v30 offset:2048
v_mfma_f32_16x16x32_bf16 v[212:215], a[0:3], v[68:71], 0
ds_read_b128 v[100:103], v30 offset:11264
v_mfma_f32_16x16x32_bf16 v[216:219], a[72:75], v[64:67], 0
v_mfma_f32_16x16x32_bf16 v[208:211], a[4:7], v[72:75], v[208:211]
ds_read_b128 v[104:107], v30 offset:20480
v_cvt_pk_bf16_f32 v56, v224, v225
v_mfma_f32_16x16x32_bf16 v[212:215], a[4:7], v[76:79], v[212:215]
ds_read_b128 v[108:111], v30 offset:29696
v_cvt_pk_bf16_f32 v57, v226, v227
v_mfma_f32_16x16x32_bf16 v[220:223], a[72:75], v[68:71], 0
v_cvt_pk_bf16_f32 v58, v228, v229
s_waitcnt lgkmcnt(4)
v_mfma_f32_16x16x32_bf16 v[208:211], a[8:11], v[80:83], v[208:211]
ds_read_b128 v[112:115], v30 offset:3072
v_cvt_pk_bf16_f32 v59, v230, v231
v_mfma_f32_16x16x32_bf16 v[212:215], a[8:11], v[84:87], v[212:215]
ds_read_b128 v[116:119], v30 offset:12288
v_mfma_f32_16x16x32_bf16 v[216:219], a[76:79], v[72:75], v[216:219]
buffer_store_dwordx4 v[56:59], v21, s[4:7], s81 offen sc1
v_mfma_f32_16x16x32_bf16 v[208:211], a[12:15], v[88:91], v[208:211]
ds_read_b128 v[120:123], v30 offset:21504
v_mov_b32 v27, s78
v_mfma_f32_16x16x32_bf16 v[212:215], a[12:15], v[92:95], v[212:215]
ds_read_b128 v[124:127], v30 offset:30720
v_mfma_f32_16x16x32_bf16 v[220:223], a[76:79], v[76:79], v[220:223]
s_waitcnt lgkmcnt(4)
v_mfma_f32_16x16x32_bf16 v[208:211], a[16:19], v[96:99], v[208:211]
ds_read_b128 v[128:131], v30 offset:4096
v_mfma_f32_16x16x32_bf16 v[212:215], a[16:19], v[100:103], v[212:215]
ds_read_b128 v[132:135], v30 offset:13312
v_mfma_f32_16x16x32_bf16 v[216:219], a[80:83], v[80:83], v[216:219]
v_mfma_f32_16x16x32_bf16 v[208:211], a[20:23], v[104:107], v[208:211]
ds_read_b128 v[136:139], v30 offset:22528
v_mfma_f32_16x16x32_bf16 v[212:215], a[20:23], v[108:111], v[212:215]
ds_read_b128 v[140:143], v30 offset:31744
v_mfma_f32_16x16x32_bf16 v[220:223], a[80:83], v[84:87], v[220:223]
s_waitcnt lgkmcnt(4)
v_mfma_f32_16x16x32_bf16 v[208:211], a[24:27], v[112:115], v[208:211]
ds_read_b128 v[144:147], v30 offset:5120
v_mfma_f32_16x16x32_bf16 v[212:215], a[24:27], v[116:119], v[212:215]
ds_read_b128 v[148:151], v30 offset:14336
v_mfma_f32_16x16x32_bf16 v[216:219], a[84:87], v[88:91], v[216:219]
v_mfma_f32_16x16x32_bf16 v[208:211], a[28:31], v[120:123], v[208:211]
ds_read_b128 v[152:155], v30 offset:23552
v_mfma_f32_16x16x32_bf16 v[212:215], a[28:31], v[124:127], v[212:215]
ds_read_b128 v[156:159], v30 offset:32768
v_mfma_f32_16x16x32_bf16 v[220:223], a[84:87], v[92:95], v[220:223]
s_waitcnt vmcnt(6)
s_barrier
s_waitcnt lgkmcnt(4)
v_mfma_f32_16x16x32_bf16 v[208:211], a[32:35], v[128:131], v[208:211]
ds_read_b128 v[160:163], v30 offset:6144
v_mfma_f32_16x16x32_bf16 v[212:215], a[32:35], v[132:135], v[212:215]
ds_read_b128 v[164:167], v30 offset:15360
s_waitcnt vmcnt(4)
ds_write_b32 v18, v24
v_mfma_f32_16x16x32_bf16 v[216:219], a[88:91], v[96:99], v[216:219]
v_mfma_f32_16x16x32_bf16 v[208:211], a[36:39], v[136:139], v[208:211]
ds_read_b128 v[168:171], v30 offset:24576
v_mfma_f32_16x16x32_bf16 v[212:215], a[36:39], v[140:143], v[212:215]
ds_read_b128 v[172:175], v30 offset:33792
s_waitcnt lgkmcnt(2)
s_barrier
v_mfma_f32_16x16x32_bf16 v[220:223], a[88:91], v[100:103], v[220:223]
ds_read_b32 v33, v32
v_mfma_f32_16x16x32_bf16 v[208:211], a[40:43], v[144:147], v[208:211]
ds_read_b128 v[176:179], v30 offset:7168
v_mfma_f32_16x16x32_bf16 v[212:215], a[40:43], v[148:151], v[212:215]
ds_read_b128 v[180:183], v30 offset:16384
v_mfma_f32_16x16x32_bf16 v[216:219], a[92:95], v[104:107], v[216:219]
s_waitcnt lgkmcnt(2)
v_cmp_gt_u32 vcc, s52, v33
v_mfma_f32_16x16x32_bf16 v[208:211], a[44:47], v[152:155], v[208:211]
ds_read_b128 v[184:187], v30 offset:25600
v_cmp_gt_u32 s[58:59], s54, v33
v_mfma_f32_16x16x32_bf16 v[212:215], a[44:47], v[156:159], v[212:215]
ds_read_b128 v[188:191], v30 offset:34816
s_and_b32 vcc_lo, vcc_lo, s56
s_cselect_b32 s70, 0, 1
v_mfma_f32_16x16x32_bf16 v[220:223], a[92:95], v[108:111], v[220:223]
s_and_b32 s59, s59, s56
s_cselect_b32 s71, 0, s89
v_mfma_f32_16x16x32_bf16 v[208:211], a[48:51], v[160:163], v[208:211]
ds_read_b128 v[192:195], v30 offset:8192
s_or_b32 s94, s70, s71
s_cselect_b32 s10, 268435456, 0
v_mfma_f32_16x16x32_bf16 v[212:215], a[48:51], v[164:167], v[212:215]
ds_read_b128 v[196:199], v30 offset:17408
v_mfma_f32_16x16x32_bf16 v[216:219], a[96:99], v[112:115], v[216:219]
s_cmp_lg_u32 s70, 0
s_cselect_b64 s[90:91], s[52:53], s[54:55]
s_cselect_b64 s[58:59], s[44:45], s[46:47]
s_mul_i32 s92, s90, s20
v_mfma_f32_16x16x32_bf16 v[208:211], a[52:55], v[168:171], v[208:211]
ds_read_b128 v[200:203], v30 offset:26624
s_add_u32 s92, s92, s58
v_mfma_f32_16x16x32_bf16 v[212:215], a[52:55], v[172:175], v[212:215]
ds_read_b128 v[204:207], v30 offset:35840
s_add_u32 m0, s51, 0
v_mfma_f32_16x16x32_bf16 v[220:223], a[96:99], v[116:119], v[220:223]
buffer_load_dwordx4 v8, s[8:11], s92 offen offset:0 sc1 lds
s_waitcnt lgkmcnt(4)
v_mfma_f32_16x16x32_bf16 v[208:211], a[56:59], v[176:179], v[208:211]
s_mul_i32 s93, s90, s21
s_add_u32 s93, s93, s59
s_andn2_b32 s71, s71, s70
v_mfma_f32_16x16x32_bf16 v[212:215], a[56:59], v[180:183], v[212:215]
s_add_u32 s52, s52, s70
s_add_u32 s54, s54, s71
s_mov_b32 s95, s94
v_mfma_f32_16x16x32_bf16 v[216:219], a[100:103], v[120:123], v[216:219]
buffer_load_dwordx4 v9, s[8:11], s92 offen offset:1024 sc1 lds
v_mfma_f32_16x16x32_bf16 v[208:211], a[60:63], v[184:187], v[208:211]
v_mfma_f32_16x16x32_bf16 v[212:215], a[60:63], v[188:191], v[212:215]
v_mfma_f32_16x16x32_bf16 v[220:223], a[100:103], v[124:127], v[220:223]
buffer_load_dwordx4 v10, s[8:11], s92 offen offset:2048 sc1 lds
s_waitcnt lgkmcnt(0)
v_mfma_f32_16x16x32_bf16 v[208:211], a[64:67], v[192:195], v[208:211]
v_mfma_f32_16x16x32_bf16 v[212:215], a[64:67], v[196:199], v[212:215]
v_mfma_f32_16x16x32_bf16 v[216:219], a[104:107], v[128:131], v[216:219]
buffer_load_dwordx4 v11, s[8:11], s92 offen offset:3072 sc1 lds
v_mfma_f32_16x16x32_bf16 v[208:211], a[68:71], v[200:203], v[208:211]
v_mfma_f32_16x16x32_bf16 v[212:215], a[68:71], v[204:207], v[212:215]
s_add_u32 m0, s51, 4096
v_mfma_f32_16x16x32_bf16 v[220:223], a[104:107], v[132:135], v[220:223]
buffer_load_dwordx4 v12, s[8:11], s92 offen offset:0 sc1 lds
v_mfma_f32_16x16x32_bf16 v[216:219], a[108:111], v[136:139], v[216:219]
v_mfma_f32_16x16x32_bf16 v[220:223], a[108:111], v[140:143], v[220:223]
v_mfma_f32_16x16x32_bf16 v[216:219], a[112:115], v[144:147], v[216:219]
buffer_load_dwordx4 v13, s[8:11], s92 offen offset:1024 sc1 lds
v_mfma_f32_16x16x32_bf16 v[220:223], a[112:115], v[148:151], v[220:223]
v_mfma_f32_16x16x32_bf16 v[216:219], a[116:119], v[152:155], v[216:219]
v_cvt_pk_bf16_f32 v48, v208, v209
v_cvt_pk_bf16_f32 v49, v210, v211
v_mfma_f32_16x16x32_bf16 v[220:223], a[116:119], v[156:159], v[220:223]
buffer_load_dwordx4 v14, s[8:11], s92 offen offset:2048 sc1 lds
v_mfma_f32_16x16x32_bf16 v[216:219], a[120:123], v[160:163], v[216:219]
v_cvt_pk_bf16_f32 v50, v212, v213
v_cvt_pk_bf16_f32 v51, v214, v215
v_mfma_f32_16x16x32_bf16 v[220:223], a[120:123], v[164:167], v[220:223]
v_permlane16_swap_b32 v48, v50
v_mfma_f32_16x16x32_bf16 v[216:219], a[124:127], v[168:171], v[216:219]
buffer_load_dwordx4 v15, s[8:11], s92 offen offset:3072 sc1 lds
v_mfma_f32_16x16x32_bf16 v[220:223], a[124:127], v[172:175], v[220:223]
v_permlane16_swap_b32 v49, v51
v_mfma_f32_16x16x32_bf16 v[216:219], a[128:131], v[176:179], v[216:219]
s_add_u32 m0, s51, 8192
v_mfma_f32_16x16x32_bf16 v[220:223], a[128:131], v[180:183], v[220:223]
buffer_load_dwordx4 v16, s[8:11], s92 offen offset:0 sc1 lds
v_mfma_f32_16x16x32_bf16 v[216:219], a[132:135], v[184:187], v[216:219]
buffer_store_dwordx4 v[48:51], v19, s[4:7], s87 offen sc1
v_mfma_f32_16x16x32_bf16 v[220:223], a[132:135], v[188:191], v[220:223]
v_mfma_f32_16x16x32_bf16 v[216:219], a[136:139], v[192:195], v[216:219]
v_mfma_f32_16x16x32_bf16 v[220:223], a[136:139], v[196:199], v[220:223]
v_mfma_f32_16x16x32_bf16 v[216:219], a[140:143], v[200:203], v[216:219]
v_mfma_f32_16x16x32_bf16 v[220:223], a[140:143], v[204:207], v[220:223]
v_mfma_f32_16x16x32_bf16 v[224:227], v[64:67], a[144:147], 0
v_mfma_f32_16x16x32_bf16 v[228:231], v[68:71], a[144:147], 0
v_mfma_f32_16x16x32_bf16 v[224:227], v[72:75], a[148:151], v[224:227]
v_mfma_f32_16x16x32_bf16 v[228:231], v[76:79], a[148:151], v[228:231]
v_mfma_f32_16x16x32_bf16 v[224:227], v[80:83], a[152:155], v[224:227]
buffer_load_dword v24, v22, s[4:7], 0 offen sc1
v_mfma_f32_16x16x32_bf16 v[228:231], v[84:87], a[152:155], v[228:231]
v_cvt_pk_bf16_f32 v52, v216, v217
v_cvt_pk_bf16_f32 v53, v218, v219
v_mfma_f32_16x16x32_bf16 v[224:227], v[88:91], a[156:159], v[224:227]
s_waitcnt vmcnt(11)
s_barrier
v_mfma_f32_16x16x32_bf16 v[228:231], v[92:95], a[156:159], v[228:231]
buffer_store_dword v27, v45, s[4:7], s79 offen
v_mfma_f32_16x16x32_bf16 v[224:227], v[96:99], a[160:163], v[224:227]
buffer_store_dword v27, v44, s[4:7], s79 offen sc1
v_mfma_f32_16x16x32_bf16 v[228:231], v[100:103], a[160:163], v[228:231]
v_cvt_pk_bf16_f32 v54, v220, v221
v_cvt_pk_bf16_f32 v55, v222, v223
v_mfma_f32_16x16x32_bf16 v[224:227], v[104:107], a[164:167], v[224:227]
v_permlane16_swap_b32 v52, v54
v_mfma_f32_16x16x32_bf16 v[228:231], v[108:111], a[164:167], v[228:231]
v_permlane16_swap_b32 v53, v55
v_mfma_f32_16x16x32_bf16 v[224:227], v[112:115], a[168:171], v[224:227]
buffer_store_dwordx4 v[52:55], v20, s[4:7], s87 offen sc1
v_mfma_f32_16x16x32_bf16 v[228:231], v[116:119], a[168:171], v[228:231]
v_mfma_f32_16x16x32_bf16 v[224:227], v[120:123], a[172:175], v[224:227]
v_mfma_f32_16x16x32_bf16 v[228:231], v[124:127], a[172:175], v[228:231]
v_mfma_f32_16x16x32_bf16 v[224:227], v[128:131], a[176:179], v[224:227]
v_mfma_f32_16x16x32_bf16 v[228:231], v[132:135], a[176:179], v[228:231]
v_mfma_f32_16x16x32_bf16 v[224:227], v[136:139], a[180:183], v[224:227]
v_mfma_f32_16x16x32_bf16 v[228:231], v[140:143], a[180:183], v[228:231]
v_mfma_f32_16x16x32_bf16 v[224:227], v[144:147], a[184:187], v[224:227]
v_mfma_f32_16x16x32_bf16 v[228:231], v[148:151], a[184:187], v[228:231]
v_mfma_f32_16x16x32_bf16 v[224:227], v[152:155], a[188:191], v[224:227]
v_mfma_f32_16x16x32_bf16 v[228:231], v[156:159], a[188:191], v[228:231]
v_mfma_f32_16x16x32_bf16 v[224:227], v[160:163], a[192:195], v[224:227]
s_waitcnt vmcnt(12)
s_barrier
v_mfma_f32_16x16x32_bf16 v[228:231], v[164:167], a[192:195], v[228:231]
v_mfma_f32_16x16x32_bf16 v[224:227], v[168:171], a[196:199], v[224:227]
s_cmp_eq_u32 s94, 0
s_cbranch_scc1 g_slow_62
v_mfma_f32_16x16x32_bf16 v[228:231], v[172:175], a[196:199], v[228:231]
ds_read_b128 v[64:67], v31 offset:0
v_mfma_f32_16x16x32_bf16 v[224:227], v[176:179], a[200:203], v[224:227]
ds_read_b128 v[68:71], v31 offset:9216
v_mfma_f32_16x16x32_bf16 v[228:231], v[180:183], a[200:203], v[228:231]
ds_read_b128 v[72:75], v31 offset:18432
v_mfma_f32_16x16x32_bf16 v[224:227], v[184:187], a[204:207], v[224:227]
ds_read_b128 v[76:79], v31 offset:27648
v_mfma_f32_16x16x32_bf16 v[228:231], v[188:191], a[204:207], v[228:231]
ds_read_b128 v[80:83], v31 offset:1024
v_mfma_f32_16x16x32_bf16 v[224:227], v[192:195], a[208:211], v[224:227]
ds_read_b128 v[84:87], v31 offset:10240
v_mfma_f32_16x16x32_bf16 v[228:231], v[196:199], a[208:211], v[228:231]
ds_read_b128 v[88:91], v31 offset:19456
v_mfma_f32_16x16x32_bf16 v[224:227], v[200:203], a[212:215], v[224:227]
ds_read_b128 v[92:95], v31 offset:28672
v_mfma_f32_16x16x32_bf16 v[228:231], v[204:207], a[212:215], v[228:231]
s_waitcnt vmcnt(8)
s_barrier
g_body_51:
s_waitcnt lgkmcnt(4)
v_mfma_f32_16x16x32_bf16 v[208:211], a[0:3], v[64:67], 0
ds_read_b128 v[96:99], v31 offset:2048
v_mfma_f32_16x16x32_bf16 v[212:215], a[0:3], v[68:71], 0
ds_read_b128 v[100:103], v31 offset:11264
v_mfma_f32_16x16x32_bf16 v[216:219], a[72:75], v[64:67], 0
v_mfma_f32_16x16x32_bf16 v[208:211], a[4:7], v[72:75], v[208:211]
ds_read_b128 v[104:107], v31 offset:20480
v_cvt_pk_bf16_f32 v56, v224, v225
v_mfma_f32_16x16x32_bf16 v[212:215], a[4:7], v[76:79], v[212:215]
ds_read_b128 v[108:111], v31 offset:29696
v_cvt_pk_bf16_f32 v57, v226, v227
v_mfma_f32_16x16x32_bf16 v[220:223], a[72:75], v[68:71], 0
v_cvt_pk_bf16_f32 v58, v228, v229
s_waitcnt lgkmcnt(4)
v_mfma_f32_16x16x32_bf16 v[208:211], a[8:11], v[80:83], v[208:211]
ds_read_b128 v[112:115], v31 offset:3072
v_cvt_pk_bf16_f32 v59, v230, v231
v_mfma_f32_16x16x32_bf16 v[212:215], a[8:11], v[84:87], v[212:215]
ds_read_b128 v[116:119], v31 offset:12288
v_mfma_f32_16x16x32_bf16 v[216:219], a[76:79], v[72:75], v[216:219]
buffer_store_dwordx4 v[56:59], v21, s[4:7], s87 offen sc1
v_mfma_f32_16x16x32_bf16 v[208:211], a[12:15], v[88:91], v[208:211]
ds_read_b128 v[120:123], v31 offset:21504
v_mov_b32 v27, s84
v_mfma_f32_16x16x32_bf16 v[212:215], a[12:15], v[92:95], v[212:215]
ds_read_b128 v[124:127], v31 offset:30720
v_mfma_f32_16x16x32_bf16 v[220:223], a[76:79], v[76:79], v[220:223]
s_waitcnt lgkmcnt(4)
v_mfma_f32_16x16x32_bf16 v[208:211], a[16:19], v[96:99], v[208:211]
ds_read_b128 v[128:131], v31 offset:4096
v_mfma_f32_16x16x32_bf16 v[212:215], a[16:19], v[100:103], v[212:215]
ds_read_b128 v[132:135], v31 offset:13312
v_mfma_f32_16x16x32_bf16 v[216:219], a[80:83], v[80:83], v[216:219]
v_mfma_f32_16x16x32_bf16 v[208:211], a[20:23], v[104:107], v[208:211]
ds_read_b128 v[136:139], v31 offset:22528
v_mfma_f32_16x16x32_bf16 v[212:215], a[20:23], v[108:111], v[212:215]
ds_read_b128 v[140:143], v31 offset:31744
v_mfma_f32_16x16x32_bf16 v[220:223], a[80:83], v[84:87], v[220:223]
s_waitcnt lgkmcnt(4)
v_mfma_f32_16x16x32_bf16 v[208:211], a[24:27], v[112:115], v[208:211]
ds_read_b128 v[144:147], v31 offset:5120
v_mfma_f32_16x16x32_bf16 v[212:215], a[24:27], v[116:119], v[212:215]
ds_read_b128 v[148:151], v31 offset:14336
v_mfma_f32_16x16x32_bf16 v[216:219], a[84:87], v[88:91], v[216:219]
v_mfma_f32_16x16x32_bf16 v[208:211], a[28:31], v[120:123], v[208:211]
ds_read_b128 v[152:155], v31 offset:23552
v_mfma_f32_16x16x32_bf16 v[212:215], a[28:31], v[124:127], v[212:215]
ds_read_b128 v[156:159], v31 offset:32768
v_mfma_f32_16x16x32_bf16 v[220:223], a[84:87], v[92:95], v[220:223]
s_waitcnt vmcnt(6)
s_barrier
s_waitcnt lgkmcnt(4)
v_mfma_f32_16x16x32_bf16 v[208:211], a[32:35], v[128:131], v[208:211]
ds_read_b128 v[160:163], v31 offset:6144
v_mfma_f32_16x16x32_bf16 v[212:215], a[32:35], v[132:135], v[212:215]
ds_read_b128 v[164:167], v31 offset:15360
s_waitcnt vmcnt(4)
ds_write_b32 v18, v24
v_mfma_f32_16x16x32_bf16 v[216:219], a[88:91], v[96:99], v[216:219]
v_mfma_f32_16x16x32_bf16 v[208:211], a[36:39], v[136:139], v[208:211]
ds_read_b128 v[168:171], v31 offset:24576
v_mfma_f32_16x16x32_bf16 v[212:215], a[36:39], v[140:143], v[212:215]
ds_read_b128 v[172:175], v31 offset:33792
s_waitcnt lgkmcnt(2)
s_barrier
v_mfma_f32_16x16x32_bf16 v[220:223], a[88:91], v[100:103], v[220:223]
ds_read_b32 v33, v32
v_mfma_f32_16x16x32_bf16 v[208:211], a[40:43], v[144:147], v[208:211]
ds_read_b128 v[176:179], v31 offset:7168
v_mfma_f32_16x16x32_bf16 v[212:215], a[40:43], v[148:151], v[212:215]
ds_read_b128 v[180:183], v31 offset:16384
v_mfma_f32_16x16x32_bf16 v[216:219], a[92:95], v[104:107], v[216:219]
s_waitcnt lgkmcnt(2)
v_cmp_gt_u32 vcc, s52, v33
v_mfma_f32_16x16x32_bf16 v[208:211], a[44:47], v[152:155], v[208:211]
ds_read_b128 v[184:187], v31 offset:25600
v_cmp_gt_u32 s[58:59], s54, v33
v_mfma_f32_16x16x32_bf16 v[212:215], a[44:47], v[156:159], v[212:215]
ds_read_b128 v[188:191], v31 offset:34816
s_and_b32 vcc_lo, vcc_lo, s56
s_cselect_b32 s70, 0, 1
v_mfma_f32_16x16x32_bf16 v[220:223], a[92:95], v[108:111], v[220:223]
s_and_b32 s59, s59, s56
s_cselect_b32 s71, 0, s95
v_mfma_f32_16x16x32_bf16 v[208:211], a[48:51], v[160:163], v[208:211]
ds_read_b128 v[192:195], v31 offset:8192
s_or_b32 s76, s70, s71
s_cselect_b32 s10, 268435456, 0
v_mfma_f32_16x16x32_bf16 v[212:215], a[48:51], v[164:167], v[212:215]
ds_read_b128 v[196:199], v31 offset:17408
v_mfma_f32_16x16x32_bf16 v[216:219], a[96:99], v[112:115], v[216:219]
s_cmp_lg_u32 s70, 0
s_cselect_b64 s[72:73], s[52:53], s[54:55]
s_cselect_b64 s[58:59], s[44:45], s[46:47]
s_mul_i32 s74, s72, s20
v_mfma_f32_16x16x32_bf16 v[208:211], a[52:55], v[168:171], v[208:211]
ds_read_b128 v[200:203], v31 offset:26624
s_add_u32 s74, s74, s58
v_mfma_f32_16x16x32_bf16 v[212:215], a[52:55], v[172:175], v[212:215]
ds_read_b128 v[204:207], v31 offset:35840
s_add_u32 m0, s48, 0
v_mfma_f32_16x16x32_bf16 v[220:223], a[96:99], v[116:119], v[220:223]
buffer_load_dwordx4 v8, s[8:11], s74 offen offset:0 sc1 lds
s_waitcnt lgkmcnt(4)
v_mfma_f32_16x16x32_bf16 v[208:211], a[56:59], v[176:179], v[208:211]
s_mul_i32 s75, s72, s21
s_add_u32 s75, s75, s59
s_andn2_b32 s71, s71, s70
v_mfma_f32_16x16x32_bf16 v[212:215], a[56:59], v[180:183], v[212:215]
s_add_u32 s52, s52, s70
s_add_u32 s54, s54, s71
s_mov_b32 s77, s76
v_mfma_f32_16x16x32_bf16 v[216:219], a[100:103], v[120:123], v[216:219]
buffer_load_dwordx4 v9, s[8:11], s74 offen offset:1024 sc1 lds
v_mfma_f32_16x16x32_bf16 v[208:211], a[60:63], v[184:187], v[208:211]
v_mfma_f32_16x16x32_bf16 v[212:215], a[60:63], v[188:191], v[212:215]
v_mfma_f32_16x16x32_bf16 v[220:223], a[100:103], v[124:127], v[220:223]
buffer_load_dwordx4 v10, s[8:11], s74 offen offset:2048 sc1 lds
s_waitcnt lgkmcnt(0)
v_mfma_f32_16x16x32_bf16 v[208:211], a[64:67], v[192:195], v[208:211]
v_mfma_f32_16x16x32_bf16 v[212:215], a[64:67], v[196:199], v[212:215]
v_mfma_f32_16x16x32_bf16 v[216:219], a[104:107], v[128:131], v[216:219]
buffer_load_dwordx4 v11, s[8:11], s74 offen offset:3072 sc1 lds
v_mfma_f32_16x16x32_bf16 v[208:211], a[68:71], v[200:203], v[208:211]
v_mfma_f32_16x16x32_bf16 v[212:215], a[68:71], v[204:207], v[212:215]
s_add_u32 m0, s48, 4096
v_mfma_f32_16x16x32_bf16 v[220:223], a[104:107], v[132:135], v[220:223]
buffer_load_dwordx4 v12, s[8:11], s74 offen offset:0 sc1 lds
v_mfma_f32_16x16x32_bf16 v[216:219], a[108:111], v[136:139], v[216:219]
v_mfma_f32_16x16x32_bf16 v[220:223], a[108:111], v[140:143], v[220:223]
v_mfma_f32_16x16x32_bf16 v[216:219], a[112:115], v[144:147], v[216:219]
buffer_load_dwordx4 v13, s[8:11], s74 offen offset:1024 sc1 lds
v_mfma_f32_16x16x32_bf16 v[220:223], a[112:115], v[148:151], v[220:223]
v_mfma_f32_16x16x32_bf16 v[216:219], a[116:119], v[152:155], v[216:219]
v_cvt_pk_bf16_f32 v48, v208, v209
v_cvt_pk_bf16_f32 v49, v210, v211
v_mfma_f32_16x16x32_bf16 v[220:223], a[116:119], v[156:159], v[220:223]
buffer_load_dwordx4 v14, s[8:11], s74 offen offset:2048 sc1 lds
v_mfma_f32_16x16x32_bf16 v[216:219], a[120:123], v[160:163], v[216:219]
v_cvt_pk_bf16_f32 v50, v212, v213
v_cvt_pk_bf16_f32 v51, v214, v215
v_mfma_f32_16x16x32_bf16 v[220:223], a[120:123], v[164:167], v[220:223]
v_permlane16_swap_b32 v48, v50
v_mfma_f32_16x16x32_bf16 v[216:219], a[124:127], v[168:171], v[216:219]
buffer_load_dwordx4 v15, s[8:11], s74 offen offset:3072 sc1 lds
v_mfma_f32_16x16x32_bf16 v[220:223], a[124:127], v[172:175], v[220:223]
v_permlane16_swap_b32 v49, v51
v_mfma_f32_16x16x32_bf16 v[216:219], a[128:131], v[176:179], v[216:219]
s_add_u32 m0, s48, 8192
v_mfma_f32_16x16x32_bf16 v[220:223], a[128:131], v[180:183], v[220:223]
buffer_load_dwordx4 v16, s[8:11], s74 offen offset:0 sc1 lds
v_mfma_f32_16x16x32_bf16 v[216:219], a[132:135], v[184:187], v[216:219]
buffer_store_dwordx4 v[48:51], v19, s[4:7], s93 offen sc1
v_mfma_f32_16x16x32_bf16 v[220:223], a[132:135], v[188:191], v[220:223]
v_mfma_f32_16x16x32_bf16 v[216:219], a[136:139], v[192:195], v[216:219]
v_mfma_f32_16x16x32_bf16 v[220:223], a[136:139], v[196:199], v[220:223]
v_mfma_f32_16x16x32_bf16 v[216:219], a[140:143], v[200:203], v[216:219]
v_mfma_f32_16x16x32_bf16 v[220:223], a[140:143], v[204:207], v[220:223]
v_mfma_f32_16x16x32_bf16 v[224:227], v[64:67], a[144:147], 0
v_mfma_f32_16x16x32_bf16 v[228:231], v[68:71], a[144:147], 0
v_mfma_f32_16x16x32_bf16 v[224:227], v[72:75], a[148:151], v[224:227]
v_mfma_f32_16x16x32_bf16 v[228:231], v[76:79], a[148:151], v[228:231]
v_mfma_f32_16x16x32_bf16 v[224:227], v[80:83], a[152:155], v[224:227]
buffer_load_dword v24, v22, s[4:7], 0 offen sc1
v_mfma_f32_16x16x32_bf16 v[228:231], v[84:87], a[152:155], v[228:231]
v_cvt_pk_bf16_f32 v52, v216, v217
v_cvt_pk_bf16_f32 v53, v218, v219
v_mfma_f32_16x16x32_bf16 v[224:227], v[88:91], a[156:159], v[224:227]
s_waitcnt vmcnt(11)
s_barrier
v_mfma_f32_16x16x32_bf16 v[228:231], v[92:95], a[156:159], v[228:231]
buffer_store_dword v27, v45, s[4:7], s85 offen
v_mfma_f32_16x16x32_bf16 v[224:227], v[96:99], a[160:163], v[224:227]
buffer_store_dword v27, v44, s[4:7], s85 offen sc1
v_mfma_f32_16x16x32_bf16 v[228:231], v[100:103], a[160:163], v[228:231]
v_cvt_pk_bf16_f32 v54, v220, v221
v_cvt_pk_bf16_f32 v55, v222, v223
v_mfma_f32_16x16x32_bf16 v[224:227], v[104:107], a[164:167], v[224:227]
v_permlane16_swap_b32 v52, v54
v_mfma_f32_16x16x32_bf16 v[228:231], v[108:111], a[164:167], v[228:231]
v_permlane16_swap_b32 v53, v55
v_mfma_f32_16x16x32_bf16 v[224:227], v[112:115], a[168:171], v[224:227]
buffer_store_dwordx4 v[52:55], v20, s[4:7], s93 offen sc1
v_mfma_f32_16x16x32_bf16 v[228:231], v[116:119], a[168:171], v[228:231]
v_mfma_f32_16x16x32_bf16 v[224:227], v[120:123], a[172:175], v[224:227]
v_mfma_f32_16x16x32_bf16 v[228:231], v[124:127], a[172:175], v[228:231]
v_mfma_f32_16x16x32_bf16 v[224:227], v[128:131], a[176:179], v[224:227]
v_mfma_f32_16x16x32_bf16 v[228:231], v[132:135], a[176:179], v[228:231]
v_mfma_f32_16x16x32_bf16 v[224:227], v[136:139], a[180:183], v[224:227]
v_mfma_f32_16x16x32_bf16 v[228:231], v[140:143], a[180:183], v[228:231]
v_mfma_f32_16x16x32_bf16 v[224:227], v[144:147], a[184:187], v[224:227]
v_mfma_f32_16x16x32_bf16 v[228:231], v[148:151], a[184:187], v[228:231]
v_mfma_f32_16x16x32_bf16 v[224:227], v[152:155], a[188:191], v[224:227]
v_mfma_f32_16x16x32_bf16 v[228:231], v[156:159], a[188:191], v[228:231]
v_mfma_f32_16x16x32_bf16 v[224:227], v[160:163], a[192:195], v[224:227]
s_waitcnt vmcnt(12)
s_barrier
v_mfma_f32_16x16x32_bf16 v[228:231], v[164:167], a[192:195], v[228:231]
v_mfma_f32_16x16x32_bf16 v[224:227], v[168:171], a[196:199], v[224:227]
s_cmp_eq_u32 s76, 0
s_cbranch_scc1 g_slow_63
v_mfma_f32_16x16x32_bf16 v[228:231], v[172:175], a[196:199], v[228:231]
ds_read_b128 v[64:67], v28 offset:0
v_mfma_f32_16x16x32_bf16 v[224:227], v[176:179], a[200:203], v[224:227]
ds_read_b128 v[68:71], v28 offset:9216
v_mfma_f32_16x16x32_bf16 v[228:231], v[180:183], a[200:203], v[228:231]
ds_read_b128 v[72:75], v28 offset:18432
v_mfma_f32_16x16x32_bf16 v[224:227], v[184:187], a[204:207], v[224:227]
ds_read_b128 v[76:79], v28 offset:27648
v_mfma_f32_16x16x32_bf16 v[228:231], v[188:191], a[204:207], v[228:231]
ds_read_b128 v[80:83], v28 offset:1024
v_mfma_f32_16x16x32_bf16 v[224:227], v[192:195], a[208:211], v[224:227]
ds_read_b128 v[84:87], v28 offset:10240
v_mfma_f32_16x16x32_bf16 v[228:231], v[196:199], a[208:211], v[228:231]
ds_read_b128 v[88:91], v28 offset:19456
v_mfma_f32_16x16x32_bf16 v[224:227], v[200:203], a[212:215], v[224:227]
ds_read_b128 v[92:95], v28 offset:28672
v_mfma_f32_16x16x32_bf16 v[228:231], v[204:207], a[212:215], v[228:231]
s_waitcnt vmcnt(8)
s_barrier
s_branch g_body_48
g_slow_60:
v_mfma_f32_16x16x32_bf16 v[228:231], v[172:175], a[196:199], v[228:231]
v_mfma_f32_16x16x32_bf16 v[224:227], v[176:179], a[200:203], v[224:227]
v_mfma_f32_16x16x32_bf16 v[228:231], v[180:183], a[200:203], v[228:231]
v_mfma_f32_16x16x32_bf16 v[224:227], v[184:187], a[204:207], v[224:227]
v_mfma_f32_16x16x32_bf16 v[228:231], v[188:191], a[204:207], v[228:231]
v_mfma_f32_16x16x32_bf16 v[224:227], v[192:195], a[208:211], v[224:227]
v_mfma_f32_16x16x32_bf16 v[228:231], v[196:199], a[208:211], v[228:231]
v_mfma_f32_16x16x32_bf16 v[224:227], v[200:203], a[212:215], v[224:227]
v_mfma_f32_16x16x32_bf16 v[228:231], v[204:207], a[212:215], v[228:231]
s_nop 6
v_cvt_pk_bf16_f32 v56, v224, v225
v_cvt_pk_bf16_f32 v57, v226, v227
v_cvt_pk_bf16_f32 v58, v228, v229
v_cvt_pk_bf16_f32 v59, v230, v231
buffer_store_dwordx4 v[56:59], v21, s[4:7], s75 offen sc1
s_mov_b32 s75, 1879048192
s_waitcnt vmcnt(4)
ds_write_b32 v18, v24
s_waitcnt lgkmcnt(0)
s_barrier
ds_read_b32 v33, v32
s_waitcnt lgkmcnt(0)
v_cmp_gt_u32 vcc, s52, v33
v_cmp_gt_u32 s[58:59], s54, v33
s_and_b32 vcc_lo, vcc_lo, s56
s_cselect_b32 s70, 0, 1
s_and_b32 s59, s59, s56
s_cselect_b32 s71, 0, s77
s_or_b32 s82, s70, s71
s_cselect_b32 s10, 268435456, 0
s_cmp_lg_u32 s70, 0
s_cselect_b64 s[78:79], s[52:53], s[54:55]
s_cselect_b64 s[58:59], s[44:45], s[46:47]
s_mul_i32 s80, s78, s20
s_add_u32 s80, s80, s58
s_mul_i32 s81, s78, s21
s_add_u32 s81, s81, s59
s_andn2_b32 s71, s71, s70
s_add_u32 s52, s52, s70
s_add_u32 s54, s54, s71
s_mov_b32 s83, s82
s_cmp_lg_u32 s82, 0
s_cbranch_scc1 g_go_64
v_mov_b32 v27, s72
s_waitcnt vmcnt(0)
s_barrier
s_add_u32 s70, s52, s54
s_cmp_eq_u32 s70, 130
s_cbranch_scc1 g_fin_52
s_cmp_lg_u32 s3, 0
s_cbranch_scc1 sp_ok_66_j
s_mov_b32 s23, 0
buffer_load_dword v33, v22, s[4:7], 0 offen sc1
buffer_store_dword v27, v45, s[4:7], s73 offen
buffer_store_dword v27, v44, s[4:7], s73 offen sc1
s_waitcnt vmcnt(2)
s_branch sp_loop_65_e
sp_loop_65:
buffer_load_dword v33, v22, s[4:7], 0 offen sc1
s_add_u32 s23, s23, 1
s_cmp_gt_u32 s23, 150000
s_cbranch_scc1 sp_bad_67
s_waitcnt vmcnt(0)
sp_loop_65_e:
v_cmp_gt_u32 vcc, s52, v33
v_cmp_gt_u32 s[58:59], s54, v33
s_and_b32 vcc_lo, vcc_lo, s56
s_cbranch_scc0 sp_ok_66
s_cmp_gt_u32 s23, 4
s_cselect_b32 s70, 0, s56
s_cmp_lg_u32 s77, 0
s_cselect_b32 s70, 0, s70
s_or_b32 s59, s59, s70
s_and_b32 s59, s59, s56
s_cbranch_scc0 sp_ok_66
s_sleep 1
s_branch sp_loop_65
sp_bad_67:
s_mov_b32 s98, 1026
s_branch L_fail
sp_ok_66:
ds_write_b32 v18, v33
s_waitcnt lgkmcnt(0)
sp_ok_66_j:
s_barrier
ds_read_b32 v33, v32
s_waitcnt lgkmcnt(0)
s_mov_b32 s73, 1879048192
v_cmp_gt_u32 vcc, s52, v33
v_cmp_gt_u32 s[58:59], s54, v33
s_and_b32 vcc_lo, vcc_lo, s56
s_cselect_b32 s70, 0, 1
s_and_b32 s59, s59, s56
s_cselect_b32 s71, 0, 1
s_or_b32 s82, s70, s71
s_cselect_b32 s10, 268435456, 0
s_cmp_lg_u32 s70, 0
s_cselect_b64 s[78:79], s[52:53], s[54:55]
s_cselect_b64 s[58:59], s[44:45], s[46:47]
s_mul_i32 s80, s78, s20
s_add_u32 s80, s80, s58
s_mul_i32 s81, s78, s21
s_add_u32 s81, s81, s59
s_andn2_b32 s71, s71, s70
s_add_u32 s52, s52, s70
s_add_u32 s54, s54, s71
s_mov_b32 s83, s82
g_go_64:
s_add_u32 m0, s49, 0
s_nop 0
buffer_load_dwordx4 v8, s[4:7], s80 offen offset:0 sc1 lds
buffer_load_dwordx4 v9, s[4:7], s80 offen offset:1024 sc1 lds
buffer_load_dwordx4 v10, s[4:7], s80 offen offset:2048 sc1 lds
buffer_load_dwordx4 v11, s[4:7], s80 offen offset:3072 sc1 lds
s_add_u32 m0, s49, 4096
s_nop 0
buffer_load_dwordx4 v12, s[4:7], s80 offen offset:0 sc1 lds
buffer_load_dwordx4 v13, s[4:7], s80 offen offset:1024 sc1 lds
buffer_load_dwordx4 v14, s[4:7], s80 offen offset:2048 sc1 lds
buffer_load_dwordx4 v15, s[4:7], s80 offen offset:3072 sc1 lds
s_add_u32 m0, s49, 8192
s_nop 0
buffer_load_dwordx4 v16, s[4:7], s80 offen offset:0 sc1 lds
buffer_load_dword v24, v22, s[4:7], 0 offen sc1
buffer_store_dword v27, v34, s[4:7], 0 offen
buffer_store_dword v27, v34, s[4:7], 0 offen
v_mov_b32 v27, s72
s_waitcnt vmcnt(10)
s_barrier
buffer_store_dword v27, v45, s[4:7], s73 offen
buffer_store_dword v27, v44, s[4:7], s73 offen sc1
s_mov_b32 s73, 1879048192
ds_read_b128 v[64:67], v29 offset:0
ds_read_b128 v[68:71], v29 offset:9216
ds_read_b128 v[72:75], v29 offset:18432
ds_read_b128 v[76:79], v29 offset:27648
ds_read_b128 v[80:83], v29 offset:1024
ds_read_b128 v[84:87], v29 offset:10240
ds_read_b128 v[88:91], v29 offset:19456
ds_read_b128 v[92:95], v29 offset:28672
s_waitcnt vmcnt(8)
s_barrier
s_branch g_body_49
g_slow_61:
v_mfma_f32_16x16x32_bf16 v[228:231], v[172:175], a[196:199], v[228:231]
v_mfma_f32_16x16x32_bf16 v[224:227], v[176:179], a[200:203], v[224:227]
v_mfma_f32_16x16x32_bf16 v[228:231], v[180:183], a[200:203], v[228:231]
v_mfma_f32_16x16x32_bf16 v[224:227], v[184:187], a[204:207], v[224:227]
v_mfma_f32_16x16x32_bf16 v[228:231], v[188:191], a[204:207], v[228:231]
v_mfma_f32_16x16x32_bf16 v[224:227], v[192:195], a[208:211], v[224:227]
v_mfma_f32_16x16x32_bf16 v[228:231], v[196:199], a[208:211], v[228:231]
v_mfma_f32_16x16x32_bf16 v[224:227], v[200:203], a[212:215], v[224:227]
v_mfma_f32_16x16x32_bf16 v[228:231], v[204:207], a[212:215], v[228:231]
s_nop 6
v_cvt_pk_bf16_f32 v56, v224, v225
v_cvt_pk_bf16_f32 v57, v226, v227
v_cvt_pk_bf16_f32 v58, v228, v229
v_cvt_pk_bf16_f32 v59, v230, v231
buffer_store_dwordx4 v[56:59], v21, s[4:7], s81 offen sc1
s_mov_b32 s81, 1879048192
s_waitcnt vmcnt(4)
ds_write_b32 v18, v24
s_waitcnt lgkmcnt(0)
s_barrier
ds_read_b32 v33, v32
s_waitcnt lgkmcnt(0)
v_cmp_gt_u32 vcc, s52, v33
v_cmp_gt_u32 s[58:59], s54, v33
s_and_b32 vcc_lo, vcc_lo, s56
s_cselect_b32 s70, 0, 1
s_and_b32 s59, s59, s56
s_cselect_b32 s71, 0, s83
s_or_b32 s88, s70, s71
s_cselect_b32 s10, 268435456, 0
s_cmp_lg_u32 s70, 0
s_cselect_b64 s[84:85], s[52:53], s[54:55]
s_cselect_b64 s[58:59], s[44:45], s[46:47]
s_mul_i32 s86, s84, s20
s_add_u32 s86, s86, s58
s_mul_i32 s87, s84, s21
s_add_u32 s87, s87, s59
s_andn2_b32 s71, s71, s70
s_add_u32 s52, s52, s70
s_add_u32 s54, s54, s71
s_mov_b32 s89, s88
s_cmp_lg_u32 s88, 0
s_cbranch_scc1 g_go_68
v_mov_b32 v27, s78
s_waitcnt vmcnt(0)
s_barrier
s_add_u32 s70, s52, s54
s_cmp_eq_u32 s70, 130
s_cbranch_scc1 g_fin_52
s_cmp_lg_u32 s3, 0
s_cbranch_scc1 sp_ok_70_j
s_mov_b32 s23, 0
buffer_load_dword v33, v22, s[4:7], 0 offen sc1
buffer_store_dword v27, v45, s[4:7], s79 offen
buffer_store_dword v27, v44, s[4:7], s79 offen sc1
s_waitcnt vmcnt(2)
s_branch sp_loop_69_e
sp_loop_69:
buffer_load_dword v33, v22, s[4:7], 0 offen sc1
s_add_u32 s23, s23, 1
s_cmp_gt_u32 s23, 150000
s_cbranch_scc1 sp_bad_71
s_waitcnt vmcnt(0)
sp_loop_69_e:
v_cmp_gt_u32 vcc, s52, v33
v_cmp_gt_u32 s[58:59], s54, v33
s_and_b32 vcc_lo, vcc_lo, s56
s_cbranch_scc0 sp_ok_70
s_cmp_gt_u32 s23, 4
s_cselect_b32 s70, 0, s56
s_cmp_lg_u32 s83, 0
s_cselect_b32 s70, 0, s70
s_or_b32 s59, s59, s70
s_and_b32 s59, s59, s56
s_cbranch_scc0 sp_ok_70
s_sleep 1
s_branch sp_loop_69
sp_bad_71:
s_mov_b32 s98, 1026
s_branch L_fail
sp_ok_70:
ds_write_b32 v18, v33
s_waitcnt lgkmcnt(0)
sp_ok_70_j:
s_barrier
ds_read_b32 v33, v32
s_waitcnt lgkmcnt(0)
s_mov_b32 s79, 1879048192
v_cmp_gt_u32 vcc, s52, v33
v_cmp_gt_u32 s[58:59], s54, v33
s_and_b32 vcc_lo, vcc_lo, s56
s_cselect_b32 s70, 0, 1
s_and_b32 s59, s59, s56
s_cselect_b32 s71, 0, 1
s_or_b32 s88, s70, s71
s_cselect_b32 s10, 268435456, 0
s_cmp_lg_u32 s70, 0
s_cselect_b64 s[84:85], s[52:53], s[54:55]
s_cselect_b64 s[58:59], s[44:45], s[46:47]
s_mul_i32 s86, s84, s20
s_add_u32 s86, s86, s58
s_mul_i32 s87, s84, s21
s_add_u32 s87, s87, s59
s_andn2_b32 s71, s71, s70
s_add_u32 s52, s52, s70
s_add_u32 s54, s54, s71
s_mov_b32 s89, s88
g_go_68:
s_add_u32 m0, s50, 0
s_nop 0
buffer_load_dwordx4 v8, s[4:7], s86 offen offset:0 sc1 lds
buffer_load_dwordx4 v9, s[4:7], s86 offen offset:1024 sc1 lds
buffer_load_dwordx4 v10, s[4:7], s86 offen offset:2048 sc1 lds
buffer_load_dwordx4 v11, s[4:7], s86 offen offset:3072 sc1 lds
s_add_u32 m0, s50, 4096
s_nop 0
buffer_load_dwordx4 v12, s[4:7], s86 offen offset:0 sc1 lds
buffer_load_dwordx4 v13, s[4:7], s86 offen offset:1024 sc1 lds
buffer_load_dwordx4 v14, s[4:7], s86 offen offset:2048 sc1 lds
buffer_load_dwordx4 v15, s[4:7], s86 offen offset:3072 sc1 lds
s_add_u32 m0, s50, 8192
s_nop 0
buffer_load_dwordx4 v16, s[4:7], s86 offen offset:0 sc1 lds
buffer_load_dword v24, v22, s[4:7], 0 offen sc1
buffer_store_dword v27, v34, s[4:7], 0 offen
buffer_store_dword v27, v34, s[4:7], 0 offen
v_mov_b32 v27, s78
s_waitcnt vmcnt(10)
s_barrier
buffer_store_dword v27, v45, s[4:7], s79 offen
buffer_store_dword v27, v44, s[4:7], s79 offen sc1
s_mov_b32 s79, 1879048192
ds_read_b128 v[64:67], v30 offset:0
ds_read_b128 v[68:71], v30 offset:9216
ds_read_b128 v[72:75], v30 offset:18432
ds_read_b128 v[76:79], v30 offset:27648
ds_read_b128 v[80:83], v30 offset:1024
ds_read_b128 v[84:87], v30 offset:10240
ds_read_b128 v[88:91], v30 offset:19456
ds_read_b128 v[92:95], v30 offset:28672
s_waitcnt vmcnt(8)
s_barrier
s_branch g_body_50
g_slow_62:
v_mfma_f32_16x16x32_bf16 v[228:231], v[172:175], a[196:199], v[228:231]
v_mfma_f32_16x16x32_bf16 v[224:227], v[176:179], a[200:203], v[224:227]
v_mfma_f32_16x16x32_bf16 v[228:231], v[180:183], a[200:203], v[228:231]
v_mfma_f32_16x16x32_bf16 v[224:227], v[184:187], a[204:207], v[224:227]
v_mfma_f32_16x16x32_bf16 v[228:231], v[188:191], a[204:207], v[228:231]
v_mfma_f32_16x16x32_bf16 v[224:227], v[192:195], a[208:211], v[224:227]
v_mfma_f32_16x16x32_bf16 v[228:231], v[196:199], a[208:211], v[228:231]
v_mfma_f32_16x16x32_bf16 v[224:227], v[200:203], a[212:215], v[224:227]
v_mfma_f32_16x16x32_bf16 v[228:231], v[204:207], a[212:215], v[228:231]
s_nop 6
v_cvt_pk_bf16_f32 v56, v224, v225
v_cvt_pk_bf16_f32 v57, v226, v227
v_cvt_pk_bf16_f32 v58, v228, v229
v_cvt_pk_bf16_f32 v59, v230, v231
buffer_store_dwordx4 v[56:59], v21, s[4:7], s87 offen sc1
s_mov_b32 s87, 1879048192
s_waitcnt vmcnt(4)
ds_write_b32 v18, v24
s_waitcnt lgkmcnt(0)
s_barrier
ds_read_b32 v33, v32
s_waitcnt lgkmcnt(0)
v_cmp_gt_u32 vcc, s52, v33
v_cmp_gt_u32 s[58:59], s54, v33
s_and_b32 vcc_lo, vcc_lo, s56
s_cselect_b32 s70, 0, 1
s_and_b32 s59, s59, s56
s_cselect_b32 s71, 0, s89
s_or_b32 s94, s70, s71
s_cselect_b32 s10, 268435456, 0
s_cmp_lg_u32 s70, 0
s_cselect_b64 s[90:91], s[52:53], s[54:55]
s_cselect_b64 s[58:59], s[44:45], s[46:47]
s_mul_i32 s92, s90, s20
s_add_u32 s92, s92, s58
s_mul_i32 s93, s90, s21
s_add_u32 s93, s93, s59
s_andn2_b32 s71, s71, s70
s_add_u32 s52, s52, s70
s_add_u32 s54, s54, s71
s_mov_b32 s95, s94
s_cmp_lg_u32 s94, 0
s_cbranch_scc1 g_go_72
v_mov_b32 v27, s84
s_waitcnt vmcnt(0)
s_barrier
s_add_u32 s70, s52, s54
s_cmp_eq_u32 s70, 130
s_cbranch_scc1 g_fin_52
s_cmp_lg_u32 s3, 0
s_cbranch_scc1 sp_ok_74_j
s_mov_b32 s23, 0
buffer_load_dword v33, v22, s[4:7], 0 offen sc1
buffer_store_dword v27, v45, s[4:7], s85 offen
buffer_store_dword v27, v44, s[4:7], s85 offen sc1
s_waitcnt vmcnt(2)
s_branch sp_loop_73_e
sp_loop_73:
buffer_load_dword v33, v22, s[4:7], 0 offen sc1
s_add_u32 s23, s23, 1
s_cmp_gt_u32 s23, 150000
s_cbranch_scc1 sp_bad_75
s_waitcnt vmcnt(0)
sp_loop_73_e:
v_cmp_gt_u32 vcc, s52, v33
v_cmp_gt_u32 s[58:59], s54, v33
s_and_b32 vcc_lo, vcc_lo, s56
s_cbranch_scc0 sp_ok_74
s_cmp_gt_u32 s23, 4
s_cselect_b32 s70, 0, s56
s_cmp_lg_u32 s89, 0
s_cselect_b32 s70, 0, s70
s_or_b32 s59, s59, s70
s_and_b32 s59, s59, s56
s_cbranch_scc0 sp_ok_74
s_sleep 1
s_branch sp_loop_73
sp_bad_75:
s_mov_b32 s98, 1026
s_branch L_fail
sp_ok_74:
ds_write_b32 v18, v33
s_waitcnt lgkmcnt(0)
sp_ok_74_j:
s_barrier
ds_read_b32 v33, v32
s_waitcnt lgkmcnt(0)
s_mov_b32 s85, 1879048192
v_cmp_gt_u32 vcc, s52, v33
v_cmp_gt_u32 s[58:59], s54, v33
s_and_b32 vcc_lo, vcc_lo, s56
s_cselect_b32 s70, 0, 1
s_and_b32 s59, s59, s56
s_cselect_b32 s71, 0, 1
s_or_b32 s94, s70, s71
s_cselect_b32 s10, 268435456, 0
s_cmp_lg_u32 s70, 0
s_cselect_b64 s[90:91], s[52:53], s[54:55]
s_cselect_b64 s[58:59], s[44:45], s[46:47]
s_mul_i32 s92, s90, s20
s_add_u32 s92, s92, s58
s_mul_i32 s93, s90, s21
s_add_u32 s93, s93, s59
s_andn2_b32 s71, s71, s70
s_add_u32 s52, s52, s70
s_add_u32 s54, s54, s71
s_mov_b32 s95, s94
g_go_72:
s_add_u32 m0, s51, 0
s_nop 0
buffer_load_dwordx4 v8, s[4:7], s92 offen offset:0 sc1 lds
buffer_load_dwordx4 v9, s[4:7], s92 offen offset:1024 sc1 lds
buffer_load_dwordx4 v10, s[4:7], s92 offen offset:2048 sc1 lds
buffer_load_dwordx4 v11, s[4:7], s92 offen offset:3072 sc1 lds
s_add_u32 m0, s51, 4096
s_nop 0
buffer_load_dwordx4 v12, s[4:7], s92 offen offset:0 sc1 lds
buffer_load_dwordx4 v13, s[4:7], s92 offen offset:1024 sc1 lds
buffer_load_dwordx4 v14, s[4:7], s92 offen offset:2048 sc1 lds
buffer_load_dwordx4 v15, s[4:7], s92 offen offset:3072 sc1 lds
s_add_u32 m0, s51, 8192
s_nop 0
buffer_load_dwordx4 v16, s[4:7], s92 offen offset:0 sc1 lds
buffer_load_dword v24, v22, s[4:7], 0 offen sc1
buffer_store_dword v27, v34, s[4:7], 0 offen
buffer_store_dword v27, v34, s[4:7], 0 offen
v_mov_b32 v27, s84
s_waitcnt vmcnt(10)
s_barrier
buffer_store_dword v27, v45, s[4:7], s85 offen
buffer_store_dword v27, v44, s[4:7], s85 offen sc1
s_mov_b32 s85, 1879048192
ds_read_b128 v[64:67], v31 offset:0
ds_read_b128 v[68:71], v31 offset:9216
ds_read_b128 v[72:75], v31 offset:18432
ds_read_b128 v[76:79], v31 offset:27648
ds_read_b128 v[80:83], v31 offset:1024
ds_read_b128 v[84:87], v31 offset:10240
ds_read_b128 v[88:91], v31 offset:19456
ds_read_b128 v[92:95], v31 offset:28672
s_waitcnt vmcnt(8)
s_barrier
s_branch g_body_51
g_slow_63:
v_mfma_f32_16x16x32_bf16 v[228:231], v[172:175], a[196:199], v[228:231]
v_mfma_f32_16x16x32_bf16 v[224:227], v[176:179], a[200:203], v[224:227]
v_mfma_f32_16x16x32_bf16 v[228:231], v[180:183], a[200:203], v[228:231]
v_mfma_f32_16x16x32_bf16 v[224:227], v[184:187], a[204:207], v[224:227]
v_mfma_f32_16x16x32_bf16 v[228:231], v[188:191], a[204:207], v[228:231]
v_mfma_f32_16x16x32_bf16 v[224:227], v[192:195], a[208:211], v[224:227]
v_mfma_f32_16x16x32_bf16 v[228:231], v[196:199], a[208:211], v[228:231]
v_mfma_f32_16x16x32_bf16 v[224:227], v[200:203], a[212:215], v[224:227]
v_mfma_f32_16x16x32_bf16 v[228:231], v[204:207], a[212:215], v[228:231]
s_nop 6
v_cvt_pk_bf16_f32 v56, v224, v225
v_cvt_pk_bf16_f32 v57, v226, v227
v_cvt_pk_bf16_f32 v58, v228, v229
v_cvt_pk_bf16_f32 v59, v230, v231
buffer_store_dwordx4 v[56:59], v21, s[4:7], s93 offen sc1
s_mov_b32 s93, 1879048192
s_waitcnt vmcnt(4)
ds_write_b32 v18, v24
s_waitcnt lgkmcnt(0)
s_barrier
ds_read_b32 v33, v32
s_waitcnt lgkmcnt(0)
v_cmp_gt_u32 vcc, s52, v33
v_cmp_gt_u32 s[58:59], s54, v33
s_and_b32 vcc_lo, vcc_lo, s56
s_cselect_b32 s70, 0, 1
s_and_b32 s59, s59, s56
s_cselect_b32 s71, 0, s95
s_or_b32 s76, s70, s71
s_cselect_b32 s10, 268435456, 0
s_cmp_lg_u32 s70, 0
s_cselect_b64 s[72:73], s[52:53], s[54:55]
s_cselect_b64 s[58:59], s[44:45], s[46:47]
s_mul_i32 s74, s72, s20
s_add_u32 s74, s74, s58
s_mul_i32 s75, s72, s21
s_add_u32 s75, s75, s59
s_andn2_b32 s71, s71, s70
s_add_u32 s52, s52, s70
s_add_u32 s54, s54, s71
s_mov_b32 s77, s76
s_cmp_lg_u32 s76, 0
s_cbranch_scc1 g_go_76
v_mov_b32 v27, s90
s_waitcnt vmcnt(0)
s_barrier
s_add_u32 s70, s52, s54
s_cmp_eq_u32 s70, 130
s_cbranch_scc1 g_fin_52
s_cmp_lg_u32 s3, 0
s_cbranch_scc1 sp_ok_78_j
s_mov_b32 s23, 0
buffer_load_dword v33, v22, s[4:7], 0 offen sc1
buffer_store_dword v27, v45, s[4:7], s91 offen
buffer_store_dword v27, v44, s[4:7], s91 offen sc1
s_waitcnt vmcnt(2)
s_branch sp_loop_77_e
sp_loop_77:
buffer_load_dword v33, v22, s[4:7], 0 offen sc1
s_add_u32 s23, s23, 1
s_cmp_gt_u32 s23, 150000
s_cbranch_scc1 sp_bad_79
s_waitcnt vmcnt(0)
sp_loop_77_e:
v_cmp_gt_u32 vcc, s52, v33
v_cmp_gt_u32 s[58:59], s54, v33
s_and_b32 vcc_lo, vcc_lo, s56
s_cbranch_scc0 sp_ok_78
s_cmp_gt_u32 s23, 4
s_cselect_b32 s70, 0, s56
s_cmp_lg_u32 s95, 0
s_cselect_b32 s70, 0, s70
s_or_b32 s59, s59, s70
s_and_b32 s59, s59, s56
s_cbranch_scc0 sp_ok_78
s_sleep 1
s_branch sp_loop_77
sp_bad_79:
s_mov_b32 s98, 1026
s_branch L_fail
sp_ok_78:
ds_write_b32 v18, v33
s_waitcnt lgkmcnt(0)
sp_ok_78_j:
s_barrier
ds_read_b32 v33, v32
s_waitcnt lgkmcnt(0)
s_mov_b32 s91, 1879048192
v_cmp_gt_u32 vcc, s52, v33
v_cmp_gt_u32 s[58:59], s54, v33
s_and_b32 vcc_lo, vcc_lo, s56
s_cselect_b32 s70, 0, 1
s_and_b32 s59, s59, s56
s_cselect_b32 s71, 0, 1
s_or_b32 s76, s70, s71
s_cselect_b32 s10, 268435456, 0
s_cmp_lg_u32 s70, 0
s_cselect_b64 s[72:73], s[52:53], s[54:55]
s_cselect_b64 s[58:59], s[44:45], s[46:47]
s_mul_i32 s74, s72, s20
s_add_u32 s74, s74, s58
s_mul_i32 s75, s72, s21
s_add_u32 s75, s75, s59
s_andn2_b32 s71, s71, s70
s_add_u32 s52, s52, s70
s_add_u32 s54, s54, s71
s_mov_b32 s77, s76
g_go_76:
s_add_u32 m0, s48, 0
s_nop 0
buffer_load_dwordx4 v8, s[4:7], s74 offen offset:0 sc1 lds
buffer_load_dwordx4 v9, s[4:7], s74 offen offset:1024 sc1 lds
buffer_load_dwordx4 v10, s[4:7], s74 offen offset:2048 sc1 lds
buffer_load_dwordx4 v11, s[4:7], s74 offen offset:3072 sc1 lds
s_add_u32 m0, s48, 4096
s_nop 0
buffer_load_dwordx4 v12, s[4:7], s74 offen offset:0 sc1 lds
buffer_load_dwordx4 v13, s[4:7], s74 offen offset:1024 sc1 lds
buffer_load_dwordx4 v14, s[4:7], s74 offen offset:2048 sc1 lds
buffer_load_dwordx4 v15, s[4:7], s74 offen offset:3072 sc1 lds
s_add_u32 m0, s48, 8192
s_nop 0
buffer_load_dwordx4 v16, s[4:7], s74 offen offset:0 sc1 lds
buffer_load_dword v24, v22, s[4:7], 0 offen sc1
buffer_store_dword v27, v34, s[4:7], 0 offen
buffer_store_dword v27, v34, s[4:7], 0 offen
v_mov_b32 v27, s90
s_waitcnt vmcnt(10)
s_barrier
buffer_store_dword v27, v45, s[4:7], s91 offen
buffer_store_dword v27, v44, s[4:7], s91 offen sc1
s_mov_b32 s91, 1879048192
ds_read_b128 v[64:67], v28 offset:0
ds_read_b128 v[68:71], v28 offset:9216
ds_read_b128 v[72:75], v28 offset:18432
ds_read_b128 v[76:79], v28 offset:27648
ds_read_b128 v[80:83], v28 offset:1024
ds_read_b128 v[84:87], v28 offset:10240
ds_read_b128 v[88:91], v28 offset:19456
ds_read_b128 v[92:95], v28 offset:28672
s_waitcnt vmcnt(8)
s_barrier
s_branch g_body_48
g_fin_52:
buffer_store_dword v27, v45, s[4:7], s91 offen
buffer_store_dword v27, v44, s[4:7], s91 offen sc1
s_endpgm
G_sss18:
s_mov_b32 s8, s42
s_and_b32 s9, s43, 0xffff
s_mov_b32 s10, 0
s_mov_b32 s11, 0x20000
s_mov_b32 s22, 0
s_mul_i32 s48, s3, 9216
s_add_u32 s49, s48, 36864
s_add_u32 s50, s48, 73728
s_add_u32 s51, s48, 110592
s_mov_b32 s57, 0xbfb8aa3b
v_add_u32 v28, 0, v17
v_add_u32 v29, 36864, v17
v_add_u32 v30, 73728, v17
v_add_u32 v31, 110592, v17
v_lshlrev_b32 v1, 2, v0
v_add_u32 v32, 147456, v1
s_lshl_b32 s70, s3, 8
v_add_u32 v18, s70, v32
v_mov_b64 v[224:225], 0
v_mov_b64 v[236:237], 0
v_mov_b64 v[226:227], 0
v_mov_b64 v[238:239], 0
v_mov_b64 v[228:229], 0
v_mov_b64 v[240:241], 0
v_mov_b64 v[230:231], 0
v_mov_b64 v[242:243], 0
s_mov_b32 s12, s40
s_and_b32 s13, s41, 0xffff
s_mov_b32 s14, 256
s_mov_b32 s15, 0x20000
v_lshlrev_b32 v26, 2, v0
v_add_u32 v27, 128, v26
v_cmp_le_u32 vcc, 2, v0
s_nop 1
v_cndmask_b32 v26, v26, v27, vcc
v_mov_b32 v27, 192
v_cmp_eq_u32 vcc, 8, v0
s_nop 1
v_cndmask_b32 v26, v26, v27, vcc
v_mov_b32 v27, 2147483632
v_cmp_lt_u32 vcc, 8, v0
s_nop 1
v_cndmask_b32 v26, v26, v27, vcc
s_mov_b32 s98, 0
wi_loop_85:
buffer_load_dword v27, v26, s[12:15], 0 offen sc1
s_add_u32 s98, s98, 1
s_cmp_gt_u32 s98, 150000
s_cbranch_scc1 wi_bad_87
s_waitcnt vmcnt(0)
v_cmp_eq_u32 vcc, 32, v27
s_nop 0
s_and_b32 s97, vcc_lo, 0x1ff
s_cmp_eq_u32 s97, 0x1ff
s_cbranch_scc1 wi_ok_86
v_cmp_lt_u32 vcc, 32, v27
s_nop 0
s_and_b32 s96, vcc_lo, 0xff
s_cselect_b32 s96, 0x100, 0
s_and_b32 s96, s96, s97
s_cbranch_scc1 wi_over_88
s_sleep 8
s_branch wi_loop_85
wi_bad_87:
s_mov_b32 s98, 512
s_branch L_fail
wi_over_88:
s_mov_b32 s100, 255
wi_ok_86:
v_add_u32 v26, 65536, v22
v_cmp_eq_u32 vcc, s100, v23
s_nop 1
v_cndmask_b32 v22, v22, v26, vcc
s_mov_b32 s90, 0
s_mov_b32 s91, 1879048192
s_mov_b32 s93, 1879048192
v_mov_b32 v34, 2147483632
s_barrier
s_mov_b32 s95, 1
s_cmp_lg_u32 s3, 0
s_cbranch_scc1 sp_ok_90_j
s_mov_b32 s23, 0
sp_loop_89:
buffer_load_dword v33, v22, s[4:7], 0 offen sc1
s_add_u32 s23, s23, 1
s_cmp_gt_u32 s23, 150000
s_cbranch_scc1 sp_bad_91
s_waitcnt vmcnt(0)
sp_loop_89_e:
v_cmp_gt_u32 vcc, s52, v33
v_cmp_gt_u32 s[58:59], s54, v33
s_and_b32 vcc_lo, vcc_lo, s56
s_cbranch_scc0 sp_ok_90
s_cmp_gt_u32 s23, 4
s_cselect_b32 s70, 0, s56
s_cmp_lg_u32 s95, 0
s_cselect_b32 s70, 0, s70
s_or_b32 s59, s59, s70
s_and_b32 s59, s59, s56
s_cbranch_scc0 sp_ok_90
s_sleep 1
s_branch sp_loop_89
sp_bad_91:
s_mov_b32 s98, 1027
s_branch L_fail
sp_ok_90:
ds_write_b32 v18, v33
s_waitcnt lgkmcnt(0)
sp_ok_90_j:
s_barrier
ds_read_b32 v33, v32
s_waitcnt lgkmcnt(0)
v_cmp_gt_u32 vcc, s52, v33
v_cmp_gt_u32 s[58:59], s54, v33
s_and_b32 vcc_lo, vcc_lo, s56
s_cselect_b32 s70, 0, 1
s_and_b32 s59, s59, s56
s_cselect_b32 s71, 0, 1
s_or_b32 s76, s70, s71
s_cselect_b32 s10, 268435456, 0
s_cmp_lg_u32 s70, 0
s_cselect_b64 s[72:73], s[52:53], s[54:55]
s_cselect_b64 s[58:59], s[44:45], s[46:47]
s_mul_i32 s74, s72, s20
s_add_u32 s74, s74, s58
s_mul_i32 s75, s72, s21
s_add_u32 s75, s75, s59
s_andn2_b32 s71, s71, s70
s_add_u32 s52, s52, s70
s_add_u32 s54, s54, s71
s_mov_b32 s77, s76
s_add_u32 m0, s48, 0
s_nop 0
buffer_load_dwordx4 v8, s[4:7], s74 offen offset:0 sc1 lds
buffer_load_dwordx4 v9, s[4:7], s74 offen offset:1024 sc1 lds
buffer_load_dwordx4 v10, s[4:7], s74 offen offset:2048 sc1 lds
buffer_load_dwordx4 v11, s[4:7], s74 offen offset:3072 sc1 lds
s_add_u32 m0, s48, 4096
s_nop 0
buffer_load_dwordx4 v12, s[4:7], s74 offen offset:0 sc1 lds
buffer_load_dwordx4 v13, s[4:7], s74 offen offset:1024 sc1 lds
buffer_load_dwordx4 v14, s[4:7], s74 offen offset:2048 sc1 lds
buffer_load_dwordx4 v15, s[4:7], s74 offen offset:3072 sc1 lds
s_add_u32 m0, s48, 8192
s_nop 0
buffer_load_dwordx4 v16, s[4:7], s74 offen offset:0 sc1 lds
buffer_load_dword v24, v22, s[4:7], 0 offen sc1
buffer_store_dword v27, v34, s[4:7], 0 offen
buffer_store_dword v27, v34, s[4:7], 0 offen
v_mov_b32 v27, s90
s_waitcnt vmcnt(10)
s_barrier
buffer_store_dword v27, v45, s[4:7], s91 offen
buffer_store_dword v27, v44, s[4:7], s91 offen sc1
s_mov_b32 s91, 1879048192
ds_read_b128 v[64:67], v28 offset:0
ds_read_b128 v[68:71], v28 offset:9216
ds_read_b128 v[72:75], v28 offset:18432
ds_read_b128 v[76:79], v28 offset:27648
ds_read_b128 v[80:83], v28 offset:1024
ds_read_b128 v[84:87], v28 offset:10240
ds_read_b128 v[88:91], v28 offset:19456
ds_read_b128 v[92:95], v28 offset:28672
s_waitcnt vmcnt(8)
s_barrier
s_branch g_body_80
g_body_80:
s_waitcnt lgkmcnt(4)
v_mfma_f32_16x16x32_bf16 v[208:211], a[0:3], v[64:67], 0
ds_read_b128 v[96:99], v28 offset:2048
v_mfma_f32_16x16x32_bf16 v[212:215], a[0:3], v[68:71], 0
ds_read_b128 v[100:103], v28 offset:11264
v_mfma_f32_16x16x32_bf16 v[216:219], a[72:75], v[64:67], 0
v_mfma_f32_16x16x32_bf16 v[208:211], a[4:7], v[72:75], v[208:211]
ds_read_b128 v[104:107], v28 offset:20480
v_cvt_pk_bf16_f32 v56, v224, v225
v_mfma_f32_16x16x32_bf16 v[212:215], a[4:7], v[76:79], v[212:215]
ds_read_b128 v[108:111], v28 offset:29696
v_cvt_pk_bf16_f32 v57, v226, v227
v_mfma_f32_16x16x32_bf16 v[220:223], a[72:75], v[68:71], 0
v_cvt_pk_bf16_f32 v58, v228, v229
s_waitcnt lgkmcnt(4)
v_mfma_f32_16x16x32_bf16 v[208:211], a[8:11], v[80:83], v[208:211]
ds_read_b128 v[112:115], v28 offset:3072
v_cvt_pk_bf16_f32 v59, v230, v231
v_mfma_f32_16x16x32_bf16 v[212:215], a[8:11], v[84:87], v[212:215]
ds_read_b128 v[116:119], v28 offset:12288
v_permlane16_swap_b32 v56, v58
v_mfma_f32_16x16x32_bf16 v[216:219], a[76:79], v[72:75], v[216:219]
v_permlane16_swap_b32 v57, v59
v_mfma_f32_16x16x32_bf16 v[208:211], a[12:15], v[88:91], v[208:211]
ds_read_b128 v[120:123], v28 offset:21504
v_mfma_f32_16x16x32_bf16 v[212:215], a[12:15], v[92:95], v[212:215]
ds_read_b128 v[124:127], v28 offset:30720
v_mfma_f32_16x16x32_bf16 v[220:223], a[76:79], v[76:79], v[220:223]
s_waitcnt lgkmcnt(4)
v_mfma_f32_16x16x32_bf16 v[208:211], a[16:19], v[96:99], v[208:211]
ds_read_b128 v[128:131], v28 offset:4096
v_mfma_f32_16x16x32_bf16 v[212:215], a[16:19], v[100:103], v[212:215]
ds_read_b128 v[132:135], v28 offset:13312
v_mfma_f32_16x16x32_bf16 v[216:219], a[80:83], v[80:83], v[216:219]
buffer_store_dwordx4 v[56:59], v21, s[4:7], s93 offen sc1
v_mfma_f32_16x16x32_bf16 v[208:211], a[20:23], v[104:107], v[208:211]
ds_read_b128 v[136:139], v28 offset:22528
v_mov_b32 v27, s90
v_mfma_f32_16x16x32_bf16 v[212:215], a[20:23], v[108:111], v[212:215]
ds_read_b128 v[140:143], v28 offset:31744
v_mfma_f32_16x16x32_bf16 v[220:223], a[80:83], v[84:87], v[220:223]
s_waitcnt lgkmcnt(4)
v_mfma_f32_16x16x32_bf16 v[208:211], a[24:27], v[112:115], v[208:211]
ds_read_b128 v[144:147], v28 offset:5120
v_mfma_f32_16x16x32_bf16 v[212:215], a[24:27], v[116:119], v[212:215]
ds_read_b128 v[148:151], v28 offset:14336
v_mfma_f32_16x16x32_bf16 v[216:219], a[84:87], v[88:91], v[216:219]
v_mfma_f32_16x16x32_bf16 v[208:211], a[28:31], v[120:123], v[208:211]
ds_read_b128 v[152:155], v28 offset:23552
v_mfma_f32_16x16x32_bf16 v[212:215], a[28:31], v[124:127], v[212:215]
ds_read_b128 v[156:159], v28 offset:32768
v_mfma_f32_16x16x32_bf16 v[220:223], a[84:87], v[92:95], v[220:223]
s_waitcnt vmcnt(6)
s_barrier
s_waitcnt lgkmcnt(4)
v_mfma_f32_16x16x32_bf16 v[208:211], a[32:35], v[128:131], v[208:211]
ds_read_b128 v[160:163], v28 offset:6144
v_mfma_f32_16x16x32_bf16 v[212:215], a[32:35], v[132:135], v[212:215]
ds_read_b128 v[164:167], v28 offset:15360
s_waitcnt vmcnt(4)
ds_write_b32 v18, v24
v_mfma_f32_16x16x32_bf16 v[216:219], a[88:91], v[96:99], v[216:219]
v_mfma_f32_16x16x32_bf16 v[208:211], a[36:39], v[136:139], v[208:211]
ds_read_b128 v[168:171], v28 offset:24576
v_mfma_f32_16x16x32_bf16 v[212:215], a[36:39], v[140:143], v[212:215]
ds_read_b128 v[172:175], v28 offset:33792
s_waitcnt lgkmcnt(2)
s_barrier
v_mfma_f32_16x16x32_bf16 v[220:223], a[88:91], v[100:103], v[220:223]
ds_read_b32 v33, v32
v_mfma_f32_16x16x32_bf16 v[208:211], a[40:43], v[144:147], v[208:211]
ds_read_b128 v[176:179], v28 offset:7168
v_mfma_f32_16x16x32_bf16 v[212:215], a[40:43], v[148:151], v[212:215]
ds_read_b128 v[180:183], v28 offset:16384
v_mfma_f32_16x16x32_bf16 v[216:219], a[92:95], v[104:107], v[216:219]
s_waitcnt lgkmcnt(2)
v_cmp_gt_u32 vcc, s52, v33
v_mfma_f32_16x16x32_bf16 v[208:211], a[44:47], v[152:155], v[208:211]
ds_read_b128 v[184:187], v28 offset:25600
v_cmp_gt_u32 s[58:59], s54, v33
v_mfma_f32_16x16x32_bf16 v[212:215], a[44:47], v[156:159], v[212:215]
ds_read_b128 v[188:191], v28 offset:34816
s_and_b32 vcc_lo, vcc_lo, s56
s_cselect_b32 s70, 0, 1
v_mfma_f32_16x16x32_bf16 v[220:223], a[92:95], v[108:111], v[220:223]
s_and_b32 s59, s59, s56
s_cselect_b32 s71, 0, s77
v_mfma_f32_16x16x32_bf16 v[208:211], a[48:51], v[160:163], v[208:211]
ds_read_b128 v[192:195], v28 offset:8192
s_or_b32 s82, s70, s71
s_cselect_b32 s10, 268435456, 0
v_mfma_f32_16x16x32_bf16 v[212:215], a[48:51], v[164:167], v[212:215]
ds_read_b128 v[196:199], v28 offset:17408
v_mfma_f32_16x16x32_bf16 v[216:219], a[96:99], v[112:115], v[216:219]
s_cmp_lg_u32 s70, 0
s_cselect_b64 s[78:79], s[52:53], s[54:55]
s_cselect_b64 s[58:59], s[44:45], s[46:47]
s_mul_i32 s80, s78, s20
v_mfma_f32_16x16x32_bf16 v[208:211], a[52:55], v[168:171], v[208:211]
ds_read_b128 v[200:203], v28 offset:26624
s_add_u32 s80, s80, s58
v_mfma_f32_16x16x32_bf16 v[212:215], a[52:55], v[172:175], v[212:215]
ds_read_b128 v[204:207], v28 offset:35840
s_add_u32 m0, s49, 0
v_mfma_f32_16x16x32_bf16 v[220:223], a[96:99], v[116:119], v[220:223]
buffer_load_dwordx4 v8, s[8:11], s80 offen offset:0 sc1 lds
s_waitcnt lgkmcnt(4)
v_mfma_f32_16x16x32_bf16 v[208:211], a[56:59], v[176:179], v[208:211]
s_mul_i32 s81, s78, s21
s_add_u32 s81, s81, s59
s_andn2_b32 s71, s71, s70
v_mfma_f32_16x16x32_bf16 v[212:215], a[56:59], v[180:183], v[212:215]
s_add_u32 s52, s52, s70
s_add_u32 s54, s54, s71
s_mov_b32 s83, s82
v_mfma_f32_16x16x32_bf16 v[216:219], a[100:103], v[120:123], v[216:219]
buffer_load_dwordx4 v9, s[8:11], s80 offen offset:1024 sc1 lds
v_mfma_f32_16x16x32_bf16 v[208:211], a[60:63], v[184:187], v[208:211]
v_mfma_f32_16x16x32_bf16 v[212:215], a[60:63], v[188:191], v[212:215]
v_mfma_f32_16x16x32_bf16 v[220:223], a[100:103], v[124:127], v[220:223]
buffer_load_dwordx4 v10, s[8:11], s80 offen offset:2048 sc1 lds
s_waitcnt lgkmcnt(0)
v_mfma_f32_16x16x32_bf16 v[208:211], a[64:67], v[192:195], v[208:211]
v_mfma_f32_16x16x32_bf16 v[212:215], a[64:67], v[196:199], v[212:215]
v_mfma_f32_16x16x32_bf16 v[216:219], a[104:107], v[128:131], v[216:219]
buffer_load_dwordx4 v11, s[8:11], s80 offen offset:3072 sc1 lds
v_mfma_f32_16x16x32_bf16 v[208:211], a[68:71], v[200:203], v[208:211]
v_mfma_f32_16x16x32_bf16 v[212:215], a[68:71], v[204:207], v[212:215]
s_add_u32 m0, s49, 4096
v_mfma_f32_16x16x32_bf16 v[220:223], a[104:107], v[132:135], v[220:223]
buffer_load_dwordx4 v12, s[8:11], s80 offen offset:0 sc1 lds
v_mfma_f32_16x16x32_bf16 v[216:219], a[108:111], v[136:139], v[216:219]
v_mfma_f32_16x16x32_bf16 v[220:223], a[108:111], v[140:143], v[220:223]
v_mfma_f32_16x16x32_bf16 v[216:219], a[112:115], v[144:147], v[216:219]
buffer_load_dwordx4 v13, s[8:11], s80 offen offset:1024 sc1 lds
v_mfma_f32_16x16x32_bf16 v[220:223], a[112:115], v[148:151], v[220:223]
v_mfma_f32_16x16x32_bf16 v[216:219], a[116:119], v[152:155], v[216:219]
v_cvt_pk_bf16_f32 v48, v208, v209
v_cvt_pk_bf16_f32 v49, v210, v211
v_mfma_f32_16x16x32_bf16 v[220:223], a[116:119], v[156:159], v[220:223]
buffer_load_dwordx4 v14, s[8:11], s80 offen offset:2048 sc1 lds
v_mfma_f32_16x16x32_bf16 v[216:219], a[120:123], v[160:163], v[216:219]
v_cvt_pk_bf16_f32 v50, v212, v213
v_cvt_pk_bf16_f32 v51, v214, v215
v_mfma_f32_16x16x32_bf16 v[220:223], a[120:123], v[164:167], v[220:223]
v_permlane16_swap_b32 v48, v50
v_mfma_f32_16x16x32_bf16 v[216:219], a[124:127], v[168:171], v[216:219]
buffer_load_dwordx4 v15, s[8:11], s80 offen offset:3072 sc1 lds
v_mfma_f32_16x16x32_bf16 v[220:223], a[124:127], v[172:175], v[220:223]
v_permlane16_swap_b32 v49, v51
v_mfma_f32_16x16x32_bf16 v[216:219], a[128:131], v[176:179], v[216:219]
s_add_u32 m0, s49, 8192
v_mfma_f32_16x16x32_bf16 v[220:223], a[128:131], v[180:183], v[220:223]
buffer_load_dwordx4 v16, s[8:11], s80 offen offset:0 sc1 lds
v_mfma_f32_16x16x32_bf16 v[216:219], a[132:135], v[184:187], v[216:219]
buffer_store_dwordx4 v[48:51], v19, s[4:7], s75 offen sc1
v_mfma_f32_16x16x32_bf16 v[220:223], a[132:135], v[188:191], v[220:223]
v_mfma_f32_16x16x32_bf16 v[216:219], a[136:139], v[192:195], v[216:219]
v_mfma_f32_16x16x32_bf16 v[220:223], a[136:139], v[196:199], v[220:223]
v_mfma_f32_16x16x32_bf16 v[216:219], a[140:143], v[200:203], v[216:219]
v_mfma_f32_16x16x32_bf16 v[220:223], a[140:143], v[204:207], v[220:223]
v_mfma_f32_16x16x32_bf16 v[224:227], a[144:147], v[64:67], 0
v_mfma_f32_16x16x32_bf16 v[228:231], a[144:147], v[68:71], 0
v_mfma_f32_16x16x32_bf16 v[224:227], a[148:151], v[72:75], v[224:227]
v_mfma_f32_16x16x32_bf16 v[228:231], a[148:151], v[76:79], v[228:231]
v_mfma_f32_16x16x32_bf16 v[224:227], a[152:155], v[80:83], v[224:227]
buffer_load_dword v24, v22, s[4:7], 0 offen sc1
v_mfma_f32_16x16x32_bf16 v[228:231], a[152:155], v[84:87], v[228:231]
v_cvt_pk_bf16_f32 v52, v216, v217
v_cvt_pk_bf16_f32 v53, v218, v219
v_mfma_f32_16x16x32_bf16 v[224:227], a[156:159], v[88:91], v[224:227]
s_waitcnt vmcnt(11)
s_barrier
v_mfma_f32_16x16x32_bf16 v[228:231], a[156:159], v[92:95], v[228:231]
buffer_store_dword v27, v45, s[4:7], s91 offen
v_mfma_f32_16x16x32_bf16 v[224:227], a[160:163], v[96:99], v[224:227]
buffer_store_dword v27, v44, s[4:7], s91 offen sc1
v_mfma_f32_16x16x32_bf16 v[228:231], a[160:163], v[100:103], v[228:231]
v_cvt_pk_bf16_f32 v54, v220, v221
v_cvt_pk_bf16_f32 v55, v222, v223
v_mfma_f32_16x16x32_bf16 v[224:227], a[164:167], v[104:107], v[224:227]
v_permlane16_swap_b32 v52, v54
v_mfma_f32_16x16x32_bf16 v[228:231], a[164:167], v[108:111], v[228:231]
v_permlane16_swap_b32 v53, v55
v_mfma_f32_16x16x32_bf16 v[224:227], a[168:171], v[112:115], v[224:227]
buffer_store_dwordx4 v[52:55], v20, s[4:7], s75 offen sc1
v_mfma_f32_16x16x32_bf16 v[228:231], a[168:171], v[116:119], v[228:231]
v_mfma_f32_16x16x32_bf16 v[224:227], a[172:175], v[120:123], v[224:227]
v_mfma_f32_16x16x32_bf16 v[228:231], a[172:175], v[124:127], v[228:231]
v_mfma_f32_16x16x32_bf16 v[224:227], a[176:179], v[128:131], v[224:227]
v_mfma_f32_16x16x32_bf16 v[228:231], a[176:179], v[132:135], v[228:231]
v_mfma_f32_16x16x32_bf16 v[224:227], a[180:183], v[136:139], v[224:227]
v_mfma_f32_16x16x32_bf16 v[228:231], a[180:183], v[140:143], v[228:231]
v_mfma_f32_16x16x32_bf16 v[224:227], a[184:187], v[144:147], v[224:227]
v_mfma_f32_16x16x32_bf16 v[228:231], a[184:187], v[148:151], v[228:231]
v_mfma_f32_16x16x32_bf16 v[224:227], a[188:191], v[152:155], v[224:227]
v_mfma_f32_16x16x32_bf16 v[228:231], a[188:191], v[156:159], v[228:231]
v_mfma_f32_16x16x32_bf16 v[224:227], a[192:195], v[160:163], v[224:227]
s_waitcnt vmcnt(12)
s_barrier
v_mfma_f32_16x16x32_bf16 v[228:231], a[192:195], v[164:167], v[228:231]
v_mfma_f32_16x16x32_bf16 v[224:227], a[196:199], v[168:171], v[224:227]
s_cmp_eq_u32 s82, 0
s_cbranch_scc1 g_slow_92
v_mfma_f32_16x16x32_bf16 v[228:231], a[196:199], v[172:175], v[228:231]
ds_read_b128 v[64:67], v29 offset:0
v_mfma_f32_16x16x32_bf16 v[224:227], a[200:203], v[176:179], v[224:227]
ds_read_b128 v[68:71], v29 offset:9216
v_mfma_f32_16x16x32_bf16 v[228:231], a[200:203], v[180:183], v[228:231]
ds_read_b128 v[72:75], v29 offset:18432
v_mfma_f32_16x16x32_bf16 v[224:227], a[204:207], v[184:187], v[224:227]
ds_read_b128 v[76:79], v29 offset:27648
v_mfma_f32_16x16x32_bf16 v[228:231], a[204:207], v[188:191], v[228:231]
ds_read_b128 v[80:83], v29 offset:1024
v_mfma_f32_16x16x32_bf16 v[224:227], a[208:211], v[192:195], v[224:227]
ds_read_b128 v[84:87], v29 offset:10240
v_mfma_f32_16x16x32_bf16 v[228:231], a[208:211], v[196:199], v[228:231]
ds_read_b128 v[88:91], v29 offset:19456
v_mfma_f32_16x16x32_bf16 v[224:227], a[212:215], v[200:203], v[224:227]
ds_read_b128 v[92:95], v29 offset:28672
v_mfma_f32_16x16x32_bf16 v[228:231], a[212:215], v[204:207], v[228:231]
s_waitcnt vmcnt(8)
s_barrier
g_body_81:
s_waitcnt lgkmcnt(4)
v_mfma_f32_16x16x32_bf16 v[208:211], a[0:3], v[64:67], 0
ds_read_b128 v[96:99], v29 offset:2048
v_mfma_f32_16x16x32_bf16 v[212:215], a[0:3], v[68:71], 0
ds_read_b128 v[100:103], v29 offset:11264
v_mfma_f32_16x16x32_bf16 v[216:219], a[72:75], v[64:67], 0
v_mfma_f32_16x16x32_bf16 v[208:211], a[4:7], v[72:75], v[208:211]
ds_read_b128 v[104:107], v29 offset:20480
v_cvt_pk_bf16_f32 v56, v224, v225
v_mfma_f32_16x16x32_bf16 v[212:215], a[4:7], v[76:79], v[212:215]
ds_read_b128 v[108:111], v29 offset:29696
v_cvt_pk_bf16_f32 v57, v226, v227
v_mfma_f32_16x16x32_bf16 v[220:223], a[72:75], v[68:71], 0
v_cvt_pk_bf16_f32 v58, v228, v229
s_waitcnt lgkmcnt(4)
v_mfma_f32_16x16x32_bf16 v[208:211], a[8:11], v[80:83], v[208:211]
ds_read_b128 v[112:115], v29 offset:3072
v_cvt_pk_bf16_f32 v59, v230, v231
v_mfma_f32_16x16x32_bf16 v[212:215], a[8:11], v[84:87], v[212:215]
ds_read_b128 v[116:119], v29 offset:12288
v_permlane16_swap_b32 v56, v58
v_mfma_f32_16x16x32_bf16 v[216:219], a[76:79], v[72:75], v[216:219]
v_permlane16_swap_b32 v57, v59
v_mfma_f32_16x16x32_bf16 v[208:211], a[12:15], v[88:91], v[208:211]
ds_read_b128 v[120:123], v29 offset:21504
v_mfma_f32_16x16x32_bf16 v[212:215], a[12:15], v[92:95], v[212:215]
ds_read_b128 v[124:127], v29 offset:30720
v_mfma_f32_16x16x32_bf16 v[220:223], a[76:79], v[76:79], v[220:223]
s_waitcnt lgkmcnt(4)
v_mfma_f32_16x16x32_bf16 v[208:211], a[16:19], v[96:99], v[208:211]
ds_read_b128 v[128:131], v29 offset:4096
v_mfma_f32_16x16x32_bf16 v[212:215], a[16:19], v[100:103], v[212:215]
ds_read_b128 v[132:135], v29 offset:13312
v_mfma_f32_16x16x32_bf16 v[216:219], a[80:83], v[80:83], v[216:219]
buffer_store_dwordx4 v[56:59], v21, s[4:7], s75 offen sc1
v_mfma_f32_16x16x32_bf16 v[208:211], a[20:23], v[104:107], v[208:211]
ds_read_b128 v[136:139], v29 offset:22528
v_mov_b32 v27, s72
v_mfma_f32_16x16x32_bf16 v[212:215], a[20:23], v[108:111], v[212:215]
ds_read_b128 v[140:143], v29 offset:31744
v_mfma_f32_16x16x32_bf16 v[220:223], a[80:83], v[84:87], v[220:223]
s_waitcnt lgkmcnt(4)
v_mfma_f32_16x16x32_bf16 v[208:211], a[24:27], v[112:115], v[208:211]
ds_read_b128 v[144:147], v29 offset:5120
v_mfma_f32_16x16x32_bf16 v[212:215], a[24:27], v[116:119], v[212:215]
ds_read_b128 v[148:151], v29 offset:14336
v_mfma_f32_16x16x32_bf16 v[216:219], a[84:87], v[88:91], v[216:219]
v_mfma_f32_16x16x32_bf16 v[208:211], a[28:31], v[120:123], v[208:211]
ds_read_b128 v[152:155], v29 offset:23552
v_mfma_f32_16x16x32_bf16 v[212:215], a[28:31], v[124:127], v[212:215]
ds_read_b128 v[156:159], v29 offset:32768
v_mfma_f32_16x16x32_bf16 v[220:223], a[84:87], v[92:95], v[220:223]
s_waitcnt vmcnt(6)
s_barrier
s_waitcnt lgkmcnt(4)
v_mfma_f32_16x16x32_bf16 v[208:211], a[32:35], v[128:131], v[208:211]
ds_read_b128 v[160:163], v29 offset:6144
v_mfma_f32_16x16x32_bf16 v[212:215], a[32:35], v[132:135], v[212:215]
ds_read_b128 v[164:167], v29 offset:15360
s_waitcnt vmcnt(4)
ds_write_b32 v18, v24
v_mfma_f32_16x16x32_bf16 v[216:219], a[88:91], v[96:99], v[216:219]
v_mfma_f32_16x16x32_bf16 v[208:211], a[36:39], v[136:139], v[208:211]
ds_read_b128 v[168:171], v29 offset:24576
v_mfma_f32_16x16x32_bf16 v[212:215], a[36:39], v[140:143], v[212:215]
ds_read_b128 v[172:175], v29 offset:33792
s_waitcnt lgkmcnt(2)
s_barrier
v_mfma_f32_16x16x32_bf16 v[220:223], a[88:91], v[100:103], v[220:223]
ds_read_b32 v33, v32
v_mfma_f32_16x16x32_bf16 v[208:211], a[40:43], v[144:147], v[208:211]
ds_read_b128 v[176:179], v29 offset:7168
v_mfma_f32_16x16x32_bf16 v[212:215], a[40:43], v[148:151], v[212:215]
ds_read_b128 v[180:183], v29 offset:16384
v_mfma_f32_16x16x32_bf16 v[216:219], a[92:95], v[104:107], v[216:219]
s_waitcnt lgkmcnt(2)
v_cmp_gt_u32 vcc, s52, v33
v_mfma_f32_16x16x32_bf16 v[208:211], a[44:47], v[152:155], v[208:211]
ds_read_b128 v[184:187], v29 offset:25600
v_cmp_gt_u32 s[58:59], s54, v33
v_mfma_f32_16x16x32_bf16 v[212:215], a[44:47], v[156:159], v[212:215]
ds_read_b128 v[188:191], v29 offset:34816
s_and_b32 vcc_lo, vcc_lo, s56
s_cselect_b32 s70, 0, 1
v_mfma_f32_16x16x32_bf16 v[220:223], a[92:95], v[108:111], v[220:223]
s_and_b32 s59, s59, s56
s_cselect_b32 s71, 0, s83
v_mfma_f32_16x16x32_bf16 v[208:211], a[48:51], v[160:163], v[208:211]
ds_read_b128 v[192:195], v29 offset:8192
s_or_b32 s88, s70, s71
s_cselect_b32 s10, 268435456, 0
v_mfma_f32_16x16x32_bf16 v[212:215], a[48:51], v[164:167], v[212:215]
ds_read_b128 v[196:199], v29 offset:17408
v_mfma_f32_16x16x32_bf16 v[216:219], a[96:99], v[112:115], v[216:219]
s_cmp_lg_u32 s70, 0
s_cselect_b64 s[84:85], s[52:53], s[54:55]
s_cselect_b64 s[58:59], s[44:45], s[46:47]
s_mul_i32 s86, s84, s20
v_mfma_f32_16x16x32_bf16 v[208:211], a[52:55], v[168:171], v[208:211]
ds_read_b128 v[200:203], v29 offset:26624
s_add_u32 s86, s86, s58
v_mfma_f32_16x16x32_bf16 v[212:215], a[52:55], v[172:175], v[212:215]
ds_read_b128 v[204:207], v29 offset:35840
s_add_u32 m0, s50, 0
v_mfma_f32_16x16x32_bf16 v[220:223], a[96:99], v[116:119], v[220:223]
buffer_load_dwordx4 v8, s[8:11], s86 offen offset:0 sc1 lds
s_waitcnt lgkmcnt(4)
v_mfma_f32_16x16x32_bf16 v[208:211], a[56:59], v[176:179], v[208:211]
s_mul_i32 s87, s84, s21
s_add_u32 s87, s87, s59
s_andn2_b32 s71, s71, s70
v_mfma_f32_16x16x32_bf16 v[212:215], a[56:59], v[180:183], v[212:215]
s_add_u32 s52, s52, s70
s_add_u32 s54, s54, s71
s_mov_b32 s89, s88
v_mfma_f32_16x16x32_bf16 v[216:219], a[100:103], v[120:123], v[216:219]
buffer_load_dwordx4 v9, s[8:11], s86 offen offset:1024 sc1 lds
v_mfma_f32_16x16x32_bf16 v[208:211], a[60:63], v[184:187], v[208:211]
v_mfma_f32_16x16x32_bf16 v[212:215], a[60:63], v[188:191], v[212:215]
v_mfma_f32_16x16x32_bf16 v[220:223], a[100:103], v[124:127], v[220:223]
buffer_load_dwordx4 v10, s[8:11], s86 offen offset:2048 sc1 lds
s_waitcnt lgkmcnt(0)
v_mfma_f32_16x16x32_bf16 v[208:211], a[64:67], v[192:195], v[208:211]
v_mfma_f32_16x16x32_bf16 v[212:215], a[64:67], v[196:199], v[212:215]
v_mfma_f32_16x16x32_bf16 v[216:219], a[104:107], v[128:131], v[216:219]
buffer_load_dwordx4 v11, s[8:11], s86 offen offset:3072 sc1 lds
v_mfma_f32_16x16x32_bf16 v[208:211], a[68:71], v[200:203], v[208:211]
v_mfma_f32_16x16x32_bf16 v[212:215], a[68:71], v[204:207], v[212:215]
s_add_u32 m0, s50, 4096
v_mfma_f32_16x16x32_bf16 v[220:223], a[104:107], v[132:135], v[220:223]
buffer_load_dwordx4 v12, s[8:11], s86 offen offset:0 sc1 lds
v_mfma_f32_16x16x32_bf16 v[216:219], a[108:111], v[136:139], v[216:219]
v_mfma_f32_16x16x32_bf16 v[220:223], a[108:111], v[140:143], v[220:223]
v_mfma_f32_16x16x32_bf16 v[216:219], a[112:115], v[144:147], v[216:219]
buffer_load_dwordx4 v13, s[8:11], s86 offen offset:1024 sc1 lds
v_mfma_f32_16x16x32_bf16 v[220:223], a[112:115], v[148:151], v[220:223]
v_mfma_f32_16x16x32_bf16 v[216:219], a[116:119], v[152:155], v[216:219]
v_cvt_pk_bf16_f32 v48, v208, v209
v_cvt_pk_bf16_f32 v49, v210, v211
v_mfma_f32_16x16x32_bf16 v[220:223], a[116:119], v[156:159], v[220:223]
buffer_load_dwordx4 v14, s[8:11], s86 offen offset:2048 sc1 lds
v_mfma_f32_16x16x32_bf16 v[216:219], a[120:123], v[160:163], v[216:219]
v_cvt_pk_bf16_f32 v50, v212, v213
v_cvt_pk_bf16_f32 v51, v214, v215
v_mfma_f32_16x16x32_bf16 v[220:223], a[120:123], v[164:167], v[220:223]
v_permlane16_swap_b32 v48, v50
v_mfma_f32_16x16x32_bf16 v[216:219], a[124:127], v[168:171], v[216:219]
buffer_load_dwordx4 v15, s[8:11], s86 offen offset:3072 sc1 lds
v_mfma_f32_16x16x32_bf16 v[220:223], a[124:127], v[172:175], v[220:223]
v_permlane16_swap_b32 v49, v51
v_mfma_f32_16x16x32_bf16 v[216:219], a[128:131], v[176:179], v[216:219]
s_add_u32 m0, s50, 8192
v_mfma_f32_16x16x32_bf16 v[220:223], a[128:131], v[180:183], v[220:223]
buffer_load_dwordx4 v16, s[8:11], s86 offen offset:0 sc1 lds
v_mfma_f32_16x16x32_bf16 v[216:219], a[132:135], v[184:187], v[216:219]
buffer_store_dwordx4 v[48:51], v19, s[4:7], s81 offen sc1
v_mfma_f32_16x16x32_bf16 v[220:223], a[132:135], v[188:191], v[220:223]
v_mfma_f32_16x16x32_bf16 v[216:219], a[136:139], v[192:195], v[216:219]
v_mfma_f32_16x16x32_bf16 v[220:223], a[136:139], v[196:199], v[220:223]
v_mfma_f32_16x16x32_bf16 v[216:219], a[140:143], v[200:203], v[216:219]
v_mfma_f32_16x16x32_bf16 v[220:223], a[140:143], v[204:207], v[220:223]
v_mfma_f32_16x16x32_bf16 v[224:227], a[144:147], v[64:67], 0
v_mfma_f32_16x16x32_bf16 v[228:231], a[144:147], v[68:71], 0
v_mfma_f32_16x16x32_bf16 v[224:227], a[148:151], v[72:75], v[224:227]
v_mfma_f32_16x16x32_bf16 v[228:231], a[148:151], v[76:79], v[228:231]
v_mfma_f32_16x16x32_bf16 v[224:227], a[152:155], v[80:83], v[224:227]
buffer_load_dword v24, v22, s[4:7], 0 offen sc1
v_mfma_f32_16x16x32_bf16 v[228:231], a[152:155], v[84:87], v[228:231]
v_cvt_pk_bf16_f32 v52, v216, v217
v_cvt_pk_bf16_f32 v53, v218, v219
v_mfma_f32_16x16x32_bf16 v[224:227], a[156:159], v[88:91], v[224:227]
s_waitcnt vmcnt(11)
s_barrier
v_mfma_f32_16x16x32_bf16 v[228:231], a[156:159], v[92:95], v[228:231]
buffer_store_dword v27, v45, s[4:7], s73 offen
v_mfma_f32_16x16x32_bf16 v[224:227], a[160:163], v[96:99], v[224:227]
buffer_store_dword v27, v44, s[4:7], s73 offen sc1
v_mfma_f32_16x16x32_bf16 v[228:231], a[160:163], v[100:103], v[228:231]
v_cvt_pk_bf16_f32 v54, v220, v221
v_cvt_pk_bf16_f32 v55, v222, v223
v_mfma_f32_16x16x32_bf16 v[224:227], a[164:167], v[104:107], v[224:227]
v_permlane16_swap_b32 v52, v54
v_mfma_f32_16x16x32_bf16 v[228:231], a[164:167], v[108:111], v[228:231]
v_permlane16_swap_b32 v53, v55
v_mfma_f32_16x16x32_bf16 v[224:227], a[168:171], v[112:115], v[224:227]
buffer_store_dwordx4 v[52:55], v20, s[4:7], s81 offen sc1
v_mfma_f32_16x16x32_bf16 v[228:231], a[168:171], v[116:119], v[228:231]
v_mfma_f32_16x16x32_bf16 v[224:227], a[172:175], v[120:123], v[224:227]
v_mfma_f32_16x16x32_bf16 v[228:231], a[172:175], v[124:127], v[228:231]
v_mfma_f32_16x16x32_bf16 v[224:227], a[176:179], v[128:131], v[224:227]
v_mfma_f32_16x16x32_bf16 v[228:231], a[176:179], v[132:135], v[228:231]
v_mfma_f32_16x16x32_bf16 v[224:227], a[180:183], v[136:139], v[224:227]
v_mfma_f32_16x16x32_bf16 v[228:231], a[180:183], v[140:143], v[228:231]
v_mfma_f32_16x16x32_bf16 v[224:227], a[184:187], v[144:147], v[224:227]
v_mfma_f32_16x16x32_bf16 v[228:231], a[184:187], v[148:151], v[228:231]
v_mfma_f32_16x16x32_bf16 v[224:227], a[188:191], v[152:155], v[224:227]
v_mfma_f32_16x16x32_bf16 v[228:231], a[188:191], v[156:159], v[228:231]
v_mfma_f32_16x16x32_bf16 v[224:227], a[192:195], v[160:163], v[224:227]
s_waitcnt vmcnt(12)
s_barrier
v_mfma_f32_16x16x32_bf16 v[228:231], a[192:195], v[164:167], v[228:231]
v_mfma_f32_16x16x32_bf16 v[224:227], a[196:199], v[168:171], v[224:227]
s_cmp_eq_u32 s88, 0
s_cbranch_scc1 g_slow_93
v_mfma_f32_16x16x32_bf16 v[228:231], a[196:199], v[172:175], v[228:231]
ds_read_b128 v[64:67], v30 offset:0
v_mfma_f32_16x16x32_bf16 v[224:227], a[200:203], v[176:179], v[224:227]
ds_read_b128 v[68:71], v30 offset:9216
v_mfma_f32_16x16x32_bf16 v[228:231], a[200:203], v[180:183], v[228:231]
ds_read_b128 v[72:75], v30 offset:18432
v_mfma_f32_16x16x32_bf16 v[224:227], a[204:207], v[184:187], v[224:227]
ds_read_b128 v[76:79], v30 offset:27648
v_mfma_f32_16x16x32_bf16 v[228:231], a[204:207], v[188:191], v[228:231]
ds_read_b128 v[80:83], v30 offset:1024
v_mfma_f32_16x16x32_bf16 v[224:227], a[208:211], v[192:195], v[224:227]
ds_read_b128 v[84:87], v30 offset:10240
v_mfma_f32_16x16x32_bf16 v[228:231], a[208:211], v[196:199], v[228:231]
ds_read_b128 v[88:91], v30 offset:19456
v_mfma_f32_16x16x32_bf16 v[224:227], a[212:215], v[200:203], v[224:227]
ds_read_b128 v[92:95], v30 offset:28672
v_mfma_f32_16x16x32_bf16 v[228:231], a[212:215], v[204:207], v[228:231]
s_waitcnt vmcnt(8)
s_barrier
g_body_82:
s_waitcnt lgkmcnt(4)
v_mfma_f32_16x16x32_bf16 v[208:211], a[0:3], v[64:67], 0
ds_read_b128 v[96:99], v30 offset:2048
v_mfma_f32_16x16x32_bf16 v[212:215], a[0:3], v[68:71], 0
ds_read_b128 v[100:103], v30 offset:11264
v_mfma_f32_16x16x32_bf16 v[216:219], a[72:75], v[64:67], 0
v_mfma_f32_16x16x32_bf16 v[208:211], a[4:7], v[72:75], v[208:211]
ds_read_b128 v[104:107], v30 offset:20480
v_cvt_pk_bf16_f32 v56, v224, v225
v_mfma_f32_16x16x32_bf16 v[212:215], a[4:7], v[76:79], v[212:215]
ds_read_b128 v[108:111], v30 offset:29696
v_cvt_pk_bf16_f32 v57, v226, v227
v_mfma_f32_16x16x32_bf16 v[220:223], a[72:75], v[68:71], 0
v_cvt_pk_bf16_f32 v58, v228, v229
s_waitcnt lgkmcnt(4)
v_mfma_f32_16x16x32_bf16 v[208:211], a[8:11], v[80:83], v[208:211]
ds_read_b128 v[112:115], v30 offset:3072
v_cvt_pk_bf16_f32 v59, v230, v231
v_mfma_f32_16x16x32_bf16 v[212:215], a[8:11], v[84:87], v[212:215]
ds_read_b128 v[116:119], v30 offset:12288
v_permlane16_swap_b32 v56, v58
v_mfma_f32_16x16x32_bf16 v[216:219], a[76:79], v[72:75], v[216:219]
v_permlane16_swap_b32 v57, v59
v_mfma_f32_16x16x32_bf16 v[208:211], a[12:15], v[88:91], v[208:211]
ds_read_b128 v[120:123], v30 offset:21504
v_mfma_f32_16x16x32_bf16 v[212:215], a[12:15], v[92:95], v[212:215]
ds_read_b128 v[124:127], v30 offset:30720
v_mfma_f32_16x16x32_bf16 v[220:223], a[76:79], v[76:79], v[220:223]
s_waitcnt lgkmcnt(4)
v_mfma_f32_16x16x32_bf16 v[208:211], a[16:19], v[96:99], v[208:211]
ds_read_b128 v[128:131], v30 offset:4096
v_mfma_f32_16x16x32_bf16 v[212:215], a[16:19], v[100:103], v[212:215]
ds_read_b128 v[132:135], v30 offset:13312
v_mfma_f32_16x16x32_bf16 v[216:219], a[80:83], v[80:83], v[216:219]
buffer_store_dwordx4 v[56:59], v21, s[4:7], s81 offen sc1
v_mfma_f32_16x16x32_bf16 v[208:211], a[20:23], v[104:107], v[208:211]
ds_read_b128 v[136:139], v30 offset:22528
v_mov_b32 v27, s78
v_mfma_f32_16x16x32_bf16 v[212:215], a[20:23], v[108:111], v[212:215]
ds_read_b128 v[140:143], v30 offset:31744
v_mfma_f32_16x16x32_bf16 v[220:223], a[80:83], v[84:87], v[220:223]
s_waitcnt lgkmcnt(4)
v_mfma_f32_16x16x32_bf16 v[208:211], a[24:27], v[112:115], v[208:211]
ds_read_b128 v[144:147], v30 offset:5120
v_mfma_f32_16x16x32_bf16 v[212:215], a[24:27], v[116:119], v[212:215]
ds_read_b128 v[148:151], v30 offset:14336
v_mfma_f32_16x16x32_bf16 v[216:219], a[84:87], v[88:91], v[216:219]
v_mfma_f32_16x16x32_bf16 v[208:211], a[28:31], v[120:123], v[208:211]
ds_read_b128 v[152:155], v30 offset:23552
v_mfma_f32_16x16x32_bf16 v[212:215], a[28:31], v[124:127], v[212:215]
ds_read_b128 v[156:159], v30 offset:32768
v_mfma_f32_16x16x32_bf16 v[220:223], a[84:87], v[92:95], v[220:223]
s_waitcnt vmcnt(6)
s_barrier
s_waitcnt lgkmcnt(4)
v_mfma_f32_16x16x32_bf16 v[208:211], a[32:35], v[128:131], v[208:211]
ds_read_b128 v[160:163], v30 offset:6144
v_mfma_f32_16x16x32_bf16 v[212:215], a[32:35], v[132:135], v[212:215]
ds_read_b128 v[164:167], v30 offset:15360
s_waitcnt vmcnt(4)
ds_write_b32 v18, v24
v_mfma_f32_16x16x32_bf16 v[216:219], a[88:91], v[96:99], v[216:219]
v_mfma_f32_16x16x32_bf16 v[208:211], a[36:39], v[136:139], v[208:211]
ds_read_b128 v[168:171], v30 offset:24576
v_mfma_f32_16x16x32_bf16 v[212:215], a[36:39], v[140:143], v[212:215]
ds_read_b128 v[172:175], v30 offset:33792
s_waitcnt lgkmcnt(2)
s_barrier
v_mfma_f32_16x16x32_bf16 v[220:223], a[88:91], v[100:103], v[220:223]
ds_read_b32 v33, v32
v_mfma_f32_16x16x32_bf16 v[208:211], a[40:43], v[144:147], v[208:211]
ds_read_b128 v[176:179], v30 offset:7168
v_mfma_f32_16x16x32_bf16 v[212:215], a[40:43], v[148:151], v[212:215]
ds_read_b128 v[180:183], v30 offset:16384
v_mfma_f32_16x16x32_bf16 v[216:219], a[92:95], v[104:107], v[216:219]
s_waitcnt lgkmcnt(2)
v_cmp_gt_u32 vcc, s52, v33
v_mfma_f32_16x16x32_bf16 v[208:211], a[44:47], v[152:155], v[208:211]
ds_read_b128 v[184:187], v30 offset:25600
v_cmp_gt_u32 s[58:59], s54, v33
v_mfma_f32_16x16x32_bf16 v[212:215], a[44:47], v[156:159], v[212:215]
ds_read_b128 v[188:191], v30 offset:34816
s_and_b32 vcc_lo, vcc_lo, s56
s_cselect_b32 s70, 0, 1
v_mfma_f32_16x16x32_bf16 v[220:223], a[92:95], v[108:111], v[220:223]
s_and_b32 s59, s59, s56
s_cselect_b32 s71, 0, s89
v_mfma_f32_16x16x32_bf16 v[208:211], a[48:51], v[160:163], v[208:211]
ds_read_b128 v[192:195], v30 offset:8192
s_or_b32 s94, s70, s71
s_cselect_b32 s10, 268435456, 0
v_mfma_f32_16x16x32_bf16 v[212:215], a[48:51], v[164:167], v[212:215]
ds_read_b128 v[196:199], v30 offset:17408
v_mfma_f32_16x16x32_bf16 v[216:219], a[96:99], v[112:115], v[216:219]
s_cmp_lg_u32 s70, 0
s_cselect_b64 s[90:91], s[52:53], s[54:55]
s_cselect_b64 s[58:59], s[44:45], s[46:47]
s_mul_i32 s92, s90, s20
v_mfma_f32_16x16x32_bf16 v[208:211], a[52:55], v[168:171], v[208:211]
ds_read_b128 v[200:203], v30 offset:26624
s_add_u32 s92, s92, s58
v_mfma_f32_16x16x32_bf16 v[212:215], a[52:55], v[172:175], v[212:215]
ds_read_b128 v[204:207], v30 offset:35840
s_add_u32 m0, s51, 0
v_mfma_f32_16x16x32_bf16 v[220:223], a[96:99], v[116:119], v[220:223]
buffer_load_dwordx4 v8, s[8:11], s92 offen offset:0 sc1 lds
s_waitcnt lgkmcnt(4)
v_mfma_f32_16x16x32_bf16 v[208:211], a[56:59], v[176:179], v[208:211]
s_mul_i32 s93, s90, s21
s_add_u32 s93, s93, s59
s_andn2_b32 s71, s71, s70
v_mfma_f32_16x16x32_bf16 v[212:215], a[56:59], v[180:183], v[212:215]
s_add_u32 s52, s52, s70
s_add_u32 s54, s54, s71
s_mov_b32 s95, s94
v_mfma_f32_16x16x32_bf16 v[216:219], a[100:103], v[120:123], v[216:219]
buffer_load_dwordx4 v9, s[8:11], s92 offen offset:1024 sc1 lds
v_mfma_f32_16x16x32_bf16 v[208:211], a[60:63], v[184:187], v[208:211]
v_mfma_f32_16x16x32_bf16 v[212:215], a[60:63], v[188:191], v[212:215]
v_mfma_f32_16x16x32_bf16 v[220:223], a[100:103], v[124:127], v[220:223]
buffer_load_dwordx4 v10, s[8:11], s92 offen offset:2048 sc1 lds
s_waitcnt lgkmcnt(0)
v_mfma_f32_16x16x32_bf16 v[208:211], a[64:67], v[192:195], v[208:211]
v_mfma_f32_16x16x32_bf16 v[212:215], a[64:67], v[196:199], v[212:215]
v_mfma_f32_16x16x32_bf16 v[216:219], a[104:107], v[128:131], v[216:219]
buffer_load_dwordx4 v11, s[8:11], s92 offen offset:3072 sc1 lds
v_mfma_f32_16x16x32_bf16 v[208:211], a[68:71], v[200:203], v[208:211]
v_mfma_f32_16x16x32_bf16 v[212:215], a[68:71], v[204:207], v[212:215]
s_add_u32 m0, s51, 4096
v_mfma_f32_16x16x32_bf16 v[220:223], a[104:107], v[132:135], v[220:223]
buffer_load_dwordx4 v12, s[8:11], s92 offen offset:0 sc1 lds
v_mfma_f32_16x16x32_bf16 v[216:219], a[108:111], v[136:139], v[216:219]
v_mfma_f32_16x16x32_bf16 v[220:223], a[108:111], v[140:143], v[220:223]
v_mfma_f32_16x16x32_bf16 v[216:219], a[112:115], v[144:147], v[216:219]
buffer_load_dwordx4 v13, s[8:11], s92 offen offset:1024 sc1 lds
v_mfma_f32_16x16x32_bf16 v[220:223], a[112:115], v[148:151], v[220:223]
v_mfma_f32_16x16x32_bf16 v[216:219], a[116:119], v[152:155], v[216:219]
v_cvt_pk_bf16_f32 v48, v208, v209
v_cvt_pk_bf16_f32 v49, v210, v211
v_mfma_f32_16x16x32_bf16 v[220:223], a[116:119], v[156:159], v[220:223]
buffer_load_dwordx4 v14, s[8:11], s92 offen offset:2048 sc1 lds
v_mfma_f32_16x16x32_bf16 v[216:219], a[120:123], v[160:163], v[216:219]
v_cvt_pk_bf16_f32 v50, v212, v213
v_cvt_pk_bf16_f32 v51, v214, v215
v_mfma_f32_16x16x32_bf16 v[220:223], a[120:123], v[164:167], v[220:223]
v_permlane16_swap_b32 v48, v50
v_mfma_f32_16x16x32_bf16 v[216:219], a[124:127], v[168:171], v[216:219]
buffer_load_dwordx4 v15, s[8:11], s92 offen offset:3072 sc1 lds
v_mfma_f32_16x16x32_bf16 v[220:223], a[124:127], v[172:175], v[220:223]
v_permlane16_swap_b32 v49, v51
v_mfma_f32_16x16x32_bf16 v[216:219], a[128:131], v[176:179], v[216:219]
s_add_u32 m0, s51, 8192
v_mfma_f32_16x16x32_bf16 v[220:223], a[128:131], v[180:183], v[220:223]
buffer_load_dwordx4 v16, s[8:11], s92 offen offset:0 sc1 lds
v_mfma_f32_16x16x32_bf16 v[216:219], a[132:135], v[184:187], v[216:219]
buffer_store_dwordx4 v[48:51], v19, s[4:7], s87 offen sc1
v_mfma_f32_16x16x32_bf16 v[220:223], a[132:135], v[188:191], v[220:223]
v_mfma_f32_16x16x32_bf16 v[216:219], a[136:139], v[192:195], v[216:219]
v_mfma_f32_16x16x32_bf16 v[220:223], a[136:139], v[196:199], v[220:223]
v_mfma_f32_16x16x32_bf16 v[216:219], a[140:143], v[200:203], v[216:219]
v_mfma_f32_16x16x32_bf16 v[220:223], a[140:143], v[204:207], v[220:223]
v_mfma_f32_16x16x32_bf16 v[224:227], a[144:147], v[64:67], 0
v_mfma_f32_16x16x32_bf16 v[228:231], a[144:147], v[68:71], 0
v_mfma_f32_16x16x32_bf16 v[224:227], a[148:151], v[72:75], v[224:227]
v_mfma_f32_16x16x32_bf16 v[228:231], a[148:151], v[76:79], v[228:231]
v_mfma_f32_16x16x32_bf16 v[224:227], a[152:155], v[80:83], v[224:227]
buffer_load_dword v24, v22, s[4:7], 0 offen sc1
v_mfma_f32_16x16x32_bf16 v[228:231], a[152:155], v[84:87], v[228:231]
v_cvt_pk_bf16_f32 v52, v216, v217
v_cvt_pk_bf16_f32 v53, v218, v219
v_mfma_f32_16x16x32_bf16 v[224:227], a[156:159], v[88:91], v[224:227]
s_waitcnt vmcnt(11)
s_barrier
v_mfma_f32_16x16x32_bf16 v[228:231], a[156:159], v[92:95], v[228:231]
buffer_store_dword v27, v45, s[4:7], s79 offen
v_mfma_f32_16x16x32_bf16 v[224:227], a[160:163], v[96:99], v[224:227]
buffer_store_dword v27, v44, s[4:7], s79 offen sc1
v_mfma_f32_16x16x32_bf16 v[228:231], a[160:163], v[100:103], v[228:231]
v_cvt_pk_bf16_f32 v54, v220, v221
v_cvt_pk_bf16_f32 v55, v222, v223
v_mfma_f32_16x16x32_bf16 v[224:227], a[164:167], v[104:107], v[224:227]
v_permlane16_swap_b32 v52, v54
v_mfma_f32_16x16x32_bf16 v[228:231], a[164:167], v[108:111], v[228:231]
v_permlane16_swap_b32 v53, v55
v_mfma_f32_16x16x32_bf16 v[224:227], a[168:171], v[112:115], v[224:227]
buffer_store_dwordx4 v[52:55], v20, s[4:7], s87 offen sc1
v_mfma_f32_16x16x32_bf16 v[228:231], a[168:171], v[116:119], v[228:231]
v_mfma_f32_16x16x32_bf16 v[224:227], a[172:175], v[120:123], v[224:227]
v_mfma_f32_16x16x32_bf16 v[228:231], a[172:175], v[124:127], v[228:231]
v_mfma_f32_16x16x32_bf16 v[224:227], a[176:179], v[128:131], v[224:227]
v_mfma_f32_16x16x32_bf16 v[228:231], a[176:179], v[132:135], v[228:231]
v_mfma_f32_16x16x32_bf16 v[224:227], a[180:183], v[136:139], v[224:227]
v_mfma_f32_16x16x32_bf16 v[228:231], a[180:183], v[140:143], v[228:231]
v_mfma_f32_16x16x32_bf16 v[224:227], a[184:187], v[144:147], v[224:227]
v_mfma_f32_16x16x32_bf16 v[228:231], a[184:187], v[148:151], v[228:231]
v_mfma_f32_16x16x32_bf16 v[224:227], a[188:191], v[152:155], v[224:227]
v_mfma_f32_16x16x32_bf16 v[228:231], a[188:191], v[156:159], v[228:231]
v_mfma_f32_16x16x32_bf16 v[224:227], a[192:195], v[160:163], v[224:227]
s_waitcnt vmcnt(12)
s_barrier
v_mfma_f32_16x16x32_bf16 v[228:231], a[192:195], v[164:167], v[228:231]
v_mfma_f32_16x16x32_bf16 v[224:227], a[196:199], v[168:171], v[224:227]
s_cmp_eq_u32 s94, 0
s_cbranch_scc1 g_slow_94
v_mfma_f32_16x16x32_bf16 v[228:231], a[196:199], v[172:175], v[228:231]
ds_read_b128 v[64:67], v31 offset:0
v_mfma_f32_16x16x32_bf16 v[224:227], a[200:203], v[176:179], v[224:227]
ds_read_b128 v[68:71], v31 offset:9216
v_mfma_f32_16x16x32_bf16 v[228:231], a[200:203], v[180:183], v[228:231]
ds_read_b128 v[72:75], v31 offset:18432
v_mfma_f32_16x16x32_bf16 v[224:227], a[204:207], v[184:187], v[224:227]
ds_read_b128 v[76:79], v31 offset:27648
v_mfma_f32_16x16x32_bf16 v[228:231], a[204:207], v[188:191], v[228:231]
ds_read_b128 v[80:83], v31 offset:1024
v_mfma_f32_16x16x32_bf16 v[224:227], a[208:211], v[192:195], v[224:227]
ds_read_b128 v[84:87], v31 offset:10240
v_mfma_f32_16x16x32_bf16 v[228:231], a[208:211], v[196:199], v[228:231]
ds_read_b128 v[88:91], v31 offset:19456
v_mfma_f32_16x16x32_bf16 v[224:227], a[212:215], v[200:203], v[224:227]
ds_read_b128 v[92:95], v31 offset:28672
v_mfma_f32_16x16x32_bf16 v[228:231], a[212:215], v[204:207], v[228:231]
s_waitcnt vmcnt(8)
s_barrier
g_body_83:
s_waitcnt lgkmcnt(4)
v_mfma_f32_16x16x32_bf16 v[208:211], a[0:3], v[64:67], 0
ds_read_b128 v[96:99], v31 offset:2048
v_mfma_f32_16x16x32_bf16 v[212:215], a[0:3], v[68:71], 0
ds_read_b128 v[100:103], v31 offset:11264
v_mfma_f32_16x16x32_bf16 v[216:219], a[72:75], v[64:67], 0
v_mfma_f32_16x16x32_bf16 v[208:211], a[4:7], v[72:75], v[208:211]
ds_read_b128 v[104:107], v31 offset:20480
v_cvt_pk_bf16_f32 v56, v224, v225
v_mfma_f32_16x16x32_bf16 v[212:215], a[4:7], v[76:79], v[212:215]
ds_read_b128 v[108:111], v31 offset:29696
v_cvt_pk_bf16_f32 v57, v226, v227
v_mfma_f32_16x16x32_bf16 v[220:223], a[72:75], v[68:71], 0
v_cvt_pk_bf16_f32 v58, v228, v229
s_waitcnt lgkmcnt(4)
v_mfma_f32_16x16x32_bf16 v[208:211], a[8:11], v[80:83], v[208:211]
ds_read_b128 v[112:115], v31 offset:3072
v_cvt_pk_bf16_f32 v59, v230, v231
v_mfma_f32_16x16x32_bf16 v[212:215], a[8:11], v[84:87], v[212:215]
ds_read_b128 v[116:119], v31 offset:12288
v_permlane16_swap_b32 v56, v58
v_mfma_f32_16x16x32_bf16 v[216:219], a[76:79], v[72:75], v[216:219]
v_permlane16_swap_b32 v57, v59
v_mfma_f32_16x16x32_bf16 v[208:211], a[12:15], v[88:91], v[208:211]
ds_read_b128 v[120:123], v31 offset:21504
v_mfma_f32_16x16x32_bf16 v[212:215], a[12:15], v[92:95], v[212:215]
ds_read_b128 v[124:127], v31 offset:30720
v_mfma_f32_16x16x32_bf16 v[220:223], a[76:79], v[76:79], v[220:223]
s_waitcnt lgkmcnt(4)
v_mfma_f32_16x16x32_bf16 v[208:211], a[16:19], v[96:99], v[208:211]
ds_read_b128 v[128:131], v31 offset:4096
v_mfma_f32_16x16x32_bf16 v[212:215], a[16:19], v[100:103], v[212:215]
ds_read_b128 v[132:135], v31 offset:13312
v_mfma_f32_16x16x32_bf16 v[216:219], a[80:83], v[80:83], v[216:219]
buffer_store_dwordx4 v[56:59], v21, s[4:7], s87 offen sc1
v_mfma_f32_16x16x32_bf16 v[208:211], a[20:23], v[104:107], v[208:211]
ds_read_b128 v[136:139], v31 offset:22528
v_mov_b32 v27, s84
v_mfma_f32_16x16x32_bf16 v[212:215], a[20:23], v[108:111], v[212:215]
ds_read_b128 v[140:143], v31 offset:31744
v_mfma_f32_16x16x32_bf16 v[220:223], a[80:83], v[84:87], v[220:223]
s_waitcnt lgkmcnt(4)
v_mfma_f32_16x16x32_bf16 v[208:211], a[24:27], v[112:115], v[208:211]
ds_read_b128 v[144:147], v31 offset:5120
v_mfma_f32_16x16x32_bf16 v[212:215], a[24:27], v[116:119], v[212:215]
ds_read_b128 v[148:151], v31 offset:14336
v_mfma_f32_16x16x32_bf16 v[216:219], a[84:87], v[88:91], v[216:219]
v_mfma_f32_16x16x32_bf16 v[208:211], a[28:31], v[120:123], v[208:211]
ds_read_b128 v[152:155], v31 offset:23552
v_mfma_f32_16x16x32_bf16 v[212:215], a[28:31], v[124:127], v[212:215]
ds_read_b128 v[156:159], v31 offset:32768
v_mfma_f32_16x16x32_bf16 v[220:223], a[84:87], v[92:95], v[220:223]
s_waitcnt vmcnt(6)
s_barrier
s_waitcnt lgkmcnt(4)
v_mfma_f32_16x16x32_bf16 v[208:211], a[32:35], v[128:131], v[208:211]
ds_read_b128 v[160:163], v31 offset:6144
v_mfma_f32_16x16x32_bf16 v[212:215], a[32:35], v[132:135], v[212:215]
ds_read_b128 v[164:167], v31 offset:15360
s_waitcnt vmcnt(4)
ds_write_b32 v18, v24
v_mfma_f32_16x16x32_bf16 v[216:219], a[88:91], v[96:99], v[216:219]
v_mfma_f32_16x16x32_bf16 v[208:211], a[36:39], v[136:139], v[208:211]
ds_read_b128 v[168:171], v31 offset:24576
v_mfma_f32_16x16x32_bf16 v[212:215], a[36:39], v[140:143], v[212:215]
ds_read_b128 v[172:175], v31 offset:33792
s_waitcnt lgkmcnt(2)
s_barrier
v_mfma_f32_16x16x32_bf16 v[220:223], a[88:91], v[100:103], v[220:223]
ds_read_b32 v33, v32
v_mfma_f32_16x16x32_bf16 v[208:211], a[40:43], v[144:147], v[208:211]
ds_read_b128 v[176:179], v31 offset:7168
v_mfma_f32_16x16x32_bf16 v[212:215], a[40:43], v[148:151], v[212:215]
ds_read_b128 v[180:183], v31 offset:16384
v_mfma_f32_16x16x32_bf16 v[216:219], a[92:95], v[104:107], v[216:219]
s_waitcnt lgkmcnt(2)
v_cmp_gt_u32 vcc, s52, v33
v_mfma_f32_16x16x32_bf16 v[208:211], a[44:47], v[152:155], v[208:211]
ds_read_b128 v[184:187], v31 offset:25600
v_cmp_gt_u32 s[58:59], s54, v33
v_mfma_f32_16x16x32_bf16 v[212:215], a[44:47], v[156:159], v[212:215]
ds_read_b128 v[188:191], v31 offset:34816
s_and_b32 vcc_lo, vcc_lo, s56
s_cselect_b32 s70, 0, 1
v_mfma_f32_16x16x32_bf16 v[220:223], a[92:95], v[108:111], v[220:223]
s_and_b32 s59, s59, s56
s_cselect_b32 s71, 0, s95
v_mfma_f32_16x16x32_bf16 v[208:211], a[48:51], v[160:163], v[208:211]
ds_read_b128 v[192:195], v31 offset:8192
s_or_b32 s76, s70, s71
s_cselect_b32 s10, 268435456, 0
v_mfma_f32_16x16x32_bf16 v[212:215], a[48:51], v[164:167], v[212:215]
ds_read_b128 v[196:199], v31 offset:17408
v_mfma_f32_16x16x32_bf16 v[216:219], a[96:99], v[112:115], v[216:219]
s_cmp_lg_u32 s70, 0
s_cselect_b64 s[72:73], s[52:53], s[54:55]
s_cselect_b64 s[58:59], s[44:45], s[46:47]
s_mul_i32 s74, s72, s20
v_mfma_f32_16x16x32_bf16 v[208:211], a[52:55], v[168:171], v[208:211]
ds_read_b128 v[200:203], v31 offset:26624
s_add_u32 s74, s74, s58
v_mfma_f32_16x16x32_bf16 v[212:215], a[52:55], v[172:175], v[212:215]
ds_read_b128 v[204:207], v31 offset:35840
s_add_u32 m0, s48, 0
v_mfma_f32_16x16x32_bf16 v[220:223], a[96:99], v[116:119], v[220:223]
buffer_load_dwordx4 v8, s[8:11], s74 offen offset:0 sc1 lds
s_waitcnt lgkmcnt(4)
v_mfma_f32_16x16x32_bf16 v[208:211], a[56:59], v[176:179], v[208:211]
s_mul_i32 s75, s72, s21
s_add_u32 s75, s75, s59
s_andn2_b32 s71, s71, s70
v_mfma_f32_16x16x32_bf16 v[212:215], a[56:59], v[180:183], v[212:215]
s_add_u32 s52, s52, s70
s_add_u32 s54, s54, s71
s_mov_b32 s77, s76
v_mfma_f32_16x16x32_bf16 v[216:219], a[100:103], v[120:123], v[216:219]
buffer_load_dwordx4 v9, s[8:11], s74 offen offset:1024 sc1 lds
v_mfma_f32_16x16x32_bf16 v[208:211], a[60:63], v[184:187], v[208:211]
v_mfma_f32_16x16x32_bf16 v[212:215], a[60:63], v[188:191], v[212:215]
v_mfma_f32_16x16x32_bf16 v[220:223], a[100:103], v[124:127], v[220:223]
buffer_load_dwordx4 v10, s[8:11], s74 offen offset:2048 sc1 lds
s_waitcnt lgkmcnt(0)
v_mfma_f32_16x16x32_bf16 v[208:211], a[64:67], v[192:195], v[208:211]
v_mfma_f32_16x16x32_bf16 v[212:215], a[64:67], v[196:199], v[212:215]
v_mfma_f32_16x16x32_bf16 v[216:219], a[104:107], v[128:131], v[216:219]
buffer_load_dwordx4 v11, s[8:11], s74 offen offset:3072 sc1 lds
v_mfma_f32_16x16x32_bf16 v[208:211], a[68:71], v[200:203], v[208:211]
v_mfma_f32_16x16x32_bf16 v[212:215], a[68:71], v[204:207], v[212:215]
s_add_u32 m0, s48, 4096
v_mfma_f32_16x16x32_bf16 v[220:223], a[104:107], v[132:135], v[220:223]
buffer_load_dwordx4 v12, s[8:11], s74 offen offset:0 sc1 lds
v_mfma_f32_16x16x32_bf16 v[216:219], a[108:111], v[136:139], v[216:219]
v_mfma_f32_16x16x32_bf16 v[220:223], a[108:111], v[140:143], v[220:223]
v_mfma_f32_16x16x32_bf16 v[216:219], a[112:115], v[144:147], v[216:219]
buffer_load_dwordx4 v13, s[8:11], s74 offen offset:1024 sc1 lds
v_mfma_f32_16x16x32_bf16 v[220:223], a[112:115], v[148:151], v[220:223]
v_mfma_f32_16x16x32_bf16 v[216:219], a[116:119], v[152:155], v[216:219]
v_cvt_pk_bf16_f32 v48, v208, v209
v_cvt_pk_bf16_f32 v49, v210, v211
v_mfma_f32_16x16x32_bf16 v[220:223], a[116:119], v[156:159], v[220:223]
buffer_load_dwordx4 v14, s[8:11], s74 offen offset:2048 sc1 lds
v_mfma_f32_16x16x32_bf16 v[216:219], a[120:123], v[160:163], v[216:219]
v_cvt_pk_bf16_f32 v50, v212, v213
v_cvt_pk_bf16_f32 v51, v214, v215
v_mfma_f32_16x16x32_bf16 v[220:223], a[120:123], v[164:167], v[220:223]
v_permlane16_swap_b32 v48, v50
v_mfma_f32_16x16x32_bf16 v[216:219], a[124:127], v[168:171], v[216:219]
buffer_load_dwordx4 v15, s[8:11], s74 offen offset:3072 sc1 lds
v_mfma_f32_16x16x32_bf16 v[220:223], a[124:127], v[172:175], v[220:223]
v_permlane16_swap_b32 v49, v51
v_mfma_f32_16x16x32_bf16 v[216:219], a[128:131], v[176:179], v[216:219]
s_add_u32 m0, s48, 8192
v_mfma_f32_16x16x32_bf16 v[220:223], a[128:131], v[180:183], v[220:223]
buffer_load_dwordx4 v16, s[8:11], s74 offen offset:0 sc1 lds
v_mfma_f32_16x16x32_bf16 v[216:219], a[132:135], v[184:187], v[216:219]
buffer_store_dwordx4 v[48:51], v19, s[4:7], s93 offen sc1
v_mfma_f32_16x16x32_bf16 v[220:223], a[132:135], v[188:191], v[220:223]
v_mfma_f32_16x16x32_bf16 v[216:219], a[136:139], v[192:195], v[216:219]
v_mfma_f32_16x16x32_bf16 v[220:223], a[136:139], v[196:199], v[220:223]
v_mfma_f32_16x16x32_bf16 v[216:219], a[140:143], v[200:203], v[216:219]
v_mfma_f32_16x16x32_bf16 v[220:223], a[140:143], v[204:207], v[220:223]
v_mfma_f32_16x16x32_bf16 v[224:227], a[144:147], v[64:67], 0
v_mfma_f32_16x16x32_bf16 v[228:231], a[144:147], v[68:71], 0
v_mfma_f32_16x16x32_bf16 v[224:227], a[148:151], v[72:75], v[224:227]
v_mfma_f32_16x16x32_bf16 v[228:231], a[148:151], v[76:79], v[228:231]
v_mfma_f32_16x16x32_bf16 v[224:227], a[152:155], v[80:83], v[224:227]
buffer_load_dword v24, v22, s[4:7], 0 offen sc1
v_mfma_f32_16x16x32_bf16 v[228:231], a[152:155], v[84:87], v[228:231]
v_cvt_pk_bf16_f32 v52, v216, v217
v_cvt_pk_bf16_f32 v53, v218, v219
v_mfma_f32_16x16x32_bf16 v[224:227], a[156:159], v[88:91], v[224:227]
s_waitcnt vmcnt(11)
s_barrier
v_mfma_f32_16x16x32_bf16 v[228:231], a[156:159], v[92:95], v[228:231]
buffer_store_dword v27, v45, s[4:7], s85 offen
v_mfma_f32_16x16x32_bf16 v[224:227], a[160:163], v[96:99], v[224:227]
buffer_store_dword v27, v44, s[4:7], s85 offen sc1
v_mfma_f32_16x16x32_bf16 v[228:231], a[160:163], v[100:103], v[228:231]
v_cvt_pk_bf16_f32 v54, v220, v221
v_cvt_pk_bf16_f32 v55, v222, v223
v_mfma_f32_16x16x32_bf16 v[224:227], a[164:167], v[104:107], v[224:227]
v_permlane16_swap_b32 v52, v54
v_mfma_f32_16x16x32_bf16 v[228:231], a[164:167], v[108:111], v[228:231]
v_permlane16_swap_b32 v53, v55
v_mfma_f32_16x16x32_bf16 v[224:227], a[168:171], v[112:115], v[224:227]
buffer_store_dwordx4 v[52:55], v20, s[4:7], s93 offen sc1
v_mfma_f32_16x16x32_bf16 v[228:231], a[168:171], v[116:119], v[228:231]
v_mfma_f32_16x16x32_bf16 v[224:227], a[172:175], v[120:123], v[224:227]
v_mfma_f32_16x16x32_bf16 v[228:231], a[172:175], v[124:127], v[228:231]
v_mfma_f32_16x16x32_bf16 v[224:227], a[176:179], v[128:131], v[224:227]
v_mfma_f32_16x16x32_bf16 v[228:231], a[176:179], v[132:135], v[228:231]
v_mfma_f32_16x16x32_bf16 v[224:227], a[180:183], v[136:139], v[224:227]
v_mfma_f32_16x16x32_bf16 v[228:231], a[180:183], v[140:143], v[228:231]
v_mfma_f32_16x16x32_bf16 v[224:227], a[184:187], v[144:147], v[224:227]
v_mfma_f32_16x16x32_bf16 v[228:231], a[184:187], v[148:151], v[228:231]
v_mfma_f32_16x16x32_bf16 v[224:227], a[188:191], v[152:155], v[224:227]
v_mfma_f32_16x16x32_bf16 v[228:231], a[188:191], v[156:159], v[228:231]
v_mfma_f32_16x16x32_bf16 v[224:227], a[192:195], v[160:163], v[224:227]
s_waitcnt vmcnt(12)
s_barrier
v_mfma_f32_16x16x32_bf16 v[228:231], a[192:195], v[164:167], v[228:231]
v_mfma_f32_16x16x32_bf16 v[224:227], a[196:199], v[168:171], v[224:227]
s_cmp_eq_u32 s76, 0
s_cbranch_scc1 g_slow_95
v_mfma_f32_16x16x32_bf16 v[228:231], a[196:199], v[172:175], v[228:231]
ds_read_b128 v[64:67], v28 offset:0
v_mfma_f32_16x16x32_bf16 v[224:227], a[200:203], v[176:179], v[224:227]
ds_read_b128 v[68:71], v28 offset:9216
v_mfma_f32_16x16x32_bf16 v[228:231], a[200:203], v[180:183], v[228:231]
ds_read_b128 v[72:75], v28 offset:18432
v_mfma_f32_16x16x32_bf16 v[224:227], a[204:207], v[184:187], v[224:227]
ds_read_b128 v[76:79], v28 offset:27648
v_mfma_f32_16x16x32_bf16 v[228:231], a[204:207], v[188:191], v[228:231]
ds_read_b128 v[80:83], v28 offset:1024
v_mfma_f32_16x16x32_bf16 v[224:227], a[208:211], v[192:195], v[224:227]
ds_read_b128 v[84:87], v28 offset:10240
v_mfma_f32_16x16x32_bf16 v[228:231], a[208:211], v[196:199], v[228:231]
ds_read_b128 v[88:91], v28 offset:19456
v_mfma_f32_16x16x32_bf16 v[224:227], a[212:215], v[200:203], v[224:227]
ds_read_b128 v[92:95], v28 offset:28672
v_mfma_f32_16x16x32_bf16 v[228:231], a[212:215], v[204:207], v[228:231]
s_waitcnt vmcnt(8)
s_barrier
s_branch g_body_80
g_slow_92:
v_mfma_f32_16x16x32_bf16 v[228:231], a[196:199], v[172:175], v[228:231]
v_mfma_f32_16x16x32_bf16 v[224:227], a[200:203], v[176:179], v[224:227]
v_mfma_f32_16x16x32_bf16 v[228:231], a[200:203], v[180:183], v[228:231]
v_mfma_f32_16x16x32_bf16 v[224:227], a[204:207], v[184:187], v[224:227]
v_mfma_f32_16x16x32_bf16 v[228:231], a[204:207], v[188:191], v[228:231]
v_mfma_f32_16x16x32_bf16 v[224:227], a[208:211], v[192:195], v[224:227]
v_mfma_f32_16x16x32_bf16 v[228:231], a[208:211], v[196:199], v[228:231]
v_mfma_f32_16x16x32_bf16 v[224:227], a[212:215], v[200:203], v[224:227]
v_mfma_f32_16x16x32_bf16 v[228:231], a[212:215], v[204:207], v[228:231]
s_nop 6
v_cvt_pk_bf16_f32 v56, v224, v225
v_cvt_pk_bf16_f32 v57, v226, v227
v_cvt_pk_bf16_f32 v58, v228, v229
v_cvt_pk_bf16_f32 v59, v230, v231
s_nop 0
v_permlane16_swap_b32 v56, v58
v_permlane16_swap_b32 v57, v59
buffer_store_dwordx4 v[56:59], v21, s[4:7], s75 offen sc1
s_mov_b32 s75, 1879048192
s_waitcnt vmcnt(4)
ds_write_b32 v18, v24
s_waitcnt lgkmcnt(0)
s_barrier
ds_read_b32 v33, v32
s_waitcnt lgkmcnt(0)
v_cmp_gt_u32 vcc, s52, v33
v_cmp_gt_u32 s[58:59], s54, v33
s_and_b32 vcc_lo, vcc_lo, s56
s_cselect_b32 s70, 0, 1
s_and_b32 s59, s59, s56
s_cselect_b32 s71, 0, s77
s_or_b32 s82, s70, s71
s_cselect_b32 s10, 268435456, 0
s_cmp_lg_u32 s70, 0
s_cselect_b64 s[78:79], s[52:53], s[54:55]
s_cselect_b64 s[58:59], s[44:45], s[46:47]
s_mul_i32 s80, s78, s20
s_add_u32 s80, s80, s58
s_mul_i32 s81, s78, s21
s_add_u32 s81, s81, s59
s_andn2_b32 s71, s71, s70
s_add_u32 s52, s52, s70
s_add_u32 s54, s54, s71
s_mov_b32 s83, s82
s_cmp_lg_u32 s82, 0
s_cbranch_scc1 g_go_96
v_mov_b32 v27, s72
s_waitcnt vmcnt(0)
s_barrier
s_add_u32 s70, s52, s54
s_cmp_eq_u32 s70, 130
s_cbranch_scc1 g_fin_84
s_cmp_lg_u32 s3, 0
s_cbranch_scc1 sp_ok_98_j
s_mov_b32 s23, 0
buffer_load_dword v33, v22, s[4:7], 0 offen sc1
buffer_store_dword v27, v45, s[4:7], s73 offen
buffer_store_dword v27, v44, s[4:7], s73 offen sc1
s_waitcnt vmcnt(2)
s_branch sp_loop_97_e
sp_loop_97:
buffer_load_dword v33, v22, s[4:7], 0 offen sc1
s_add_u32 s23, s23, 1
s_cmp_gt_u32 s23, 150000
s_cbranch_scc1 sp_bad_99
s_waitcnt vmcnt(0)
sp_loop_97_e:
v_cmp_gt_u32 vcc, s52, v33
v_cmp_gt_u32 s[58:59], s54, v33
s_and_b32 vcc_lo, vcc_lo, s56
s_cbranch_scc0 sp_ok_98
s_cmp_gt_u32 s23, 4
s_cselect_b32 s70, 0, s56
s_cmp_lg_u32 s77, 0
s_cselect_b32 s70, 0, s70
s_or_b32 s59, s59, s70
s_and_b32 s59, s59, s56
s_cbranch_scc0 sp_ok_98
s_sleep 1
s_branch sp_loop_97
sp_bad_99:
s_mov_b32 s98, 1027
s_branch L_fail
sp_ok_98:
ds_write_b32 v18, v33
s_waitcnt lgkmcnt(0)
sp_ok_98_j:
s_barrier
ds_read_b32 v33, v32
s_waitcnt lgkmcnt(0)
s_mov_b32 s73, 1879048192
v_cmp_gt_u32 vcc, s52, v33
v_cmp_gt_u32 s[58:59], s54, v33
s_and_b32 vcc_lo, vcc_lo, s56
s_cselect_b32 s70, 0, 1
s_and_b32 s59, s59, s56
s_cselect_b32 s71, 0, 1
s_or_b32 s82, s70, s71
s_cselect_b32 s10, 268435456, 0
s_cmp_lg_u32 s70, 0
s_cselect_b64 s[78:79], s[52:53], s[54:55]
s_cselect_b64 s[58:59], s[44:45], s[46:47]
s_mul_i32 s80, s78, s20
s_add_u32 s80, s80, s58
s_mul_i32 s81, s78, s21
s_add_u32 s81, s81, s59
s_andn2_b32 s71, s71, s70
s_add_u32 s52, s52, s70
s_add_u32 s54, s54, s71
s_mov_b32 s83, s82
g_go_96:
s_add_u32 m0, s49, 0
s_nop 0
buffer_load_dwordx4 v8, s[4:7], s80 offen offset:0 sc1 lds
buffer_load_dwordx4 v9, s[4:7], s80 offen offset:1024 sc1 lds
buffer_load_dwordx4 v10, s[4:7], s80 offen offset:2048 sc1 lds
buffer_load_dwordx4 v11, s[4:7], s80 offen offset:3072 sc1 lds
s_add_u32 m0, s49, 4096
s_nop 0
buffer_load_dwordx4 v12, s[4:7], s80 offen offset:0 sc1 lds
buffer_load_dwordx4 v13, s[4:7], s80 offen offset:1024 sc1 lds
buffer_load_dwordx4 v14, s[4:7], s80 offen offset:2048 sc1 lds
buffer_load_dwordx4 v15, s[4:7], s80 offen offset:3072 sc1 lds
s_add_u32 m0, s49, 8192
s_nop 0
buffer_load_dwordx4 v16, s[4:7], s80 offen offset:0 sc1 lds
buffer_load_dword v24, v22, s[4:7], 0 offen sc1
buffer_store_dword v27, v34, s[4:7], 0 offen
buffer_store_dword v27, v34, s[4:7], 0 offen
v_mov_b32 v27, s72
s_waitcnt vmcnt(10)
s_barrier
buffer_store_dword v27, v45, s[4:7], s73 offen
buffer_store_dword v27, v44, s[4:7], s73 offen sc1
s_mov_b32 s73, 1879048192
ds_read_b128 v[64:67], v29 offset:0
ds_read_b128 v[68:71], v29 offset:9216
ds_read_b128 v[72:75], v29 offset:18432
ds_read_b128 v[76:79], v29 offset:27648
ds_read_b128 v[80:83], v29 offset:1024
ds_read_b128 v[84:87], v29 offset:10240
ds_read_b128 v[88:91], v29 offset:19456
ds_read_b128 v[92:95], v29 offset:28672
s_waitcnt vmcnt(8)
s_barrier
s_branch g_body_81
g_slow_93:
v_mfma_f32_16x16x32_bf16 v[228:231], a[196:199], v[172:175], v[228:231]
v_mfma_f32_16x16x32_bf16 v[224:227], a[200:203], v[176:179], v[224:227]
v_mfma_f32_16x16x32_bf16 v[228:231], a[200:203], v[180:183], v[228:231]
v_mfma_f32_16x16x32_bf16 v[224:227], a[204:207], v[184:187], v[224:227]
v_mfma_f32_16x16x32_bf16 v[228:231], a[204:207], v[188:191], v[228:231]
v_mfma_f32_16x16x32_bf16 v[224:227], a[208:211], v[192:195], v[224:227]
v_mfma_f32_16x16x32_bf16 v[228:231], a[208:211], v[196:199], v[228:231]
v_mfma_f32_16x16x32_bf16 v[224:227], a[212:215], v[200:203], v[224:227]
v_mfma_f32_16x16x32_bf16 v[228:231], a[212:215], v[204:207], v[228:231]
s_nop 6
v_cvt_pk_bf16_f32 v56, v224, v225
v_cvt_pk_bf16_f32 v57, v226, v227
v_cvt_pk_bf16_f32 v58, v228, v229
v_cvt_pk_bf16_f32 v59, v230, v231
s_nop 0
v_permlane16_swap_b32 v56, v58
v_permlane16_swap_b32 v57, v59
buffer_store_dwordx4 v[56:59], v21, s[4:7], s81 offen sc1
s_mov_b32 s81, 1879048192
s_waitcnt vmcnt(4)
ds_write_b32 v18, v24
s_waitcnt lgkmcnt(0)
s_barrier
ds_read_b32 v33, v32
s_waitcnt lgkmcnt(0)
v_cmp_gt_u32 vcc, s52, v33
v_cmp_gt_u32 s[58:59], s54, v33
s_and_b32 vcc_lo, vcc_lo, s56
s_cselect_b32 s70, 0, 1
s_and_b32 s59, s59, s56
s_cselect_b32 s71, 0, s83
s_or_b32 s88, s70, s71
s_cselect_b32 s10, 268435456, 0
s_cmp_lg_u32 s70, 0
s_cselect_b64 s[84:85], s[52:53], s[54:55]
s_cselect_b64 s[58:59], s[44:45], s[46:47]
s_mul_i32 s86, s84, s20
s_add_u32 s86, s86, s58
s_mul_i32 s87, s84, s21
s_add_u32 s87, s87, s59
s_andn2_b32 s71, s71, s70
s_add_u32 s52, s52, s70
s_add_u32 s54, s54, s71
s_mov_b32 s89, s88
s_cmp_lg_u32 s88, 0
s_cbranch_scc1 g_go_100
v_mov_b32 v27, s78
s_waitcnt vmcnt(0)
s_barrier
s_add_u32 s70, s52, s54
s_cmp_eq_u32 s70, 130
s_cbranch_scc1 g_fin_84
s_cmp_lg_u32 s3, 0
s_cbranch_scc1 sp_ok_102_j
s_mov_b32 s23, 0
buffer_load_dword v33, v22, s[4:7], 0 offen sc1
buffer_store_dword v27, v45, s[4:7], s79 offen
buffer_store_dword v27, v44, s[4:7], s79 offen sc1
s_waitcnt vmcnt(2)
s_branch sp_loop_101_e
sp_loop_101:
buffer_load_dword v33, v22, s[4:7], 0 offen sc1
s_add_u32 s23, s23, 1
s_cmp_gt_u32 s23, 150000
s_cbranch_scc1 sp_bad_103
s_waitcnt vmcnt(0)
sp_loop_101_e:
v_cmp_gt_u32 vcc, s52, v33
v_cmp_gt_u32 s[58:59], s54, v33
s_and_b32 vcc_lo, vcc_lo, s56
s_cbranch_scc0 sp_ok_102
s_cmp_gt_u32 s23, 4
s_cselect_b32 s70, 0, s56
s_cmp_lg_u32 s83, 0
s_cselect_b32 s70, 0, s70
s_or_b32 s59, s59, s70
s_and_b32 s59, s59, s56
s_cbranch_scc0 sp_ok_102
s_sleep 1
s_branch sp_loop_101
sp_bad_103:
s_mov_b32 s98, 1027
s_branch L_fail
sp_ok_102:
ds_write_b32 v18, v33
s_waitcnt lgkmcnt(0)
sp_ok_102_j:
s_barrier
ds_read_b32 v33, v32
s_waitcnt lgkmcnt(0)
s_mov_b32 s79, 1879048192
v_cmp_gt_u32 vcc, s52, v33
v_cmp_gt_u32 s[58:59], s54, v33
s_and_b32 vcc_lo, vcc_lo, s56
s_cselect_b32 s70, 0, 1
s_and_b32 s59, s59, s56
s_cselect_b32 s71, 0, 1
s_or_b32 s88, s70, s71
s_cselect_b32 s10, 268435456, 0
s_cmp_lg_u32 s70, 0
s_cselect_b64 s[84:85], s[52:53], s[54:55]
s_cselect_b64 s[58:59], s[44:45], s[46:47]
s_mul_i32 s86, s84, s20
s_add_u32 s86, s86, s58
s_mul_i32 s87, s84, s21
s_add_u32 s87, s87, s59
s_andn2_b32 s71, s71, s70
s_add_u32 s52, s52, s70
s_add_u32 s54, s54, s71
s_mov_b32 s89, s88
g_go_100:
s_add_u32 m0, s50, 0
s_nop 0
buffer_load_dwordx4 v8, s[4:7], s86 offen offset:0 sc1 lds
buffer_load_dwordx4 v9, s[4:7], s86 offen offset:1024 sc1 lds
buffer_load_dwordx4 v10, s[4:7], s86 offen offset:2048 sc1 lds
buffer_load_dwordx4 v11, s[4:7], s86 offen offset:3072 sc1 lds
s_add_u32 m0, s50, 4096
s_nop 0
buffer_load_dwordx4 v12, s[4:7], s86 offen offset:0 sc1 lds
buffer_load_dwordx4 v13, s[4:7], s86 offen offset:1024 sc1 lds
buffer_load_dwordx4 v14, s[4:7], s86 offen offset:2048 sc1 lds
buffer_load_dwordx4 v15, s[4:7], s86 offen offset:3072 sc1 lds
s_add_u32 m0, s50, 8192
s_nop 0
buffer_load_dwordx4 v16, s[4:7], s86 offen offset:0 sc1 lds
buffer_load_dword v24, v22, s[4:7], 0 offen sc1
buffer_store_dword v27, v34, s[4:7], 0 offen
buffer_store_dword v27, v34, s[4:7], 0 offen
v_mov_b32 v27, s78
s_waitcnt vmcnt(10)
s_barrier
buffer_store_dword v27, v45, s[4:7], s79 offen
buffer_store_dword v27, v44, s[4:7], s79 offen sc1
s_mov_b32 s79, 1879048192
ds_read_b128 v[64:67], v30 offset:0
ds_read_b128 v[68:71], v30 offset:9216
ds_read_b128 v[72:75], v30 offset:18432
ds_read_b128 v[76:79], v30 offset:27648
ds_read_b128 v[80:83], v30 offset:1024
ds_read_b128 v[84:87], v30 offset:10240
ds_read_b128 v[88:91], v30 offset:19456
ds_read_b128 v[92:95], v30 offset:28672
s_waitcnt vmcnt(8)
s_barrier
s_branch g_body_82
g_slow_94:
v_mfma_f32_16x16x32_bf16 v[228:231], a[196:199], v[172:175], v[228:231]
v_mfma_f32_16x16x32_bf16 v[224:227], a[200:203], v[176:179], v[224:227]
v_mfma_f32_16x16x32_bf16 v[228:231], a[200:203], v[180:183], v[228:231]
v_mfma_f32_16x16x32_bf16 v[224:227], a[204:207], v[184:187], v[224:227]
v_mfma_f32_16x16x32_bf16 v[228:231], a[204:207], v[188:191], v[228:231]
v_mfma_f32_16x16x32_bf16 v[224:227], a[208:211], v[192:195], v[224:227]
v_mfma_f32_16x16x32_bf16 v[228:231], a[208:211], v[196:199], v[228:231]
v_mfma_f32_16x16x32_bf16 v[224:227], a[212:215], v[200:203], v[224:227]
v_mfma_f32_16x16x32_bf16 v[228:231], a[212:215], v[204:207], v[228:231]
s_nop 6
v_cvt_pk_bf16_f32 v56, v224, v225
v_cvt_pk_bf16_f32 v57, v226, v227
v_cvt_pk_bf16_f32 v58, v228, v229
v_cvt_pk_bf16_f32 v59, v230, v231
s_nop 0
v_permlane16_swap_b32 v56, v58
v_permlane16_swap_b32 v57, v59
buffer_store_dwordx4 v[56:59], v21, s[4:7], s87 offen sc1
s_mov_b32 s87, 1879048192
s_waitcnt vmcnt(4)
ds_write_b32 v18, v24
s_waitcnt lgkmcnt(0)
s_barrier
ds_read_b32 v33, v32
s_waitcnt lgkmcnt(0)
v_cmp_gt_u32 vcc, s52, v33
v_cmp_gt_u32 s[58:59], s54, v33
s_and_b32 vcc_lo, vcc_lo, s56
s_cselect_b32 s70, 0, 1
s_and_b32 s59, s59, s56
s_cselect_b32 s71, 0, s89
s_or_b32 s94, s70, s71
s_cselect_b32 s10, 268435456, 0
s_cmp_lg_u32 s70, 0
s_cselect_b64 s[90:91], s[52:53], s[54:55]
s_cselect_b64 s[58:59], s[44:45], s[46:47]
s_mul_i32 s92, s90, s20
s_add_u32 s92, s92, s58
s_mul_i32 s93, s90, s21
s_add_u32 s93, s93, s59
s_andn2_b32 s71, s71, s70
s_add_u32 s52, s52, s70
s_add_u32 s54, s54, s71
s_mov_b32 s95, s94
s_cmp_lg_u32 s94, 0
s_cbranch_scc1 g_go_104
v_mov_b32 v27, s84
s_waitcnt vmcnt(0)
s_barrier
s_add_u32 s70, s52, s54
s_cmp_eq_u32 s70, 130
s_cbranch_scc1 g_fin_84
s_cmp_lg_u32 s3, 0
s_cbranch_scc1 sp_ok_106_j
s_mov_b32 s23, 0
buffer_load_dword v33, v22, s[4:7], 0 offen sc1
buffer_store_dword v27, v45, s[4:7], s85 offen
buffer_store_dword v27, v44, s[4:7], s85 offen sc1
s_waitcnt vmcnt(2)
s_branch sp_loop_105_e
sp_loop_105:
buffer_load_dword v33, v22, s[4:7], 0 offen sc1
s_add_u32 s23, s23, 1
s_cmp_gt_u32 s23, 150000
s_cbranch_scc1 sp_bad_107
s_waitcnt vmcnt(0)
sp_loop_105_e:
v_cmp_gt_u32 vcc, s52, v33
v_cmp_gt_u32 s[58:59], s54, v33
s_and_b32 vcc_lo, vcc_lo, s56
s_cbranch_scc0 sp_ok_106
s_cmp_gt_u32 s23, 4
s_cselect_b32 s70, 0, s56
s_cmp_lg_u32 s89, 0
s_cselect_b32 s70, 0, s70
s_or_b32 s59, s59, s70
s_and_b32 s59, s59, s56
s_cbranch_scc0 sp_ok_106
s_sleep 1
s_branch sp_loop_105
sp_bad_107:
s_mov_b32 s98, 1027
s_branch L_fail
sp_ok_106:
ds_write_b32 v18, v33
s_waitcnt lgkmcnt(0)
sp_ok_106_j:
s_barrier
ds_read_b32 v33, v32
s_waitcnt lgkmcnt(0)
s_mov_b32 s85, 1879048192
v_cmp_gt_u32 vcc, s52, v33
v_cmp_gt_u32 s[58:59], s54, v33
s_and_b32 vcc_lo, vcc_lo, s56
s_cselect_b32 s70, 0, 1
s_and_b32 s59, s59, s56
s_cselect_b32 s71, 0, 1
s_or_b32 s94, s70, s71
s_cselect_b32 s10, 268435456, 0
s_cmp_lg_u32 s70, 0
s_cselect_b64 s[90:91], s[52:53], s[54:55]
s_cselect_b64 s[58:59], s[44:45], s[46:47]
s_mul_i32 s92, s90, s20
s_add_u32 s92, s92, s58
s_mul_i32 s93, s90, s21
s_add_u32 s93, s93, s59
s_andn2_b32 s71, s71, s70
s_add_u32 s52, s52, s70
s_add_u32 s54, s54, s71
s_mov_b32 s95, s94
g_go_104:
s_add_u32 m0, s51, 0
s_nop 0
buffer_load_dwordx4 v8, s[4:7], s92 offen offset:0 sc1 lds
buffer_load_dwordx4 v9, s[4:7], s92 offen offset:1024 sc1 lds
buffer_load_dwordx4 v10, s[4:7], s92 offen offset:2048 sc1 lds
buffer_load_dwordx4 v11, s[4:7], s92 offen offset:3072 sc1 lds
s_add_u32 m0, s51, 4096
s_nop 0
buffer_load_dwordx4 v12, s[4:7], s92 offen offset:0 sc1 lds
buffer_load_dwordx4 v13, s[4:7], s92 offen offset:1024 sc1 lds
buffer_load_dwordx4 v14, s[4:7], s92 offen offset:2048 sc1 lds
buffer_load_dwordx4 v15, s[4:7], s92 offen offset:3072 sc1 lds
s_add_u32 m0, s51, 8192
s_nop 0
buffer_load_dwordx4 v16, s[4:7], s92 offen offset:0 sc1 lds
buffer_load_dword v24, v22, s[4:7], 0 offen sc1
buffer_store_dword v27, v34, s[4:7], 0 offen
buffer_store_dword v27, v34, s[4:7], 0 offen
v_mov_b32 v27, s84
s_waitcnt vmcnt(10)
s_barrier
buffer_store_dword v27, v45, s[4:7], s85 offen
buffer_store_dword v27, v44, s[4:7], s85 offen sc1
s_mov_b32 s85, 1879048192
ds_read_b128 v[64:67], v31 offset:0
ds_read_b128 v[68:71], v31 offset:9216
ds_read_b128 v[72:75], v31 offset:18432
ds_read_b128 v[76:79], v31 offset:27648
ds_read_b128 v[80:83], v31 offset:1024
ds_read_b128 v[84:87], v31 offset:10240
ds_read_b128 v[88:91], v31 offset:19456
ds_read_b128 v[92:95], v31 offset:28672
s_waitcnt vmcnt(8)
s_barrier
s_branch g_body_83
g_slow_95:
v_mfma_f32_16x16x32_bf16 v[228:231], a[196:199], v[172:175], v[228:231]
v_mfma_f32_16x16x32_bf16 v[224:227], a[200:203], v[176:179], v[224:227]
v_mfma_f32_16x16x32_bf16 v[228:231], a[200:203], v[180:183], v[228:231]
v_mfma_f32_16x16x32_bf16 v[224:227], a[204:207], v[184:187], v[224:227]
v_mfma_f32_16x16x32_bf16 v[228:231], a[204:207], v[188:191], v[228:231]
v_mfma_f32_16x16x32_bf16 v[224:227], a[208:211], v[192:195], v[224:227]
v_mfma_f32_16x16x32_bf16 v[228:231], a[208:211], v[196:199], v[228:231]
v_mfma_f32_16x16x32_bf16 v[224:227], a[212:215], v[200:203], v[224:227]
v_mfma_f32_16x16x32_bf16 v[228:231], a[212:215], v[204:207], v[228:231]
s_nop 6
v_cvt_pk_bf16_f32 v56, v224, v225
v_cvt_pk_bf16_f32 v57, v226, v227
v_cvt_pk_bf16_f32 v58, v228, v229
v_cvt_pk_bf16_f32 v59, v230, v231
s_nop 0
v_permlane16_swap_b32 v56, v58
v_permlane16_swap_b32 v57, v59
buffer_store_dwordx4 v[56:59], v21, s[4:7], s93 offen sc1
s_mov_b32 s93, 1879048192
s_waitcnt vmcnt(4)
ds_write_b32 v18, v24
s_waitcnt lgkmcnt(0)
s_barrier
ds_read_b32 v33, v32
s_waitcnt lgkmcnt(0)
v_cmp_gt_u32 vcc, s52, v33
v_cmp_gt_u32 s[58:59], s54, v33
s_and_b32 vcc_lo, vcc_lo, s56
s_cselect_b32 s70, 0, 1
s_and_b32 s59, s59, s56
s_cselect_b32 s71, 0, s95
s_or_b32 s76, s70, s71
s_cselect_b32 s10, 268435456, 0
s_cmp_lg_u32 s70, 0
s_cselect_b64 s[72:73], s[52:53], s[54:55]
s_cselect_b64 s[58:59], s[44:45], s[46:47]
s_mul_i32 s74, s72, s20
s_add_u32 s74, s74, s58
s_mul_i32 s75, s72, s21
s_add_u32 s75, s75, s59
s_andn2_b32 s71, s71, s70
s_add_u32 s52, s52, s70
s_add_u32 s54, s54, s71
s_mov_b32 s77, s76
s_cmp_lg_u32 s76, 0
s_cbranch_scc1 g_go_108
v_mov_b32 v27, s90
s_waitcnt vmcnt(0)
s_barrier
s_add_u32 s70, s52, s54
s_cmp_eq_u32 s70, 130
s_cbranch_scc1 g_fin_84
s_cmp_lg_u32 s3, 0
s_cbranch_scc1 sp_ok_110_j
s_mov_b32 s23, 0
buffer_load_dword v33, v22, s[4:7], 0 offen sc1
buffer_store_dword v27, v45, s[4:7], s91 offen
buffer_store_dword v27, v44, s[4:7], s91 offen sc1
s_waitcnt vmcnt(2)
s_branch sp_loop_109_e
sp_loop_109:
buffer_load_dword v33, v22, s[4:7], 0 offen sc1
s_add_u32 s23, s23, 1
s_cmp_gt_u32 s23, 150000
s_cbranch_scc1 sp_bad_111
s_waitcnt vmcnt(0)
sp_loop_109_e:
v_cmp_gt_u32 vcc, s52, v33
v_cmp_gt_u32 s[58:59], s54, v33
s_and_b32 vcc_lo, vcc_lo, s56
s_cbranch_scc0 sp_ok_110
s_cmp_gt_u32 s23, 4
s_cselect_b32 s70, 0, s56
s_cmp_lg_u32 s95, 0
s_cselect_b32 s70, 0, s70
s_or_b32 s59, s59, s70
s_and_b32 s59, s59, s56
s_cbranch_scc0 sp_ok_110
s_sleep 1
s_branch sp_loop_109
sp_bad_111:
s_mov_b32 s98, 1027
s_branch L_fail
sp_ok_110:
ds_write_b32 v18, v33
s_waitcnt lgkmcnt(0)
sp_ok_110_j:
s_barrier
ds_read_b32 v33, v32
s_waitcnt lgkmcnt(0)
s_mov_b32 s91, 1879048192
v_cmp_gt_u32 vcc, s52, v33
v_cmp_gt_u32 s[58:59], s54, v33
s_and_b32 vcc_lo, vcc_lo, s56
s_cselect_b32 s70, 0, 1
s_and_b32 s59, s59, s56
s_cselect_b32 s71, 0, 1
s_or_b32 s76, s70, s71
s_cselect_b32 s10, 268435456, 0
s_cmp_lg_u32 s70, 0
s_cselect_b64 s[72:73], s[52:53], s[54:55]
s_cselect_b64 s[58:59], s[44:45], s[46:47]
s_mul_i32 s74, s72, s20
s_add_u32 s74, s74, s58
s_mul_i32 s75, s72, s21
s_add_u32 s75, s75, s59
s_andn2_b32 s71, s71, s70
s_add_u32 s52, s52, s70
s_add_u32 s54, s54, s71
s_mov_b32 s77, s76
g_go_108:
s_add_u32 m0, s48, 0
s_nop 0
buffer_load_dwordx4 v8, s[4:7], s74 offen offset:0 sc1 lds
buffer_load_dwordx4 v9, s[4:7], s74 offen offset:1024 sc1 lds
buffer_load_dwordx4 v10, s[4:7], s74 offen offset:2048 sc1 lds
buffer_load_dwordx4 v11, s[4:7], s74 offen offset:3072 sc1 lds
s_add_u32 m0, s48, 4096
s_nop 0
buffer_load_dwordx4 v12, s[4:7], s74 offen offset:0 sc1 lds
buffer_load_dwordx4 v13, s[4:7], s74 offen offset:1024 sc1 lds
buffer_load_dwordx4 v14, s[4:7], s74 offen offset:2048 sc1 lds
buffer_load_dwordx4 v15, s[4:7], s74 offen offset:3072 sc1 lds
s_add_u32 m0, s48, 8192
s_nop 0
buffer_load_dwordx4 v16, s[4:7], s74 offen offset:0 sc1 lds
buffer_load_dword v24, v22, s[4:7], 0 offen sc1
buffer_store_dword v27, v34, s[4:7], 0 offen
buffer_store_dword v27, v34, s[4:7], 0 offen
v_mov_b32 v27, s90
s_waitcnt vmcnt(10)
s_barrier
buffer_store_dword v27, v45, s[4:7], s91 offen
buffer_store_dword v27, v44, s[4:7], s91 offen sc1
s_mov_b32 s91, 1879048192
ds_read_b128 v[64:67], v28 offset:0
ds_read_b128 v[68:71], v28 offset:9216
ds_read_b128 v[72:75], v28 offset:18432
ds_read_b128 v[76:79], v28 offset:27648
ds_read_b128 v[80:83], v28 offset:1024
ds_read_b128 v[84:87], v28 offset:10240
ds_read_b128 v[88:91], v28 offset:19456
ds_read_b128 v[92:95], v28 offset:28672
s_waitcnt vmcnt(8)
s_barrier
s_branch g_body_80
g_fin_84:
buffer_store_dword v27, v45, s[4:7], s91 offen
buffer_store_dword v27, v44, s[4:7], s91 offen sc1
s_endpgm
H_dn:
s_mul_i32 s75, s74, 43
s_lshr_b32 s75, s75, 7
s_mul_i32 s76, s75, 3
s_sub_u32 s76, s74, s76
s_mov_b32 s8, s36
s_and_b32 s9, s37, 0xffff
s_mov_b32 s10, 5308416
s_mov_b32 s11, 0x20000
s_mul_i32 s77, s76, 12
s_mul_i32 s78, s3, 3
s_add_u32 s77, s77, s78
s_mul_i32 s78, s75, 663552
v_bfe_u32 v1, v0, 4, 1
v_bfe_u32 v2, v0, 1, 3
v_lshl_add_u32 v1, v1, 3, v2
v_mul_u32_u24 v1, 2304, v1
v_lshrrev_b32 v2, 5, v0
v_lshl_add_u32 v1, v2, 5, v1
v_and_b32 v2, 1, v0
v_lshl_add_u32 v5, v2, 4, v1
s_mul_i32 s79, s75, 36864
s_add_u32 s80, s77, 0
s_lshl_b32 s81, s80, 5
s_add_u32 s48, s81, s78
s_lshl_b32 s81, s80, 6
s_add_u32 s81, s81, s79
v_add_u32 v19, s81, v5
s_add_u32 s80, s77, 1
s_lshl_b32 s81, s80, 5
s_add_u32 s49, s81, s78
s_lshl_b32 s81, s80, 6
s_add_u32 s81, s81, s79
v_add_u32 v20, s81, v5
s_add_u32 s80, s77, 2
s_lshl_b32 s81, s80, 5
s_add_u32 s50, s81, s78
s_lshl_b32 s81, s80, 6
s_add_u32 s81, s81, s79
v_add_u32 v21, s81, v5
s_cmp_lg_u32 s3, 0
s_cbranch_scc1 wp_ok_113
s_mov_b32 s16, s40
s_and_b32 s17, s41, 0xffff
s_mov_b32 s18, 256
s_mov_b32 s19, 0x20000
v_mov_b32 v1, 224
s_mov_b32 s98, 0
s_mov_b64 exec, 1
wp_loop_112:
buffer_load_dword v2, v1, s[16:19], 0 offen sc1
s_add_u32 s98, s98, 1
s_cmp_gt_u32 s98, 150000
s_cbranch_scc1 wp_bad_114
s_waitcnt vmcnt(0)
v_readfirstlane_b32 s97, v2
s_nop 0
s_cmp_ge_u32 s97, 32
s_cbranch_scc1 wp_ok_113
s_sleep 8
s_branch wp_loop_112
wp_bad_114:
s_mov_b32 s98, 513
s_branch L_fail
wp_ok_113:
s_mov_b64 exec, -1
s_barrier
v_lshrrev_b32 v1, 5, v0
v_bfe_u32 v2, v0, 3, 1
v_lshl_add_u32 v1, v1, 1, v2
v_bfe_u32 v2, v0, 4, 1
v_bfe_u32 v3, v0, 1, 2
v_lshlrev_b32 v1, 3, v1
v_lshl_add_u32 v1, v2, 2, v1
v_add_u32 v1, v1, v3
v_mul_u32_u24 v1, 1152, v1
v_and_b32 v2, 1, v0
v_lshl_add_u32 v63, v2, 4, v1
s_mul_i32 s70, s3, 40960
v_lshrrev_b32 v1, 5, v0
v_lshlrev_b32 v1, 9, v1
v_bfe_u32 v2, v0, 4, 1
v_lshl_add_u32 v1, v2, 7, v1
v_add_u32 v1, s70, v1
v_and_b32 v2, 15, v0
v_lshl_add_u32 v2, v2, 3, v1
v_add_u32 v60, 0, v2
v_add_u32 v61, 1024, v2
v_add_u32 v62, 2048, v2
s_add_u32 m0, s70, 0
s_add_u32 s71, s48, 0
buffer_load_dwordx4 v63, s[8:11], s71 offen lds
s_add_u32 m0, s70, 1024
s_add_u32 s71, s49, 0
buffer_load_dwordx4 v63, s[8:11], s71 offen lds
s_add_u32 m0, s70, 2048
s_add_u32 s71, s50, 0
buffer_load_dwordx4 v63, s[8:11], s71 offen lds
s_add_u32 m0, s70, 3072
s_add_u32 s71, s48, 36864
buffer_load_dwordx4 v63, s[8:11], s71 offen lds
s_add_u32 m0, s70, 4096
s_add_u32 s71, s49, 36864
buffer_load_dwordx4 v63, s[8:11], s71 offen lds
s_add_u32 m0, s70, 5120
s_add_u32 s71, s50, 36864
buffer_load_dwordx4 v63, s[8:11], s71 offen lds
s_add_u32 m0, s70, 6144
s_add_u32 s71, s48, 73728
buffer_load_dwordx4 v63, s[8:11], s71 offen lds
s_add_u32 m0, s70, 7168
s_add_u32 s71, s49, 73728
buffer_load_dwordx4 v63, s[8:11], s71 offen lds
s_add_u32 m0, s70, 8192
s_add_u32 s71, s50, 73728
buffer_load_dwordx4 v63, s[8:11], s71 offen lds
s_add_u32 m0, s70, 9216
s_add_u32 s71, s48, 110592
buffer_load_dwordx4 v63, s[8:11], s71 offen lds
s_add_u32 m0, s70, 10240
s_add_u32 s71, s49, 110592
buffer_load_dwordx4 v63, s[8:11], s71 offen lds
s_add_u32 m0, s70, 11264
s_add_u32 s71, s50, 110592
buffer_load_dwordx4 v63, s[8:11], s71 offen lds
s_add_u32 m0, s70, 12288
s_add_u32 s71, s48, 147456
buffer_load_dwordx4 v63, s[8:11], s71 offen lds
s_add_u32 m0, s70, 13312
s_add_u32 s71, s49, 147456
buffer_load_dwordx4 v63, s[8:11], s71 offen lds
s_add_u32 m0, s70, 14336
s_add_u32 s71, s50, 147456
buffer_load_dwordx4 v63, s[8:11], s71 offen lds
s_add_u32 m0, s70, 15360
s_add_u32 s71, s48, 184320
buffer_load_dwordx4 v63, s[8:11], s71 offen lds
s_add_u32 m0, s70, 16384
s_add_u32 s71, s49, 184320
buffer_load_dwordx4 v63, s[8:11], s71 offen lds
s_add_u32 m0, s70, 17408
s_add_u32 s71, s50, 184320
buffer_load_dwordx4 v63, s[8:11], s71 offen lds
s_add_u32 m0, s70, 18432
s_add_u32 s71, s48, 221184
buffer_load_dwordx4 v63, s[8:11], s71 offen lds
s_add_u32 m0, s70, 19456
s_add_u32 s71, s49, 221184
buffer_load_dwordx4 v63, s[8:11], s71 offen lds
s_add_u32 m0, s70, 20480
s_add_u32 s71, s50, 221184
buffer_load_dwordx4 v63, s[8:11], s71 offen lds
s_add_u32 m0, s70, 21504
s_add_u32 s71, s48, 258048
buffer_load_dwordx4 v63, s[8:11], s71 offen lds
s_add_u32 m0, s70, 22528
s_add_u32 s71, s49, 258048
buffer_load_dwordx4 v63, s[8:11], s71 offen lds
s_add_u32 m0, s70, 23552
s_add_u32 s71, s50, 258048
buffer_load_dwordx4 v63, s[8:11], s71 offen lds
s_add_u32 m0, s70, 24576
s_add_u32 s71, s48, 294912
buffer_load_dwordx4 v63, s[8:11], s71 offen lds
s_add_u32 m0, s70, 25600
s_add_u32 s71, s49, 294912
buffer_load_dwordx4 v63, s[8:11], s71 offen lds
s_add_u32 m0, s70, 26624
s_add_u32 s71, s50, 294912
buffer_load_dwordx4 v63, s[8:11], s71 offen lds
s_add_u32 m0, s70, 27648
s_add_u32 s71, s48, 331776
buffer_load_dwordx4 v63, s[8:11], s71 offen lds
s_add_u32 m0, s70, 28672
s_add_u32 s71, s49, 331776
buffer_load_dwordx4 v63, s[8:11], s71 offen lds
s_add_u32 m0, s70, 29696
s_add_u32 s71, s50, 331776
buffer_load_dwordx4 v63, s[8:11], s71 offen lds
s_add_u32 m0, s70, 30720
s_add_u32 s71, s48, 368640
buffer_load_dwordx4 v63, s[8:11], s71 offen lds
s_add_u32 m0, s70, 31744
s_add_u32 s71, s49, 368640
buffer_load_dwordx4 v63, s[8:11], s71 offen lds
s_add_u32 m0, s70, 32768
s_add_u32 s71, s50, 368640
buffer_load_dwordx4 v63, s[8:11], s71 offen lds
s_add_u32 m0, s70, 33792
s_add_u32 s71, s48, 405504
buffer_load_dwordx4 v63, s[8:11], s71 offen lds
s_add_u32 m0, s70, 34816
s_add_u32 s71, s49, 405504
buffer_load_dwordx4 v63, s[8:11], s71 offen lds
s_add_u32 m0, s70, 35840
s_add_u32 s71, s50, 405504
buffer_load_dwordx4 v63, s[8:11], s71 offen lds
s_add_u32 m0, s70, 36864
s_add_u32 s71, s48, 442368
buffer_load_dwordx4 v63, s[8:11], s71 offen lds
s_add_u32 m0, s70, 37888
s_add_u32 s71, s49, 442368
buffer_load_dwordx4 v63, s[8:11], s71 offen lds
s_add_u32 m0, s70, 38912
s_add_u32 s71, s50, 442368
buffer_load_dwordx4 v63, s[8:11], s71 offen lds
s_waitcnt vmcnt(36)
ds_read_b64_tr_b16 a[0:1], v60 offset:0
ds_read_b64_tr_b16 a[2:3], v60 offset:256
ds_read_b64_tr_b16 a[72:73], v61 offset:0
ds_read_b64_tr_b16 a[74:75], v61 offset:256
ds_read_b64_tr_b16 a[144:145], v62 offset:0
ds_read_b64_tr_b16 a[146:147], v62 offset:256
s_waitcnt lgkmcnt(0)
s_add_u32 m0, s70, 0
s_add_u32 s71, s48, 479232
buffer_load_dwordx4 v63, s[8:11], s71 offen lds
s_add_u32 m0, s70, 1024
s_add_u32 s71, s49, 479232
buffer_load_dwordx4 v63, s[8:11], s71 offen lds
s_add_u32 m0, s70, 2048
s_add_u32 s71, s50, 479232
buffer_load_dwordx4 v63, s[8:11], s71 offen lds
s_waitcnt vmcnt(36)
ds_read_b64_tr_b16 a[4:5], v60 offset:3072
ds_read_b64_tr_b16 a[6:7], v60 offset:3328
ds_read_b64_tr_b16 a[76:77], v61 offset:3072
ds_read_b64_tr_b16 a[78:79], v61 offset:3328
ds_read_b64_tr_b16 a[148:149], v62 offset:3072
ds_read_b64_tr_b16 a[150:151], v62 offset:3328
s_waitcnt lgkmcnt(0)
s_add_u32 m0, s70, 3072
s_add_u32 s71, s48, 516096
buffer_load_dwordx4 v63, s[8:11], s71 offen lds
s_add_u32 m0, s70, 4096
s_add_u32 s71, s49, 516096
buffer_load_dwordx4 v63, s[8:11], s71 offen lds
s_add_u32 m0, s70, 5120
s_add_u32 s71, s50, 516096
buffer_load_dwordx4 v63, s[8:11], s71 offen lds
s_waitcnt vmcnt(36)
ds_read_b64_tr_b16 a[8:9], v60 offset:6144
ds_read_b64_tr_b16 a[10:11], v60 offset:6400
ds_read_b64_tr_b16 a[80:81], v61 offset:6144
ds_read_b64_tr_b16 a[82:83], v61 offset:6400
ds_read_b64_tr_b16 a[152:153], v62 offset:6144
ds_read_b64_tr_b16 a[154:155], v62 offset:6400
s_waitcnt lgkmcnt(0)
s_add_u32 m0, s70, 6144
s_add_u32 s71, s48, 552960
buffer_load_dwordx4 v63, s[8:11], s71 offen lds
s_add_u32 m0, s70, 7168
s_add_u32 s71, s49, 552960
buffer_load_dwordx4 v63, s[8:11], s71 offen lds
s_add_u32 m0, s70, 8192
s_add_u32 s71, s50, 552960
buffer_load_dwordx4 v63, s[8:11], s71 offen lds
s_waitcnt vmcnt(36)
ds_read_b64_tr_b16 a[12:13], v60 offset:9216
ds_read_b64_tr_b16 a[14:15], v60 offset:9472
ds_read_b64_tr_b16 a[84:85], v61 offset:9216
ds_read_b64_tr_b16 a[86:87], v61 offset:9472
ds_read_b64_tr_b16 a[156:157], v62 offset:9216
ds_read_b64_tr_b16 a[158:159], v62 offset:9472
s_waitcnt lgkmcnt(0)
s_add_u32 m0, s70, 9216
s_add_u32 s71, s48, 589824
buffer_load_dwordx4 v63, s[8:11], s71 offen lds
s_add_u32 m0, s70, 10240
s_add_u32 s71, s49, 589824
buffer_load_dwordx4 v63, s[8:11], s71 offen lds
s_add_u32 m0, s70, 11264
s_add_u32 s71, s50, 589824
buffer_load_dwordx4 v63, s[8:11], s71 offen lds
s_waitcnt vmcnt(36)
ds_read_b64_tr_b16 a[16:17], v60 offset:12288
ds_read_b64_tr_b16 a[18:19], v60 offset:12544
ds_read_b64_tr_b16 a[88:89], v61 offset:12288
ds_read_b64_tr_b16 a[90:91], v61 offset:12544
ds_read_b64_tr_b16 a[160:161], v62 offset:12288
ds_read_b64_tr_b16 a[162:163], v62 offset:12544
s_waitcnt lgkmcnt(0)
s_add_u32 m0, s70, 12288
s_add_u32 s71, s48, 626688
buffer_load_dwordx4 v63, s[8:11], s71 offen lds
s_add_u32 m0, s70, 13312
s_add_u32 s71, s49, 626688
buffer_load_dwordx4 v63, s[8:11], s71 offen lds
s_add_u32 m0, s70, 14336
s_add_u32 s71, s50, 626688
buffer_load_dwordx4 v63, s[8:11], s71 offen lds
s_waitcnt vmcnt(36)
ds_read_b64_tr_b16 a[20:21], v60 offset:15360
ds_read_b64_tr_b16 a[22:23], v60 offset:15616
ds_read_b64_tr_b16 a[92:93], v61 offset:15360
ds_read_b64_tr_b16 a[94:95], v61 offset:15616
ds_read_b64_tr_b16 a[164:165], v62 offset:15360
ds_read_b64_tr_b16 a[166:167], v62 offset:15616
s_waitcnt vmcnt(33)
ds_read_b64_tr_b16 a[24:25], v60 offset:18432
ds_read_b64_tr_b16 a[26:27], v60 offset:18688
ds_read_b64_tr_b16 a[96:97], v61 offset:18432
ds_read_b64_tr_b16 a[98:99], v61 offset:18688
ds_read_b64_tr_b16 a[168:169], v62 offset:18432
ds_read_b64_tr_b16 a[170:171], v62 offset:18688
s_waitcnt vmcnt(30)
ds_read_b64_tr_b16 a[28:29], v60 offset:21504
ds_read_b64_tr_b16 a[30:31], v60 offset:21760
ds_read_b64_tr_b16 a[100:101], v61 offset:21504
ds_read_b64_tr_b16 a[102:103], v61 offset:21760
ds_read_b64_tr_b16 a[172:173], v62 offset:21504
ds_read_b64_tr_b16 a[174:175], v62 offset:21760
s_waitcnt vmcnt(27)
ds_read_b64_tr_b16 a[32:33], v60 offset:24576
ds_read_b64_tr_b16 a[34:35], v60 offset:24832
ds_read_b64_tr_b16 a[104:105], v61 offset:24576
ds_read_b64_tr_b16 a[106:107], v61 offset:24832
ds_read_b64_tr_b16 a[176:177], v62 offset:24576
ds_read_b64_tr_b16 a[178:179], v62 offset:24832
s_waitcnt vmcnt(24)
ds_read_b64_tr_b16 a[36:37], v60 offset:27648
ds_read_b64_tr_b16 a[38:39], v60 offset:27904
ds_read_b64_tr_b16 a[108:109], v61 offset:27648
ds_read_b64_tr_b16 a[110:111], v61 offset:27904
ds_read_b64_tr_b16 a[180:181], v62 offset:27648
ds_read_b64_tr_b16 a[182:183], v62 offset:27904
s_waitcnt vmcnt(21)
ds_read_b64_tr_b16 a[40:41], v60 offset:30720
ds_read_b64_tr_b16 a[42:43], v60 offset:30976
ds_read_b64_tr_b16 a[112:113], v61 offset:30720
ds_read_b64_tr_b16 a[114:115], v61 offset:30976
ds_read_b64_tr_b16 a[184:185], v62 offset:30720
ds_read_b64_tr_b16 a[186:187], v62 offset:30976
s_waitcnt vmcnt(18)
ds_read_b64_tr_b16 a[44:45], v60 offset:33792
ds_read_b64_tr_b16 a[46:47], v60 offset:34048
ds_read_b64_tr_b16 a[116:117], v61 offset:33792
ds_read_b64_tr_b16 a[118:119], v61 offset:34048
ds_read_b64_tr_b16 a[188:189], v62 offset:33792
ds_read_b64_tr_b16 a[190:191], v62 offset:34048
s_waitcnt vmcnt(15)
ds_read_b64_tr_b16 a[48:49], v60 offset:36864
ds_read_b64_tr_b16 a[50:51], v60 offset:37120
ds_read_b64_tr_b16 a[120:121], v61 offset:36864
ds_read_b64_tr_b16 a[122:123], v61 offset:37120
ds_read_b64_tr_b16 a[192:193], v62 offset:36864
ds_read_b64_tr_b16 a[194:195], v62 offset:37120
s_waitcnt vmcnt(12)
ds_read_b64_tr_b16 a[52:53], v60 offset:0
ds_read_b64_tr_b16 a[54:55], v60 offset:256
ds_read_b64_tr_b16 a[124:125], v61 offset:0
ds_read_b64_tr_b16 a[126:127], v61 offset:256
ds_read_b64_tr_b16 a[196:197], v62 offset:0
ds_read_b64_tr_b16 a[198:199], v62 offset:256
s_waitcnt vmcnt(9)
ds_read_b64_tr_b16 a[56:57], v60 offset:3072
ds_read_b64_tr_b16 a[58:59], v60 offset:3328
ds_read_b64_tr_b16 a[128:129], v61 offset:3072
ds_read_b64_tr_b16 a[130:131], v61 offset:3328
ds_read_b64_tr_b16 a[200:201], v62 offset:3072
ds_read_b64_tr_b16 a[202:203], v62 offset:3328
s_waitcnt vmcnt(6)
ds_read_b64_tr_b16 a[60:61], v60 offset:6144
ds_read_b64_tr_b16 a[62:63], v60 offset:6400
ds_read_b64_tr_b16 a[132:133], v61 offset:6144
ds_read_b64_tr_b16 a[134:135], v61 offset:6400
ds_read_b64_tr_b16 a[204:205], v62 offset:6144
ds_read_b64_tr_b16 a[206:207], v62 offset:6400
s_waitcnt vmcnt(3)
ds_read_b64_tr_b16 a[64:65], v60 offset:9216
ds_read_b64_tr_b16 a[66:67], v60 offset:9472
ds_read_b64_tr_b16 a[136:137], v61 offset:9216
ds_read_b64_tr_b16 a[138:139], v61 offset:9472
ds_read_b64_tr_b16 a[208:209], v62 offset:9216
ds_read_b64_tr_b16 a[210:211], v62 offset:9472
s_waitcnt vmcnt(0)
ds_read_b64_tr_b16 a[68:69], v60 offset:12288
ds_read_b64_tr_b16 a[70:71], v60 offset:12544
ds_read_b64_tr_b16 a[140:141], v61 offset:12288
ds_read_b64_tr_b16 a[142:143], v61 offset:12544
ds_read_b64_tr_b16 a[212:213], v62 offset:12288
ds_read_b64_tr_b16 a[214:215], v62 offset:12544
s_waitcnt lgkmcnt(0)
v_lshlrev_b32 v17, 4, v0
s_lshl_b32 s70, s3, 10
v_add_u32 v1, s70, v17
v_add_u32 v8, 4096, v1
v_add_u32 v9, 7168, v1
v_add_u32 v10, 10240, v1
v_add_u32 v11, 13312, v1
v_add_u32 v12, 20480, v1
v_add_u32 v13, 23552, v1
v_add_u32 v14, 26624, v1
v_add_u32 v15, 29696, v1
v_add_u32 v16, 36864, v1
s_mul_i32 s77, s75, 6
v_and_b32 v2, 31, v0
v_add_u32 v1, s77, v2
v_mul_u32_u24 v1, 128, v1
v_lshrrev_b32 v3, 5, v0
v_mul_u32_u24 v3, 32768, v3
v_add_u32 v1, 23552, v1
v_add_u32 v1, v1, v3
v_mov_b32 v3, 2147483632
s_cmp_eq_u32 s3, 0
s_cselect_b32 s71, 6, 0
v_cmp_gt_u32 vcc, s71, v2
s_nop 1
v_cndmask_b32 v22, v3, v1, vcc
s_mov_b32 s56, 0x3f
s_mul_i32 s70, s74, 128
s_add_u32 s70, s70, 29696
v_mov_b32 v1, s70
s_min_u32 s71, s71, 1
v_cmp_gt_u32 vcc, s71, v0
s_nop 1
v_cndmask_b32 v44, v3, v1, vcc
v_add_u32 v45, 65536, v44
s_getpc_b64 s[96:97]
pc_115:
s_add_u32 s96, s96, L_writers-pc_115
s_addc_u32 s97, s97, 0
v_subrev_u32 v23, 0, v22
v_lshrrev_b32 v23, 7, v23
v_cmp_gt_u32 vcc, 0x200, v23
s_nop 1
v_cndmask_b32 v23, 0, v23, vcc
global_load_ubyte v23, v23, s[96:97]
s_mul_i32 s77, s75, 36864
s_add_u32 s44, s77, 161517568
s_mov_b32 s45, 218144768
s_mov_b32 s52, 1
s_mov_b32 s53, 0
s_add_u32 s46, s77, 180391936
s_mov_b32 s47, 218144768
s_mov_b32 s54, 1
s_mov_b32 s55, 32768
s_mov_b32 s25, 200
s_mov_b32 s20, 294912
s_mov_b32 s21, 294912
s_branch G_sss18
H_wo:
s_mul_i32 s75, s74, 43
s_lshr_b32 s75, s75, 7
s_mul_i32 s76, s75, 3
s_sub_u32 s76, s74, s76
s_mov_b32 s8, s30
s_and_b32 s9, s31, 0xffff
s_mov_b32 s10, 4718592
s_mov_b32 s11, 0x20000
s_mul_i32 s77, s76, 12
s_mul_i32 s78, s3, 3
s_add_u32 s77, s77, s78
s_mul_i32 s78, s75, 589824
v_bfe_u32 v1, v0, 4, 1
v_bfe_u32 v2, v0, 1, 3
v_lshl_add_u32 v1, v1, 3, v2
v_mul_u32_u24 v1, 2304, v1
v_lshrrev_b32 v2, 5, v0
v_lshl_add_u32 v1, v2, 5, v1
v_and_b32 v2, 1, v0
v_lshl_add_u32 v5, v2, 4, v1
s_mul_i32 s79, s75, 36864
s_add_u32 s80, s77, 0
s_lshl_b32 s81, s80, 5
s_add_u32 s48, s81, s78
s_lshl_b32 s81, s80, 6
s_add_u32 s81, s81, s79
v_add_u32 v19, s81, v5
s_add_u32 s80, s77, 1
s_lshl_b32 s81, s80, 5
s_add_u32 s49, s81, s78
s_lshl_b32 s81, s80, 6
s_add_u32 s81, s81, s79
v_add_u32 v20, s81, v5
s_add_u32 s80, s77, 2
s_lshl_b32 s81, s80, 5
s_add_u32 s50, s81, s78
s_lshl_b32 s81, s80, 6
s_add_u32 s81, s81, s79
v_add_u32 v21, s81, v5
v_lshrrev_b32 v1, 5, v0
v_bfe_u32 v2, v0, 3, 1
v_lshl_add_u32 v1, v1, 1, v2
v_bfe_u32 v2, v0, 4, 1
v_bfe_u32 v3, v0, 1, 2
v_lshlrev_b32 v1, 2, v1
v_lshl_add_u32 v1, v2, 4, v1
v_add_u32 v1, v1, v3
v_mul_u32_u24 v1, 1152, v1
v_and_b32 v2, 1, v0
v_lshl_add_u32 v63, v2, 4, v1
s_mul_i32 s70, s3, 40960
v_lshrrev_b32 v1, 5, v0
v_lshlrev_b32 v1, 9, v1
v_bfe_u32 v2, v0, 4, 1
v_lshl_add_u32 v1, v2, 7, v1
v_add_u32 v1, s70, v1
v_and_b32 v2, 15, v0
v_lshl_add_u32 v2, v2, 3, v1
v_add_u32 v60, 0, v2
v_add_u32 v61, 1024, v2
v_add_u32 v62, 2048, v2
s_add_u32 m0, s70, 0
s_add_u32 s71, s48, 0
buffer_load_dwordx4 v63, s[8:11], s71 offen lds
s_add_u32 m0, s70, 1024
s_add_u32 s71, s49, 0
buffer_load_dwordx4 v63, s[8:11], s71 offen lds
s_add_u32 m0, s70, 2048
s_add_u32 s71, s50, 0
buffer_load_dwordx4 v63, s[8:11], s71 offen lds
s_add_u32 m0, s70, 3072
s_add_u32 s71, s48, 36864
buffer_load_dwordx4 v63, s[8:11], s71 offen lds
s_add_u32 m0, s70, 4096
s_add_u32 s71, s49, 36864
buffer_load_dwordx4 v63, s[8:11], s71 offen lds
s_add_u32 m0, s70, 5120
s_add_u32 s71, s50, 36864
buffer_load_dwordx4 v63, s[8:11], s71 offen lds
s_add_u32 m0, s70, 6144
s_add_u32 s71, s48, 73728
buffer_load_dwordx4 v63, s[8:11], s71 offen lds
s_add_u32 m0, s70, 7168
s_add_u32 s71, s49, 73728
buffer_load_dwordx4 v63, s[8:11], s71 offen lds
s_add_u32 m0, s70, 8192
s_add_u32 s71, s50, 73728
buffer_load_dwordx4 v63, s[8:11], s71 offen lds
s_add_u32 m0, s70, 9216
s_add_u32 s71, s48, 110592
buffer_load_dwordx4 v63, s[8:11], s71 offen lds
s_add_u32 m0, s70, 10240
s_add_u32 s71, s49, 110592
buffer_load_dwordx4 v63, s[8:11], s71 offen lds
s_add_u32 m0, s70, 11264
s_add_u32 s71, s50, 110592
buffer_load_dwordx4 v63, s[8:11], s71 offen lds
s_add_u32 m0, s70, 12288
s_add_u32 s71, s48, 147456
buffer_load_dwordx4 v63, s[8:11], s71 offen lds
s_add_u32 m0, s70, 13312
s_add_u32 s71, s49, 147456
buffer_load_dwordx4 v63, s[8:11], s71 offen lds
s_add_u32 m0, s70, 14336
s_add_u32 s71, s50, 147456
buffer_load_dwordx4 v63, s[8:11], s71 offen lds
s_add_u32 m0, s70, 15360
s_add_u32 s71, s48, 184320
buffer_load_dwordx4 v63, s[8:11], s71 offen lds
s_add_u32 m0, s70, 16384
s_add_u32 s71, s49, 184320
buffer_load_dwordx4 v63, s[8:11], s71 offen lds
s_add_u32 m0, s70, 17408
s_add_u32 s71, s50, 184320
buffer_load_dwordx4 v63, s[8:11], s71 offen lds
s_add_u32 m0, s70, 18432
s_add_u32 s71, s48, 221184
buffer_load_dwordx4 v63, s[8:11], s71 offen lds
s_add_u32 m0, s70, 19456
s_add_u32 s71, s49, 221184
buffer_load_dwordx4 v63, s[8:11], s71 offen lds
s_add_u32 m0, s70, 20480
s_add_u32 s71, s50, 221184
buffer_load_dwordx4 v63, s[8:11], s71 offen lds
s_add_u32 m0, s70, 21504
s_add_u32 s71, s48, 258048
buffer_load_dwordx4 v63, s[8:11], s71 offen lds
s_add_u32 m0, s70, 22528
s_add_u32 s71, s49, 258048
buffer_load_dwordx4 v63, s[8:11], s71 offen lds
s_add_u32 m0, s70, 23552
s_add_u32 s71, s50, 258048
buffer_load_dwordx4 v63, s[8:11], s71 offen lds
s_add_u32 m0, s70, 24576
s_add_u32 s71, s48, 294912
buffer_load_dwordx4 v63, s[8:11], s71 offen lds
s_add_u32 m0, s70, 25600
s_add_u32 s71, s49, 294912
buffer_load_dwordx4 v63, s[8:11], s71 offen lds
s_add_u32 m0, s70, 26624
s_add_u32 s71, s50, 294912
buffer_load_dwordx4 v63, s[8:11], s71 offen lds
s_add_u32 m0, s70, 27648
s_add_u32 s71, s48, 331776
buffer_load_dwordx4 v63, s[8:11], s71 offen lds
s_add_u32 m0, s70, 28672
s_add_u32 s71, s49, 331776
buffer_load_dwordx4 v63, s[8:11], s71 offen lds
s_add_u32 m0, s70, 29696
s_add_u32 s71, s50, 331776
buffer_load_dwordx4 v63, s[8:11], s71 offen lds
s_add_u32 m0, s70, 30720
s_add_u32 s71, s48, 368640
buffer_load_dwordx4 v63, s[8:11], s71 offen lds
s_add_u32 m0, s70, 31744
s_add_u32 s71, s49, 368640
buffer_load_dwordx4 v63, s[8:11], s71 offen lds
s_add_u32 m0, s70, 32768
s_add_u32 s71, s50, 368640
buffer_load_dwordx4 v63, s[8:11], s71 offen lds
s_add_u32 m0, s70, 33792
s_add_u32 s71, s48, 405504
buffer_load_dwordx4 v63, s[8:11], s71 offen lds
s_add_u32 m0, s70, 34816
s_add_u32 s71, s49, 405504
buffer_load_dwordx4 v63, s[8:11], s71 offen lds
s_add_u32 m0, s70, 35840
s_add_u32 s71, s50, 405504
buffer_load_dwordx4 v63, s[8:11], s71 offen lds
s_add_u32 m0, s70, 36864
s_add_u32 s71, s48, 442368
buffer_load_dwordx4 v63, s[8:11], s71 offen lds
s_add_u32 m0, s70, 37888
s_add_u32 s71, s49, 442368
buffer_load_dwordx4 v63, s[8:11], s71 offen lds
s_add_u32 m0, s70, 38912
s_add_u32 s71, s50, 442368
buffer_load_dwordx4 v63, s[8:11], s71 offen lds
s_waitcnt vmcnt(36)
ds_read_b64_tr_b16 a[0:1], v60 offset:0
ds_read_b64_tr_b16 a[2:3], v60 offset:256
ds_read_b64_tr_b16 a[72:73], v61 offset:0
ds_read_b64_tr_b16 a[74:75], v61 offset:256
ds_read_b64_tr_b16 a[144:145], v62 offset:0
ds_read_b64_tr_b16 a[146:147], v62 offset:256
s_waitcnt lgkmcnt(0)
s_add_u32 m0, s70, 0
s_add_u32 s71, s48, 479232
buffer_load_dwordx4 v63, s[8:11], s71 offen lds
s_add_u32 m0, s70, 1024
s_add_u32 s71, s49, 479232
buffer_load_dwordx4 v63, s[8:11], s71 offen lds
s_add_u32 m0, s70, 2048
s_add_u32 s71, s50, 479232
buffer_load_dwordx4 v63, s[8:11], s71 offen lds
s_waitcnt vmcnt(36)
ds_read_b64_tr_b16 a[4:5], v60 offset:3072
ds_read_b64_tr_b16 a[6:7], v60 offset:3328
ds_read_b64_tr_b16 a[76:77], v61 offset:3072
ds_read_b64_tr_b16 a[78:79], v61 offset:3328
ds_read_b64_tr_b16 a[148:149], v62 offset:3072
ds_read_b64_tr_b16 a[150:151], v62 offset:3328
s_waitcnt lgkmcnt(0)
s_add_u32 m0, s70, 3072
s_add_u32 s71, s48, 516096
buffer_load_dwordx4 v63, s[8:11], s71 offen lds
s_add_u32 m0, s70, 4096
s_add_u32 s71, s49, 516096
buffer_load_dwordx4 v63, s[8:11], s71 offen lds
s_add_u32 m0, s70, 5120
s_add_u32 s71, s50, 516096
buffer_load_dwordx4 v63, s[8:11], s71 offen lds
s_waitcnt vmcnt(36)
ds_read_b64_tr_b16 a[8:9], v60 offset:6144
ds_read_b64_tr_b16 a[10:11], v60 offset:6400
ds_read_b64_tr_b16 a[80:81], v61 offset:6144
ds_read_b64_tr_b16 a[82:83], v61 offset:6400
ds_read_b64_tr_b16 a[152:153], v62 offset:6144
ds_read_b64_tr_b16 a[154:155], v62 offset:6400
s_waitcnt lgkmcnt(0)
s_add_u32 m0, s70, 6144
s_add_u32 s71, s48, 552960
buffer_load_dwordx4 v63, s[8:11], s71 offen lds
s_add_u32 m0, s70, 7168
s_add_u32 s71, s49, 552960
buffer_load_dwordx4 v63, s[8:11], s71 offen lds
s_add_u32 m0, s70, 8192
s_add_u32 s71, s50, 552960
buffer_load_dwordx4 v63, s[8:11], s71 offen lds
s_waitcnt vmcnt(36)
ds_read_b64_tr_b16 a[12:13], v60 offset:9216
ds_read_b64_tr_b16 a[14:15], v60 offset:9472
ds_read_b64_tr_b16 a[84:85], v61 offset:9216
ds_read_b64_tr_b16 a[86:87], v61 offset:9472
ds_read_b64_tr_b16 a[156:157], v62 offset:9216
ds_read_b64_tr_b16 a[158:159], v62 offset:9472
s_waitcnt vmcnt(33)
ds_read_b64_tr_b16 a[16:17], v60 offset:12288
ds_read_b64_tr_b16 a[18:19], v60 offset:12544
ds_read_b64_tr_b16 a[88:89], v61 offset:12288
ds_read_b64_tr_b16 a[90:91], v61 offset:12544
ds_read_b64_tr_b16 a[160:161], v62 offset:12288
ds_read_b64_tr_b16 a[162:163], v62 offset:12544
s_waitcnt vmcnt(30)
ds_read_b64_tr_b16 a[20:21], v60 offset:15360
ds_read_b64_tr_b16 a[22:23], v60 offset:15616
ds_read_b64_tr_b16 a[92:93], v61 offset:15360
ds_read_b64_tr_b16 a[94:95], v61 offset:15616
ds_read_b64_tr_b16 a[164:165], v62 offset:15360
ds_read_b64_tr_b16 a[166:167], v62 offset:15616
s_waitcnt vmcnt(27)
ds_read_b64_tr_b16 a[24:25], v60 offset:18432
ds_read_b64_tr_b16 a[26:27], v60 offset:18688
ds_read_b64_tr_b16 a[96:97], v61 offset:18432
ds_read_b64_tr_b16 a[98:99], v61 offset:18688
ds_read_b64_tr_b16 a[168:169], v62 offset:18432
ds_read_b64_tr_b16 a[170:171], v62 offset:18688
s_waitcnt vmcnt(24)
ds_read_b64_tr_b16 a[28:29], v60 offset:21504
ds_read_b64_tr_b16 a[30:31], v60 offset:21760
ds_read_b64_tr_b16 a[100:101], v61 offset:21504
ds_read_b64_tr_b16 a[102:103], v61 offset:21760
ds_read_b64_tr_b16 a[172:173], v62 offset:21504
ds_read_b64_tr_b16 a[174:175], v62 offset:21760
s_waitcnt vmcnt(21)
ds_read_b64_tr_b16 a[32:33], v60 offset:24576
ds_read_b64_tr_b16 a[34:35], v60 offset:24832
ds_read_b64_tr_b16 a[104:105], v61 offset:24576
ds_read_b64_tr_b16 a[106:107], v61 offset:24832
ds_read_b64_tr_b16 a[176:177], v62 offset:24576
ds_read_b64_tr_b16 a[178:179], v62 offset:24832
s_waitcnt vmcnt(18)
ds_read_b64_tr_b16 a[36:37], v60 offset:27648
ds_read_b64_tr_b16 a[38:39], v60 offset:27904
ds_read_b64_tr_b16 a[108:109], v61 offset:27648
ds_read_b64_tr_b16 a[110:111], v61 offset:27904
ds_read_b64_tr_b16 a[180:181], v62 offset:27648
ds_read_b64_tr_b16 a[182:183], v62 offset:27904
s_waitcnt vmcnt(15)
ds_read_b64_tr_b16 a[40:41], v60 offset:30720
ds_read_b64_tr_b16 a[42:43], v60 offset:30976
ds_read_b64_tr_b16 a[112:113], v61 offset:30720
ds_read_b64_tr_b16 a[114:115], v61 offset:30976
ds_read_b64_tr_b16 a[184:185], v62 offset:30720
ds_read_b64_tr_b16 a[186:187], v62 offset:30976
s_waitcnt vmcnt(12)
ds_read_b64_tr_b16 a[44:45], v60 offset:33792
ds_read_b64_tr_b16 a[46:47], v60 offset:34048
ds_read_b64_tr_b16 a[116:117], v61 offset:33792
ds_read_b64_tr_b16 a[118:119], v61 offset:34048
ds_read_b64_tr_b16 a[188:189], v62 offset:33792
ds_read_b64_tr_b16 a[190:191], v62 offset:34048
s_waitcnt vmcnt(9)
ds_read_b64_tr_b16 a[48:49], v60 offset:36864
ds_read_b64_tr_b16 a[50:51], v60 offset:37120
ds_read_b64_tr_b16 a[120:121], v61 offset:36864
ds_read_b64_tr_b16 a[122:123], v61 offset:37120
ds_read_b64_tr_b16 a[192:193], v62 offset:36864
ds_read_b64_tr_b16 a[194:195], v62 offset:37120
s_waitcnt vmcnt(6)
ds_read_b64_tr_b16 a[52:53], v60 offset:0
ds_read_b64_tr_b16 a[54:55], v60 offset:256
ds_read_b64_tr_b16 a[124:125], v61 offset:0
ds_read_b64_tr_b16 a[126:127], v61 offset:256
ds_read_b64_tr_b16 a[196:197], v62 offset:0
ds_read_b64_tr_b16 a[198:199], v62 offset:256
s_waitcnt vmcnt(3)
ds_read_b64_tr_b16 a[56:57], v60 offset:3072
ds_read_b64_tr_b16 a[58:59], v60 offset:3328
ds_read_b64_tr_b16 a[128:129], v61 offset:3072
ds_read_b64_tr_b16 a[130:131], v61 offset:3328
ds_read_b64_tr_b16 a[200:201], v62 offset:3072
ds_read_b64_tr_b16 a[202:203], v62 offset:3328
s_waitcnt vmcnt(0)
ds_read_b64_tr_b16 a[60:61], v60 offset:6144
ds_read_b64_tr_b16 a[62:63], v60 offset:6400
ds_read_b64_tr_b16 a[132:133], v61 offset:6144
ds_read_b64_tr_b16 a[134:135], v61 offset:6400
ds_read_b64_tr_b16 a[204:205], v62 offset:6144
ds_read_b64_tr_b16 a[206:207], v62 offset:6400
s_waitcnt lgkmcnt(0)
v_lshlrev_b32 v17, 4, v0
s_lshl_b32 s70, s3, 10
v_add_u32 v1, s70, v17
v_add_u32 v8, 4096, v1
v_add_u32 v9, 7168, v1
v_add_u32 v10, 10240, v1
v_add_u32 v11, 13312, v1
v_add_u32 v12, 20480, v1
v_add_u32 v13, 23552, v1
v_add_u32 v14, 26624, v1
v_add_u32 v15, 29696, v1
s_mul_i32 s77, s75, 4
v_and_b32 v2, 31, v0
v_add_u32 v1, s77, v2
v_mul_u32_u24 v1, 128, v1
v_lshrrev_b32 v3, 5, v0
v_mul_u32_u24 v3, 32768, v3
v_add_u32 v1, 14336, v1
v_add_u32 v1, v1, v3
v_mov_b32 v3, 2147483632
s_cmp_eq_u32 s3, 0
s_cselect_b32 s71, 4, 0
v_cmp_gt_u32 vcc, s71, v2
s_nop 1
v_cndmask_b32 v22, v3, v1, vcc
s_mov_b32 s56, 0xf
s_mul_i32 s70, s74, 128
s_add_u32 s70, s70, 18432
v_mov_b32 v1, s70
s_min_u32 s71, s71, 1
v_cmp_gt_u32 vcc, s71, v0
s_nop 1
v_cndmask_b32 v44, v3, v1, vcc
v_add_u32 v45, 65536, v44
s_getpc_b64 s[96:97]
pc_116:
s_add_u32 s96, s96, L_writers-pc_116
s_addc_u32 s97, s97, 0
v_subrev_u32 v23, 0, v22
v_lshrrev_b32 v23, 7, v23
v_cmp_gt_u32 vcc, 0x200, v23
s_nop 1
v_cndmask_b32 v23, 0, v23, vcc
global_load_ubyte v23, v23, s[96:97]
s_mul_i32 s77, s75, 32768
s_add_u32 s44, s77, 127995904
s_mov_b32 s45, 199270400
s_mov_b32 s52, 1
s_mov_b32 s53, 0
s_add_u32 s46, s77, 144773120
s_mov_b32 s47, 199270400
s_mov_b32 s54, 1
s_mov_b32 s55, 32768
s_mov_b32 s25, 200
s_mov_b32 s20, 262144
s_mov_b32 s21, 294912
s_mov_b32 s8, s42
s_and_b32 s9, s43, 0xffff
s_mov_b32 s10, 0
s_mov_b32 s11, 0x20000
s_mov_b32 s22, 0
s_mul_i32 s48, s3, 8192
s_add_u32 s49, s48, 36864
s_add_u32 s50, s48, 73728
s_add_u32 s51, s48, 110592
s_mov_b32 s57, 0xbfb8aa3b
v_add_u32 v28, 0, v17
v_add_u32 v29, 36864, v17
v_add_u32 v30, 73728, v17
v_add_u32 v31, 110592, v17
v_lshlrev_b32 v1, 2, v0
v_add_u32 v32, 147456, v1
s_lshl_b32 s70, s3, 8
v_add_u32 v18, s70, v32
v_mov_b64 v[224:225], 0
v_mov_b64 v[236:237], 0
v_mov_b64 v[226:227], 0
v_mov_b64 v[238:239], 0
v_mov_b64 v[228:229], 0
v_mov_b64 v[240:241], 0
v_mov_b64 v[230:231], 0
v_mov_b64 v[242:243], 0
s_mov_b32 s12, s40
s_and_b32 s13, s41, 0xffff
s_mov_b32 s14, 256
s_mov_b32 s15, 0x20000
v_lshlrev_b32 v26, 2, v0
v_add_u32 v27, 128, v26
v_cmp_le_u32 vcc, 2, v0
s_nop 1
v_cndmask_b32 v26, v26, v27, vcc
v_mov_b32 v27, 192
v_cmp_eq_u32 vcc, 8, v0
s_nop 1
v_cndmask_b32 v26, v26, v27, vcc
v_mov_b32 v27, 2147483632
v_cmp_lt_u32 vcc, 8, v0
s_nop 1
v_cndmask_b32 v26, v26, v27, vcc
s_mov_b32 s98, 0
wi_loop_122:
buffer_load_dword v27, v26, s[12:15], 0 offen sc1
s_add_u32 s98, s98, 1
s_cmp_gt_u32 s98, 150000
s_cbranch_scc1 wi_bad_124
s_waitcnt vmcnt(0)
v_cmp_eq_u32 vcc, 32, v27
s_nop 0
s_and_b32 s97, vcc_lo, 0x1ff
s_cmp_eq_u32 s97, 0x1ff
s_cbranch_scc1 wi_ok_123
v_cmp_lt_u32 vcc, 32, v27
s_nop 0
s_and_b32 s96, vcc_lo, 0xff
s_cselect_b32 s96, 0x100, 0
s_and_b32 s96, s96, s97
s_cbranch_scc1 wi_over_125
s_sleep 8
s_branch wi_loop_122
wi_bad_124:
s_mov_b32 s98, 512
s_branch L_fail
wi_over_125:
s_mov_b32 s100, 255
wi_ok_123:
v_add_u32 v26, 65536, v22
v_cmp_eq_u32 vcc, s100, v23
s_nop 1
v_cndmask_b32 v22, v22, v26, vcc
s_mov_b32 s90, 0
s_mov_b32 s91, 1879048192
s_mov_b32 s93, 1879048192
v_mov_b32 v34, 2147483632
s_barrier
s_mov_b32 s95, 1
s_cmp_lg_u32 s3, 0
s_cbranch_scc1 sp_ok_127_j
s_mov_b32 s23, 0
sp_loop_126:
buffer_load_dword v33, v22, s[4:7], 0 offen sc1
s_add_u32 s23, s23, 1
s_cmp_gt_u32 s23, 150000
s_cbranch_scc1 sp_bad_128
s_waitcnt vmcnt(0)
sp_loop_126_e:
v_cmp_gt_u32 vcc, s52, v33
v_cmp_gt_u32 s[58:59], s54, v33
s_and_b32 vcc_lo, vcc_lo, s56
s_cbranch_scc0 sp_ok_127
s_cmp_gt_u32 s23, 4
s_cselect_b32 s70, 0, s56
s_cmp_lg_u32 s95, 0
s_cselect_b32 s70, 0, s70
s_or_b32 s59, s59, s70
s_and_b32 s59, s59, s56
s_cbranch_scc0 sp_ok_127
s_sleep 1
s_branch sp_loop_126
sp_bad_128:
s_mov_b32 s98, 1029
s_branch L_fail
sp_ok_127:
ds_write_b32 v18, v33
s_waitcnt lgkmcnt(0)
sp_ok_127_j:
s_barrier
ds_read_b32 v33, v32
s_waitcnt lgkmcnt(0)
v_cmp_gt_u32 vcc, s52, v33
v_cmp_gt_u32 s[58:59], s54, v33
s_and_b32 vcc_lo, vcc_lo, s56
s_cselect_b32 s70, 0, 1
s_and_b32 s59, s59, s56
s_cselect_b32 s71, 0, 1
s_or_b32 s76, s70, s71
s_cselect_b32 s10, 268435456, 0
s_cmp_lg_u32 s70, 0
s_cselect_b64 s[72:73], s[52:53], s[54:55]
s_cselect_b64 s[58:59], s[44:45], s[46:47]
s_mul_i32 s74, s72, s20
s_add_u32 s74, s74, s58
s_mul_i32 s75, s72, s21
s_add_u32 s75, s75, s59
s_andn2_b32 s71, s71, s70
s_add_u32 s52, s52, s70
s_add_u32 s54, s54, s71
s_mov_b32 s77, s76
s_add_u32 m0, s48, 0
s_nop 0
buffer_load_dwordx4 v8, s[4:7], s74 offen offset:0 sc1 lds
buffer_load_dwordx4 v9, s[4:7], s74 offen offset:1024 sc1 lds
buffer_load_dwordx4 v10, s[4:7], s74 offen offset:2048 sc1 lds
buffer_load_dwordx4 v11, s[4:7], s74 offen offset:3072 sc1 lds
s_add_u32 m0, s48, 4096
s_nop 0
buffer_load_dwordx4 v12, s[4:7], s74 offen offset:0 sc1 lds
buffer_load_dwordx4 v13, s[4:7], s74 offen offset:1024 sc1 lds
buffer_load_dwordx4 v14, s[4:7], s74 offen offset:2048 sc1 lds
buffer_load_dwordx4 v15, s[4:7], s74 offen offset:3072 sc1 lds
buffer_load_dword v24, v22, s[4:7], 0 offen sc1
buffer_store_dword v27, v34, s[4:7], 0 offen
buffer_store_dword v27, v34, s[4:7], 0 offen
v_mov_b32 v27, s90
s_waitcnt vmcnt(9)
s_barrier
buffer_store_dword v27, v45, s[4:7], s91 offen
buffer_store_dword v27, v44, s[4:7], s91 offen sc1
s_mov_b32 s91, 1879048192
ds_read_b128 v[64:67], v28 offset:0
ds_read_b128 v[68:71], v28 offset:8192
ds_read_b128 v[72:75], v28 offset:16384
ds_read_b128 v[76:79], v28 offset:24576
ds_read_b128 v[80:83], v28 offset:1024
ds_read_b128 v[84:87], v28 offset:9216
ds_read_b128 v[88:91], v28 offset:17408
ds_read_b128 v[92:95], v28 offset:25600
s_waitcnt vmcnt(7)
s_barrier
s_branch g_body_117
g_body_117:
s_waitcnt lgkmcnt(4)
v_mfma_f32_16x16x32_bf16 v[208:211], a[0:3], v[64:67], 0
ds_read_b128 v[96:99], v28 offset:2048
v_mfma_f32_16x16x32_bf16 v[212:215], a[0:3], v[68:71], 0
ds_read_b128 v[100:103], v28 offset:10240
v_mfma_f32_16x16x32_bf16 v[216:219], a[72:75], v[64:67], 0
v_mfma_f32_16x16x32_bf16 v[208:211], a[4:7], v[72:75], v[208:211]
ds_read_b128 v[104:107], v28 offset:18432
v_cvt_pk_bf16_f32 v56, v224, v225
v_mfma_f32_16x16x32_bf16 v[212:215], a[4:7], v[76:79], v[212:215]
ds_read_b128 v[108:111], v28 offset:26624
v_cvt_pk_bf16_f32 v57, v226, v227
v_mfma_f32_16x16x32_bf16 v[220:223], a[72:75], v[68:71], 0
v_cvt_pk_bf16_f32 v58, v228, v229
s_waitcnt lgkmcnt(4)
v_mfma_f32_16x16x32_bf16 v[208:211], a[8:11], v[80:83], v[208:211]
ds_read_b128 v[112:115], v28 offset:3072
v_cvt_pk_bf16_f32 v59, v230, v231
v_mfma_f32_16x16x32_bf16 v[212:215], a[8:11], v[84:87], v[212:215]
ds_read_b128 v[116:119], v28 offset:11264
v_permlane16_swap_b32 v56, v58
v_mfma_f32_16x16x32_bf16 v[216:219], a[76:79], v[72:75], v[216:219]
v_permlane16_swap_b32 v57, v59
v_mfma_f32_16x16x32_bf16 v[208:211], a[12:15], v[88:91], v[208:211]
ds_read_b128 v[120:123], v28 offset:19456
v_mfma_f32_16x16x32_bf16 v[212:215], a[12:15], v[92:95], v[212:215]
ds_read_b128 v[124:127], v28 offset:27648
v_mfma_f32_16x16x32_bf16 v[220:223], a[76:79], v[76:79], v[220:223]
s_waitcnt lgkmcnt(4)
v_mfma_f32_16x16x32_bf16 v[208:211], a[16:19], v[96:99], v[208:211]
ds_read_b128 v[128:131], v28 offset:4096
v_mfma_f32_16x16x32_bf16 v[212:215], a[16:19], v[100:103], v[212:215]
ds_read_b128 v[132:135], v28 offset:12288
v_mfma_f32_16x16x32_bf16 v[216:219], a[80:83], v[80:83], v[216:219]
buffer_store_dwordx4 v[56:59], v21, s[4:7], s93 offen sc1
v_mfma_f32_16x16x32_bf16 v[208:211], a[20:23], v[104:107], v[208:211]
ds_read_b128 v[136:139], v28 offset:20480
v_mov_b32 v27, s90
v_mfma_f32_16x16x32_bf16 v[212:215], a[20:23], v[108:111], v[212:215]
ds_read_b128 v[140:143], v28 offset:28672
v_mfma_f32_16x16x32_bf16 v[220:223], a[80:83], v[84:87], v[220:223]
s_waitcnt lgkmcnt(4)
v_mfma_f32_16x16x32_bf16 v[208:211], a[24:27], v[112:115], v[208:211]
ds_read_b128 v[144:147], v28 offset:5120
v_mfma_f32_16x16x32_bf16 v[212:215], a[24:27], v[116:119], v[212:215]
ds_read_b128 v[148:151], v28 offset:13312
v_mfma_f32_16x16x32_bf16 v[216:219], a[84:87], v[88:91], v[216:219]
v_mfma_f32_16x16x32_bf16 v[208:211], a[28:31], v[120:123], v[208:211]
ds_read_b128 v[152:155], v28 offset:21504
s_waitcnt vmcnt(4)
ds_write_b32 v18, v24
v_mfma_f32_16x16x32_bf16 v[212:215], a[28:31], v[124:127], v[212:215]
ds_read_b128 v[156:159], v28 offset:29696
v_mfma_f32_16x16x32_bf16 v[220:223], a[84:87], v[92:95], v[220:223]
s_waitcnt vmcnt(6)
s_barrier
s_waitcnt lgkmcnt(5)
v_mfma_f32_16x16x32_bf16 v[208:211], a[32:35], v[128:131], v[208:211]
ds_read_b128 v[160:163], v28 offset:6144
s_waitcnt lgkmcnt(2)
s_barrier
v_mfma_f32_16x16x32_bf16 v[212:215], a[32:35], v[132:135], v[212:215]
ds_read_b128 v[164:167], v28 offset:14336
ds_read_b32 v33, v32
v_mfma_f32_16x16x32_bf16 v[216:219], a[88:91], v[96:99], v[216:219]
v_mfma_f32_16x16x32_bf16 v[208:211], a[36:39], v[136:139], v[208:211]
ds_read_b128 v[168:171], v28 offset:22528
v_mfma_f32_16x16x32_bf16 v[212:215], a[36:39], v[140:143], v[212:215]
ds_read_b128 v[172:175], v28 offset:30720
s_waitcnt lgkmcnt(2)
v_mfma_f32_16x16x32_bf16 v[220:223], a[88:91], v[100:103], v[220:223]
v_cmp_gt_u32 vcc, s52, v33
v_mfma_f32_16x16x32_bf16 v[208:211], a[40:43], v[144:147], v[208:211]
ds_read_b128 v[176:179], v28 offset:7168
v_cmp_gt_u32 s[58:59], s54, v33
v_mfma_f32_16x16x32_bf16 v[212:215], a[40:43], v[148:151], v[212:215]
ds_read_b128 v[180:183], v28 offset:15360
s_and_b32 vcc_lo, vcc_lo, s56
s_cselect_b32 s70, 0, 1
v_mfma_f32_16x16x32_bf16 v[216:219], a[92:95], v[104:107], v[216:219]
s_and_b32 s59, s59, s56
s_cselect_b32 s71, 0, s77
s_or_b32 s82, s70, s71
s_cselect_b32 s10, 268435456, 0
v_mfma_f32_16x16x32_bf16 v[208:211], a[44:47], v[152:155], v[208:211]
ds_read_b128 v[184:187], v28 offset:23552
s_cmp_lg_u32 s70, 0
s_cselect_b64 s[78:79], s[52:53], s[54:55]
s_cselect_b64 s[58:59], s[44:45], s[46:47]
v_mfma_f32_16x16x32_bf16 v[212:215], a[44:47], v[156:159], v[212:215]
ds_read_b128 v[188:191], v28 offset:31744
s_mul_i32 s80, s78, s20
v_mfma_f32_16x16x32_bf16 v[220:223], a[92:95], v[108:111], v[220:223]
s_add_u32 s80, s80, s58
s_waitcnt lgkmcnt(4)
v_mfma_f32_16x16x32_bf16 v[208:211], a[48:51], v[160:163], v[208:211]
s_add_u32 m0, s49, 0
s_mul_i32 s81, s78, s21
s_add_u32 s81, s81, s59
v_mfma_f32_16x16x32_bf16 v[212:215], a[48:51], v[164:167], v[212:215]
buffer_load_dwordx4 v8, s[8:11], s80 offen offset:0 sc1 lds
v_mfma_f32_16x16x32_bf16 v[216:219], a[96:99], v[112:115], v[216:219]
s_andn2_b32 s71, s71, s70
s_add_u32 s52, s52, s70
s_add_u32 s54, s54, s71
v_mfma_f32_16x16x32_bf16 v[208:211], a[52:55], v[168:171], v[208:211]
s_mov_b32 s83, s82
v_mfma_f32_16x16x32_bf16 v[212:215], a[52:55], v[172:175], v[212:215]
buffer_load_dwordx4 v9, s[8:11], s80 offen offset:1024 sc1 lds
v_mfma_f32_16x16x32_bf16 v[220:223], a[96:99], v[116:119], v[220:223]
s_waitcnt lgkmcnt(0)
v_mfma_f32_16x16x32_bf16 v[208:211], a[56:59], v[176:179], v[208:211]
v_mfma_f32_16x16x32_bf16 v[212:215], a[56:59], v[180:183], v[212:215]
buffer_load_dwordx4 v10, s[8:11], s80 offen offset:2048 sc1 lds
v_mfma_f32_16x16x32_bf16 v[216:219], a[100:103], v[120:123], v[216:219]
v_mfma_f32_16x16x32_bf16 v[208:211], a[60:63], v[184:187], v[208:211]
v_mfma_f32_16x16x32_bf16 v[212:215], a[60:63], v[188:191], v[212:215]
buffer_load_dwordx4 v11, s[8:11], s80 offen offset:3072 sc1 lds
v_mfma_f32_16x16x32_bf16 v[220:223], a[100:103], v[124:127], v[220:223]
v_mfma_f32_16x16x32_bf16 v[216:219], a[104:107], v[128:131], v[216:219]
s_add_u32 m0, s49, 4096
v_mfma_f32_16x16x32_bf16 v[220:223], a[104:107], v[132:135], v[220:223]
buffer_load_dwordx4 v12, s[8:11], s80 offen offset:0 sc1 lds
v_mfma_f32_16x16x32_bf16 v[216:219], a[108:111], v[136:139], v[216:219]
v_mfma_f32_16x16x32_bf16 v[220:223], a[108:111], v[140:143], v[220:223]
v_mfma_f32_16x16x32_bf16 v[216:219], a[112:115], v[144:147], v[216:219]
buffer_load_dwordx4 v13, s[8:11], s80 offen offset:1024 sc1 lds
v_mfma_f32_16x16x32_bf16 v[220:223], a[112:115], v[148:151], v[220:223]
v_cvt_pk_bf16_f32 v48, v208, v209
v_cvt_pk_bf16_f32 v49, v210, v211
v_mfma_f32_16x16x32_bf16 v[216:219], a[116:119], v[152:155], v[216:219]
v_cvt_pk_bf16_f32 v50, v212, v213
v_cvt_pk_bf16_f32 v51, v214, v215
v_mfma_f32_16x16x32_bf16 v[220:223], a[116:119], v[156:159], v[220:223]
buffer_load_dwordx4 v14, s[8:11], s80 offen offset:2048 sc1 lds
v_mfma_f32_16x16x32_bf16 v[216:219], a[120:123], v[160:163], v[216:219]
v_permlane16_swap_b32 v48, v50
v_mfma_f32_16x16x32_bf16 v[220:223], a[120:123], v[164:167], v[220:223]
v_permlane16_swap_b32 v49, v51
v_mfma_f32_16x16x32_bf16 v[216:219], a[124:127], v[168:171], v[216:219]
buffer_load_dwordx4 v15, s[8:11], s80 offen offset:3072 sc1 lds
v_mfma_f32_16x16x32_bf16 v[220:223], a[124:127], v[172:175], v[220:223]
buffer_store_dwordx4 v[48:51], v19, s[4:7], s75 offen sc1
v_mfma_f32_16x16x32_bf16 v[216:219], a[128:131], v[176:179], v[216:219]
v_mfma_f32_16x16x32_bf16 v[220:223], a[128:131], v[180:183], v[220:223]
v_mfma_f32_16x16x32_bf16 v[216:219], a[132:135], v[184:187], v[216:219]
v_mfma_f32_16x16x32_bf16 v[220:223], a[132:135], v[188:191], v[220:223]
v_mfma_f32_16x16x32_bf16 v[224:227], a[144:147], v[64:67], 0
v_mfma_f32_16x16x32_bf16 v[228:231], a[144:147], v[68:71], 0
v_mfma_f32_16x16x32_bf16 v[224:227], a[148:151], v[72:75], v[224:227]
v_mfma_f32_16x16x32_bf16 v[228:231], a[148:151], v[76:79], v[228:231]
buffer_load_dword v24, v22, s[4:7], 0 offen sc1
v_mfma_f32_16x16x32_bf16 v[224:227], a[152:155], v[80:83], v[224:227]
v_mfma_f32_16x16x32_bf16 v[228:231], a[152:155], v[84:87], v[228:231]
s_waitcnt vmcnt(10)
s_barrier
v_mfma_f32_16x16x32_bf16 v[224:227], a[156:159], v[88:91], v[224:227]
buffer_store_dword v27, v45, s[4:7], s91 offen
v_mfma_f32_16x16x32_bf16 v[228:231], a[156:159], v[92:95], v[228:231]
buffer_store_dword v27, v44, s[4:7], s91 offen sc1
v_mfma_f32_16x16x32_bf16 v[224:227], a[160:163], v[96:99], v[224:227]
v_cvt_pk_bf16_f32 v52, v216, v217
v_cvt_pk_bf16_f32 v53, v218, v219
v_mfma_f32_16x16x32_bf16 v[228:231], a[160:163], v[100:103], v[228:231]
v_cvt_pk_bf16_f32 v54, v220, v221
v_cvt_pk_bf16_f32 v55, v222, v223
v_mfma_f32_16x16x32_bf16 v[224:227], a[164:167], v[104:107], v[224:227]
v_permlane16_swap_b32 v52, v54
v_mfma_f32_16x16x32_bf16 v[228:231], a[164:167], v[108:111], v[228:231]
v_permlane16_swap_b32 v53, v55
v_mfma_f32_16x16x32_bf16 v[224:227], a[168:171], v[112:115], v[224:227]
buffer_store_dwordx4 v[52:55], v20, s[4:7], s75 offen sc1
v_mfma_f32_16x16x32_bf16 v[228:231], a[168:171], v[116:119], v[228:231]
v_mfma_f32_16x16x32_bf16 v[224:227], a[172:175], v[120:123], v[224:227]
v_mfma_f32_16x16x32_bf16 v[228:231], a[172:175], v[124:127], v[228:231]
v_mfma_f32_16x16x32_bf16 v[224:227], a[176:179], v[128:131], v[224:227]
v_mfma_f32_16x16x32_bf16 v[228:231], a[176:179], v[132:135], v[228:231]
v_mfma_f32_16x16x32_bf16 v[224:227], a[180:183], v[136:139], v[224:227]
v_mfma_f32_16x16x32_bf16 v[228:231], a[180:183], v[140:143], v[228:231]
v_mfma_f32_16x16x32_bf16 v[224:227], a[184:187], v[144:147], v[224:227]
s_waitcnt vmcnt(11)
s_barrier
v_mfma_f32_16x16x32_bf16 v[228:231], a[184:187], v[148:151], v[228:231]
v_mfma_f32_16x16x32_bf16 v[224:227], a[188:191], v[152:155], v[224:227]
s_cmp_eq_u32 s82, 0
s_cbranch_scc1 g_slow_129
v_mfma_f32_16x16x32_bf16 v[228:231], a[188:191], v[156:159], v[228:231]
ds_read_b128 v[64:67], v29 offset:0
v_mfma_f32_16x16x32_bf16 v[224:227], a[192:195], v[160:163], v[224:227]
ds_read_b128 v[68:71], v29 offset:8192
v_mfma_f32_16x16x32_bf16 v[228:231], a[192:195], v[164:167], v[228:231]
ds_read_b128 v[72:75], v29 offset:16384
v_mfma_f32_16x16x32_bf16 v[224:227], a[196:199], v[168:171], v[224:227]
ds_read_b128 v[76:79], v29 offset:24576
v_mfma_f32_16x16x32_bf16 v[228:231], a[196:199], v[172:175], v[228:231]
ds_read_b128 v[80:83], v29 offset:1024
v_mfma_f32_16x16x32_bf16 v[224:227], a[200:203], v[176:179], v[224:227]
ds_read_b128 v[84:87], v29 offset:9216
v_mfma_f32_16x16x32_bf16 v[228:231], a[200:203], v[180:183], v[228:231]
ds_read_b128 v[88:91], v29 offset:17408
v_mfma_f32_16x16x32_bf16 v[224:227], a[204:207], v[184:187], v[224:227]
ds_read_b128 v[92:95], v29 offset:25600
v_mfma_f32_16x16x32_bf16 v[228:231], a[204:207], v[188:191], v[228:231]
s_waitcnt vmcnt(7)
s_barrier
g_body_118:
s_waitcnt lgkmcnt(4)
v_mfma_f32_16x16x32_bf16 v[208:211], a[0:3], v[64:67], 0
ds_read_b128 v[96:99], v29 offset:2048
v_mfma_f32_16x16x32_bf16 v[212:215], a[0:3], v[68:71], 0
ds_read_b128 v[100:103], v29 offset:10240
v_mfma_f32_16x16x32_bf16 v[216:219], a[72:75], v[64:67], 0
v_mfma_f32_16x16x32_bf16 v[208:211], a[4:7], v[72:75], v[208:211]
ds_read_b128 v[104:107], v29 offset:18432
v_cvt_pk_bf16_f32 v56, v224, v225
v_mfma_f32_16x16x32_bf16 v[212:215], a[4:7], v[76:79], v[212:215]
ds_read_b128 v[108:111], v29 offset:26624
v_cvt_pk_bf16_f32 v57, v226, v227
v_mfma_f32_16x16x32_bf16 v[220:223], a[72:75], v[68:71], 0
v_cvt_pk_bf16_f32 v58, v228, v229
s_waitcnt lgkmcnt(4)
v_mfma_f32_16x16x32_bf16 v[208:211], a[8:11], v[80:83], v[208:211]
ds_read_b128 v[112:115], v29 offset:3072
v_cvt_pk_bf16_f32 v59, v230, v231
v_mfma_f32_16x16x32_bf16 v[212:215], a[8:11], v[84:87], v[212:215]
ds_read_b128 v[116:119], v29 offset:11264
v_permlane16_swap_b32 v56, v58
v_mfma_f32_16x16x32_bf16 v[216:219], a[76:79], v[72:75], v[216:219]
v_permlane16_swap_b32 v57, v59
v_mfma_f32_16x16x32_bf16 v[208:211], a[12:15], v[88:91], v[208:211]
ds_read_b128 v[120:123], v29 offset:19456
v_mfma_f32_16x16x32_bf16 v[212:215], a[12:15], v[92:95], v[212:215]
ds_read_b128 v[124:127], v29 offset:27648
v_mfma_f32_16x16x32_bf16 v[220:223], a[76:79], v[76:79], v[220:223]
s_waitcnt lgkmcnt(4)
v_mfma_f32_16x16x32_bf16 v[208:211], a[16:19], v[96:99], v[208:211]
ds_read_b128 v[128:131], v29 offset:4096
v_mfma_f32_16x16x32_bf16 v[212:215], a[16:19], v[100:103], v[212:215]
ds_read_b128 v[132:135], v29 offset:12288
v_mfma_f32_16x16x32_bf16 v[216:219], a[80:83], v[80:83], v[216:219]
buffer_store_dwordx4 v[56:59], v21, s[4:7], s75 offen sc1
v_mfma_f32_16x16x32_bf16 v[208:211], a[20:23], v[104:107], v[208:211]
ds_read_b128 v[136:139], v29 offset:20480
v_mov_b32 v27, s72
v_mfma_f32_16x16x32_bf16 v[212:215], a[20:23], v[108:111], v[212:215]
ds_read_b128 v[140:143], v29 offset:28672
v_mfma_f32_16x16x32_bf16 v[220:223], a[80:83], v[84:87], v[220:223]
s_waitcnt lgkmcnt(4)
v_mfma_f32_16x16x32_bf16 v[208:211], a[24:27], v[112:115], v[208:211]
ds_read_b128 v[144:147], v29 offset:5120
v_mfma_f32_16x16x32_bf16 v[212:215], a[24:27], v[116:119], v[212:215]
ds_read_b128 v[148:151], v29 offset:13312
v_mfma_f32_16x16x32_bf16 v[216:219], a[84:87], v[88:91], v[216:219]
v_mfma_f32_16x16x32_bf16 v[208:211], a[28:31], v[120:123], v[208:211]
ds_read_b128 v[152:155], v29 offset:21504
s_waitcnt vmcnt(4)
ds_write_b32 v18, v24
v_mfma_f32_16x16x32_bf16 v[212:215], a[28:31], v[124:127], v[212:215]
ds_read_b128 v[156:159], v29 offset:29696
v_mfma_f32_16x16x32_bf16 v[220:223], a[84:87], v[92:95], v[220:223]
s_waitcnt vmcnt(6)
s_barrier
s_waitcnt lgkmcnt(5)
v_mfma_f32_16x16x32_bf16 v[208:211], a[32:35], v[128:131], v[208:211]
ds_read_b128 v[160:163], v29 offset:6144
s_waitcnt lgkmcnt(2)
s_barrier
v_mfma_f32_16x16x32_bf16 v[212:215], a[32:35], v[132:135], v[212:215]
ds_read_b128 v[164:167], v29 offset:14336
ds_read_b32 v33, v32
v_mfma_f32_16x16x32_bf16 v[216:219], a[88:91], v[96:99], v[216:219]
v_mfma_f32_16x16x32_bf16 v[208:211], a[36:39], v[136:139], v[208:211]
ds_read_b128 v[168:171], v29 offset:22528
v_mfma_f32_16x16x32_bf16 v[212:215], a[36:39], v[140:143], v[212:215]
ds_read_b128 v[172:175], v29 offset:30720
s_waitcnt lgkmcnt(2)
v_mfma_f32_16x16x32_bf16 v[220:223], a[88:91], v[100:103], v[220:223]
v_cmp_gt_u32 vcc, s52, v33
v_mfma_f32_16x16x32_bf16 v[208:211], a[40:43], v[144:147], v[208:211]
ds_read_b128 v[176:179], v29 offset:7168
v_cmp_gt_u32 s[58:59], s54, v33
v_mfma_f32_16x16x32_bf16 v[212:215], a[40:43], v[148:151], v[212:215]
ds_read_b128 v[180:183], v29 offset:15360
s_and_b32 vcc_lo, vcc_lo, s56
s_cselect_b32 s70, 0, 1
v_mfma_f32_16x16x32_bf16 v[216:219], a[92:95], v[104:107], v[216:219]
s_and_b32 s59, s59, s56
s_cselect_b32 s71, 0, s83
s_or_b32 s88, s70, s71
s_cselect_b32 s10, 268435456, 0
v_mfma_f32_16x16x32_bf16 v[208:211], a[44:47], v[152:155], v[208:211]
ds_read_b128 v[184:187], v29 offset:23552
s_cmp_lg_u32 s70, 0
s_cselect_b64 s[84:85], s[52:53], s[54:55]
s_cselect_b64 s[58:59], s[44:45], s[46:47]
v_mfma_f32_16x16x32_bf16 v[212:215], a[44:47], v[156:159], v[212:215]
ds_read_b128 v[188:191], v29 offset:31744
s_mul_i32 s86, s84, s20
v_mfma_f32_16x16x32_bf16 v[220:223], a[92:95], v[108:111], v[220:223]
s_add_u32 s86, s86, s58
s_waitcnt lgkmcnt(4)
v_mfma_f32_16x16x32_bf16 v[208:211], a[48:51], v[160:163], v[208:211]
s_add_u32 m0, s50, 0
s_mul_i32 s87, s84, s21
s_add_u32 s87, s87, s59
v_mfma_f32_16x16x32_bf16 v[212:215], a[48:51], v[164:167], v[212:215]
buffer_load_dwordx4 v8, s[8:11], s86 offen offset:0 sc1 lds
v_mfma_f32_16x16x32_bf16 v[216:219], a[96:99], v[112:115], v[216:219]
s_andn2_b32 s71, s71, s70
s_add_u32 s52, s52, s70
s_add_u32 s54, s54, s71
v_mfma_f32_16x16x32_bf16 v[208:211], a[52:55], v[168:171], v[208:211]
s_mov_b32 s89, s88
v_mfma_f32_16x16x32_bf16 v[212:215], a[52:55], v[172:175], v[212:215]
buffer_load_dwordx4 v9, s[8:11], s86 offen offset:1024 sc1 lds
v_mfma_f32_16x16x32_bf16 v[220:223], a[96:99], v[116:119], v[220:223]
s_waitcnt lgkmcnt(0)
v_mfma_f32_16x16x32_bf16 v[208:211], a[56:59], v[176:179], v[208:211]
v_mfma_f32_16x16x32_bf16 v[212:215], a[56:59], v[180:183], v[212:215]
buffer_load_dwordx4 v10, s[8:11], s86 offen offset:2048 sc1 lds
v_mfma_f32_16x16x32_bf16 v[216:219], a[100:103], v[120:123], v[216:219]
v_mfma_f32_16x16x32_bf16 v[208:211], a[60:63], v[184:187], v[208:211]
v_mfma_f32_16x16x32_bf16 v[212:215], a[60:63], v[188:191], v[212:215]
buffer_load_dwordx4 v11, s[8:11], s86 offen offset:3072 sc1 lds
v_mfma_f32_16x16x32_bf16 v[220:223], a[100:103], v[124:127], v[220:223]
v_mfma_f32_16x16x32_bf16 v[216:219], a[104:107], v[128:131], v[216:219]
s_add_u32 m0, s50, 4096
v_mfma_f32_16x16x32_bf16 v[220:223], a[104:107], v[132:135], v[220:223]
buffer_load_dwordx4 v12, s[8:11], s86 offen offset:0 sc1 lds
v_mfma_f32_16x16x32_bf16 v[216:219], a[108:111], v[136:139], v[216:219]
v_mfma_f32_16x16x32_bf16 v[220:223], a[108:111], v[140:143], v[220:223]
v_mfma_f32_16x16x32_bf16 v[216:219], a[112:115], v[144:147], v[216:219]
buffer_load_dwordx4 v13, s[8:11], s86 offen offset:1024 sc1 lds
v_mfma_f32_16x16x32_bf16 v[220:223], a[112:115], v[148:151], v[220:223]
v_cvt_pk_bf16_f32 v48, v208, v209
v_cvt_pk_bf16_f32 v49, v210, v211
v_mfma_f32_16x16x32_bf16 v[216:219], a[116:119], v[152:155], v[216:219]
v_cvt_pk_bf16_f32 v50, v212, v213
v_cvt_pk_bf16_f32 v51, v214, v215
v_mfma_f32_16x16x32_bf16 v[220:223], a[116:119], v[156:159], v[220:223]
buffer_load_dwordx4 v14, s[8:11], s86 offen offset:2048 sc1 lds
v_mfma_f32_16x16x32_bf16 v[216:219], a[120:123], v[160:163], v[216:219]
v_permlane16_swap_b32 v48, v50
v_mfma_f32_16x16x32_bf16 v[220:223], a[120:123], v[164:167], v[220:223]
v_permlane16_swap_b32 v49, v51
v_mfma_f32_16x16x32_bf16 v[216:219], a[124:127], v[168:171], v[216:219]
buffer_load_dwordx4 v15, s[8:11], s86 offen offset:3072 sc1 lds
v_mfma_f32_16x16x32_bf16 v[220:223], a[124:127], v[172:175], v[220:223]
buffer_store_dwordx4 v[48:51], v19, s[4:7], s81 offen sc1
v_mfma_f32_16x16x32_bf16 v[216:219], a[128:131], v[176:179], v[216:219]
v_mfma_f32_16x16x32_bf16 v[220:223], a[128:131], v[180:183], v[220:223]
v_mfma_f32_16x16x32_bf16 v[216:219], a[132:135], v[184:187], v[216:219]
v_mfma_f32_16x16x32_bf16 v[220:223], a[132:135], v[188:191], v[220:223]
v_mfma_f32_16x16x32_bf16 v[224:227], a[144:147], v[64:67], 0
v_mfma_f32_16x16x32_bf16 v[228:231], a[144:147], v[68:71], 0
v_mfma_f32_16x16x32_bf16 v[224:227], a[148:151], v[72:75], v[224:227]
v_mfma_f32_16x16x32_bf16 v[228:231], a[148:151], v[76:79], v[228:231]
buffer_load_dword v24, v22, s[4:7], 0 offen sc1
v_mfma_f32_16x16x32_bf16 v[224:227], a[152:155], v[80:83], v[224:227]
v_mfma_f32_16x16x32_bf16 v[228:231], a[152:155], v[84:87], v[228:231]
s_waitcnt vmcnt(10)
s_barrier
v_mfma_f32_16x16x32_bf16 v[224:227], a[156:159], v[88:91], v[224:227]
buffer_store_dword v27, v45, s[4:7], s73 offen
v_mfma_f32_16x16x32_bf16 v[228:231], a[156:159], v[92:95], v[228:231]
buffer_store_dword v27, v44, s[4:7], s73 offen sc1
v_mfma_f32_16x16x32_bf16 v[224:227], a[160:163], v[96:99], v[224:227]
v_cvt_pk_bf16_f32 v52, v216, v217
v_cvt_pk_bf16_f32 v53, v218, v219
v_mfma_f32_16x16x32_bf16 v[228:231], a[160:163], v[100:103], v[228:231]
v_cvt_pk_bf16_f32 v54, v220, v221
v_cvt_pk_bf16_f32 v55, v222, v223
v_mfma_f32_16x16x32_bf16 v[224:227], a[164:167], v[104:107], v[224:227]
v_permlane16_swap_b32 v52, v54
v_mfma_f32_16x16x32_bf16 v[228:231], a[164:167], v[108:111], v[228:231]
v_permlane16_swap_b32 v53, v55
v_mfma_f32_16x16x32_bf16 v[224:227], a[168:171], v[112:115], v[224:227]
buffer_store_dwordx4 v[52:55], v20, s[4:7], s81 offen sc1
v_mfma_f32_16x16x32_bf16 v[228:231], a[168:171], v[116:119], v[228:231]
v_mfma_f32_16x16x32_bf16 v[224:227], a[172:175], v[120:123], v[224:227]
v_mfma_f32_16x16x32_bf16 v[228:231], a[172:175], v[124:127], v[228:231]
v_mfma_f32_16x16x32_bf16 v[224:227], a[176:179], v[128:131], v[224:227]
v_mfma_f32_16x16x32_bf16 v[228:231], a[176:179], v[132:135], v[228:231]
v_mfma_f32_16x16x32_bf16 v[224:227], a[180:183], v[136:139], v[224:227]
v_mfma_f32_16x16x32_bf16 v[228:231], a[180:183], v[140:143], v[228:231]
v_mfma_f32_16x16x32_bf16 v[224:227], a[184:187], v[144:147], v[224:227]
s_waitcnt vmcnt(11)
s_barrier
v_mfma_f32_16x16x32_bf16 v[228:231], a[184:187], v[148:151], v[228:231]
v_mfma_f32_16x16x32_bf16 v[224:227], a[188:191], v[152:155], v[224:227]
s_cmp_eq_u32 s88, 0
s_cbranch_scc1 g_slow_130
v_mfma_f32_16x16x32_bf16 v[228:231], a[188:191], v[156:159], v[228:231]
ds_read_b128 v[64:67], v30 offset:0
v_mfma_f32_16x16x32_bf16 v[224:227], a[192:195], v[160:163], v[224:227]
ds_read_b128 v[68:71], v30 offset:8192
v_mfma_f32_16x16x32_bf16 v[228:231], a[192:195], v[164:167], v[228:231]
ds_read_b128 v[72:75], v30 offset:16384
v_mfma_f32_16x16x32_bf16 v[224:227], a[196:199], v[168:171], v[224:227]
ds_read_b128 v[76:79], v30 offset:24576
v_mfma_f32_16x16x32_bf16 v[228:231], a[196:199], v[172:175], v[228:231]
ds_read_b128 v[80:83], v30 offset:1024
v_mfma_f32_16x16x32_bf16 v[224:227], a[200:203], v[176:179], v[224:227]
ds_read_b128 v[84:87], v30 offset:9216
v_mfma_f32_16x16x32_bf16 v[228:231], a[200:203], v[180:183], v[228:231]
ds_read_b128 v[88:91], v30 offset:17408
v_mfma_f32_16x16x32_bf16 v[224:227], a[204:207], v[184:187], v[224:227]
ds_read_b128 v[92:95], v30 offset:25600
v_mfma_f32_16x16x32_bf16 v[228:231], a[204:207], v[188:191], v[228:231]
s_waitcnt vmcnt(7)
s_barrier
g_body_119:
s_waitcnt lgkmcnt(4)
v_mfma_f32_16x16x32_bf16 v[208:211], a[0:3], v[64:67], 0
ds_read_b128 v[96:99], v30 offset:2048
v_mfma_f32_16x16x32_bf16 v[212:215], a[0:3], v[68:71], 0
ds_read_b128 v[100:103], v30 offset:10240
v_mfma_f32_16x16x32_bf16 v[216:219], a[72:75], v[64:67], 0
v_mfma_f32_16x16x32_bf16 v[208:211], a[4:7], v[72:75], v[208:211]
ds_read_b128 v[104:107], v30 offset:18432
v_cvt_pk_bf16_f32 v56, v224, v225
v_mfma_f32_16x16x32_bf16 v[212:215], a[4:7], v[76:79], v[212:215]
ds_read_b128 v[108:111], v30 offset:26624
v_cvt_pk_bf16_f32 v57, v226, v227
v_mfma_f32_16x16x32_bf16 v[220:223], a[72:75], v[68:71], 0
v_cvt_pk_bf16_f32 v58, v228, v229
s_waitcnt lgkmcnt(4)
v_mfma_f32_16x16x32_bf16 v[208:211], a[8:11], v[80:83], v[208:211]
ds_read_b128 v[112:115], v30 offset:3072
v_cvt_pk_bf16_f32 v59, v230, v231
v_mfma_f32_16x16x32_bf16 v[212:215], a[8:11], v[84:87], v[212:215]
ds_read_b128 v[116:119], v30 offset:11264
v_permlane16_swap_b32 v56, v58
v_mfma_f32_16x16x32_bf16 v[216:219], a[76:79], v[72:75], v[216:219]
v_permlane16_swap_b32 v57, v59
v_mfma_f32_16x16x32_bf16 v[208:211], a[12:15], v[88:91], v[208:211]
ds_read_b128 v[120:123], v30 offset:19456
v_mfma_f32_16x16x32_bf16 v[212:215], a[12:15], v[92:95], v[212:215]
ds_read_b128 v[124:127], v30 offset:27648
v_mfma_f32_16x16x32_bf16 v[220:223], a[76:79], v[76:79], v[220:223]
s_waitcnt lgkmcnt(4)
v_mfma_f32_16x16x32_bf16 v[208:211], a[16:19], v[96:99], v[208:211]
ds_read_b128 v[128:131], v30 offset:4096
v_mfma_f32_16x16x32_bf16 v[212:215], a[16:19], v[100:103], v[212:215]
ds_read_b128 v[132:135], v30 offset:12288
v_mfma_f32_16x16x32_bf16 v[216:219], a[80:83], v[80:83], v[216:219]
buffer_store_dwordx4 v[56:59], v21, s[4:7], s81 offen sc1
v_mfma_f32_16x16x32_bf16 v[208:211], a[20:23], v[104:107], v[208:211]
ds_read_b128 v[136:139], v30 offset:20480
v_mov_b32 v27, s78
v_mfma_f32_16x16x32_bf16 v[212:215], a[20:23], v[108:111], v[212:215]
ds_read_b128 v[140:143], v30 offset:28672
v_mfma_f32_16x16x32_bf16 v[220:223], a[80:83], v[84:87], v[220:223]
s_waitcnt lgkmcnt(4)
v_mfma_f32_16x16x32_bf16 v[208:211], a[24:27], v[112:115], v[208:211]
ds_read_b128 v[144:147], v30 offset:5120
v_mfma_f32_16x16x32_bf16 v[212:215], a[24:27], v[116:119], v[212:215]
ds_read_b128 v[148:151], v30 offset:13312
v_mfma_f32_16x16x32_bf16 v[216:219], a[84:87], v[88:91], v[216:219]
v_mfma_f32_16x16x32_bf16 v[208:211], a[28:31], v[120:123], v[208:211]
ds_read_b128 v[152:155], v30 offset:21504
s_waitcnt vmcnt(4)
ds_write_b32 v18, v24
v_mfma_f32_16x16x32_bf16 v[212:215], a[28:31], v[124:127], v[212:215]
ds_read_b128 v[156:159], v30 offset:29696
v_mfma_f32_16x16x32_bf16 v[220:223], a[84:87], v[92:95], v[220:223]
s_waitcnt vmcnt(6)
s_barrier
s_waitcnt lgkmcnt(5)
v_mfma_f32_16x16x32_bf16 v[208:211], a[32:35], v[128:131], v[208:211]
ds_read_b128 v[160:163], v30 offset:6144
s_waitcnt lgkmcnt(2)
s_barrier
v_mfma_f32_16x16x32_bf16 v[212:215], a[32:35], v[132:135], v[212:215]
ds_read_b128 v[164:167], v30 offset:14336
ds_read_b32 v33, v32
v_mfma_f32_16x16x32_bf16 v[216:219], a[88:91], v[96:99], v[216:219]
v_mfma_f32_16x16x32_bf16 v[208:211], a[36:39], v[136:139], v[208:211]
ds_read_b128 v[168:171], v30 offset:22528
v_mfma_f32_16x16x32_bf16 v[212:215], a[36:39], v[140:143], v[212:215]
ds_read_b128 v[172:175], v30 offset:30720
s_waitcnt lgkmcnt(2)
v_mfma_f32_16x16x32_bf16 v[220:223], a[88:91], v[100:103], v[220:223]
v_cmp_gt_u32 vcc, s52, v33
v_mfma_f32_16x16x32_bf16 v[208:211], a[40:43], v[144:147], v[208:211]
ds_read_b128 v[176:179], v30 offset:7168
v_cmp_gt_u32 s[58:59], s54, v33
v_mfma_f32_16x16x32_bf16 v[212:215], a[40:43], v[148:151], v[212:215]
ds_read_b128 v[180:183], v30 offset:15360
s_and_b32 vcc_lo, vcc_lo, s56
s_cselect_b32 s70, 0, 1
v_mfma_f32_16x16x32_bf16 v[216:219], a[92:95], v[104:107], v[216:219]
s_and_b32 s59, s59, s56
s_cselect_b32 s71, 0, s89
s_or_b32 s94, s70, s71
s_cselect_b32 s10, 268435456, 0
v_mfma_f32_16x16x32_bf16 v[208:211], a[44:47], v[152:155], v[208:211]
ds_read_b128 v[184:187], v30 offset:23552
s_cmp_lg_u32 s70, 0
s_cselect_b64 s[90:91], s[52:53], s[54:55]
s_cselect_b64 s[58:59], s[44:45], s[46:47]
v_mfma_f32_16x16x32_bf16 v[212:215], a[44:47], v[156:159], v[212:215]
ds_read_b128 v[188:191], v30 offset:31744
s_mul_i32 s92, s90, s20
v_mfma_f32_16x16x32_bf16 v[220:223], a[92:95], v[108:111], v[220:223]
s_add_u32 s92, s92, s58
s_waitcnt lgkmcnt(4)
v_mfma_f32_16x16x32_bf16 v[208:211], a[48:51], v[160:163], v[208:211]
s_add_u32 m0, s51, 0
s_mul_i32 s93, s90, s21
s_add_u32 s93, s93, s59
v_mfma_f32_16x16x32_bf16 v[212:215], a[48:51], v[164:167], v[212:215]
buffer_load_dwordx4 v8, s[8:11], s92 offen offset:0 sc1 lds
v_mfma_f32_16x16x32_bf16 v[216:219], a[96:99], v[112:115], v[216:219]
s_andn2_b32 s71, s71, s70
s_add_u32 s52, s52, s70
s_add_u32 s54, s54, s71
v_mfma_f32_16x16x32_bf16 v[208:211], a[52:55], v[168:171], v[208:211]
s_mov_b32 s95, s94
v_mfma_f32_16x16x32_bf16 v[212:215], a[52:55], v[172:175], v[212:215]
buffer_load_dwordx4 v9, s[8:11], s92 offen offset:1024 sc1 lds
v_mfma_f32_16x16x32_bf16 v[220:223], a[96:99], v[116:119], v[220:223]
s_waitcnt lgkmcnt(0)
v_mfma_f32_16x16x32_bf16 v[208:211], a[56:59], v[176:179], v[208:211]
v_mfma_f32_16x16x32_bf16 v[212:215], a[56:59], v[180:183], v[212:215]
buffer_load_dwordx4 v10, s[8:11], s92 offen offset:2048 sc1 lds
v_mfma_f32_16x16x32_bf16 v[216:219], a[100:103], v[120:123], v[216:219]
v_mfma_f32_16x16x32_bf16 v[208:211], a[60:63], v[184:187], v[208:211]
v_mfma_f32_16x16x32_bf16 v[212:215], a[60:63], v[188:191], v[212:215]
buffer_load_dwordx4 v11, s[8:11], s92 offen offset:3072 sc1 lds
v_mfma_f32_16x16x32_bf16 v[220:223], a[100:103], v[124:127], v[220:223]
v_mfma_f32_16x16x32_bf16 v[216:219], a[104:107], v[128:131], v[216:219]
s_add_u32 m0, s51, 4096
v_mfma_f32_16x16x32_bf16 v[220:223], a[104:107], v[132:135], v[220:223]
buffer_load_dwordx4 v12, s[8:11], s92 offen offset:0 sc1 lds
v_mfma_f32_16x16x32_bf16 v[216:219], a[108:111], v[136:139], v[216:219]
v_mfma_f32_16x16x32_bf16 v[220:223], a[108:111], v[140:143], v[220:223]
v_mfma_f32_16x16x32_bf16 v[216:219], a[112:115], v[144:147], v[216:219]
buffer_load_dwordx4 v13, s[8:11], s92 offen offset:1024 sc1 lds
v_mfma_f32_16x16x32_bf16 v[220:223], a[112:115], v[148:151], v[220:223]
v_cvt_pk_bf16_f32 v48, v208, v209
v_cvt_pk_bf16_f32 v49, v210, v211
v_mfma_f32_16x16x32_bf16 v[216:219], a[116:119], v[152:155], v[216:219]
v_cvt_pk_bf16_f32 v50, v212, v213
v_cvt_pk_bf16_f32 v51, v214, v215
v_mfma_f32_16x16x32_bf16 v[220:223], a[116:119], v[156:159], v[220:223]
buffer_load_dwordx4 v14, s[8:11], s92 offen offset:2048 sc1 lds
v_mfma_f32_16x16x32_bf16 v[216:219], a[120:123], v[160:163], v[216:219]
v_permlane16_swap_b32 v48, v50
v_mfma_f32_16x16x32_bf16 v[220:223], a[120:123], v[164:167], v[220:223]
v_permlane16_swap_b32 v49, v51
v_mfma_f32_16x16x32_bf16 v[216:219], a[124:127], v[168:171], v[216:219]
buffer_load_dwordx4 v15, s[8:11], s92 offen offset:3072 sc1 lds
v_mfma_f32_16x16x32_bf16 v[220:223], a[124:127], v[172:175], v[220:223]
buffer_store_dwordx4 v[48:51], v19, s[4:7], s87 offen sc1
v_mfma_f32_16x16x32_bf16 v[216:219], a[128:131], v[176:179], v[216:219]
v_mfma_f32_16x16x32_bf16 v[220:223], a[128:131], v[180:183], v[220:223]
v_mfma_f32_16x16x32_bf16 v[216:219], a[132:135], v[184:187], v[216:219]
v_mfma_f32_16x16x32_bf16 v[220:223], a[132:135], v[188:191], v[220:223]
v_mfma_f32_16x16x32_bf16 v[224:227], a[144:147], v[64:67], 0
v_mfma_f32_16x16x32_bf16 v[228:231], a[144:147], v[68:71], 0
v_mfma_f32_16x16x32_bf16 v[224:227], a[148:151], v[72:75], v[224:227]
v_mfma_f32_16x16x32_bf16 v[228:231], a[148:151], v[76:79], v[228:231]
buffer_load_dword v24, v22, s[4:7], 0 offen sc1
v_mfma_f32_16x16x32_bf16 v[224:227], a[152:155], v[80:83], v[224:227]
v_mfma_f32_16x16x32_bf16 v[228:231], a[152:155], v[84:87], v[228:231]
s_waitcnt vmcnt(10)
s_barrier
v_mfma_f32_16x16x32_bf16 v[224:227], a[156:159], v[88:91], v[224:227]
buffer_store_dword v27, v45, s[4:7], s79 offen
v_mfma_f32_16x16x32_bf16 v[228:231], a[156:159], v[92:95], v[228:231]
buffer_store_dword v27, v44, s[4:7], s79 offen sc1
v_mfma_f32_16x16x32_bf16 v[224:227], a[160:163], v[96:99], v[224:227]
v_cvt_pk_bf16_f32 v52, v216, v217
v_cvt_pk_bf16_f32 v53, v218, v219
v_mfma_f32_16x16x32_bf16 v[228:231], a[160:163], v[100:103], v[228:231]
v_cvt_pk_bf16_f32 v54, v220, v221
v_cvt_pk_bf16_f32 v55, v222, v223
v_mfma_f32_16x16x32_bf16 v[224:227], a[164:167], v[104:107], v[224:227]
v_permlane16_swap_b32 v52, v54
v_mfma_f32_16x16x32_bf16 v[228:231], a[164:167], v[108:111], v[228:231]
v_permlane16_swap_b32 v53, v55
v_mfma_f32_16x16x32_bf16 v[224:227], a[168:171], v[112:115], v[224:227]
buffer_store_dwordx4 v[52:55], v20, s[4:7], s87 offen sc1
v_mfma_f32_16x16x32_bf16 v[228:231], a[168:171], v[116:119], v[228:231]
v_mfma_f32_16x16x32_bf16 v[224:227], a[172:175], v[120:123], v[224:227]
v_mfma_f32_16x16x32_bf16 v[228:231], a[172:175], v[124:127], v[228:231]
v_mfma_f32_16x16x32_bf16 v[224:227], a[176:179], v[128:131], v[224:227]
v_mfma_f32_16x16x32_bf16 v[228:231], a[176:179], v[132:135], v[228:231]
v_mfma_f32_16x16x32_bf16 v[224:227], a[180:183], v[136:139], v[224:227]
v_mfma_f32_16x16x32_bf16 v[228:231], a[180:183], v[140:143], v[228:231]
v_mfma_f32_16x16x32_bf16 v[224:227], a[184:187], v[144:147], v[224:227]
s_waitcnt vmcnt(11)
s_barrier
v_mfma_f32_16x16x32_bf16 v[228:231], a[184:187], v[148:151], v[228:231]
v_mfma_f32_16x16x32_bf16 v[224:227], a[188:191], v[152:155], v[224:227]
s_cmp_eq_u32 s94, 0
s_cbranch_scc1 g_slow_131
v_mfma_f32_16x16x32_bf16 v[228:231], a[188:191], v[156:159], v[228:231]
ds_read_b128 v[64:67], v31 offset:0
v_mfma_f32_16x16x32_bf16 v[224:227], a[192:195], v[160:163], v[224:227]
ds_read_b128 v[68:71], v31 offset:8192
v_mfma_f32_16x16x32_bf16 v[228:231], a[192:195], v[164:167], v[228:231]
ds_read_b128 v[72:75], v31 offset:16384
v_mfma_f32_16x16x32_bf16 v[224:227], a[196:199], v[168:171], v[224:227]
ds_read_b128 v[76:79], v31 offset:24576
v_mfma_f32_16x16x32_bf16 v[228:231], a[196:199], v[172:175], v[228:231]
ds_read_b128 v[80:83], v31 offset:1024
v_mfma_f32_16x16x32_bf16 v[224:227], a[200:203], v[176:179], v[224:227]
ds_read_b128 v[84:87], v31 offset:9216
v_mfma_f32_16x16x32_bf16 v[228:231], a[200:203], v[180:183], v[228:231]
ds_read_b128 v[88:91], v31 offset:17408
v_mfma_f32_16x16x32_bf16 v[224:227], a[204:207], v[184:187], v[224:227]
ds_read_b128 v[92:95], v31 offset:25600
v_mfma_f32_16x16x32_bf16 v[228:231], a[204:207], v[188:191], v[228:231]
s_waitcnt vmcnt(7)
s_barrier
g_body_120:
s_waitcnt lgkmcnt(4)
v_mfma_f32_16x16x32_bf16 v[208:211], a[0:3], v[64:67], 0
ds_read_b128 v[96:99], v31 offset:2048
v_mfma_f32_16x16x32_bf16 v[212:215], a[0:3], v[68:71], 0
ds_read_b128 v[100:103], v31 offset:10240
v_mfma_f32_16x16x32_bf16 v[216:219], a[72:75], v[64:67], 0
v_mfma_f32_16x16x32_bf16 v[208:211], a[4:7], v[72:75], v[208:211]
ds_read_b128 v[104:107], v31 offset:18432
v_cvt_pk_bf16_f32 v56, v224, v225
v_mfma_f32_16x16x32_bf16 v[212:215], a[4:7], v[76:79], v[212:215]
ds_read_b128 v[108:111], v31 offset:26624
v_cvt_pk_bf16_f32 v57, v226, v227
v_mfma_f32_16x16x32_bf16 v[220:223], a[72:75], v[68:71], 0
v_cvt_pk_bf16_f32 v58, v228, v229
s_waitcnt lgkmcnt(4)
v_mfma_f32_16x16x32_bf16 v[208:211], a[8:11], v[80:83], v[208:211]
ds_read_b128 v[112:115], v31 offset:3072
v_cvt_pk_bf16_f32 v59, v230, v231
v_mfma_f32_16x16x32_bf16 v[212:215], a[8:11], v[84:87], v[212:215]
ds_read_b128 v[116:119], v31 offset:11264
v_permlane16_swap_b32 v56, v58
v_mfma_f32_16x16x32_bf16 v[216:219], a[76:79], v[72:75], v[216:219]
v_permlane16_swap_b32 v57, v59
v_mfma_f32_16x16x32_bf16 v[208:211], a[12:15], v[88:91], v[208:211]
ds_read_b128 v[120:123], v31 offset:19456
v_mfma_f32_16x16x32_bf16 v[212:215], a[12:15], v[92:95], v[212:215]
ds_read_b128 v[124:127], v31 offset:27648
v_mfma_f32_16x16x32_bf16 v[220:223], a[76:79], v[76:79], v[220:223]
s_waitcnt lgkmcnt(4)
v_mfma_f32_16x16x32_bf16 v[208:211], a[16:19], v[96:99], v[208:211]
ds_read_b128 v[128:131], v31 offset:4096
v_mfma_f32_16x16x32_bf16 v[212:215], a[16:19], v[100:103], v[212:215]
ds_read_b128 v[132:135], v31 offset:12288
v_mfma_f32_16x16x32_bf16 v[216:219], a[80:83], v[80:83], v[216:219]
buffer_store_dwordx4 v[56:59], v21, s[4:7], s87 offen sc1
v_mfma_f32_16x16x32_bf16 v[208:211], a[20:23], v[104:107], v[208:211]
ds_read_b128 v[136:139], v31 offset:20480
v_mov_b32 v27, s84
v_mfma_f32_16x16x32_bf16 v[212:215], a[20:23], v[108:111], v[212:215]
ds_read_b128 v[140:143], v31 offset:28672
v_mfma_f32_16x16x32_bf16 v[220:223], a[80:83], v[84:87], v[220:223]
s_waitcnt lgkmcnt(4)
v_mfma_f32_16x16x32_bf16 v[208:211], a[24:27], v[112:115], v[208:211]
ds_read_b128 v[144:147], v31 offset:5120
v_mfma_f32_16x16x32_bf16 v[212:215], a[24:27], v[116:119], v[212:215]
ds_read_b128 v[148:151], v31 offset:13312
v_mfma_f32_16x16x32_bf16 v[216:219], a[84:87], v[88:91], v[216:219]
v_mfma_f32_16x16x32_bf16 v[208:211], a[28:31], v[120:123], v[208:211]
ds_read_b128 v[152:155], v31 offset:21504
s_waitcnt vmcnt(4)
ds_write_b32 v18, v24
v_mfma_f32_16x16x32_bf16 v[212:215], a[28:31], v[124:127], v[212:215]
ds_read_b128 v[156:159], v31 offset:29696
v_mfma_f32_16x16x32_bf16 v[220:223], a[84:87], v[92:95], v[220:223]
s_waitcnt vmcnt(6)
s_barrier
s_waitcnt lgkmcnt(5)
v_mfma_f32_16x16x32_bf16 v[208:211], a[32:35], v[128:131], v[208:211]
ds_read_b128 v[160:163], v31 offset:6144
s_waitcnt lgkmcnt(2)
s_barrier
v_mfma_f32_16x16x32_bf16 v[212:215], a[32:35], v[132:135], v[212:215]
ds_read_b128 v[164:167], v31 offset:14336
ds_read_b32 v33, v32
v_mfma_f32_16x16x32_bf16 v[216:219], a[88:91], v[96:99], v[216:219]
v_mfma_f32_16x16x32_bf16 v[208:211], a[36:39], v[136:139], v[208:211]
ds_read_b128 v[168:171], v31 offset:22528
v_mfma_f32_16x16x32_bf16 v[212:215], a[36:39], v[140:143], v[212:215]
ds_read_b128 v[172:175], v31 offset:30720
s_waitcnt lgkmcnt(2)
v_mfma_f32_16x16x32_bf16 v[220:223], a[88:91], v[100:103], v[220:223]
v_cmp_gt_u32 vcc, s52, v33
v_mfma_f32_16x16x32_bf16 v[208:211], a[40:43], v[144:147], v[208:211]
ds_read_b128 v[176:179], v31 offset:7168
v_cmp_gt_u32 s[58:59], s54, v33
v_mfma_f32_16x16x32_bf16 v[212:215], a[40:43], v[148:151], v[212:215]
ds_read_b128 v[180:183], v31 offset:15360
s_and_b32 vcc_lo, vcc_lo, s56
s_cselect_b32 s70, 0, 1
v_mfma_f32_16x16x32_bf16 v[216:219], a[92:95], v[104:107], v[216:219]
s_and_b32 s59, s59, s56
s_cselect_b32 s71, 0, s95
s_or_b32 s76, s70, s71
s_cselect_b32 s10, 268435456, 0
v_mfma_f32_16x16x32_bf16 v[208:211], a[44:47], v[152:155], v[208:211]
ds_read_b128 v[184:187], v31 offset:23552
s_cmp_lg_u32 s70, 0
s_cselect_b64 s[72:73], s[52:53], s[54:55]
s_cselect_b64 s[58:59], s[44:45], s[46:47]
v_mfma_f32_16x16x32_bf16 v[212:215], a[44:47], v[156:159], v[212:215]
ds_read_b128 v[188:191], v31 offset:31744
s_mul_i32 s74, s72, s20
v_mfma_f32_16x16x32_bf16 v[220:223], a[92:95], v[108:111], v[220:223]
s_add_u32 s74, s74, s58
s_waitcnt lgkmcnt(4)
v_mfma_f32_16x16x32_bf16 v[208:211], a[48:51], v[160:163], v[208:211]
s_add_u32 m0, s48, 0
s_mul_i32 s75, s72, s21
s_add_u32 s75, s75, s59
v_mfma_f32_16x16x32_bf16 v[212:215], a[48:51], v[164:167], v[212:215]
buffer_load_dwordx4 v8, s[8:11], s74 offen offset:0 sc1 lds
v_mfma_f32_16x16x32_bf16 v[216:219], a[96:99], v[112:115], v[216:219]
s_andn2_b32 s71, s71, s70
s_add_u32 s52, s52, s70
s_add_u32 s54, s54, s71
v_mfma_f32_16x16x32_bf16 v[208:211], a[52:55], v[168:171], v[208:211]
s_mov_b32 s77, s76
v_mfma_f32_16x16x32_bf16 v[212:215], a[52:55], v[172:175], v[212:215]
buffer_load_dwordx4 v9, s[8:11], s74 offen offset:1024 sc1 lds
v_mfma_f32_16x16x32_bf16 v[220:223], a[96:99], v[116:119], v[220:223]
s_waitcnt lgkmcnt(0)
v_mfma_f32_16x16x32_bf16 v[208:211], a[56:59], v[176:179], v[208:211]
v_mfma_f32_16x16x32_bf16 v[212:215], a[56:59], v[180:183], v[212:215]
buffer_load_dwordx4 v10, s[8:11], s74 offen offset:2048 sc1 lds
v_mfma_f32_16x16x32_bf16 v[216:219], a[100:103], v[120:123], v[216:219]
v_mfma_f32_16x16x32_bf16 v[208:211], a[60:63], v[184:187], v[208:211]
v_mfma_f32_16x16x32_bf16 v[212:215], a[60:63], v[188:191], v[212:215]
buffer_load_dwordx4 v11, s[8:11], s74 offen offset:3072 sc1 lds
v_mfma_f32_16x16x32_bf16 v[220:223], a[100:103], v[124:127], v[220:223]
v_mfma_f32_16x16x32_bf16 v[216:219], a[104:107], v[128:131], v[216:219]
s_add_u32 m0, s48, 4096
v_mfma_f32_16x16x32_bf16 v[220:223], a[104:107], v[132:135], v[220:223]
buffer_load_dwordx4 v12, s[8:11], s74 offen offset:0 sc1 lds
v_mfma_f32_16x16x32_bf16 v[216:219], a[108:111], v[136:139], v[216:219]
v_mfma_f32_16x16x32_bf16 v[220:223], a[108:111], v[140:143], v[220:223]
v_mfma_f32_16x16x32_bf16 v[216:219], a[112:115], v[144:147], v[216:219]
buffer_load_dwordx4 v13, s[8:11], s74 offen offset:1024 sc1 lds
v_mfma_f32_16x16x32_bf16 v[220:223], a[112:115], v[148:151], v[220:223]
v_cvt_pk_bf16_f32 v48, v208, v209
v_cvt_pk_bf16_f32 v49, v210, v211
v_mfma_f32_16x16x32_bf16 v[216:219], a[116:119], v[152:155], v[216:219]
v_cvt_pk_bf16_f32 v50, v212, v213
v_cvt_pk_bf16_f32 v51, v214, v215
v_mfma_f32_16x16x32_bf16 v[220:223], a[116:119], v[156:159], v[220:223]
buffer_load_dwordx4 v14, s[8:11], s74 offen offset:2048 sc1 lds
v_mfma_f32_16x16x32_bf16 v[216:219], a[120:123], v[160:163], v[216:219]
v_permlane16_swap_b32 v48, v50
v_mfma_f32_16x16x32_bf16 v[220:223], a[120:123], v[164:167], v[220:223]
v_permlane16_swap_b32 v49, v51
v_mfma_f32_16x16x32_bf16 v[216:219], a[124:127], v[168:171], v[216:219]
buffer_load_dwordx4 v15, s[8:11], s74 offen offset:3072 sc1 lds
v_mfma_f32_16x16x32_bf16 v[220:223], a[124:127], v[172:175], v[220:223]
buffer_store_dwordx4 v[48:51], v19, s[4:7], s93 offen sc1
v_mfma_f32_16x16x32_bf16 v[216:219], a[128:131], v[176:179], v[216:219]
v_mfma_f32_16x16x32_bf16 v[220:223], a[128:131], v[180:183], v[220:223]
v_mfma_f32_16x16x32_bf16 v[216:219], a[132:135], v[184:187], v[216:219]
v_mfma_f32_16x16x32_bf16 v[220:223], a[132:135], v[188:191], v[220:223]
v_mfma_f32_16x16x32_bf16 v[224:227], a[144:147], v[64:67], 0
v_mfma_f32_16x16x32_bf16 v[228:231], a[144:147], v[68:71], 0
v_mfma_f32_16x16x32_bf16 v[224:227], a[148:151], v[72:75], v[224:227]
v_mfma_f32_16x16x32_bf16 v[228:231], a[148:151], v[76:79], v[228:231]
buffer_load_dword v24, v22, s[4:7], 0 offen sc1
v_mfma_f32_16x16x32_bf16 v[224:227], a[152:155], v[80:83], v[224:227]
v_mfma_f32_16x16x32_bf16 v[228:231], a[152:155], v[84:87], v[228:231]
s_waitcnt vmcnt(10)
s_barrier
v_mfma_f32_16x16x32_bf16 v[224:227], a[156:159], v[88:91], v[224:227]
buffer_store_dword v27, v45, s[4:7], s85 offen
v_mfma_f32_16x16x32_bf16 v[228:231], a[156:159], v[92:95], v[228:231]
buffer_store_dword v27, v44, s[4:7], s85 offen sc1
v_mfma_f32_16x16x32_bf16 v[224:227], a[160:163], v[96:99], v[224:227]
v_cvt_pk_bf16_f32 v52, v216, v217
v_cvt_pk_bf16_f32 v53, v218, v219
v_mfma_f32_16x16x32_bf16 v[228:231], a[160:163], v[100:103], v[228:231]
v_cvt_pk_bf16_f32 v54, v220, v221
v_cvt_pk_bf16_f32 v55, v222, v223
v_mfma_f32_16x16x32_bf16 v[224:227], a[164:167], v[104:107], v[224:227]
v_permlane16_swap_b32 v52, v54
v_mfma_f32_16x16x32_bf16 v[228:231], a[164:167], v[108:111], v[228:231]
v_permlane16_swap_b32 v53, v55
v_mfma_f32_16x16x32_bf16 v[224:227], a[168:171], v[112:115], v[224:227]
buffer_store_dwordx4 v[52:55], v20, s[4:7], s93 offen sc1
v_mfma_f32_16x16x32_bf16 v[228:231], a[168:171], v[116:119], v[228:231]
v_mfma_f32_16x16x32_bf16 v[224:227], a[172:175], v[120:123], v[224:227]
v_mfma_f32_16x16x32_bf16 v[228:231], a[172:175], v[124:127], v[228:231]
v_mfma_f32_16x16x32_bf16 v[224:227], a[176:179], v[128:131], v[224:227]
v_mfma_f32_16x16x32_bf16 v[228:231], a[176:179], v[132:135], v[228:231]
v_mfma_f32_16x16x32_bf16 v[224:227], a[180:183], v[136:139], v[224:227]
v_mfma_f32_16x16x32_bf16 v[228:231], a[180:183], v[140:143], v[228:231]
v_mfma_f32_16x16x32_bf16 v[224:227], a[184:187], v[144:147], v[224:227]
s_waitcnt vmcnt(11)
s_barrier
v_mfma_f32_16x16x32_bf16 v[228:231], a[184:187], v[148:151], v[228:231]
v_mfma_f32_16x16x32_bf16 v[224:227], a[188:191], v[152:155], v[224:227]
s_cmp_eq_u32 s76, 0
s_cbranch_scc1 g_slow_132
v_mfma_f32_16x16x32_bf16 v[228:231], a[188:191], v[156:159], v[228:231]
ds_read_b128 v[64:67], v28 offset:0
v_mfma_f32_16x16x32_bf16 v[224:227], a[192:195], v[160:163], v[224:227]
ds_read_b128 v[68:71], v28 offset:8192
v_mfma_f32_16x16x32_bf16 v[228:231], a[192:195], v[164:167], v[228:231]
ds_read_b128 v[72:75], v28 offset:16384
v_mfma_f32_16x16x32_bf16 v[224:227], a[196:199], v[168:171], v[224:227]
ds_read_b128 v[76:79], v28 offset:24576
v_mfma_f32_16x16x32_bf16 v[228:231], a[196:199], v[172:175], v[228:231]
ds_read_b128 v[80:83], v28 offset:1024
v_mfma_f32_16x16x32_bf16 v[224:227], a[200:203], v[176:179], v[224:227]
ds_read_b128 v[84:87], v28 offset:9216
v_mfma_f32_16x16x32_bf16 v[228:231], a[200:203], v[180:183], v[228:231]
ds_read_b128 v[88:91], v28 offset:17408
v_mfma_f32_16x16x32_bf16 v[224:227], a[204:207], v[184:187], v[224:227]
ds_read_b128 v[92:95], v28 offset:25600
v_mfma_f32_16x16x32_bf16 v[228:231], a[204:207], v[188:191], v[228:231]
s_waitcnt vmcnt(7)
s_barrier
s_branch g_body_117
g_slow_129:
v_mfma_f32_16x16x32_bf16 v[228:231], a[188:191], v[156:159], v[228:231]
v_mfma_f32_16x16x32_bf16 v[224:227], a[192:195], v[160:163], v[224:227]
v_mfma_f32_16x16x32_bf16 v[228:231], a[192:195], v[164:167], v[228:231]
v_mfma_f32_16x16x32_bf16 v[224:227], a[196:199], v[168:171], v[224:227]
v_mfma_f32_16x16x32_bf16 v[228:231], a[196:199], v[172:175], v[228:231]
v_mfma_f32_16x16x32_bf16 v[224:227], a[200:203], v[176:179], v[224:227]
v_mfma_f32_16x16x32_bf16 v[228:231], a[200:203], v[180:183], v[228:231]
v_mfma_f32_16x16x32_bf16 v[224:227], a[204:207], v[184:187], v[224:227]
v_mfma_f32_16x16x32_bf16 v[228:231], a[204:207], v[188:191], v[228:231]
s_nop 6
v_cvt_pk_bf16_f32 v56, v224, v225
v_cvt_pk_bf16_f32 v57, v226, v227
v_cvt_pk_bf16_f32 v58, v228, v229
v_cvt_pk_bf16_f32 v59, v230, v231
s_nop 0
v_permlane16_swap_b32 v56, v58
v_permlane16_swap_b32 v57, v59
buffer_store_dwordx4 v[56:59], v21, s[4:7], s75 offen sc1
s_mov_b32 s75, 1879048192
s_waitcnt vmcnt(4)
ds_write_b32 v18, v24
s_waitcnt lgkmcnt(0)
s_barrier
ds_read_b32 v33, v32
s_waitcnt lgkmcnt(0)
v_cmp_gt_u32 vcc, s52, v33
v_cmp_gt_u32 s[58:59], s54, v33
s_and_b32 vcc_lo, vcc_lo, s56
s_cselect_b32 s70, 0, 1
s_and_b32 s59, s59, s56
s_cselect_b32 s71, 0, s77
s_or_b32 s82, s70, s71
s_cselect_b32 s10, 268435456, 0
s_cmp_lg_u32 s70, 0
s_cselect_b64 s[78:79], s[52:53], s[54:55]
s_cselect_b64 s[58:59], s[44:45], s[46:47]
s_mul_i32 s80, s78, s20
s_add_u32 s80, s80, s58
s_mul_i32 s81, s78, s21
s_add_u32 s81, s81, s59
s_andn2_b32 s71, s71, s70
s_add_u32 s52, s52, s70
s_add_u32 s54, s54, s71
s_mov_b32 s83, s82
s_cmp_lg_u32 s82, 0
s_cbranch_scc1 g_go_133
v_mov_b32 v27, s72
s_waitcnt vmcnt(0)
s_barrier
s_add_u32 s70, s52, s54
s_cmp_eq_u32 s70, 130
s_cbranch_scc1 g_fin_121
s_cmp_lg_u32 s3, 0
s_cbranch_scc1 sp_ok_135_j
s_mov_b32 s23, 0
buffer_load_dword v33, v22, s[4:7], 0 offen sc1
buffer_store_dword v27, v45, s[4:7], s73 offen
buffer_store_dword v27, v44, s[4:7], s73 offen sc1
s_waitcnt vmcnt(2)
s_branch sp_loop_134_e
sp_loop_134:
buffer_load_dword v33, v22, s[4:7], 0 offen sc1
s_add_u32 s23, s23, 1
s_cmp_gt_u32 s23, 150000
s_cbranch_scc1 sp_bad_136
s_waitcnt vmcnt(0)
sp_loop_134_e:
v_cmp_gt_u32 vcc, s52, v33
v_cmp_gt_u32 s[58:59], s54, v33
s_and_b32 vcc_lo, vcc_lo, s56
s_cbranch_scc0 sp_ok_135
s_cmp_gt_u32 s23, 4
s_cselect_b32 s70, 0, s56
s_cmp_lg_u32 s77, 0
s_cselect_b32 s70, 0, s70
s_or_b32 s59, s59, s70
s_and_b32 s59, s59, s56
s_cbranch_scc0 sp_ok_135
s_sleep 1
s_branch sp_loop_134
sp_bad_136:
s_mov_b32 s98, 1029
s_branch L_fail
sp_ok_135:
ds_write_b32 v18, v33
s_waitcnt lgkmcnt(0)
sp_ok_135_j:
s_barrier
ds_read_b32 v33, v32
s_waitcnt lgkmcnt(0)
s_mov_b32 s73, 1879048192
v_cmp_gt_u32 vcc, s52, v33
v_cmp_gt_u32 s[58:59], s54, v33
s_and_b32 vcc_lo, vcc_lo, s56
s_cselect_b32 s70, 0, 1
s_and_b32 s59, s59, s56
s_cselect_b32 s71, 0, 1
s_or_b32 s82, s70, s71
s_cselect_b32 s10, 268435456, 0
s_cmp_lg_u32 s70, 0
s_cselect_b64 s[78:79], s[52:53], s[54:55]
s_cselect_b64 s[58:59], s[44:45], s[46:47]
s_mul_i32 s80, s78, s20
s_add_u32 s80, s80, s58
s_mul_i32 s81, s78, s21
s_add_u32 s81, s81, s59
s_andn2_b32 s71, s71, s70
s_add_u32 s52, s52, s70
s_add_u32 s54, s54, s71
s_mov_b32 s83, s82
g_go_133:
s_add_u32 m0, s49, 0
s_nop 0
buffer_load_dwordx4 v8, s[4:7], s80 offen offset:0 sc1 lds
buffer_load_dwordx4 v9, s[4:7], s80 offen offset:1024 sc1 lds
buffer_load_dwordx4 v10, s[4:7], s80 offen offset:2048 sc1 lds
buffer_load_dwordx4 v11, s[4:7], s80 offen offset:3072 sc1 lds
s_add_u32 m0, s49, 4096
s_nop 0
buffer_load_dwordx4 v12, s[4:7], s80 offen offset:0 sc1 lds
buffer_load_dwordx4 v13, s[4:7], s80 offen offset:1024 sc1 lds
buffer_load_dwordx4 v14, s[4:7], s80 offen offset:2048 sc1 lds
buffer_load_dwordx4 v15, s[4:7], s80 offen offset:3072 sc1 lds
buffer_load_dword v24, v22, s[4:7], 0 offen sc1
buffer_store_dword v27, v34, s[4:7], 0 offen
buffer_store_dword v27, v34, s[4:7], 0 offen
v_mov_b32 v27, s72
s_waitcnt vmcnt(9)
s_barrier
buffer_store_dword v27, v45, s[4:7], s73 offen
buffer_store_dword v27, v44, s[4:7], s73 offen sc1
s_mov_b32 s73, 1879048192
ds_read_b128 v[64:67], v29 offset:0
ds_read_b128 v[68:71], v29 offset:8192
ds_read_b128 v[72:75], v29 offset:16384
ds_read_b128 v[76:79], v29 offset:24576
ds_read_b128 v[80:83], v29 offset:1024
ds_read_b128 v[84:87], v29 offset:9216
ds_read_b128 v[88:91], v29 offset:17408
ds_read_b128 v[92:95], v29 offset:25600
s_waitcnt vmcnt(7)
s_barrier
s_branch g_body_118
g_slow_130:
v_mfma_f32_16x16x32_bf16 v[228:231], a[188:191], v[156:159], v[228:231]
v_mfma_f32_16x16x32_bf16 v[224:227], a[192:195], v[160:163], v[224:227]
v_mfma_f32_16x16x32_bf16 v[228:231], a[192:195], v[164:167], v[228:231]
v_mfma_f32_16x16x32_bf16 v[224:227], a[196:199], v[168:171], v[224:227]
v_mfma_f32_16x16x32_bf16 v[228:231], a[196:199], v[172:175], v[228:231]
v_mfma_f32_16x16x32_bf16 v[224:227], a[200:203], v[176:179], v[224:227]
v_mfma_f32_16x16x32_bf16 v[228:231], a[200:203], v[180:183], v[228:231]
v_mfma_f32_16x16x32_bf16 v[224:227], a[204:207], v[184:187], v[224:227]
v_mfma_f32_16x16x32_bf16 v[228:231], a[204:207], v[188:191], v[228:231]
s_nop 6
v_cvt_pk_bf16_f32 v56, v224, v225
v_cvt_pk_bf16_f32 v57, v226, v227
v_cvt_pk_bf16_f32 v58, v228, v229
v_cvt_pk_bf16_f32 v59, v230, v231
s_nop 0
v_permlane16_swap_b32 v56, v58
v_permlane16_swap_b32 v57, v59
buffer_store_dwordx4 v[56:59], v21, s[4:7], s81 offen sc1
s_mov_b32 s81, 1879048192
s_waitcnt vmcnt(4)
ds_write_b32 v18, v24
s_waitcnt lgkmcnt(0)
s_barrier
ds_read_b32 v33, v32
s_waitcnt lgkmcnt(0)
v_cmp_gt_u32 vcc, s52, v33
v_cmp_gt_u32 s[58:59], s54, v33
s_and_b32 vcc_lo, vcc_lo, s56
s_cselect_b32 s70, 0, 1
s_and_b32 s59, s59, s56
s_cselect_b32 s71, 0, s83
s_or_b32 s88, s70, s71
s_cselect_b32 s10, 268435456, 0
s_cmp_lg_u32 s70, 0
s_cselect_b64 s[84:85], s[52:53], s[54:55]
s_cselect_b64 s[58:59], s[44:45], s[46:47]
s_mul_i32 s86, s84, s20
s_add_u32 s86, s86, s58
s_mul_i32 s87, s84, s21
s_add_u32 s87, s87, s59
s_andn2_b32 s71, s71, s70
s_add_u32 s52, s52, s70
s_add_u32 s54, s54, s71
s_mov_b32 s89, s88
s_cmp_lg_u32 s88, 0
s_cbranch_scc1 g_go_137
v_mov_b32 v27, s78
s_waitcnt vmcnt(0)
s_barrier
s_add_u32 s70, s52, s54
s_cmp_eq_u32 s70, 130
s_cbranch_scc1 g_fin_121
s_cmp_lg_u32 s3, 0
s_cbranch_scc1 sp_ok_139_j
s_mov_b32 s23, 0
buffer_load_dword v33, v22, s[4:7], 0 offen sc1
buffer_store_dword v27, v45, s[4:7], s79 offen
buffer_store_dword v27, v44, s[4:7], s79 offen sc1
s_waitcnt vmcnt(2)
s_branch sp_loop_138_e
sp_loop_138:
buffer_load_dword v33, v22, s[4:7], 0 offen sc1
s_add_u32 s23, s23, 1
s_cmp_gt_u32 s23, 150000
s_cbranch_scc1 sp_bad_140
s_waitcnt vmcnt(0)
sp_loop_138_e:
v_cmp_gt_u32 vcc, s52, v33
v_cmp_gt_u32 s[58:59], s54, v33
s_and_b32 vcc_lo, vcc_lo, s56
s_cbranch_scc0 sp_ok_139
s_cmp_gt_u32 s23, 4
s_cselect_b32 s70, 0, s56
s_cmp_lg_u32 s83, 0
s_cselect_b32 s70, 0, s70
s_or_b32 s59, s59, s70
s_and_b32 s59, s59, s56
s_cbranch_scc0 sp_ok_139
s_sleep 1
s_branch sp_loop_138
sp_bad_140:
s_mov_b32 s98, 1029
s_branch L_fail
sp_ok_139:
ds_write_b32 v18, v33
s_waitcnt lgkmcnt(0)
sp_ok_139_j:
s_barrier
ds_read_b32 v33, v32
s_waitcnt lgkmcnt(0)
s_mov_b32 s79, 1879048192
v_cmp_gt_u32 vcc, s52, v33
v_cmp_gt_u32 s[58:59], s54, v33
s_and_b32 vcc_lo, vcc_lo, s56
s_cselect_b32 s70, 0, 1
s_and_b32 s59, s59, s56
s_cselect_b32 s71, 0, 1
s_or_b32 s88, s70, s71
s_cselect_b32 s10, 268435456, 0
s_cmp_lg_u32 s70, 0
s_cselect_b64 s[84:85], s[52:53], s[54:55]
s_cselect_b64 s[58:59], s[44:45], s[46:47]
s_mul_i32 s86, s84, s20
s_add_u32 s86, s86, s58
s_mul_i32 s87, s84, s21
s_add_u32 s87, s87, s59
s_andn2_b32 s71, s71, s70
s_add_u32 s52, s52, s70
s_add_u32 s54, s54, s71
s_mov_b32 s89, s88
g_go_137:
s_add_u32 m0, s50, 0
s_nop 0
buffer_load_dwordx4 v8, s[4:7], s86 offen offset:0 sc1 lds
buffer_load_dwordx4 v9, s[4:7], s86 offen offset:1024 sc1 lds
buffer_load_dwordx4 v10, s[4:7], s86 offen offset:2048 sc1 lds
buffer_load_dwordx4 v11, s[4:7], s86 offen offset:3072 sc1 lds
s_add_u32 m0, s50, 4096
s_nop 0
buffer_load_dwordx4 v12, s[4:7], s86 offen offset:0 sc1 lds
buffer_load_dwordx4 v13, s[4:7], s86 offen offset:1024 sc1 lds
buffer_load_dwordx4 v14, s[4:7], s86 offen offset:2048 sc1 lds
buffer_load_dwordx4 v15, s[4:7], s86 offen offset:3072 sc1 lds
buffer_load_dword v24, v22, s[4:7], 0 offen sc1
buffer_store_dword v27, v34, s[4:7], 0 offen
buffer_store_dword v27, v34, s[4:7], 0 offen
v_mov_b32 v27, s78
s_waitcnt vmcnt(9)
s_barrier
buffer_store_dword v27, v45, s[4:7], s79 offen
buffer_store_dword v27, v44, s[4:7], s79 offen sc1
s_mov_b32 s79, 1879048192
ds_read_b128 v[64:67], v30 offset:0
ds_read_b128 v[68:71], v30 offset:8192
ds_read_b128 v[72:75], v30 offset:16384
ds_read_b128 v[76:79], v30 offset:24576
ds_read_b128 v[80:83], v30 offset:1024
ds_read_b128 v[84:87], v30 offset:9216
ds_read_b128 v[88:91], v30 offset:17408
ds_read_b128 v[92:95], v30 offset:25600
s_waitcnt vmcnt(7)
s_barrier
s_branch g_body_119
g_slow_131:
v_mfma_f32_16x16x32_bf16 v[228:231], a[188:191], v[156:159], v[228:231]
v_mfma_f32_16x16x32_bf16 v[224:227], a[192:195], v[160:163], v[224:227]
v_mfma_f32_16x16x32_bf16 v[228:231], a[192:195], v[164:167], v[228:231]
v_mfma_f32_16x16x32_bf16 v[224:227], a[196:199], v[168:171], v[224:227]
v_mfma_f32_16x16x32_bf16 v[228:231], a[196:199], v[172:175], v[228:231]
v_mfma_f32_16x16x32_bf16 v[224:227], a[200:203], v[176:179], v[224:227]
v_mfma_f32_16x16x32_bf16 v[228:231], a[200:203], v[180:183], v[228:231]
v_mfma_f32_16x16x32_bf16 v[224:227], a[204:207], v[184:187], v[224:227]
v_mfma_f32_16x16x32_bf16 v[228:231], a[204:207], v[188:191], v[228:231]
s_nop 6
v_cvt_pk_bf16_f32 v56, v224, v225
v_cvt_pk_bf16_f32 v57, v226, v227
v_cvt_pk_bf16_f32 v58, v228, v229
v_cvt_pk_bf16_f32 v59, v230, v231
s_nop 0
v_permlane16_swap_b32 v56, v58
v_permlane16_swap_b32 v57, v59
buffer_store_dwordx4 v[56:59], v21, s[4:7], s87 offen sc1
s_mov_b32 s87, 1879048192
s_waitcnt vmcnt(4)
ds_write_b32 v18, v24
s_waitcnt lgkmcnt(0)
s_barrier
ds_read_b32 v33, v32
s_waitcnt lgkmcnt(0)
v_cmp_gt_u32 vcc, s52, v33
v_cmp_gt_u32 s[58:59], s54, v33
s_and_b32 vcc_lo, vcc_lo, s56
s_cselect_b32 s70, 0, 1
s_and_b32 s59, s59, s56
s_cselect_b32 s71, 0, s89
s_or_b32 s94, s70, s71
s_cselect_b32 s10, 268435456, 0
s_cmp_lg_u32 s70, 0
s_cselect_b64 s[90:91], s[52:53], s[54:55]
s_cselect_b64 s[58:59], s[44:45], s[46:47]
s_mul_i32 s92, s90, s20
s_add_u32 s92, s92, s58
s_mul_i32 s93, s90, s21
s_add_u32 s93, s93, s59
s_andn2_b32 s71, s71, s70
s_add_u32 s52, s52, s70
s_add_u32 s54, s54, s71
s_mov_b32 s95, s94
s_cmp_lg_u32 s94, 0
s_cbranch_scc1 g_go_141
v_mov_b32 v27, s84
s_waitcnt vmcnt(0)
s_barrier
s_add_u32 s70, s52, s54
s_cmp_eq_u32 s70, 130
s_cbranch_scc1 g_fin_121
s_cmp_lg_u32 s3, 0
s_cbranch_scc1 sp_ok_143_j
s_mov_b32 s23, 0
buffer_load_dword v33, v22, s[4:7], 0 offen sc1
buffer_store_dword v27, v45, s[4:7], s85 offen
buffer_store_dword v27, v44, s[4:7], s85 offen sc1
s_waitcnt vmcnt(2)
s_branch sp_loop_142_e
sp_loop_142:
buffer_load_dword v33, v22, s[4:7], 0 offen sc1
s_add_u32 s23, s23, 1
s_cmp_gt_u32 s23, 150000
s_cbranch_scc1 sp_bad_144
s_waitcnt vmcnt(0)
sp_loop_142_e:
v_cmp_gt_u32 vcc, s52, v33
v_cmp_gt_u32 s[58:59], s54, v33
s_and_b32 vcc_lo, vcc_lo, s56
s_cbranch_scc0 sp_ok_143
s_cmp_gt_u32 s23, 4
s_cselect_b32 s70, 0, s56
s_cmp_lg_u32 s89, 0
s_cselect_b32 s70, 0, s70
s_or_b32 s59, s59, s70
s_and_b32 s59, s59, s56
s_cbranch_scc0 sp_ok_143
s_sleep 1
s_branch sp_loop_142
sp_bad_144:
s_mov_b32 s98, 1029
s_branch L_fail
sp_ok_143:
ds_write_b32 v18, v33
s_waitcnt lgkmcnt(0)
sp_ok_143_j:
s_barrier
ds_read_b32 v33, v32
s_waitcnt lgkmcnt(0)
s_mov_b32 s85, 1879048192
v_cmp_gt_u32 vcc, s52, v33
v_cmp_gt_u32 s[58:59], s54, v33
s_and_b32 vcc_lo, vcc_lo, s56
s_cselect_b32 s70, 0, 1
s_and_b32 s59, s59, s56
s_cselect_b32 s71, 0, 1
s_or_b32 s94, s70, s71
s_cselect_b32 s10, 268435456, 0
s_cmp_lg_u32 s70, 0
s_cselect_b64 s[90:91], s[52:53], s[54:55]
s_cselect_b64 s[58:59], s[44:45], s[46:47]
s_mul_i32 s92, s90, s20
s_add_u32 s92, s92, s58
s_mul_i32 s93, s90, s21
s_add_u32 s93, s93, s59
s_andn2_b32 s71, s71, s70
s_add_u32 s52, s52, s70
s_add_u32 s54, s54, s71
s_mov_b32 s95, s94
g_go_141:
s_add_u32 m0, s51, 0
s_nop 0
buffer_load_dwordx4 v8, s[4:7], s92 offen offset:0 sc1 lds
buffer_load_dwordx4 v9, s[4:7], s92 offen offset:1024 sc1 lds
buffer_load_dwordx4 v10, s[4:7], s92 offen offset:2048 sc1 lds
buffer_load_dwordx4 v11, s[4:7], s92 offen offset:3072 sc1 lds
s_add_u32 m0, s51, 4096
s_nop 0
buffer_load_dwordx4 v12, s[4:7], s92 offen offset:0 sc1 lds
buffer_load_dwordx4 v13, s[4:7], s92 offen offset:1024 sc1 lds
buffer_load_dwordx4 v14, s[4:7], s92 offen offset:2048 sc1 lds
buffer_load_dwordx4 v15, s[4:7], s92 offen offset:3072 sc1 lds
buffer_load_dword v24, v22, s[4:7], 0 offen sc1
buffer_store_dword v27, v34, s[4:7], 0 offen
buffer_store_dword v27, v34, s[4:7], 0 offen
v_mov_b32 v27, s84
s_waitcnt vmcnt(9)
s_barrier
buffer_store_dword v27, v45, s[4:7], s85 offen
buffer_store_dword v27, v44, s[4:7], s85 offen sc1
s_mov_b32 s85, 1879048192
ds_read_b128 v[64:67], v31 offset:0
ds_read_b128 v[68:71], v31 offset:8192
ds_read_b128 v[72:75], v31 offset:16384
ds_read_b128 v[76:79], v31 offset:24576
ds_read_b128 v[80:83], v31 offset:1024
ds_read_b128 v[84:87], v31 offset:9216
ds_read_b128 v[88:91], v31 offset:17408
ds_read_b128 v[92:95], v31 offset:25600
s_waitcnt vmcnt(7)
s_barrier
s_branch g_body_120
g_slow_132:
v_mfma_f32_16x16x32_bf16 v[228:231], a[188:191], v[156:159], v[228:231]
v_mfma_f32_16x16x32_bf16 v[224:227], a[192:195], v[160:163], v[224:227]
v_mfma_f32_16x16x32_bf16 v[228:231], a[192:195], v[164:167], v[228:231]
v_mfma_f32_16x16x32_bf16 v[224:227], a[196:199], v[168:171], v[224:227]
v_mfma_f32_16x16x32_bf16 v[228:231], a[196:199], v[172:175], v[228:231]
v_mfma_f32_16x16x32_bf16 v[224:227], a[200:203], v[176:179], v[224:227]
v_mfma_f32_16x16x32_bf16 v[228:231], a[200:203], v[180:183], v[228:231]
v_mfma_f32_16x16x32_bf16 v[224:227], a[204:207], v[184:187], v[224:227]
v_mfma_f32_16x16x32_bf16 v[228:231], a[204:207], v[188:191], v[228:231]
s_nop 6
v_cvt_pk_bf16_f32 v56, v224, v225
v_cvt_pk_bf16_f32 v57, v226, v227
v_cvt_pk_bf16_f32 v58, v228, v229
v_cvt_pk_bf16_f32 v59, v230, v231
s_nop 0
v_permlane16_swap_b32 v56, v58
v_permlane16_swap_b32 v57, v59
buffer_store_dwordx4 v[56:59], v21, s[4:7], s93 offen sc1
s_mov_b32 s93, 1879048192
s_waitcnt vmcnt(4)
ds_write_b32 v18, v24
s_waitcnt lgkmcnt(0)
s_barrier
ds_read_b32 v33, v32
s_waitcnt lgkmcnt(0)
v_cmp_gt_u32 vcc, s52, v33
v_cmp_gt_u32 s[58:59], s54, v33
s_and_b32 vcc_lo, vcc_lo, s56
s_cselect_b32 s70, 0, 1
s_and_b32 s59, s59, s56
s_cselect_b32 s71, 0, s95
s_or_b32 s76, s70, s71
s_cselect_b32 s10, 268435456, 0
s_cmp_lg_u32 s70, 0
s_cselect_b64 s[72:73], s[52:53], s[54:55]
s_cselect_b64 s[58:59], s[44:45], s[46:47]
s_mul_i32 s74, s72, s20
s_add_u32 s74, s74, s58
s_mul_i32 s75, s72, s21
s_add_u32 s75, s75, s59
s_andn2_b32 s71, s71, s70
s_add_u32 s52, s52, s70
s_add_u32 s54, s54, s71
s_mov_b32 s77, s76
s_cmp_lg_u32 s76, 0
s_cbranch_scc1 g_go_145
v_mov_b32 v27, s90
s_waitcnt vmcnt(0)
s_barrier
s_add_u32 s70, s52, s54
s_cmp_eq_u32 s70, 130
s_cbranch_scc1 g_fin_121
s_cmp_lg_u32 s3, 0
s_cbranch_scc1 sp_ok_147_j
s_mov_b32 s23, 0
buffer_load_dword v33, v22, s[4:7], 0 offen sc1
buffer_store_dword v27, v45, s[4:7], s91 offen
buffer_store_dword v27, v44, s[4:7], s91 offen sc1
s_waitcnt vmcnt(2)
s_branch sp_loop_146_e
sp_loop_146:
buffer_load_dword v33, v22, s[4:7], 0 offen sc1
s_add_u32 s23, s23, 1
s_cmp_gt_u32 s23, 150000
s_cbranch_scc1 sp_bad_148
s_waitcnt vmcnt(0)
sp_loop_146_e:
v_cmp_gt_u32 vcc, s52, v33
v_cmp_gt_u32 s[58:59], s54, v33
s_and_b32 vcc_lo, vcc_lo, s56
s_cbranch_scc0 sp_ok_147
s_cmp_gt_u32 s23, 4
s_cselect_b32 s70, 0, s56
s_cmp_lg_u32 s95, 0
s_cselect_b32 s70, 0, s70
s_or_b32 s59, s59, s70
s_and_b32 s59, s59, s56
s_cbranch_scc0 sp_ok_147
s_sleep 1
s_branch sp_loop_146
sp_bad_148:
s_mov_b32 s98, 1029
s_branch L_fail
sp_ok_147:
ds_write_b32 v18, v33
s_waitcnt lgkmcnt(0)
sp_ok_147_j:
s_barrier
ds_read_b32 v33, v32
s_waitcnt lgkmcnt(0)
s_mov_b32 s91, 1879048192
v_cmp_gt_u32 vcc, s52, v33
v_cmp_gt_u32 s[58:59], s54, v33
s_and_b32 vcc_lo, vcc_lo, s56
s_cselect_b32 s70, 0, 1
s_and_b32 s59, s59, s56
s_cselect_b32 s71, 0, 1
s_or_b32 s76, s70, s71
s_cselect_b32 s10, 268435456, 0
s_cmp_lg_u32 s70, 0
s_cselect_b64 s[72:73], s[52:53], s[54:55]
s_cselect_b64 s[58:59], s[44:45], s[46:47]
s_mul_i32 s74, s72, s20
s_add_u32 s74, s74, s58
s_mul_i32 s75, s72, s21
s_add_u32 s75, s75, s59
s_andn2_b32 s71, s71, s70
s_add_u32 s52, s52, s70
s_add_u32 s54, s54, s71
s_mov_b32 s77, s76
g_go_145:
s_add_u32 m0, s48, 0
s_nop 0
buffer_load_dwordx4 v8, s[4:7], s74 offen offset:0 sc1 lds
buffer_load_dwordx4 v9, s[4:7], s74 offen offset:1024 sc1 lds
buffer_load_dwordx4 v10, s[4:7], s74 offen offset:2048 sc1 lds
buffer_load_dwordx4 v11, s[4:7], s74 offen offset:3072 sc1 lds
s_add_u32 m0, s48, 4096
s_nop 0
buffer_load_dwordx4 v12, s[4:7], s74 offen offset:0 sc1 lds
buffer_load_dwordx4 v13, s[4:7], s74 offen offset:1024 sc1 lds
buffer_load_dwordx4 v14, s[4:7], s74 offen offset:2048 sc1 lds
buffer_load_dwordx4 v15, s[4:7], s74 offen offset:3072 sc1 lds
buffer_load_dword v24, v22, s[4:7], 0 offen sc1
buffer_store_dword v27, v34, s[4:7], 0 offen
buffer_store_dword v27, v34, s[4:7], 0 offen
v_mov_b32 v27, s90
s_waitcnt vmcnt(9)
s_barrier
buffer_store_dword v27, v45, s[4:7], s91 offen
buffer_store_dword v27, v44, s[4:7], s91 offen sc1
s_mov_b32 s91, 1879048192
ds_read_b128 v[64:67], v28 offset:0
ds_read_b128 v[68:71], v28 offset:8192
ds_read_b128 v[72:75], v28 offset:16384
ds_read_b128 v[76:79], v28 offset:24576
ds_read_b128 v[80:83], v28 offset:1024
ds_read_b128 v[84:87], v28 offset:9216
ds_read_b128 v[88:91], v28 offset:17408
ds_read_b128 v[92:95], v28 offset:25600
s_waitcnt vmcnt(7)
s_barrier
s_branch g_body_117
g_fin_121:
buffer_store_dword v27, v45, s[4:7], s91 offen
buffer_store_dword v27, v44, s[4:7], s91 offen sc1
s_endpgm
H_up:
s_mov_b32 s8, s32
s_and_b32 s9, s33, 0xffff
s_mov_b32 s10, 5308416
s_mov_b32 s11, 0x20000
s_mov_b32 s12, s34
s_and_b32 s13, s35, 0xffff
s_mov_b32 s14, 5308416
s_mov_b32 s15, 0x20000
s_mul_i32 s75, s74, 192
s_lshl_b32 s76, s3, 5
s_add_u32 s48, s75, s76
s_mov_b32 s49, s48
s_lshr_b32 s77, s3, 1
s_lshl_b32 s76, s77, 5
s_add_u32 s76, s76, s75
s_add_u32 s50, s76, 128
s_mov_b32 s51, s50
s_mul_i32 s75, s74, 6144
v_lshrrev_b32 v1, 5, v0
v_lshlrev_b32 v1, 10, v1
v_and_b32 v2, 15, v0
v_lshl_add_u32 v1, v2, 4, v1
v_bfe_u32 v2, v0, 4, 1
v_lshl_add_u32 v1, v2, 3, v1
s_lshl_b32 s76, s3, 8
s_add_u32 s76, s76, s75
s_add_u32 s76, s76, 4096
v_add_u32 v19, s76, v1
v_bfe_u32 v1, v0, 4, 1
v_lshlrev_b32 v1, 10, v1
v_lshrrev_b32 v2, 5, v0
v_lshl_add_u32 v1, v2, 8, v1
v_and_b32 v2, 15, v0
v_lshl_add_u32 v5, v2, 4, v1
s_lshl_b32 s76, s77, 11
s_add_u32 s76, s76, s75
s_and_b32 s77, s3, 1
s_lshl_b32 s77, s77, 9
s_add_u32 s76, s76, s77
v_add_u32 v20, s76, v5
s_cmp_lg_u32 s3, 0
s_cbranch_scc1 wp_ok_150
s_mov_b32 s16, s40
s_and_b32 s17, s41, 0xffff
s_mov_b32 s18, 256
s_mov_b32 s19, 0x20000
v_mov_b32 v1, 224
s_mov_b32 s98, 0
s_mov_b64 exec, 1
wp_loop_149:
buffer_load_dword v2, v1, s[16:19], 0 offen sc1
s_add_u32 s98, s98, 1
s_cmp_gt_u32 s98, 150000
s_cbranch_scc1 wp_bad_151
s_waitcnt vmcnt(0)
v_readfirstlane_b32 s97, v2
s_nop 0
s_cmp_ge_u32 s97, 32
s_cbranch_scc1 wp_ok_150
s_sleep 8
s_branch wp_loop_149
wp_bad_151:
s_mov_b32 s98, 513
s_branch L_fail
wp_ok_150:
s_mov_b64 exec, -1
s_barrier
v_lshrrev_b32 v1, 5, v0
v_bfe_u32 v2, v0, 3, 1
v_lshl_add_u32 v1, v1, 1, v2
v_bfe_u32 v2, v0, 4, 1
v_bfe_u32 v3, v0, 1, 2
v_lshlrev_b32 v1, 3, v1
v_lshl_add_u32 v1, v2, 2, v1
v_add_u32 v1, v1, v3
v_mul_u32_u24 v1, 9216, v1
v_and_b32 v2, 1, v0
v_lshl_add_u32 v63, v2, 4, v1
s_mul_i32 s70, s3, 40960
v_lshrrev_b32 v1, 5, v0
v_lshlrev_b32 v1, 9, v1
v_bfe_u32 v2, v0, 4, 1
v_lshl_add_u32 v1, v2, 7, v1
v_add_u32 v1, s70, v1
v_and_b32 v2, 15, v0
v_lshl_add_u32 v2, v2, 3, v1
v_mov_b32 v61, v2
v_add_u32 v62, 1024, v2
v_bfe_u32 v2, v0, 2, 2
v_lshl_add_u32 v1, v2, 5, v1
v_bfe_u32 v2, v0, 1, 1
v_lshl_add_u32 v1, v2, 10, v1
v_and_b32 v2, 1, v0
v_lshl_add_u32 v1, v2, 3, v1
s_and_b32 s71, s3, 1
s_lshl_b32 s71, s71, 4
s_add_u32 s71, s71, 2048
v_add_u32 v60, s71, v1
s_add_u32 m0, s70, 0
s_add_u32 s71, s48, 0
buffer_load_dwordx4 v63, s[8:11], s71 offen lds
s_add_u32 m0, s70, 1024
s_add_u32 s71, s49, 0
buffer_load_dwordx4 v63, s[12:15], s71 offen lds
s_add_u32 m0, s70, 2048
s_add_u32 s71, s50, 0
buffer_load_dwordx4 v63, s[8:11], s71 offen lds
s_add_u32 m0, s70, 3072
s_add_u32 s71, s51, 0
buffer_load_dwordx4 v63, s[12:15], s71 offen lds
s_add_u32 m0, s70, 4096
s_add_u32 s71, s48, 294912
buffer_load_dwordx4 v63, s[8:11], s71 offen lds
s_add_u32 m0, s70, 5120
s_add_u32 s71, s49, 294912
buffer_load_dwordx4 v63, s[12:15], s71 offen lds
s_add_u32 m0, s70, 6144
s_add_u32 s71, s50, 294912
buffer_load_dwordx4 v63, s[8:11], s71 offen lds
s_add_u32 m0, s70, 7168
s_add_u32 s71, s51, 294912
buffer_load_dwordx4 v63, s[12:15], s71 offen lds
s_add_u32 m0, s70, 8192
s_add_u32 s71, s48, 589824
buffer_load_dwordx4 v63, s[8:11], s71 offen lds
s_add_u32 m0, s70, 9216
s_add_u32 s71, s49, 589824
buffer_load_dwordx4 v63, s[12:15], s71 offen lds
s_add_u32 m0, s70, 10240
s_add_u32 s71, s50, 589824
buffer_load_dwordx4 v63, s[8:11], s71 offen lds
s_add_u32 m0, s70, 11264
s_add_u32 s71, s51, 589824
buffer_load_dwordx4 v63, s[12:15], s71 offen lds
s_add_u32 m0, s70, 12288
s_add_u32 s71, s48, 884736
buffer_load_dwordx4 v63, s[8:11], s71 offen lds
s_add_u32 m0, s70, 13312
s_add_u32 s71, s49, 884736
buffer_load_dwordx4 v63, s[12:15], s71 offen lds
s_add_u32 m0, s70, 14336
s_add_u32 s71, s50, 884736
buffer_load_dwordx4 v63, s[8:11], s71 offen lds
s_add_u32 m0, s70, 15360
s_add_u32 s71, s51, 884736
buffer_load_dwordx4 v63, s[12:15], s71 offen lds
s_add_u32 m0, s70, 16384
s_add_u32 s71, s48, 1179648
buffer_load_dwordx4 v63, s[8:11], s71 offen lds
s_add_u32 m0, s70, 17408
s_add_u32 s71, s49, 1179648
buffer_load_dwordx4 v63, s[12:15], s71 offen lds
s_add_u32 m0, s70, 18432
s_add_u32 s71, s50, 1179648
buffer_load_dwordx4 v63, s[8:11], s71 offen lds
s_add_u32 m0, s70, 19456
s_add_u32 s71, s51, 1179648
buffer_load_dwordx4 v63, s[12:15], s71 offen lds
s_add_u32 m0, s70, 20480
s_add_u32 s71, s48, 1474560
buffer_load_dwordx4 v63, s[8:11], s71 offen lds
s_add_u32 m0, s70, 21504
s_add_u32 s71, s49, 1474560
buffer_load_dwordx4 v63, s[12:15], s71 offen lds
s_add_u32 m0, s70, 22528
s_add_u32 s71, s50, 1474560
buffer_load_dwordx4 v63, s[8:11], s71 offen lds
s_add_u32 m0, s70, 23552
s_add_u32 s71, s51, 1474560
buffer_load_dwordx4 v63, s[12:15], s71 offen lds
s_add_u32 m0, s70, 24576
s_add_u32 s71, s48, 1769472
buffer_load_dwordx4 v63, s[8:11], s71 offen lds
s_add_u32 m0, s70, 25600
s_add_u32 s71, s49, 1769472
buffer_load_dwordx4 v63, s[12:15], s71 offen lds
s_add_u32 m0, s70, 26624
s_add_u32 s71, s50, 1769472
buffer_load_dwordx4 v63, s[8:11], s71 offen lds
s_add_u32 m0, s70, 27648
s_add_u32 s71, s51, 1769472
buffer_load_dwordx4 v63, s[12:15], s71 offen lds
s_add_u32 m0, s70, 28672
s_add_u32 s71, s48, 2064384
buffer_load_dwordx4 v63, s[8:11], s71 offen lds
s_add_u32 m0, s70, 29696
s_add_u32 s71, s49, 2064384
buffer_load_dwordx4 v63, s[12:15], s71 offen lds
s_add_u32 m0, s70, 30720
s_add_u32 s71, s50, 2064384
buffer_load_dwordx4 v63, s[8:11], s71 offen lds
s_add_u32 m0, s70, 31744
s_add_u32 s71, s51, 2064384
buffer_load_dwordx4 v63, s[12:15], s71 offen lds
s_add_u32 m0, s70, 32768
s_add_u32 s71, s48, 2359296
buffer_load_dwordx4 v63, s[8:11], s71 offen lds
s_add_u32 m0, s70, 33792
s_add_u32 s71, s49, 2359296
buffer_load_dwordx4 v63, s[12:15], s71 offen lds
s_add_u32 m0, s70, 34816
s_add_u32 s71, s50, 2359296
buffer_load_dwordx4 v63, s[8:11], s71 offen lds
s_add_u32 m0, s70, 35840
s_add_u32 s71, s51, 2359296
buffer_load_dwordx4 v63, s[12:15], s71 offen lds
s_add_u32 m0, s70, 36864
s_add_u32 s71, s48, 2654208
buffer_load_dwordx4 v63, s[8:11], s71 offen lds
s_add_u32 m0, s70, 37888
s_add_u32 s71, s49, 2654208
buffer_load_dwordx4 v63, s[12:15], s71 offen lds
s_add_u32 m0, s70, 38912
s_add_u32 s71, s50, 2654208
buffer_load_dwordx4 v63, s[8:11], s71 offen lds
s_add_u32 m0, s70, 39936
s_add_u32 s71, s51, 2654208
buffer_load_dwordx4 v63, s[12:15], s71 offen lds
s_waitcnt vmcnt(36)
ds_read_b64_tr_b16 a[0:1], v60 offset:0
ds_read_b64_tr_b16 a[2:3], v60 offset:256
ds_read_b64_tr_b16 a[72:73], v61 offset:0
ds_read_b64_tr_b16 a[74:75], v61 offset:256
ds_read_b64_tr_b16 a[144:145], v62 offset:0
ds_read_b64_tr_b16 a[146:147], v62 offset:256
s_waitcnt lgkmcnt(0)
s_add_u32 m0, s70, 0
s_add_u32 s71, s48, 2949120
buffer_load_dwordx4 v63, s[8:11], s71 offen lds
s_add_u32 m0, s70, 1024
s_add_u32 s71, s49, 2949120
buffer_load_dwordx4 v63, s[12:15], s71 offen lds
s_add_u32 m0, s70, 2048
s_add_u32 s71, s50, 2949120
buffer_load_dwordx4 v63, s[8:11], s71 offen lds
s_add_u32 m0, s70, 3072
s_add_u32 s71, s51, 2949120
buffer_load_dwordx4 v63, s[12:15], s71 offen lds
s_waitcnt vmcnt(36)
ds_read_b64_tr_b16 a[4:5], v60 offset:4096
ds_read_b64_tr_b16 a[6:7], v60 offset:4352
ds_read_b64_tr_b16 a[76:77], v61 offset:4096
ds_read_b64_tr_b16 a[78:79], v61 offset:4352
ds_read_b64_tr_b16 a[148:149], v62 offset:4096
ds_read_b64_tr_b16 a[150:151], v62 offset:4352
s_waitcnt lgkmcnt(0)
s_add_u32 m0, s70, 4096
s_add_u32 s71, s48, 3244032
buffer_load_dwordx4 v63, s[8:11], s71 offen lds
s_add_u32 m0, s70, 5120
s_add_u32 s71, s49, 3244032
buffer_load_dwordx4 v63, s[12:15], s71 offen lds
s_add_u32 m0, s70, 6144
s_add_u32 s71, s50, 3244032
buffer_load_dwordx4 v63, s[8:11], s71 offen lds
s_add_u32 m0, s70, 7168
s_add_u32 s71, s51, 3244032
buffer_load_dwordx4 v63, s[12:15], s71 offen lds
s_waitcnt vmcnt(36)
ds_read_b64_tr_b16 a[8:9], v60 offset:8192
ds_read_b64_tr_b16 a[10:11], v60 offset:8448
ds_read_b64_tr_b16 a[80:81], v61 offset:8192
ds_read_b64_tr_b16 a[82:83], v61 offset:8448
ds_read_b64_tr_b16 a[152:153], v62 offset:8192
ds_read_b64_tr_b16 a[154:155], v62 offset:8448
s_waitcnt lgkmcnt(0)
s_add_u32 m0, s70, 8192
s_add_u32 s71, s48, 3538944
buffer_load_dwordx4 v63, s[8:11], s71 offen lds
s_add_u32 m0, s70, 9216
s_add_u32 s71, s49, 3538944
buffer_load_dwordx4 v63, s[12:15], s71 offen lds
s_add_u32 m0, s70, 10240
s_add_u32 s71, s50, 3538944
buffer_load_dwordx4 v63, s[8:11], s71 offen lds
s_add_u32 m0, s70, 11264
s_add_u32 s71, s51, 3538944
buffer_load_dwordx4 v63, s[12:15], s71 offen lds
s_waitcnt vmcnt(36)
ds_read_b64_tr_b16 a[12:13], v60 offset:12288
ds_read_b64_tr_b16 a[14:15], v60 offset:12544
ds_read_b64_tr_b16 a[84:85], v61 offset:12288
ds_read_b64_tr_b16 a[86:87], v61 offset:12544
ds_read_b64_tr_b16 a[156:157], v62 offset:12288
ds_read_b64_tr_b16 a[158:159], v62 offset:12544
s_waitcnt lgkmcnt(0)
s_add_u32 m0, s70, 12288
s_add_u32 s71, s48, 3833856
buffer_load_dwordx4 v63, s[8:11], s71 offen lds
s_add_u32 m0, s70, 13312
s_add_u32 s71, s49, 3833856
buffer_load_dwordx4 v63, s[12:15], s71 offen lds
s_add_u32 m0, s70, 14336
s_add_u32 s71, s50, 3833856
buffer_load_dwordx4 v63, s[8:11], s71 offen lds
s_add_u32 m0, s70, 15360
s_add_u32 s71, s51, 3833856
buffer_load_dwordx4 v63, s[12:15], s71 offen lds
s_waitcnt vmcnt(36)
ds_read_b64_tr_b16 a[16:17], v60 offset:16384
ds_read_b64_tr_b16 a[18:19], v60 offset:16640
ds_read_b64_tr_b16 a[88:89], v61 offset:16384
ds_read_b64_tr_b16 a[90:91], v61 offset:16640
ds_read_b64_tr_b16 a[160:161], v62 offset:16384
ds_read_b64_tr_b16 a[162:163], v62 offset:16640
s_waitcnt lgkmcnt(0)
s_add_u32 m0, s70, 16384
s_add_u32 s71, s48, 4128768
buffer_load_dwordx4 v63, s[8:11], s71 offen lds
s_add_u32 m0, s70, 17408
s_add_u32 s71, s49, 4128768
buffer_load_dwordx4 v63, s[12:15], s71 offen lds
s_add_u32 m0, s70, 18432
s_add_u32 s71, s50, 4128768
buffer_load_dwordx4 v63, s[8:11], s71 offen lds
s_add_u32 m0, s70, 19456
s_add_u32 s71, s51, 4128768
buffer_load_dwordx4 v63, s[12:15], s71 offen lds
s_waitcnt vmcnt(36)
ds_read_b64_tr_b16 a[20:21], v60 offset:20480
ds_read_b64_tr_b16 a[22:23], v60 offset:20736
ds_read_b64_tr_b16 a[92:93], v61 offset:20480
ds_read_b64_tr_b16 a[94:95], v61 offset:20736
ds_read_b64_tr_b16 a[164:165], v62 offset:20480
ds_read_b64_tr_b16 a[166:167], v62 offset:20736
s_waitcnt lgkmcnt(0)
s_add_u32 m0, s70, 20480
s_add_u32 s71, s48, 4423680
buffer_load_dwordx4 v63, s[8:11], s71 offen lds
s_add_u32 m0, s70, 21504
s_add_u32 s71, s49, 4423680
buffer_load_dwordx4 v63, s[12:15], s71 offen lds
s_add_u32 m0, s70, 22528
s_add_u32 s71, s50, 4423680
buffer_load_dwordx4 v63, s[8:11], s71 offen lds
s_add_u32 m0, s70, 23552
s_add_u32 s71, s51, 4423680
buffer_load_dwordx4 v63, s[12:15], s71 offen lds
s_waitcnt vmcnt(36)
ds_read_b64_tr_b16 a[24:25], v60 offset:24576
ds_read_b64_tr_b16 a[26:27], v60 offset:24832
ds_read_b64_tr_b16 a[96:97], v61 offset:24576
ds_read_b64_tr_b16 a[98:99], v61 offset:24832
ds_read_b64_tr_b16 a[168:169], v62 offset:24576
ds_read_b64_tr_b16 a[170:171], v62 offset:24832
s_waitcnt lgkmcnt(0)
s_add_u32 m0, s70, 24576
s_add_u32 s71, s48, 4718592
buffer_load_dwordx4 v63, s[8:11], s71 offen lds
s_add_u32 m0, s70, 25600
s_add_u32 s71, s49, 4718592
buffer_load_dwordx4 v63, s[12:15], s71 offen lds
s_add_u32 m0, s70, 26624
s_add_u32 s71, s50, 4718592
buffer_load_dwordx4 v63, s[8:11], s71 offen lds
s_add_u32 m0, s70, 27648
s_add_u32 s71, s51, 4718592
buffer_load_dwordx4 v63, s[12:15], s71 offen lds
s_waitcnt vmcnt(36)
ds_read_b64_tr_b16 a[28:29], v60 offset:28672
ds_read_b64_tr_b16 a[30:31], v60 offset:28928
ds_read_b64_tr_b16 a[100:101], v61 offset:28672
ds_read_b64_tr_b16 a[102:103], v61 offset:28928
ds_read_b64_tr_b16 a[172:173], v62 offset:28672
ds_read_b64_tr_b16 a[174:175], v62 offset:28928
s_waitcnt lgkmcnt(0)
s_add_u32 m0, s70, 28672
s_add_u32 s71, s48, 5013504
buffer_load_dwordx4 v63, s[8:11], s71 offen lds
s_add_u32 m0, s70, 29696
s_add_u32 s71, s49, 5013504
buffer_load_dwordx4 v63, s[12:15], s71 offen lds
s_add_u32 m0, s70, 30720
s_add_u32 s71, s50, 5013504
buffer_load_dwordx4 v63, s[8:11], s71 offen lds
s_add_u32 m0, s70, 31744
s_add_u32 s71, s51, 5013504
buffer_load_dwordx4 v63, s[12:15], s71 offen lds
s_waitcnt vmcnt(36)
ds_read_b64_tr_b16 a[32:33], v60 offset:32768
ds_read_b64_tr_b16 a[34:35], v60 offset:33024
ds_read_b64_tr_b16 a[104:105], v61 offset:32768
ds_read_b64_tr_b16 a[106:107], v61 offset:33024
ds_read_b64_tr_b16 a[176:177], v62 offset:32768
ds_read_b64_tr_b16 a[178:179], v62 offset:33024
s_waitcnt vmcnt(32)
ds_read_b64_tr_b16 a[36:37], v60 offset:36864
ds_read_b64_tr_b16 a[38:39], v60 offset:37120
ds_read_b64_tr_b16 a[108:109], v61 offset:36864
ds_read_b64_tr_b16 a[110:111], v61 offset:37120
ds_read_b64_tr_b16 a[180:181], v62 offset:36864
ds_read_b64_tr_b16 a[182:183], v62 offset:37120
s_waitcnt vmcnt(28)
ds_read_b64_tr_b16 a[40:41], v60 offset:0
ds_read_b64_tr_b16 a[42:43], v60 offset:256
ds_read_b64_tr_b16 a[112:113], v61 offset:0
ds_read_b64_tr_b16 a[114:115], v61 offset:256
ds_read_b64_tr_b16 a[184:185], v62 offset:0
ds_read_b64_tr_b16 a[186:187], v62 offset:256
s_waitcnt vmcnt(24)
ds_read_b64_tr_b16 a[44:45], v60 offset:4096
ds_read_b64_tr_b16 a[46:47], v60 offset:4352
ds_read_b64_tr_b16 a[116:117], v61 offset:4096
ds_read_b64_tr_b16 a[118:119], v61 offset:4352
ds_read_b64_tr_b16 a[188:189], v62 offset:4096
ds_read_b64_tr_b16 a[190:191], v62 offset:4352
s_waitcnt vmcnt(20)
ds_read_b64_tr_b16 a[48:49], v60 offset:8192
ds_read_b64_tr_b16 a[50:51], v60 offset:8448
ds_read_b64_tr_b16 a[120:121], v61 offset:8192
ds_read_b64_tr_b16 a[122:123], v61 offset:8448
ds_read_b64_tr_b16 a[192:193], v62 offset:8192
ds_read_b64_tr_b16 a[194:195], v62 offset:8448
s_waitcnt vmcnt(16)
ds_read_b64_tr_b16 a[52:53], v60 offset:12288
ds_read_b64_tr_b16 a[54:55], v60 offset:12544
ds_read_b64_tr_b16 a[124:125], v61 offset:12288
ds_read_b64_tr_b16 a[126:127], v61 offset:12544
ds_read_b64_tr_b16 a[196:197], v62 offset:12288
ds_read_b64_tr_b16 a[198:199], v62 offset:12544
s_waitcnt vmcnt(12)
ds_read_b64_tr_b16 a[56:57], v60 offset:16384
ds_read_b64_tr_b16 a[58:59], v60 offset:16640
ds_read_b64_tr_b16 a[128:129], v61 offset:16384
ds_read_b64_tr_b16 a[130:131], v61 offset:16640
ds_read_b64_tr_b16 a[200:201], v62 offset:16384
ds_read_b64_tr_b16 a[202:203], v62 offset:16640
s_waitcnt vmcnt(8)
ds_read_b64_tr_b16 a[60:61], v60 offset:20480
ds_read_b64_tr_b16 a[62:63], v60 offset:20736
ds_read_b64_tr_b16 a[132:133], v61 offset:20480
ds_read_b64_tr_b16 a[134:135], v61 offset:20736
ds_read_b64_tr_b16 a[204:205], v62 offset:20480
ds_read_b64_tr_b16 a[206:207], v62 offset:20736
s_waitcnt vmcnt(4)
ds_read_b64_tr_b16 a[64:65], v60 offset:24576
ds_read_b64_tr_b16 a[66:67], v60 offset:24832
ds_read_b64_tr_b16 a[136:137], v61 offset:24576
ds_read_b64_tr_b16 a[138:139], v61 offset:24832
ds_read_b64_tr_b16 a[208:209], v62 offset:24576
ds_read_b64_tr_b16 a[210:211], v62 offset:24832
s_waitcnt vmcnt(0)
ds_read_b64_tr_b16 a[68:69], v60 offset:28672
ds_read_b64_tr_b16 a[70:71], v60 offset:28928
ds_read_b64_tr_b16 a[140:141], v61 offset:28672
ds_read_b64_tr_b16 a[142:143], v61 offset:28928
ds_read_b64_tr_b16 a[212:213], v62 offset:28672
ds_read_b64_tr_b16 a[214:215], v62 offset:28928
s_waitcnt lgkmcnt(0)
v_lshrrev_b32 v1, 3, v0
v_bfe_u32 v2, v0, 1, 2
v_lshrrev_b32 v3, 5, v0
v_lshlrev_b32 v3, 1, v3
v_xor_b32 v2, v2, v3
v_mul_u32_u24 v1, 2304, v1
v_lshl_add_u32 v1, v2, 5, v1
v_and_b32 v2, 1, v0
v_lshl_add_u32 v1, v2, 4, v1
s_and_b32 s70, s3, 1
s_mul_i32 s70, s70, 18432
s_lshr_b32 s71, s3, 1
s_lshl_b32 s71, s71, 7
s_add_u32 s70, s70, s71
v_add_u32 v1, s70, v1
v_add_u32 v8, 4096, v1
v_add_u32 v9, 3328, v1
v_add_u32 v10, 2560, v1
v_add_u32 v11, 1792, v1
v_add_u32 v12, 5120, v1
v_add_u32 v13, 4352, v1
v_add_u32 v14, 3584, v1
v_add_u32 v15, 2816, v1
v_add_u32 v16, 6144, v1
v_bfe_u32 v1, v0, 1, 3
v_lshlrev_b32 v1, 7, v1
v_lshrrev_b32 v2, 4, v0
v_bfe_u32 v3, v0, 3, 1
v_lshlrev_b32 v3, 1, v3
v_xor_b32 v2, v2, v3
v_lshl_add_u32 v1, v2, 5, v1
v_and_b32 v2, 1, v0
v_lshl_add_u32 v17, v2, 4, v1
v_and_b32 v2, 31, v0
v_add_u32 v1, 0, v2
v_mul_u32_u24 v1, 128, v1
v_lshrrev_b32 v3, 5, v0
v_mul_u32_u24 v3, 32768, v3
v_add_u32 v1, 21504, v1
v_add_u32 v1, v1, v3
v_mov_b32 v3, 2147483632
s_cmp_eq_u32 s3, 0
s_cselect_b32 s71, 16, 0
v_cmp_gt_u32 vcc, s71, v2
s_nop 1
v_cndmask_b32 v22, v3, v1, vcc
s_mov_b32 s56, 0xffff
s_mul_i32 s70, s74, 128
s_add_u32 s70, s70, 23552
v_mov_b32 v1, s70
s_min_u32 s71, s71, 1
v_cmp_gt_u32 vcc, s71, v0
s_nop 1
v_cndmask_b32 v44, v3, v1, vcc
v_add_u32 v45, 65536, v44
s_getpc_b64 s[96:97]
pc_152:
s_add_u32 s96, s96, L_writers-pc_152
s_addc_u32 s97, s97, 0
v_subrev_u32 v23, 0, v22
v_lshrrev_b32 v23, 7, v23
v_cmp_gt_u32 vcc, 0x200, v23
s_nop 1
v_cndmask_b32 v23, 0, v23, vcc
global_load_ubyte v23, v23, s[96:97]
s_mov_b32 s44, 6062080
s_mov_b32 s45, 161521664
s_mov_b32 s52, 1
s_mov_b32 s53, 0
s_mov_b32 s46, 8421376
s_mov_b32 s47, 180396032
s_mov_b32 s54, 1
s_mov_b32 s55, 32768
s_mov_b32 s25, 200
s_mov_b32 s20, 36864
s_mov_b32 s21, 294912
s_mov_b32 s8, s42
s_and_b32 s9, s43, 0xffff
s_mov_b32 s10, 0
s_mov_b32 s11, 0x20000
s_mov_b32 s22, 0
s_mul_i32 s48, s3, 9216
s_add_u32 s49, s48, 36864
s_add_u32 s50, s48, 73728
s_add_u32 s51, s48, 110592
s_mov_b32 s57, 0xbfb8aa3b
v_add_u32 v28, 0, v17
v_add_u32 v29, 36864, v17
v_add_u32 v30, 73728, v17
v_add_u32 v31, 110592, v17
v_lshlrev_b32 v1, 2, v0
v_add_u32 v32, 147456, v1
s_lshl_b32 s70, s3, 8
v_add_u32 v18, s70, v32
v_mov_b64 v[224:225], 0
v_mov_b64 v[236:237], 0
v_mov_b64 v[226:227], 0
v_mov_b64 v[238:239], 0
v_mov_b64 v[228:229], 0
v_mov_b64 v[240:241], 0
v_mov_b64 v[230:231], 0
v_mov_b64 v[242:243], 0
s_mov_b32 s12, s40
s_and_b32 s13, s41, 0xffff
s_mov_b32 s14, 256
s_mov_b32 s15, 0x20000
v_lshlrev_b32 v26, 2, v0
v_add_u32 v27, 128, v26
v_cmp_le_u32 vcc, 2, v0
s_nop 1
v_cndmask_b32 v26, v26, v27, vcc
v_mov_b32 v27, 192
v_cmp_eq_u32 vcc, 8, v0
s_nop 1
v_cndmask_b32 v26, v26, v27, vcc
v_mov_b32 v27, 2147483632
v_cmp_lt_u32 vcc, 8, v0
s_nop 1
v_cndmask_b32 v26, v26, v27, vcc
s_mov_b32 s98, 0
wi_loop_158:
buffer_load_dword v27, v26, s[12:15], 0 offen sc1
s_add_u32 s98, s98, 1
s_cmp_gt_u32 s98, 150000
s_cbranch_scc1 wi_bad_160
s_waitcnt vmcnt(0)
v_cmp_eq_u32 vcc, 32, v27
s_nop 0
s_and_b32 s97, vcc_lo, 0x1ff
s_cmp_eq_u32 s97, 0x1ff
s_cbranch_scc1 wi_ok_159
v_cmp_lt_u32 vcc, 32, v27
s_nop 0
s_and_b32 s96, vcc_lo, 0xff
s_cselect_b32 s96, 0x100, 0
s_and_b32 s96, s96, s97
s_cbranch_scc1 wi_over_161
s_sleep 8
s_branch wi_loop_158
wi_bad_160:
s_mov_b32 s98, 512
s_branch L_fail
wi_over_161:
s_mov_b32 s100, 255
wi_ok_159:
v_add_u32 v26, 65536, v22
v_cmp_eq_u32 vcc, s100, v23
s_nop 1
v_cndmask_b32 v22, v22, v26, vcc
v_mov_b32 v26, 2147483632
s_cmp_lg_u32 s100, 255
s_cselect_b64 vcc, -1, 0
v_cndmask_b32 v44, v44, v26, vcc
s_cselect_b32 s38, 1, 0
s_mov_b32 s90, 0
s_mov_b32 s91, 1879048192
s_mov_b32 s93, 1879048192
v_mov_b32 v34, 2147483632
s_barrier
s_mov_b32 s95, 1
s_cmp_lg_u32 s3, 0
s_cbranch_scc1 sp_ok_163_j
s_mov_b32 s23, 0
sp_loop_162:
buffer_load_dword v33, v22, s[4:7], 0 offen sc1
s_add_u32 s23, s23, 1
s_cmp_gt_u32 s23, 150000
s_cbranch_scc1 sp_bad_164
s_waitcnt vmcnt(0)
sp_loop_162_e:
v_cmp_gt_u32 vcc, s52, v33
v_cmp_gt_u32 s[58:59], s54, v33
s_and_b32 vcc_lo, vcc_lo, s56
s_cbranch_scc0 sp_ok_163
s_cmp_gt_u32 s23, 4
s_cselect_b32 s70, 0, s56
s_cmp_lg_u32 s95, 0
s_cselect_b32 s70, 0, s70
s_or_b32 s59, s59, s70
s_and_b32 s59, s59, s56
s_cbranch_scc0 sp_ok_163
s_sleep 1
s_branch sp_loop_162
sp_bad_164:
s_mov_b32 s98, 1028
s_branch L_fail
sp_ok_163:
ds_write_b32 v18, v33
s_waitcnt lgkmcnt(0)
sp_ok_163_j:
s_barrier
ds_read_b32 v33, v32
s_waitcnt lgkmcnt(0)
v_cmp_gt_u32 vcc, s52, v33
v_cmp_gt_u32 s[58:59], s54, v33
s_and_b32 vcc_lo, vcc_lo, s56
s_cselect_b32 s70, 0, 1
s_and_b32 s59, s59, s56
s_cselect_b32 s71, 0, 1
s_or_b32 s76, s70, s71
s_cselect_b32 s10, 268435456, 0
s_cmp_lg_u32 s70, 0
s_cselect_b64 s[72:73], s[52:53], s[54:55]
s_cselect_b64 s[58:59], s[44:45], s[46:47]
s_mul_i32 s74, s72, s20
s_add_u32 s74, s74, s58
s_mul_i32 s75, s72, s21
s_add_u32 s75, s75, s59
s_andn2_b32 s71, s71, s70
s_add_u32 s52, s52, s70
s_add_u32 s54, s54, s71
s_mov_b32 s77, s76
s_add_u32 m0, s48, 0
s_nop 0
buffer_load_dwordx4 v8, s[4:7], s74 offen offset:0 sc1 lds
buffer_load_dwordx4 v9, s[4:7], s74 offen offset:1024 sc1 lds
buffer_load_dwordx4 v10, s[4:7], s74 offen offset:2048 sc1 lds
buffer_load_dwordx4 v11, s[4:7], s74 offen offset:3072 sc1 lds
s_add_u32 m0, s48, 4096
s_nop 0
buffer_load_dwordx4 v12, s[4:7], s74 offen offset:0 sc1 lds
buffer_load_dwordx4 v13, s[4:7], s74 offen offset:1024 sc1 lds
buffer_load_dwordx4 v14, s[4:7], s74 offen offset:2048 sc1 lds
buffer_load_dwordx4 v15, s[4:7], s74 offen offset:3072 sc1 lds
s_add_u32 m0, s48, 8192
s_nop 0
buffer_load_dwordx4 v16, s[4:7], s74 offen offset:0 sc1 lds
buffer_load_dword v24, v22, s[4:7], 0 offen sc1
buffer_store_dword v27, v34, s[4:7], 0 offen
v_mov_b32 v27, s90
s_waitcnt vmcnt(9)
s_barrier
buffer_store_dword v27, v45, s[4:7], s91 offen
buffer_store_dword v27, v44, s[4:7], s91 offen sc1
s_mov_b32 s91, 1879048192
ds_read_b128 v[64:67], v28 offset:0
ds_read_b128 v[68:71], v28 offset:9216
ds_read_b128 v[72:75], v28 offset:18432
ds_read_b128 v[76:79], v28 offset:27648
ds_read_b128 v[80:83], v28 offset:1024
ds_read_b128 v[84:87], v28 offset:10240
ds_read_b128 v[88:91], v28 offset:19456
ds_read_b128 v[92:95], v28 offset:28672
s_waitcnt vmcnt(7)
s_barrier
s_branch g_body_153
g_body_153:
s_waitcnt lgkmcnt(4)
v_mfma_f32_16x16x32_bf16 v[208:211], a[0:3], v[64:67], 0
ds_read_b128 v[96:99], v28 offset:2048
v_mfma_f32_16x16x32_bf16 v[212:215], a[0:3], v[68:71], 0
ds_read_b128 v[100:103], v28 offset:11264
v_mfma_f32_16x16x32_bf16 v[208:211], a[4:7], v[72:75], v[208:211]
ds_read_b128 v[104:107], v28 offset:20480
v_mfma_f32_16x16x32_bf16 v[212:215], a[4:7], v[76:79], v[212:215]
ds_read_b128 v[108:111], v28 offset:29696
v_mul_f32 v224, v224, v236
v_mfma_f32_16x16x32_bf16 v[216:219], a[72:75], v[64:67], 0
v_mul_f32 v225, v225, v237
s_waitcnt lgkmcnt(4)
v_mfma_f32_16x16x32_bf16 v[208:211], a[8:11], v[80:83], v[208:211]
ds_read_b128 v[112:115], v28 offset:3072
v_mul_f32 v226, v226, v238
v_mfma_f32_16x16x32_bf16 v[212:215], a[8:11], v[84:87], v[212:215]
ds_read_b128 v[116:119], v28 offset:12288
v_mul_f32 v227, v227, v239
v_mfma_f32_16x16x32_bf16 v[208:211], a[12:15], v[88:91], v[208:211]
ds_read_b128 v[120:123], v28 offset:21504
v_mul_f32 v228, v228, v240
v_mfma_f32_16x16x32_bf16 v[212:215], a[12:15], v[92:95], v[212:215]
ds_read_b128 v[124:127], v28 offset:30720
v_mul_f32 v229, v229, v241
v_mfma_f32_16x16x32_bf16 v[220:223], a[72:75], v[68:71], 0
v_mul_f32 v230, v230, v242
s_waitcnt lgkmcnt(4)
v_mfma_f32_16x16x32_bf16 v[208:211], a[16:19], v[96:99], v[208:211]
ds_read_b128 v[128:131], v28 offset:4096
v_mul_f32 v231, v231, v243
v_mfma_f32_16x16x32_bf16 v[212:215], a[16:19], v[100:103], v[212:215]
ds_read_b128 v[132:135], v28 offset:13312
v_cvt_pk_bf16_f32 v52, v224, v225
v_mfma_f32_16x16x32_bf16 v[208:211], a[20:23], v[104:107], v[208:211]
ds_read_b128 v[136:139], v28 offset:22528
v_cvt_pk_bf16_f32 v53, v226, v227
v_mfma_f32_16x16x32_bf16 v[212:215], a[20:23], v[108:111], v[212:215]
ds_read_b128 v[140:143], v28 offset:31744
v_cvt_pk_bf16_f32 v54, v228, v229
v_mfma_f32_16x16x32_bf16 v[216:219], a[76:79], v[72:75], v[216:219]
v_cvt_pk_bf16_f32 v55, v230, v231
s_waitcnt lgkmcnt(4)
v_mfma_f32_16x16x32_bf16 v[208:211], a[24:27], v[112:115], v[208:211]
ds_read_b128 v[144:147], v28 offset:5120
v_permlane16_swap_b32 v52, v54
v_mfma_f32_16x16x32_bf16 v[212:215], a[24:27], v[116:119], v[212:215]
ds_read_b128 v[148:151], v28 offset:14336
v_permlane16_swap_b32 v53, v55
v_mfma_f32_16x16x32_bf16 v[208:211], a[28:31], v[120:123], v[208:211]
ds_read_b128 v[152:155], v28 offset:23552
buffer_store_dwordx4 v[52:55], v20, s[4:7], s93 offen sc1
v_mfma_f32_16x16x32_bf16 v[212:215], a[28:31], v[124:127], v[212:215]
ds_read_b128 v[156:159], v28 offset:32768
v_mov_b32 v27, s90
v_mfma_f32_16x16x32_bf16 v[220:223], a[76:79], v[76:79], v[220:223]
s_waitcnt vmcnt(5)
s_barrier
s_waitcnt lgkmcnt(4)
v_mfma_f32_16x16x32_bf16 v[208:211], a[32:35], v[128:131], v[208:211]
ds_read_b128 v[160:163], v28 offset:6144
v_mfma_f32_16x16x32_bf16 v[212:215], a[32:35], v[132:135], v[212:215]
ds_read_b128 v[164:167], v28 offset:15360
v_mfma_f32_16x16x32_bf16 v[208:211], a[36:39], v[136:139], v[208:211]
ds_read_b128 v[168:171], v28 offset:24576
v_mfma_f32_16x16x32_bf16 v[212:215], a[36:39], v[140:143], v[212:215]
ds_read_b128 v[172:175], v28 offset:33792
v_mfma_f32_16x16x32_bf16 v[216:219], a[80:83], v[80:83], v[216:219]
s_waitcnt lgkmcnt(4)
v_mfma_f32_16x16x32_bf16 v[208:211], a[40:43], v[144:147], v[208:211]
ds_read_b128 v[176:179], v28 offset:7168
s_waitcnt vmcnt(4)
ds_write_b32 v18, v24
v_mfma_f32_16x16x32_bf16 v[212:215], a[40:43], v[148:151], v[212:215]
ds_read_b128 v[180:183], v28 offset:16384
v_mfma_f32_16x16x32_bf16 v[208:211], a[44:47], v[152:155], v[208:211]
ds_read_b128 v[184:187], v28 offset:25600
v_mfma_f32_16x16x32_bf16 v[212:215], a[44:47], v[156:159], v[212:215]
ds_read_b128 v[188:191], v28 offset:34816
s_waitcnt lgkmcnt(3)
s_barrier
v_mfma_f32_16x16x32_bf16 v[220:223], a[80:83], v[84:87], v[220:223]
ds_read_b32 v33, v32
v_mfma_f32_16x16x32_bf16 v[208:211], a[48:51], v[160:163], v[208:211]
ds_read_b128 v[192:195], v28 offset:8192
v_mfma_f32_16x16x32_bf16 v[212:215], a[48:51], v[164:167], v[212:215]
ds_read_b128 v[196:199], v28 offset:17408
v_mfma_f32_16x16x32_bf16 v[208:211], a[52:55], v[168:171], v[208:211]
ds_read_b128 v[200:203], v28 offset:26624
s_waitcnt lgkmcnt(3)
v_mfma_f32_16x16x32_bf16 v[212:215], a[52:55], v[172:175], v[212:215]
ds_read_b128 v[204:207], v28 offset:35840
v_cmp_gt_u32 vcc, s52, v33
v_mfma_f32_16x16x32_bf16 v[216:219], a[84:87], v[88:91], v[216:219]
v_cmp_gt_u32 s[58:59], s54, v33
v_mfma_f32_16x16x32_bf16 v[208:211], a[56:59], v[176:179], v[208:211]
s_and_b32 vcc_lo, vcc_lo, s56
s_cselect_b32 s70, 0, 1
s_and_b32 s59, s59, s56
s_cselect_b32 s71, 0, s77
v_mfma_f32_16x16x32_bf16 v[212:215], a[56:59], v[180:183], v[212:215]
s_or_b32 s82, s70, s71
s_cselect_b32 s10, 268435456, 0
v_mfma_f32_16x16x32_bf16 v[208:211], a[60:63], v[184:187], v[208:211]
s_cmp_lg_u32 s70, 0
s_cselect_b64 s[78:79], s[52:53], s[54:55]
s_cselect_b64 s[58:59], s[44:45], s[46:47]
v_mfma_f32_16x16x32_bf16 v[212:215], a[60:63], v[188:191], v[212:215]
s_mul_i32 s80, s78, s20
s_add_u32 s80, s80, s58
v_mfma_f32_16x16x32_bf16 v[220:223], a[84:87], v[92:95], v[220:223]
s_add_u32 m0, s49, 0
s_waitcnt lgkmcnt(0)
v_mfma_f32_16x16x32_bf16 v[208:211], a[64:67], v[192:195], v[208:211]
buffer_load_dwordx4 v8, s[8:11], s80 offen offset:0 sc1 lds
v_mfma_f32_16x16x32_bf16 v[212:215], a[64:67], v[196:199], v[212:215]
s_mul_i32 s81, s78, s21
s_add_u32 s81, s81, s59
s_andn2_b32 s71, s71, s70
v_mfma_f32_16x16x32_bf16 v[208:211], a[68:71], v[200:203], v[208:211]
s_add_u32 s52, s52, s70
s_add_u32 s54, s54, s71
s_mov_b32 s83, s82
v_mfma_f32_16x16x32_bf16 v[212:215], a[68:71], v[204:207], v[212:215]
buffer_load_dwordx4 v9, s[8:11], s80 offen offset:1024 sc1 lds
v_mfma_f32_16x16x32_bf16 v[216:219], a[88:91], v[96:99], v[216:219]
v_mfma_f32_16x16x32_bf16 v[220:223], a[88:91], v[100:103], v[220:223]
v_mfma_f32_16x16x32_bf16 v[216:219], a[92:95], v[104:107], v[216:219]
buffer_load_dwordx4 v10, s[8:11], s80 offen offset:2048 sc1 lds
v_mfma_f32_16x16x32_bf16 v[220:223], a[92:95], v[108:111], v[220:223]
v_mfma_f32_16x16x32_bf16 v[216:219], a[96:99], v[112:115], v[216:219]
v_mfma_f32_16x16x32_bf16 v[220:223], a[96:99], v[116:119], v[220:223]
buffer_load_dwordx4 v11, s[8:11], s80 offen offset:3072 sc1 lds
v_mfma_f32_16x16x32_bf16 v[216:219], a[100:103], v[120:123], v[216:219]
v_permlane32_swap_b32 v208, v212
v_mfma_f32_16x16x32_bf16 v[220:223], a[100:103], v[124:127], v[220:223]
s_add_u32 m0, s49, 4096
v_mfma_f32_16x16x32_bf16 v[216:219], a[104:107], v[128:131], v[216:219]
buffer_load_dwordx4 v12, s[8:11], s80 offen offset:0 sc1 lds
v_mfma_f32_16x16x32_bf16 v[220:223], a[104:107], v[132:135], v[220:223]
v_permlane32_swap_b32 v209, v213
v_mfma_f32_16x16x32_bf16 v[216:219], a[108:111], v[136:139], v[216:219]
v_permlane32_swap_b32 v210, v214
v_mfma_f32_16x16x32_bf16 v[220:223], a[108:111], v[140:143], v[220:223]
buffer_load_dwordx4 v13, s[8:11], s80 offen offset:1024 sc1 lds
v_mfma_f32_16x16x32_bf16 v[216:219], a[112:115], v[144:147], v[216:219]
v_permlane32_swap_b32 v211, v215
v_mfma_f32_16x16x32_bf16 v[220:223], a[112:115], v[148:151], v[220:223]
v_mul_f32 v232, s57, v208
v_mul_f32 v233, s57, v209
v_mfma_f32_16x16x32_bf16 v[216:219], a[116:119], v[152:155], v[216:219]
buffer_load_dwordx4 v14, s[8:11], s80 offen offset:2048 sc1 lds
v_mfma_f32_16x16x32_bf16 v[220:223], a[116:119], v[156:159], v[220:223]
v_mul_f32 v234, s57, v210
v_mul_f32 v235, s57, v211
v_mfma_f32_16x16x32_bf16 v[216:219], a[120:123], v[160:163], v[216:219]
v_exp_f32 v232, v232
v_mfma_f32_16x16x32_bf16 v[220:223], a[120:123], v[164:167], v[220:223]
buffer_load_dwordx4 v15, s[8:11], s80 offen offset:3072 sc1 lds
v_mfma_f32_16x16x32_bf16 v[216:219], a[124:127], v[168:171], v[216:219]
v_exp_f32 v233, v233
v_mfma_f32_16x16x32_bf16 v[220:223], a[124:127], v[172:175], v[220:223]
s_add_u32 m0, s49, 8192
v_mfma_f32_16x16x32_bf16 v[216:219], a[128:131], v[176:179], v[216:219]
buffer_load_dwordx4 v16, s[8:11], s80 offen offset:0 sc1 lds
v_mfma_f32_16x16x32_bf16 v[220:223], a[128:131], v[180:183], v[220:223]
v_exp_f32 v234, v234
v_mfma_f32_16x16x32_bf16 v[216:219], a[132:135], v[184:187], v[216:219]
v_exp_f32 v235, v235
v_mfma_f32_16x16x32_bf16 v[220:223], a[132:135], v[188:191], v[220:223]
v_add_f32 v232, 1.0, v232
v_add_f32 v233, 1.0, v233
v_mfma_f32_16x16x32_bf16 v[216:219], a[136:139], v[192:195], v[216:219]
v_add_f32 v234, 1.0, v234
v_add_f32 v235, 1.0, v235
v_mfma_f32_16x16x32_bf16 v[220:223], a[136:139], v[196:199], v[220:223]
v_rcp_f32 v232, v232
v_mfma_f32_16x16x32_bf16 v[216:219], a[140:143], v[200:203], v[216:219]
v_rcp_f32 v233, v233
v_mfma_f32_16x16x32_bf16 v[220:223], a[140:143], v[204:207], v[220:223]
v_rcp_f32 v234, v234
v_mfma_f32_16x16x32_bf16 v[224:227], a[144:147], v[64:67], 0
v_rcp_f32 v235, v235
v_mfma_f32_16x16x32_bf16 v[228:231], a[144:147], v[68:71], 0
v_mul_f32 v212, v208, v212
v_mul_f32 v213, v209, v213
v_mfma_f32_16x16x32_bf16 v[224:227], a[148:151], v[72:75], v[224:227]
v_mul_f32 v214, v210, v214
v_mul_f32 v215, v211, v215
v_mfma_f32_16x16x32_bf16 v[228:231], a[148:151], v[76:79], v[228:231]
v_mul_f32 v212, v212, v232
v_mul_f32 v213, v213, v233
v_mfma_f32_16x16x32_bf16 v[224:227], a[152:155], v[80:83], v[224:227]
buffer_load_dword v24, v22, s[4:7], 0 offen sc1
v_mfma_f32_16x16x32_bf16 v[228:231], a[152:155], v[84:87], v[228:231]
v_mul_f32 v214, v214, v234
v_mul_f32 v215, v215, v235
v_mul_f32 v236, s57, v216
v_mul_f32 v237, s57, v217
v_mul_f32 v238, s57, v218
v_mul_f32 v239, s57, v219
v_exp_f32 v236, v236
v_exp_f32 v237, v237
v_exp_f32 v238, v238
v_exp_f32 v239, v239
v_add_f32 v236, 1.0, v236
v_add_f32 v237, 1.0, v237
v_add_f32 v238, 1.0, v238
v_add_f32 v239, 1.0, v239
v_mfma_f32_16x16x32_bf16 v[224:227], a[156:159], v[88:91], v[224:227]
s_waitcnt vmcnt(10)
s_barrier
v_mfma_f32_16x16x32_bf16 v[228:231], a[156:159], v[92:95], v[228:231]
buffer_store_dword v27, v45, s[4:7], s91 offen
v_mfma_f32_16x16x32_bf16 v[224:227], a[160:163], v[96:99], v[224:227]
buffer_store_dword v27, v44, s[4:7], s91 offen sc1
v_mfma_f32_16x16x32_bf16 v[228:231], a[160:163], v[100:103], v[228:231]
v_cvt_pk_bf16_f32 v48, v212, v213
v_cvt_pk_bf16_f32 v49, v214, v215
v_mfma_f32_16x16x32_bf16 v[224:227], a[164:167], v[104:107], v[224:227]
buffer_store_dwordx2 v[48:49], v19, s[4:7], s75 offen sc1
v_mfma_f32_16x16x32_bf16 v[228:231], a[164:167], v[108:111], v[228:231]
v_rcp_f32 v236, v236
v_mfma_f32_16x16x32_bf16 v[224:227], a[168:171], v[112:115], v[224:227]
v_rcp_f32 v237, v237
v_mfma_f32_16x16x32_bf16 v[228:231], a[168:171], v[116:119], v[228:231]
v_rcp_f32 v238, v238
v_mfma_f32_16x16x32_bf16 v[224:227], a[172:175], v[120:123], v[224:227]
v_rcp_f32 v239, v239
v_mfma_f32_16x16x32_bf16 v[228:231], a[172:175], v[124:127], v[228:231]
v_mul_f32 v240, s57, v220
v_mul_f32 v241, s57, v221
v_mfma_f32_16x16x32_bf16 v[224:227], a[176:179], v[128:131], v[224:227]
v_mul_f32 v242, s57, v222
v_mul_f32 v243, s57, v223
v_mfma_f32_16x16x32_bf16 v[228:231], a[176:179], v[132:135], v[228:231]
v_mul_f32 v236, v216, v236
v_mul_f32 v237, v217, v237
v_mfma_f32_16x16x32_bf16 v[224:227], a[180:183], v[136:139], v[224:227]
v_mul_f32 v238, v218, v238
v_mul_f32 v239, v219, v239
v_mfma_f32_16x16x32_bf16 v[228:231], a[180:183], v[140:143], v[228:231]
v_exp_f32 v240, v240
v_mfma_f32_16x16x32_bf16 v[224:227], a[184:187], v[144:147], v[224:227]
v_exp_f32 v241, v241
v_mfma_f32_16x16x32_bf16 v[228:231], a[184:187], v[148:151], v[228:231]
v_exp_f32 v242, v242
v_mfma_f32_16x16x32_bf16 v[224:227], a[188:191], v[152:155], v[224:227]
v_exp_f32 v243, v243
v_mfma_f32_16x16x32_bf16 v[228:231], a[188:191], v[156:159], v[228:231]
v_add_f32 v240, 1.0, v240
v_add_f32 v241, 1.0, v241
v_mfma_f32_16x16x32_bf16 v[224:227], a[192:195], v[160:163], v[224:227]
s_waitcnt vmcnt(11)
s_barrier
v_mfma_f32_16x16x32_bf16 v[228:231], a[192:195], v[164:167], v[228:231]
v_add_f32 v242, 1.0, v242
v_add_f32 v243, 1.0, v243
v_mfma_f32_16x16x32_bf16 v[224:227], a[196:199], v[168:171], v[224:227]
s_cmp_eq_u32 s82, 0
s_cbranch_scc1 g_slow_165
v_mfma_f32_16x16x32_bf16 v[228:231], a[196:199], v[172:175], v[228:231]
v_rcp_f32 v240, v240
ds_read_b128 v[64:67], v29 offset:0
v_mfma_f32_16x16x32_bf16 v[224:227], a[200:203], v[176:179], v[224:227]
v_rcp_f32 v241, v241
ds_read_b128 v[68:71], v29 offset:9216
v_mfma_f32_16x16x32_bf16 v[228:231], a[200:203], v[180:183], v[228:231]
v_rcp_f32 v242, v242
ds_read_b128 v[72:75], v29 offset:18432
v_mfma_f32_16x16x32_bf16 v[224:227], a[204:207], v[184:187], v[224:227]
v_rcp_f32 v243, v243
ds_read_b128 v[76:79], v29 offset:27648
v_mfma_f32_16x16x32_bf16 v[228:231], a[204:207], v[188:191], v[228:231]
v_mul_f32 v240, v220, v240
ds_read_b128 v[80:83], v29 offset:1024
v_mfma_f32_16x16x32_bf16 v[224:227], a[208:211], v[192:195], v[224:227]
v_mul_f32 v241, v221, v241
ds_read_b128 v[84:87], v29 offset:10240
v_mfma_f32_16x16x32_bf16 v[228:231], a[208:211], v[196:199], v[228:231]
v_mul_f32 v242, v222, v242
ds_read_b128 v[88:91], v29 offset:19456
v_mfma_f32_16x16x32_bf16 v[224:227], a[212:215], v[200:203], v[224:227]
v_mul_f32 v243, v223, v243
ds_read_b128 v[92:95], v29 offset:28672
v_mfma_f32_16x16x32_bf16 v[228:231], a[212:215], v[204:207], v[228:231]
s_waitcnt vmcnt(7)
s_barrier
g_body_154:
s_waitcnt lgkmcnt(4)
v_mfma_f32_16x16x32_bf16 v[208:211], a[0:3], v[64:67], 0
ds_read_b128 v[96:99], v29 offset:2048
v_mfma_f32_16x16x32_bf16 v[212:215], a[0:3], v[68:71], 0
ds_read_b128 v[100:103], v29 offset:11264
v_mfma_f32_16x16x32_bf16 v[208:211], a[4:7], v[72:75], v[208:211]
ds_read_b128 v[104:107], v29 offset:20480
v_mfma_f32_16x16x32_bf16 v[212:215], a[4:7], v[76:79], v[212:215]
ds_read_b128 v[108:111], v29 offset:29696
v_mul_f32 v224, v224, v236
v_mfma_f32_16x16x32_bf16 v[216:219], a[72:75], v[64:67], 0
v_mul_f32 v225, v225, v237
s_waitcnt lgkmcnt(4)
v_mfma_f32_16x16x32_bf16 v[208:211], a[8:11], v[80:83], v[208:211]
ds_read_b128 v[112:115], v29 offset:3072
v_mul_f32 v226, v226, v238
v_mfma_f32_16x16x32_bf16 v[212:215], a[8:11], v[84:87], v[212:215]
ds_read_b128 v[116:119], v29 offset:12288
v_mul_f32 v227, v227, v239
v_mfma_f32_16x16x32_bf16 v[208:211], a[12:15], v[88:91], v[208:211]
ds_read_b128 v[120:123], v29 offset:21504
v_mul_f32 v228, v228, v240
v_mfma_f32_16x16x32_bf16 v[212:215], a[12:15], v[92:95], v[212:215]
ds_read_b128 v[124:127], v29 offset:30720
v_mul_f32 v229, v229, v241
v_mfma_f32_16x16x32_bf16 v[220:223], a[72:75], v[68:71], 0
v_mul_f32 v230, v230, v242
s_waitcnt lgkmcnt(4)
v_mfma_f32_16x16x32_bf16 v[208:211], a[16:19], v[96:99], v[208:211]
ds_read_b128 v[128:131], v29 offset:4096
v_mul_f32 v231, v231, v243
v_mfma_f32_16x16x32_bf16 v[212:215], a[16:19], v[100:103], v[212:215]
ds_read_b128 v[132:135], v29 offset:13312
v_cvt_pk_bf16_f32 v52, v224, v225
v_mfma_f32_16x16x32_bf16 v[208:211], a[20:23], v[104:107], v[208:211]
ds_read_b128 v[136:139], v29 offset:22528
v_cvt_pk_bf16_f32 v53, v226, v227
v_mfma_f32_16x16x32_bf16 v[212:215], a[20:23], v[108:111], v[212:215]
ds_read_b128 v[140:143], v29 offset:31744
v_cvt_pk_bf16_f32 v54, v228, v229
v_mfma_f32_16x16x32_bf16 v[216:219], a[76:79], v[72:75], v[216:219]
v_cvt_pk_bf16_f32 v55, v230, v231
s_waitcnt lgkmcnt(4)
v_mfma_f32_16x16x32_bf16 v[208:211], a[24:27], v[112:115], v[208:211]
ds_read_b128 v[144:147], v29 offset:5120
v_permlane16_swap_b32 v52, v54
v_mfma_f32_16x16x32_bf16 v[212:215], a[24:27], v[116:119], v[212:215]
ds_read_b128 v[148:151], v29 offset:14336
v_permlane16_swap_b32 v53, v55
v_mfma_f32_16x16x32_bf16 v[208:211], a[28:31], v[120:123], v[208:211]
ds_read_b128 v[152:155], v29 offset:23552
buffer_store_dwordx4 v[52:55], v20, s[4:7], s75 offen sc1
v_mfma_f32_16x16x32_bf16 v[212:215], a[28:31], v[124:127], v[212:215]
ds_read_b128 v[156:159], v29 offset:32768
v_mov_b32 v27, s72
v_mfma_f32_16x16x32_bf16 v[220:223], a[76:79], v[76:79], v[220:223]
s_waitcnt vmcnt(5)
s_barrier
s_waitcnt lgkmcnt(4)
v_mfma_f32_16x16x32_bf16 v[208:211], a[32:35], v[128:131], v[208:211]
ds_read_b128 v[160:163], v29 offset:6144
v_mfma_f32_16x16x32_bf16 v[212:215], a[32:35], v[132:135], v[212:215]
ds_read_b128 v[164:167], v29 offset:15360
v_mfma_f32_16x16x32_bf16 v[208:211], a[36:39], v[136:139], v[208:211]
ds_read_b128 v[168:171], v29 offset:24576
v_mfma_f32_16x16x32_bf16 v[212:215], a[36:39], v[140:143], v[212:215]
ds_read_b128 v[172:175], v29 offset:33792
v_mfma_f32_16x16x32_bf16 v[216:219], a[80:83], v[80:83], v[216:219]
s_waitcnt lgkmcnt(4)
v_mfma_f32_16x16x32_bf16 v[208:211], a[40:43], v[144:147], v[208:211]
ds_read_b128 v[176:179], v29 offset:7168
s_waitcnt vmcnt(4)
ds_write_b32 v18, v24
v_mfma_f32_16x16x32_bf16 v[212:215], a[40:43], v[148:151], v[212:215]
ds_read_b128 v[180:183], v29 offset:16384
v_mfma_f32_16x16x32_bf16 v[208:211], a[44:47], v[152:155], v[208:211]
ds_read_b128 v[184:187], v29 offset:25600
v_mfma_f32_16x16x32_bf16 v[212:215], a[44:47], v[156:159], v[212:215]
ds_read_b128 v[188:191], v29 offset:34816
s_waitcnt lgkmcnt(3)
s_barrier
v_mfma_f32_16x16x32_bf16 v[220:223], a[80:83], v[84:87], v[220:223]
ds_read_b32 v33, v32
v_mfma_f32_16x16x32_bf16 v[208:211], a[48:51], v[160:163], v[208:211]
ds_read_b128 v[192:195], v29 offset:8192
v_mfma_f32_16x16x32_bf16 v[212:215], a[48:51], v[164:167], v[212:215]
ds_read_b128 v[196:199], v29 offset:17408
v_mfma_f32_16x16x32_bf16 v[208:211], a[52:55], v[168:171], v[208:211]
ds_read_b128 v[200:203], v29 offset:26624
s_waitcnt lgkmcnt(3)
v_mfma_f32_16x16x32_bf16 v[212:215], a[52:55], v[172:175], v[212:215]
ds_read_b128 v[204:207], v29 offset:35840
v_cmp_gt_u32 vcc, s52, v33
v_mfma_f32_16x16x32_bf16 v[216:219], a[84:87], v[88:91], v[216:219]
v_cmp_gt_u32 s[58:59], s54, v33
v_mfma_f32_16x16x32_bf16 v[208:211], a[56:59], v[176:179], v[208:211]
s_and_b32 vcc_lo, vcc_lo, s56
s_cselect_b32 s70, 0, 1
s_and_b32 s59, s59, s56
s_cselect_b32 s71, 0, s83
v_mfma_f32_16x16x32_bf16 v[212:215], a[56:59], v[180:183], v[212:215]
s_or_b32 s88, s70, s71
s_cselect_b32 s10, 268435456, 0
v_mfma_f32_16x16x32_bf16 v[208:211], a[60:63], v[184:187], v[208:211]
s_cmp_lg_u32 s70, 0
s_cselect_b64 s[84:85], s[52:53], s[54:55]
s_cselect_b64 s[58:59], s[44:45], s[46:47]
v_mfma_f32_16x16x32_bf16 v[212:215], a[60:63], v[188:191], v[212:215]
s_mul_i32 s86, s84, s20
s_add_u32 s86, s86, s58
v_mfma_f32_16x16x32_bf16 v[220:223], a[84:87], v[92:95], v[220:223]
s_add_u32 m0, s50, 0
s_waitcnt lgkmcnt(0)
v_mfma_f32_16x16x32_bf16 v[208:211], a[64:67], v[192:195], v[208:211]
buffer_load_dwordx4 v8, s[8:11], s86 offen offset:0 sc1 lds
v_mfma_f32_16x16x32_bf16 v[212:215], a[64:67], v[196:199], v[212:215]
s_mul_i32 s87, s84, s21
s_add_u32 s87, s87, s59
s_andn2_b32 s71, s71, s70
v_mfma_f32_16x16x32_bf16 v[208:211], a[68:71], v[200:203], v[208:211]
s_add_u32 s52, s52, s70
s_add_u32 s54, s54, s71
s_mov_b32 s89, s88
v_mfma_f32_16x16x32_bf16 v[212:215], a[68:71], v[204:207], v[212:215]
buffer_load_dwordx4 v9, s[8:11], s86 offen offset:1024 sc1 lds
v_mfma_f32_16x16x32_bf16 v[216:219], a[88:91], v[96:99], v[216:219]
v_mfma_f32_16x16x32_bf16 v[220:223], a[88:91], v[100:103], v[220:223]
v_mfma_f32_16x16x32_bf16 v[216:219], a[92:95], v[104:107], v[216:219]
buffer_load_dwordx4 v10, s[8:11], s86 offen offset:2048 sc1 lds
v_mfma_f32_16x16x32_bf16 v[220:223], a[92:95], v[108:111], v[220:223]
v_mfma_f32_16x16x32_bf16 v[216:219], a[96:99], v[112:115], v[216:219]
v_mfma_f32_16x16x32_bf16 v[220:223], a[96:99], v[116:119], v[220:223]
buffer_load_dwordx4 v11, s[8:11], s86 offen offset:3072 sc1 lds
v_mfma_f32_16x16x32_bf16 v[216:219], a[100:103], v[120:123], v[216:219]
v_permlane32_swap_b32 v208, v212
v_mfma_f32_16x16x32_bf16 v[220:223], a[100:103], v[124:127], v[220:223]
s_add_u32 m0, s50, 4096
v_mfma_f32_16x16x32_bf16 v[216:219], a[104:107], v[128:131], v[216:219]
buffer_load_dwordx4 v12, s[8:11], s86 offen offset:0 sc1 lds
v_mfma_f32_16x16x32_bf16 v[220:223], a[104:107], v[132:135], v[220:223]
v_permlane32_swap_b32 v209, v213
v_mfma_f32_16x16x32_bf16 v[216:219], a[108:111], v[136:139], v[216:219]
v_permlane32_swap_b32 v210, v214
v_mfma_f32_16x16x32_bf16 v[220:223], a[108:111], v[140:143], v[220:223]
buffer_load_dwordx4 v13, s[8:11], s86 offen offset:1024 sc1 lds
v_mfma_f32_16x16x32_bf16 v[216:219], a[112:115], v[144:147], v[216:219]
v_permlane32_swap_b32 v211, v215
v_mfma_f32_16x16x32_bf16 v[220:223], a[112:115], v[148:151], v[220:223]
v_mul_f32 v232, s57, v208
v_mul_f32 v233, s57, v209
v_mfma_f32_16x16x32_bf16 v[216:219], a[116:119], v[152:155], v[216:219]
buffer_load_dwordx4 v14, s[8:11], s86 offen offset:2048 sc1 lds
v_mfma_f32_16x16x32_bf16 v[220:223], a[116:119], v[156:159], v[220:223]
v_mul_f32 v234, s57, v210
v_mul_f32 v235, s57, v211
v_mfma_f32_16x16x32_bf16 v[216:219], a[120:123], v[160:163], v[216:219]
v_exp_f32 v232, v232
v_mfma_f32_16x16x32_bf16 v[220:223], a[120:123], v[164:167], v[220:223]
buffer_load_dwordx4 v15, s[8:11], s86 offen offset:3072 sc1 lds
v_mfma_f32_16x16x32_bf16 v[216:219], a[124:127], v[168:171], v[216:219]
v_exp_f32 v233, v233
v_mfma_f32_16x16x32_bf16 v[220:223], a[124:127], v[172:175], v[220:223]
s_add_u32 m0, s50, 8192
v_mfma_f32_16x16x32_bf16 v[216:219], a[128:131], v[176:179], v[216:219]
buffer_load_dwordx4 v16, s[8:11], s86 offen offset:0 sc1 lds
v_mfma_f32_16x16x32_bf16 v[220:223], a[128:131], v[180:183], v[220:223]
v_exp_f32 v234, v234
v_mfma_f32_16x16x32_bf16 v[216:219], a[132:135], v[184:187], v[216:219]
v_exp_f32 v235, v235
v_mfma_f32_16x16x32_bf16 v[220:223], a[132:135], v[188:191], v[220:223]
v_add_f32 v232, 1.0, v232
v_add_f32 v233, 1.0, v233
v_mfma_f32_16x16x32_bf16 v[216:219], a[136:139], v[192:195], v[216:219]
v_add_f32 v234, 1.0, v234
v_add_f32 v235, 1.0, v235
v_mfma_f32_16x16x32_bf16 v[220:223], a[136:139], v[196:199], v[220:223]
v_rcp_f32 v232, v232
v_mfma_f32_16x16x32_bf16 v[216:219], a[140:143], v[200:203], v[216:219]
v_rcp_f32 v233, v233
v_mfma_f32_16x16x32_bf16 v[220:223], a[140:143], v[204:207], v[220:223]
v_rcp_f32 v234, v234
v_mfma_f32_16x16x32_bf16 v[224:227], a[144:147], v[64:67], 0
v_rcp_f32 v235, v235
v_mfma_f32_16x16x32_bf16 v[228:231], a[144:147], v[68:71], 0
v_mul_f32 v212, v208, v212
v_mul_f32 v213, v209, v213
v_mfma_f32_16x16x32_bf16 v[224:227], a[148:151], v[72:75], v[224:227]
v_mul_f32 v214, v210, v214
v_mul_f32 v215, v211, v215
v_mfma_f32_16x16x32_bf16 v[228:231], a[148:151], v[76:79], v[228:231]
v_mul_f32 v212, v212, v232
v_mul_f32 v213, v213, v233
v_mfma_f32_16x16x32_bf16 v[224:227], a[152:155], v[80:83], v[224:227]
buffer_load_dword v24, v22, s[4:7], 0 offen sc1
v_mfma_f32_16x16x32_bf16 v[228:231], a[152:155], v[84:87], v[228:231]
v_mul_f32 v214, v214, v234
v_mul_f32 v215, v215, v235
v_mul_f32 v236, s57, v216
v_mul_f32 v237, s57, v217
v_mul_f32 v238, s57, v218
v_mul_f32 v239, s57, v219
v_exp_f32 v236, v236
v_exp_f32 v237, v237
v_exp_f32 v238, v238
v_exp_f32 v239, v239
v_add_f32 v236, 1.0, v236
v_add_f32 v237, 1.0, v237
v_add_f32 v238, 1.0, v238
v_add_f32 v239, 1.0, v239
v_mfma_f32_16x16x32_bf16 v[224:227], a[156:159], v[88:91], v[224:227]
s_waitcnt vmcnt(10)
s_barrier
v_mfma_f32_16x16x32_bf16 v[228:231], a[156:159], v[92:95], v[228:231]
buffer_store_dword v27, v45, s[4:7], s73 offen
v_mfma_f32_16x16x32_bf16 v[224:227], a[160:163], v[96:99], v[224:227]
buffer_store_dword v27, v44, s[4:7], s73 offen sc1
v_mfma_f32_16x16x32_bf16 v[228:231], a[160:163], v[100:103], v[228:231]
v_cvt_pk_bf16_f32 v48, v212, v213
v_cvt_pk_bf16_f32 v49, v214, v215
v_mfma_f32_16x16x32_bf16 v[224:227], a[164:167], v[104:107], v[224:227]
buffer_store_dwordx2 v[48:49], v19, s[4:7], s81 offen sc1
v_mfma_f32_16x16x32_bf16 v[228:231], a[164:167], v[108:111], v[228:231]
v_rcp_f32 v236, v236
v_mfma_f32_16x16x32_bf16 v[224:227], a[168:171], v[112:115], v[224:227]
v_rcp_f32 v237, v237
v_mfma_f32_16x16x32_bf16 v[228:231], a[168:171], v[116:119], v[228:231]
v_rcp_f32 v238, v238
v_mfma_f32_16x16x32_bf16 v[224:227], a[172:175], v[120:123], v[224:227]
v_rcp_f32 v239, v239
v_mfma_f32_16x16x32_bf16 v[228:231], a[172:175], v[124:127], v[228:231]
v_mul_f32 v240, s57, v220
v_mul_f32 v241, s57, v221
v_mfma_f32_16x16x32_bf16 v[224:227], a[176:179], v[128:131], v[224:227]
v_mul_f32 v242, s57, v222
v_mul_f32 v243, s57, v223
v_mfma_f32_16x16x32_bf16 v[228:231], a[176:179], v[132:135], v[228:231]
v_mul_f32 v236, v216, v236
v_mul_f32 v237, v217, v237
v_mfma_f32_16x16x32_bf16 v[224:227], a[180:183], v[136:139], v[224:227]
v_mul_f32 v238, v218, v238
v_mul_f32 v239, v219, v239
v_mfma_f32_16x16x32_bf16 v[228:231], a[180:183], v[140:143], v[228:231]
v_exp_f32 v240, v240
v_mfma_f32_16x16x32_bf16 v[224:227], a[184:187], v[144:147], v[224:227]
v_exp_f32 v241, v241
v_mfma_f32_16x16x32_bf16 v[228:231], a[184:187], v[148:151], v[228:231]
v_exp_f32 v242, v242
v_mfma_f32_16x16x32_bf16 v[224:227], a[188:191], v[152:155], v[224:227]
v_exp_f32 v243, v243
v_mfma_f32_16x16x32_bf16 v[228:231], a[188:191], v[156:159], v[228:231]
v_add_f32 v240, 1.0, v240
v_add_f32 v241, 1.0, v241
v_mfma_f32_16x16x32_bf16 v[224:227], a[192:195], v[160:163], v[224:227]
s_waitcnt vmcnt(11)
s_barrier
v_mfma_f32_16x16x32_bf16 v[228:231], a[192:195], v[164:167], v[228:231]
v_add_f32 v242, 1.0, v242
v_add_f32 v243, 1.0, v243
v_mfma_f32_16x16x32_bf16 v[224:227], a[196:199], v[168:171], v[224:227]
s_cmp_eq_u32 s88, 0
s_cbranch_scc1 g_slow_166
v_mfma_f32_16x16x32_bf16 v[228:231], a[196:199], v[172:175], v[228:231]
v_rcp_f32 v240, v240
ds_read_b128 v[64:67], v30 offset:0
v_mfma_f32_16x16x32_bf16 v[224:227], a[200:203], v[176:179], v[224:227]
v_rcp_f32 v241, v241
ds_read_b128 v[68:71], v30 offset:9216
v_mfma_f32_16x16x32_bf16 v[228:231], a[200:203], v[180:183], v[228:231]
v_rcp_f32 v242, v242
ds_read_b128 v[72:75], v30 offset:18432
v_mfma_f32_16x16x32_bf16 v[224:227], a[204:207], v[184:187], v[224:227]
v_rcp_f32 v243, v243
ds_read_b128 v[76:79], v30 offset:27648
v_mfma_f32_16x16x32_bf16 v[228:231], a[204:207], v[188:191], v[228:231]
v_mul_f32 v240, v220, v240
ds_read_b128 v[80:83], v30 offset:1024
v_mfma_f32_16x16x32_bf16 v[224:227], a[208:211], v[192:195], v[224:227]
v_mul_f32 v241, v221, v241
ds_read_b128 v[84:87], v30 offset:10240
v_mfma_f32_16x16x32_bf16 v[228:231], a[208:211], v[196:199], v[228:231]
v_mul_f32 v242, v222, v242
ds_read_b128 v[88:91], v30 offset:19456
v_mfma_f32_16x16x32_bf16 v[224:227], a[212:215], v[200:203], v[224:227]
v_mul_f32 v243, v223, v243
ds_read_b128 v[92:95], v30 offset:28672
v_mfma_f32_16x16x32_bf16 v[228:231], a[212:215], v[204:207], v[228:231]
s_waitcnt vmcnt(7)
s_barrier
g_body_155:
s_waitcnt lgkmcnt(4)
v_mfma_f32_16x16x32_bf16 v[208:211], a[0:3], v[64:67], 0
ds_read_b128 v[96:99], v30 offset:2048
v_mfma_f32_16x16x32_bf16 v[212:215], a[0:3], v[68:71], 0
ds_read_b128 v[100:103], v30 offset:11264
v_mfma_f32_16x16x32_bf16 v[208:211], a[4:7], v[72:75], v[208:211]
ds_read_b128 v[104:107], v30 offset:20480
v_mfma_f32_16x16x32_bf16 v[212:215], a[4:7], v[76:79], v[212:215]
ds_read_b128 v[108:111], v30 offset:29696
v_mul_f32 v224, v224, v236
v_mfma_f32_16x16x32_bf16 v[216:219], a[72:75], v[64:67], 0
v_mul_f32 v225, v225, v237
s_waitcnt lgkmcnt(4)
v_mfma_f32_16x16x32_bf16 v[208:211], a[8:11], v[80:83], v[208:211]
ds_read_b128 v[112:115], v30 offset:3072
v_mul_f32 v226, v226, v238
v_mfma_f32_16x16x32_bf16 v[212:215], a[8:11], v[84:87], v[212:215]
ds_read_b128 v[116:119], v30 offset:12288
v_mul_f32 v227, v227, v239
v_mfma_f32_16x16x32_bf16 v[208:211], a[12:15], v[88:91], v[208:211]
ds_read_b128 v[120:123], v30 offset:21504
v_mul_f32 v228, v228, v240
v_mfma_f32_16x16x32_bf16 v[212:215], a[12:15], v[92:95], v[212:215]
ds_read_b128 v[124:127], v30 offset:30720
v_mul_f32 v229, v229, v241
v_mfma_f32_16x16x32_bf16 v[220:223], a[72:75], v[68:71], 0
v_mul_f32 v230, v230, v242
s_waitcnt lgkmcnt(4)
v_mfma_f32_16x16x32_bf16 v[208:211], a[16:19], v[96:99], v[208:211]
ds_read_b128 v[128:131], v30 offset:4096
v_mul_f32 v231, v231, v243
v_mfma_f32_16x16x32_bf16 v[212:215], a[16:19], v[100:103], v[212:215]
ds_read_b128 v[132:135], v30 offset:13312
v_cvt_pk_bf16_f32 v52, v224, v225
v_mfma_f32_16x16x32_bf16 v[208:211], a[20:23], v[104:107], v[208:211]
ds_read_b128 v[136:139], v30 offset:22528
v_cvt_pk_bf16_f32 v53, v226, v227
v_mfma_f32_16x16x32_bf16 v[212:215], a[20:23], v[108:111], v[212:215]
ds_read_b128 v[140:143], v30 offset:31744
v_cvt_pk_bf16_f32 v54, v228, v229
v_mfma_f32_16x16x32_bf16 v[216:219], a[76:79], v[72:75], v[216:219]
v_cvt_pk_bf16_f32 v55, v230, v231
s_waitcnt lgkmcnt(4)
v_mfma_f32_16x16x32_bf16 v[208:211], a[24:27], v[112:115], v[208:211]
ds_read_b128 v[144:147], v30 offset:5120
v_permlane16_swap_b32 v52, v54
v_mfma_f32_16x16x32_bf16 v[212:215], a[24:27], v[116:119], v[212:215]
ds_read_b128 v[148:151], v30 offset:14336
v_permlane16_swap_b32 v53, v55
v_mfma_f32_16x16x32_bf16 v[208:211], a[28:31], v[120:123], v[208:211]
ds_read_b128 v[152:155], v30 offset:23552
buffer_store_dwordx4 v[52:55], v20, s[4:7], s81 offen sc1
v_mfma_f32_16x16x32_bf16 v[212:215], a[28:31], v[124:127], v[212:215]
ds_read_b128 v[156:159], v30 offset:32768
v_mov_b32 v27, s78
v_mfma_f32_16x16x32_bf16 v[220:223], a[76:79], v[76:79], v[220:223]
s_waitcnt vmcnt(5)
s_barrier
s_waitcnt lgkmcnt(4)
v_mfma_f32_16x16x32_bf16 v[208:211], a[32:35], v[128:131], v[208:211]
ds_read_b128 v[160:163], v30 offset:6144
v_mfma_f32_16x16x32_bf16 v[212:215], a[32:35], v[132:135], v[212:215]
ds_read_b128 v[164:167], v30 offset:15360
v_mfma_f32_16x16x32_bf16 v[208:211], a[36:39], v[136:139], v[208:211]
ds_read_b128 v[168:171], v30 offset:24576
v_mfma_f32_16x16x32_bf16 v[212:215], a[36:39], v[140:143], v[212:215]
ds_read_b128 v[172:175], v30 offset:33792
v_mfma_f32_16x16x32_bf16 v[216:219], a[80:83], v[80:83], v[216:219]
s_waitcnt lgkmcnt(4)
v_mfma_f32_16x16x32_bf16 v[208:211], a[40:43], v[144:147], v[208:211]
ds_read_b128 v[176:179], v30 offset:7168
s_waitcnt vmcnt(4)
ds_write_b32 v18, v24
v_mfma_f32_16x16x32_bf16 v[212:215], a[40:43], v[148:151], v[212:215]
ds_read_b128 v[180:183], v30 offset:16384
v_mfma_f32_16x16x32_bf16 v[208:211], a[44:47], v[152:155], v[208:211]
ds_read_b128 v[184:187], v30 offset:25600
v_mfma_f32_16x16x32_bf16 v[212:215], a[44:47], v[156:159], v[212:215]
ds_read_b128 v[188:191], v30 offset:34816
s_waitcnt lgkmcnt(3)
s_barrier
v_mfma_f32_16x16x32_bf16 v[220:223], a[80:83], v[84:87], v[220:223]
ds_read_b32 v33, v32
v_mfma_f32_16x16x32_bf16 v[208:211], a[48:51], v[160:163], v[208:211]
ds_read_b128 v[192:195], v30 offset:8192
v_mfma_f32_16x16x32_bf16 v[212:215], a[48:51], v[164:167], v[212:215]
ds_read_b128 v[196:199], v30 offset:17408
v_mfma_f32_16x16x32_bf16 v[208:211], a[52:55], v[168:171], v[208:211]
ds_read_b128 v[200:203], v30 offset:26624
s_waitcnt lgkmcnt(3)
v_mfma_f32_16x16x32_bf16 v[212:215], a[52:55], v[172:175], v[212:215]
ds_read_b128 v[204:207], v30 offset:35840
v_cmp_gt_u32 vcc, s52, v33
v_mfma_f32_16x16x32_bf16 v[216:219], a[84:87], v[88:91], v[216:219]
v_cmp_gt_u32 s[58:59], s54, v33
v_mfma_f32_16x16x32_bf16 v[208:211], a[56:59], v[176:179], v[208:211]
s_and_b32 vcc_lo, vcc_lo, s56
s_cselect_b32 s70, 0, 1
s_and_b32 s59, s59, s56
s_cselect_b32 s71, 0, s89
v_mfma_f32_16x16x32_bf16 v[212:215], a[56:59], v[180:183], v[212:215]
s_or_b32 s94, s70, s71
s_cselect_b32 s10, 268435456, 0
v_mfma_f32_16x16x32_bf16 v[208:211], a[60:63], v[184:187], v[208:211]
s_cmp_lg_u32 s70, 0
s_cselect_b64 s[90:91], s[52:53], s[54:55]
s_cselect_b64 s[58:59], s[44:45], s[46:47]
v_mfma_f32_16x16x32_bf16 v[212:215], a[60:63], v[188:191], v[212:215]
s_mul_i32 s92, s90, s20
s_add_u32 s92, s92, s58
v_mfma_f32_16x16x32_bf16 v[220:223], a[84:87], v[92:95], v[220:223]
s_add_u32 m0, s51, 0
s_waitcnt lgkmcnt(0)
v_mfma_f32_16x16x32_bf16 v[208:211], a[64:67], v[192:195], v[208:211]
buffer_load_dwordx4 v8, s[8:11], s92 offen offset:0 sc1 lds
v_mfma_f32_16x16x32_bf16 v[212:215], a[64:67], v[196:199], v[212:215]
s_mul_i32 s93, s90, s21
s_add_u32 s93, s93, s59
s_andn2_b32 s71, s71, s70
v_mfma_f32_16x16x32_bf16 v[208:211], a[68:71], v[200:203], v[208:211]
s_add_u32 s52, s52, s70
s_add_u32 s54, s54, s71
s_mov_b32 s95, s94
v_mfma_f32_16x16x32_bf16 v[212:215], a[68:71], v[204:207], v[212:215]
buffer_load_dwordx4 v9, s[8:11], s92 offen offset:1024 sc1 lds
v_mfma_f32_16x16x32_bf16 v[216:219], a[88:91], v[96:99], v[216:219]
v_mfma_f32_16x16x32_bf16 v[220:223], a[88:91], v[100:103], v[220:223]
v_mfma_f32_16x16x32_bf16 v[216:219], a[92:95], v[104:107], v[216:219]
buffer_load_dwordx4 v10, s[8:11], s92 offen offset:2048 sc1 lds
v_mfma_f32_16x16x32_bf16 v[220:223], a[92:95], v[108:111], v[220:223]
v_mfma_f32_16x16x32_bf16 v[216:219], a[96:99], v[112:115], v[216:219]
v_mfma_f32_16x16x32_bf16 v[220:223], a[96:99], v[116:119], v[220:223]
buffer_load_dwordx4 v11, s[8:11], s92 offen offset:3072 sc1 lds
v_mfma_f32_16x16x32_bf16 v[216:219], a[100:103], v[120:123], v[216:219]
v_permlane32_swap_b32 v208, v212
v_mfma_f32_16x16x32_bf16 v[220:223], a[100:103], v[124:127], v[220:223]
s_add_u32 m0, s51, 4096
v_mfma_f32_16x16x32_bf16 v[216:219], a[104:107], v[128:131], v[216:219]
buffer_load_dwordx4 v12, s[8:11], s92 offen offset:0 sc1 lds
v_mfma_f32_16x16x32_bf16 v[220:223], a[104:107], v[132:135], v[220:223]
v_permlane32_swap_b32 v209, v213
v_mfma_f32_16x16x32_bf16 v[216:219], a[108:111], v[136:139], v[216:219]
v_permlane32_swap_b32 v210, v214
v_mfma_f32_16x16x32_bf16 v[220:223], a[108:111], v[140:143], v[220:223]
buffer_load_dwordx4 v13, s[8:11], s92 offen offset:1024 sc1 lds
v_mfma_f32_16x16x32_bf16 v[216:219], a[112:115], v[144:147], v[216:219]
v_permlane32_swap_b32 v211, v215
v_mfma_f32_16x16x32_bf16 v[220:223], a[112:115], v[148:151], v[220:223]
v_mul_f32 v232, s57, v208
v_mul_f32 v233, s57, v209
v_mfma_f32_16x16x32_bf16 v[216:219], a[116:119], v[152:155], v[216:219]
buffer_load_dwordx4 v14, s[8:11], s92 offen offset:2048 sc1 lds
v_mfma_f32_16x16x32_bf16 v[220:223], a[116:119], v[156:159], v[220:223]
v_mul_f32 v234, s57, v210
v_mul_f32 v235, s57, v211
v_mfma_f32_16x16x32_bf16 v[216:219], a[120:123], v[160:163], v[216:219]
v_exp_f32 v232, v232
v_mfma_f32_16x16x32_bf16 v[220:223], a[120:123], v[164:167], v[220:223]
buffer_load_dwordx4 v15, s[8:11], s92 offen offset:3072 sc1 lds
v_mfma_f32_16x16x32_bf16 v[216:219], a[124:127], v[168:171], v[216:219]
v_exp_f32 v233, v233
v_mfma_f32_16x16x32_bf16 v[220:223], a[124:127], v[172:175], v[220:223]
s_add_u32 m0, s51, 8192
v_mfma_f32_16x16x32_bf16 v[216:219], a[128:131], v[176:179], v[216:219]
buffer_load_dwordx4 v16, s[8:11], s92 offen offset:0 sc1 lds
v_mfma_f32_16x16x32_bf16 v[220:223], a[128:131], v[180:183], v[220:223]
v_exp_f32 v234, v234
v_mfma_f32_16x16x32_bf16 v[216:219], a[132:135], v[184:187], v[216:219]
v_exp_f32 v235, v235
v_mfma_f32_16x16x32_bf16 v[220:223], a[132:135], v[188:191], v[220:223]
v_add_f32 v232, 1.0, v232
v_add_f32 v233, 1.0, v233
v_mfma_f32_16x16x32_bf16 v[216:219], a[136:139], v[192:195], v[216:219]
v_add_f32 v234, 1.0, v234
v_add_f32 v235, 1.0, v235
v_mfma_f32_16x16x32_bf16 v[220:223], a[136:139], v[196:199], v[220:223]
v_rcp_f32 v232, v232
v_mfma_f32_16x16x32_bf16 v[216:219], a[140:143], v[200:203], v[216:219]
v_rcp_f32 v233, v233
v_mfma_f32_16x16x32_bf16 v[220:223], a[140:143], v[204:207], v[220:223]
v_rcp_f32 v234, v234
v_mfma_f32_16x16x32_bf16 v[224:227], a[144:147], v[64:67], 0
v_rcp_f32 v235, v235
v_mfma_f32_16x16x32_bf16 v[228:231], a[144:147], v[68:71], 0
v_mul_f32 v212, v208, v212
v_mul_f32 v213, v209, v213
v_mfma_f32_16x16x32_bf16 v[224:227], a[148:151], v[72:75], v[224:227]
v_mul_f32 v214, v210, v214
v_mul_f32 v215, v211, v215
v_mfma_f32_16x16x32_bf16 v[228:231], a[148:151], v[76:79], v[228:231]
v_mul_f32 v212, v212, v232
v_mul_f32 v213, v213, v233
v_mfma_f32_16x16x32_bf16 v[224:227], a[152:155], v[80:83], v[224:227]
buffer_load_dword v24, v22, s[4:7], 0 offen sc1
v_mfma_f32_16x16x32_bf16 v[228:231], a[152:155], v[84:87], v[228:231]
v_mul_f32 v214, v214, v234
v_mul_f32 v215, v215, v235
v_mul_f32 v236, s57, v216
v_mul_f32 v237, s57, v217
v_mul_f32 v238, s57, v218
v_mul_f32 v239, s57, v219
v_exp_f32 v236, v236
v_exp_f32 v237, v237
v_exp_f32 v238, v238
v_exp_f32 v239, v239
v_add_f32 v236, 1.0, v236
v_add_f32 v237, 1.0, v237
v_add_f32 v238, 1.0, v238
v_add_f32 v239, 1.0, v239
v_mfma_f32_16x16x32_bf16 v[224:227], a[156:159], v[88:91], v[224:227]
s_waitcnt vmcnt(10)
s_barrier
v_mfma_f32_16x16x32_bf16 v[228:231], a[156:159], v[92:95], v[228:231]
buffer_store_dword v27, v45, s[4:7], s79 offen
v_mfma_f32_16x16x32_bf16 v[224:227], a[160:163], v[96:99], v[224:227]
buffer_store_dword v27, v44, s[4:7], s79 offen sc1
v_mfma_f32_16x16x32_bf16 v[228:231], a[160:163], v[100:103], v[228:231]
v_cvt_pk_bf16_f32 v48, v212, v213
v_cvt_pk_bf16_f32 v49, v214, v215
v_mfma_f32_16x16x32_bf16 v[224:227], a[164:167], v[104:107], v[224:227]
buffer_store_dwordx2 v[48:49], v19, s[4:7], s87 offen sc1
v_mfma_f32_16x16x32_bf16 v[228:231], a[164:167], v[108:111], v[228:231]
v_rcp_f32 v236, v236
v_mfma_f32_16x16x32_bf16 v[224:227], a[168:171], v[112:115], v[224:227]
v_rcp_f32 v237, v237
v_mfma_f32_16x16x32_bf16 v[228:231], a[168:171], v[116:119], v[228:231]
v_rcp_f32 v238, v238
v_mfma_f32_16x16x32_bf16 v[224:227], a[172:175], v[120:123], v[224:227]
v_rcp_f32 v239, v239
v_mfma_f32_16x16x32_bf16 v[228:231], a[172:175], v[124:127], v[228:231]
v_mul_f32 v240, s57, v220
v_mul_f32 v241, s57, v221
v_mfma_f32_16x16x32_bf16 v[224:227], a[176:179], v[128:131], v[224:227]
v_mul_f32 v242, s57, v222
v_mul_f32 v243, s57, v223
v_mfma_f32_16x16x32_bf16 v[228:231], a[176:179], v[132:135], v[228:231]
v_mul_f32 v236, v216, v236
v_mul_f32 v237, v217, v237
v_mfma_f32_16x16x32_bf16 v[224:227], a[180:183], v[136:139], v[224:227]
v_mul_f32 v238, v218, v238
v_mul_f32 v239, v219, v239
v_mfma_f32_16x16x32_bf16 v[228:231], a[180:183], v[140:143], v[228:231]
v_exp_f32 v240, v240
v_mfma_f32_16x16x32_bf16 v[224:227], a[184:187], v[144:147], v[224:227]
v_exp_f32 v241, v241
v_mfma_f32_16x16x32_bf16 v[228:231], a[184:187], v[148:151], v[228:231]
v_exp_f32 v242, v242
v_mfma_f32_16x16x32_bf16 v[224:227], a[188:191], v[152:155], v[224:227]
v_exp_f32 v243, v243
v_mfma_f32_16x16x32_bf16 v[228:231], a[188:191], v[156:159], v[228:231]
v_add_f32 v240, 1.0, v240
v_add_f32 v241, 1.0, v241
v_mfma_f32_16x16x32_bf16 v[224:227], a[192:195], v[160:163], v[224:227]
s_waitcnt vmcnt(11)
s_barrier
v_mfma_f32_16x16x32_bf16 v[228:231], a[192:195], v[164:167], v[228:231]
v_add_f32 v242, 1.0, v242
v_add_f32 v243, 1.0, v243
v_mfma_f32_16x16x32_bf16 v[224:227], a[196:199], v[168:171], v[224:227]
s_cmp_eq_u32 s94, 0
s_cbranch_scc1 g_slow_167
v_mfma_f32_16x16x32_bf16 v[228:231], a[196:199], v[172:175], v[228:231]
v_rcp_f32 v240, v240
ds_read_b128 v[64:67], v31 offset:0
v_mfma_f32_16x16x32_bf16 v[224:227], a[200:203], v[176:179], v[224:227]
v_rcp_f32 v241, v241
ds_read_b128 v[68:71], v31 offset:9216
v_mfma_f32_16x16x32_bf16 v[228:231], a[200:203], v[180:183], v[228:231]
v_rcp_f32 v242, v242
ds_read_b128 v[72:75], v31 offset:18432
v_mfma_f32_16x16x32_bf16 v[224:227], a[204:207], v[184:187], v[224:227]
v_rcp_f32 v243, v243
ds_read_b128 v[76:79], v31 offset:27648
v_mfma_f32_16x16x32_bf16 v[228:231], a[204:207], v[188:191], v[228:231]
v_mul_f32 v240, v220, v240
ds_read_b128 v[80:83], v31 offset:1024
v_mfma_f32_16x16x32_bf16 v[224:227], a[208:211], v[192:195], v[224:227]
v_mul_f32 v241, v221, v241
ds_read_b128 v[84:87], v31 offset:10240
v_mfma_f32_16x16x32_bf16 v[228:231], a[208:211], v[196:199], v[228:231]
v_mul_f32 v242, v222, v242
ds_read_b128 v[88:91], v31 offset:19456
v_mfma_f32_16x16x32_bf16 v[224:227], a[212:215], v[200:203], v[224:227]
v_mul_f32 v243, v223, v243
ds_read_b128 v[92:95], v31 offset:28672
v_mfma_f32_16x16x32_bf16 v[228:231], a[212:215], v[204:207], v[228:231]
s_waitcnt vmcnt(7)
s_barrier
g_body_156:
s_waitcnt lgkmcnt(4)
v_mfma_f32_16x16x32_bf16 v[208:211], a[0:3], v[64:67], 0
ds_read_b128 v[96:99], v31 offset:2048
v_mfma_f32_16x16x32_bf16 v[212:215], a[0:3], v[68:71], 0
ds_read_b128 v[100:103], v31 offset:11264
v_mfma_f32_16x16x32_bf16 v[208:211], a[4:7], v[72:75], v[208:211]
ds_read_b128 v[104:107], v31 offset:20480
v_mfma_f32_16x16x32_bf16 v[212:215], a[4:7], v[76:79], v[212:215]
ds_read_b128 v[108:111], v31 offset:29696
v_mul_f32 v224, v224, v236
v_mfma_f32_16x16x32_bf16 v[216:219], a[72:75], v[64:67], 0
v_mul_f32 v225, v225, v237
s_waitcnt lgkmcnt(4)
v_mfma_f32_16x16x32_bf16 v[208:211], a[8:11], v[80:83], v[208:211]
ds_read_b128 v[112:115], v31 offset:3072
v_mul_f32 v226, v226, v238
v_mfma_f32_16x16x32_bf16 v[212:215], a[8:11], v[84:87], v[212:215]
ds_read_b128 v[116:119], v31 offset:12288
v_mul_f32 v227, v227, v239
v_mfma_f32_16x16x32_bf16 v[208:211], a[12:15], v[88:91], v[208:211]
ds_read_b128 v[120:123], v31 offset:21504
v_mul_f32 v228, v228, v240
v_mfma_f32_16x16x32_bf16 v[212:215], a[12:15], v[92:95], v[212:215]
ds_read_b128 v[124:127], v31 offset:30720
v_mul_f32 v229, v229, v241
v_mfma_f32_16x16x32_bf16 v[220:223], a[72:75], v[68:71], 0
v_mul_f32 v230, v230, v242
s_waitcnt lgkmcnt(4)
v_mfma_f32_16x16x32_bf16 v[208:211], a[16:19], v[96:99], v[208:211]
ds_read_b128 v[128:131], v31 offset:4096
v_mul_f32 v231, v231, v243
v_mfma_f32_16x16x32_bf16 v[212:215], a[16:19], v[100:103], v[212:215]
ds_read_b128 v[132:135], v31 offset:13312
v_cvt_pk_bf16_f32 v52, v224, v225
v_mfma_f32_16x16x32_bf16 v[208:211], a[20:23], v[104:107], v[208:211]
ds_read_b128 v[136:139], v31 offset:22528
v_cvt_pk_bf16_f32 v53, v226, v227
v_mfma_f32_16x16x32_bf16 v[212:215], a[20:23], v[108:111], v[212:215]
ds_read_b128 v[140:143], v31 offset:31744
v_cvt_pk_bf16_f32 v54, v228, v229
v_mfma_f32_16x16x32_bf16 v[216:219], a[76:79], v[72:75], v[216:219]
v_cvt_pk_bf16_f32 v55, v230, v231
s_waitcnt lgkmcnt(4)
v_mfma_f32_16x16x32_bf16 v[208:211], a[24:27], v[112:115], v[208:211]
ds_read_b128 v[144:147], v31 offset:5120
v_permlane16_swap_b32 v52, v54
v_mfma_f32_16x16x32_bf16 v[212:215], a[24:27], v[116:119], v[212:215]
ds_read_b128 v[148:151], v31 offset:14336
v_permlane16_swap_b32 v53, v55
v_mfma_f32_16x16x32_bf16 v[208:211], a[28:31], v[120:123], v[208:211]
ds_read_b128 v[152:155], v31 offset:23552
buffer_store_dwordx4 v[52:55], v20, s[4:7], s87 offen sc1
v_mfma_f32_16x16x32_bf16 v[212:215], a[28:31], v[124:127], v[212:215]
ds_read_b128 v[156:159], v31 offset:32768
v_mov_b32 v27, s84
v_mfma_f32_16x16x32_bf16 v[220:223], a[76:79], v[76:79], v[220:223]
s_waitcnt vmcnt(5)
s_barrier
s_waitcnt lgkmcnt(4)
v_mfma_f32_16x16x32_bf16 v[208:211], a[32:35], v[128:131], v[208:211]
ds_read_b128 v[160:163], v31 offset:6144
v_mfma_f32_16x16x32_bf16 v[212:215], a[32:35], v[132:135], v[212:215]
ds_read_b128 v[164:167], v31 offset:15360
v_mfma_f32_16x16x32_bf16 v[208:211], a[36:39], v[136:139], v[208:211]
ds_read_b128 v[168:171], v31 offset:24576
v_mfma_f32_16x16x32_bf16 v[212:215], a[36:39], v[140:143], v[212:215]
ds_read_b128 v[172:175], v31 offset:33792
v_mfma_f32_16x16x32_bf16 v[216:219], a[80:83], v[80:83], v[216:219]
s_waitcnt lgkmcnt(4)
v_mfma_f32_16x16x32_bf16 v[208:211], a[40:43], v[144:147], v[208:211]
ds_read_b128 v[176:179], v31 offset:7168
s_waitcnt vmcnt(4)
ds_write_b32 v18, v24
v_mfma_f32_16x16x32_bf16 v[212:215], a[40:43], v[148:151], v[212:215]
ds_read_b128 v[180:183], v31 offset:16384
v_mfma_f32_16x16x32_bf16 v[208:211], a[44:47], v[152:155], v[208:211]
ds_read_b128 v[184:187], v31 offset:25600
v_mfma_f32_16x16x32_bf16 v[212:215], a[44:47], v[156:159], v[212:215]
ds_read_b128 v[188:191], v31 offset:34816
s_waitcnt lgkmcnt(3)
s_barrier
v_mfma_f32_16x16x32_bf16 v[220:223], a[80:83], v[84:87], v[220:223]
ds_read_b32 v33, v32
v_mfma_f32_16x16x32_bf16 v[208:211], a[48:51], v[160:163], v[208:211]
ds_read_b128 v[192:195], v31 offset:8192
v_mfma_f32_16x16x32_bf16 v[212:215], a[48:51], v[164:167], v[212:215]
ds_read_b128 v[196:199], v31 offset:17408
v_mfma_f32_16x16x32_bf16 v[208:211], a[52:55], v[168:171], v[208:211]
ds_read_b128 v[200:203], v31 offset:26624
s_waitcnt lgkmcnt(3)
v_mfma_f32_16x16x32_bf16 v[212:215], a[52:55], v[172:175], v[212:215]
ds_read_b128 v[204:207], v31 offset:35840
v_cmp_gt_u32 vcc, s52, v33
v_mfma_f32_16x16x32_bf16 v[216:219], a[84:87], v[88:91], v[216:219]
v_cmp_gt_u32 s[58:59], s54, v33
v_mfma_f32_16x16x32_bf16 v[208:211], a[56:59], v[176:179], v[208:211]
s_and_b32 vcc_lo, vcc_lo, s56
s_cselect_b32 s70, 0, 1
s_and_b32 s59, s59, s56
s_cselect_b32 s71, 0, s95
v_mfma_f32_16x16x32_bf16 v[212:215], a[56:59], v[180:183], v[212:215]
s_or_b32 s76, s70, s71
s_cselect_b32 s10, 268435456, 0
v_mfma_f32_16x16x32_bf16 v[208:211], a[60:63], v[184:187], v[208:211]
s_cmp_lg_u32 s70, 0
s_cselect_b64 s[72:73], s[52:53], s[54:55]
s_cselect_b64 s[58:59], s[44:45], s[46:47]
v_mfma_f32_16x16x32_bf16 v[212:215], a[60:63], v[188:191], v[212:215]
s_mul_i32 s74, s72, s20
s_add_u32 s74, s74, s58
v_mfma_f32_16x16x32_bf16 v[220:223], a[84:87], v[92:95], v[220:223]
s_add_u32 m0, s48, 0
s_waitcnt lgkmcnt(0)
v_mfma_f32_16x16x32_bf16 v[208:211], a[64:67], v[192:195], v[208:211]
buffer_load_dwordx4 v8, s[8:11], s74 offen offset:0 sc1 lds
v_mfma_f32_16x16x32_bf16 v[212:215], a[64:67], v[196:199], v[212:215]
s_mul_i32 s75, s72, s21
s_add_u32 s75, s75, s59
s_andn2_b32 s71, s71, s70
v_mfma_f32_16x16x32_bf16 v[208:211], a[68:71], v[200:203], v[208:211]
s_add_u32 s52, s52, s70
s_add_u32 s54, s54, s71
s_mov_b32 s77, s76
v_mfma_f32_16x16x32_bf16 v[212:215], a[68:71], v[204:207], v[212:215]
buffer_load_dwordx4 v9, s[8:11], s74 offen offset:1024 sc1 lds
v_mfma_f32_16x16x32_bf16 v[216:219], a[88:91], v[96:99], v[216:219]
v_mfma_f32_16x16x32_bf16 v[220:223], a[88:91], v[100:103], v[220:223]
v_mfma_f32_16x16x32_bf16 v[216:219], a[92:95], v[104:107], v[216:219]
buffer_load_dwordx4 v10, s[8:11], s74 offen offset:2048 sc1 lds
v_mfma_f32_16x16x32_bf16 v[220:223], a[92:95], v[108:111], v[220:223]
v_mfma_f32_16x16x32_bf16 v[216:219], a[96:99], v[112:115], v[216:219]
v_mfma_f32_16x16x32_bf16 v[220:223], a[96:99], v[116:119], v[220:223]
buffer_load_dwordx4 v11, s[8:11], s74 offen offset:3072 sc1 lds
v_mfma_f32_16x16x32_bf16 v[216:219], a[100:103], v[120:123], v[216:219]
v_permlane32_swap_b32 v208, v212
v_mfma_f32_16x16x32_bf16 v[220:223], a[100:103], v[124:127], v[220:223]
s_add_u32 m0, s48, 4096
v_mfma_f32_16x16x32_bf16 v[216:219], a[104:107], v[128:131], v[216:219]
buffer_load_dwordx4 v12, s[8:11], s74 offen offset:0 sc1 lds
v_mfma_f32_16x16x32_bf16 v[220:223], a[104:107], v[132:135], v[220:223]
v_permlane32_swap_b32 v209, v213
v_mfma_f32_16x16x32_bf16 v[216:219], a[108:111], v[136:139], v[216:219]
v_permlane32_swap_b32 v210, v214
v_mfma_f32_16x16x32_bf16 v[220:223], a[108:111], v[140:143], v[220:223]
buffer_load_dwordx4 v13, s[8:11], s74 offen offset:1024 sc1 lds
v_mfma_f32_16x16x32_bf16 v[216:219], a[112:115], v[144:147], v[216:219]
v_permlane32_swap_b32 v211, v215
v_mfma_f32_16x16x32_bf16 v[220:223], a[112:115], v[148:151], v[220:223]
v_mul_f32 v232, s57, v208
v_mul_f32 v233, s57, v209
v_mfma_f32_16x16x32_bf16 v[216:219], a[116:119], v[152:155], v[216:219]
buffer_load_dwordx4 v14, s[8:11], s74 offen offset:2048 sc1 lds
v_mfma_f32_16x16x32_bf16 v[220:223], a[116:119], v[156:159], v[220:223]
v_mul_f32 v234, s57, v210
v_mul_f32 v235, s57, v211
v_mfma_f32_16x16x32_bf16 v[216:219], a[120:123], v[160:163], v[216:219]
v_exp_f32 v232, v232
v_mfma_f32_16x16x32_bf16 v[220:223], a[120:123], v[164:167], v[220:223]
buffer_load_dwordx4 v15, s[8:11], s74 offen offset:3072 sc1 lds
v_mfma_f32_16x16x32_bf16 v[216:219], a[124:127], v[168:171], v[216:219]
v_exp_f32 v233, v233
v_mfma_f32_16x16x32_bf16 v[220:223], a[124:127], v[172:175], v[220:223]
s_add_u32 m0, s48, 8192
v_mfma_f32_16x16x32_bf16 v[216:219], a[128:131], v[176:179], v[216:219]
buffer_load_dwordx4 v16, s[8:11], s74 offen offset:0 sc1 lds
v_mfma_f32_16x16x32_bf16 v[220:223], a[128:131], v[180:183], v[220:223]
v_exp_f32 v234, v234
v_mfma_f32_16x16x32_bf16 v[216:219], a[132:135], v[184:187], v[216:219]
v_exp_f32 v235, v235
v_mfma_f32_16x16x32_bf16 v[220:223], a[132:135], v[188:191], v[220:223]
v_add_f32 v232, 1.0, v232
v_add_f32 v233, 1.0, v233
v_mfma_f32_16x16x32_bf16 v[216:219], a[136:139], v[192:195], v[216:219]
v_add_f32 v234, 1.0, v234
v_add_f32 v235, 1.0, v235
v_mfma_f32_16x16x32_bf16 v[220:223], a[136:139], v[196:199], v[220:223]
v_rcp_f32 v232, v232
v_mfma_f32_16x16x32_bf16 v[216:219], a[140:143], v[200:203], v[216:219]
v_rcp_f32 v233, v233
v_mfma_f32_16x16x32_bf16 v[220:223], a[140:143], v[204:207], v[220:223]
v_rcp_f32 v234, v234
v_mfma_f32_16x16x32_bf16 v[224:227], a[144:147], v[64:67], 0
v_rcp_f32 v235, v235
v_mfma_f32_16x16x32_bf16 v[228:231], a[144:147], v[68:71], 0
v_mul_f32 v212, v208, v212
v_mul_f32 v213, v209, v213
v_mfma_f32_16x16x32_bf16 v[224:227], a[148:151], v[72:75], v[224:227]
v_mul_f32 v214, v210, v214
v_mul_f32 v215, v211, v215
v_mfma_f32_16x16x32_bf16 v[228:231], a[148:151], v[76:79], v[228:231]
v_mul_f32 v212, v212, v232
v_mul_f32 v213, v213, v233
v_mfma_f32_16x16x32_bf16 v[224:227], a[152:155], v[80:83], v[224:227]
buffer_load_dword v24, v22, s[4:7], 0 offen sc1
v_mfma_f32_16x16x32_bf16 v[228:231], a[152:155], v[84:87], v[228:231]
v_mul_f32 v214, v214, v234
v_mul_f32 v215, v215, v235
v_mul_f32 v236, s57, v216
v_mul_f32 v237, s57, v217
v_mul_f32 v238, s57, v218
v_mul_f32 v239, s57, v219
v_exp_f32 v236, v236
v_exp_f32 v237, v237
v_exp_f32 v238, v238
v_exp_f32 v239, v239
v_add_f32 v236, 1.0, v236
v_add_f32 v237, 1.0, v237
v_add_f32 v238, 1.0, v238
v_add_f32 v239, 1.0, v239
v_mfma_f32_16x16x32_bf16 v[224:227], a[156:159], v[88:91], v[224:227]
s_waitcnt vmcnt(10)
s_barrier
v_mfma_f32_16x16x32_bf16 v[228:231], a[156:159], v[92:95], v[228:231]
buffer_store_dword v27, v45, s[4:7], s85 offen
v_mfma_f32_16x16x32_bf16 v[224:227], a[160:163], v[96:99], v[224:227]
buffer_store_dword v27, v44, s[4:7], s85 offen sc1
v_mfma_f32_16x16x32_bf16 v[228:231], a[160:163], v[100:103], v[228:231]
v_cvt_pk_bf16_f32 v48, v212, v213
v_cvt_pk_bf16_f32 v49, v214, v215
v_mfma_f32_16x16x32_bf16 v[224:227], a[164:167], v[104:107], v[224:227]
buffer_store_dwordx2 v[48:49], v19, s[4:7], s93 offen sc1
v_mfma_f32_16x16x32_bf16 v[228:231], a[164:167], v[108:111], v[228:231]
v_rcp_f32 v236, v236
v_mfma_f32_16x16x32_bf16 v[224:227], a[168:171], v[112:115], v[224:227]
v_rcp_f32 v237, v237
v_mfma_f32_16x16x32_bf16 v[228:231], a[168:171], v[116:119], v[228:231]
v_rcp_f32 v238, v238
v_mfma_f32_16x16x32_bf16 v[224:227], a[172:175], v[120:123], v[224:227]
v_rcp_f32 v239, v239
v_mfma_f32_16x16x32_bf16 v[228:231], a[172:175], v[124:127], v[228:231]
v_mul_f32 v240, s57, v220
v_mul_f32 v241, s57, v221
v_mfma_f32_16x16x32_bf16 v[224:227], a[176:179], v[128:131], v[224:227]
v_mul_f32 v242, s57, v222
v_mul_f32 v243, s57, v223
v_mfma_f32_16x16x32_bf16 v[228:231], a[176:179], v[132:135], v[228:231]
v_mul_f32 v236, v216, v236
v_mul_f32 v237, v217, v237
v_mfma_f32_16x16x32_bf16 v[224:227], a[180:183], v[136:139], v[224:227]
v_mul_f32 v238, v218, v238
v_mul_f32 v239, v219, v239
v_mfma_f32_16x16x32_bf16 v[228:231], a[180:183], v[140:143], v[228:231]
v_exp_f32 v240, v240
v_mfma_f32_16x16x32_bf16 v[224:227], a[184:187], v[144:147], v[224:227]
v_exp_f32 v241, v241
v_mfma_f32_16x16x32_bf16 v[228:231], a[184:187], v[148:151], v[228:231]
v_exp_f32 v242, v242
v_mfma_f32_16x16x32_bf16 v[224:227], a[188:191], v[152:155], v[224:227]
v_exp_f32 v243, v243
v_mfma_f32_16x16x32_bf16 v[228:231], a[188:191], v[156:159], v[228:231]
v_add_f32 v240, 1.0, v240
v_add_f32 v241, 1.0, v241
v_mfma_f32_16x16x32_bf16 v[224:227], a[192:195], v[160:163], v[224:227]
s_waitcnt vmcnt(11)
s_barrier
v_mfma_f32_16x16x32_bf16 v[228:231], a[192:195], v[164:167], v[228:231]
v_add_f32 v242, 1.0, v242
v_add_f32 v243, 1.0, v243
v_mfma_f32_16x16x32_bf16 v[224:227], a[196:199], v[168:171], v[224:227]
s_cmp_eq_u32 s76, 0
s_cbranch_scc1 g_slow_168
v_mfma_f32_16x16x32_bf16 v[228:231], a[196:199], v[172:175], v[228:231]
v_rcp_f32 v240, v240
ds_read_b128 v[64:67], v28 offset:0
v_mfma_f32_16x16x32_bf16 v[224:227], a[200:203], v[176:179], v[224:227]
v_rcp_f32 v241, v241
ds_read_b128 v[68:71], v28 offset:9216
v_mfma_f32_16x16x32_bf16 v[228:231], a[200:203], v[180:183], v[228:231]
v_rcp_f32 v242, v242
ds_read_b128 v[72:75], v28 offset:18432
v_mfma_f32_16x16x32_bf16 v[224:227], a[204:207], v[184:187], v[224:227]
v_rcp_f32 v243, v243
ds_read_b128 v[76:79], v28 offset:27648
v_mfma_f32_16x16x32_bf16 v[228:231], a[204:207], v[188:191], v[228:231]
v_mul_f32 v240, v220, v240
ds_read_b128 v[80:83], v28 offset:1024
v_mfma_f32_16x16x32_bf16 v[224:227], a[208:211], v[192:195], v[224:227]
v_mul_f32 v241, v221, v241
ds_read_b128 v[84:87], v28 offset:10240
v_mfma_f32_16x16x32_bf16 v[228:231], a[208:211], v[196:199], v[228:231]
v_mul_f32 v242, v222, v242
ds_read_b128 v[88:91], v28 offset:19456
v_mfma_f32_16x16x32_bf16 v[224:227], a[212:215], v[200:203], v[224:227]
v_mul_f32 v243, v223, v243
ds_read_b128 v[92:95], v28 offset:28672
v_mfma_f32_16x16x32_bf16 v[228:231], a[212:215], v[204:207], v[228:231]
s_waitcnt vmcnt(7)
s_barrier
s_branch g_body_153
g_slow_165:
v_mfma_f32_16x16x32_bf16 v[228:231], a[196:199], v[172:175], v[228:231]
v_rcp_f32 v240, v240
v_mfma_f32_16x16x32_bf16 v[224:227], a[200:203], v[176:179], v[224:227]
v_rcp_f32 v241, v241
v_mfma_f32_16x16x32_bf16 v[228:231], a[200:203], v[180:183], v[228:231]
v_rcp_f32 v242, v242
v_mfma_f32_16x16x32_bf16 v[224:227], a[204:207], v[184:187], v[224:227]
v_rcp_f32 v243, v243
v_mfma_f32_16x16x32_bf16 v[228:231], a[204:207], v[188:191], v[228:231]
v_mul_f32 v240, v220, v240
v_mfma_f32_16x16x32_bf16 v[224:227], a[208:211], v[192:195], v[224:227]
v_mul_f32 v241, v221, v241
v_mfma_f32_16x16x32_bf16 v[228:231], a[208:211], v[196:199], v[228:231]
v_mul_f32 v242, v222, v242
v_mfma_f32_16x16x32_bf16 v[224:227], a[212:215], v[200:203], v[224:227]
v_mul_f32 v243, v223, v243
v_mfma_f32_16x16x32_bf16 v[228:231], a[212:215], v[204:207], v[228:231]
s_nop 5
v_mul_f32 v224, v224, v236
v_mul_f32 v225, v225, v237
v_mul_f32 v226, v226, v238
v_mul_f32 v227, v227, v239
v_mul_f32 v228, v228, v240
v_mul_f32 v229, v229, v241
v_mul_f32 v230, v230, v242
v_mul_f32 v231, v231, v243
v_cvt_pk_bf16_f32 v52, v224, v225
v_cvt_pk_bf16_f32 v53, v226, v227
v_cvt_pk_bf16_f32 v54, v228, v229
v_cvt_pk_bf16_f32 v55, v230, v231
s_nop 0
v_permlane16_swap_b32 v52, v54
v_permlane16_swap_b32 v53, v55
buffer_store_dwordx4 v[52:55], v20, s[4:7], s75 offen sc1
s_mov_b32 s75, 1879048192
s_waitcnt vmcnt(4)
ds_write_b32 v18, v24
s_waitcnt lgkmcnt(0)
s_barrier
ds_read_b32 v33, v32
s_waitcnt lgkmcnt(0)
v_cmp_gt_u32 vcc, s52, v33
v_cmp_gt_u32 s[58:59], s54, v33
s_and_b32 vcc_lo, vcc_lo, s56
s_cselect_b32 s70, 0, 1
s_and_b32 s59, s59, s56
s_cselect_b32 s71, 0, s77
s_or_b32 s82, s70, s71
s_cselect_b32 s10, 268435456, 0
s_cmp_lg_u32 s70, 0
s_cselect_b64 s[78:79], s[52:53], s[54:55]
s_cselect_b64 s[58:59], s[44:45], s[46:47]
s_mul_i32 s80, s78, s20
s_add_u32 s80, s80, s58
s_mul_i32 s81, s78, s21
s_add_u32 s81, s81, s59
s_andn2_b32 s71, s71, s70
s_add_u32 s52, s52, s70
s_add_u32 s54, s54, s71
s_mov_b32 s83, s82
s_cmp_lg_u32 s82, 0
s_cbranch_scc1 g_go_169
v_mov_b32 v27, s72
s_waitcnt vmcnt(0)
s_barrier
s_add_u32 s70, s52, s54
s_cmp_eq_u32 s70, 130
s_cbranch_scc1 g_fin_157
s_cmp_lg_u32 s3, 0
s_cbranch_scc1 sp_ok_171_j
s_mov_b32 s23, 0
buffer_load_dword v33, v22, s[4:7], 0 offen sc1
buffer_store_dword v27, v45, s[4:7], s73 offen
buffer_store_dword v27, v44, s[4:7], s73 offen sc1
s_waitcnt vmcnt(2)
s_branch sp_loop_170_e
sp_loop_170:
buffer_load_dword v33, v22, s[4:7], 0 offen sc1
s_add_u32 s23, s23, 1
s_cmp_gt_u32 s23, 150000
s_cbranch_scc1 sp_bad_172
s_waitcnt vmcnt(0)
sp_loop_170_e:
v_cmp_gt_u32 vcc, s52, v33
v_cmp_gt_u32 s[58:59], s54, v33
s_and_b32 vcc_lo, vcc_lo, s56
s_cbranch_scc0 sp_ok_171
s_cmp_gt_u32 s23, 4
s_cselect_b32 s70, 0, s56
s_cmp_lg_u32 s77, 0
s_cselect_b32 s70, 0, s70
s_or_b32 s59, s59, s70
s_and_b32 s59, s59, s56
s_cbranch_scc0 sp_ok_171
s_sleep 1
s_branch sp_loop_170
sp_bad_172:
s_mov_b32 s98, 1028
s_branch L_fail
sp_ok_171:
ds_write_b32 v18, v33
s_waitcnt lgkmcnt(0)
sp_ok_171_j:
s_barrier
ds_read_b32 v33, v32
s_waitcnt lgkmcnt(0)
s_mov_b32 s73, 1879048192
v_cmp_gt_u32 vcc, s52, v33
v_cmp_gt_u32 s[58:59], s54, v33
s_and_b32 vcc_lo, vcc_lo, s56
s_cselect_b32 s70, 0, 1
s_and_b32 s59, s59, s56
s_cselect_b32 s71, 0, 1
s_or_b32 s82, s70, s71
s_cselect_b32 s10, 268435456, 0
s_cmp_lg_u32 s70, 0
s_cselect_b64 s[78:79], s[52:53], s[54:55]
s_cselect_b64 s[58:59], s[44:45], s[46:47]
s_mul_i32 s80, s78, s20
s_add_u32 s80, s80, s58
s_mul_i32 s81, s78, s21
s_add_u32 s81, s81, s59
s_andn2_b32 s71, s71, s70
s_add_u32 s52, s52, s70
s_add_u32 s54, s54, s71
s_mov_b32 s83, s82
g_go_169:
s_add_u32 m0, s49, 0
s_nop 0
buffer_load_dwordx4 v8, s[4:7], s80 offen offset:0 sc1 lds
buffer_load_dwordx4 v9, s[4:7], s80 offen offset:1024 sc1 lds
buffer_load_dwordx4 v10, s[4:7], s80 offen offset:2048 sc1 lds
buffer_load_dwordx4 v11, s[4:7], s80 offen offset:3072 sc1 lds
s_add_u32 m0, s49, 4096
s_nop 0
buffer_load_dwordx4 v12, s[4:7], s80 offen offset:0 sc1 lds
buffer_load_dwordx4 v13, s[4:7], s80 offen offset:1024 sc1 lds
buffer_load_dwordx4 v14, s[4:7], s80 offen offset:2048 sc1 lds
buffer_load_dwordx4 v15, s[4:7], s80 offen offset:3072 sc1 lds
s_add_u32 m0, s49, 8192
s_nop 0
buffer_load_dwordx4 v16, s[4:7], s80 offen offset:0 sc1 lds
buffer_load_dword v24, v22, s[4:7], 0 offen sc1
buffer_store_dword v27, v34, s[4:7], 0 offen
v_mov_b32 v27, s72
s_waitcnt vmcnt(9)
s_barrier
buffer_store_dword v27, v45, s[4:7], s73 offen
buffer_store_dword v27, v44, s[4:7], s73 offen sc1
s_mov_b32 s73, 1879048192
ds_read_b128 v[64:67], v29 offset:0
ds_read_b128 v[68:71], v29 offset:9216
ds_read_b128 v[72:75], v29 offset:18432
ds_read_b128 v[76:79], v29 offset:27648
ds_read_b128 v[80:83], v29 offset:1024
ds_read_b128 v[84:87], v29 offset:10240
ds_read_b128 v[88:91], v29 offset:19456
ds_read_b128 v[92:95], v29 offset:28672
s_waitcnt vmcnt(7)
s_barrier
s_branch g_body_154
g_slow_166:
v_mfma_f32_16x16x32_bf16 v[228:231], a[196:199], v[172:175], v[228:231]
v_rcp_f32 v240, v240
v_mfma_f32_16x16x32_bf16 v[224:227], a[200:203], v[176:179], v[224:227]
v_rcp_f32 v241, v241
v_mfma_f32_16x16x32_bf16 v[228:231], a[200:203], v[180:183], v[228:231]
v_rcp_f32 v242, v242
v_mfma_f32_16x16x32_bf16 v[224:227], a[204:207], v[184:187], v[224:227]
v_rcp_f32 v243, v243
v_mfma_f32_16x16x32_bf16 v[228:231], a[204:207], v[188:191], v[228:231]
v_mul_f32 v240, v220, v240
v_mfma_f32_16x16x32_bf16 v[224:227], a[208:211], v[192:195], v[224:227]
v_mul_f32 v241, v221, v241
v_mfma_f32_16x16x32_bf16 v[228:231], a[208:211], v[196:199], v[228:231]
v_mul_f32 v242, v222, v242
v_mfma_f32_16x16x32_bf16 v[224:227], a[212:215], v[200:203], v[224:227]
v_mul_f32 v243, v223, v243
v_mfma_f32_16x16x32_bf16 v[228:231], a[212:215], v[204:207], v[228:231]
s_nop 5
v_mul_f32 v224, v224, v236
v_mul_f32 v225, v225, v237
v_mul_f32 v226, v226, v238
v_mul_f32 v227, v227, v239
v_mul_f32 v228, v228, v240
v_mul_f32 v229, v229, v241
v_mul_f32 v230, v230, v242
v_mul_f32 v231, v231, v243
v_cvt_pk_bf16_f32 v52, v224, v225
v_cvt_pk_bf16_f32 v53, v226, v227
v_cvt_pk_bf16_f32 v54, v228, v229
v_cvt_pk_bf16_f32 v55, v230, v231
s_nop 0
v_permlane16_swap_b32 v52, v54
v_permlane16_swap_b32 v53, v55
buffer_store_dwordx4 v[52:55], v20, s[4:7], s81 offen sc1
s_mov_b32 s81, 1879048192
s_waitcnt vmcnt(4)
ds_write_b32 v18, v24
s_waitcnt lgkmcnt(0)
s_barrier
ds_read_b32 v33, v32
s_waitcnt lgkmcnt(0)
v_cmp_gt_u32 vcc, s52, v33
v_cmp_gt_u32 s[58:59], s54, v33
s_and_b32 vcc_lo, vcc_lo, s56
s_cselect_b32 s70, 0, 1
s_and_b32 s59, s59, s56
s_cselect_b32 s71, 0, s83
s_or_b32 s88, s70, s71
s_cselect_b32 s10, 268435456, 0
s_cmp_lg_u32 s70, 0
s_cselect_b64 s[84:85], s[52:53], s[54:55]
s_cselect_b64 s[58:59], s[44:45], s[46:47]
s_mul_i32 s86, s84, s20
s_add_u32 s86, s86, s58
s_mul_i32 s87, s84, s21
s_add_u32 s87, s87, s59
s_andn2_b32 s71, s71, s70
s_add_u32 s52, s52, s70
s_add_u32 s54, s54, s71
s_mov_b32 s89, s88
s_cmp_lg_u32 s88, 0
s_cbranch_scc1 g_go_173
v_mov_b32 v27, s78
s_waitcnt vmcnt(0)
s_barrier
s_add_u32 s70, s52, s54
s_cmp_eq_u32 s70, 130
s_cbranch_scc1 g_fin_157
s_cmp_lg_u32 s3, 0
s_cbranch_scc1 sp_ok_175_j
s_mov_b32 s23, 0
buffer_load_dword v33, v22, s[4:7], 0 offen sc1
buffer_store_dword v27, v45, s[4:7], s79 offen
buffer_store_dword v27, v44, s[4:7], s79 offen sc1
s_waitcnt vmcnt(2)
s_branch sp_loop_174_e
sp_loop_174:
buffer_load_dword v33, v22, s[4:7], 0 offen sc1
s_add_u32 s23, s23, 1
s_cmp_gt_u32 s23, 150000
s_cbranch_scc1 sp_bad_176
s_waitcnt vmcnt(0)
sp_loop_174_e:
v_cmp_gt_u32 vcc, s52, v33
v_cmp_gt_u32 s[58:59], s54, v33
s_and_b32 vcc_lo, vcc_lo, s56
s_cbranch_scc0 sp_ok_175
s_cmp_gt_u32 s23, 4
s_cselect_b32 s70, 0, s56
s_cmp_lg_u32 s83, 0
s_cselect_b32 s70, 0, s70
s_or_b32 s59, s59, s70
s_and_b32 s59, s59, s56
s_cbranch_scc0 sp_ok_175
s_sleep 1
s_branch sp_loop_174
sp_bad_176:
s_mov_b32 s98, 1028
s_branch L_fail
sp_ok_175:
ds_write_b32 v18, v33
s_waitcnt lgkmcnt(0)
sp_ok_175_j:
s_barrier
ds_read_b32 v33, v32
s_waitcnt lgkmcnt(0)
s_mov_b32 s79, 1879048192
v_cmp_gt_u32 vcc, s52, v33
v_cmp_gt_u32 s[58:59], s54, v33
s_and_b32 vcc_lo, vcc_lo, s56
s_cselect_b32 s70, 0, 1
s_and_b32 s59, s59, s56
s_cselect_b32 s71, 0, 1
s_or_b32 s88, s70, s71
s_cselect_b32 s10, 268435456, 0
s_cmp_lg_u32 s70, 0
s_cselect_b64 s[84:85], s[52:53], s[54:55]
s_cselect_b64 s[58:59], s[44:45], s[46:47]
s_mul_i32 s86, s84, s20
s_add_u32 s86, s86, s58
s_mul_i32 s87, s84, s21
s_add_u32 s87, s87, s59
s_andn2_b32 s71, s71, s70
s_add_u32 s52, s52, s70
s_add_u32 s54, s54, s71
s_mov_b32 s89, s88
g_go_173:
s_add_u32 m0, s50, 0
s_nop 0
buffer_load_dwordx4 v8, s[4:7], s86 offen offset:0 sc1 lds
buffer_load_dwordx4 v9, s[4:7], s86 offen offset:1024 sc1 lds
buffer_load_dwordx4 v10, s[4:7], s86 offen offset:2048 sc1 lds
buffer_load_dwordx4 v11, s[4:7], s86 offen offset:3072 sc1 lds
s_add_u32 m0, s50, 4096
s_nop 0
buffer_load_dwordx4 v12, s[4:7], s86 offen offset:0 sc1 lds
buffer_load_dwordx4 v13, s[4:7], s86 offen offset:1024 sc1 lds
buffer_load_dwordx4 v14, s[4:7], s86 offen offset:2048 sc1 lds
buffer_load_dwordx4 v15, s[4:7], s86 offen offset:3072 sc1 lds
s_add_u32 m0, s50, 8192
s_nop 0
buffer_load_dwordx4 v16, s[4:7], s86 offen offset:0 sc1 lds
buffer_load_dword v24, v22, s[4:7], 0 offen sc1
buffer_store_dword v27, v34, s[4:7], 0 offen
v_mov_b32 v27, s78
s_waitcnt vmcnt(9)
s_barrier
buffer_store_dword v27, v45, s[4:7], s79 offen
buffer_store_dword v27, v44, s[4:7], s79 offen sc1
s_mov_b32 s79, 1879048192
ds_read_b128 v[64:67], v30 offset:0
ds_read_b128 v[68:71], v30 offset:9216
ds_read_b128 v[72:75], v30 offset:18432
ds_read_b128 v[76:79], v30 offset:27648
ds_read_b128 v[80:83], v30 offset:1024
ds_read_b128 v[84:87], v30 offset:10240
ds_read_b128 v[88:91], v30 offset:19456
ds_read_b128 v[92:95], v30 offset:28672
s_waitcnt vmcnt(7)
s_barrier
s_branch g_body_155
g_slow_167:
v_mfma_f32_16x16x32_bf16 v[228:231], a[196:199], v[172:175], v[228:231]
v_rcp_f32 v240, v240
v_mfma_f32_16x16x32_bf16 v[224:227], a[200:203], v[176:179], v[224:227]
v_rcp_f32 v241, v241
v_mfma_f32_16x16x32_bf16 v[228:231], a[200:203], v[180:183], v[228:231]
v_rcp_f32 v242, v242
v_mfma_f32_16x16x32_bf16 v[224:227], a[204:207], v[184:187], v[224:227]
v_rcp_f32 v243, v243
v_mfma_f32_16x16x32_bf16 v[228:231], a[204:207], v[188:191], v[228:231]
v_mul_f32 v240, v220, v240
v_mfma_f32_16x16x32_bf16 v[224:227], a[208:211], v[192:195], v[224:227]
v_mul_f32 v241, v221, v241
v_mfma_f32_16x16x32_bf16 v[228:231], a[208:211], v[196:199], v[228:231]
v_mul_f32 v242, v222, v242
v_mfma_f32_16x16x32_bf16 v[224:227], a[212:215], v[200:203], v[224:227]
v_mul_f32 v243, v223, v243
v_mfma_f32_16x16x32_bf16 v[228:231], a[212:215], v[204:207], v[228:231]
s_nop 5
v_mul_f32 v224, v224, v236
v_mul_f32 v225, v225, v237
v_mul_f32 v226, v226, v238
v_mul_f32 v227, v227, v239
v_mul_f32 v228, v228, v240
v_mul_f32 v229, v229, v241
v_mul_f32 v230, v230, v242
v_mul_f32 v231, v231, v243
v_cvt_pk_bf16_f32 v52, v224, v225
v_cvt_pk_bf16_f32 v53, v226, v227
v_cvt_pk_bf16_f32 v54, v228, v229
v_cvt_pk_bf16_f32 v55, v230, v231
s_nop 0
v_permlane16_swap_b32 v52, v54
v_permlane16_swap_b32 v53, v55
buffer_store_dwordx4 v[52:55], v20, s[4:7], s87 offen sc1
s_mov_b32 s87, 1879048192
s_waitcnt vmcnt(4)
ds_write_b32 v18, v24
s_waitcnt lgkmcnt(0)
s_barrier
ds_read_b32 v33, v32
s_waitcnt lgkmcnt(0)
v_cmp_gt_u32 vcc, s52, v33
v_cmp_gt_u32 s[58:59], s54, v33
s_and_b32 vcc_lo, vcc_lo, s56
s_cselect_b32 s70, 0, 1
s_and_b32 s59, s59, s56
s_cselect_b32 s71, 0, s89
s_or_b32 s94, s70, s71
s_cselect_b32 s10, 268435456, 0
s_cmp_lg_u32 s70, 0
s_cselect_b64 s[90:91], s[52:53], s[54:55]
s_cselect_b64 s[58:59], s[44:45], s[46:47]
s_mul_i32 s92, s90, s20
s_add_u32 s92, s92, s58
s_mul_i32 s93, s90, s21
s_add_u32 s93, s93, s59
s_andn2_b32 s71, s71, s70
s_add_u32 s52, s52, s70
s_add_u32 s54, s54, s71
s_mov_b32 s95, s94
s_cmp_lg_u32 s94, 0
s_cbranch_scc1 g_go_177
v_mov_b32 v27, s84
s_waitcnt vmcnt(0)
s_barrier
s_add_u32 s70, s52, s54
s_cmp_eq_u32 s70, 130
s_cbranch_scc1 g_fin_157
s_cmp_lg_u32 s3, 0
s_cbranch_scc1 sp_ok_179_j
s_mov_b32 s23, 0
buffer_load_dword v33, v22, s[4:7], 0 offen sc1
buffer_store_dword v27, v45, s[4:7], s85 offen
buffer_store_dword v27, v44, s[4:7], s85 offen sc1
s_waitcnt vmcnt(2)
s_branch sp_loop_178_e
sp_loop_178:
buffer_load_dword v33, v22, s[4:7], 0 offen sc1
s_add_u32 s23, s23, 1
s_cmp_gt_u32 s23, 150000
s_cbranch_scc1 sp_bad_180
s_waitcnt vmcnt(0)
sp_loop_178_e:
v_cmp_gt_u32 vcc, s52, v33
v_cmp_gt_u32 s[58:59], s54, v33
s_and_b32 vcc_lo, vcc_lo, s56
s_cbranch_scc0 sp_ok_179
s_cmp_gt_u32 s23, 4
s_cselect_b32 s70, 0, s56
s_cmp_lg_u32 s89, 0
s_cselect_b32 s70, 0, s70
s_or_b32 s59, s59, s70
s_and_b32 s59, s59, s56
s_cbranch_scc0 sp_ok_179
s_sleep 1
s_branch sp_loop_178
sp_bad_180:
s_mov_b32 s98, 1028
s_branch L_fail
sp_ok_179:
ds_write_b32 v18, v33
s_waitcnt lgkmcnt(0)
sp_ok_179_j:
s_barrier
ds_read_b32 v33, v32
s_waitcnt lgkmcnt(0)
s_mov_b32 s85, 1879048192
v_cmp_gt_u32 vcc, s52, v33
v_cmp_gt_u32 s[58:59], s54, v33
s_and_b32 vcc_lo, vcc_lo, s56
s_cselect_b32 s70, 0, 1
s_and_b32 s59, s59, s56
s_cselect_b32 s71, 0, 1
s_or_b32 s94, s70, s71
s_cselect_b32 s10, 268435456, 0
s_cmp_lg_u32 s70, 0
s_cselect_b64 s[90:91], s[52:53], s[54:55]
s_cselect_b64 s[58:59], s[44:45], s[46:47]
s_mul_i32 s92, s90, s20
s_add_u32 s92, s92, s58
s_mul_i32 s93, s90, s21
s_add_u32 s93, s93, s59
s_andn2_b32 s71, s71, s70
s_add_u32 s52, s52, s70
s_add_u32 s54, s54, s71
s_mov_b32 s95, s94
g_go_177:
s_add_u32 m0, s51, 0
s_nop 0
buffer_load_dwordx4 v8, s[4:7], s92 offen offset:0 sc1 lds
buffer_load_dwordx4 v9, s[4:7], s92 offen offset:1024 sc1 lds
buffer_load_dwordx4 v10, s[4:7], s92 offen offset:2048 sc1 lds
buffer_load_dwordx4 v11, s[4:7], s92 offen offset:3072 sc1 lds
s_add_u32 m0, s51, 4096
s_nop 0
buffer_load_dwordx4 v12, s[4:7], s92 offen offset:0 sc1 lds
buffer_load_dwordx4 v13, s[4:7], s92 offen offset:1024 sc1 lds
buffer_load_dwordx4 v14, s[4:7], s92 offen offset:2048 sc1 lds
buffer_load_dwordx4 v15, s[4:7], s92 offen offset:3072 sc1 lds
s_add_u32 m0, s51, 8192
s_nop 0
buffer_load_dwordx4 v16, s[4:7], s92 offen offset:0 sc1 lds
buffer_load_dword v24, v22, s[4:7], 0 offen sc1
buffer_store_dword v27, v34, s[4:7], 0 offen
v_mov_b32 v27, s84
s_waitcnt vmcnt(9)
s_barrier
buffer_store_dword v27, v45, s[4:7], s85 offen
buffer_store_dword v27, v44, s[4:7], s85 offen sc1
s_mov_b32 s85, 1879048192
ds_read_b128 v[64:67], v31 offset:0
ds_read_b128 v[68:71], v31 offset:9216
ds_read_b128 v[72:75], v31 offset:18432
ds_read_b128 v[76:79], v31 offset:27648
ds_read_b128 v[80:83], v31 offset:1024
ds_read_b128 v[84:87], v31 offset:10240
ds_read_b128 v[88:91], v31 offset:19456
ds_read_b128 v[92:95], v31 offset:28672
s_waitcnt vmcnt(7)
s_barrier
s_branch g_body_156
g_slow_168:
v_mfma_f32_16x16x32_bf16 v[228:231], a[196:199], v[172:175], v[228:231]
v_rcp_f32 v240, v240
v_mfma_f32_16x16x32_bf16 v[224:227], a[200:203], v[176:179], v[224:227]
v_rcp_f32 v241, v241
v_mfma_f32_16x16x32_bf16 v[228:231], a[200:203], v[180:183], v[228:231]
v_rcp_f32 v242, v242
v_mfma_f32_16x16x32_bf16 v[224:227], a[204:207], v[184:187], v[224:227]
v_rcp_f32 v243, v243
v_mfma_f32_16x16x32_bf16 v[228:231], a[204:207], v[188:191], v[228:231]
v_mul_f32 v240, v220, v240
v_mfma_f32_16x16x32_bf16 v[224:227], a[208:211], v[192:195], v[224:227]
v_mul_f32 v241, v221, v241
v_mfma_f32_16x16x32_bf16 v[228:231], a[208:211], v[196:199], v[228:231]
v_mul_f32 v242, v222, v242
v_mfma_f32_16x16x32_bf16 v[224:227], a[212:215], v[200:203], v[224:227]
v_mul_f32 v243, v223, v243
v_mfma_f32_16x16x32_bf16 v[228:231], a[212:215], v[204:207], v[228:231]
s_nop 5
v_mul_f32 v224, v224, v236
v_mul_f32 v225, v225, v237
v_mul_f32 v226, v226, v238
v_mul_f32 v227, v227, v239
v_mul_f32 v228, v228, v240
v_mul_f32 v229, v229, v241
v_mul_f32 v230, v230, v242
v_mul_f32 v231, v231, v243
v_cvt_pk_bf16_f32 v52, v224, v225
v_cvt_pk_bf16_f32 v53, v226, v227
v_cvt_pk_bf16_f32 v54, v228, v229
v_cvt_pk_bf16_f32 v55, v230, v231
s_nop 0
v_permlane16_swap_b32 v52, v54
v_permlane16_swap_b32 v53, v55
buffer_store_dwordx4 v[52:55], v20, s[4:7], s93 offen sc1
s_mov_b32 s93, 1879048192
s_waitcnt vmcnt(4)
ds_write_b32 v18, v24
s_waitcnt lgkmcnt(0)
s_barrier
ds_read_b32 v33, v32
s_waitcnt lgkmcnt(0)
v_cmp_gt_u32 vcc, s52, v33
v_cmp_gt_u32 s[58:59], s54, v33
s_and_b32 vcc_lo, vcc_lo, s56
s_cselect_b32 s70, 0, 1
s_and_b32 s59, s59, s56
s_cselect_b32 s71, 0, s95
s_or_b32 s76, s70, s71
s_cselect_b32 s10, 268435456, 0
s_cmp_lg_u32 s70, 0
s_cselect_b64 s[72:73], s[52:53], s[54:55]
s_cselect_b64 s[58:59], s[44:45], s[46:47]
s_mul_i32 s74, s72, s20
s_add_u32 s74, s74, s58
s_mul_i32 s75, s72, s21
s_add_u32 s75, s75, s59
s_andn2_b32 s71, s71, s70
s_add_u32 s52, s52, s70
s_add_u32 s54, s54, s71
s_mov_b32 s77, s76
s_cmp_lg_u32 s76, 0
s_cbranch_scc1 g_go_181
v_mov_b32 v27, s90
s_waitcnt vmcnt(0)
s_barrier
s_add_u32 s70, s52, s54
s_cmp_eq_u32 s70, 130
s_cbranch_scc1 g_fin_157
s_cmp_lg_u32 s3, 0
s_cbranch_scc1 sp_ok_183_j
s_mov_b32 s23, 0
buffer_load_dword v33, v22, s[4:7], 0 offen sc1
buffer_store_dword v27, v45, s[4:7], s91 offen
buffer_store_dword v27, v44, s[4:7], s91 offen sc1
s_waitcnt vmcnt(2)
s_branch sp_loop_182_e
sp_loop_182:
buffer_load_dword v33, v22, s[4:7], 0 offen sc1
s_add_u32 s23, s23, 1
s_cmp_gt_u32 s23, 150000
s_cbranch_scc1 sp_bad_184
s_waitcnt vmcnt(0)
sp_loop_182_e:
v_cmp_gt_u32 vcc, s52, v33
v_cmp_gt_u32 s[58:59], s54, v33
s_and_b32 vcc_lo, vcc_lo, s56
s_cbranch_scc0 sp_ok_183
s_cmp_gt_u32 s23, 4
s_cselect_b32 s70, 0, s56
s_cmp_lg_u32 s95, 0
s_cselect_b32 s70, 0, s70
s_or_b32 s59, s59, s70
s_and_b32 s59, s59, s56
s_cbranch_scc0 sp_ok_183
s_sleep 1
s_branch sp_loop_182
sp_bad_184:
s_mov_b32 s98, 1028
s_branch L_fail
sp_ok_183:
ds_write_b32 v18, v33
s_waitcnt lgkmcnt(0)
sp_ok_183_j:
s_barrier
ds_read_b32 v33, v32
s_waitcnt lgkmcnt(0)
s_mov_b32 s91, 1879048192
v_cmp_gt_u32 vcc, s52, v33
v_cmp_gt_u32 s[58:59], s54, v33
s_and_b32 vcc_lo, vcc_lo, s56
s_cselect_b32 s70, 0, 1
s_and_b32 s59, s59, s56
s_cselect_b32 s71, 0, 1
s_or_b32 s76, s70, s71
s_cselect_b32 s10, 268435456, 0
s_cmp_lg_u32 s70, 0
s_cselect_b64 s[72:73], s[52:53], s[54:55]
s_cselect_b64 s[58:59], s[44:45], s[46:47]
s_mul_i32 s74, s72, s20
s_add_u32 s74, s74, s58
s_mul_i32 s75, s72, s21
s_add_u32 s75, s75, s59
s_andn2_b32 s71, s71, s70
s_add_u32 s52, s52, s70
s_add_u32 s54, s54, s71
s_mov_b32 s77, s76
g_go_181:
s_add_u32 m0, s48, 0
s_nop 0
buffer_load_dwordx4 v8, s[4:7], s74 offen offset:0 sc1 lds
buffer_load_dwordx4 v9, s[4:7], s74 offen offset:1024 sc1 lds
buffer_load_dwordx4 v10, s[4:7], s74 offen offset:2048 sc1 lds
buffer_load_dwordx4 v11, s[4:7], s74 offen offset:3072 sc1 lds
s_add_u32 m0, s48, 4096
s_nop 0
buffer_load_dwordx4 v12, s[4:7], s74 offen offset:0 sc1 lds
buffer_load_dwordx4 v13, s[4:7], s74 offen offset:1024 sc1 lds
buffer_load_dwordx4 v14, s[4:7], s74 offen offset:2048 sc1 lds
buffer_load_dwordx4 v15, s[4:7], s74 offen offset:3072 sc1 lds
s_add_u32 m0, s48, 8192
s_nop 0
buffer_load_dwordx4 v16, s[4:7], s74 offen offset:0 sc1 lds
buffer_load_dword v24, v22, s[4:7], 0 offen sc1
buffer_store_dword v27, v34, s[4:7], 0 offen
v_mov_b32 v27, s90
s_waitcnt vmcnt(9)
s_barrier
buffer_store_dword v27, v45, s[4:7], s91 offen
buffer_store_dword v27, v44, s[4:7], s91 offen sc1
s_mov_b32 s91, 1879048192
ds_read_b128 v[64:67], v28 offset:0
ds_read_b128 v[68:71], v28 offset:9216
ds_read_b128 v[72:75], v28 offset:18432
ds_read_b128 v[76:79], v28 offset:27648
ds_read_b128 v[80:83], v28 offset:1024
ds_read_b128 v[84:87], v28 offset:10240
ds_read_b128 v[88:91], v28 offset:19456
ds_read_b128 v[92:95], v28 offset:28672
s_waitcnt vmcnt(7)
s_barrier
s_branch g_body_153
g_fin_157:
buffer_store_dword v27, v45, s[4:7], s91 offen
buffer_store_dword v27, v44, s[4:7], s91 offen sc1
s_endpgm
H_att:
s_lshr_b32 s75, s74, 1
s_and_b32 s76, s74, 1
s_lshl_b32 s44, s75, 2
s_add_u32 s44, s44, s3
s_mul_i32 s52, s76, 32768
s_mul_i32 s46, s76, 50331648
s_add_u32 s46, s46, 10821632
s_mul_i32 s49, s44, 24576
s_add_u32 s46, s46, s49
s_mul_i32 s47, s76, 8388608
s_add_u32 s47, s47, 111484928
s_mul_i32 s49, s44, 4096
s_add_u32 s47, s47, s49
s_mul_i32 s48, s76, 16777216
s_add_u32 s48, s48, 128262144
s_mul_i32 s49, s44, 8192
s_add_u32 s48, s48, s49
s_mov_b32 s64, s47
s_mov_b32 s50, 0x3e0293ee
v_lshlrev_b32 v8, 4, v0
v_lshlrev_b32 v10, 3, v0
v_add_u32 v10, 2048, v10
v_bfe_u32 v1, v0, 2, 2
v_and_b32 v2, 1, v0
v_lshl_add_u32 v1, v1, 1, v2
v_lshlrev_b32 v1, 4, v1
v_lshrrev_b32 v2, 4, v0
v_lshl_add_u32 v9, v2, 7, v1
v_and_b32 v1, 15, v0
v_lshlrev_b32 v2, 2, v2
v_sub_u32 v1, v1, v2
v_cmp_le_i32 s[56:57], 0, v1
v_cmp_le_i32 s[58:59], 1, v1
v_cmp_le_i32 s[60:61], 2, v1
v_cmp_le_i32 s[62:63], 3, v1
v_mov_b32 v16, 0xff800000
v_mov_b64 v[50:51], 0
v_mov_b32 v57, 0
v_mov_b32 v58, 0
v_mov_b32 v61, 0
v_mov_b32 v62, 0
v_min_u32 v1, 5, v0
v_lshrrev_b32 v2, 1, v1
v_lshlrev_b32 v2, 8, v2
v_and_b32 v1, 1, v1
v_mul_u32_u24 v1, 7, v1
v_add_u32 v1, v1, v2
s_lshl_b32 s49, s44, 3
v_add_u32 v1, s49, v1
v_mul_u32_u24 v1, 43691, v1
v_lshrrev_b32 v1, 19, v1
v_mul_u32_u24 v1, 128, v1
v_add_u32 v1, 2048, v1
v_mov_b32 v7, 2147483632
v_cmp_gt_u32 vcc, 6, v0
s_nop 1
v_cndmask_b32 v11, v7, v1, vcc
s_mul_i32 s49, s44, 128
s_add_u32 s49, s49, 10240
v_mov_b32 v1, s49
v_mov_b32 v7, 2147483632
v_cmp_gt_u32 vcc, 1, v0
s_nop 1
v_cndmask_b32 v124, v7, v1, vcc
v_mov_b64 v[120:121], 0
v_mov_b64 v[122:123], 0
s_mul_i32 s49, s44, 128
s_add_u32 s49, s49, 14336
v_mov_b32 v1, s49
v_mov_b32 v2, 2147483632
v_cmp_eq_u32 vcc, 0, v0
s_nop 1
v_cndmask_b32 v22, v2, v1, vcc
v_add_u32 v23, 65536, v22
s_mov_b32 s45, 0
s_getpc_b64 s[96:97]
pc_185:
s_add_u32 s96, s96, L_writers-pc_185
s_addc_u32 s97, s97, 0
v_subrev_u32 v2, 0, v11
v_lshrrev_b32 v2, 7, v2
v_cmp_gt_u32 vcc, 0x200, v2
s_nop 1
v_cndmask_b32 v2, 0, v2, vcc
global_load_ubyte v2, v2, s[96:97]
s_mov_b32 s12, s40
s_and_b32 s13, s41, 0xffff
s_mov_b32 s14, 256
s_mov_b32 s15, 0x20000
v_lshlrev_b32 v14, 2, v0
v_add_u32 v15, 128, v14
v_cmp_le_u32 vcc, 2, v0
s_nop 1
v_cndmask_b32 v14, v14, v15, vcc
v_mov_b32 v15, 192
v_cmp_eq_u32 vcc, 8, v0
s_nop 1
v_cndmask_b32 v14, v14, v15, vcc
v_mov_b32 v15, 2147483632
v_cmp_lt_u32 vcc, 8, v0
s_nop 1
v_cndmask_b32 v14, v14, v15, vcc
s_mov_b32 s98, 0
wi_loop_186:
buffer_load_dword v15, v14, s[12:15], 0 offen sc1
s_add_u32 s98, s98, 1
s_cmp_gt_u32 s98, 150000
s_cbranch_scc1 wi_bad_188
s_waitcnt vmcnt(0)
v_cmp_eq_u32 vcc, 32, v15
s_nop 0
s_and_b32 s97, vcc_lo, 0x1ff
s_cmp_eq_u32 s97, 0x1ff
s_cbranch_scc1 wi_ok_187
v_cmp_lt_u32 vcc, 32, v15
s_nop 0
s_and_b32 s96, vcc_lo, 0xff
s_cselect_b32 s96, 0x100, 0
s_and_b32 s96, s96, s97
s_cbranch_scc1 wi_over_189
s_sleep 8
s_branch wi_loop_186
wi_bad_188:
s_mov_b32 s98, 512
s_branch L_fail
wi_over_189:
s_mov_b32 s100, 255
wi_ok_187:
v_add_u32 v3, 65536, v11
v_cmp_eq_u32 vcc, s100, v2
s_nop 1
v_cndmask_b32 v11, v11, v3, vcc
v_mov_b32 v3, 2147483632
s_cmp_lg_u32 s100, 255
s_cselect_b64 vcc, -1, 0
v_cndmask_b32 v22, v22, v3, vcc
s_mov_b32 s8, s42
s_and_b32 s9, s43, 0xffff
s_mov_b32 s10, 0
s_mov_b32 s11, 0x20000
s_add_u32 s49, s47, 0
buffer_store_dwordx4 v[120:123], v8, s[4:7], s49 offen offset:0 sc1
buffer_store_dwordx4 v[120:123], v8, s[4:7], s49 offen offset:1024 sc1
buffer_store_dwordx4 v[120:123], v8, s[4:7], s49 offen offset:2048 sc1
buffer_store_dwordx4 v[120:123], v8, s[4:7], s49 offen offset:3072 sc1
s_add_u32 s49, s47, 131072
buffer_store_dwordx4 v[120:123], v8, s[4:7], s49 offen offset:0 sc1
buffer_store_dwordx4 v[120:123], v8, s[4:7], s49 offen offset:1024 sc1
buffer_store_dwordx4 v[120:123], v8, s[4:7], s49 offen offset:2048 sc1
buffer_store_dwordx4 v[120:123], v8, s[4:7], s49 offen offset:3072 sc1
s_add_u32 s49, s47, 262144
buffer_store_dwordx4 v[120:123], v8, s[4:7], s49 offen offset:0 sc1
buffer_store_dwordx4 v[120:123], v8, s[4:7], s49 offen offset:1024 sc1
buffer_store_dwordx4 v[120:123], v8, s[4:7], s49 offen offset:2048 sc1
buffer_store_dwordx4 v[120:123], v8, s[4:7], s49 offen offset:3072 sc1
s_add_u32 s49, s47, 393216
buffer_store_dwordx4 v[120:123], v8, s[4:7], s49 offen offset:0 sc1
buffer_store_dwordx4 v[120:123], v8, s[4:7], s49 offen offset:1024 sc1
buffer_store_dwordx4 v[120:123], v8, s[4:7], s49 offen offset:2048 sc1
buffer_store_dwordx4 v[120:123], v8, s[4:7], s49 offen offset:3072 sc1
s_add_u32 s49, s47, 524288
buffer_store_dwordx4 v[120:123], v8, s[4:7], s49 offen offset:0 sc1
buffer_store_dwordx4 v[120:123], v8, s[4:7], s49 offen offset:1024 sc1
buffer_store_dwordx4 v[120:123], v8, s[4:7], s49 offen offset:2048 sc1
buffer_store_dwordx4 v[120:123], v8, s[4:7], s49 offen offset:3072 sc1
s_add_u32 s49, s47, 655360
buffer_store_dwordx4 v[120:123], v8, s[4:7], s49 offen offset:0 sc1
buffer_store_dwordx4 v[120:123], v8, s[4:7], s49 offen offset:1024 sc1
buffer_store_dwordx4 v[120:123], v8, s[4:7], s49 offen offset:2048 sc1
buffer_store_dwordx4 v[120:123], v8, s[4:7], s49 offen offset:3072 sc1
s_add_u32 s49, s47, 786432
buffer_store_dwordx4 v[120:123], v8, s[4:7], s49 offen offset:0 sc1
buffer_store_dwordx4 v[120:123], v8, s[4:7], s49 offen offset:1024 sc1
buffer_store_dwordx4 v[120:123], v8, s[4:7], s49 offen offset:2048 sc1
buffer_store_dwordx4 v[120:123], v8, s[4:7], s49 offen offset:3072 sc1
s_add_u32 s49, s47, 917504
buffer_store_dwordx4 v[120:123], v8, s[4:7], s49 offen offset:0 sc1
buffer_store_dwordx4 v[120:123], v8, s[4:7], s49 offen offset:1024 sc1
buffer_store_dwordx4 v[120:123], v8, s[4:7], s49 offen offset:2048 sc1
buffer_store_dwordx4 v[120:123], v8, s[4:7], s49 offen offset:3072 sc1
s_waitcnt vmcnt(0)
v_mov_b32 v125, 8
buffer_store_dword v125, v124, s[4:7], s52 offen sc1
s_mov_b32 s98, 0
sp_loop_192:
buffer_load_dword v24, v11, s[4:7], s52 offen sc1
s_add_u32 s98, s98, 1
s_cmp_gt_u32 s98, 150000
s_cbranch_scc1 sp_bad_194
s_waitcnt vmcnt(0)
v_cmp_gt_u32 vcc, 1, v24
s_nop 0
s_and_b32 vcc_lo, vcc_lo, 0x3f
s_cbranch_scc0 sp_ok_193
s_sleep 2
s_branch sp_loop_192
sp_bad_194:
s_mov_b32 s98, 1536
s_branch L_fail
sp_ok_193:
s_add_u32 s54, s46, 0
buffer_load_dwordx4 a[0:3], v8, s[4:7], s54 offen offset:0 sc1
buffer_load_dwordx4 a[4:7], v8, s[4:7], s54 offen offset:1024 sc1
buffer_load_dwordx4 a[8:11], v8, s[4:7], s54 offen offset:2048 sc1
buffer_load_dwordx4 a[12:15], v8, s[4:7], s54 offen offset:3072 sc1
s_add_u32 s54, s46, 4096
buffer_load_dwordx4 a[16:19], v8, s[4:7], s54 offen offset:0 sc1
buffer_load_dwordx4 a[20:23], v8, s[4:7], s54 offen offset:1024 sc1
buffer_load_dwordx4 a[24:27], v8, s[4:7], s54 offen offset:2048 sc1
buffer_load_dwordx4 a[28:31], v8, s[4:7], s54 offen offset:3072 sc1
s_add_u32 s54, s46, 8192
buffer_load_dwordx4 a[32:35], v8, s[4:7], s54 offen offset:0 sc1
buffer_load_dwordx4 a[36:39], v8, s[4:7], s54 offen offset:1024 sc1
buffer_load_dwordx4 a[40:43], v8, s[4:7], s54 offen offset:2048 sc1
buffer_load_dwordx4 a[44:47], v8, s[4:7], s54 offen offset:3072 sc1
s_add_u32 s54, s46, 12288
buffer_load_dwordx4 a[48:51], v8, s[4:7], s54 offen offset:0 sc1
buffer_load_dwordx4 a[52:55], v8, s[4:7], s54 offen offset:1024 sc1
buffer_load_dwordx4 a[56:59], v8, s[4:7], s54 offen offset:2048 sc1
buffer_load_dwordx4 a[60:63], v8, s[4:7], s54 offen offset:3072 sc1
s_add_u32 s54, s46, 16384
buffer_load_dwordx4 a[64:67], v8, s[4:7], s54 offen offset:0 sc1
buffer_load_dwordx4 a[68:71], v8, s[4:7], s54 offen offset:1024 sc1
buffer_load_dwordx4 a[72:75], v8, s[4:7], s54 offen offset:2048 sc1
buffer_load_dwordx4 a[76:79], v8, s[4:7], s54 offen offset:3072 sc1
s_add_u32 s54, s46, 20480
buffer_load_dwordx4 a[80:83], v8, s[4:7], s54 offen offset:0 sc1
buffer_load_dwordx4 a[84:87], v8, s[4:7], s54 offen offset:1024 sc1
buffer_load_dwordx4 a[88:91], v8, s[4:7], s54 offen offset:2048 sc1
buffer_load_dwordx4 a[92:95], v8, s[4:7], s54 offen offset:3072 sc1
s_waitcnt vmcnt(0)
buffer_load_dwordx4 v[64:67], v9, s[4:7], s47 offen offset:0 sc1
buffer_load_dwordx4 v[68:71], v9, s[4:7], s47 offen offset:512 sc1
buffer_load_dwordx4 v[72:75], v9, s[4:7], s47 offen offset:1024 sc1
buffer_load_dwordx4 v[76:79], v9, s[4:7], s47 offen offset:1536 sc1
buffer_load_dwordx2 v[80:81], v10, s[4:7], s47 offen offset:0 sc1
buffer_load_dwordx2 v[82:83], v10, s[4:7], s47 offen offset:512 sc1
buffer_load_dwordx2 v[84:85], v10, s[4:7], s47 offen offset:1024 sc1
buffer_load_dwordx2 v[86:87], v10, s[4:7], s47 offen offset:1536 sc1
v_mfma_f32_16x16x32_bf16 v[28:31], a[32:35], a[0:3], 0
v_mfma_f32_16x16x32_bf16 v[32:35], a[32:35], a[4:7], 0
v_mfma_f32_16x16x32_bf16 v[36:39], a[36:39], a[4:7], 0
v_mfma_f32_16x16x32_bf16 v[28:31], a[40:43], a[8:11], v[28:31]
v_mfma_f32_16x16x32_bf16 v[32:35], a[40:43], a[12:15], v[32:35]
v_mfma_f32_16x16x32_bf16 v[36:39], a[44:47], a[12:15], v[36:39]
v_mfma_f32_16x16x32_bf16 v[28:31], a[48:51], a[16:19], v[28:31]
v_mfma_f32_16x16x32_bf16 v[32:35], a[48:51], a[20:23], v[32:35]
v_mfma_f32_16x16x32_bf16 v[36:39], a[52:55], a[20:23], v[36:39]
v_mfma_f32_16x16x32_bf16 v[28:31], a[56:59], a[24:27], v[28:31]
v_mfma_f32_16x16x32_bf16 v[32:35], a[56:59], a[28:31], v[32:35]
v_mfma_f32_16x16x32_bf16 v[36:39], a[60:63], a[28:31], v[36:39]
s_add_u32 s53, s45, 1
s_nop 4
v_cndmask_b32 v28, v16, v28, s[56:57]
v_cndmask_b32 v29, v16, v29, s[58:59]
v_cndmask_b32 v30, v16, v30, s[60:61]
v_cndmask_b32 v31, v16, v31, s[62:63]
v_cndmask_b32 v36, v16, v36, s[56:57]
v_cndmask_b32 v37, v16, v37, s[58:59]
v_cndmask_b32 v38, v16, v38, s[60:61]
v_cndmask_b32 v39, v16, v39, s[62:63]
v_max3_f32 v18, v32, v33, v34
v_max3_f32 v17, v28, v29, v30
v_max3_f32 v18, v18, v35, v36
v_max_f32 v17, v17, v31
v_max3_f32 v18, v18, v37, v38
v_max_f32 v18, v18, v39
s_waitcnt vmcnt(0)
att_loop_190:
s_mov_b32 s98, 0
s_bfe_u32 s55, s45, 0x10003
s_xor_b32 s55, s55, 1
att_sp_195:
v_xor_b32 v14, s55, v64
v_xor_b32 v19, s55, v80
v_bitop3_b32 v14, v14, v68, s55 bitop3:0xf6
v_bitop3_b32 v19, v19, v82, s55 bitop3:0xf6
v_bitop3_b32 v14, v14, v72, s55 bitop3:0xf6
v_bitop3_b32 v19, v19, v84, s55 bitop3:0xf6
v_bitop3_b32 v14, v14, v76, s55 bitop3:0xf6
v_bitop3_b32 v19, v19, v86, s55 bitop3:0xf6
v_or_b32 v14, v14, v19
v_and_b32 v14, 1, v14
v_cmp_ne_u32 vcc, 0, v14
s_nop 0
s_cbranch_vccz att_ok_196
s_sleep 2
buffer_load_dwordx4 v[64:67], v9, s[4:7], s47 offen offset:0 sc1
buffer_load_dwordx4 v[68:71], v9, s[4:7], s47 offen offset:512 sc1
buffer_load_dwordx4 v[72:75], v9, s[4:7], s47 offen offset:1024 sc1
buffer_load_dwordx4 v[76:79], v9, s[4:7], s47 offen offset:1536 sc1
buffer_load_dwordx2 v[80:81], v10, s[4:7], s47 offen offset:0 sc1
buffer_load_dwordx2 v[82:83], v10, s[4:7], s47 offen offset:512 sc1
buffer_load_dwordx2 v[84:85], v10, s[4:7], s47 offen offset:1024 sc1
buffer_load_dwordx2 v[86:87], v10, s[4:7], s47 offen offset:1536 sc1
buffer_load_dword v24, v11, s[4:7], s52 offen sc1
s_add_u32 s98, s98, 1
s_cmp_gt_u32 s98, 150000
s_cbranch_scc1 att_bad_197
s_waitcnt vmcnt(0)
s_branch att_sp_195
att_bad_197:
s_mov_b32 s98, 1537
s_branch L_fail
att_ok_196:
s_add_u32 s49, s53, 1
v_cmp_gt_u32 vcc, s49, v24
s_nop 0
s_and_b32 vcc_lo, vcc_lo, 0x3f
s_cselect_b32 s51, 0, 1
s_cselect_b32 s10, 0, 268435456
s_add_u32 s46, s46, 786432
s_and_b32 s49, s53, 7
s_mul_i32 s49, s49, 131072
s_add_u32 s47, s64, s49
v_mfma_f32_16x16x32_bf16 v[40:43], v[64:67], a[0:3], 0
v_mfma_f32_16x16x32_bf16 v[44:47], v[64:67], a[4:7], 0
s_add_u32 s54, s46, 0
buffer_load_dwordx4 a[96:99], v8, s[8:11], s54 offen offset:0 sc1
buffer_load_dwordx4 a[100:103], v8, s[8:11], s54 offen offset:1024 sc1
v_mfma_f32_16x16x32_bf16 v[40:43], v[68:71], a[8:11], v[40:43]
v_mfma_f32_16x16x32_bf16 v[44:47], v[68:71], a[12:15], v[44:47]
buffer_load_dwordx4 a[104:107], v8, s[8:11], s54 offen offset:2048 sc1
buffer_load_dwordx4 a[108:111], v8, s[8:11], s54 offen offset:3072 sc1
v_mfma_f32_16x16x32_bf16 v[40:43], v[72:75], a[16:19], v[40:43]
v_mfma_f32_16x16x32_bf16 v[44:47], v[72:75], a[20:23], v[44:47]
s_add_u32 s54, s46, 4096
buffer_load_dwordx4 a[112:115], v8, s[8:11], s54 offen offset:0 sc1
buffer_load_dwordx4 a[116:119], v8, s[8:11], s54 offen offset:1024 sc1
v_mfma_f32_16x16x32_bf16 v[40:43], v[76:79], a[24:27], v[40:43]
v_mfma_f32_16x16x32_bf16 v[44:47], v[76:79], a[28:31], v[44:47]
buffer_load_dwordx4 a[120:123], v8, s[8:11], s54 offen offset:2048 sc1
buffer_load_dwordx4 a[124:127], v8, s[8:11], s54 offen offset:3072 sc1
s_add_u32 s54, s46, 8192
buffer_load_dwordx4 a[128:131], v8, s[8:11], s54 offen offset:0 sc1
buffer_load_dwordx4 a[132:135], v8, s[8:11], s54 offen offset:1024 sc1
s_nop 1
v_max3_f32 v17, v17, v40, v41
v_max3_f32 v18, v18, v44, v45
s_nop 1
v_permlane32_swap_b32 v17, v18
v_max_f32 v17, v17, v18
v_mov_b32 v19, v17
s_nop 1
v_permlane16_swap_b32 v17, v19
v_max_f32 v17, v17, v19
v_mul_f32 v17, s50, v17
v_mov_b32 v18, v17
buffer_load_dwordx4 a[136:139], v8, s[8:11], s54 offen offset:2048 sc1
s_nop 0
v_permlane32_swap_b32 v17, v18
v_fma_f32 v28, v28, s50, -v17
v_fma_f32 v29, v29, s50, -v17
v_fma_f32 v30, v30, s50, -v17
v_fma_f32 v31, v31, s50, -v17
v_fma_f32 v40, v40, s50, -v17
v_fma_f32 v41, v41, s50, -v17
v_fma_f32 v32, v32, s50, -v18
v_fma_f32 v33, v33, s50, -v18
v_fma_f32 v34, v34, s50, -v18
v_fma_f32 v35, v35, s50, -v18
v_fma_f32 v36, v36, s50, -v18
v_fma_f32 v37, v37, s50, -v18
v_fma_f32 v38, v38, s50, -v18
v_fma_f32 v39, v39, s50, -v18
v_fma_f32 v44, v44, s50, -v18
v_fma_f32 v45, v45, s50, -v18
buffer_load_dwordx4 a[140:143], v8, s[8:11], s54 offen offset:3072 sc1
v_exp_f32 v28, v28
v_exp_f32 v29, v29
v_exp_f32 v30, v30
v_exp_f32 v31, v31
v_exp_f32 v40, v40
v_exp_f32 v41, v41
s_add_u32 s54, s46, 12288
buffer_load_dwordx4 a[144:147], v8, s[8:11], s54 offen offset:0 sc1
v_exp_f32 v32, v32
v_exp_f32 v33, v33
v_exp_f32 v34, v34
v_exp_f32 v35, v35
v_exp_f32 v36, v36
v_exp_f32 v37, v37
v_exp_f32 v38, v38
v_exp_f32 v39, v39
v_exp_f32 v44, v44
v_exp_f32 v45, v45
buffer_load_dwordx4 a[148:151], v8, s[8:11], s54 offen offset:1024 sc1
v_add_f32 v17, v28, v29
v_add_f32 v18, v32, v33
v_add_f32 v17, v17, v30
v_add_f32 v18, v18, v34
v_add_f32 v17, v17, v31
v_add_f32 v18, v18, v35
v_add_f32 v17, v17, v40
v_add_f32 v18, v18, v36
v_add_f32 v17, v17, v41
v_add_f32 v18, v18, v37
v_add_f32 v18, v18, v38
v_add_f32 v18, v18, v39
v_add_f32 v18, v18, v44
v_add_f32 v18, v18, v45
buffer_load_dwordx4 a[152:155], v8, s[8:11], s54 offen offset:2048 sc1
s_nop 0
v_permlane32_swap_b32 v17, v18
v_add_f32 v17, v17, v18
v_mov_b32 v19, v17
s_nop 1
v_permlane16_swap_b32 v17, v19
v_add_f32 v17, v17, v19
v_rcp_f32 v17, v17
buffer_load_dwordx4 a[156:159], v8, s[8:11], s54 offen offset:3072 sc1
v_mov_b32 v18, v17
s_nop 1
v_permlane32_swap_b32 v17, v18
v_mul_f32 v28, v28, v17
v_mul_f32 v29, v29, v17
v_mul_f32 v30, v30, v17
v_mul_f32 v31, v31, v17
v_mul_f32 v40, v40, v17
v_mul_f32 v41, v41, v17
v_cvt_pk_bf16_f32 v48, v28, v29
v_cvt_pk_bf16_f32 v49, v30, v31
v_cvt_pk_bf16_f32 v56, v40, v41
v_cvt_pk_bf16_f32 v59, v40, v41
v_mul_f32 v32, v32, v18
v_mul_f32 v33, v33, v18
v_mul_f32 v34, v34, v18
v_mul_f32 v35, v35, v18
v_mul_f32 v36, v36, v18
v_mul_f32 v37, v37, v18
v_mul_f32 v38, v38, v18
v_mul_f32 v39, v39, v18
v_mul_f32 v44, v44, v18
v_mul_f32 v45, v45, v18
v_cvt_pk_bf16_f32 v52, v32, v33
v_cvt_pk_bf16_f32 v53, v34, v35
v_cvt_pk_bf16_f32 v54, v36, v37
v_cvt_pk_bf16_f32 v55, v38, v39
v_cvt_pk_bf16_f32 v60, v44, v45
v_cvt_pk_bf16_f32 v63, v44, v45
s_add_u32 s49, s48, 4096
s_waitcnt vmcnt(17)
buffer_load_dword v24, v11, s[4:7], s52 offen sc1
v_mfma_f32_16x16x32_bf16 v[128:131], a[64:67], v[48:51], 0
v_mfma_f32_16x16x32_bf16 v[132:135], a[68:71], v[48:51], 0
v_mfma_f32_16x16x16_bf16 v[128:131], v[80:81], v[56:57], v[128:131]
v_mfma_f32_16x16x16_bf16 v[132:135], v[80:81], v[58:59], v[132:135]
v_mfma_f32_16x16x32_bf16 v[136:139], a[72:75], v[48:51], 0
v_mfma_f32_16x16x32_bf16 v[140:143], a[76:79], v[48:51], 0
v_mfma_f32_16x16x16_bf16 v[136:139], v[82:83], v[56:57], v[136:139]
v_mfma_f32_16x16x16_bf16 v[140:143], v[82:83], v[58:59], v[140:143]
v_mfma_f32_16x16x32_bf16 v[144:147], a[80:83], v[48:51], 0
s_nop 1
v_cvt_pk_bf16_f32 v88, v128, v129
v_mfma_f32_16x16x32_bf16 v[148:151], a[84:87], v[48:51], 0
v_cvt_pk_bf16_f32 v89, v130, v131
v_mfma_f32_16x16x16_bf16 v[144:147], v[84:85], v[56:57], v[144:147]
v_cvt_pk_bf16_f32 v90, v132, v133
v_mfma_f32_16x16x16_bf16 v[148:151], v[84:85], v[58:59], v[148:151]
v_cvt_pk_bf16_f32 v91, v134, v135
buffer_store_dwordx4 v[88:91], v8, s[4:7], s48 offen offset:0 sc1
v_mfma_f32_16x16x32_bf16 v[152:155], a[88:91], v[48:51], 0
v_cvt_pk_bf16_f32 v92, v136, v137
v_mfma_f32_16x16x32_bf16 v[156:159], a[92:95], v[48:51], 0
v_cvt_pk_bf16_f32 v93, v138, v139
v_mfma_f32_16x16x16_bf16 v[152:155], v[86:87], v[56:57], v[152:155]
v_cvt_pk_bf16_f32 v94, v140, v141
v_mfma_f32_16x16x16_bf16 v[156:159], v[86:87], v[58:59], v[156:159]
v_cvt_pk_bf16_f32 v95, v142, v143
buffer_store_dwordx4 v[92:95], v8, s[4:7], s48 offen offset:2048 sc1
v_mfma_f32_16x16x32_bf16 v[160:163], a[64:67], v[52:55], 0
v_cvt_pk_bf16_f32 v96, v144, v145
v_mfma_f32_16x16x32_bf16 v[164:167], a[68:71], v[52:55], 0
v_cvt_pk_bf16_f32 v97, v146, v147
v_mfma_f32_16x16x16_bf16 v[160:163], v[80:81], v[60:61], v[160:163]
v_cvt_pk_bf16_f32 v98, v148, v149
v_mfma_f32_16x16x16_bf16 v[164:167], v[80:81], v[62:63], v[164:167]
v_cvt_pk_bf16_f32 v99, v150, v151
buffer_store_dwordx4 v[96:99], v8, s[4:7], s49 offen offset:0 sc1
v_mfma_f32_16x16x32_bf16 v[168:171], a[72:75], v[52:55], 0
v_cvt_pk_bf16_f32 v100, v152, v153
v_mfma_f32_16x16x32_bf16 v[172:175], a[76:79], v[52:55], 0
v_cvt_pk_bf16_f32 v101, v154, v155
v_mfma_f32_16x16x16_bf16 v[168:171], v[82:83], v[60:61], v[168:171]
v_cvt_pk_bf16_f32 v102, v156, v157
v_mfma_f32_16x16x16_bf16 v[172:175], v[82:83], v[62:63], v[172:175]
v_cvt_pk_bf16_f32 v103, v158, v159
buffer_store_dwordx4 v[100:103], v8, s[4:7], s49 offen offset:2048 sc1
v_mfma_f32_16x16x32_bf16 v[176:179], a[80:83], v[52:55], 0
v_cvt_pk_bf16_f32 v104, v160, v161
v_mfma_f32_16x16x32_bf16 v[180:183], a[84:87], v[52:55], 0
v_cvt_pk_bf16_f32 v105, v162, v163
v_mfma_f32_16x16x16_bf16 v[176:179], v[84:85], v[60:61], v[176:179]
v_cvt_pk_bf16_f32 v106, v164, v165
v_mfma_f32_16x16x16_bf16 v[180:183], v[84:85], v[62:63], v[180:183]
v_cvt_pk_bf16_f32 v107, v166, v167
buffer_store_dwordx4 v[104:107], v8, s[4:7], s48 offen offset:1024 sc1
v_mfma_f32_16x16x32_bf16 v[184:187], a[88:91], v[52:55], 0
v_cvt_pk_bf16_f32 v108, v168, v169
v_mfma_f32_16x16x32_bf16 v[188:191], a[92:95], v[52:55], 0
v_cvt_pk_bf16_f32 v109, v170, v171
v_mfma_f32_16x16x16_bf16 v[184:187], v[86:87], v[60:61], v[184:187]
v_cvt_pk_bf16_f32 v110, v172, v173
v_mfma_f32_16x16x16_bf16 v[188:191], v[86:87], v[62:63], v[188:191]
v_cvt_pk_bf16_f32 v111, v174, v175
buffer_store_dwordx4 v[108:111], v8, s[4:7], s48 offen offset:3072 sc1
v_cvt_pk_bf16_f32 v112, v176, v177
v_cvt_pk_bf16_f32 v113, v178, v179
v_cvt_pk_bf16_f32 v114, v180, v181
v_cvt_pk_bf16_f32 v115, v182, v183
buffer_store_dwordx4 v[112:115], v8, s[4:7], s49 offen offset:1024 sc1
v_cvt_pk_bf16_f32 v116, v184, v185
v_cvt_pk_bf16_f32 v117, v186, v187
v_cvt_pk_bf16_f32 v118, v188, v189
v_cvt_pk_bf16_f32 v119, v190, v191
buffer_store_dwordx4 v[116:119], v8, s[4:7], s49 offen offset:3072 sc1
s_add_u32 s54, s46, 16384
buffer_load_dwordx4 a[160:163], v8, s[8:11], s54 offen offset:0 sc1
buffer_load_dwordx4 a[164:167], v8, s[8:11], s54 offen offset:1024 sc1
buffer_load_dwordx4 a[168:171], v8, s[8:11], s54 offen offset:2048 sc1
buffer_load_dwordx4 a[172:175], v8, s[8:11], s54 offen offset:3072 sc1
s_add_u32 s48, s48, 262144
v_mov_b32 v15, s53
s_mov_b32 s45, s53
s_cmp_eq_u32 s51, 0
s_cbranch_scc1 att_nopre_198
s_waitcnt vmcnt(13)
v_mfma_f32_16x16x32_bf16 v[28:31], a[128:131], a[96:99], 0
v_mfma_f32_16x16x32_bf16 v[32:35], a[128:131], a[100:103], 0
v_mfma_f32_16x16x32_bf16 v[36:39], a[132:135], a[100:103], 0
v_mfma_f32_16x16x32_bf16 v[28:31], a[136:139], a[104:107], v[28:31]
v_mfma_f32_16x16x32_bf16 v[32:35], a[136:139], a[108:111], v[32:35]
v_mfma_f32_16x16x32_bf16 v[36:39], a[140:143], a[108:111], v[36:39]
v_mfma_f32_16x16x32_bf16 v[28:31], a[144:147], a[112:115], v[28:31]
v_mfma_f32_16x16x32_bf16 v[32:35], a[144:147], a[116:119], v[32:35]
v_mfma_f32_16x16x32_bf16 v[36:39], a[148:151], a[116:119], v[36:39]
v_mfma_f32_16x16x32_bf16 v[28:31], a[152:155], a[120:123], v[28:31]
v_mfma_f32_16x16x32_bf16 v[32:35], a[152:155], a[124:127], v[32:35]
v_mfma_f32_16x16x32_bf16 v[36:39], a[156:159], a[124:127], v[36:39]
s_add_u32 s53, s45, 1
s_nop 4
v_cndmask_b32 v28, v16, v28, s[56:57]
v_cndmask_b32 v29, v16, v29, s[58:59]
v_cndmask_b32 v30, v16, v30, s[60:61]
v_cndmask_b32 v31, v16, v31, s[62:63]
v_cndmask_b32 v36, v16, v36, s[56:57]
v_cndmask_b32 v37, v16, v37, s[58:59]
v_cndmask_b32 v38, v16, v38, s[60:61]
v_cndmask_b32 v39, v16, v39, s[62:63]
v_max3_f32 v18, v32, v33, v34
v_max3_f32 v17, v28, v29, v30
v_max3_f32 v18, v18, v35, v36
v_max_f32 v17, v17, v31
v_max3_f32 v18, v18, v37, v38
v_max_f32 v18, v18, v39
buffer_load_dwordx4 v[64:67], v9, s[4:7], s47 offen offset:0 sc1
buffer_load_dwordx4 v[68:71], v9, s[4:7], s47 offen offset:512 sc1
buffer_load_dwordx4 v[72:75], v9, s[4:7], s47 offen offset:1024 sc1
buffer_load_dwordx4 v[76:79], v9, s[4:7], s47 offen offset:1536 sc1
buffer_load_dwordx2 v[80:81], v10, s[4:7], s47 offen offset:0 sc1
buffer_load_dwordx2 v[82:83], v10, s[4:7], s47 offen offset:512 sc1
buffer_load_dwordx2 v[84:85], v10, s[4:7], s47 offen offset:1024 sc1
buffer_load_dwordx2 v[86:87], v10, s[4:7], s47 offen offset:1536 sc1
s_waitcnt vmcnt(12)
buffer_store_dword v15, v23, s[4:7], s52 offen
buffer_store_dword v15, v22, s[4:7], s52 offen sc1
s_add_u32 s54, s46, 20480
buffer_load_dwordx4 a[176:179], v8, s[8:11], s54 offen offset:0 sc1
buffer_load_dwordx4 a[180:183], v8, s[8:11], s54 offen offset:1024 sc1
buffer_load_dwordx4 a[184:187], v8, s[8:11], s54 offen offset:2048 sc1
buffer_load_dwordx4 a[188:191], v8, s[8:11], s54 offen offset:3072 sc1
s_add_u32 s49, s45, 8
v_mov_b32 v125, s49
buffer_store_dword v125, v124, s[4:7], s52 offen sc1
s_waitcnt vmcnt(7)
att_j2_199:
s_mov_b32 s98, 0
s_bfe_u32 s55, s45, 0x10003
s_xor_b32 s55, s55, 1
att_sp_200:
v_xor_b32 v14, s55, v64
v_xor_b32 v19, s55, v80
v_bitop3_b32 v14, v14, v68, s55 bitop3:0xf6
v_bitop3_b32 v19, v19, v82, s55 bitop3:0xf6
v_bitop3_b32 v14, v14, v72, s55 bitop3:0xf6
v_bitop3_b32 v19, v19, v84, s55 bitop3:0xf6
v_bitop3_b32 v14, v14, v76, s55 bitop3:0xf6
v_bitop3_b32 v19, v19, v86, s55 bitop3:0xf6
v_or_b32 v14, v14, v19
v_and_b32 v14, 1, v14
v_cmp_ne_u32 vcc, 0, v14
s_nop 0
s_cbranch_vccz att_ok_201
s_sleep 2
buffer_load_dwordx4 v[64:67], v9, s[4:7], s47 offen offset:0 sc1
buffer_load_dwordx4 v[68:71], v9, s[4:7], s47 offen offset:512 sc1
buffer_load_dwordx4 v[72:75], v9, s[4:7], s47 offen offset:1024 sc1
buffer_load_dwordx4 v[76:79], v9, s[4:7], s47 offen offset:1536 sc1
buffer_load_dwordx2 v[80:81], v10, s[4:7], s47 offen offset:0 sc1
buffer_load_dwordx2 v[82:83], v10, s[4:7], s47 offen offset:512 sc1
buffer_load_dwordx2 v[84:85], v10, s[4:7], s47 offen offset:1024 sc1
buffer_load_dwordx2 v[86:87], v10, s[4:7], s47 offen offset:1536 sc1
buffer_load_dword v24, v11, s[4:7], s52 offen sc1
s_add_u32 s98, s98, 1
s_cmp_gt_u32 s98, 150000
s_cbranch_scc1 att_bad_202
s_waitcnt vmcnt(0)
s_branch att_sp_200
att_bad_202:
s_mov_b32 s98, 1537
s_branch L_fail
att_ok_201:
s_add_u32 s49, s53, 1
v_cmp_gt_u32 vcc, s49, v24
s_nop 0
s_and_b32 vcc_lo, vcc_lo, 0x3f
s_cselect_b32 s51, 0, 1
s_cselect_b32 s10, 0, 268435456
s_add_u32 s46, s46, 786432
s_and_b32 s49, s53, 7
s_mul_i32 s49, s49, 131072
s_add_u32 s47, s64, s49
v_mfma_f32_16x16x32_bf16 v[40:43], v[64:67], a[96:99], 0
v_mfma_f32_16x16x32_bf16 v[44:47], v[64:67], a[100:103], 0
s_add_u32 s54, s46, 0
buffer_load_dwordx4 a[0:3], v8, s[8:11], s54 offen offset:0 sc1
buffer_load_dwordx4 a[4:7], v8, s[8:11], s54 offen offset:1024 sc1
v_mfma_f32_16x16x32_bf16 v[40:43], v[68:71], a[104:107], v[40:43]
v_mfma_f32_16x16x32_bf16 v[44:47], v[68:71], a[108:111], v[44:47]
buffer_load_dwordx4 a[8:11], v8, s[8:11], s54 offen offset:2048 sc1
buffer_load_dwordx4 a[12:15], v8, s[8:11], s54 offen offset:3072 sc1
v_mfma_f32_16x16x32_bf16 v[40:43], v[72:75], a[112:115], v[40:43]
v_mfma_f32_16x16x32_bf16 v[44:47], v[72:75], a[116:119], v[44:47]
s_add_u32 s54, s46, 4096
buffer_load_dwordx4 a[16:19], v8, s[8:11], s54 offen offset:0 sc1
buffer_load_dwordx4 a[20:23], v8, s[8:11], s54 offen offset:1024 sc1
v_mfma_f32_16x16x32_bf16 v[40:43], v[76:79], a[120:123], v[40:43]
v_mfma_f32_16x16x32_bf16 v[44:47], v[76:79], a[124:127], v[44:47]
buffer_load_dwordx4 a[24:27], v8, s[8:11], s54 offen offset:2048 sc1
buffer_load_dwordx4 a[28:31], v8, s[8:11], s54 offen offset:3072 sc1
s_add_u32 s54, s46, 8192
buffer_load_dwordx4 a[32:35], v8, s[8:11], s54 offen offset:0 sc1
buffer_load_dwordx4 a[36:39], v8, s[8:11], s54 offen offset:1024 sc1
s_nop 1
v_max3_f32 v17, v17, v40, v41
v_max3_f32 v18, v18, v44, v45
s_nop 1
v_permlane32_swap_b32 v17, v18
v_max_f32 v17, v17, v18
v_mov_b32 v19, v17
s_nop 1
v_permlane16_swap_b32 v17, v19
v_max_f32 v17, v17, v19
v_mul_f32 v17, s50, v17
v_mov_b32 v18, v17
buffer_load_dwordx4 a[40:43], v8, s[8:11], s54 offen offset:2048 sc1
s_nop 0
v_permlane32_swap_b32 v17, v18
v_fma_f32 v28, v28, s50, -v17
v_fma_f32 v29, v29, s50, -v17
v_fma_f32 v30, v30, s50, -v17
v_fma_f32 v31, v31, s50, -v17
v_fma_f32 v40, v40, s50, -v17
v_fma_f32 v41, v41, s50, -v17
v_fma_f32 v32, v32, s50, -v18
v_fma_f32 v33, v33, s50, -v18
v_fma_f32 v34, v34, s50, -v18
v_fma_f32 v35, v35, s50, -v18
v_fma_f32 v36, v36, s50, -v18
v_fma_f32 v37, v37, s50, -v18
v_fma_f32 v38, v38, s50, -v18
v_fma_f32 v39, v39, s50, -v18
v_fma_f32 v44, v44, s50, -v18
v_fma_f32 v45, v45, s50, -v18
buffer_load_dwordx4 a[44:47], v8, s[8:11], s54 offen offset:3072 sc1
v_exp_f32 v28, v28
v_exp_f32 v29, v29
v_exp_f32 v30, v30
v_exp_f32 v31, v31
v_exp_f32 v40, v40
v_exp_f32 v41, v41
s_add_u32 s54, s46, 12288
buffer_load_dwordx4 a[48:51], v8, s[8:11], s54 offen offset:0 sc1
v_exp_f32 v32, v32
v_exp_f32 v33, v33
v_exp_f32 v34, v34
v_exp_f32 v35, v35
v_exp_f32 v36, v36
v_exp_f32 v37, v37
v_exp_f32 v38, v38
v_exp_f32 v39, v39
v_exp_f32 v44, v44
v_exp_f32 v45, v45
buffer_load_dwordx4 a[52:55], v8, s[8:11], s54 offen offset:1024 sc1
v_add_f32 v17, v28, v29
v_add_f32 v18, v32, v33
v_add_f32 v17, v17, v30
v_add_f32 v18, v18, v34
v_add_f32 v17, v17, v31
v_add_f32 v18, v18, v35
v_add_f32 v17, v17, v40
v_add_f32 v18, v18, v36
v_add_f32 v17, v17, v41
v_add_f32 v18, v18, v37
v_add_f32 v18, v18, v38
v_add_f32 v18, v18, v39
v_add_f32 v18, v18, v44
v_add_f32 v18, v18, v45
buffer_load_dwordx4 a[56:59], v8, s[8:11], s54 offen offset:2048 sc1
s_nop 0
v_permlane32_swap_b32 v17, v18
v_add_f32 v17, v17, v18
v_mov_b32 v19, v17
s_nop 1
v_permlane16_swap_b32 v17, v19
v_add_f32 v17, v17, v19
v_rcp_f32 v17, v17
buffer_load_dwordx4 a[60:63], v8, s[8:11], s54 offen offset:3072 sc1
v_mov_b32 v18, v17
s_nop 1
v_permlane32_swap_b32 v17, v18
v_mul_f32 v28, v28, v17
v_mul_f32 v29, v29, v17
v_mul_f32 v30, v30, v17
v_mul_f32 v31, v31, v17
v_mul_f32 v40, v40, v17
v_mul_f32 v41, v41, v17
v_cvt_pk_bf16_f32 v48, v28, v29
v_cvt_pk_bf16_f32 v49, v30, v31
v_cvt_pk_bf16_f32 v56, v40, v41
v_cvt_pk_bf16_f32 v59, v40, v41
v_mul_f32 v32, v32, v18
v_mul_f32 v33, v33, v18
v_mul_f32 v34, v34, v18
v_mul_f32 v35, v35, v18
v_mul_f32 v36, v36, v18
v_mul_f32 v37, v37, v18
v_mul_f32 v38, v38, v18
v_mul_f32 v39, v39, v18
v_mul_f32 v44, v44, v18
v_mul_f32 v45, v45, v18
v_cvt_pk_bf16_f32 v52, v32, v33
v_cvt_pk_bf16_f32 v53, v34, v35
v_cvt_pk_bf16_f32 v54, v36, v37
v_cvt_pk_bf16_f32 v55, v38, v39
v_cvt_pk_bf16_f32 v60, v44, v45
v_cvt_pk_bf16_f32 v63, v44, v45
s_add_u32 s49, s48, 4096
s_waitcnt vmcnt(17)
buffer_load_dword v24, v11, s[4:7], s52 offen sc1
v_mfma_f32_16x16x32_bf16 v[128:131], a[160:163], v[48:51], 0
v_mfma_f32_16x16x32_bf16 v[132:135], a[164:167], v[48:51], 0
v_mfma_f32_16x16x16_bf16 v[128:131], v[80:81], v[56:57], v[128:131]
v_mfma_f32_16x16x16_bf16 v[132:135], v[80:81], v[58:59], v[132:135]
v_mfma_f32_16x16x32_bf16 v[136:139], a[168:171], v[48:51], 0
v_mfma_f32_16x16x32_bf16 v[140:143], a[172:175], v[48:51], 0
v_mfma_f32_16x16x16_bf16 v[136:139], v[82:83], v[56:57], v[136:139]
v_mfma_f32_16x16x16_bf16 v[140:143], v[82:83], v[58:59], v[140:143]
v_mfma_f32_16x16x32_bf16 v[144:147], a[176:179], v[48:51], 0
s_nop 1
v_cvt_pk_bf16_f32 v88, v128, v129
v_mfma_f32_16x16x32_bf16 v[148:151], a[180:183], v[48:51], 0
v_cvt_pk_bf16_f32 v89, v130, v131
v_mfma_f32_16x16x16_bf16 v[144:147], v[84:85], v[56:57], v[144:147]
v_cvt_pk_bf16_f32 v90, v132, v133
v_mfma_f32_16x16x16_bf16 v[148:151], v[84:85], v[58:59], v[148:151]
v_cvt_pk_bf16_f32 v91, v134, v135
buffer_store_dwordx4 v[88:91], v8, s[4:7], s48 offen offset:0 sc1
v_mfma_f32_16x16x32_bf16 v[152:155], a[184:187], v[48:51], 0
v_cvt_pk_bf16_f32 v92, v136, v137
v_mfma_f32_16x16x32_bf16 v[156:159], a[188:191], v[48:51], 0
v_cvt_pk_bf16_f32 v93, v138, v139
v_mfma_f32_16x16x16_bf16 v[152:155], v[86:87], v[56:57], v[152:155]
v_cvt_pk_bf16_f32 v94, v140, v141
v_mfma_f32_16x16x16_bf16 v[156:159], v[86:87], v[58:59], v[156:159]
v_cvt_pk_bf16_f32 v95, v142, v143
buffer_store_dwordx4 v[92:95], v8, s[4:7], s48 offen offset:2048 sc1
v_mfma_f32_16x16x32_bf16 v[160:163], a[160:163], v[52:55], 0
v_cvt_pk_bf16_f32 v96, v144, v145
v_mfma_f32_16x16x32_bf16 v[164:167], a[164:167], v[52:55], 0
v_cvt_pk_bf16_f32 v97, v146, v147
v_mfma_f32_16x16x16_bf16 v[160:163], v[80:81], v[60:61], v[160:163]
v_cvt_pk_bf16_f32 v98, v148, v149
v_mfma_f32_16x16x16_bf16 v[164:167], v[80:81], v[62:63], v[164:167]
v_cvt_pk_bf16_f32 v99, v150, v151
buffer_store_dwordx4 v[96:99], v8, s[4:7], s49 offen offset:0 sc1
v_mfma_f32_16x16x32_bf16 v[168:171], a[168:171], v[52:55], 0
v_cvt_pk_bf16_f32 v100, v152, v153
v_mfma_f32_16x16x32_bf16 v[172:175], a[172:175], v[52:55], 0
v_cvt_pk_bf16_f32 v101, v154, v155
v_mfma_f32_16x16x16_bf16 v[168:171], v[82:83], v[60:61], v[168:171]
v_cvt_pk_bf16_f32 v102, v156, v157
v_mfma_f32_16x16x16_bf16 v[172:175], v[82:83], v[62:63], v[172:175]
v_cvt_pk_bf16_f32 v103, v158, v159
buffer_store_dwordx4 v[100:103], v8, s[4:7], s49 offen offset:2048 sc1
v_mfma_f32_16x16x32_bf16 v[176:179], a[176:179], v[52:55], 0
v_cvt_pk_bf16_f32 v104, v160, v161
v_mfma_f32_16x16x32_bf16 v[180:183], a[180:183], v[52:55], 0
v_cvt_pk_bf16_f32 v105, v162, v163
v_mfma_f32_16x16x16_bf16 v[176:179], v[84:85], v[60:61], v[176:179]
v_cvt_pk_bf16_f32 v106, v164, v165
v_mfma_f32_16x16x16_bf16 v[180:183], v[84:85], v[62:63], v[180:183]
v_cvt_pk_bf16_f32 v107, v166, v167
buffer_store_dwordx4 v[104:107], v8, s[4:7], s48 offen offset:1024 sc1
v_mfma_f32_16x16x32_bf16 v[184:187], a[184:187], v[52:55], 0
v_cvt_pk_bf16_f32 v108, v168, v169
v_mfma_f32_16x16x32_bf16 v[188:191], a[188:191], v[52:55], 0
v_cvt_pk_bf16_f32 v109, v170, v171
v_mfma_f32_16x16x16_bf16 v[184:187], v[86:87], v[60:61], v[184:187]
v_cvt_pk_bf16_f32 v110, v172, v173
v_mfma_f32_16x16x16_bf16 v[188:191], v[86:87], v[62:63], v[188:191]
v_cvt_pk_bf16_f32 v111, v174, v175
buffer_store_dwordx4 v[108:111], v8, s[4:7], s48 offen offset:3072 sc1
v_cvt_pk_bf16_f32 v112, v176, v177
v_cvt_pk_bf16_f32 v113, v178, v179
v_cvt_pk_bf16_f32 v114, v180, v181
v_cvt_pk_bf16_f32 v115, v182, v183
buffer_store_dwordx4 v[112:115], v8, s[4:7], s49 offen offset:1024 sc1
v_cvt_pk_bf16_f32 v116, v184, v185
v_cvt_pk_bf16_f32 v117, v186, v187
v_cvt_pk_bf16_f32 v118, v188, v189
v_cvt_pk_bf16_f32 v119, v190, v191
buffer_store_dwordx4 v[116:119], v8, s[4:7], s49 offen offset:3072 sc1
s_add_u32 s54, s46, 16384
buffer_load_dwordx4 a[64:67], v8, s[8:11], s54 offen offset:0 sc1
buffer_load_dwordx4 a[68:71], v8, s[8:11], s54 offen offset:1024 sc1
buffer_load_dwordx4 a[72:75], v8, s[8:11], s54 offen offset:2048 sc1
buffer_load_dwordx4 a[76:79], v8, s[8:11], s54 offen offset:3072 sc1
s_add_u32 s48, s48, 262144
v_mov_b32 v15, s53
s_mov_b32 s45, s53
s_cmp_eq_u32 s51, 0
s_cbranch_scc1 att_nopre_203
s_waitcnt vmcnt(13)
v_mfma_f32_16x16x32_bf16 v[28:31], a[32:35], a[0:3], 0
v_mfma_f32_16x16x32_bf16 v[32:35], a[32:35], a[4:7], 0
v_mfma_f32_16x16x32_bf16 v[36:39], a[36:39], a[4:7], 0
v_mfma_f32_16x16x32_bf16 v[28:31], a[40:43], a[8:11], v[28:31]
v_mfma_f32_16x16x32_bf16 v[32:35], a[40:43], a[12:15], v[32:35]
v_mfma_f32_16x16x32_bf16 v[36:39], a[44:47], a[12:15], v[36:39]
v_mfma_f32_16x16x32_bf16 v[28:31], a[48:51], a[16:19], v[28:31]
v_mfma_f32_16x16x32_bf16 v[32:35], a[48:51], a[20:23], v[32:35]
v_mfma_f32_16x16x32_bf16 v[36:39], a[52:55], a[20:23], v[36:39]
v_mfma_f32_16x16x32_bf16 v[28:31], a[56:59], a[24:27], v[28:31]
v_mfma_f32_16x16x32_bf16 v[32:35], a[56:59], a[28:31], v[32:35]
v_mfma_f32_16x16x32_bf16 v[36:39], a[60:63], a[28:31], v[36:39]
s_add_u32 s53, s45, 1
s_nop 4
v_cndmask_b32 v28, v16, v28, s[56:57]
v_cndmask_b32 v29, v16, v29, s[58:59]
v_cndmask_b32 v30, v16, v30, s[60:61]
v_cndmask_b32 v31, v16, v31, s[62:63]
v_cndmask_b32 v36, v16, v36, s[56:57]
v_cndmask_b32 v37, v16, v37, s[58:59]
v_cndmask_b32 v38, v16, v38, s[60:61]
v_cndmask_b32 v39, v16, v39, s[62:63]
v_max3_f32 v18, v32, v33, v34
v_max3_f32 v17, v28, v29, v30
v_max3_f32 v18, v18, v35, v36
v_max_f32 v17, v17, v31
v_max3_f32 v18, v18, v37, v38
v_max_f32 v18, v18, v39
buffer_load_dwordx4 v[64:67], v9, s[4:7], s47 offen offset:0 sc1
buffer_load_dwordx4 v[68:71], v9, s[4:7], s47 offen offset:512 sc1
buffer_load_dwordx4 v[72:75], v9, s[4:7], s47 offen offset:1024 sc1
buffer_load_dwordx4 v[76:79], v9, s[4:7], s47 offen offset:1536 sc1
buffer_load_dwordx2 v[80:81], v10, s[4:7], s47 offen offset:0 sc1
buffer_load_dwordx2 v[82:83], v10, s[4:7], s47 offen offset:512 sc1
buffer_load_dwordx2 v[84:85], v10, s[4:7], s47 offen offset:1024 sc1
buffer_load_dwordx2 v[86:87], v10, s[4:7], s47 offen offset:1536 sc1
s_waitcnt vmcnt(12)
buffer_store_dword v15, v23, s[4:7], s52 offen
buffer_store_dword v15, v22, s[4:7], s52 offen sc1
s_add_u32 s54, s46, 20480
buffer_load_dwordx4 a[80:83], v8, s[8:11], s54 offen offset:0 sc1
buffer_load_dwordx4 a[84:87], v8, s[8:11], s54 offen offset:1024 sc1
buffer_load_dwordx4 a[88:91], v8, s[8:11], s54 offen offset:2048 sc1
buffer_load_dwordx4 a[92:95], v8, s[8:11], s54 offen offset:3072 sc1
s_add_u32 s49, s45, 8
v_mov_b32 v125, s49
buffer_store_dword v125, v124, s[4:7], s52 offen sc1
s_waitcnt vmcnt(7)
att_j2_204:
s_branch att_loop_190
att_nopre_198:
s_waitcnt vmcnt(12)
s_add_u32 s49, s45, 1
v_cmp_gt_u32 vcc, s49, v24
s_nop 0
s_and_b32 vcc_lo, vcc_lo, 0x3f
s_cbranch_scc1 att_still_205
s_add_u32 s54, s46, 0
buffer_load_dwordx4 a[96:99], v8, s[4:7], s54 offen offset:0 sc1
buffer_load_dwordx4 a[100:103], v8, s[4:7], s54 offen offset:1024 sc1
buffer_load_dwordx4 a[104:107], v8, s[4:7], s54 offen offset:2048 sc1
buffer_load_dwordx4 a[108:111], v8, s[4:7], s54 offen offset:3072 sc1
s_add_u32 s54, s46, 4096
buffer_load_dwordx4 a[112:115], v8, s[4:7], s54 offen offset:0 sc1
buffer_load_dwordx4 a[116:119], v8, s[4:7], s54 offen offset:1024 sc1
buffer_load_dwordx4 a[120:123], v8, s[4:7], s54 offen offset:2048 sc1
buffer_load_dwordx4 a[124:127], v8, s[4:7], s54 offen offset:3072 sc1
s_add_u32 s54, s46, 8192
buffer_load_dwordx4 a[128:131], v8, s[4:7], s54 offen offset:0 sc1
buffer_load_dwordx4 a[132:135], v8, s[4:7], s54 offen offset:1024 sc1
buffer_load_dwordx4 a[136:139], v8, s[4:7], s54 offen offset:2048 sc1
buffer_load_dwordx4 a[140:143], v8, s[4:7], s54 offen offset:3072 sc1
s_waitcnt vmcnt(16)
buffer_store_dword v15, v23, s[4:7], s52 offen
buffer_store_dword v15, v22, s[4:7], s52 offen sc1
s_add_u32 s54, s46, 12288
buffer_load_dwordx4 a[144:147], v8, s[4:7], s54 offen offset:0 sc1
buffer_load_dwordx4 a[148:151], v8, s[4:7], s54 offen offset:1024 sc1
buffer_load_dwordx4 a[152:155], v8, s[4:7], s54 offen offset:2048 sc1
buffer_load_dwordx4 a[156:159], v8, s[4:7], s54 offen offset:3072 sc1
buffer_load_dwordx4 v[64:67], v9, s[4:7], s47 offen offset:0 sc1
buffer_load_dwordx4 v[68:71], v9, s[4:7], s47 offen offset:512 sc1
buffer_load_dwordx4 v[72:75], v9, s[4:7], s47 offen offset:1024 sc1
buffer_load_dwordx4 v[76:79], v9, s[4:7], s47 offen offset:1536 sc1
buffer_load_dwordx2 v[80:81], v10, s[4:7], s47 offen offset:0 sc1
buffer_load_dwordx2 v[82:83], v10, s[4:7], s47 offen offset:512 sc1
buffer_load_dwordx2 v[84:85], v10, s[4:7], s47 offen offset:1024 sc1
buffer_load_dwordx2 v[86:87], v10, s[4:7], s47 offen offset:1536 sc1
s_add_u32 s54, s46, 16384
buffer_load_dwordx4 a[160:163], v8, s[4:7], s54 offen offset:0 sc1
buffer_load_dwordx4 a[164:167], v8, s[4:7], s54 offen offset:1024 sc1
buffer_load_dwordx4 a[168:171], v8, s[4:7], s54 offen offset:2048 sc1
buffer_load_dwordx4 a[172:175], v8, s[4:7], s54 offen offset:3072 sc1
s_add_u32 s54, s46, 20480
buffer_load_dwordx4 a[176:179], v8, s[4:7], s54 offen offset:0 sc1
buffer_load_dwordx4 a[180:183], v8, s[4:7], s54 offen offset:1024 sc1
buffer_load_dwordx4 a[184:187], v8, s[4:7], s54 offen offset:2048 sc1
buffer_load_dwordx4 a[188:191], v8, s[4:7], s54 offen offset:3072 sc1
s_add_u32 s49, s45, 8
v_mov_b32 v125, s49
buffer_store_dword v125, v124, s[4:7], s52 offen sc1
s_waitcnt vmcnt(17)
v_mfma_f32_16x16x32_bf16 v[28:31], a[128:131], a[96:99], 0
v_mfma_f32_16x16x32_bf16 v[32:35], a[128:131], a[100:103], 0
v_mfma_f32_16x16x32_bf16 v[36:39], a[132:135], a[100:103], 0
v_mfma_f32_16x16x32_bf16 v[28:31], a[136:139], a[104:107], v[28:31]
v_mfma_f32_16x16x32_bf16 v[32:35], a[136:139], a[108:111], v[32:35]
v_mfma_f32_16x16x32_bf16 v[36:39], a[140:143], a[108:111], v[36:39]
v_mfma_f32_16x16x32_bf16 v[28:31], a[144:147], a[112:115], v[28:31]
v_mfma_f32_16x16x32_bf16 v[32:35], a[144:147], a[116:119], v[32:35]
v_mfma_f32_16x16x32_bf16 v[36:39], a[148:151], a[116:119], v[36:39]
v_mfma_f32_16x16x32_bf16 v[28:31], a[152:155], a[120:123], v[28:31]
v_mfma_f32_16x16x32_bf16 v[32:35], a[152:155], a[124:127], v[32:35]
v_mfma_f32_16x16x32_bf16 v[36:39], a[156:159], a[124:127], v[36:39]
s_add_u32 s53, s45, 1
s_nop 4
v_cndmask_b32 v28, v16, v28, s[56:57]
v_cndmask_b32 v29, v16, v29, s[58:59]
v_cndmask_b32 v30, v16, v30, s[60:61]
v_cndmask_b32 v31, v16, v31, s[62:63]
v_cndmask_b32 v36, v16, v36, s[56:57]
v_cndmask_b32 v37, v16, v37, s[58:59]
v_cndmask_b32 v38, v16, v38, s[60:61]
v_cndmask_b32 v39, v16, v39, s[62:63]
v_max3_f32 v18, v32, v33, v34
v_max3_f32 v17, v28, v29, v30
v_max3_f32 v18, v18, v35, v36
v_max_f32 v17, v17, v31
v_max3_f32 v18, v18, v37, v38
v_max_f32 v18, v18, v39
s_waitcnt vmcnt(9)
s_branch att_j2_199
att_still_205:
s_waitcnt vmcnt(0)
buffer_store_dword v15, v23, s[4:7], s52 offen
buffer_store_dword v15, v22, s[4:7], s52 offen sc1
s_cmp_ge_u32 s45, 64
s_cbranch_scc1 att_done_191
s_add_u32 s49, s45, 8
v_mov_b32 v125, s49
buffer_store_dword v125, v124, s[4:7], s52 offen sc1
s_add_u32 s49, s45, 1
s_mov_b32 s98, 0
sp_loop_206:
buffer_load_dword v24, v11, s[4:7], s52 offen sc1
s_add_u32 s98, s98, 1
s_cmp_gt_u32 s98, 150000
s_cbranch_scc1 sp_bad_208
s_waitcnt vmcnt(0)
v_cmp_gt_u32 vcc, s49, v24
s_nop 0
s_and_b32 vcc_lo, vcc_lo, 0x3f
s_cbranch_scc0 sp_ok_207
s_sleep 2
s_branch sp_loop_206
sp_bad_208:
s_mov_b32 s98, 1536
s_branch L_fail
sp_ok_207:
s_add_u32 s54, s46, 0
buffer_load_dwordx4 a[96:99], v8, s[4:7], s54 offen offset:0 sc1
buffer_load_dwordx4 a[100:103], v8, s[4:7], s54 offen offset:1024 sc1
buffer_load_dwordx4 a[104:107], v8, s[4:7], s54 offen offset:2048 sc1
buffer_load_dwordx4 a[108:111], v8, s[4:7], s54 offen offset:3072 sc1
s_add_u32 s54, s46, 4096
buffer_load_dwordx4 a[112:115], v8, s[4:7], s54 offen offset:0 sc1
buffer_load_dwordx4 a[116:119], v8, s[4:7], s54 offen offset:1024 sc1
buffer_load_dwordx4 a[120:123], v8, s[4:7], s54 offen offset:2048 sc1
buffer_load_dwordx4 a[124:127], v8, s[4:7], s54 offen offset:3072 sc1
s_add_u32 s54, s46, 8192
buffer_load_dwordx4 a[128:131], v8, s[4:7], s54 offen offset:0 sc1
buffer_load_dwordx4 a[132:135], v8, s[4:7], s54 offen offset:1024 sc1
buffer_load_dwordx4 a[136:139], v8, s[4:7], s54 offen offset:2048 sc1
buffer_load_dwordx4 a[140:143], v8, s[4:7], s54 offen offset:3072 sc1
s_add_u32 s54, s46, 12288
buffer_load_dwordx4 a[144:147], v8, s[4:7], s54 offen offset:0 sc1
buffer_load_dwordx4 a[148:151], v8, s[4:7], s54 offen offset:1024 sc1
buffer_load_dwordx4 a[152:155], v8, s[4:7], s54 offen offset:2048 sc1
buffer_load_dwordx4 a[156:159], v8, s[4:7], s54 offen offset:3072 sc1
buffer_load_dwordx4 v[64:67], v9, s[4:7], s47 offen offset:0 sc1
buffer_load_dwordx4 v[68:71], v9, s[4:7], s47 offen offset:512 sc1
buffer_load_dwordx4 v[72:75], v9, s[4:7], s47 offen offset:1024 sc1
buffer_load_dwordx4 v[76:79], v9, s[4:7], s47 offen offset:1536 sc1
buffer_load_dwordx2 v[80:81], v10, s[4:7], s47 offen offset:0 sc1
buffer_load_dwordx2 v[82:83], v10, s[4:7], s47 offen offset:512 sc1
buffer_load_dwordx2 v[84:85], v10, s[4:7], s47 offen offset:1024 sc1
buffer_load_dwordx2 v[86:87], v10, s[4:7], s47 offen offset:1536 sc1
s_add_u32 s54, s46, 16384
buffer_load_dwordx4 a[160:163], v8, s[4:7], s54 offen offset:0 sc1
buffer_load_dwordx4 a[164:167], v8, s[4:7], s54 offen offset:1024 sc1
buffer_load_dwordx4 a[168:171], v8, s[4:7], s54 offen offset:2048 sc1
buffer_load_dwordx4 a[172:175], v8, s[4:7], s54 offen offset:3072 sc1
s_add_u32 s54, s46, 20480
buffer_load_dwordx4 a[176:179], v8, s[4:7], s54 offen offset:0 sc1
buffer_load_dwordx4 a[180:183], v8, s[4:7], s54 offen offset:1024 sc1
buffer_load_dwordx4 a[184:187], v8, s[4:7], s54 offen offset:2048 sc1
buffer_load_dwordx4 a[188:191], v8, s[4:7], s54 offen offset:3072 sc1
s_waitcnt vmcnt(16)
v_mfma_f32_16x16x32_bf16 v[28:31], a[128:131], a[96:99], 0
v_mfma_f32_16x16x32_bf16 v[32:35], a[128:131], a[100:103], 0
v_mfma_f32_16x16x32_bf16 v[36:39], a[132:135], a[100:103], 0
v_mfma_f32_16x16x32_bf16 v[28:31], a[136:139], a[104:107], v[28:31]
v_mfma_f32_16x16x32_bf16 v[32:35], a[136:139], a[108:111], v[32:35]
v_mfma_f32_16x16x32_bf16 v[36:39], a[140:143], a[108:111], v[36:39]
v_mfma_f32_16x16x32_bf16 v[28:31], a[144:147], a[112:115], v[28:31]
v_mfma_f32_16x16x32_bf16 v[32:35], a[144:147], a[116:119], v[32:35]
v_mfma_f32_16x16x32_bf16 v[36:39], a[148:151], a[116:119], v[36:39]
v_mfma_f32_16x16x32_bf16 v[28:31], a[152:155], a[120:123], v[28:31]
v_mfma_f32_16x16x32_bf16 v[32:35], a[152:155], a[124:127], v[32:35]
v_mfma_f32_16x16x32_bf16 v[36:39], a[156:159], a[124:127], v[36:39]
s_add_u32 s53, s45, 1
s_nop 4
v_cndmask_b32 v28, v16, v28, s[56:57]
v_cndmask_b32 v29, v16, v29, s[58:59]
v_cndmask_b32 v30, v16, v30, s[60:61]
v_cndmask_b32 v31, v16, v31, s[62:63]
v_cndmask_b32 v36, v16, v36, s[56:57]
v_cndmask_b32 v37, v16, v37, s[58:59]
v_cndmask_b32 v38, v16, v38, s[60:61]
v_cndmask_b32 v39, v16, v39, s[62:63]
v_max3_f32 v18, v32, v33, v34
v_max3_f32 v17, v28, v29, v30
v_max3_f32 v18, v18, v35, v36
v_max_f32 v17, v17, v31
v_max3_f32 v18, v18, v37, v38
v_max_f32 v18, v18, v39
s_waitcnt vmcnt(0)
s_branch att_j2_199
att_nopre_203:
s_waitcnt vmcnt(12)
s_add_u32 s49, s45, 1
v_cmp_gt_u32 vcc, s49, v24
s_nop 0
s_and_b32 vcc_lo, vcc_lo, 0x3f
s_cbranch_scc1 att_still_209
s_add_u32 s54, s46, 0
buffer_load_dwordx4 a[0:3], v8, s[4:7], s54 offen offset:0 sc1
buffer_load_dwordx4 a[4:7], v8, s[4:7], s54 offen offset:1024 sc1
buffer_load_dwordx4 a[8:11], v8, s[4:7], s54 offen offset:2048 sc1
buffer_load_dwordx4 a[12:15], v8, s[4:7], s54 offen offset:3072 sc1
s_add_u32 s54, s46, 4096
buffer_load_dwordx4 a[16:19], v8, s[4:7], s54 offen offset:0 sc1
buffer_load_dwordx4 a[20:23], v8, s[4:7], s54 offen offset:1024 sc1
buffer_load_dwordx4 a[24:27], v8, s[4:7], s54 offen offset:2048 sc1
buffer_load_dwordx4 a[28:31], v8, s[4:7], s54 offen offset:3072 sc1
s_add_u32 s54, s46, 8192
buffer_load_dwordx4 a[32:35], v8, s[4:7], s54 offen offset:0 sc1
buffer_load_dwordx4 a[36:39], v8, s[4:7], s54 offen offset:1024 sc1
buffer_load_dwordx4 a[40:43], v8, s[4:7], s54 offen offset:2048 sc1
buffer_load_dwordx4 a[44:47], v8, s[4:7], s54 offen offset:3072 sc1
s_waitcnt vmcnt(16)
buffer_store_dword v15, v23, s[4:7], s52 offen
buffer_store_dword v15, v22, s[4:7], s52 offen sc1
s_add_u32 s54, s46, 12288
buffer_load_dwordx4 a[48:51], v8, s[4:7], s54 offen offset:0 sc1
buffer_load_dwordx4 a[52:55], v8, s[4:7], s54 offen offset:1024 sc1
buffer_load_dwordx4 a[56:59], v8, s[4:7], s54 offen offset:2048 sc1
buffer_load_dwordx4 a[60:63], v8, s[4:7], s54 offen offset:3072 sc1
buffer_load_dwordx4 v[64:67], v9, s[4:7], s47 offen offset:0 sc1
buffer_load_dwordx4 v[68:71], v9, s[4:7], s47 offen offset:512 sc1
buffer_load_dwordx4 v[72:75], v9, s[4:7], s47 offen offset:1024 sc1
buffer_load_dwordx4 v[76:79], v9, s[4:7], s47 offen offset:1536 sc1
buffer_load_dwordx2 v[80:81], v10, s[4:7], s47 offen offset:0 sc1
buffer_load_dwordx2 v[82:83], v10, s[4:7], s47 offen offset:512 sc1
buffer_load_dwordx2 v[84:85], v10, s[4:7], s47 offen offset:1024 sc1
buffer_load_dwordx2 v[86:87], v10, s[4:7], s47 offen offset:1536 sc1
s_add_u32 s54, s46, 16384
buffer_load_dwordx4 a[64:67], v8, s[4:7], s54 offen offset:0 sc1
buffer_load_dwordx4 a[68:71], v8, s[4:7], s54 offen offset:1024 sc1
buffer_load_dwordx4 a[72:75], v8, s[4:7], s54 offen offset:2048 sc1
buffer_load_dwordx4 a[76:79], v8, s[4:7], s54 offen offset:3072 sc1
s_add_u32 s54, s46, 20480
buffer_load_dwordx4 a[80:83], v8, s[4:7], s54 offen offset:0 sc1
buffer_load_dwordx4 a[84:87], v8, s[4:7], s54 offen offset:1024 sc1
buffer_load_dwordx4 a[88:91], v8, s[4:7], s54 offen offset:2048 sc1
buffer_load_dwordx4 a[92:95], v8, s[4:7], s54 offen offset:3072 sc1
s_add_u32 s49, s45, 8
v_mov_b32 v125, s49
buffer_store_dword v125, v124, s[4:7], s52 offen sc1
s_waitcnt vmcnt(17)
v_mfma_f32_16x16x32_bf16 v[28:31], a[32:35], a[0:3], 0
v_mfma_f32_16x16x32_bf16 v[32:35], a[32:35], a[4:7], 0
v_mfma_f32_16x16x32_bf16 v[36:39], a[36:39], a[4:7], 0
v_mfma_f32_16x16x32_bf16 v[28:31], a[40:43], a[8:11], v[28:31]
v_mfma_f32_16x16x32_bf16 v[32:35], a[40:43], a[12:15], v[32:35]
v_mfma_f32_16x16x32_bf16 v[36:39], a[44:47], a[12:15], v[36:39]
v_mfma_f32_16x16x32_bf16 v[28:31], a[48:51], a[16:19], v[28:31]
v_mfma_f32_16x16x32_bf16 v[32:35], a[48:51], a[20:23], v[32:35]
v_mfma_f32_16x16x32_bf16 v[36:39], a[52:55], a[20:23], v[36:39]
v_mfma_f32_16x16x32_bf16 v[28:31], a[56:59], a[24:27], v[28:31]
v_mfma_f32_16x16x32_bf16 v[32:35], a[56:59], a[28:31], v[32:35]
v_mfma_f32_16x16x32_bf16 v[36:39], a[60:63], a[28:31], v[36:39]
s_add_u32 s53, s45, 1
s_nop 4
v_cndmask_b32 v28, v16, v28, s[56:57]
v_cndmask_b32 v29, v16, v29, s[58:59]
v_cndmask_b32 v30, v16, v30, s[60:61]
v_cndmask_b32 v31, v16, v31, s[62:63]
v_cndmask_b32 v36, v16, v36, s[56:57]
v_cndmask_b32 v37, v16, v37, s[58:59]
v_cndmask_b32 v38, v16, v38, s[60:61]
v_cndmask_b32 v39, v16, v39, s[62:63]
v_max3_f32 v18, v32, v33, v34
v_max3_f32 v17, v28, v29, v30
v_max3_f32 v18, v18, v35, v36
v_max_f32 v17, v17, v31
v_max3_f32 v18, v18, v37, v38
v_max_f32 v18, v18, v39
s_waitcnt vmcnt(9)
s_branch att_j2_204
att_still_209:
s_waitcnt vmcnt(0)
buffer_store_dword v15, v23, s[4:7], s52 offen
buffer_store_dword v15, v22, s[4:7], s52 offen sc1
s_cmp_ge_u32 s45, 64
s_cbranch_scc1 att_done_191
s_add_u32 s49, s45, 8
v_mov_b32 v125, s49
buffer_store_dword v125, v124, s[4:7], s52 offen sc1
s_add_u32 s49, s45, 1
s_mov_b32 s98, 0
sp_loop_210:
buffer_load_dword v24, v11, s[4:7], s52 offen sc1
s_add_u32 s98, s98, 1
s_cmp_gt_u32 s98, 150000
s_cbranch_scc1 sp_bad_212
s_waitcnt vmcnt(0)
v_cmp_gt_u32 vcc, s49, v24
s_nop 0
s_and_b32 vcc_lo, vcc_lo, 0x3f
s_cbranch_scc0 sp_ok_211
s_sleep 2
s_branch sp_loop_210
sp_bad_212:
s_mov_b32 s98, 1536
s_branch L_fail
sp_ok_211:
s_add_u32 s54, s46, 0
buffer_load_dwordx4 a[0:3], v8, s[4:7], s54 offen offset:0 sc1
buffer_load_dwordx4 a[4:7], v8, s[4:7], s54 offen offset:1024 sc1
buffer_load_dwordx4 a[8:11], v8, s[4:7], s54 offen offset:2048 sc1
buffer_load_dwordx4 a[12:15], v8, s[4:7], s54 offen offset:3072 sc1
s_add_u32 s54, s46, 4096
buffer_load_dwordx4 a[16:19], v8, s[4:7], s54 offen offset:0 sc1
buffer_load_dwordx4 a[20:23], v8, s[4:7], s54 offen offset:1024 sc1
buffer_load_dwordx4 a[24:27], v8, s[4:7], s54 offen offset:2048 sc1
buffer_load_dwordx4 a[28:31], v8, s[4:7], s54 offen offset:3072 sc1
s_add_u32 s54, s46, 8192
buffer_load_dwordx4 a[32:35], v8, s[4:7], s54 offen offset:0 sc1
buffer_load_dwordx4 a[36:39], v8, s[4:7], s54 offen offset:1024 sc1
buffer_load_dwordx4 a[40:43], v8, s[4:7], s54 offen offset:2048 sc1
buffer_load_dwordx4 a[44:47], v8, s[4:7], s54 offen offset:3072 sc1
s_add_u32 s54, s46, 12288
buffer_load_dwordx4 a[48:51], v8, s[4:7], s54 offen offset:0 sc1
buffer_load_dwordx4 a[52:55], v8, s[4:7], s54 offen offset:1024 sc1
buffer_load_dwordx4 a[56:59], v8, s[4:7], s54 offen offset:2048 sc1
buffer_load_dwordx4 a[60:63], v8, s[4:7], s54 offen offset:3072 sc1
buffer_load_dwordx4 v[64:67], v9, s[4:7], s47 offen offset:0 sc1
buffer_load_dwordx4 v[68:71], v9, s[4:7], s47 offen offset:512 sc1
buffer_load_dwordx4 v[72:75], v9, s[4:7], s47 offen offset:1024 sc1
buffer_load_dwordx4 v[76:79], v9, s[4:7], s47 offen offset:1536 sc1
buffer_load_dwordx2 v[80:81], v10, s[4:7], s47 offen offset:0 sc1
buffer_load_dwordx2 v[82:83], v10, s[4:7], s47 offen offset:512 sc1
buffer_load_dwordx2 v[84:85], v10, s[4:7], s47 offen offset:1024 sc1
buffer_load_dwordx2 v[86:87], v10, s[4:7], s47 offen offset:1536 sc1
s_add_u32 s54, s46, 16384
buffer_load_dwordx4 a[64:67], v8, s[4:7], s54 offen offset:0 sc1
buffer_load_dwordx4 a[68:71], v8, s[4:7], s54 offen offset:1024 sc1
buffer_load_dwordx4 a[72:75], v8, s[4:7], s54 offen offset:2048 sc1
buffer_load_dwordx4 a[76:79], v8, s[4:7], s54 offen offset:3072 sc1
s_add_u32 s54, s46, 20480
buffer_load_dwordx4 a[80:83], v8, s[4:7], s54 offen offset:0 sc1
buffer_load_dwordx4 a[84:87], v8, s[4:7], s54 offen offset:1024 sc1
buffer_load_dwordx4 a[88:91], v8, s[4:7], s54 offen offset:2048 sc1
buffer_load_dwordx4 a[92:95], v8, s[4:7], s54 offen offset:3072 sc1
s_waitcnt vmcnt(16)
v_mfma_f32_16x16x32_bf16 v[28:31], a[32:35], a[0:3], 0
v_mfma_f32_16x16x32_bf16 v[32:35], a[32:35], a[4:7], 0
v_mfma_f32_16x16x32_bf16 v[36:39], a[36:39], a[4:7], 0
v_mfma_f32_16x16x32_bf16 v[28:31], a[40:43], a[8:11], v[28:31]
v_mfma_f32_16x16x32_bf16 v[32:35], a[40:43], a[12:15], v[32:35]
v_mfma_f32_16x16x32_bf16 v[36:39], a[44:47], a[12:15], v[36:39]
v_mfma_f32_16x16x32_bf16 v[28:31], a[48:51], a[16:19], v[28:31]
v_mfma_f32_16x16x32_bf16 v[32:35], a[48:51], a[20:23], v[32:35]
v_mfma_f32_16x16x32_bf16 v[36:39], a[52:55], a[20:23], v[36:39]
v_mfma_f32_16x16x32_bf16 v[28:31], a[56:59], a[24:27], v[28:31]
v_mfma_f32_16x16x32_bf16 v[32:35], a[56:59], a[28:31], v[32:35]
v_mfma_f32_16x16x32_bf16 v[36:39], a[60:63], a[28:31], v[36:39]
s_add_u32 s53, s45, 1
s_nop 4
v_cndmask_b32 v28, v16, v28, s[56:57]
v_cndmask_b32 v29, v16, v29, s[58:59]
v_cndmask_b32 v30, v16, v30, s[60:61]
v_cndmask_b32 v31, v16, v31, s[62:63]
v_cndmask_b32 v36, v16, v36, s[56:57]
v_cndmask_b32 v37, v16, v37, s[58:59]
v_cndmask_b32 v38, v16, v38, s[60:61]
v_cndmask_b32 v39, v16, v39, s[62:63]
v_max3_f32 v18, v32, v33, v34
v_max3_f32 v17, v28, v29, v30
v_max3_f32 v18, v18, v35, v36
v_max_f32 v17, v17, v31
v_max3_f32 v18, v18, v37, v38
v_max_f32 v18, v18, v39
s_waitcnt vmcnt(0)
s_branch att_j2_204
att_done_191:
s_endpgm
H_red:
s_mov_b32 s44, s74
s_cmp_lg_u32 s44, 0
s_cbranch_scc1 nozero_213
s_lshl_b32 s46, s3, 15
s_add_u32 s46, s46, 0
v_lshlrev_b32 v2, 4, v0
v_mov_b64 v[4:5], 0
v_mov_b64 v[6:7], 0
buffer_store_dwordx4 v[4:7], v2, s[4:7], s46 offen offset:0 sc1
buffer_store_dwordx4 v[4:7], v2, s[4:7], s46 offen offset:1024 sc1
buffer_store_dwordx4 v[4:7], v2, s[4:7], s46 offen offset:2048 sc1
buffer_store_dwordx4 v[4:7], v2, s[4:7], s46 offen offset:3072 sc1
s_add_u32 s46, s46, 4096
buffer_store_dwordx4 v[4:7], v2, s[4:7], s46 offen offset:0 sc1
buffer_store_dwordx4 v[4:7], v2, s[4:7], s46 offen offset:1024 sc1
buffer_store_dwordx4 v[4:7], v2, s[4:7], s46 offen offset:2048 sc1
buffer_store_dwordx4 v[4:7], v2, s[4:7], s46 offen offset:3072 sc1
s_add_u32 s46, s46, 4096
buffer_store_dwordx4 v[4:7], v2, s[4:7], s46 offen offset:0 sc1
buffer_store_dwordx4 v[4:7], v2, s[4:7], s46 offen offset:1024 sc1
buffer_store_dwordx4 v[4:7], v2, s[4:7], s46 offen offset:2048 sc1
buffer_store_dwordx4 v[4:7], v2, s[4:7], s46 offen offset:3072 sc1
s_add_u32 s46, s46, 4096
buffer_store_dwordx4 v[4:7], v2, s[4:7], s46 offen offset:0 sc1
buffer_store_dwordx4 v[4:7], v2, s[4:7], s46 offen offset:1024 sc1
buffer_store_dwordx4 v[4:7], v2, s[4:7], s46 offen offset:2048 sc1
buffer_store_dwordx4 v[4:7], v2, s[4:7], s46 offen offset:3072 sc1
s_add_u32 s46, s46, 4096
buffer_store_dwordx4 v[4:7], v2, s[4:7], s46 offen offset:0 sc1
buffer_store_dwordx4 v[4:7], v2, s[4:7], s46 offen offset:1024 sc1
buffer_store_dwordx4 v[4:7], v2, s[4:7], s46 offen offset:2048 sc1
buffer_store_dwordx4 v[4:7], v2, s[4:7], s46 offen offset:3072 sc1
s_add_u32 s46, s46, 4096
buffer_store_dwordx4 v[4:7], v2, s[4:7], s46 offen offset:0 sc1
buffer_store_dwordx4 v[4:7], v2, s[4:7], s46 offen offset:1024 sc1
buffer_store_dwordx4 v[4:7], v2, s[4:7], s46 offen offset:2048 sc1
buffer_store_dwordx4 v[4:7], v2, s[4:7], s46 offen offset:3072 sc1
s_add_u32 s46, s46, 4096
buffer_store_dwordx4 v[4:7], v2, s[4:7], s46 offen offset:0 sc1
buffer_store_dwordx4 v[4:7], v2, s[4:7], s46 offen offset:1024 sc1
buffer_store_dwordx4 v[4:7], v2, s[4:7], s46 offen offset:2048 sc1
buffer_store_dwordx4 v[4:7], v2, s[4:7], s46 offen offset:3072 sc1
s_add_u32 s46, s46, 4096
buffer_store_dwordx4 v[4:7], v2, s[4:7], s46 offen offset:0 sc1
buffer_store_dwordx4 v[4:7], v2, s[4:7], s46 offen offset:1024 sc1
buffer_store_dwordx4 v[4:7], v2, s[4:7], s46 offen offset:2048 sc1
buffer_store_dwordx4 v[4:7], v2, s[4:7], s46 offen offset:3072 sc1
s_add_u32 s46, s46, 4096
s_waitcnt vmcnt(0)
s_barrier
s_cmp_lg_u32 s3, 0
s_cbranch_scc1 nozero_213
s_mov_b32 s12, s40
s_and_b32 s13, s41, 0xffff
s_mov_b32 s14, 256
s_mov_b32 s15, 0x20000
v_mov_b32 v2, 32
v_mov_b32 v3, 192
s_mov_b64 exec, 1
buffer_store_dword v2, v3, s[12:15], 0 offen sc1
s_mov_b64 exec, -1
nozero_213:
v_and_b32 v1, 15, v0
v_lshrrev_b32 v2, 4, v0
v_and_b32 v3, 1, v0
v_bfe_u32 v4, v0, 1, 3
v_bfe_u32 v5, v0, 4, 1
v_lshrrev_b32 v6, 5, v0
s_mul_i32 s46, s44, 2304
v_mul_u32_u24 v7, 36864, v2
v_lshl_add_u32 v7, v1, 4, v7
v_add_u32 v8, s46, v7
v_lshlrev_b32 v7, 9, v5
v_lshl_add_u32 v7, v6, 8, v7
v_lshl_add_u32 v7, v1, 4, v7
v_add_u32 v10, s46, v7
v_lshlrev_b32 v7, 4, v1
v_lshl_add_u32 v7, v5, 3, v7
v_add_u32 v11, s46, v7
v_mul_u32_u24 v7, 1152, v3
v_lshl_add_u32 v7, v4, 4, v7
v_add_u32 v7, s46, v7
v_lshl_add_u32 v13, v5, 3, v7
v_lshl_add_u32 v9, v6, 7, v13
v_lshl_add_u32 v7, v6, 7, v7
v_lshl_add_u32 v12, v5, 8, v7
v_lshlrev_b32 v7, 4, v3
v_mov_b32 v22, 0x3f80
v_lshlrev_b32 v7, v7, v22
v_cmp_eq_u32 vcc, 0, v4
s_nop 1
v_cndmask_b32 v28, 0, v7, vcc
v_cmp_eq_u32 vcc, 1, v4
s_nop 1
v_cndmask_b32 v29, 0, v7, vcc
v_cmp_eq_u32 vcc, 2, v4
s_nop 1
v_cndmask_b32 v30, 0, v7, vcc
v_cmp_eq_u32 vcc, 3, v4
s_nop 1
v_cndmask_b32 v31, 0, v7, vcc
v_cmp_eq_u32 vcc, 4, v4
s_nop 1
v_cndmask_b32 v32, 0, v7, vcc
v_cmp_eq_u32 vcc, 5, v4
s_nop 1
v_cndmask_b32 v33, 0, v7, vcc
v_cmp_eq_u32 vcc, 6, v4
s_nop 1
v_cndmask_b32 v34, 0, v7, vcc
v_cmp_eq_u32 vcc, 7, v4
s_nop 1
v_cndmask_b32 v35, 0, v7, vcc
s_mul_i32 s46, s44, 128
v_mov_b32 v1, s46
v_mov_b32 v22, 2147483632
v_cmp_eq_u32 vcc, 0, v0
s_nop 1
v_cndmask_b32 v36, v22, v1, vcc
v_add_u32 v37, 65536, v36
v_lshlrev_b32 v1, 2, v0
v_add_u32 v1, 147456, v1
v_mov_b32 v2, 0
ds_write_b32 v1, v2
v_mov_b32 v14, 147460
s_mov_b32 s8, s20
s_and_b32 s9, s21, 0xffff
s_mov_b32 s10, 2359296
s_mov_b32 s11, 0x20000
s_mov_b32 s16, s38
s_and_b32 s17, s39, 0xffff
s_mov_b32 s18, 2359296
s_mov_b32 s19, 0x20000
s_mov_b32 s45, s3
s_mov_b32 s52, 1384448
s_mov_b32 s50, 0
s_mul_i32 s47, s45, 36864
buffer_load_dwordx2 v[60:61], v9, s[8:11], s47 offen offset:0
buffer_load_dwordx2 v[62:63], v9, s[8:11], s47 offen offset:256
buffer_load_dwordx2 v[64:65], v9, s[8:11], s47 offen offset:512
buffer_load_dwordx2 v[66:67], v9, s[8:11], s47 offen offset:768
v_mov_b64 v[68:69], 0
s_mov_b64 exec, 0xffffffff
buffer_load_dwordx2 v[68:69], v9, s[8:11], s47 offen offset:1024
s_mov_b64 exec, -1
s_waitcnt lgkmcnt(0)
s_barrier
s_mov_b32 s12, s40
s_and_b32 s13, s41, 0xffff
s_mov_b32 s14, 256
s_mov_b32 s15, 0x20000
v_lshlrev_b32 v17, 2, v0
v_add_u32 v18, 128, v17
v_cmp_le_u32 vcc, 2, v0
s_nop 1
v_cndmask_b32 v17, v17, v18, vcc
v_mov_b32 v18, 192
v_cmp_eq_u32 vcc, 8, v0
s_nop 1
v_cndmask_b32 v17, v17, v18, vcc
v_mov_b32 v18, 2147483632
v_cmp_lt_u32 vcc, 8, v0
s_nop 1
v_cndmask_b32 v17, v17, v18, vcc
s_mov_b32 s98, 0
wi_loop_214:
buffer_load_dword v18, v17, s[12:15], 0 offen sc1
s_add_u32 s98, s98, 1
s_cmp_gt_u32 s98, 150000
s_cbranch_scc1 wi_bad_216
s_waitcnt vmcnt(0)
v_cmp_eq_u32 vcc, 32, v18
s_nop 0
s_and_b32 s97, vcc_lo, 0x1ff
s_cmp_eq_u32 s97, 0x1ff
s_cbranch_scc1 wi_ok_215
v_cmp_lt_u32 vcc, 32, v18
s_nop 0
s_and_b32 s96, vcc_lo, 0xff
s_cselect_b32 s96, 0x100, 0
s_and_b32 s96, s96, s97
s_cbranch_scc1 wi_over_217
s_sleep 8
s_branch wi_loop_214
wi_bad_216:
s_mov_b32 s98, 512
s_branch L_fail
wi_over_217:
s_mov_b32 s100, 255
wi_ok_215:
ln0_218:
v_lshlrev_b32 v40, 16, v60
v_and_b32 v41, 0xffff0000, v60
v_lshlrev_b32 v42, 16, v61
v_and_b32 v43, 0xffff0000, v61
v_lshlrev_b32 v44, 16, v62
v_and_b32 v45, 0xffff0000, v62
v_lshlrev_b32 v46, 16, v63
v_and_b32 v47, 0xffff0000, v63
v_lshlrev_b32 v48, 16, v64
v_and_b32 v49, 0xffff0000, v64
v_lshlrev_b32 v50, 16, v65
v_and_b32 v51, 0xffff0000, v65
v_lshlrev_b32 v52, 16, v66
v_and_b32 v53, 0xffff0000, v66
v_lshlrev_b32 v54, 16, v67
v_and_b32 v55, 0xffff0000, v67
v_lshlrev_b32 v56, 16, v68
v_and_b32 v57, 0xffff0000, v68
v_lshlrev_b32 v58, 16, v69
v_and_b32 v59, 0xffff0000, v69
v_mul_f32 v20, v40, v40
v_add_f32 v19, v40, v41
v_fmac_f32 v20, v41, v41
v_add_f32 v19, v19, v42
v_fmac_f32 v20, v42, v42
v_add_f32 v19, v19, v43
v_fmac_f32 v20, v43, v43
v_add_f32 v19, v19, v44
v_fmac_f32 v20, v44, v44
v_add_f32 v19, v19, v45
v_fmac_f32 v20, v45, v45
v_add_f32 v19, v19, v46
v_fmac_f32 v20, v46, v46
v_add_f32 v19, v19, v47
v_fmac_f32 v20, v47, v47
v_add_f32 v19, v19, v48
v_fmac_f32 v20, v48, v48
v_add_f32 v19, v19, v49
v_fmac_f32 v20, v49, v49
v_add_f32 v19, v19, v50
v_fmac_f32 v20, v50, v50
v_add_f32 v19, v19, v51
v_fmac_f32 v20, v51, v51
v_add_f32 v19, v19, v52
v_fmac_f32 v20, v52, v52
v_add_f32 v19, v19, v53
v_fmac_f32 v20, v53, v53
v_add_f32 v19, v19, v54
v_fmac_f32 v20, v54, v54
v_add_f32 v19, v19, v55
v_fmac_f32 v20, v55, v55
v_add_f32 v19, v19, v56
v_fmac_f32 v20, v56, v56
v_add_f32 v19, v19, v57
v_fmac_f32 v20, v57, v57
v_add_f32 v19, v19, v58
v_fmac_f32 v20, v58, v58
v_add_f32 v19, v19, v59
v_fmac_f32 v20, v59, v59
s_mul_i32 s47, s45, 36864
s_add_u32 s47, s47, s52
v_permlane32_swap_b32 v19, v20
v_add_f32 v19, v19, v20
v_mov_b32 v21, v19
s_nop 1
v_permlane16_swap_b32 v19, v21
v_add_f32 v19, v19, v21
s_nop 1
v_add_f32_dpp v19, v19, v19 quad_perm:[2,3,0,1] row_mask:0xf bank_mask:0xf
s_nop 1
v_add_f32_dpp v19, v19, v19 row_ror:4 row_mask:0xf bank_mask:0xf
s_nop 1
v_add_f32_dpp v19, v19, v19 row_ror:8 row_mask:0xf bank_mask:0xf
v_mul_f32 v19, 0x3ae38e39, v19
v_mov_b32 v20, v19
s_nop 1
v_permlane32_swap_b32 v19, v20
v_fma_f32 v20, -v19, v19, v20
v_max_f32 v20, 0, v20
v_add_f32 v20, 0x3727c5ac, v20
v_rsq_f32 v20, v20
s_nop 0
v_mul_f32 v19, v19, v20
v_fma_f32 v40, v40, v20, -v19
v_fma_f32 v41, v41, v20, -v19
v_fma_f32 v42, v42, v20, -v19
v_fma_f32 v43, v43, v20, -v19
v_fma_f32 v44, v44, v20, -v19
v_fma_f32 v45, v45, v20, -v19
v_fma_f32 v46, v46, v20, -v19
v_fma_f32 v47, v47, v20, -v19
v_fma_f32 v48, v48, v20, -v19
v_fma_f32 v49, v49, v20, -v19
v_fma_f32 v50, v50, v20, -v19
v_fma_f32 v51, v51, v20, -v19
v_fma_f32 v52, v52, v20, -v19
v_fma_f32 v53, v53, v20, -v19
v_fma_f32 v54, v54, v20, -v19
v_fma_f32 v55, v55, v20, -v19
v_fma_f32 v56, v56, v20, -v19
v_fma_f32 v57, v57, v20, -v19
v_fma_f32 v58, v58, v20, -v19
v_fma_f32 v59, v59, v20, -v19
v_cvt_pk_bf16_f32 v72, v40, v41
v_cvt_pk_bf16_f32 v74, v44, v45
v_cvt_pk_bf16_f32 v73, v42, v43
v_cvt_pk_bf16_f32 v75, v46, v47
v_permlane16_swap_b32 v72, v74
s_nop 0
v_permlane16_swap_b32 v73, v75
buffer_store_dwordx4 v[72:75], v10, s[4:7], s47 offen offset:0 sc1
v_cvt_pk_bf16_f32 v76, v48, v49
v_cvt_pk_bf16_f32 v78, v52, v53
v_cvt_pk_bf16_f32 v77, v50, v51
v_cvt_pk_bf16_f32 v79, v54, v55
v_permlane16_swap_b32 v76, v78
s_nop 0
v_permlane16_swap_b32 v77, v79
buffer_store_dwordx4 v[76:79], v10, s[4:7], s47 offen offset:1024 sc1
v_cvt_pk_bf16_f32 v80, v56, v57
v_cvt_pk_bf16_f32 v81, v58, v59
s_mov_b64 exec, 0xffffffff
buffer_store_dwordx2 v[80:81], v11, s[4:7], s47 offen offset:2048 sc1
s_mov_b64 exec, -1
s_add_u32 s45, s45, 4
s_cmp_ge_u32 s45, 64
s_cbranch_scc1 ln0_done_219
s_mul_i32 s47, s45, 36864
buffer_load_dwordx2 v[60:61], v9, s[8:11], s47 offen offset:0
buffer_load_dwordx2 v[62:63], v9, s[8:11], s47 offen offset:256
buffer_load_dwordx2 v[64:65], v9, s[8:11], s47 offen offset:512
buffer_load_dwordx2 v[66:67], v9, s[8:11], s47 offen offset:768
v_mov_b64 v[68:69], 0
s_mov_b64 exec, 0xffffffff
buffer_load_dwordx2 v[68:69], v9, s[8:11], s47 offen offset:1024
s_mov_b64 exec, -1
s_waitcnt vmcnt(0)
v_mov_b32 v17, 1
s_mov_b64 exec, 1
ds_add_rtn_u32 v17, v14, v17
s_mov_b64 exec, -1
s_andn2_b32 s48, s45, 3
s_waitcnt lgkmcnt(0)
v_readfirstlane_b32 s47, v17
v_mov_b32 v18, s48
s_and_b32 s47, s47, 3
s_cmp_lg_u32 s47, 3
s_cbranch_scc1 nolast_220
buffer_store_dword v18, v36, s[4:7], s50 offen sc1
buffer_store_dword v18, v37, s[4:7], s50 offen
nolast_220:
v_add_u32 v14, 4, v14
s_branch ln0_218
ln0_done_219:
s_waitcnt vmcnt(0)
v_mov_b32 v17, 1
s_mov_b64 exec, 1
ds_add_rtn_u32 v17, v14, v17
s_mov_b64 exec, -1
s_andn2_b32 s48, s45, 3
s_waitcnt lgkmcnt(0)
v_readfirstlane_b32 s47, v17
v_mov_b32 v18, s48
s_and_b32 s47, s47, 3
s_cmp_lg_u32 s47, 3
s_cbranch_scc1 nolast_221
buffer_store_dword v18, v36, s[4:7], s50 offen sc1
buffer_store_dword v18, v37, s[4:7], s50 offen
nolast_221:
v_add_u32 v14, 4, v14
s_mov_b32 s99, 100
s_and_b32 s47, s3, 1
s_mul_i32 s51, s47, 18874368
s_add_u32 s51, s51, 199565312
s_mul_i32 s47, s47, 11264
s_add_u32 s47, s47, 18432
v_mul_u32_u24 v1, 128, v0
v_add_u32 v1, s47, v1
v_mov_b32 v7, 2147483632
v_cmp_gt_u32 vcc, 24, v0
s_nop 1
v_cndmask_b32 v15, v7, v1, vcc
s_getpc_b64 s[96:97]
pc_222:
s_add_u32 s96, s96, L_writers-pc_222
s_addc_u32 s97, s97, 0
v_subrev_u32 v2, 0, v15
v_lshrrev_b32 v2, 7, v2
v_cmp_gt_u32 vcc, 0x200, v2
s_nop 1
v_cndmask_b32 v2, 0, v2, vcc
global_load_ubyte v2, v2, s[96:97]
s_waitcnt vmcnt(0)
v_add_u32 v3, 65536, v15
v_cmp_eq_u32 vcc, s100, v2
s_nop 1
v_cndmask_b32 v15, v15, v3, vcc
s_lshr_b32 s47, s3, 1
s_mul_i32 s49, s47, 32768
s_mov_b32 s52, 6103040
s_mov_b32 s50, 21504
s_cmp_eq_u32 s3, 1
s_cselect_b32 s52, 3743744, s52
s_cselect_b32 s50, 32768, s50
s_cmp_eq_u32 s3, 2
s_cselect_b32 s52, 8462336, s52
s_cselect_b32 s50, 54272, s50
s_mov_b32 s45, 0
v_mov_b32 v16, 2147483632
s_cmp_eq_u32 s3, 3
s_cbranch_scc1 red_fin_224
s_cmp_lg_u32 s3, 0
s_cbranch_scc1 red_mid_223
red_loop_225:
s_add_u32 s48, s45, 1
s_mov_b32 s98, 0
grd_228:
v_mov_b32 v1, 147456
ds_read_b32 v2, v1
s_waitcnt lgkmcnt(0)
v_readfirstlane_b32 s47, v2
s_nop 0
s_add_u32 s47, s47, 32
s_cmp_gt_u32 s47, s45
s_cbranch_scc1 grd_ok_229
s_add_u32 s98, s98, 1
s_cmp_gt_u32 s98, 600000
s_cbranch_scc1 grd_bad_230
s_sleep 2
s_branch grd_228
grd_bad_230:
s_mov_b32 s98, 1280
s_branch L_fail
grd_ok_229:
s_mov_b32 s98, 0
sp_loop_231:
buffer_load_dword v24, v15, s[4:7], s49 offen sc1
s_add_u32 s98, s98, 1
s_cmp_gt_u32 s98, 150000
s_cbranch_scc1 sp_bad_233
s_waitcnt vmcnt(0)
v_cmp_gt_u32 vcc, s48, v24
s_nop 0
s_and_b32 vcc_lo, vcc_lo, 0xffffff
s_cbranch_scc0 sp_ok_232
s_sleep 2
s_branch sp_loop_231
sp_bad_233:
s_mov_b32 s98, 1281
s_branch L_fail
sp_ok_232:
s_mul_i32 s47, s45, 36864
buffer_load_dwordx2 v[60:61], v9, s[8:11], s47 offen offset:0
buffer_load_dwordx2 v[62:63], v9, s[8:11], s47 offen offset:256
buffer_load_dwordx2 v[64:65], v9, s[8:11], s47 offen offset:512
buffer_load_dwordx2 v[66:67], v9, s[8:11], s47 offen offset:768
v_mov_b64 v[68:69], 0
s_mov_b64 exec, 0xffffffff
buffer_load_dwordx2 v[68:69], v9, s[8:11], s47 offen offset:1024
s_mov_b64 exec, -1
s_mul_i32 s47, s45, 294912
s_add_u32 s47, s47, s51
s_add_u32 s46, s47, 147456
buffer_load_dwordx4 v[96:99], v8, s[4:7], s47 offen offset:0 sc1
buffer_load_dwordx4 v[100:103], v8, s[4:7], s46 offen offset:0 sc1
buffer_load_dwordx4 v[104:107], v8, s[4:7], s47 offen offset:256 sc1
buffer_load_dwordx4 v[108:111], v8, s[4:7], s46 offen offset:256 sc1
buffer_load_dwordx4 v[112:115], v8, s[4:7], s47 offen offset:512 sc1
buffer_load_dwordx4 v[116:119], v8, s[4:7], s46 offen offset:512 sc1
buffer_load_dwordx4 v[120:123], v8, s[4:7], s47 offen offset:768 sc1
buffer_load_dwordx4 v[124:127], v8, s[4:7], s46 offen offset:768 sc1
buffer_load_dwordx4 v[128:131], v8, s[4:7], s47 offen offset:1024 sc1
buffer_load_dwordx4 v[132:135], v8, s[4:7], s46 offen offset:1024 sc1
buffer_load_dwordx4 v[136:139], v8, s[4:7], s47 offen offset:1280 sc1
buffer_load_dwordx4 v[140:143], v8, s[4:7], s46 offen offset:1280 sc1
buffer_load_dwordx4 v[144:147], v8, s[4:7], s47 offen offset:1536 sc1
buffer_load_dwordx4 v[148:151], v8, s[4:7], s46 offen offset:1536 sc1
buffer_load_dwordx4 v[152:155], v8, s[4:7], s47 offen offset:1792 sc1
buffer_load_dwordx4 v[156:159], v8, s[4:7], s46 offen offset:1792 sc1
buffer_load_dwordx4 v[160:163], v8, s[4:7], s47 offen offset:2048 sc1
buffer_load_dwordx4 v[164:167], v8, s[4:7], s46 offen offset:2048 sc1
buffer_store_dword v18, v16, s[4:7], 0 offen
buffer_store_dword v18, v16, s[4:7], 0 offen
red_have_226:
buffer_load_dword v24, v15, s[4:7], s49 offen sc1
s_and_b32 s47, s45, 31
s_mul_i32 s47, s47, 4608
v_lshlrev_b32 v14, 4, v0
v_add_u32 v14, s47, v14
s_waitcnt vmcnt(21)
v_lshlrev_b32 v40, 16, v60
v_and_b32 v41, 0xffff0000, v60
v_lshlrev_b32 v42, 16, v61
v_and_b32 v43, 0xffff0000, v61
v_lshlrev_b32 v44, 16, v62
v_and_b32 v45, 0xffff0000, v62
v_lshlrev_b32 v46, 16, v63
v_and_b32 v47, 0xffff0000, v63
v_lshlrev_b32 v48, 16, v64
v_and_b32 v49, 0xffff0000, v64
v_lshlrev_b32 v50, 16, v65
v_and_b32 v51, 0xffff0000, v65
v_lshlrev_b32 v52, 16, v66
v_and_b32 v53, 0xffff0000, v66
v_lshlrev_b32 v54, 16, v67
v_and_b32 v55, 0xffff0000, v67
v_lshlrev_b32 v56, 16, v68
v_and_b32 v57, 0xffff0000, v68
v_lshlrev_b32 v58, 16, v69
v_and_b32 v59, 0xffff0000, v69
s_waitcnt vmcnt(20)
v_mfma_f32_16x16x32_bf16 v[40:43], v[28:31], v[96:99], v[40:43]
s_waitcnt vmcnt(19)
v_mfma_f32_16x16x32_bf16 v[40:43], v[28:31], v[100:103], v[40:43]
s_waitcnt vmcnt(18)
v_mfma_f32_16x16x32_bf16 v[40:43], v[32:35], v[104:107], v[40:43]
s_waitcnt vmcnt(17)
v_mfma_f32_16x16x32_bf16 v[40:43], v[32:35], v[108:111], v[40:43]
s_waitcnt vmcnt(16)
v_mfma_f32_16x16x32_bf16 v[44:47], v[28:31], v[112:115], v[44:47]
s_waitcnt vmcnt(15)
v_mfma_f32_16x16x32_bf16 v[44:47], v[28:31], v[116:119], v[44:47]
s_nop 3
ds_write_b128 v14, v[40:43] offset:0
v_mul_f32 v20, v40, v40
v_add_f32 v19, v40, v41
v_fmac_f32 v20, v41, v41
v_add_f32 v19, v19, v42
v_fmac_f32 v20, v42, v42
v_add_f32 v19, v19, v43
v_fmac_f32 v20, v43, v43
s_waitcnt vmcnt(14)
v_mfma_f32_16x16x32_bf16 v[44:47], v[32:35], v[120:123], v[44:47]
s_waitcnt vmcnt(13)
v_mfma_f32_16x16x32_bf16 v[44:47], v[32:35], v[124:127], v[44:47]
s_waitcnt vmcnt(12)
v_mfma_f32_16x16x32_bf16 v[48:51], v[28:31], v[128:131], v[48:51]
s_waitcnt vmcnt(11)
v_mfma_f32_16x16x32_bf16 v[48:51], v[28:31], v[132:135], v[48:51]
s_nop 3
ds_write_b128 v14, v[44:47] offset:1024
v_add_f32 v19, v19, v44
v_fmac_f32 v20, v44, v44
v_add_f32 v19, v19, v45
v_fmac_f32 v20, v45, v45
v_add_f32 v19, v19, v46
v_fmac_f32 v20, v46, v46
v_add_f32 v19, v19, v47
v_fmac_f32 v20, v47, v47
s_waitcnt vmcnt(10)
v_mfma_f32_16x16x32_bf16 v[48:51], v[32:35], v[136:139], v[48:51]
s_waitcnt vmcnt(9)
v_mfma_f32_16x16x32_bf16 v[48:51], v[32:35], v[140:143], v[48:51]
s_waitcnt vmcnt(8)
v_mfma_f32_16x16x32_bf16 v[52:55], v[28:31], v[144:147], v[52:55]
s_waitcnt vmcnt(7)
v_mfma_f32_16x16x32_bf16 v[52:55], v[28:31], v[148:151], v[52:55]
s_nop 3
ds_write_b128 v14, v[48:51] offset:2048
v_add_f32 v19, v19, v48
v_fmac_f32 v20, v48, v48
v_add_f32 v19, v19, v49
v_fmac_f32 v20, v49, v49
v_add_f32 v19, v19, v50
v_fmac_f32 v20, v50, v50
v_add_f32 v19, v19, v51
v_fmac_f32 v20, v51, v51
s_waitcnt vmcnt(6)
v_mfma_f32_16x16x32_bf16 v[52:55], v[32:35], v[152:155], v[52:55]
s_waitcnt vmcnt(5)
v_mfma_f32_16x16x32_bf16 v[52:55], v[32:35], v[156:159], v[52:55]
s_waitcnt vmcnt(4)
v_mfma_f32_16x16x32_bf16 v[56:59], v[28:31], v[160:163], v[56:59]
s_waitcnt vmcnt(3)
v_mfma_f32_16x16x32_bf16 v[56:59], v[28:31], v[164:167], v[56:59]
s_nop 3
ds_write_b128 v14, v[52:55] offset:3072
v_add_f32 v19, v19, v52
v_fmac_f32 v20, v52, v52
v_add_f32 v19, v19, v53
v_fmac_f32 v20, v53, v53
v_add_f32 v19, v19, v54
v_fmac_f32 v20, v54, v54
v_add_f32 v19, v19, v55
v_fmac_f32 v20, v55, v55
s_mov_b64 exec, 0xffffffff
ds_write_b128 v14, v[56:59] offset:4096
s_mov_b64 exec, -1
v_add_f32 v19, v19, v56
v_fmac_f32 v20, v56, v56
v_add_f32 v19, v19, v57
v_fmac_f32 v20, v57, v57
v_add_f32 v19, v19, v58
v_fmac_f32 v20, v58, v58
v_add_f32 v19, v19, v59
v_fmac_f32 v20, v59, v59
s_mul_i32 s47, s45, 36864
s_add_u32 s47, s47, s52
v_permlane32_swap_b32 v19, v20
v_add_f32 v19, v19, v20
v_mov_b32 v21, v19
s_nop 1
v_permlane16_swap_b32 v19, v21
v_add_f32 v19, v19, v21
s_nop 1
v_add_f32_dpp v19, v19, v19 quad_perm:[2,3,0,1] row_mask:0xf bank_mask:0xf
s_nop 1
v_add_f32_dpp v19, v19, v19 row_ror:4 row_mask:0xf bank_mask:0xf
s_nop 1
v_add_f32_dpp v19, v19, v19 row_ror:8 row_mask:0xf bank_mask:0xf
v_mul_f32 v19, 0x3ae38e39, v19
v_mov_b32 v20, v19
s_nop 1
v_permlane32_swap_b32 v19, v20
v_fma_f32 v20, -v19, v19, v20
v_max_f32 v20, 0, v20
v_add_f32 v20, 0x3727c5ac, v20
v_rsq_f32 v20, v20
s_nop 0
v_mul_f32 v19, v19, v20
v_fma_f32 v40, v40, v20, -v19
v_fma_f32 v41, v41, v20, -v19
v_fma_f32 v42, v42, v20, -v19
v_fma_f32 v43, v43, v20, -v19
v_fma_f32 v44, v44, v20, -v19
v_fma_f32 v45, v45, v20, -v19
v_fma_f32 v46, v46, v20, -v19
v_fma_f32 v47, v47, v20, -v19
v_fma_f32 v48, v48, v20, -v19
v_fma_f32 v49, v49, v20, -v19
v_fma_f32 v50, v50, v20, -v19
v_fma_f32 v51, v51, v20, -v19
v_fma_f32 v52, v52, v20, -v19
v_fma_f32 v53, v53, v20, -v19
v_fma_f32 v54, v54, v20, -v19
v_fma_f32 v55, v55, v20, -v19
v_fma_f32 v56, v56, v20, -v19
v_fma_f32 v57, v57, v20, -v19
v_fma_f32 v58, v58, v20, -v19
v_fma_f32 v59, v59, v20, -v19
v_cvt_pk_bf16_f32 v72, v40, v41
v_cvt_pk_bf16_f32 v74, v44, v45
v_cvt_pk_bf16_f32 v73, v42, v43
v_cvt_pk_bf16_f32 v75, v46, v47
v_permlane16_swap_b32 v72, v74
s_nop 0
v_permlane16_swap_b32 v73, v75
buffer_store_dwordx4 v[72:75], v10, s[4:7], s47 offen offset:0 sc1
v_cvt_pk_bf16_f32 v76, v48, v49
v_cvt_pk_bf16_f32 v78, v52, v53
v_cvt_pk_bf16_f32 v77, v50, v51
v_cvt_pk_bf16_f32 v79, v54, v55
v_permlane16_swap_b32 v76, v78
s_nop 0
v_permlane16_swap_b32 v77, v79
buffer_store_dwordx4 v[76:79], v10, s[4:7], s47 offen offset:1024 sc1
v_cvt_pk_bf16_f32 v80, v56, v57
v_cvt_pk_bf16_f32 v81, v58, v59
s_mov_b64 exec, 0xffffffff
buffer_store_dwordx2 v[80:81], v11, s[4:7], s47 offen offset:2048 sc1
s_mov_b64 exec, -1
v_mov_b32 v18, s48
s_mov_b32 s45, s48
s_add_u32 s48, s48, 1
s_waitcnt vmcnt(3)
v_cmp_gt_u32 vcc, s48, v24
s_nop 0
s_and_b32 vcc_lo, vcc_lo, 0xffffff
s_cbranch_scc1 red_late_227
v_mov_b32 v1, 147456
ds_read_b32 v2, v1
s_waitcnt lgkmcnt(0)
v_readfirstlane_b32 s47, v2
s_nop 0
s_add_u32 s47, s47, 32
s_cmp_gt_u32 s47, s45
s_cbranch_scc0 red_late_227
s_mul_i32 s47, s45, 36864
buffer_load_dwordx2 v[60:61], v9, s[8:11], s47 offen offset:0
buffer_load_dwordx2 v[62:63], v9, s[8:11], s47 offen offset:256
buffer_load_dwordx2 v[64:65], v9, s[8:11], s47 offen offset:512
buffer_load_dwordx2 v[66:67], v9, s[8:11], s47 offen offset:768
v_mov_b64 v[68:69], 0
s_mov_b64 exec, 0xffffffff
buffer_load_dwordx2 v[68:69], v9, s[8:11], s47 offen offset:1024
s_mov_b64 exec, -1
s_mul_i32 s47, s45, 294912
s_add_u32 s47, s47, s51
s_add_u32 s46, s47, 147456
buffer_load_dwordx4 v[96:99], v8, s[4:7], s47 offen offset:0 sc1
buffer_load_dwordx4 v[100:103], v8, s[4:7], s46 offen offset:0 sc1
buffer_load_dwordx4 v[104:107], v8, s[4:7], s47 offen offset:256 sc1
buffer_load_dwordx4 v[108:111], v8, s[4:7], s46 offen offset:256 sc1
buffer_load_dwordx4 v[112:115], v8, s[4:7], s47 offen offset:512 sc1
buffer_load_dwordx4 v[116:119], v8, s[4:7], s46 offen offset:512 sc1
buffer_load_dwordx4 v[120:123], v8, s[4:7], s47 offen offset:768 sc1
buffer_load_dwordx4 v[124:127], v8, s[4:7], s46 offen offset:768 sc1
buffer_load_dwordx4 v[128:131], v8, s[4:7], s47 offen offset:1024 sc1
buffer_load_dwordx4 v[132:135], v8, s[4:7], s46 offen offset:1024 sc1
buffer_load_dwordx4 v[136:139], v8, s[4:7], s47 offen offset:1280 sc1
buffer_load_dwordx4 v[140:143], v8, s[4:7], s46 offen offset:1280 sc1
buffer_load_dwordx4 v[144:147], v8, s[4:7], s47 offen offset:1536 sc1
buffer_load_dwordx4 v[148:151], v8, s[4:7], s46 offen offset:1536 sc1
buffer_load_dwordx4 v[152:155], v8, s[4:7], s47 offen offset:1792 sc1
buffer_load_dwordx4 v[156:159], v8, s[4:7], s46 offen offset:1792 sc1
buffer_load_dwordx4 v[160:163], v8, s[4:7], s47 offen offset:2048 sc1
buffer_load_dwordx4 v[164:167], v8, s[4:7], s46 offen offset:2048 sc1
s_waitcnt vmcnt(23) lgkmcnt(0)
buffer_store_dword v18, v36, s[4:7], s50 offen sc1
buffer_store_dword v18, v37, s[4:7], s50 offen
s_branch red_have_226
red_late_227:
s_waitcnt vmcnt(0) lgkmcnt(0)
buffer_store_dword v18, v36, s[4:7], s50 offen sc1
buffer_store_dword v18, v37, s[4:7], s50 offen
s_cmp_lt_u32 s45, 64
s_cbranch_scc1 red_loop_225
s_endpgm
red_mid_223:
red_loop_234:
s_add_u32 s48, s45, 1
s_mov_b32 s98, 0
sp_loop_237:
buffer_load_dword v24, v15, s[4:7], s49 offen sc1
s_add_u32 s98, s98, 1
s_cmp_gt_u32 s98, 150000
s_cbranch_scc1 sp_bad_239
s_waitcnt vmcnt(0)
v_cmp_gt_u32 vcc, s48, v24
s_nop 0
s_and_b32 vcc_lo, vcc_lo, 0xffffff
s_cbranch_scc0 sp_ok_238
s_sleep 2
s_branch sp_loop_237
sp_bad_239:
s_mov_b32 s98, 1281
s_branch L_fail
sp_ok_238:
s_mul_i32 s47, s45, 294912
s_add_u32 s47, s47, s51
s_add_u32 s46, s47, 147456
buffer_load_dwordx4 v[96:99], v8, s[4:7], s47 offen offset:0 sc1
buffer_load_dwordx4 v[100:103], v8, s[4:7], s46 offen offset:0 sc1
buffer_load_dwordx4 v[104:107], v8, s[4:7], s47 offen offset:256 sc1
buffer_load_dwordx4 v[108:111], v8, s[4:7], s46 offen offset:256 sc1
buffer_load_dwordx4 v[112:115], v8, s[4:7], s47 offen offset:512 sc1
buffer_load_dwordx4 v[116:119], v8, s[4:7], s46 offen offset:512 sc1
buffer_load_dwordx4 v[120:123], v8, s[4:7], s47 offen offset:768 sc1
buffer_load_dwordx4 v[124:127], v8, s[4:7], s46 offen offset:768 sc1
buffer_load_dwordx4 v[128:131], v8, s[4:7], s47 offen offset:1024 sc1
buffer_load_dwordx4 v[132:135], v8, s[4:7], s46 offen offset:1024 sc1
buffer_load_dwordx4 v[136:139], v8, s[4:7], s47 offen offset:1280 sc1
buffer_load_dwordx4 v[140:143], v8, s[4:7], s46 offen offset:1280 sc1
buffer_load_dwordx4 v[144:147], v8, s[4:7], s47 offen offset:1536 sc1
buffer_load_dwordx4 v[148:151], v8, s[4:7], s46 offen offset:1536 sc1
buffer_load_dwordx4 v[152:155], v8, s[4:7], s47 offen offset:1792 sc1
buffer_load_dwordx4 v[156:159], v8, s[4:7], s46 offen offset:1792 sc1
buffer_load_dwordx4 v[160:163], v8, s[4:7], s47 offen offset:2048 sc1
buffer_load_dwordx4 v[164:167], v8, s[4:7], s46 offen offset:2048 sc1
buffer_store_dword v18, v16, s[4:7], 0 offen
buffer_store_dword v18, v16, s[4:7], 0 offen
red_have_235:
buffer_load_dword v24, v15, s[4:7], s49 offen sc1
s_and_b32 s47, s45, 31
s_mul_i32 s47, s47, 4608
v_lshlrev_b32 v14, 4, v0
v_add_u32 v14, s47, v14
ds_read_b128 v[40:43], v14 offset:0
ds_read_b128 v[44:47], v14 offset:1024
ds_read_b128 v[48:51], v14 offset:2048
ds_read_b128 v[52:55], v14 offset:3072
v_mov_b64 v[56:57], 0
v_mov_b64 v[58:59], 0
s_mov_b64 exec, 0xffffffff
ds_read_b128 v[56:59], v14 offset:4096
s_mov_b64 exec, -1
s_waitcnt lgkmcnt(0)
s_waitcnt vmcnt(20)
v_mfma_f32_16x16x32_bf16 v[40:43], v[28:31], v[96:99], v[40:43]
s_waitcnt vmcnt(19)
v_mfma_f32_16x16x32_bf16 v[40:43], v[28:31], v[100:103], v[40:43]
s_waitcnt vmcnt(18)
v_mfma_f32_16x16x32_bf16 v[40:43], v[32:35], v[104:107], v[40:43]
s_waitcnt vmcnt(17)
v_mfma_f32_16x16x32_bf16 v[40:43], v[32:35], v[108:111], v[40:43]
s_waitcnt vmcnt(16)
v_mfma_f32_16x16x32_bf16 v[44:47], v[28:31], v[112:115], v[44:47]
s_waitcnt vmcnt(15)
v_mfma_f32_16x16x32_bf16 v[44:47], v[28:31], v[116:119], v[44:47]
s_nop 3
ds_write_b128 v14, v[40:43] offset:0
v_mul_f32 v20, v40, v40
v_add_f32 v19, v40, v41
v_fmac_f32 v20, v41, v41
v_add_f32 v19, v19, v42
v_fmac_f32 v20, v42, v42
v_add_f32 v19, v19, v43
v_fmac_f32 v20, v43, v43
s_waitcnt vmcnt(14)
v_mfma_f32_16x16x32_bf16 v[44:47], v[32:35], v[120:123], v[44:47]
s_waitcnt vmcnt(13)
v_mfma_f32_16x16x32_bf16 v[44:47], v[32:35], v[124:127], v[44:47]
s_waitcnt vmcnt(12)
v_mfma_f32_16x16x32_bf16 v[48:51], v[28:31], v[128:131], v[48:51]
s_waitcnt vmcnt(11)
v_mfma_f32_16x16x32_bf16 v[48:51], v[28:31], v[132:135], v[48:51]
s_nop 3
ds_write_b128 v14, v[44:47] offset:1024
v_add_f32 v19, v19, v44
v_fmac_f32 v20, v44, v44
v_add_f32 v19, v19, v45
v_fmac_f32 v20, v45, v45
v_add_f32 v19, v19, v46
v_fmac_f32 v20, v46, v46
v_add_f32 v19, v19, v47
v_fmac_f32 v20, v47, v47
s_waitcnt vmcnt(10)
v_mfma_f32_16x16x32_bf16 v[48:51], v[32:35], v[136:139], v[48:51]
s_waitcnt vmcnt(9)
v_mfma_f32_16x16x32_bf16 v[48:51], v[32:35], v[140:143], v[48:51]
s_waitcnt vmcnt(8)
v_mfma_f32_16x16x32_bf16 v[52:55], v[28:31], v[144:147], v[52:55]
s_waitcnt vmcnt(7)
v_mfma_f32_16x16x32_bf16 v[52:55], v[28:31], v[148:151], v[52:55]
s_nop 3
ds_write_b128 v14, v[48:51] offset:2048
v_add_f32 v19, v19, v48
v_fmac_f32 v20, v48, v48
v_add_f32 v19, v19, v49
v_fmac_f32 v20, v49, v49
v_add_f32 v19, v19, v50
v_fmac_f32 v20, v50, v50
v_add_f32 v19, v19, v51
v_fmac_f32 v20, v51, v51
s_waitcnt vmcnt(6)
v_mfma_f32_16x16x32_bf16 v[52:55], v[32:35], v[152:155], v[52:55]
s_waitcnt vmcnt(5)
v_mfma_f32_16x16x32_bf16 v[52:55], v[32:35], v[156:159], v[52:55]
s_waitcnt vmcnt(4)
v_mfma_f32_16x16x32_bf16 v[56:59], v[28:31], v[160:163], v[56:59]
s_waitcnt vmcnt(3)
v_mfma_f32_16x16x32_bf16 v[56:59], v[28:31], v[164:167], v[56:59]
s_nop 3
ds_write_b128 v14, v[52:55] offset:3072
v_add_f32 v19, v19, v52
v_fmac_f32 v20, v52, v52
v_add_f32 v19, v19, v53
v_fmac_f32 v20, v53, v53
v_add_f32 v19, v19, v54
v_fmac_f32 v20, v54, v54
v_add_f32 v19, v19, v55
v_fmac_f32 v20, v55, v55
s_mov_b64 exec, 0xffffffff
ds_write_b128 v14, v[56:59] offset:4096
s_mov_b64 exec, -1
v_add_f32 v19, v19, v56
v_fmac_f32 v20, v56, v56
v_add_f32 v19, v19, v57
v_fmac_f32 v20, v57, v57
v_add_f32 v19, v19, v58
v_fmac_f32 v20, v58, v58
v_add_f32 v19, v19, v59
v_fmac_f32 v20, v59, v59
s_mul_i32 s47, s45, 36864
s_add_u32 s47, s47, s52
v_permlane32_swap_b32 v19, v20
v_add_f32 v19, v19, v20
v_mov_b32 v21, v19
s_nop 1
v_permlane16_swap_b32 v19, v21
v_add_f32 v19, v19, v21
s_nop 1
v_add_f32_dpp v19, v19, v19 quad_perm:[2,3,0,1] row_mask:0xf bank_mask:0xf
s_nop 1
v_add_f32_dpp v19, v19, v19 row_ror:4 row_mask:0xf bank_mask:0xf
s_nop 1
v_add_f32_dpp v19, v19, v19 row_ror:8 row_mask:0xf bank_mask:0xf
v_mul_f32 v19, 0x3ae38e39, v19
v_mov_b32 v20, v19
s_nop 1
v_permlane32_swap_b32 v19, v20
v_fma_f32 v20, -v19, v19, v20
v_max_f32 v20, 0, v20
v_add_f32 v20, 0x3727c5ac, v20
v_rsq_f32 v20, v20
s_nop 0
v_mul_f32 v19, v19, v20
v_fma_f32 v40, v40, v20, -v19
v_fma_f32 v41, v41, v20, -v19
v_fma_f32 v42, v42, v20, -v19
v_fma_f32 v43, v43, v20, -v19
v_fma_f32 v44, v44, v20, -v19
v_fma_f32 v45, v45, v20, -v19
v_fma_f32 v46, v46, v20, -v19
v_fma_f32 v47, v47, v20, -v19
v_fma_f32 v48, v48, v20, -v19
v_fma_f32 v49, v49, v20, -v19
v_fma_f32 v50, v50, v20, -v19
v_fma_f32 v51, v51, v20, -v19
v_fma_f32 v52, v52, v20, -v19
v_fma_f32 v53, v53, v20, -v19
v_fma_f32 v54, v54, v20, -v19
v_fma_f32 v55, v55, v20, -v19
v_fma_f32 v56, v56, v20, -v19
v_fma_f32 v57, v57, v20, -v19
v_fma_f32 v58, v58, v20, -v19
v_fma_f32 v59, v59, v20, -v19
v_cvt_pk_bf16_f32 v72, v40, v41
v_cvt_pk_bf16_f32 v74, v44, v45
v_cvt_pk_bf16_f32 v73, v42, v43
v_cvt_pk_bf16_f32 v75, v46, v47
v_permlane16_swap_b32 v72, v74
s_nop 0
v_permlane16_swap_b32 v73, v75
buffer_store_dwordx4 v[72:75], v10, s[4:7], s47 offen offset:0 sc1
v_cvt_pk_bf16_f32 v76, v48, v49
v_cvt_pk_bf16_f32 v78, v52, v53
v_cvt_pk_bf16_f32 v77, v50, v51
v_cvt_pk_bf16_f32 v79, v54, v55
v_permlane16_swap_b32 v76, v78
s_nop 0
v_permlane16_swap_b32 v77, v79
buffer_store_dwordx4 v[76:79], v10, s[4:7], s47 offen offset:1024 sc1
v_cvt_pk_bf16_f32 v80, v56, v57
v_cvt_pk_bf16_f32 v81, v58, v59
s_mov_b64 exec, 0xffffffff
buffer_store_dwordx2 v[80:81], v11, s[4:7], s47 offen offset:2048 sc1
s_mov_b64 exec, -1
v_mov_b32 v18, s48
s_mov_b32 s45, s48
s_add_u32 s48, s48, 1
s_waitcnt vmcnt(3)
v_cmp_gt_u32 vcc, s48, v24
s_nop 0
s_and_b32 vcc_lo, vcc_lo, 0xffffff
s_cbranch_scc1 red_late_236
s_mul_i32 s47, s45, 294912
s_add_u32 s47, s47, s51
s_add_u32 s46, s47, 147456
buffer_load_dwordx4 v[96:99], v8, s[4:7], s47 offen offset:0 sc1
buffer_load_dwordx4 v[100:103], v8, s[4:7], s46 offen offset:0 sc1
buffer_load_dwordx4 v[104:107], v8, s[4:7], s47 offen offset:256 sc1
buffer_load_dwordx4 v[108:111], v8, s[4:7], s46 offen offset:256 sc1
buffer_load_dwordx4 v[112:115], v8, s[4:7], s47 offen offset:512 sc1
buffer_load_dwordx4 v[116:119], v8, s[4:7], s46 offen offset:512 sc1
buffer_load_dwordx4 v[120:123], v8, s[4:7], s47 offen offset:768 sc1
buffer_load_dwordx4 v[124:127], v8, s[4:7], s46 offen offset:768 sc1
buffer_load_dwordx4 v[128:131], v8, s[4:7], s47 offen offset:1024 sc1
buffer_load_dwordx4 v[132:135], v8, s[4:7], s46 offen offset:1024 sc1
buffer_load_dwordx4 v[136:139], v8, s[4:7], s47 offen offset:1280 sc1
buffer_load_dwordx4 v[140:143], v8, s[4:7], s46 offen offset:1280 sc1
buffer_load_dwordx4 v[144:147], v8, s[4:7], s47 offen offset:1536 sc1
buffer_load_dwordx4 v[148:151], v8, s[4:7], s46 offen offset:1536 sc1
buffer_load_dwordx4 v[152:155], v8, s[4:7], s47 offen offset:1792 sc1
buffer_load_dwordx4 v[156:159], v8, s[4:7], s46 offen offset:1792 sc1
buffer_load_dwordx4 v[160:163], v8, s[4:7], s47 offen offset:2048 sc1
buffer_load_dwordx4 v[164:167], v8, s[4:7], s46 offen offset:2048 sc1
s_waitcnt vmcnt(18) lgkmcnt(0)
buffer_store_dword v18, v36, s[4:7], s50 offen sc1
buffer_store_dword v18, v37, s[4:7], s50 offen
s_branch red_have_235
red_late_236:
s_waitcnt vmcnt(0) lgkmcnt(0)
buffer_store_dword v18, v36, s[4:7], s50 offen sc1
buffer_store_dword v18, v37, s[4:7], s50 offen
s_cmp_lt_u32 s45, 64
s_cbranch_scc1 red_loop_234
s_endpgm
red_fin_224:
red_loop_240:
s_add_u32 s48, s45, 1
s_mov_b32 s98, 0
sp_loop_243:
buffer_load_dword v24, v15, s[4:7], s49 offen sc1
s_add_u32 s98, s98, 1
s_cmp_gt_u32 s98, 150000
s_cbranch_scc1 sp_bad_245
s_waitcnt vmcnt(0)
v_cmp_gt_u32 vcc, s48, v24
s_nop 0
s_and_b32 vcc_lo, vcc_lo, 0xffffff
s_cbranch_scc0 sp_ok_244
s_sleep 2
s_branch sp_loop_243
sp_bad_245:
s_mov_b32 s98, 1281
s_branch L_fail
sp_ok_244:
s_mul_i32 s47, s45, 294912
s_add_u32 s47, s47, s51
s_add_u32 s46, s47, 147456
buffer_load_dwordx4 v[96:99], v8, s[4:7], s47 offen offset:0 sc1
buffer_load_dwordx4 v[100:103], v8, s[4:7], s46 offen offset:0 sc1
buffer_load_dwordx4 v[104:107], v8, s[4:7], s47 offen offset:256 sc1
buffer_load_dwordx4 v[108:111], v8, s[4:7], s46 offen offset:256 sc1
buffer_load_dwordx4 v[112:115], v8, s[4:7], s47 offen offset:512 sc1
buffer_load_dwordx4 v[116:119], v8, s[4:7], s46 offen offset:512 sc1
buffer_load_dwordx4 v[120:123], v8, s[4:7], s47 offen offset:768 sc1
buffer_load_dwordx4 v[124:127], v8, s[4:7], s46 offen offset:768 sc1
buffer_load_dwordx4 v[128:131], v8, s[4:7], s47 offen offset:1024 sc1
buffer_load_dwordx4 v[132:135], v8, s[4:7], s46 offen offset:1024 sc1
buffer_load_dwordx4 v[136:139], v8, s[4:7], s47 offen offset:1280 sc1
buffer_load_dwordx4 v[140:143], v8, s[4:7], s46 offen offset:1280 sc1
buffer_load_dwordx4 v[144:147], v8, s[4:7], s47 offen offset:1536 sc1
buffer_load_dwordx4 v[148:151], v8, s[4:7], s46 offen offset:1536 sc1
buffer_load_dwordx4 v[152:155], v8, s[4:7], s47 offen offset:1792 sc1
buffer_load_dwordx4 v[156:159], v8, s[4:7], s46 offen offset:1792 sc1
buffer_load_dwordx4 v[160:163], v8, s[4:7], s47 offen offset:2048 sc1
buffer_load_dwordx4 v[164:167], v8, s[4:7], s46 offen offset:2048 sc1
red_have_241:
buffer_load_dword v24, v15, s[4:7], s49 offen sc1
s_and_b32 s47, s45, 31
s_mul_i32 s47, s47, 4608
v_lshlrev_b32 v14, 4, v0
v_add_u32 v14, s47, v14
ds_read_b128 v[40:43], v14 offset:0
ds_read_b128 v[44:47], v14 offset:1024
ds_read_b128 v[48:51], v14 offset:2048
ds_read_b128 v[52:55], v14 offset:3072
v_mov_b64 v[56:57], 0
v_mov_b64 v[58:59], 0
s_mov_b64 exec, 0xffffffff
ds_read_b128 v[56:59], v14 offset:4096
s_mov_b64 exec, -1
s_waitcnt lgkmcnt(0)
v_mov_b32 v1, 147456
v_mov_b32 v2, s48
ds_write_b32 v1, v2
s_waitcnt vmcnt(18)
v_mfma_f32_16x16x32_bf16 v[40:43], v[28:31], v[96:99], v[40:43]
s_waitcnt vmcnt(17)
v_mfma_f32_16x16x32_bf16 v[40:43], v[28:31], v[100:103], v[40:43]
s_waitcnt vmcnt(16)
v_mfma_f32_16x16x32_bf16 v[40:43], v[32:35], v[104:107], v[40:43]
s_waitcnt vmcnt(15)
v_mfma_f32_16x16x32_bf16 v[40:43], v[32:35], v[108:111], v[40:43]
s_waitcnt vmcnt(14)
v_mfma_f32_16x16x32_bf16 v[44:47], v[28:31], v[112:115], v[44:47]
s_waitcnt vmcnt(13)
v_mfma_f32_16x16x32_bf16 v[44:47], v[28:31], v[116:119], v[44:47]
s_waitcnt vmcnt(12)
v_mfma_f32_16x16x32_bf16 v[44:47], v[32:35], v[120:123], v[44:47]
s_waitcnt vmcnt(11)
v_mfma_f32_16x16x32_bf16 v[44:47], v[32:35], v[124:127], v[44:47]
s_waitcnt vmcnt(10)
v_mfma_f32_16x16x32_bf16 v[48:51], v[28:31], v[128:131], v[48:51]
s_waitcnt vmcnt(9)
v_mfma_f32_16x16x32_bf16 v[48:51], v[28:31], v[132:135], v[48:51]
s_waitcnt vmcnt(8)
v_mfma_f32_16x16x32_bf16 v[48:51], v[32:35], v[136:139], v[48:51]
s_waitcnt vmcnt(7)
v_mfma_f32_16x16x32_bf16 v[48:51], v[32:35], v[140:143], v[48:51]
s_waitcnt vmcnt(6)
v_mfma_f32_16x16x32_bf16 v[52:55], v[28:31], v[144:147], v[52:55]
s_waitcnt vmcnt(5)
v_mfma_f32_16x16x32_bf16 v[52:55], v[28:31], v[148:151], v[52:55]
s_waitcnt vmcnt(4)
v_mfma_f32_16x16x32_bf16 v[52:55], v[32:35], v[152:155], v[52:55]
s_waitcnt vmcnt(3)
v_mfma_f32_16x16x32_bf16 v[52:55], v[32:35], v[156:159], v[52:55]
s_waitcnt vmcnt(2)
v_mfma_f32_16x16x32_bf16 v[56:59], v[28:31], v[160:163], v[56:59]
s_waitcnt vmcnt(1)
v_mfma_f32_16x16x32_bf16 v[56:59], v[28:31], v[164:167], v[56:59]
s_mul_i32 s47, s45, 36864
v_cvt_pk_bf16_f32 v72, v40, v41
v_cvt_pk_bf16_f32 v74, v44, v45
v_cvt_pk_bf16_f32 v73, v42, v43
v_cvt_pk_bf16_f32 v75, v46, v47
v_permlane16_swap_b32 v72, v74
s_nop 0
v_permlane16_swap_b32 v73, v75
buffer_store_dwordx4 v[72:75], v12, s[16:19], s47 offen offset:0
v_cvt_pk_bf16_f32 v76, v48, v49
v_cvt_pk_bf16_f32 v78, v52, v53
v_cvt_pk_bf16_f32 v77, v50, v51
v_cvt_pk_bf16_f32 v79, v54, v55
v_permlane16_swap_b32 v76, v78
s_nop 0
v_permlane16_swap_b32 v77, v79
buffer_store_dwordx4 v[76:79], v12, s[16:19], s47 offen offset:512
v_cvt_pk_bf16_f32 v80, v56, v57
v_cvt_pk_bf16_f32 v81, v58, v59
s_mov_b64 exec, 0xffffffff
buffer_store_dwordx2 v[80:81], v13, s[16:19], s47 offen offset:1024
s_mov_b64 exec, -1
v_mov_b32 v18, s48
s_mov_b32 s45, s48
s_add_u32 s48, s48, 1
s_waitcnt vmcnt(3)
v_cmp_gt_u32 vcc, s48, v24
s_nop 0
s_and_b32 vcc_lo, vcc_lo, 0xffffff
s_cbranch_scc1 red_late_242
s_mul_i32 s47, s45, 294912
s_add_u32 s47, s47, s51
s_add_u32 s46, s47, 147456
buffer_load_dwordx4 v[96:99], v8, s[4:7], s47 offen offset:0 sc1
buffer_load_dwordx4 v[100:103], v8, s[4:7], s46 offen offset:0 sc1
buffer_load_dwordx4 v[104:107], v8, s[4:7], s47 offen offset:256 sc1
buffer_load_dwordx4 v[108:111], v8, s[4:7], s46 offen offset:256 sc1
buffer_load_dwordx4 v[112:115], v8, s[4:7], s47 offen offset:512 sc1
buffer_load_dwordx4 v[116:119], v8, s[4:7], s46 offen offset:512 sc1
buffer_load_dwordx4 v[120:123], v8, s[4:7], s47 offen offset:768 sc1
buffer_load_dwordx4 v[124:127], v8, s[4:7], s46 offen offset:768 sc1
buffer_load_dwordx4 v[128:131], v8, s[4:7], s47 offen offset:1024 sc1
buffer_load_dwordx4 v[132:135], v8, s[4:7], s46 offen offset:1024 sc1
buffer_load_dwordx4 v[136:139], v8, s[4:7], s47 offen offset:1280 sc1
buffer_load_dwordx4 v[140:143], v8, s[4:7], s46 offen offset:1280 sc1
buffer_load_dwordx4 v[144:147], v8, s[4:7], s47 offen offset:1536 sc1
buffer_load_dwordx4 v[148:151], v8, s[4:7], s46 offen offset:1536 sc1
buffer_load_dwordx4 v[152:155], v8, s[4:7], s47 offen offset:1792 sc1
buffer_load_dwordx4 v[156:159], v8, s[4:7], s46 offen offset:1792 sc1
buffer_load_dwordx4 v[160:163], v8, s[4:7], s47 offen offset:2048 sc1
buffer_load_dwordx4 v[164:167], v8, s[4:7], s46 offen offset:2048 sc1
s_branch red_have_241
red_late_242:
s_cmp_lt_u32 s45, 64
s_cbranch_scc1 red_loop_240
s_endpgm
L_fail:
s_mov_b64 exec, -1
v_mov_b32 v2, s98
v_mov_b32 v3, 252
s_mov_b32 s12, s40
s_and_b32 s13, s41, 0xffff
s_mov_b32 s14, 256
s_mov_b32 s15, 0x20000
buffer_store_dword v2, v3, s[12:15], 0 offen
s_waitcnt vmcnt(0)
s_endpgm
L_chain:
s_mul_i32 s53, s50, 50331648
s_add_u32 s53, s53, 10821632
s_mul_i32 s54, s50, 8388608
s_add_u32 s54, s54, 111484928
s_mul_i32 s55, s50, 589824
s_add_u32 s55, s55, 131072
s_mul_i32 s56, s50, 36864
s_add_u32 s56, s56, 1310720
s_mul_i32 s57, s50, 4
s_add_u32 s57, s57, 48
s_mul_i32 s58, s50, 32768
s_add_u32 s58, s58, 0
v_lshlrev_b32 v1, 4, v0
v_lshrrev_b32 v28, 4, v0
v_lshlrev_b32 v29, 1, v28
v_and_b32 v32, 15, v0
v_xor_b32 v32, v32, v29
v_lshlrev_b32 v32, 4, v32
v_lshlrev_b32 v28, 13, v28
v_add_u32 v32, v28, v32
v_xor_b32 v33, 128, v32
s_mov_b32 s8, s24
s_and_b32 s9, s25, 0xffff
s_mov_b32 s10, 4718592
s_mov_b32 s11, 0x20000
s_lshl_b32 s61, s51, 8
s_mul_i32 s60, s3, 393216
s_add_u32 s61, s61, s60
s_add_u32 s61, s61, 0
s_mul_i32 s60, s3, 12288
s_add_u32 m0, s60, 0
s_mul_i32 s62, s3, 48
s_add_u32 s63, s62, 48
sq_248:
s_bitcmp1_b32 s62, 5
s_cbranch_scc1 sq_249
buffer_load_dwordx4 v32, s[8:11], s61 offen lds
s_branch sq_250
sq_249:
buffer_load_dwordx4 v33, s[8:11], s61 offen lds
sq_250:
s_add_u32 s62, s62, 4
s_add_u32 s61, s61, 32768
s_add_u32 m0, m0, 1024
s_cmp_lt_u32 s62, s63
s_cbranch_scc1 sq_248
s_mov_b32 s8, s24
s_and_b32 s9, s25, 0xffff
s_mov_b32 s10, 4718592
s_mov_b32 s11, 0x20000
s_lshl_b32 s61, s51, 8
s_mul_i32 s60, s3, 393216
s_add_u32 s61, s61, s60
s_add_u32 s61, s61, 1572864
s_mul_i32 s60, s3, 12288
s_add_u32 m0, s60, 49152
s_mul_i32 s62, s3, 48
s_add_u32 s63, s62, 48
sq_251:
s_bitcmp1_b32 s62, 5
s_cbranch_scc1 sq_252
buffer_load_dwordx4 v32, s[8:11], s61 offen lds
s_branch sq_253
sq_252:
buffer_load_dwordx4 v33, s[8:11], s61 offen lds
sq_253:
s_add_u32 s62, s62, 4
s_add_u32 s61, s61, 32768
s_add_u32 m0, m0, 1024
s_cmp_lt_u32 s62, s63
s_cbranch_scc1 sq_251
s_mov_b32 s8, s24
s_and_b32 s9, s25, 0xffff
s_mov_b32 s10, 4718592
s_mov_b32 s11, 0x20000
s_lshl_b32 s61, s51, 8
s_mul_i32 s60, s3, 393216
s_add_u32 s61, s61, s60
s_add_u32 s61, s61, 3145728
s_mul_i32 s60, s3, 12288
s_add_u32 m0, s60, 98304
s_mul_i32 s62, s3, 48
s_add_u32 s63, s62, 48
sq_254:
s_bitcmp1_b32 s62, 5
s_cbranch_scc1 sq_255
buffer_load_dwordx4 v32, s[8:11], s61 offen lds
s_branch sq_256
sq_255:
buffer_load_dwordx4 v33, s[8:11], s61 offen lds
sq_256:
s_add_u32 s62, s62, 4
s_add_u32 s61, s61, 32768
s_add_u32 m0, m0, 1024
s_cmp_lt_u32 s62, s63
s_cbranch_scc1 sq_254
v_lshlrev_b32 v1, 4, v0
v_lshlrev_b32 v15, 3, v0
v_add_u32 v2, 139264, v15
v_and_b32 v24, 1, v0
v_mov_b32 v25, 0x88888888
v_mov_b32 v26, 0xdddddddd
v_cmp_eq_u32 vcc, 1, v24
s_nop 1
v_cndmask_b32 v3, v25, v26, vcc
v_lshrrev_b32 v24, 5, v0
v_bfe_u32 v25, v0, 4, 1
v_and_b32 v26, 15, v0
v_lshrrev_b32 v27, 4, v0
s_lshl_b32 s60, s3, 5
v_bfe_u32 v28, v0, 2, 1
v_lshlrev_b32 v28, 3, v28
v_bfe_u32 v29, v0, 3, 1
v_lshl_add_u32 v28, v29, 2, v28
v_and_b32 v29, 3, v0
v_add3_u32 v28, v28, v29, s60
v_lshlrev_b32 v28, 5, v28
v_lshl_add_u32 v28, v27, 3, v28
v_add_u32 v4, 148480, v28
v_bfe_u32 v28, v0, 1, 3
v_lshlrev_b32 v28, 5, v28
v_and_b32 v29, 1, v0
v_lshl_add_u32 v28, v29, 9, v28
v_lshl_add_u32 v28, v27, 3, v28
s_mul_i32 s60, s3, 2304
s_add_u32 s60, s60, 139264
v_add_u32 v11, s60, v28
s_add_u32 s68, s60, 2048
s_lshl_b32 s78, s3, 9
s_sub_u32 s78, s78, 137216
v_lshrrev_b32 v28, 3, v0
v_lshlrev_b32 v28, 12, v28
v_and_b32 v29, 7, v0
v_lshl_add_u32 v9, v29, 4, v28
v_lshlrev_b32 v28, 9, v24
v_lshl_add_u32 v28, v25, 7, v28
v_lshl_add_u32 v28, v26, 3, v28
v_add_u32 v5, 148480, v28
v_bfe_u32 v28, v0, 2, 2
v_lshlrev_b32 v28, 1, v28
v_and_b32 v30, 1, v0
v_add_u32 v30, v28, v30
v_lshlrev_b32 v28, 8, v24
v_lshl_add_u32 v28, v25, 7, v28
v_lshl_add_u32 v12, v30, 4, v28
v_mov_b32 v31, v30
v_mov_b32 v29, 2147483632
v_and_b32 v28, 2, v0
v_cmp_eq_u32 vcc, 0, v28
s_lshl_b32 s60, s3, 9
v_add_u32 v12, s60, v12
v_cndmask_b32 v12, v29, v12, vcc
v_min_u32 v28, 3, v0
v_lshrrev_b32 v29, 1, v28
v_lshlrev_b32 v29, 8, v29
v_and_b32 v28, 1, v28
v_mul_u32_u24 v28, 7, v28
s_lshl_b32 s60, s51, 3
s_add_u32 s60, s60, 256
v_add3_u32 v28, v28, v29, s60
v_mul_u32_u24 v28, 43691, v28
v_lshrrev_b32 v28, 19, v28
v_mul_u32_u24 v28, 128, v28
v_add_u32 v28, 2048, v28
s_mul_i32 s60, s51, 128
s_add_u32 s60, s60, 10240
v_mov_b32 v29, s60
v_cmp_eq_u32 vcc, 4, v0
s_nop 1
v_cndmask_b32 v28, v28, v29, vcc
v_mov_b32 v29, 2147483632
s_cmp_eq_u32 s3, 3
s_cselect_b32 s61, 5, 0
v_cmp_gt_u32 vcc, s61, v0
s_nop 1
v_cndmask_b32 v7, v29, v28, vcc
s_lshr_b32 s60, s3, 1
s_lshl_b32 s60, s60, 10
s_and_b32 s61, s3, 1
s_lshl_b32 s61, s61, 9
s_add_u32 s60, s60, s61
s_add_u32 s60, s60, 152576
v_lshrrev_b32 v28, 4, v0
v_lshlrev_b32 v28, 2, v28
v_lshl_add_u32 v28, v31, 5, v28
v_add_u32 v6, s60, v28
v_lshlrev_b32 v28, 2, v0
v_add_u32 v28, 162816, v28
v_and_b32 v29, 2, v0
v_cmp_eq_u32 vcc, 0, v29
s_nop 1
v_cndmask_b32 v6, v6, v28, vcc
s_and_b32 s72, s3, 1
s_lshl_b32 s72, s72, 2
s_and_b32 s60, s3, 2
s_lshl_b32 s60, s60, 3
s_add_u32 s72, s72, s60
v_lshlrev_b32 v29, 6, v25
v_lshl_add_u32 v29, v24, 5, v29
v_lshl_add_u32 v10, v26, 2, v29
v_mov_b32 v29, 2147483632
v_cmp_gt_u32 vcc, 8, v26
s_nop 1
v_cndmask_b32 v10, v29, v10, vcc
s_mov_b32 s66, 0x3e0293ee
s_mov_b32 s70, 0xfffffffe
s_mov_b32 s98, 0xff800000
s_mov_b32 s99, 0xff800000
s_mul_i32 s60, s3, 65536
s_lshl_b32 s61, s51, 7
s_add_u32 s74, s60, s61
s_add_u32 s74, s74, s55
s_lshl_b32 s69, s51, 1
s_add_u32 s69, s69, s3
s_add_u32 s60, s51, 64
s_cmp_lt_u32 s3, 2
s_cselect_b32 s69, s69, s60
s_cselect_b32 s48, 1, 0
s_cmp_eq_u32 s3, 2
s_cselect_b32 s60, 1, 0
s_cmp_lt_u32 s51, 8
s_cselect_b32 s60, s60, 0
s_or_b32 s48, s48, s60
s_lshl_b32 s60, s3, 13
s_lshl_b32 s49, s51, 7
s_add_u32 s49, s49, s60
s_add_u32 s49, s49, s55
s_add_u32 s49, s49, 262144
s_lshl_b32 s75, s69, 12
s_add_u32 s75, s75, s55
s_lshl_b32 s76, s69, 7
s_cmp_eq_u32 s48, 0
s_cselect_b32 s76, 0x70000000, s76
s_add_u32 s79, s56, 9216
s_add_u32 s71, s56, 18432
s_mov_b32 s73, s56
s_cmp_eq_u32 s48, 0
s_cselect_b32 s61, 0x70000000, s75
v_mov_b64 v[24:25], 0
v_mov_b64 v[26:27], 0
buffer_store_dwordx4 v[24:27], v1, s[4:7], s61 offen offset:0 sc1
buffer_store_dwordx4 v[24:27], v1, s[4:7], s61 offen offset:1024 sc1
buffer_store_dwordx4 v[24:27], v1, s[4:7], s61 offen offset:2048 sc1
buffer_store_dwordx4 v[24:27], v1, s[4:7], s61 offen offset:3072 sc1
v_mov_b32 v28, -1
s_add_u32 s60, s76, s56
s_add_u32 s60, s60, 0
buffer_store_dword v28, v10, s[4:7], s60 offen sc1
s_add_u32 s60, s76, s56
s_add_u32 s60, s60, 9216
buffer_store_dword v28, v10, s[4:7], s60 offen sc1
s_add_u32 s60, s76, s56
s_add_u32 s60, s60, 18432
buffer_store_dword v28, v10, s[4:7], s60 offen sc1
s_mov_b64 exec, -1
s_mov_b32 s8, s22
s_and_b32 s9, s23, 0xffff
s_mov_b32 s10, 9216
s_mov_b32 s11, 0x20000
s_lshl_b32 s60, s3, 6
v_add_u32 v24, s60, v0
v_lshrrev_b32 v26, 3, v24
v_lshlrev_b32 v26, 2, v26
v_and_b32 v27, 7, v24
v_mul_u32_u24 v27, 1152, v27
v_add_u32 v26, v26, v27
buffer_load_dword v16, v26, s[8:11], 0 offen offset:0
buffer_load_dword v17, v26, s[8:11], 0 offen offset:128
buffer_load_dword v18, v26, s[8:11], 0 offen offset:256
buffer_load_dword v19, v26, s[8:11], 0 offen offset:384
buffer_load_dword v20, v26, s[8:11], 0 offen offset:512
buffer_load_dword v21, v26, s[8:11], 0 offen offset:640
buffer_load_dword v22, v26, s[8:11], 0 offen offset:768
buffer_load_dword v23, v26, s[8:11], 0 offen offset:896
buffer_load_dword v14, v26, s[8:11], 0 offen offset:1024
v_bfe_u32 v24, v0, 4, 1
v_lshrrev_b32 v25, 5, v0
v_bfe_u32 v26, v0, 2, 2
v_lshlrev_b32 v27, 5, v24
v_lshl_add_u32 v27, v25, 3, v27
v_add_u32 v27, v27, v26
v_lshlrev_b32 v27, 8, v27
v_lshl_add_u32 v26, v24, 2, v26
s_lshl_b32 s60, s3, 1
s_add_u32 s60, s60, 0
v_xor_b32 v26, s60, v26
v_lshl_add_u32 v27, v26, 5, v27
v_and_b32 v26, 3, v0
v_lshl_add_u32 v15, v26, 3, v27
v_bfe_u32 v24, v0, 4, 1
v_lshrrev_b32 v25, 5, v0
v_bfe_u32 v26, v0, 2, 2
v_lshlrev_b32 v27, 5, v24
v_lshl_add_u32 v27, v25, 3, v27
v_add_u32 v27, v27, v26
v_lshlrev_b32 v27, 8, v27
v_lshl_add_u32 v26, v24, 2, v26
s_lshl_b32 s60, s3, 1
s_add_u32 s60, s60, 1
v_xor_b32 v26, s60, v26
v_lshl_add_u32 v27, v26, 5, v27
v_and_b32 v26, 3, v0
v_lshl_add_u32 v13, v26, 3, v27
v_lshrrev_b32 v24, 4, v0
v_lshlrev_b32 v24, 3, v24
v_bfe_u32 v25, v0, 2, 2
v_add_u32 v24, v24, v25
v_mul_u32_u24 v24, 1152, v24
v_and_b32 v25, 3, v0
v_lshl_add_u32 v24, v25, 3, v24
s_mul_i32 s60, s3, 288
v_add_u32 v8, s60, v24
s_waitcnt vmcnt(40)
s_barrier
v_add_u32 v28, 0, v15
v_add_u32 v29, 0, v13
ds_read_b64_tr_b16 a[0:1], v28 offset:0
ds_read_b64_tr_b16 a[2:3], v28 offset:1024
ds_read_b64_tr_b16 a[4:5], v28 offset:4096
ds_read_b64_tr_b16 a[6:7], v28 offset:5120
ds_read_b64_tr_b16 a[72:73], v29 offset:0
ds_read_b64_tr_b16 a[74:75], v29 offset:1024
ds_read_b64_tr_b16 a[76:77], v29 offset:4096
ds_read_b64_tr_b16 a[78:79], v29 offset:5120
s_waitcnt lgkmcnt(0)
ds_read_b64_tr_b16 a[8:9], v28 offset:16384
ds_read_b64_tr_b16 a[10:11], v28 offset:17408
ds_read_b64_tr_b16 a[12:13], v28 offset:20480
ds_read_b64_tr_b16 a[14:15], v28 offset:21504
ds_read_b64_tr_b16 a[80:81], v29 offset:16384
ds_read_b64_tr_b16 a[82:83], v29 offset:17408
ds_read_b64_tr_b16 a[84:85], v29 offset:20480
ds_read_b64_tr_b16 a[86:87], v29 offset:21504
s_waitcnt lgkmcnt(0)
ds_read_b64_tr_b16 a[16:17], v28 offset:32768
ds_read_b64_tr_b16 a[18:19], v28 offset:33792
ds_read_b64_tr_b16 a[20:21], v28 offset:36864
ds_read_b64_tr_b16 a[22:23], v28 offset:37888
ds_read_b64_tr_b16 a[88:89], v29 offset:32768
ds_read_b64_tr_b16 a[90:91], v29 offset:33792
ds_read_b64_tr_b16 a[92:93], v29 offset:36864
ds_read_b64_tr_b16 a[94:95], v29 offset:37888
s_waitcnt lgkmcnt(0)
s_barrier
s_mov_b32 s8, s26
s_and_b32 s9, s27, 0xffff
s_mov_b32 s10, 4718592
s_mov_b32 s11, 0x20000
s_lshl_b32 s61, s51, 8
s_mul_i32 s60, s3, 393216
s_add_u32 s61, s61, s60
s_add_u32 s61, s61, 0
s_mul_i32 s60, s3, 12288
s_add_u32 m0, s60, 0
s_mul_i32 s62, s3, 48
s_add_u32 s63, s62, 48
sq_257:
s_bitcmp1_b32 s62, 5
s_cbranch_scc1 sq_258
buffer_load_dwordx4 v32, s[8:11], s61 offen lds
s_branch sq_259
sq_258:
buffer_load_dwordx4 v33, s[8:11], s61 offen lds
sq_259:
s_add_u32 s62, s62, 4
s_add_u32 s61, s61, 32768
s_add_u32 m0, m0, 1024
s_cmp_lt_u32 s62, s63
s_cbranch_scc1 sq_257
s_waitcnt vmcnt(40)
s_barrier
v_add_u32 v28, 49152, v15
v_add_u32 v29, 49152, v13
ds_read_b64_tr_b16 a[24:25], v28 offset:0
ds_read_b64_tr_b16 a[26:27], v28 offset:1024
ds_read_b64_tr_b16 a[28:29], v28 offset:4096
ds_read_b64_tr_b16 a[30:31], v28 offset:5120
ds_read_b64_tr_b16 a[96:97], v29 offset:0
ds_read_b64_tr_b16 a[98:99], v29 offset:1024
ds_read_b64_tr_b16 a[100:101], v29 offset:4096
ds_read_b64_tr_b16 a[102:103], v29 offset:5120
s_waitcnt lgkmcnt(0)
ds_read_b64_tr_b16 a[32:33], v28 offset:16384
ds_read_b64_tr_b16 a[34:35], v28 offset:17408
ds_read_b64_tr_b16 a[36:37], v28 offset:20480
ds_read_b64_tr_b16 a[38:39], v28 offset:21504
ds_read_b64_tr_b16 a[104:105], v29 offset:16384
ds_read_b64_tr_b16 a[106:107], v29 offset:17408
ds_read_b64_tr_b16 a[108:109], v29 offset:20480
ds_read_b64_tr_b16 a[110:111], v29 offset:21504
s_waitcnt lgkmcnt(0)
ds_read_b64_tr_b16 a[40:41], v28 offset:32768
ds_read_b64_tr_b16 a[42:43], v28 offset:33792
ds_read_b64_tr_b16 a[44:45], v28 offset:36864
ds_read_b64_tr_b16 a[46:47], v28 offset:37888
ds_read_b64_tr_b16 a[112:113], v29 offset:32768
ds_read_b64_tr_b16 a[114:115], v29 offset:33792
ds_read_b64_tr_b16 a[116:117], v29 offset:36864
ds_read_b64_tr_b16 a[118:119], v29 offset:37888
s_waitcnt lgkmcnt(0)
s_barrier
s_mov_b32 s8, s26
s_and_b32 s9, s27, 0xffff
s_mov_b32 s10, 4718592
s_mov_b32 s11, 0x20000
s_lshl_b32 s61, s51, 8
s_mul_i32 s60, s3, 393216
s_add_u32 s61, s61, s60
s_add_u32 s61, s61, 1572864
s_mul_i32 s60, s3, 12288
s_add_u32 m0, s60, 49152
s_mul_i32 s62, s3, 48
s_add_u32 s63, s62, 48
sq_260:
s_bitcmp1_b32 s62, 5
s_cbranch_scc1 sq_261
buffer_load_dwordx4 v32, s[8:11], s61 offen lds
s_branch sq_262
sq_261:
buffer_load_dwordx4 v33, s[8:11], s61 offen lds
sq_262:
s_add_u32 s62, s62, 4
s_add_u32 s61, s61, 32768
s_add_u32 m0, m0, 1024
s_cmp_lt_u32 s62, s63
s_cbranch_scc1 sq_260
s_waitcnt vmcnt(40)
s_barrier
s_or_b32 s60, s3, s58
s_cbranch_scc1 pri_263
v_mov_b32 v24, 1
v_mov_b32 v25, 224
s_mov_b64 exec, 1
buffer_atomic_add v24, v25, s[12:15], 0 offen
s_mov_b64 exec, -1
pri_263:
v_add_u32 v28, 98304, v15
v_add_u32 v29, 98304, v13
ds_read_b64_tr_b16 a[48:49], v28 offset:0
ds_read_b64_tr_b16 a[50:51], v28 offset:1024
ds_read_b64_tr_b16 a[52:53], v28 offset:4096
ds_read_b64_tr_b16 a[54:55], v28 offset:5120
ds_read_b64_tr_b16 a[120:121], v29 offset:0
ds_read_b64_tr_b16 a[122:123], v29 offset:1024
ds_read_b64_tr_b16 a[124:125], v29 offset:4096
ds_read_b64_tr_b16 a[126:127], v29 offset:5120
s_waitcnt lgkmcnt(0)
ds_read_b64_tr_b16 a[56:57], v28 offset:16384
ds_read_b64_tr_b16 a[58:59], v28 offset:17408
ds_read_b64_tr_b16 a[60:61], v28 offset:20480
ds_read_b64_tr_b16 a[62:63], v28 offset:21504
ds_read_b64_tr_b16 a[128:129], v29 offset:16384
ds_read_b64_tr_b16 a[130:131], v29 offset:17408
ds_read_b64_tr_b16 a[132:133], v29 offset:20480
ds_read_b64_tr_b16 a[134:135], v29 offset:21504
s_waitcnt lgkmcnt(0)
ds_read_b64_tr_b16 a[64:65], v28 offset:32768
ds_read_b64_tr_b16 a[66:67], v28 offset:33792
ds_read_b64_tr_b16 a[68:69], v28 offset:36864
ds_read_b64_tr_b16 a[70:71], v28 offset:37888
ds_read_b64_tr_b16 a[136:137], v29 offset:32768
ds_read_b64_tr_b16 a[138:139], v29 offset:33792
ds_read_b64_tr_b16 a[140:141], v29 offset:36864
ds_read_b64_tr_b16 a[142:143], v29 offset:37888
s_waitcnt lgkmcnt(0)
s_barrier
s_mov_b32 s8, s26
s_and_b32 s9, s27, 0xffff
s_mov_b32 s10, 4718592
s_mov_b32 s11, 0x20000
s_lshl_b32 s61, s51, 8
s_mul_i32 s60, s3, 393216
s_add_u32 s61, s61, s60
s_add_u32 s61, s61, 3145728
s_mul_i32 s60, s3, 12288
s_add_u32 m0, s60, 98304
s_mul_i32 s62, s3, 48
s_add_u32 s63, s62, 48
sq_264:
s_bitcmp1_b32 s62, 5
s_cbranch_scc1 sq_265
buffer_load_dwordx4 v32, s[8:11], s61 offen lds
s_branch sq_266
sq_265:
buffer_load_dwordx4 v33, s[8:11], s61 offen lds
sq_266:
s_add_u32 s62, s62, 4
s_add_u32 s61, s61, 32768
s_add_u32 m0, m0, 1024
s_cmp_lt_u32 s62, s63
s_cbranch_scc1 sq_264
s_waitcnt vmcnt(24)
s_barrier
s_cmp_lg_u32 s3, 0
s_cbranch_scc1 cb_267
v_mov_b32 v24, s52
v_mov_b32 v25, s57
s_mov_b64 exec, 1
buffer_atomic_add v24, v25, s[12:15], 0 offen
s_mov_b64 exec, -1
cb_267:
v_add_u32 v28, 0, v15
v_add_u32 v29, 0, v13
ds_read_b64_tr_b16 a[144:145], v28 offset:0
ds_read_b64_tr_b16 a[146:147], v28 offset:1024
ds_read_b64_tr_b16 a[148:149], v28 offset:4096
ds_read_b64_tr_b16 a[150:151], v28 offset:5120
ds_read_b64_tr_b16 a[216:217], v29 offset:0
ds_read_b64_tr_b16 a[218:219], v29 offset:1024
ds_read_b64_tr_b16 a[220:221], v29 offset:4096
ds_read_b64_tr_b16 a[222:223], v29 offset:5120
s_waitcnt lgkmcnt(0)
ds_read_b64_tr_b16 a[152:153], v28 offset:16384
ds_read_b64_tr_b16 a[154:155], v28 offset:17408
ds_read_b64_tr_b16 a[156:157], v28 offset:20480
ds_read_b64_tr_b16 a[158:159], v28 offset:21504
ds_read_b64_tr_b16 a[224:225], v29 offset:16384
ds_read_b64_tr_b16 a[226:227], v29 offset:17408
ds_read_b64_tr_b16 a[228:229], v29 offset:20480
ds_read_b64_tr_b16 a[230:231], v29 offset:21504
s_waitcnt lgkmcnt(0)
ds_read_b64_tr_b16 a[160:161], v28 offset:32768
ds_read_b64_tr_b16 a[162:163], v28 offset:33792
ds_read_b64_tr_b16 a[164:165], v28 offset:36864
ds_read_b64_tr_b16 a[166:167], v28 offset:37888
ds_read_b64_tr_b16 a[232:233], v29 offset:32768
ds_read_b64_tr_b16 a[234:235], v29 offset:33792
ds_read_b64_tr_b16 a[236:237], v29 offset:36864
ds_read_b64_tr_b16 a[238:239], v29 offset:37888
s_waitcnt lgkmcnt(0)
s_barrier
s_mov_b32 s8, s30
s_and_b32 s9, s31, 0xffff
s_mov_b32 s10, 4718592
s_mov_b32 s11, 0x20000
s_mul_i32 s61, s51, 147456
s_mul_i32 s60, s3, 9216
s_add_u32 s61, s61, s60
s_add_u32 s61, s61, 0
s_add_u32 m0, s60, 0
s_mov_b32 s62, 9
so_268:
buffer_load_dwordx4 v1, s[8:11], s61 offen lds
s_add_u32 s61, s61, 1024
s_add_u32 m0, m0, 1024
s_sub_u32 s62, s62, 1
s_cmp_lg_u32 s62, 0
s_cbranch_scc1 so_268
s_waitcnt vmcnt(21)
s_barrier
v_add_u32 v28, 49152, v15
v_add_u32 v29, 49152, v13
ds_read_b64_tr_b16 a[168:169], v28 offset:0
ds_read_b64_tr_b16 a[170:171], v28 offset:1024
ds_read_b64_tr_b16 a[172:173], v28 offset:4096
ds_read_b64_tr_b16 a[174:175], v28 offset:5120
ds_read_b64_tr_b16 a[240:241], v29 offset:0
ds_read_b64_tr_b16 a[242:243], v29 offset:1024
ds_read_b64_tr_b16 a[244:245], v29 offset:4096
ds_read_b64_tr_b16 a[246:247], v29 offset:5120
s_waitcnt lgkmcnt(0)
ds_read_b64_tr_b16 a[176:177], v28 offset:16384
ds_read_b64_tr_b16 a[178:179], v28 offset:17408
ds_read_b64_tr_b16 a[180:181], v28 offset:20480
ds_read_b64_tr_b16 a[182:183], v28 offset:21504
ds_read_b64_tr_b16 a[248:249], v29 offset:16384
ds_read_b64_tr_b16 a[250:251], v29 offset:17408
ds_read_b64_tr_b16 a[252:253], v29 offset:20480
ds_read_b64_tr_b16 a[254:255], v29 offset:21504
s_waitcnt lgkmcnt(0)
ds_read_b64_tr_b16 a[184:185], v28 offset:32768
ds_read_b64_tr_b16 a[186:187], v28 offset:33792
ds_read_b64_tr_b16 a[188:189], v28 offset:36864
ds_read_b64_tr_b16 a[190:191], v28 offset:37888
ds_read_b64_tr_b16 v[72:73], v29 offset:32768
ds_read_b64_tr_b16 v[74:75], v29 offset:33792
ds_read_b64_tr_b16 v[76:77], v29 offset:36864
ds_read_b64_tr_b16 v[78:79], v29 offset:37888
s_waitcnt lgkmcnt(0)
s_barrier
s_mov_b32 s8, s30
s_and_b32 s9, s31, 0xffff
s_mov_b32 s10, 4718592
s_mov_b32 s11, 0x20000
s_mul_i32 s61, s51, 147456
s_mul_i32 s60, s3, 9216
s_add_u32 s61, s61, s60
s_add_u32 s61, s61, 36864
s_add_u32 m0, s60, 49152
s_mov_b32 s62, 9
so_269:
buffer_load_dwordx4 v1, s[8:11], s61 offen lds
s_add_u32 s61, s61, 1024
s_add_u32 m0, m0, 1024
s_sub_u32 s62, s62, 1
s_cmp_lg_u32 s62, 0
s_cbranch_scc1 so_269
s_waitcnt vmcnt(18)
s_barrier
v_add_u32 v28, 98304, v15
v_add_u32 v29, 98304, v13
ds_read_b64_tr_b16 a[192:193], v28 offset:0
ds_read_b64_tr_b16 a[194:195], v28 offset:1024
ds_read_b64_tr_b16 a[196:197], v28 offset:4096
ds_read_b64_tr_b16 a[198:199], v28 offset:5120
ds_read_b64_tr_b16 v[80:81], v29 offset:0
ds_read_b64_tr_b16 v[82:83], v29 offset:1024
ds_read_b64_tr_b16 v[84:85], v29 offset:4096
ds_read_b64_tr_b16 v[86:87], v29 offset:5120
s_waitcnt lgkmcnt(0)
ds_read_b64_tr_b16 a[200:201], v28 offset:16384
ds_read_b64_tr_b16 a[202:203], v28 offset:17408
ds_read_b64_tr_b16 a[204:205], v28 offset:20480
ds_read_b64_tr_b16 a[206:207], v28 offset:21504
ds_read_b64_tr_b16 v[88:89], v29 offset:16384
ds_read_b64_tr_b16 v[90:91], v29 offset:17408
ds_read_b64_tr_b16 v[92:93], v29 offset:20480
ds_read_b64_tr_b16 v[94:95], v29 offset:21504
s_waitcnt lgkmcnt(0)
ds_read_b64_tr_b16 a[208:209], v28 offset:32768
ds_read_b64_tr_b16 a[210:211], v28 offset:33792
ds_read_b64_tr_b16 a[212:213], v28 offset:36864
ds_read_b64_tr_b16 a[214:215], v28 offset:37888
ds_read_b64_tr_b16 v[96:97], v29 offset:32768
ds_read_b64_tr_b16 v[98:99], v29 offset:33792
ds_read_b64_tr_b16 v[100:101], v29 offset:36864
ds_read_b64_tr_b16 v[102:103], v29 offset:37888
s_waitcnt lgkmcnt(0)
s_barrier
s_mov_b32 s8, s30
s_and_b32 s9, s31, 0xffff
s_mov_b32 s10, 4718592
s_mov_b32 s11, 0x20000
s_mul_i32 s61, s51, 147456
s_mul_i32 s60, s3, 9216
s_add_u32 s61, s61, s60
s_add_u32 s61, s61, 73728
s_add_u32 m0, s60, 98304
s_mov_b32 s62, 9
so_270:
buffer_load_dwordx4 v1, s[8:11], s61 offen lds
s_add_u32 s61, s61, 1024
s_add_u32 m0, m0, 1024
s_sub_u32 s62, s62, 1
s_cmp_lg_u32 s62, 0
s_cbranch_scc1 so_270
s_waitcnt vmcnt(18)
s_barrier
v_add_u32 v28, 0, v8
ds_read_b64_tr_b16 v[104:105], v28 offset:0
ds_read_b64_tr_b16 v[106:107], v28 offset:4608
ds_read_b64_tr_b16 v[120:121], v28 offset:32
ds_read_b64_tr_b16 v[122:123], v28 offset:4640
ds_read_b64_tr_b16 v[136:137], v28 offset:64
ds_read_b64_tr_b16 v[138:139], v28 offset:4672
s_waitcnt lgkmcnt(0)
ds_read_b64_tr_b16 v[152:153], v28 offset:96
ds_read_b64_tr_b16 v[154:155], v28 offset:4704
ds_read_b64_tr_b16 v[168:169], v28 offset:128
ds_read_b64_tr_b16 v[170:171], v28 offset:4736
ds_read_b64_tr_b16 v[184:185], v28 offset:160
ds_read_b64_tr_b16 v[186:187], v28 offset:4768
s_waitcnt lgkmcnt(0)
ds_read_b64_tr_b16 v[200:201], v28 offset:192
ds_read_b64_tr_b16 v[202:203], v28 offset:4800
ds_read_b64_tr_b16 v[216:217], v28 offset:224
ds_read_b64_tr_b16 v[218:219], v28 offset:4832
ds_read_b64_tr_b16 v[232:233], v28 offset:256
ds_read_b64_tr_b16 v[234:235], v28 offset:4864
s_waitcnt lgkmcnt(0)
s_barrier
s_mov_b32 s8, s30
s_and_b32 s9, s31, 0xffff
s_mov_b32 s10, 4718592
s_mov_b32 s11, 0x20000
s_mul_i32 s61, s51, 147456
s_mul_i32 s60, s3, 9216
s_add_u32 s61, s61, s60
s_add_u32 s61, s61, 110592
s_add_u32 m0, s60, 0
s_mov_b32 s62, 9
so_271:
buffer_load_dwordx4 v1, s[8:11], s61 offen lds
s_add_u32 s61, s61, 1024
s_add_u32 m0, m0, 1024
s_sub_u32 s62, s62, 1
s_cmp_lg_u32 s62, 0
s_cbranch_scc1 so_271
s_waitcnt vmcnt(18)
s_barrier
v_add_u32 v28, 49152, v8
ds_read_b64_tr_b16 v[108:109], v28 offset:0
ds_read_b64_tr_b16 v[110:111], v28 offset:4608
ds_read_b64_tr_b16 v[124:125], v28 offset:32
ds_read_b64_tr_b16 v[126:127], v28 offset:4640
ds_read_b64_tr_b16 v[140:141], v28 offset:64
ds_read_b64_tr_b16 v[142:143], v28 offset:4672
s_waitcnt lgkmcnt(0)
ds_read_b64_tr_b16 v[156:157], v28 offset:96
ds_read_b64_tr_b16 v[158:159], v28 offset:4704
ds_read_b64_tr_b16 v[172:173], v28 offset:128
ds_read_b64_tr_b16 v[174:175], v28 offset:4736
ds_read_b64_tr_b16 v[188:189], v28 offset:160
ds_read_b64_tr_b16 v[190:191], v28 offset:4768
s_waitcnt lgkmcnt(0)
ds_read_b64_tr_b16 v[204:205], v28 offset:192
ds_read_b64_tr_b16 v[206:207], v28 offset:4800
ds_read_b64_tr_b16 v[220:221], v28 offset:224
ds_read_b64_tr_b16 v[222:223], v28 offset:4832
ds_read_b64_tr_b16 v[236:237], v28 offset:256
ds_read_b64_tr_b16 v[238:239], v28 offset:4864
s_waitcnt lgkmcnt(0)
s_barrier
s_mov_b32 s8, s28
s_and_b32 s9, s29, 0xffff
s_mov_b32 s10, 4718592
s_mov_b32 s11, 0x20000
s_lshl_b32 s61, s51, 8
s_mul_i32 s60, s3, 393216
s_add_u32 s61, s61, s60
s_add_u32 s61, s61, 1572864
s_mul_i32 s60, s3, 12288
s_add_u32 m0, s60, 49152
s_mul_i32 s62, s3, 48
s_add_u32 s63, s62, 48
sq_272:
s_bitcmp1_b32 s62, 5
s_cbranch_scc1 sq_273
buffer_load_dwordx4 v32, s[8:11], s61 offen lds
s_branch sq_274
sq_273:
buffer_load_dwordx4 v33, s[8:11], s61 offen lds
sq_274:
s_add_u32 s62, s62, 4
s_add_u32 s61, s61, 32768
s_add_u32 m0, m0, 1024
s_cmp_lt_u32 s62, s63
s_cbranch_scc1 sq_272
s_waitcnt vmcnt(21)
s_barrier
v_lshlrev_b32 v24, 2, v0
v_add_u32 v25, 128, v24
v_cmp_le_u32 vcc, 2, v0
s_nop 1
v_cndmask_b32 v24, v24, v25, vcc
s_mov_b32 s60, 192
v_writelane_b32 v24, s60, 8
v_writelane_b32 v24, s57, 9
s_mov_b64 exec, 0x3ff
buffer_load_dword v27, v24, s[12:15], 0 offen sc1
s_mov_b64 exec, -1
v_add_u32 v28, 98304, v8
ds_read_b64_tr_b16 v[112:113], v28 offset:0
ds_read_b64_tr_b16 v[114:115], v28 offset:4608
ds_read_b64_tr_b16 v[128:129], v28 offset:32
ds_read_b64_tr_b16 v[130:131], v28 offset:4640
ds_read_b64_tr_b16 v[144:145], v28 offset:64
ds_read_b64_tr_b16 v[146:147], v28 offset:4672
s_waitcnt lgkmcnt(0)
ds_read_b64_tr_b16 v[160:161], v28 offset:96
ds_read_b64_tr_b16 v[162:163], v28 offset:4704
ds_read_b64_tr_b16 v[176:177], v28 offset:128
ds_read_b64_tr_b16 v[178:179], v28 offset:4736
ds_read_b64_tr_b16 v[192:193], v28 offset:160
ds_read_b64_tr_b16 v[194:195], v28 offset:4768
s_waitcnt lgkmcnt(0)
ds_read_b64_tr_b16 v[208:209], v28 offset:192
ds_read_b64_tr_b16 v[210:211], v28 offset:4800
ds_read_b64_tr_b16 v[224:225], v28 offset:224
ds_read_b64_tr_b16 v[226:227], v28 offset:4832
ds_read_b64_tr_b16 v[240:241], v28 offset:256
ds_read_b64_tr_b16 v[242:243], v28 offset:4864
s_waitcnt lgkmcnt(0)
s_barrier
s_mov_b32 s8, s28
s_and_b32 s9, s29, 0xffff
s_mov_b32 s10, 4718592
s_mov_b32 s11, 0x20000
s_lshl_b32 s61, s51, 8
s_mul_i32 s60, s3, 393216
s_add_u32 s61, s61, s60
s_add_u32 s61, s61, 3145728
s_mul_i32 s60, s3, 12288
s_add_u32 m0, s60, 98304
s_mul_i32 s62, s3, 48
s_add_u32 s63, s62, 48
sq_275:
s_bitcmp1_b32 s62, 5
s_cbranch_scc1 sq_276
buffer_load_dwordx4 v32, s[8:11], s61 offen lds
s_branch sq_277
sq_276:
buffer_load_dwordx4 v33, s[8:11], s61 offen lds
sq_277:
s_add_u32 s62, s62, 4
s_add_u32 s61, s61, 32768
s_add_u32 m0, m0, 1024
s_cmp_lt_u32 s62, s63
s_cbranch_scc1 sq_275
s_waitcnt vmcnt(24)
s_barrier
v_add_u32 v28, 0, v8
ds_read_b64_tr_b16 v[116:117], v28 offset:0
ds_read_b64_tr_b16 v[118:119], v28 offset:4608
ds_read_b64_tr_b16 v[132:133], v28 offset:32
ds_read_b64_tr_b16 v[134:135], v28 offset:4640
ds_read_b64_tr_b16 v[148:149], v28 offset:64
ds_read_b64_tr_b16 v[150:151], v28 offset:4672
s_waitcnt lgkmcnt(0)
ds_read_b64_tr_b16 v[164:165], v28 offset:96
ds_read_b64_tr_b16 v[166:167], v28 offset:4704
ds_read_b64_tr_b16 v[180:181], v28 offset:128
ds_read_b64_tr_b16 v[182:183], v28 offset:4736
ds_read_b64_tr_b16 v[196:197], v28 offset:160
ds_read_b64_tr_b16 v[198:199], v28 offset:4768
s_waitcnt lgkmcnt(0)
ds_read_b64_tr_b16 v[212:213], v28 offset:192
ds_read_b64_tr_b16 v[214:215], v28 offset:4800
ds_read_b64_tr_b16 v[228:229], v28 offset:224
ds_read_b64_tr_b16 v[230:231], v28 offset:4832
ds_read_b64_tr_b16 v[244:245], v28 offset:256
ds_read_b64_tr_b16 v[246:247], v28 offset:4864
s_waitcnt lgkmcnt(0)
s_barrier
s_mov_b32 s8, s28
s_and_b32 s9, s29, 0xffff
s_mov_b32 s10, 4718592
s_mov_b32 s11, 0x20000
s_lshl_b32 s61, s51, 8
s_mul_i32 s60, s3, 393216
s_add_u32 s61, s61, s60
s_add_u32 s61, s61, 0
s_mul_i32 s60, s3, 12288
s_add_u32 m0, s60, 0
s_mul_i32 s62, s3, 48
s_add_u32 s63, s62, 48
sq_278:
s_bitcmp1_b32 s62, 5
s_cbranch_scc1 sq_279
buffer_load_dwordx4 v32, s[8:11], s61 offen lds
s_branch sq_280
sq_279:
buffer_load_dwordx4 v33, s[8:11], s61 offen lds
sq_280:
s_add_u32 s62, s62, 4
s_add_u32 s61, s61, 32768
s_add_u32 m0, m0, 1024
s_cmp_lt_u32 s62, s63
s_cbranch_scc1 sq_278
s_waitcnt vmcnt(24)
s_barrier
v_cmp_eq_u32 vcc, 32, v27
s_nop 0
s_and_b32 s60, vcc_lo, 0x3ff
s_cmp_eq_u32 s60, 0x3ff
s_cselect_b32 s100, 1, 0
buffer_load_dword v26, v7, s[4:7], s58 offen sc1
v_add_u32 v28, 49152, v15
v_add_u32 v29, 49152, v13
ds_read_b64_tr_b16 v[32:33], v28 offset:0
ds_read_b64_tr_b16 v[34:35], v28 offset:1024
ds_read_b64_tr_b16 v[36:37], v28 offset:4096
ds_read_b64_tr_b16 v[38:39], v28 offset:5120
ds_read_b64_tr_b16 v[40:41], v29 offset:0
ds_read_b64_tr_b16 v[42:43], v29 offset:1024
ds_read_b64_tr_b16 v[44:45], v29 offset:4096
ds_read_b64_tr_b16 v[46:47], v29 offset:5120
s_waitcnt lgkmcnt(0)
ds_read_b64_tr_b16 v[48:49], v28 offset:16384
ds_read_b64_tr_b16 v[50:51], v28 offset:17408
ds_read_b64_tr_b16 v[52:53], v28 offset:20480
ds_read_b64_tr_b16 v[54:55], v28 offset:21504
ds_read_b64_tr_b16 v[56:57], v29 offset:16384
ds_read_b64_tr_b16 v[58:59], v29 offset:17408
ds_read_b64_tr_b16 v[60:61], v29 offset:20480
ds_read_b64_tr_b16 v[62:63], v29 offset:21504
s_waitcnt lgkmcnt(0)
ds_read_b64_tr_b16 v[64:65], v28 offset:32768
ds_read_b64_tr_b16 v[66:67], v28 offset:33792
ds_read_b64_tr_b16 v[68:69], v28 offset:36864
ds_read_b64_tr_b16 v[70:71], v28 offset:37888
ds_read_b64_tr_b16 v[248:249], v29 offset:32768
ds_read_b64_tr_b16 v[250:251], v29 offset:33792
ds_read_b64_tr_b16 v[252:253], v29 offset:36864
ds_read_b64_tr_b16 v[254:255], v29 offset:37888
s_waitcnt lgkmcnt(0)
s_barrier
s_lshl_b32 s60, s3, 12
s_add_u32 s60, s60, 49152
v_add_u32 v28, s60, v1
ds_write_b128 v28, v[32:35] offset:0
ds_write_b128 v28, v[36:39] offset:1024
ds_write_b128 v28, v[40:43] offset:2048
ds_write_b128 v28, v[44:47] offset:3072
ds_write_b128 v28, v[48:51] offset:16384
ds_write_b128 v28, v[52:55] offset:17408
ds_write_b128 v28, v[56:59] offset:18432
ds_write_b128 v28, v[60:63] offset:19456
ds_write_b128 v28, v[64:67] offset:32768
ds_write_b128 v28, v[68:71] offset:33792
ds_write_b128 v28, v[248:251] offset:34816
ds_write_b128 v28, v[252:255] offset:35840
s_waitcnt lgkmcnt(0)
s_barrier
s_waitcnt vmcnt(0)
s_barrier
v_add_u32 v28, 0, v15
v_add_u32 v29, 0, v13
ds_read_b64_tr_b16 v[32:33], v28 offset:0
ds_read_b64_tr_b16 v[34:35], v28 offset:1024
ds_read_b64_tr_b16 v[36:37], v28 offset:4096
ds_read_b64_tr_b16 v[38:39], v28 offset:5120
ds_read_b64_tr_b16 v[40:41], v29 offset:0
ds_read_b64_tr_b16 v[42:43], v29 offset:1024
ds_read_b64_tr_b16 v[44:45], v29 offset:4096
ds_read_b64_tr_b16 v[46:47], v29 offset:5120
s_waitcnt lgkmcnt(0)
ds_read_b64_tr_b16 v[48:49], v28 offset:16384
ds_read_b64_tr_b16 v[50:51], v28 offset:17408
ds_read_b64_tr_b16 v[52:53], v28 offset:20480
ds_read_b64_tr_b16 v[54:55], v28 offset:21504
ds_read_b64_tr_b16 v[56:57], v29 offset:16384
ds_read_b64_tr_b16 v[58:59], v29 offset:17408
ds_read_b64_tr_b16 v[60:61], v29 offset:20480
ds_read_b64_tr_b16 v[62:63], v29 offset:21504
s_waitcnt lgkmcnt(0)
ds_read_b64_tr_b16 v[64:65], v28 offset:32768
ds_read_b64_tr_b16 v[66:67], v28 offset:33792
ds_read_b64_tr_b16 v[68:69], v28 offset:36864
ds_read_b64_tr_b16 v[70:71], v28 offset:37888
ds_read_b64_tr_b16 v[248:249], v29 offset:32768
ds_read_b64_tr_b16 v[250:251], v29 offset:33792
ds_read_b64_tr_b16 v[252:253], v29 offset:36864
ds_read_b64_tr_b16 v[254:255], v29 offset:37888
s_waitcnt lgkmcnt(0)
s_barrier
s_lshl_b32 s60, s3, 12
s_add_u32 s60, s60, 0
v_add_u32 v28, s60, v1
ds_write_b128 v28, v[32:35] offset:0
ds_write_b128 v28, v[36:39] offset:1024
ds_write_b128 v28, v[40:43] offset:2048
ds_write_b128 v28, v[44:47] offset:3072
ds_write_b128 v28, v[48:51] offset:16384
ds_write_b128 v28, v[52:55] offset:17408
ds_write_b128 v28, v[56:59] offset:18432
ds_write_b128 v28, v[60:63] offset:19456
ds_write_b128 v28, v[64:67] offset:32768
ds_write_b128 v28, v[68:71] offset:33792
ds_write_b128 v28, v[248:251] offset:34816
ds_write_b128 v28, v[252:255] offset:35840
s_waitcnt lgkmcnt(0)
s_barrier
s_waitcnt vmcnt(12)
s_barrier
v_add_u32 v28, 98304, v15
v_add_u32 v29, 98304, v13
ds_read_b64_tr_b16 v[32:33], v28 offset:0
ds_read_b64_tr_b16 v[34:35], v28 offset:1024
ds_read_b64_tr_b16 v[36:37], v28 offset:4096
ds_read_b64_tr_b16 v[38:39], v28 offset:5120
ds_read_b64_tr_b16 v[40:41], v29 offset:0
ds_read_b64_tr_b16 v[42:43], v29 offset:1024
ds_read_b64_tr_b16 v[44:45], v29 offset:4096
ds_read_b64_tr_b16 v[46:47], v29 offset:5120
s_waitcnt lgkmcnt(0)
ds_read_b64_tr_b16 v[48:49], v28 offset:16384
ds_read_b64_tr_b16 v[50:51], v28 offset:17408
ds_read_b64_tr_b16 v[52:53], v28 offset:20480
ds_read_b64_tr_b16 v[54:55], v28 offset:21504
ds_read_b64_tr_b16 v[56:57], v29 offset:16384
ds_read_b64_tr_b16 v[58:59], v29 offset:17408
ds_read_b64_tr_b16 v[60:61], v29 offset:20480
ds_read_b64_tr_b16 v[62:63], v29 offset:21504
s_waitcnt lgkmcnt(0)
ds_read_b64_tr_b16 v[64:65], v28 offset:32768
ds_read_b64_tr_b16 v[66:67], v28 offset:33792
ds_read_b64_tr_b16 v[68:69], v28 offset:36864
ds_read_b64_tr_b16 v[70:71], v28 offset:37888
ds_read_b64_tr_b16 v[248:249], v29 offset:32768
ds_read_b64_tr_b16 v[250:251], v29 offset:33792
ds_read_b64_tr_b16 v[252:253], v29 offset:36864
ds_read_b64_tr_b16 v[254:255], v29 offset:37888
s_waitcnt lgkmcnt(0)
s_barrier
s_lshl_b32 s60, s3, 12
s_add_u32 s60, s60, 98304
v_add_u32 v28, s60, v1
ds_write_b128 v28, v[32:35] offset:0
ds_write_b128 v28, v[36:39] offset:1024
ds_write_b128 v28, v[40:43] offset:2048
ds_write_b128 v28, v[44:47] offset:3072
ds_write_b128 v28, v[48:51] offset:16384
ds_write_b128 v28, v[52:55] offset:17408
ds_write_b128 v28, v[56:59] offset:18432
ds_write_b128 v28, v[60:63] offset:19456
s_lshl_b32 s60, s3, 11
s_add_u32 s60, s60, 131072
v_add_u32 v29, s60, v1
ds_write_b128 v29, v[64:67] offset:0
ds_write_b128 v29, v[68:71] offset:1024
s_waitcnt lgkmcnt(0)
s_barrier
s_lshl_b32 s60, s3, 6
v_add_u32 v24, s60, v0
v_lshlrev_b32 v25, 2, v24
v_add_u32 v25, 139264, v25
ds_write_b32 v25, v16 offset:0
ds_write_b32 v25, v17 offset:1024
ds_write_b32 v25, v18 offset:2048
ds_write_b32 v25, v19 offset:3072
ds_write_b32 v25, v20 offset:4096
ds_write_b32 v25, v21 offset:5120
ds_write_b32 v25, v22 offset:6144
ds_write_b32 v25, v23 offset:7168
ds_write_b32 v25, v14 offset:8192
s_waitcnt lgkmcnt(0)
s_mov_b32 s47, 0
s_cmp_lg_u32 s100, 0
s_cbranch_scc1 quick_281
s_mov_b32 s67, 0
v_mov_b32 v25, s57
cbp_282:
buffer_load_dword v24, v25, s[12:15], 0 offen sc1
s_add_u32 s67, s67, 1
s_cmp_gt_u32 s67, 400000
s_cbranch_scc1 chain_fail_246
s_waitcnt vmcnt(0)
v_readfirstlane_b32 s61, v24
s_nop 0
s_and_b32 s60, s61, 0xffff
s_cmp_lt_u32 s60, 32
s_cbranch_scc1 cbp_282
s_lshr_b32 s47, s61, 16
s_mov_b32 s12, s40
s_and_b32 s13, s41, 0xffff
s_mov_b32 s14, 256
s_mov_b32 s15, 0x20000
v_lshlrev_b32 v24, 2, v0
v_add_u32 v25, 128, v24
v_cmp_le_u32 vcc, 2, v0
s_nop 1
v_cndmask_b32 v24, v24, v25, vcc
v_mov_b32 v25, 192
v_cmp_eq_u32 vcc, 8, v0
s_nop 1
v_cndmask_b32 v24, v24, v25, vcc
v_mov_b32 v25, 2147483632
v_cmp_lt_u32 vcc, 8, v0
s_nop 1
v_cndmask_b32 v24, v24, v25, vcc
s_mov_b32 s98, 0
wi_loop_283:
buffer_load_dword v25, v24, s[12:15], 0 offen sc1
s_add_u32 s98, s98, 1
s_cmp_gt_u32 s98, 150000
s_cbranch_scc1 wi_bad_285
s_waitcnt vmcnt(0)
v_cmp_eq_u32 vcc, 32, v25
s_nop 0
s_and_b32 s97, vcc_lo, 0x1ff
s_cmp_eq_u32 s97, 0x1ff
s_cbranch_scc1 wi_ok_284
v_cmp_lt_u32 vcc, 32, v25
s_nop 0
s_and_b32 s96, vcc_lo, 0xff
s_cselect_b32 s96, 0x100, 0
s_and_b32 s96, s96, s97
s_cbranch_scc1 wi_over_286
s_sleep 8
s_branch wi_loop_283
wi_bad_285:
s_mov_b32 s98, 512
s_branch L_fail
wi_over_286:
s_mov_b32 s100, 255
wi_ok_284:
v_mov_b32 v26, 0
quick_281:
s_waitcnt vmcnt(0)
v_cmp_gt_u32 vcc, 1, v26
s_nop 0
s_and_b32 vcc_lo, vcc_lo, 31
s_cselect_b32 s100, 0, 1
s_mov_b32 s98, 0xff800000
s_mov_b32 s99, 0xff800000
s_cmp_lg_u32 s47, 0
s_cbranch_scc1 chain_foreign_287
s_mov_b32 s62, 0
s_lshl_b32 s65, s3, 11
s_add_u32 s65, s65, 16384
s_mul_i32 s63, s51, 24576
s_add_u32 s63, s63, s53
s_mul_i32 s77, s51, 4096
s_add_u32 s77, s77, s54
s_mov_b32 s59, s77
v_mov_b32 v8, 1
v_mov_b64 v[48:49], 0
v_mov_b64 v[50:51], 0
v_mov_b64 v[52:53], 0
v_mov_b64 v[54:55], 0
v_mov_b64 v[56:57], 0
v_mov_b64 v[58:59], 0
v_mov_b64 v[60:61], 0
v_mov_b64 v[62:63], 0
v_mov_b64 v[64:65], 0
v_mov_b64 v[66:67], 0
v_mov_b64 v[68:69], 0
v_mov_b64 v[70:71], 0
s_lshl_b32 s60, s3, 12
v_add_u32 v15, s60, v1
s_lshl_b32 s60, s3, 11
s_add_u32 s60, s60, 131072
v_add_u32 v14, s60, v1
s_cmp_lg_u32 s3, 3
s_cbranch_scc1 kx0_288
s_cmp_lg_u32 s100, 0
s_cbranch_scc1 kx0_288
s_add_u32 s61, s62, 1
s_mov_b32 s67, 0
sp_loop_289:
buffer_load_dword v32, v7, s[4:7], s58 offen sc1
s_add_u32 s67, s67, 1
s_cmp_gt_u32 s67, 150000
s_cbranch_scc1 sp_bad_291
s_waitcnt vmcnt(0)
v_cmp_gt_u32 vcc, s61, v32
s_nop 0
s_and_b32 vcc_lo, vcc_lo, 31
s_cbranch_scc0 sp_ok_290
s_sleep 1
s_branch sp_loop_289
sp_bad_291:
s_mov_b32 s98, 1792
s_branch L_fail
sp_ok_290:
kx0_288:
s_barrier
chain_loop_292:
ds_read_b64_tr_b16 v[24:25], v2 offset:0
ds_read_b64_tr_b16 v[26:27], v2 offset:512
ds_read_b128 v[32:35], v15 offset:0
ds_read_b128 v[36:39], v15 offset:1024
ds_read_b64_tr_b16 v[28:29], v2 offset:1024
ds_read_b64_tr_b16 v[30:31], v2 offset:1536
s_sub_u32 s60, s65, 8192
s_add_u32 m0, s60, 146432
s_add_u32 s60, s60, s63
buffer_load_dwordx4 v1, s[4:7], s60 offen offset:0 sc1 lds
buffer_load_dwordx4 v1, s[4:7], s60 offen offset:1024 sc1 lds
s_waitcnt lgkmcnt(4)
v_smfmac_f32_16x16x64_bf16 v[48:51], v[24:27], a[0:7], v3
ds_read_b128 v[40:43], v15 offset:2048
v_smfmac_f32_16x16x64_bf16 v[52:55], v[24:27], a[72:79], v3
ds_read_b128 v[44:47], v15 offset:3072
v_smfmac_f32_16x16x64_bf16 v[56:59], v[24:27], a[144:151], v3
ds_read_b128 v[16:19], v15 offset:16384
v_smfmac_f32_16x16x64_bf16 v[60:63], v[24:27], a[216:223], v3
ds_read_b128 v[20:23], v15 offset:17408
s_waitcnt lgkmcnt(6)
v_smfmac_f32_16x16x64_bf16 v[64:67], v[24:27], v[32:39], v3
ds_read_b128 v[32:35], v15 offset:18432
s_waitcnt lgkmcnt(3)
v_smfmac_f32_16x16x64_bf16 v[68:71], v[24:27], v[40:47], v3
ds_read_b128 v[36:39], v15 offset:19456
v_smfmac_f32_16x16x64_bf16 v[48:51], v[28:31], a[8:15], v3
ds_read_b64_tr_b16 v[24:25], v2 offset:2048
v_smfmac_f32_16x16x64_bf16 v[52:55], v[28:31], a[80:87], v3
ds_read_b64_tr_b16 v[26:27], v2 offset:2560
v_smfmac_f32_16x16x64_bf16 v[56:59], v[28:31], a[152:159], v3
ds_read_b128 v[40:43], v15 offset:32768
v_smfmac_f32_16x16x64_bf16 v[60:63], v[28:31], a[224:231], v3
ds_read_b128 v[44:47], v15 offset:33792
s_waitcnt lgkmcnt(6)
v_smfmac_f32_16x16x64_bf16 v[64:67], v[28:31], v[16:23], v3
ds_read_b128 v[16:19], v15 offset:34816
s_waitcnt lgkmcnt(5)
v_smfmac_f32_16x16x64_bf16 v[68:71], v[28:31], v[32:39], v3
ds_read_b128 v[20:23], v15 offset:35840
s_waitcnt lgkmcnt(4)
v_smfmac_f32_16x16x64_bf16 v[48:51], v[24:27], a[16:23], v3
ds_read_b64_tr_b16 v[28:29], v2 offset:3072
v_smfmac_f32_16x16x64_bf16 v[52:55], v[24:27], a[88:95], v3
ds_read_b64_tr_b16 v[30:31], v2 offset:3584
v_smfmac_f32_16x16x64_bf16 v[56:59], v[24:27], a[160:167], v3
ds_read_b128 v[32:35], v15 offset:49152
v_smfmac_f32_16x16x64_bf16 v[60:63], v[24:27], a[232:239], v3
ds_read_b128 v[36:39], v15 offset:50176
s_waitcnt lgkmcnt(6)
v_smfmac_f32_16x16x64_bf16 v[64:67], v[24:27], v[40:47], v3
ds_read_b128 v[40:43], v15 offset:51200
s_waitcnt lgkmcnt(5)
v_smfmac_f32_16x16x64_bf16 v[68:71], v[24:27], v[16:23], v3
ds_read_b128 v[44:47], v15 offset:52224
s_waitcnt lgkmcnt(4)
v_smfmac_f32_16x16x64_bf16 v[48:51], v[28:31], a[24:31], v3
ds_read_b64_tr_b16 v[24:25], v2 offset:4096
v_smfmac_f32_16x16x64_bf16 v[52:55], v[28:31], a[96:103], v3
ds_read_b64_tr_b16 v[26:27], v2 offset:4608
v_smfmac_f32_16x16x64_bf16 v[56:59], v[28:31], a[168:175], v3
v_add_u32 v15, 65536, v15
ds_read_b128 v[16:19], v15 offset:0
v_smfmac_f32_16x16x64_bf16 v[60:63], v[28:31], a[240:247], v3
ds_read_b128 v[20:23], v15 offset:1024
s_waitcnt lgkmcnt(6)
v_smfmac_f32_16x16x64_bf16 v[64:67], v[28:31], v[32:39], v3
ds_read_b128 v[32:35], v15 offset:2048
s_waitcnt lgkmcnt(5)
v_smfmac_f32_16x16x64_bf16 v[68:71], v[28:31], v[40:47], v3
ds_read_b128 v[36:39], v15 offset:3072
s_waitcnt lgkmcnt(4)
v_smfmac_f32_16x16x64_bf16 v[48:51], v[24:27], a[32:39], v3
ds_read_b64_tr_b16 v[28:29], v2 offset:5120
v_smfmac_f32_16x16x64_bf16 v[52:55], v[24:27], a[104:111], v3
ds_read_b64_tr_b16 v[30:31], v2 offset:5632
v_smfmac_f32_16x16x64_bf16 v[56:59], v[24:27], a[176:183], v3
ds_read_b128 v[40:43], v15 offset:16384
v_smfmac_f32_16x16x64_bf16 v[60:63], v[24:27], a[248:255], v3
ds_read_b128 v[44:47], v15 offset:17408
s_waitcnt lgkmcnt(6)
v_smfmac_f32_16x16x64_bf16 v[64:67], v[24:27], v[16:23], v3
ds_read_b128 v[16:19], v15 offset:18432
s_waitcnt lgkmcnt(5)
v_smfmac_f32_16x16x64_bf16 v[68:71], v[24:27], v[32:39], v3
ds_read_b128 v[20:23], v15 offset:19456
s_waitcnt lgkmcnt(4)
v_smfmac_f32_16x16x64_bf16 v[48:51], v[28:31], a[40:47], v3
ds_read_b64_tr_b16 v[24:25], v2 offset:6144
v_smfmac_f32_16x16x64_bf16 v[52:55], v[28:31], a[112:119], v3
ds_read_b64_tr_b16 v[26:27], v2 offset:6656
v_smfmac_f32_16x16x64_bf16 v[56:59], v[28:31], a[184:191], v3
ds_read_b128 v[32:35], v15 offset:32768
v_smfmac_f32_16x16x64_bf16 v[60:63], v[28:31], v[72:79], v3
ds_read_b128 v[36:39], v15 offset:33792
s_waitcnt lgkmcnt(6)
v_smfmac_f32_16x16x64_bf16 v[64:67], v[28:31], v[40:47], v3
ds_read_b128 v[40:43], v15 offset:34816
s_waitcnt lgkmcnt(5)
v_smfmac_f32_16x16x64_bf16 v[68:71], v[28:31], v[16:23], v3
ds_read_b128 v[44:47], v15 offset:35840
s_waitcnt lgkmcnt(4)
v_smfmac_f32_16x16x64_bf16 v[48:51], v[24:27], a[48:55], v3
ds_read_b64_tr_b16 v[28:29], v2 offset:7168
v_smfmac_f32_16x16x64_bf16 v[52:55], v[24:27], a[120:127], v3
ds_read_b64_tr_b16 v[30:31], v2 offset:7680
v_smfmac_f32_16x16x64_bf16 v[56:59], v[24:27], a[192:199], v3
ds_read_b128 v[16:19], v15 offset:49152
v_smfmac_f32_16x16x64_bf16 v[60:63], v[24:27], v[80:87], v3
ds_read_b128 v[20:23], v15 offset:50176
s_waitcnt lgkmcnt(6)
v_smfmac_f32_16x16x64_bf16 v[64:67], v[24:27], v[32:39], v3
ds_read_b128 v[32:35], v15 offset:51200
s_waitcnt lgkmcnt(5)
v_smfmac_f32_16x16x64_bf16 v[68:71], v[24:27], v[40:47], v3
ds_read_b128 v[36:39], v15 offset:52224
s_waitcnt lgkmcnt(4)
v_smfmac_f32_16x16x64_bf16 v[48:51], v[28:31], a[56:63], v3
ds_read_b64_tr_b16 v[24:25], v2 offset:8192
v_smfmac_f32_16x16x64_bf16 v[52:55], v[28:31], a[128:135], v3
ds_read_b64_tr_b16 v[26:27], v2 offset:8704
v_smfmac_f32_16x16x64_bf16 v[56:59], v[28:31], a[200:207], v3
ds_read_b128 v[40:43], v14 offset:0
v_smfmac_f32_16x16x64_bf16 v[60:63], v[28:31], v[88:95], v3
ds_read_b128 v[44:47], v14 offset:1024
v_add_u32 v15, 152576, v1
s_waitcnt lgkmcnt(2)
v_smfmac_f32_16x16x64_bf16 v[48:51], v[24:27], a[64:71], v3
v_smfmac_f32_16x16x64_bf16 v[52:55], v[24:27], a[136:143], v3
v_smfmac_f32_16x16x64_bf16 v[56:59], v[24:27], a[208:215], v3
v_smfmac_f32_16x16x64_bf16 v[60:63], v[24:27], v[96:103], v3
s_add_u32 s61, s63, s65
v_smfmac_f32_16x16x64_bf16 v[64:67], v[28:31], v[16:23], v3
v_smfmac_f32_16x16x64_bf16 v[68:71], v[28:31], v[32:39], v3
s_nop 1
v_add_f32 v48, v48, v49
v_add_f32 v50, v50, v51
v_cvt_pk_bf16_f32 v49, v48, v50
s_waitcnt lgkmcnt(0)
v_smfmac_f32_16x16x64_bf16 v[64:67], v[24:27], v[40:47], v3
v_add_f32 v52, v52, v53
v_add_f32 v54, v54, v55
v_cvt_pk_bf16_f32 v53, v52, v54
v_smfmac_f32_16x16x64_bf16 v[68:71], v[24:27], v[248:255], v3
v_add_f32 v56, v56, v57
v_add_f32 v58, v58, v59
v_cvt_pk_bf16_f32 v48, v56, v58
ds_write_b64 v4, v[48:49] offset:0
v_add_f32 v60, v60, v61
v_add_f32 v62, v62, v63
v_cvt_pk_bf16_f32 v52, v60, v62
ds_write_b64 v4, v[52:53] offset:512
buffer_load_dwordx4 v[16:19], v1, s[4:7], s61 offen sc1
buffer_load_dwordx4 v[20:23], v1, s[4:7], s61 offen offset:1024 sc1
v_add_f32 v64, v64, v65
v_add_f32 v66, v66, v67
v_cvt_pk_bf16_f32 v28, v64, v66
v_add_f32 v68, v68, v69
v_add_f32 v70, v70, v71
v_cvt_pk_bf16_f32 v29, v68, v70
s_waitcnt vmcnt(2) lgkmcnt(0)
s_barrier
ds_read_b64_tr_b16 v[48:49], v5 offset:0
ds_read_b64_tr_b16 v[50:51], v5 offset:256
ds_read_b128 v[32:35], v15 offset:2048
ds_read_b128 v[36:39], v15 offset:3072
ds_read_b64_tr_b16 v[52:53], v5 offset:1024
ds_read_b64_tr_b16 v[54:55], v5 offset:1280
ds_read_b128 v[40:43], v15 offset:4096
ds_read_b128 v[44:47], v15 offset:5120
ds_read_b64_tr_b16 v[64:65], v5 offset:2048
ds_read_b64_tr_b16 v[66:67], v5 offset:2304
ds_read_b64_tr_b16 v[68:69], v5 offset:3072
ds_read_b64_tr_b16 v[70:71], v5 offset:3328
s_add_u32 s60, s77, s78
v_and_or_b32 v28, v28, s70, v8
buffer_store_dwordx2 v[28:29], v2, s[4:7], s60 offen sc1
v_mov_b64 v[24:25], 0
v_mov_b64 v[26:27], s[98:99]
s_waitcnt lgkmcnt(10)
s_nop 0
v_mfma_f32_16x16x32_bf16 v[24:27], v[48:51], v[48:51], v[24:27]
s_waitcnt lgkmcnt(8)
v_mfma_f32_16x16x32_bf16 v[56:59], v[32:35], v[48:51], 0
v_mfma_f32_16x16x32_bf16 v[60:63], v[36:39], v[48:51], 0
ds_read_b128 v[32:35], v15 offset:6144
ds_read_b128 v[36:39], v15 offset:7168
s_waitcnt lgkmcnt(8)
v_mfma_f32_16x16x32_bf16 v[24:27], v[52:55], v[52:55], v[24:27]
s_waitcnt lgkmcnt(6)
v_mfma_f32_16x16x32_bf16 v[56:59], v[40:43], v[52:55], v[56:59]
v_mfma_f32_16x16x32_bf16 v[60:63], v[44:47], v[52:55], v[60:63]
ds_read_b128 v[40:43], v15 offset:8192
ds_read_b128 v[44:47], v15 offset:9216
s_waitcnt lgkmcnt(6)
v_mfma_f32_16x16x32_bf16 v[24:27], v[64:67], v[64:67], v[24:27]
s_waitcnt lgkmcnt(2)
v_mfma_f32_16x16x32_bf16 v[56:59], v[32:35], v[64:67], v[56:59]
v_mfma_f32_16x16x32_bf16 v[60:63], v[36:39], v[64:67], v[60:63]
v_mfma_f32_16x16x32_bf16 v[24:27], v[68:71], v[68:71], v[24:27]
s_waitcnt lgkmcnt(0)
v_mfma_f32_16x16x32_bf16 v[56:59], v[40:43], v[68:71], v[56:59]
v_mfma_f32_16x16x32_bf16 v[60:63], v[44:47], v[68:71], v[60:63]
s_set_gpr_idx_on s72, gpr_idx(SRC0)
v_mov_b32 v32, v48
v_mov_b32 v33, v49
v_mov_b32 v34, v50
v_mov_b32 v35, v51
s_set_gpr_idx_off
v_and_or_b32 v32, v32, s70, v8
buffer_store_dwordx4 v[32:35], v12, s[4:7], s77 offen sc1
v_mov_b32 v36, 0x3f803f80
v_mov_b32 v37, 0x3f803f80
v_mov_b32 v45, 0
v_mov_b32 v46, 0
v_mov_b64 v[38:39], v[36:37]
v_max3_f32 v30, v24, v25, v56
v_max3_f32 v30, v30, v57, v58
v_max3_f32 v30, v30, v59, v60
v_max3_f32 v30, v30, v61, v62
v_max_f32 v30, v30, v63
v_mov_b32 v31, v30
s_add_u32 s63, s63, 786432
s_add_u32 s62, s62, 1
v_permlane16_swap_b32 v31, v30
v_max_f32 v30, v30, v31
v_mov_b32 v31, v30
s_and_b32 s64, s62, 1
s_nop 0
v_permlane32_swap_b32 v31, v30
v_max_f32 v30, v30, v31
v_mul_f32 v30, s66, v30
v_pk_fma_f32 v[24:25], v[24:25], s[66:67], v[30:31] op_sel_hi:[1,0,0] neg_lo:[0,0,1] neg_hi:[0,0,1]
v_pk_fma_f32 v[56:57], v[56:57], s[66:67], v[30:31] op_sel_hi:[1,0,0] neg_lo:[0,0,1] neg_hi:[0,0,1]
v_pk_fma_f32 v[58:59], v[58:59], s[66:67], v[30:31] op_sel_hi:[1,0,0] neg_lo:[0,0,1] neg_hi:[0,0,1]
v_pk_fma_f32 v[60:61], v[60:61], s[66:67], v[30:31] op_sel_hi:[1,0,0] neg_lo:[0,0,1] neg_hi:[0,0,1]
v_pk_fma_f32 v[62:63], v[62:63], s[66:67], v[30:31] op_sel_hi:[1,0,0] neg_lo:[0,0,1] neg_hi:[0,0,1]
v_exp_f32 v24, v24
v_exp_f32 v25, v25
v_exp_f32 v56, v56
v_exp_f32 v57, v57
v_cvt_pk_bf16_f32 v44, v24, v25
v_cvt_pk_bf16_f32 v47, v24, v25
v_exp_f32 v58, v58
v_exp_f32 v59, v59
v_mfma_f32_16x16x16_bf16 v[48:51], v[36:37], v[44:45], 0
v_exp_f32 v60, v60
v_mfma_f32_16x16x16_bf16 v[68:71], v[28:29], v[46:47], 0
v_exp_f32 v61, v61
v_mfma_f32_16x16x16_bf16 v[64:67], v[28:29], v[44:45], 0
v_exp_f32 v62, v62
v_exp_f32 v63, v63
v_cvt_pk_bf16_f32 v40, v56, v57
v_cvt_pk_bf16_f32 v41, v58, v59
v_cvt_pk_bf16_f32 v42, v60, v61
v_cvt_pk_bf16_f32 v43, v62, v63
s_waitcnt vmcnt(2)
s_nop 0
v_mfma_f32_16x16x32_bf16 v[48:51], v[36:39], v[40:43], v[48:51]
v_mfma_f32_16x16x32_bf16 v[68:71], v[20:23], v[40:43], v[68:71]
v_mfma_f32_16x16x32_bf16 v[64:67], v[16:19], v[40:43], v[64:67]
s_cmp_eq_u32 s62, 64
s_cbranch_scc1 chain_done_247
v_mov_b32 v13, s64
v_mov_b64 v[24:25], 0
v_mov_b64 v[26:27], 0
v_mov_b64 v[56:57], 0
v_mov_b64 v[58:59], 0
v_mov_b64 v[60:61], 0
v_mov_b64 v[62:63], 0
v_rcp_f32 v52, v48
s_nop 0
v_pk_mul_f32 v[68:69], v[68:69], v[52:53] op_sel_hi:[1,0]
v_pk_mul_f32 v[70:71], v[70:71], v[52:53] op_sel_hi:[1,0]
s_nop 0
v_cvt_pk_bf16_f32 v50, v68, v70
v_cvt_pk_bf16_f32 v51, v69, v71
v_pk_mul_f32 v[64:65], v[64:65], v[52:53] op_sel_hi:[1,0]
v_pk_mul_f32 v[66:67], v[66:67], v[52:53] op_sel_hi:[1,0]
ds_write2_b32 v6, v50, v51 offset0:64 offset1:68
v_cvt_pk_bf16_f32 v48, v64, v66
v_cvt_pk_bf16_f32 v49, v65, v67
ds_write2_b32 v6, v48, v49 offset1:4
v_mov_b64 v[32:33], 0
v_mov_b64 v[34:35], 0
v_mov_b64 v[36:37], 0
v_mov_b64 v[38:39], 0
v_mov_b64 v[40:41], 0
v_mov_b64 v[42:43], 0
v_mov_b64 v[44:45], 0
v_mov_b64 v[46:47], 0
v_add_u32 v20, 152576, v1
s_waitcnt lgkmcnt(0)
s_barrier
ds_read_b128 v[48:51], v20 offset:0
ds_read_b128 v[52:55], v20 offset:1024
v_mov_b64 v[64:65], 0
v_mov_b64 v[66:67], 0
v_mov_b64 v[68:69], 0
v_mov_b64 v[70:71], 0
s_mov_b64 exec, 31
buffer_load_dword v23, v7, s[4:7], s58 offen sc1
s_mov_b64 exec, -1
s_add_u32 s45, s74, 32768
s_waitcnt lgkmcnt(0)
v_smfmac_f32_16x16x64_bf16 v[24:27], v[48:51], v[232:239], v3
v_smfmac_f32_16x16x64_bf16 v[24:27], v[52:55], v[240:247], v3
v_smfmac_f32_16x16x64_bf16 v[32:35], v[48:51], v[104:111], v3
v_smfmac_f32_16x16x64_bf16 v[36:39], v[48:51], v[120:127], v3
v_smfmac_f32_16x16x64_bf16 v[40:43], v[48:51], v[136:143], v3
v_smfmac_f32_16x16x64_bf16 v[44:47], v[48:51], v[152:159], v3
v_smfmac_f32_16x16x64_bf16 v[32:35], v[52:55], v[112:119], v3
s_nop 2
v_add_f32 v24, v24, v25
v_add_f32 v26, v26, v27
v_smfmac_f32_16x16x64_bf16 v[36:39], v[52:55], v[128:135], v3
v_cvt_pk_bf16_f32 v24, v24, v26
v_smfmac_f32_16x16x64_bf16 v[40:43], v[52:55], v[144:151], v3
s_nop 0
v_permlane32_swap_b32 v24, v26
v_smfmac_f32_16x16x64_bf16 v[44:47], v[52:55], v[160:167], v3
s_nop 0
v_permlane16_swap_b32 v24, v25
v_permlane16_swap_b32 v26, v27
v_smfmac_f32_16x16x64_bf16 v[56:59], v[48:51], v[168:175], v3
v_and_or_b32 v24, v24, s70, v13
v_smfmac_f32_16x16x64_bf16 v[60:63], v[48:51], v[184:191], v3
s_mov_b64 exec, 0xffff
buffer_store_dwordx4 v[24:27], v9, s[4:7], s49 offen
s_mov_b64 exec, -1
v_smfmac_f32_16x16x64_bf16 v[64:67], v[48:51], v[200:207], v3
v_add_f32 v32, v32, v33
v_add_f32 v34, v34, v35
v_cvt_pk_bf16_f32 v28, v32, v34
v_smfmac_f32_16x16x64_bf16 v[68:71], v[48:51], v[216:223], v3
v_add_f32 v36, v36, v37
v_add_f32 v38, v38, v39
v_smfmac_f32_16x16x64_bf16 v[56:59], v[52:55], v[176:183], v3
v_cvt_pk_bf16_f32 v29, v36, v38
v_add_f32 v40, v40, v41
v_smfmac_f32_16x16x64_bf16 v[60:63], v[52:55], v[192:199], v3
v_add_f32 v42, v42, v43
v_cvt_pk_bf16_f32 v30, v40, v42
v_add_f32 v44, v44, v45
v_smfmac_f32_16x16x64_bf16 v[64:67], v[52:55], v[208:215], v3
v_add_f32 v46, v46, v47
v_cvt_pk_bf16_f32 v31, v44, v46
v_smfmac_f32_16x16x64_bf16 v[68:71], v[52:55], v[224:231], v3
v_and_or_b32 v28, v28, s70, v13
buffer_store_dwordx4 v[28:31], v9, s[4:7], s74 offen
v_add_f32 v56, v56, v57
v_add_f32 v58, v58, v59
v_cvt_pk_bf16_f32 v32, v56, v58
v_add_f32 v60, v60, v61
v_add_f32 v62, v62, v63
v_cvt_pk_bf16_f32 v33, v60, v62
v_add_f32 v64, v64, v65
v_add_f32 v66, v66, v67
v_cvt_pk_bf16_f32 v34, v64, v66
v_add_f32 v68, v68, v69
v_add_f32 v70, v70, v71
v_cvt_pk_bf16_f32 v35, v68, v70
v_and_or_b32 v32, v32, s70, v13
buffer_store_dwordx4 v[32:35], v9, s[4:7], s45 offen
s_and_b32 s60, s62, 7
s_mul_i32 s60, s60, 131072
s_add_u32 s77, s59, s60
s_bfe_u32 s60, s62, 0x10003
s_xor_b32 s60, s60, 1
v_mov_b32 v8, s60
v_mov_b64 v[64:65], 0
v_mov_b64 v[66:67], 0
v_mov_b64 v[68:69], 0
v_mov_b64 v[70:71], 0
s_lshl_b32 s60, s3, 12
v_add_u32 v15, s60, v1
s_cmp_lg_u32 s48, 0
s_cbranch_scc1 own_296
s_lshl_b32 s45, s3, 11
s_add_u32 s45, s45, s79
s_lshl_b32 s46, s3, 8
s_add_u32 s46, s46, 8192
s_add_u32 s46, s46, s79
v_and_b32 v20, 0xf0, v1
v_add_u32 v21, s68, v20
s_branch noown_293
own_296:
s_sleep 3
s_mov_b32 s67, 0
buffer_load_dwordx4 v[32:35], v1, s[4:7], s75 offen offset:0 sc1
buffer_load_dwordx4 v[36:39], v1, s[4:7], s75 offen offset:1024 sc1
buffer_load_dwordx4 v[40:43], v1, s[4:7], s75 offen offset:2048 sc1
buffer_load_dwordx4 v[44:47], v1, s[4:7], s75 offen offset:3072 sc1
v_and_b32 v20, 15, v0
v_and_b32 v21, 1, v0
v_lshlrev_b32 v21, 4, v21
v_mov_b32 v22, 0x3f80
v_lshlrev_b32 v21, v21, v22
v_lshrrev_b32 v22, 1, v20
v_cmp_eq_u32 vcc, 0, v22
s_nop 1
v_cndmask_b32 v16, 0, v21, vcc
v_cmp_eq_u32 vcc, 1, v22
s_nop 1
v_cndmask_b32 v17, 0, v21, vcc
v_cmp_eq_u32 vcc, 2, v22
s_nop 1
v_cndmask_b32 v18, 0, v21, vcc
v_cmp_eq_u32 vcc, 3, v22
s_nop 1
v_cndmask_b32 v19, 0, v21, vcc
s_lshl_b32 s45, s3, 11
s_add_u32 s45, s45, s79
s_lshl_b32 s46, s3, 8
s_add_u32 s46, s46, 8192
s_add_u32 s46, s46, s79
v_and_b32 v20, 0xf0, v1
v_add_u32 v21, s68, v20
h1_297:
buffer_load_dwordx4 v[48:51], v1, s[4:7], s75 offen offset:0 sc1
buffer_load_dwordx4 v[52:55], v1, s[4:7], s75 offen offset:1024 sc1
buffer_load_dwordx4 v[56:59], v1, s[4:7], s75 offen offset:2048 sc1
buffer_load_dwordx4 v[60:63], v1, s[4:7], s75 offen offset:3072 sc1
s_waitcnt vmcnt(7)
v_mfma_f32_16x16x32_bf16 v[24:27], v[32:35], v[16:19], 0
v_xor_b32 v28, v32, v13
s_waitcnt vmcnt(6)
v_mfma_f32_16x16x32_bf16 v[24:27], v[36:39], v[16:19], v[24:27]
v_bitop3_b32 v28, v28, v36, v13 bitop3:0xf6
s_waitcnt vmcnt(5)
v_mfma_f32_16x16x32_bf16 v[24:27], v[40:43], v[16:19], v[24:27]
v_bitop3_b32 v28, v28, v40, v13 bitop3:0xf6
s_waitcnt vmcnt(4)
v_mfma_f32_16x16x32_bf16 v[24:27], v[44:47], v[16:19], v[24:27]
v_bitop3_b32 v28, v28, v44, v13 bitop3:0xf6
v_and_b32 v28, 1, v28
v_cmp_ne_u32 vcc, 0, v28
s_nop 0
s_cbranch_vccz h1ok_298
s_add_u32 s67, s67, 1
s_cmp_gt_u32 s67, 400000
s_cbranch_scc1 chain_fail_246
buffer_load_dwordx4 v[32:35], v1, s[4:7], s75 offen offset:0 sc1
buffer_load_dwordx4 v[36:39], v1, s[4:7], s75 offen offset:1024 sc1
buffer_load_dwordx4 v[40:43], v1, s[4:7], s75 offen offset:2048 sc1
buffer_load_dwordx4 v[44:47], v1, s[4:7], s75 offen offset:3072 sc1
s_waitcnt vmcnt(7)
v_mfma_f32_16x16x32_bf16 v[24:27], v[48:51], v[16:19], 0
v_xor_b32 v28, v48, v13
s_waitcnt vmcnt(6)
v_mfma_f32_16x16x32_bf16 v[24:27], v[52:55], v[16:19], v[24:27]
v_bitop3_b32 v28, v28, v52, v13 bitop3:0xf6
s_waitcnt vmcnt(5)
v_mfma_f32_16x16x32_bf16 v[24:27], v[56:59], v[16:19], v[24:27]
v_bitop3_b32 v28, v28, v56, v13 bitop3:0xf6
s_waitcnt vmcnt(4)
v_mfma_f32_16x16x32_bf16 v[24:27], v[60:63], v[16:19], v[24:27]
v_bitop3_b32 v28, v28, v60, v13 bitop3:0xf6
v_and_b32 v28, 1, v28
v_cmp_ne_u32 vcc, 0, v28
s_nop 0
s_cbranch_vccnz h1_297
h1ok_298:
s_add_u32 s60, s79, s76
s_nop 1
v_permlane32_swap_b32 v24, v26
v_permlane32_swap_b32 v25, v27
v_add_f32 v24, v24, v26
v_add_f32 v25, v25, v27
v_cvt_pk_bf16_f32 v30, v24, v25
v_min_u32 v30, s70, v30
buffer_store_dword v30, v10, s[4:7], s60 offen
v_mov_b32 v29, -1
s_add_u32 s60, s73, s76
buffer_store_dword v29, v10, s[4:7], s60 offen
noown_293:
s_waitcnt vmcnt(2)
v_mov_b64 v[48:49], 0
v_mov_b64 v[50:51], 0
v_mov_b64 v[52:53], 0
v_mov_b64 v[54:55], 0
v_mov_b64 v[56:57], 0
v_mov_b64 v[58:59], 0
v_mov_b64 v[60:61], 0
v_mov_b64 v[62:63], 0
s_barrier
s_sleep 1
s_mov_b32 s67, 0
h2_299:
buffer_load_dwordx4 v[24:27], v1, s[4:7], s45 offen offset:0 sc1
buffer_load_dwordx4 v[28:31], v1, s[4:7], s45 offen offset:1024 sc1
buffer_load_dwordx4 v[32:35], v20, s[4:7], s46 offen sc1
s_add_u32 s67, s67, 1
s_cmp_gt_u32 s67, 400000
s_cbranch_scc1 chain_fail_246
s_waitcnt vmcnt(2)
ds_write2_b64 v11, v[24:25], v[26:27] offset1:32
v_max3_u32 v16, v24, v25, v26
v_max3_u32 v16, v16, v26, v27
s_waitcnt vmcnt(1)
ds_write2_b64 v11, v[28:29], v[30:31] offset0:128 offset1:160
v_max3_u32 v16, v28, v29, v16
v_max3_u32 v16, v16, v30, v31
s_waitcnt vmcnt(0)
ds_write_b128 v21, v[32:35]
v_max3_u32 v16, v32, v33, v16
v_max3_u32 v16, v16, v34, v35
v_cmp_eq_u32 vcc, -1, v16
s_nop 0
s_cbranch_vccnz h2_299
s_cmp_eq_u32 s3, 3
s_cbranch_scc1 io_294
io_end_295:
s_mov_b32 s60, s79
s_mov_b32 s79, s71
s_mov_b32 s71, s73
s_mov_b32 s73, s60
s_waitcnt lgkmcnt(0)
s_barrier
s_branch chain_loop_292
io_294:
s_sub_u32 s62, s62, 1
s_add_u32 s62, s62, 1
s_add_u32 s61, s62, 1
v_cmp_gt_u32 vcc, s61, v23
s_nop 0
s_and_b32 vcc_lo, vcc_lo, 31
s_cbranch_scc0 io_end_295
s_add_u32 s61, s62, 1
s_mov_b32 s67, 0
sp_loop_300:
buffer_load_dword v32, v7, s[4:7], s58 offen sc1
s_add_u32 s67, s67, 1
s_cmp_gt_u32 s67, 150000
s_cbranch_scc1 sp_bad_302
s_waitcnt vmcnt(0)
v_cmp_gt_u32 vcc, s61, v32
s_nop 0
s_and_b32 vcc_lo, vcc_lo, 31
s_cbranch_scc0 sp_ok_301
s_sleep 1
s_branch sp_loop_300
sp_bad_302:
s_mov_b32 s98, 1792
s_branch L_fail
sp_ok_301:
s_branch io_end_295
chain_foreign_287:
s_mov_b32 s62, 0
s_lshl_b32 s65, s3, 11
s_add_u32 s65, s65, 16384
s_mul_i32 s63, s51, 24576
s_add_u32 s63, s63, s53
s_mul_i32 s77, s51, 4096
s_add_u32 s77, s77, s54
s_mov_b32 s59, s77
v_mov_b32 v8, 1
v_mov_b64 v[48:49], 0
v_mov_b64 v[50:51], 0
v_mov_b64 v[52:53], 0
v_mov_b64 v[54:55], 0
v_mov_b64 v[56:57], 0
v_mov_b64 v[58:59], 0
v_mov_b64 v[60:61], 0
v_mov_b64 v[62:63], 0
v_mov_b64 v[64:65], 0
v_mov_b64 v[66:67], 0
v_mov_b64 v[68:69], 0
v_mov_b64 v[70:71], 0
s_lshl_b32 s60, s3, 12
v_add_u32 v15, s60, v1
s_lshl_b32 s60, s3, 11
s_add_u32 s60, s60, 131072
v_add_u32 v14, s60, v1
s_cmp_lg_u32 s3, 3
s_cbranch_scc1 kx0_303
s_cmp_lg_u32 s100, 0
s_cbranch_scc1 kx0_303
s_add_u32 s61, s62, 1
s_mov_b32 s67, 0
sp_loop_304:
buffer_load_dword v32, v7, s[4:7], s58 offen sc1
s_add_u32 s67, s67, 1
s_cmp_gt_u32 s67, 150000
s_cbranch_scc1 sp_bad_306
s_waitcnt vmcnt(0)
v_cmp_gt_u32 vcc, s61, v32
s_nop 0
s_and_b32 vcc_lo, vcc_lo, 31
s_cbranch_scc0 sp_ok_305
s_sleep 1
s_branch sp_loop_304
sp_bad_306:
s_mov_b32 s98, 1792
s_branch L_fail
sp_ok_305:
kx0_303:
s_barrier
chain_loop_307:
ds_read_b64_tr_b16 v[24:25], v2 offset:0
ds_read_b64_tr_b16 v[26:27], v2 offset:512
ds_read_b128 v[32:35], v15 offset:0
ds_read_b128 v[36:39], v15 offset:1024
ds_read_b64_tr_b16 v[28:29], v2 offset:1024
ds_read_b64_tr_b16 v[30:31], v2 offset:1536
s_sub_u32 s60, s65, 8192
s_add_u32 m0, s60, 146432
s_add_u32 s60, s60, s63
buffer_load_dwordx4 v1, s[4:7], s60 offen offset:0 sc1 lds
buffer_load_dwordx4 v1, s[4:7], s60 offen offset:1024 sc1 lds
s_waitcnt lgkmcnt(4)
v_smfmac_f32_16x16x64_bf16 v[48:51], v[24:27], a[0:7], v3
ds_read_b128 v[40:43], v15 offset:2048
v_smfmac_f32_16x16x64_bf16 v[52:55], v[24:27], a[72:79], v3
ds_read_b128 v[44:47], v15 offset:3072
v_smfmac_f32_16x16x64_bf16 v[56:59], v[24:27], a[144:151], v3
ds_read_b128 v[16:19], v15 offset:16384
v_smfmac_f32_16x16x64_bf16 v[60:63], v[24:27], a[216:223], v3
ds_read_b128 v[20:23], v15 offset:17408
s_waitcnt lgkmcnt(6)
v_smfmac_f32_16x16x64_bf16 v[64:67], v[24:27], v[32:39], v3
ds_read_b128 v[32:35], v15 offset:18432
s_waitcnt lgkmcnt(3)
v_smfmac_f32_16x16x64_bf16 v[68:71], v[24:27], v[40:47], v3
ds_read_b128 v[36:39], v15 offset:19456
v_smfmac_f32_16x16x64_bf16 v[48:51], v[28:31], a[8:15], v3
ds_read_b64_tr_b16 v[24:25], v2 offset:2048
v_smfmac_f32_16x16x64_bf16 v[52:55], v[28:31], a[80:87], v3
ds_read_b64_tr_b16 v[26:27], v2 offset:2560
v_smfmac_f32_16x16x64_bf16 v[56:59], v[28:31], a[152:159], v3
ds_read_b128 v[40:43], v15 offset:32768
v_smfmac_f32_16x16x64_bf16 v[60:63], v[28:31], a[224:231], v3
ds_read_b128 v[44:47], v15 offset:33792
s_waitcnt lgkmcnt(6)
v_smfmac_f32_16x16x64_bf16 v[64:67], v[28:31], v[16:23], v3
ds_read_b128 v[16:19], v15 offset:34816
s_waitcnt lgkmcnt(5)
v_smfmac_f32_16x16x64_bf16 v[68:71], v[28:31], v[32:39], v3
ds_read_b128 v[20:23], v15 offset:35840
s_waitcnt lgkmcnt(4)
v_smfmac_f32_16x16x64_bf16 v[48:51], v[24:27], a[16:23], v3
ds_read_b64_tr_b16 v[28:29], v2 offset:3072
v_smfmac_f32_16x16x64_bf16 v[52:55], v[24:27], a[88:95], v3
ds_read_b64_tr_b16 v[30:31], v2 offset:3584
v_smfmac_f32_16x16x64_bf16 v[56:59], v[24:27], a[160:167], v3
ds_read_b128 v[32:35], v15 offset:49152
v_smfmac_f32_16x16x64_bf16 v[60:63], v[24:27], a[232:239], v3
ds_read_b128 v[36:39], v15 offset:50176
s_waitcnt lgkmcnt(6)
v_smfmac_f32_16x16x64_bf16 v[64:67], v[24:27], v[40:47], v3
ds_read_b128 v[40:43], v15 offset:51200
s_waitcnt lgkmcnt(5)
v_smfmac_f32_16x16x64_bf16 v[68:71], v[24:27], v[16:23], v3
ds_read_b128 v[44:47], v15 offset:52224
s_waitcnt lgkmcnt(4)
v_smfmac_f32_16x16x64_bf16 v[48:51], v[28:31], a[24:31], v3
ds_read_b64_tr_b16 v[24:25], v2 offset:4096
v_smfmac_f32_16x16x64_bf16 v[52:55], v[28:31], a[96:103], v3
ds_read_b64_tr_b16 v[26:27], v2 offset:4608
v_smfmac_f32_16x16x64_bf16 v[56:59], v[28:31], a[168:175], v3
v_add_u32 v15, 65536, v15
ds_read_b128 v[16:19], v15 offset:0
v_smfmac_f32_16x16x64_bf16 v[60:63], v[28:31], a[240:247], v3
ds_read_b128 v[20:23], v15 offset:1024
s_waitcnt lgkmcnt(6)
v_smfmac_f32_16x16x64_bf16 v[64:67], v[28:31], v[32:39], v3
ds_read_b128 v[32:35], v15 offset:2048
s_waitcnt lgkmcnt(5)
v_smfmac_f32_16x16x64_bf16 v[68:71], v[28:31], v[40:47], v3
ds_read_b128 v[36:39], v15 offset:3072
s_waitcnt lgkmcnt(4)
v_smfmac_f32_16x16x64_bf16 v[48:51], v[24:27], a[32:39], v3
ds_read_b64_tr_b16 v[28:29], v2 offset:5120
v_smfmac_f32_16x16x64_bf16 v[52:55], v[24:27], a[104:111], v3
ds_read_b64_tr_b16 v[30:31], v2 offset:5632
v_smfmac_f32_16x16x64_bf16 v[56:59], v[24:27], a[176:183], v3
ds_read_b128 v[40:43], v15 offset:16384
v_smfmac_f32_16x16x64_bf16 v[60:63], v[24:27], a[248:255], v3
ds_read_b128 v[44:47], v15 offset:17408
s_waitcnt lgkmcnt(6)
v_smfmac_f32_16x16x64_bf16 v[64:67], v[24:27], v[16:23], v3
ds_read_b128 v[16:19], v15 offset:18432
s_waitcnt lgkmcnt(5)
v_smfmac_f32_16x16x64_bf16 v[68:71], v[24:27], v[32:39], v3
ds_read_b128 v[20:23], v15 offset:19456
s_waitcnt lgkmcnt(4)
v_smfmac_f32_16x16x64_bf16 v[48:51], v[28:31], a[40:47], v3
ds_read_b64_tr_b16 v[24:25], v2 offset:6144
v_smfmac_f32_16x16x64_bf16 v[52:55], v[28:31], a[112:119], v3
ds_read_b64_tr_b16 v[26:27], v2 offset:6656
v_smfmac_f32_16x16x64_bf16 v[56:59], v[28:31], a[184:191], v3
ds_read_b128 v[32:35], v15 offset:32768
v_smfmac_f32_16x16x64_bf16 v[60:63], v[28:31], v[72:79], v3
ds_read_b128 v[36:39], v15 offset:33792
s_waitcnt lgkmcnt(6)
v_smfmac_f32_16x16x64_bf16 v[64:67], v[28:31], v[40:47], v3
ds_read_b128 v[40:43], v15 offset:34816
s_waitcnt lgkmcnt(5)
v_smfmac_f32_16x16x64_bf16 v[68:71], v[28:31], v[16:23], v3
ds_read_b128 v[44:47], v15 offset:35840
s_waitcnt lgkmcnt(4)
v_smfmac_f32_16x16x64_bf16 v[48:51], v[24:27], a[48:55], v3
ds_read_b64_tr_b16 v[28:29], v2 offset:7168
v_smfmac_f32_16x16x64_bf16 v[52:55], v[24:27], a[120:127], v3
ds_read_b64_tr_b16 v[30:31], v2 offset:7680
v_smfmac_f32_16x16x64_bf16 v[56:59], v[24:27], a[192:199], v3
ds_read_b128 v[16:19], v15 offset:49152
v_smfmac_f32_16x16x64_bf16 v[60:63], v[24:27], v[80:87], v3
ds_read_b128 v[20:23], v15 offset:50176
s_waitcnt lgkmcnt(6)
v_smfmac_f32_16x16x64_bf16 v[64:67], v[24:27], v[32:39], v3
ds_read_b128 v[32:35], v15 offset:51200
s_waitcnt lgkmcnt(5)
v_smfmac_f32_16x16x64_bf16 v[68:71], v[24:27], v[40:47], v3
ds_read_b128 v[36:39], v15 offset:52224
s_waitcnt lgkmcnt(4)
v_smfmac_f32_16x16x64_bf16 v[48:51], v[28:31], a[56:63], v3
ds_read_b64_tr_b16 v[24:25], v2 offset:8192
v_smfmac_f32_16x16x64_bf16 v[52:55], v[28:31], a[128:135], v3
ds_read_b64_tr_b16 v[26:27], v2 offset:8704
v_smfmac_f32_16x16x64_bf16 v[56:59], v[28:31], a[200:207], v3
ds_read_b128 v[40:43], v14 offset:0
v_smfmac_f32_16x16x64_bf16 v[60:63], v[28:31], v[88:95], v3
ds_read_b128 v[44:47], v14 offset:1024
v_add_u32 v15, 152576, v1
s_waitcnt lgkmcnt(2)
v_smfmac_f32_16x16x64_bf16 v[48:51], v[24:27], a[64:71], v3
v_smfmac_f32_16x16x64_bf16 v[52:55], v[24:27], a[136:143], v3
v_smfmac_f32_16x16x64_bf16 v[56:59], v[24:27], a[208:215], v3
v_smfmac_f32_16x16x64_bf16 v[60:63], v[24:27], v[96:103], v3
s_add_u32 s61, s63, s65
v_smfmac_f32_16x16x64_bf16 v[64:67], v[28:31], v[16:23], v3
v_smfmac_f32_16x16x64_bf16 v[68:71], v[28:31], v[32:39], v3
s_nop 1
v_add_f32 v48, v48, v49
v_add_f32 v50, v50, v51
v_cvt_pk_bf16_f32 v49, v48, v50
s_waitcnt lgkmcnt(0)
v_smfmac_f32_16x16x64_bf16 v[64:67], v[24:27], v[40:47], v3
v_add_f32 v52, v52, v53
v_add_f32 v54, v54, v55
v_cvt_pk_bf16_f32 v53, v52, v54
v_smfmac_f32_16x16x64_bf16 v[68:71], v[24:27], v[248:255], v3
v_add_f32 v56, v56, v57
v_add_f32 v58, v58, v59
v_cvt_pk_bf16_f32 v48, v56, v58
ds_write_b64 v4, v[48:49] offset:0
v_add_f32 v60, v60, v61
v_add_f32 v62, v62, v63
v_cvt_pk_bf16_f32 v52, v60, v62
ds_write_b64 v4, v[52:53] offset:512
buffer_load_dwordx4 v[16:19], v1, s[4:7], s61 offen sc1
buffer_load_dwordx4 v[20:23], v1, s[4:7], s61 offen offset:1024 sc1
v_add_f32 v64, v64, v65
v_add_f32 v66, v66, v67
v_cvt_pk_bf16_f32 v28, v64, v66
v_add_f32 v68, v68, v69
v_add_f32 v70, v70, v71
v_cvt_pk_bf16_f32 v29, v68, v70
s_waitcnt vmcnt(2) lgkmcnt(0)
s_barrier
ds_read_b64_tr_b16 v[48:49], v5 offset:0
ds_read_b64_tr_b16 v[50:51], v5 offset:256
ds_read_b128 v[32:35], v15 offset:2048
ds_read_b128 v[36:39], v15 offset:3072
ds_read_b64_tr_b16 v[52:53], v5 offset:1024
ds_read_b64_tr_b16 v[54:55], v5 offset:1280
ds_read_b128 v[40:43], v15 offset:4096
ds_read_b128 v[44:47], v15 offset:5120
ds_read_b64_tr_b16 v[64:65], v5 offset:2048
ds_read_b64_tr_b16 v[66:67], v5 offset:2304
ds_read_b64_tr_b16 v[68:69], v5 offset:3072
ds_read_b64_tr_b16 v[70:71], v5 offset:3328
s_add_u32 s60, s77, s78
v_and_or_b32 v28, v28, s70, v8
buffer_store_dwordx2 v[28:29], v2, s[4:7], s60 offen sc1
v_mov_b64 v[24:25], 0
v_mov_b64 v[26:27], s[98:99]
s_waitcnt lgkmcnt(10)
s_nop 0
v_mfma_f32_16x16x32_bf16 v[24:27], v[48:51], v[48:51], v[24:27]
s_waitcnt lgkmcnt(8)
v_mfma_f32_16x16x32_bf16 v[56:59], v[32:35], v[48:51], 0
v_mfma_f32_16x16x32_bf16 v[60:63], v[36:39], v[48:51], 0
ds_read_b128 v[32:35], v15 offset:6144
ds_read_b128 v[36:39], v15 offset:7168
s_waitcnt lgkmcnt(8)
v_mfma_f32_16x16x32_bf16 v[24:27], v[52:55], v[52:55], v[24:27]
s_waitcnt lgkmcnt(6)
v_mfma_f32_16x16x32_bf16 v[56:59], v[40:43], v[52:55], v[56:59]
v_mfma_f32_16x16x32_bf16 v[60:63], v[44:47], v[52:55], v[60:63]
ds_read_b128 v[40:43], v15 offset:8192
ds_read_b128 v[44:47], v15 offset:9216
s_waitcnt lgkmcnt(6)
v_mfma_f32_16x16x32_bf16 v[24:27], v[64:67], v[64:67], v[24:27]
s_waitcnt lgkmcnt(2)
v_mfma_f32_16x16x32_bf16 v[56:59], v[32:35], v[64:67], v[56:59]
v_mfma_f32_16x16x32_bf16 v[60:63], v[36:39], v[64:67], v[60:63]
v_mfma_f32_16x16x32_bf16 v[24:27], v[68:71], v[68:71], v[24:27]
s_waitcnt lgkmcnt(0)
v_mfma_f32_16x16x32_bf16 v[56:59], v[40:43], v[68:71], v[56:59]
v_mfma_f32_16x16x32_bf16 v[60:63], v[44:47], v[68:71], v[60:63]
s_set_gpr_idx_on s72, gpr_idx(SRC0)
v_mov_b32 v32, v48
v_mov_b32 v33, v49
v_mov_b32 v34, v50
v_mov_b32 v35, v51
s_set_gpr_idx_off
v_and_or_b32 v32, v32, s70, v8
buffer_store_dwordx4 v[32:35], v12, s[4:7], s77 offen sc1
v_mov_b32 v36, 0x3f803f80
v_mov_b32 v37, 0x3f803f80
v_mov_b32 v45, 0
v_mov_b32 v46, 0
v_mov_b64 v[38:39], v[36:37]
v_max3_f32 v30, v24, v25, v56
v_max3_f32 v30, v30, v57, v58
v_max3_f32 v30, v30, v59, v60
v_max3_f32 v30, v30, v61, v62
v_max_f32 v30, v30, v63
v_mov_b32 v31, v30
s_add_u32 s63, s63, 786432
s_add_u32 s62, s62, 1
v_permlane16_swap_b32 v31, v30
v_max_f32 v30, v30, v31
v_mov_b32 v31, v30
s_and_b32 s64, s62, 1
s_nop 0
v_permlane32_swap_b32 v31, v30
v_max_f32 v30, v30, v31
v_mul_f32 v30, s66, v30
v_pk_fma_f32 v[24:25], v[24:25], s[66:67], v[30:31] op_sel_hi:[1,0,0] neg_lo:[0,0,1] neg_hi:[0,0,1]
v_pk_fma_f32 v[56:57], v[56:57], s[66:67], v[30:31] op_sel_hi:[1,0,0] neg_lo:[0,0,1] neg_hi:[0,0,1]
v_pk_fma_f32 v[58:59], v[58:59], s[66:67], v[30:31] op_sel_hi:[1,0,0] neg_lo:[0,0,1] neg_hi:[0,0,1]
v_pk_fma_f32 v[60:61], v[60:61], s[66:67], v[30:31] op_sel_hi:[1,0,0] neg_lo:[0,0,1] neg_hi:[0,0,1]
v_pk_fma_f32 v[62:63], v[62:63], s[66:67], v[30:31] op_sel_hi:[1,0,0] neg_lo:[0,0,1] neg_hi:[0,0,1]
v_exp_f32 v24, v24
v_exp_f32 v25, v25
v_exp_f32 v56, v56
v_exp_f32 v57, v57
v_cvt_pk_bf16_f32 v44, v24, v25
v_cvt_pk_bf16_f32 v47, v24, v25
v_exp_f32 v58, v58
v_exp_f32 v59, v59
v_mfma_f32_16x16x16_bf16 v[48:51], v[36:37], v[44:45], 0
v_exp_f32 v60, v60
v_mfma_f32_16x16x16_bf16 v[68:71], v[28:29], v[46:47], 0
v_exp_f32 v61, v61
v_mfma_f32_16x16x16_bf16 v[64:67], v[28:29], v[44:45], 0
v_exp_f32 v62, v62
v_exp_f32 v63, v63
v_cvt_pk_bf16_f32 v40, v56, v57
v_cvt_pk_bf16_f32 v41, v58, v59
v_cvt_pk_bf16_f32 v42, v60, v61
v_cvt_pk_bf16_f32 v43, v62, v63
s_waitcnt vmcnt(2)
s_nop 0
v_mfma_f32_16x16x32_bf16 v[48:51], v[36:39], v[40:43], v[48:51]
v_mfma_f32_16x16x32_bf16 v[68:71], v[20:23], v[40:43], v[68:71]
v_mfma_f32_16x16x32_bf16 v[64:67], v[16:19], v[40:43], v[64:67]
s_cmp_eq_u32 s62, 64
s_cbranch_scc1 chain_done_247
v_mov_b32 v13, s64
v_mov_b64 v[24:25], 0
v_mov_b64 v[26:27], 0
v_mov_b64 v[56:57], 0
v_mov_b64 v[58:59], 0
v_mov_b64 v[60:61], 0
v_mov_b64 v[62:63], 0
v_rcp_f32 v52, v48
s_nop 0
v_pk_mul_f32 v[68:69], v[68:69], v[52:53] op_sel_hi:[1,0]
v_pk_mul_f32 v[70:71], v[70:71], v[52:53] op_sel_hi:[1,0]
s_nop 0
v_cvt_pk_bf16_f32 v50, v68, v70
v_cvt_pk_bf16_f32 v51, v69, v71
v_pk_mul_f32 v[64:65], v[64:65], v[52:53] op_sel_hi:[1,0]
v_pk_mul_f32 v[66:67], v[66:67], v[52:53] op_sel_hi:[1,0]
ds_write2_b32 v6, v50, v51 offset0:64 offset1:68
v_cvt_pk_bf16_f32 v48, v64, v66
v_cvt_pk_bf16_f32 v49, v65, v67
ds_write2_b32 v6, v48, v49 offset1:4
v_mov_b64 v[32:33], 0
v_mov_b64 v[34:35], 0
v_mov_b64 v[36:37], 0
v_mov_b64 v[38:39], 0
v_mov_b64 v[40:41], 0
v_mov_b64 v[42:43], 0
v_mov_b64 v[44:45], 0
v_mov_b64 v[46:47], 0
v_add_u32 v20, 152576, v1
s_waitcnt lgkmcnt(0)
s_barrier
ds_read_b128 v[48:51], v20 offset:0
ds_read_b128 v[52:55], v20 offset:1024
v_mov_b64 v[64:65], 0
v_mov_b64 v[66:67], 0
v_mov_b64 v[68:69], 0
v_mov_b64 v[70:71], 0
s_mov_b64 exec, 31
buffer_load_dword v23, v7, s[4:7], s58 offen sc1
s_mov_b64 exec, -1
s_add_u32 s45, s74, 32768
s_waitcnt lgkmcnt(0)
v_smfmac_f32_16x16x64_bf16 v[24:27], v[48:51], v[232:239], v3
v_smfmac_f32_16x16x64_bf16 v[24:27], v[52:55], v[240:247], v3
v_smfmac_f32_16x16x64_bf16 v[32:35], v[48:51], v[104:111], v3
v_smfmac_f32_16x16x64_bf16 v[36:39], v[48:51], v[120:127], v3
v_smfmac_f32_16x16x64_bf16 v[40:43], v[48:51], v[136:143], v3
v_smfmac_f32_16x16x64_bf16 v[44:47], v[48:51], v[152:159], v3
v_smfmac_f32_16x16x64_bf16 v[32:35], v[52:55], v[112:119], v3
s_nop 2
v_add_f32 v24, v24, v25
v_add_f32 v26, v26, v27
v_smfmac_f32_16x16x64_bf16 v[36:39], v[52:55], v[128:135], v3
v_cvt_pk_bf16_f32 v24, v24, v26
v_smfmac_f32_16x16x64_bf16 v[40:43], v[52:55], v[144:151], v3
s_nop 0
v_permlane32_swap_b32 v24, v26
v_smfmac_f32_16x16x64_bf16 v[44:47], v[52:55], v[160:167], v3
s_nop 0
v_permlane16_swap_b32 v24, v25
v_permlane16_swap_b32 v26, v27
v_smfmac_f32_16x16x64_bf16 v[56:59], v[48:51], v[168:175], v3
v_and_or_b32 v24, v24, s70, v13
v_smfmac_f32_16x16x64_bf16 v[60:63], v[48:51], v[184:191], v3
s_mov_b64 exec, 0xffff
buffer_store_dwordx4 v[24:27], v9, s[4:7], s49 offen sc1
s_mov_b64 exec, -1
v_smfmac_f32_16x16x64_bf16 v[64:67], v[48:51], v[200:207], v3
v_add_f32 v32, v32, v33
v_add_f32 v34, v34, v35
v_cvt_pk_bf16_f32 v28, v32, v34
v_smfmac_f32_16x16x64_bf16 v[68:71], v[48:51], v[216:223], v3
v_add_f32 v36, v36, v37
v_add_f32 v38, v38, v39
v_smfmac_f32_16x16x64_bf16 v[56:59], v[52:55], v[176:183], v3
v_cvt_pk_bf16_f32 v29, v36, v38
v_add_f32 v40, v40, v41
v_smfmac_f32_16x16x64_bf16 v[60:63], v[52:55], v[192:199], v3
v_add_f32 v42, v42, v43
v_cvt_pk_bf16_f32 v30, v40, v42
v_add_f32 v44, v44, v45
v_smfmac_f32_16x16x64_bf16 v[64:67], v[52:55], v[208:215], v3
v_add_f32 v46, v46, v47
v_cvt_pk_bf16_f32 v31, v44, v46
v_smfmac_f32_16x16x64_bf16 v[68:71], v[52:55], v[224:231], v3
v_and_or_b32 v28, v28, s70, v13
buffer_store_dwordx4 v[28:31], v9, s[4:7], s74 offen sc1
v_add_f32 v56, v56, v57
v_add_f32 v58, v58, v59
v_cvt_pk_bf16_f32 v32, v56, v58
v_add_f32 v60, v60, v61
v_add_f32 v62, v62, v63
v_cvt_pk_bf16_f32 v33, v60, v62
v_add_f32 v64, v64, v65
v_add_f32 v66, v66, v67
v_cvt_pk_bf16_f32 v34, v64, v66
v_add_f32 v68, v68, v69
v_add_f32 v70, v70, v71
v_cvt_pk_bf16_f32 v35, v68, v70
v_and_or_b32 v32, v32, s70, v13
buffer_store_dwordx4 v[32:35], v9, s[4:7], s45 offen sc1
s_and_b32 s60, s62, 7
s_mul_i32 s60, s60, 131072
s_add_u32 s77, s59, s60
s_bfe_u32 s60, s62, 0x10003
s_xor_b32 s60, s60, 1
v_mov_b32 v8, s60
v_mov_b64 v[64:65], 0
v_mov_b64 v[66:67], 0
v_mov_b64 v[68:69], 0
v_mov_b64 v[70:71], 0
s_lshl_b32 s60, s3, 12
v_add_u32 v15, s60, v1
s_cmp_lg_u32 s48, 0
s_cbranch_scc1 own_311
s_lshl_b32 s45, s3, 11
s_add_u32 s45, s45, s79
s_lshl_b32 s46, s3, 8
s_add_u32 s46, s46, 8192
s_add_u32 s46, s46, s79
v_and_b32 v20, 0xf0, v1
v_add_u32 v21, s68, v20
s_branch noown_308
own_311:
s_sleep 3
s_mov_b32 s67, 0
buffer_load_dwordx4 v[32:35], v1, s[4:7], s75 offen offset:0 sc1
buffer_load_dwordx4 v[36:39], v1, s[4:7], s75 offen offset:1024 sc1
buffer_load_dwordx4 v[40:43], v1, s[4:7], s75 offen offset:2048 sc1
buffer_load_dwordx4 v[44:47], v1, s[4:7], s75 offen offset:3072 sc1
v_and_b32 v20, 15, v0
v_and_b32 v21, 1, v0
v_lshlrev_b32 v21, 4, v21
v_mov_b32 v22, 0x3f80
v_lshlrev_b32 v21, v21, v22
v_lshrrev_b32 v22, 1, v20
v_cmp_eq_u32 vcc, 0, v22
s_nop 1
v_cndmask_b32 v16, 0, v21, vcc
v_cmp_eq_u32 vcc, 1, v22
s_nop 1
v_cndmask_b32 v17, 0, v21, vcc
v_cmp_eq_u32 vcc, 2, v22
s_nop 1
v_cndmask_b32 v18, 0, v21, vcc
v_cmp_eq_u32 vcc, 3, v22
s_nop 1
v_cndmask_b32 v19, 0, v21, vcc
s_lshl_b32 s45, s3, 11
s_add_u32 s45, s45, s79
s_lshl_b32 s46, s3, 8
s_add_u32 s46, s46, 8192
s_add_u32 s46, s46, s79
v_and_b32 v20, 0xf0, v1
v_add_u32 v21, s68, v20
h1_312:
buffer_load_dwordx4 v[48:51], v1, s[4:7], s75 offen offset:0 sc1
buffer_load_dwordx4 v[52:55], v1, s[4:7], s75 offen offset:1024 sc1
buffer_load_dwordx4 v[56:59], v1, s[4:7], s75 offen offset:2048 sc1
buffer_load_dwordx4 v[60:63], v1, s[4:7], s75 offen offset:3072 sc1
s_waitcnt vmcnt(7)
v_mfma_f32_16x16x32_bf16 v[24:27], v[32:35], v[16:19], 0
v_xor_b32 v28, v32, v13
s_waitcnt vmcnt(6)
v_mfma_f32_16x16x32_bf16 v[24:27], v[36:39], v[16:19], v[24:27]
v_bitop3_b32 v28, v28, v36, v13 bitop3:0xf6
s_waitcnt vmcnt(5)
v_mfma_f32_16x16x32_bf16 v[24:27], v[40:43], v[16:19], v[24:27]
v_bitop3_b32 v28, v28, v40, v13 bitop3:0xf6
s_waitcnt vmcnt(4)
v_mfma_f32_16x16x32_bf16 v[24:27], v[44:47], v[16:19], v[24:27]
v_bitop3_b32 v28, v28, v44, v13 bitop3:0xf6
v_and_b32 v28, 1, v28
v_cmp_ne_u32 vcc, 0, v28
s_nop 0
s_cbranch_vccz h1ok_313
s_add_u32 s67, s67, 1
s_cmp_gt_u32 s67, 400000
s_cbranch_scc1 chain_fail_246
buffer_load_dwordx4 v[32:35], v1, s[4:7], s75 offen offset:0 sc1
buffer_load_dwordx4 v[36:39], v1, s[4:7], s75 offen offset:1024 sc1
buffer_load_dwordx4 v[40:43], v1, s[4:7], s75 offen offset:2048 sc1
buffer_load_dwordx4 v[44:47], v1, s[4:7], s75 offen offset:3072 sc1
s_waitcnt vmcnt(7)
v_mfma_f32_16x16x32_bf16 v[24:27], v[48:51], v[16:19], 0
v_xor_b32 v28, v48, v13
s_waitcnt vmcnt(6)
v_mfma_f32_16x16x32_bf16 v[24:27], v[52:55], v[16:19], v[24:27]
v_bitop3_b32 v28, v28, v52, v13 bitop3:0xf6
s_waitcnt vmcnt(5)
v_mfma_f32_16x16x32_bf16 v[24:27], v[56:59], v[16:19], v[24:27]
v_bitop3_b32 v28, v28, v56, v13 bitop3:0xf6
s_waitcnt vmcnt(4)
v_mfma_f32_16x16x32_bf16 v[24:27], v[60:63], v[16:19], v[24:27]
v_bitop3_b32 v28, v28, v60, v13 bitop3:0xf6
v_and_b32 v28, 1, v28
v_cmp_ne_u32 vcc, 0, v28
s_nop 0
s_cbranch_vccnz h1_312
h1ok_313:
s_add_u32 s60, s79, s76
s_nop 1
v_permlane32_swap_b32 v24, v26
v_permlane32_swap_b32 v25, v27
v_add_f32 v24, v24, v26
v_add_f32 v25, v25, v27
v_cvt_pk_bf16_f32 v30, v24, v25
v_min_u32 v30, s70, v30
buffer_store_dword v30, v10, s[4:7], s60 offen sc1
v_mov_b32 v29, -1
s_add_u32 s60, s73, s76
buffer_store_dword v29, v10, s[4:7], s60 offen sc1
noown_308:
s_waitcnt vmcnt(2)
v_mov_b64 v[48:49], 0
v_mov_b64 v[50:51], 0
v_mov_b64 v[52:53], 0
v_mov_b64 v[54:55], 0
v_mov_b64 v[56:57], 0
v_mov_b64 v[58:59], 0
v_mov_b64 v[60:61], 0
v_mov_b64 v[62:63], 0
s_barrier
s_sleep 1
s_mov_b32 s67, 0
h2_314:
buffer_load_dwordx4 v[24:27], v1, s[4:7], s45 offen offset:0 sc1
buffer_load_dwordx4 v[28:31], v1, s[4:7], s45 offen offset:1024 sc1
buffer_load_dwordx4 v[32:35], v20, s[4:7], s46 offen sc1
s_add_u32 s67, s67, 1
s_cmp_gt_u32 s67, 400000
s_cbranch_scc1 chain_fail_246
s_waitcnt vmcnt(2)
ds_write2_b64 v11, v[24:25], v[26:27] offset1:32
v_max3_u32 v16, v24, v25, v26
v_max3_u32 v16, v16, v26, v27
s_waitcnt vmcnt(1)
ds_write2_b64 v11, v[28:29], v[30:31] offset0:128 offset1:160
v_max3_u32 v16, v28, v29, v16
v_max3_u32 v16, v16, v30, v31
s_waitcnt vmcnt(0)
ds_write_b128 v21, v[32:35]
v_max3_u32 v16, v32, v33, v16
v_max3_u32 v16, v16, v34, v35
v_cmp_eq_u32 vcc, -1, v16
s_nop 0
s_cbranch_vccnz h2_314
s_cmp_eq_u32 s3, 3
s_cbranch_scc1 io_309
io_end_310:
s_mov_b32 s60, s79
s_mov_b32 s79, s71
s_mov_b32 s71, s73
s_mov_b32 s73, s60
s_waitcnt lgkmcnt(0)
s_barrier
s_branch chain_loop_307
io_309:
s_sub_u32 s62, s62, 1
s_add_u32 s62, s62, 1
s_add_u32 s61, s62, 1
v_cmp_gt_u32 vcc, s61, v23
s_nop 0
s_and_b32 vcc_lo, vcc_lo, 31
s_cbranch_scc0 io_end_310
s_add_u32 s61, s62, 1
s_mov_b32 s67, 0
sp_loop_315:
buffer_load_dword v32, v7, s[4:7], s58 offen sc1
s_add_u32 s67, s67, 1
s_cmp_gt_u32 s67, 150000
s_cbranch_scc1 sp_bad_317
s_waitcnt vmcnt(0)
v_cmp_gt_u32 vcc, s61, v32
s_nop 0
s_and_b32 vcc_lo, vcc_lo, 31
s_cbranch_scc0 sp_ok_316
s_sleep 1
s_branch sp_loop_315
sp_bad_317:
s_mov_b32 s98, 1792
s_branch L_fail
sp_ok_316:
s_branch io_end_310
chain_fail_246:
v_mov_b32 v24, 0xdead
v_mov_b32 v25, 252
buffer_store_dword v24, v25, s[12:15], 0 offen
s_waitcnt vmcnt(0)
s_endpgm
chain_done_247:
s_endpgm
.p2align 2
L_roles:
.short 0,0,0,0,0,0,0,0,0,0,0,0,0,0,0,0,0,0,0,0,0,0,0,0,0,0,0,0,0,0,0,0
.short 0,0,0,0,0,0,0,0,0,0,0,0,0,0,0,0,0,0,0,0,0,0,0,0,0,0,0,0,0,0,0,0
.short 1024,1025,1280,1281,1282,1283,1284,1285,1286,768,769,512,513,514,0,1,2,3,4,5,6,7,8,9,10,11,256,257,258,259,260,261
.short 1026,1027,1287,1288,1289,1290,1291,1292,1293,770,771,515,516,517,12,13,14,15,16,17,18,19,20,21,22,23,262,263,264,265,266,267
.short 1028,1029,1301,1302,1303,1304,1294,1295,1296,1297,1298,1299,1300,772,773,774,775,518,519,520,521,522,523,24,25,26,27,28,29,268,269,270
.short 1030,1031,1305,1306,1307,1308,1309,1310,1311,1312,1313,1314,1315,776,777,778,779,524,525,526,527,528,529,30,31,32,33,34,35,271,272,273
.short 1032,1033,1034,1035,1316,1317,1318,1319,1320,1321,1322,1323,1324,1325,1326,1327,1328,1329,780,781,530,531,532,36,37,38,39,40,41,274,275,276
.short 1036,1037,1038,1039,1330,1331,1332,1333,1334,1335,1336,1337,1338,1339,1340,1341,1342,1343,782,783,533,534,535,42,43,44,45,46,47,277,278,279
L_writers:
.byte 2,2,3,3,4,4,5,5,6,6,6,6,7,7,7,7,2,2,2,2,2,2,2,3,3,3,3,3,3,3,4,4,4,4,4,4,4,4,4,4,4,5,5,5,5,5,5,5,5,5,5,5,6,6,6,6,6,6,6,6,6,6,6,6
.byte 6,6,7,7,7,7,7,7,7,7,7,7,7,7,7,7,0,0,0,0,0,0,0,0,0,0,0,0,0,0,0,0,0,0,0,0,0,0,0,0,0,0,0,0,0,0,0,0,2,2,2,2,3,3,3,3,4,4,4,4,4,4,4,4
.byte 5,5,5,5,5,5,5,5,6,6,6,6,7,7,7,7,2,2,2,3,3,3,4,4,4,4,4,4,5,5,5,5,5,5,6,6,6,7,7,7,2,2,3,3,4,4,5,5,6,6,6,6,7,7,7,7,2,2,2,2,2,2,2,2
.byte 2,2,2,2,3,3,3,3,3,3,3,3,3,3,3,3,4,4,4,4,4,4,5,5,5,5,5,5,6,6,6,6,6,6,7,7,7,7,7,7,2,2,2,2,2,2,3,3,3,3,3,3,4,4,4,5,5,5,6,6,6,7,7,7
.byte 2,2,3,3,4,4,5,5,6,6,6,6,7,7,7,7,2,2,2,2,2,2,2,3,3,3,3,3,3,3,4,4,4,4,4,4,4,4,4,4,4,5,5,5,5,5,5,5,5,5,5,5,6,6,6,6,6,6,6,6,6,6,6,6
.byte 6,6,7,7,7,7,7,7,7,7,7,7,7,7,7,7,1,1,1,1,1,1,1,1,1,1,1,1,1,1,1,1,1,1,1,1,1,1,1,1,1,1,1,1,1,1,1,1,2,2,2,2,3,3,3,3,4,4,4,4,4,4,4,4
.byte 5,5,5,5,5,5,5,5,6,6,6,6,7,7,7,7,2,2,2,3,3,3,4,4,4,4,4,4,5,5,5,5,5,5,6,6,6,7,7,7,2,2,3,3,4,4,5,5,6,6,6,6,7,7,7,7,2,2,2,2,2,2,2,2
.byte 2,2,2,2,3,3,3,3,3,3,3,3,3,3,3,3,4,4,4,4,4,4,5,5,5,5,5,5,6,6,6,6,6,6,7,7,7,7,7,7,2,2,2,2,2,2,3,3,3,3,3,3,4,4,4,5,5,5,6,6,6,7,7,7
L_code_end:
.section .rodata,"a"
.p2align 6
.amdhsa_kernel interleave_layers__memory_aug_recurrent_mem_tr__glu_gated_swiglu__prompt_kernel
  .amdhsa_next_free_vgpr 512
  .amdhsa_next_free_sgpr 102
  .amdhsa_accum_offset 256
  .amdhsa_group_segment_fixed_size 0
  .amdhsa_kernarg_size 112
  .amdhsa_user_sgpr_count 2
  .amdhsa_user_sgpr_kernarg_segment_ptr 1
  .amdhsa_system_sgpr_workgroup_id_x 1
  .amdhsa_float_denorm_mode_32 3
.end_amdhsa_kernel
```
